```python
import torch

def _softmax(x, axis=-1):
    return torch.softmax(x, dim=axis)
def _gelu(x):
    return torch.nn.functional.gelu(x, approximate="tanh")
def _silu(x):
    return torch.nn.functional.silu(x)
def _sigmoid(x):
    return torch.sigmoid(x)
def _layernorm(x, axis=-1, eps=1e-5):
    m = x.mean(dim=axis, keepdim=True)
    v = x.var(dim=axis, keepdim=True, unbiased=False)
    return (x - m) / torch.sqrt(v + eps)
def _scatter_add(tgt, idx, src, axis=0):
    return tgt.clone().index_add_(axis, idx, src)
def _segment_sum(src, seg, n):
    out = torch.zeros((n,) + src.shape[1:], dtype=src.dtype)
    return out.index_add_(0, seg, src)
def _pad(x, pw):
    flat = tuple(v for pair in reversed(pw) for v in pair)
    return torch.nn.functional.pad(x, flat)

kernel_name = 'gated_mix__compressed_kv_cla__ssm_conv_s5__prompt'

def setup_inputs():

    _w = (lambda a: (lambda t: t.to(torch.bfloat16) if t.is_floating_point() else t)(torch.as_tensor(a)))
    def _A_setup():
        B, H, Sq, Sk, D, M = 1, 32, 2048, 2048, 128, 512
        Dc = 4 * D
        return {
            "x": _w((lambda *s: torch.randn(*s, dtype=torch.bfloat16) * 0.05)(B, Sq, M)),
            "c_kv": _w((lambda *s: torch.randn(*s, dtype=torch.bfloat16) * 0.4)(B, Sk, Dc)),
            "w_q": _w((lambda *s: torch.randn(*s, dtype=torch.bfloat16) * 6.4)(M, H, D) * (M ** -0.5)),
            "w_uk": _w((lambda *s: torch.randn(*s, dtype=torch.bfloat16) * 6.4)(Dc, H, D) * (Dc ** -0.5)),
            "w_uv": _w((lambda *s: torch.randn(*s, dtype=torch.bfloat16) * 0.4)(Dc, H, D) * (Dc ** -0.5)),
            "w_o": _w((lambda *s: torch.randn(*s, dtype=torch.bfloat16) * 0.4)(H, D, M) * ((H * D) ** -0.5)),
        }
    _A_in = _A_setup()

    def _B_setup():
        B, S, D = 1, 2048, 512
        P = D
        Lambda_re = -0.5 * (lambda _x: torch.exp(torch.as_tensor(_x)))((lambda *s: torch.randn(*s, dtype=torch.bfloat16) * 0.4)(P))
        Lambda_im = (lambda *s: torch.randn(*s, dtype=torch.bfloat16) * 0.4)(P) * 1.0
        B_re = (lambda *s: torch.randn(*s, dtype=torch.bfloat16) * 0.4)(P, D) * (D ** -0.5)
        B_im = (lambda *s: torch.randn(*s, dtype=torch.bfloat16) * 0.4)(P, D) * (D ** -0.5)
        C_re = (lambda *s: torch.randn(*s, dtype=torch.bfloat16) * 0.4)(D, P) * (P ** -0.5)
        C_im = (lambda *s: torch.randn(*s, dtype=torch.bfloat16) * 0.4)(D, P) * (P ** -0.5)
        log_dt = (lambda *s: torch.randn(*s, dtype=torch.bfloat16) * 0.4)(P) * 0.3 - 2.0
        Dskip = (lambda *s: torch.randn(*s, dtype=torch.bfloat16) * 0.05)(D)
        return {
            "x": _w((lambda *s: torch.randn(*s, dtype=torch.bfloat16) * 0.05)(B, S, D)),
            "Lambda_re": _w(Lambda_re),
            "Lambda_im": _w(Lambda_im),
            "B_re": _w(B_re),
            "B_im": _w(B_im),
            "C_re": _w(C_re),
            "C_im": _w(C_im),
            "log_dt": _w(log_dt),
            "Dskip": _w(Dskip),
        }
    _B_in = _B_setup()

    return {
        "A_x": _A_in["x"],
        "A_c_kv": _A_in["c_kv"],
        "A_w_q": _A_in["w_q"],
        "A_w_uk": _A_in["w_uk"],
        "A_w_uv": _A_in["w_uv"],
        "A_w_o": _A_in["w_o"],
        "B_x": _B_in["x"],
        "B_Lambda_re": _B_in["Lambda_re"],
        "B_Lambda_im": _B_in["Lambda_im"],
        "B_B_re": _B_in["B_re"],
        "B_B_im": _B_in["B_im"],
        "B_C_re": _B_in["C_re"],
        "B_C_im": _B_in["C_im"],
        "B_log_dt": _B_in["log_dt"],
        "B_Dskip": _B_in["Dskip"],
        "gate_w": _w((lambda *s: torch.randn(*s, dtype=torch.bfloat16) * 0.05)(512) * 16.0),
    }

def reference(A_x, A_c_kv, A_w_q, A_w_uk, A_w_uv, A_w_o, B_x, B_Lambda_re, B_Lambda_im, B_B_re, B_B_im, B_C_re, B_C_im, B_log_dt, B_Dskip, gate_w):
    def _A_ref(x, c_kv, w_q, w_uk, w_uv, w_o):
        B, Sq, M = x.shape[0], x.shape[1], x.shape[2]
        Sk = c_kv.shape[1]
        H, D = w_q.shape[1], w_q.shape[2]
        q = torch.einsum("bqm,mhd->bhqd", x, w_q)
        k = torch.einsum("bkc,chd->bhkd", c_kv, w_uk)
        v = torch.einsum("bkc,chd->bhkd", c_kv, w_uv)
        scores = torch.einsum("bhqd,bhkd->bhqk", q, k) * (D ** -0.5)
        off = Sk - Sq
        qi = torch.arange(Sq)[:, None]
        kj = torch.arange(Sk)[None, :]
        cmask = kj <= (qi + off)
        scores = torch.where(cmask[None, None], scores, -1e9)
        p = _softmax(scores, axis=-1)
        ctx = torch.einsum("bhqk,bhkd->bhqd", p, v)
        return torch.einsum("bhqd,hdm->bqm", ctx, w_o)

    def _B_ref(x, Lambda_re, Lambda_im, B_re, B_im, C_re, C_im, log_dt, Dskip):
        Bsz, L, H = x.shape
        Lam = Lambda_re + 1j * Lambda_im
        Bmat = B_re + 1j * B_im
        Cmat = C_re + 1j * C_im
        dt = torch.exp(log_dt)
        Lam_bar = torch.exp(dt * Lam)
        B_bar = ((Lam_bar - 1.0) / Lam)[:, None] * Bmat
        Bu = torch.einsum("bld,pd->blp", x + 0j, B_bar)
        h = torch.zeros_like(Bu[:, 0, :])
        hs = []
        for t in range(L):
            h = Lam_bar[None, :] * h + Bu[:, t, :]
            hs.append(h)
        hseq = torch.stack(hs, 1)
        y = 2.0 * torch.einsum("blp,dp->bld", hseq, Cmat).real + x * Dskip[None, None, :]
        return y

    x = A_x
    g = _sigmoid((x * gate_w).sum(-1, keepdims=True))
    a = _A_ref(x, A_c_kv, A_w_q, A_w_uk, A_w_uv, A_w_o)
    b = _B_ref(x, B_Lambda_re, B_Lambda_im, B_B_re, B_B_im, B_C_re, B_C_im, B_log_dt, B_Dskip)
    return g * a + (1 - g) * b
```

```asm
; @launch kernel=gated_mix__compressed_kv_cla__ssm_conv_s5__prompt_kernel grid=(256,1,1) block=(256,1,1) lds=163840
.amdgcn_target "amdgcn-amd-amdhsa--gfx950"
.text
.globl gated_mix__compressed_kv_cla__ssm_conv_s5__prompt_kernel
.p2align 8
.type gated_mix__compressed_kv_cla__ssm_conv_s5__prompt_kernel,@function
gated_mix__compressed_kv_cla__ssm_conv_s5__prompt_kernel:
s_cmp_ge_u32 s2, 256
s_cbranch_scc1 LA_end
s_load_dwordx16 s[36:51], s[0:1], 0
s_load_dwordx16 s[52:67], s[0:1], 64
s_load_dwordx4 s[68:71], s[0:1], 128
s_load_dwordx2 s[72:73], s[0:1], 144
s_getpc_b64 s[30:31]
LA_pc:
s_lshr_b32 s3, s2, 3
s_lshl_b32 s3, s3, 12
v_lshl_add_u32 v4, v0, 4, s3
v_min_u32 v4, LA_last-LA_pc, v4
v_mad_u64_u32 v[4:5], s[4:5], v4, 1, s[30:31]
global_load_dword v60, v[4:5], off
v_lshrrev_b32 v1, 6, v0
v_and_b32 v3, 63, v0
v_readfirstlane_b32 s80, v1
s_and_b32 s84, s2, 7
s_bfe_u32 s85, s2, 0x20003
s_lshr_b32 s82, s2, 5
s_lshl_b32 s81, s84, 2
s_add_u32 s81, s81, s85
v_lshlrev_b32 v0, 4, v3
v_and_b32 v36, 15, v3
v_lshrrev_b32 v37, 4, v3
v_and_b32 v38, 7, v3
v_lshrrev_b32 v39, 3, v3
s_add_u32 s83, s82, s84
s_and_b32 s83, s83, 7
s_lshl_b32 s86, s83, 19
s_lshl_b32 s83, s83, 7
s_mov_b32 s87, s83
s_mov_b32 s100, s83
s_and_b32 s3, s80, 1
s_lshr_b32 s33, s80, 1
s_lshl_b32 s96, s80, 12
s_add_u32 s96, s96, 98304
s_mul_i32 s97, s33, 49152
s_lshl_b32 s32, s3, 13
s_add_u32 s97, s97, s32
v_lshrrev_b32 v40, 1, v36
v_xor_b32 v40, v40, v37
v_and_b32 v41, 1, v36
v_lshlrev_b32 v41, 4, v41
v_lshl_or_b32 v41, v37, 13, v41
v_lshl_or_b32 v42, v40, 5, v41
s_lshl_b32 s32, s3, 17
v_add_u32 v14, s32, v42
v_add_u32 v15, 31744, v14
v_xor_b32 v43, 128, v14
v_add_u32 v16, 63488, v43
v_add_u32 v17, 95232, v43
v_lshrrev_b32 v43, 1, v39
v_xor_b32 v43, v43, v38
s_lshl_b32 s32, s80, 1
v_xor_b32 v43, s32, v43
v_lshlrev_b32 v43, 4, v43
v_lshl_or_b32 v18, v39, 10, v43
v_xor_b32 v43, 64, v18
v_add_u32 v19, 7168, v43
v_add_u32 v20, 14336, v18
v_add_u32 v21, 21504, v43
s_lshl_b32 s34, s82, 17
s_lshl_b32 s35, s3, 20
s_add_u32 s34, s34, s35
s_lshl_b32 s35, s33, 16
s_add_u32 s34, s34, s35
s_lshl_b32 s35, s81, 8
s_cmp_eq_u32 s33, 0
s_waitcnt lgkmcnt(0)
s_cselect_b32 s12, s42, s44
s_cselect_b32 s13, s43, s45
s_add_u32 s12, s12, s35
s_addc_u32 s13, s13, 0
s_mov_b32 s14, 0x3fe100
s_mov_b32 s15, 0x20000
s_add_u32 s4, s38, s34
s_addc_u32 s5, s39, 0
s_mov_b32 s6, 65536
s_mov_b32 s7, 0x20000
s_add_u32 m0, s96, 0
s_nop 0
buffer_load_dwordx4 v14, s[12:15], s86 offen offset:0 lds
buffer_load_dwordx4 v15, s[12:15], s86 offen offset:1024 lds
buffer_load_dwordx4 v16, s[12:15], s86 offen offset:2048 lds
buffer_load_dwordx4 v17, s[12:15], s86 offen offset:3072 lds
s_add_u32 s86, s86, 0x40000
s_and_b32 s86, s86, 0x3c0000
s_add_u32 m0, s97, 0
s_add_u32 s74, s87, 0
buffer_load_dwordx4 v18, s[4:7], s74 offen offset:0 lds
buffer_load_dwordx4 v19, s[4:7], s74 offen offset:1024 lds
buffer_load_dwordx4 v20, s[4:7], s74 offen offset:2048 lds
buffer_load_dwordx4 v21, s[4:7], s74 offen offset:3072 lds
s_add_u32 m0, s97, 4096
s_add_u32 s74, s87, 32768
buffer_load_dwordx4 v18, s[4:7], s74 offen offset:0 lds
buffer_load_dwordx4 v19, s[4:7], s74 offen offset:1024 lds
buffer_load_dwordx4 v20, s[4:7], s74 offen offset:2048 lds
buffer_load_dwordx4 v21, s[4:7], s74 offen offset:3072 lds
s_add_u32 s87, s87, 128
s_and_b32 s87, s87, 1023
v_and_b32 v44, 3, v3
v_lshl_add_u32 v44, v44, 6, s87
v_and_b32 v44, 1023, v44
v_lshrrev_b32 v45, 2, v3
v_lshl_or_b32 v44, v45, 10, v44
s_lshl_b32 s34, s85, 14
buffer_load_dword v35, v44, s[4:7], s34 offen
s_add_u32 s16, s40, s35
s_addc_u32 s17, s41, 0
s_mov_b32 s18, 0x3fe100
s_mov_b32 s19, 0x20000
s_lshl_b32 s34, s80, 14
s_add_u32 s8, s36, s34
s_addc_u32 s9, s37, 0
s_mov_b32 s10, 0
s_mov_b32 s11, 0x20000
s_sub_u32 s10, 0x200000, s34
s_lshl_b32 s34, s81, 20
s_add_u32 s20, s72, s34
s_addc_u32 s21, s73, 0
s_mov_b32 s22, 0x100000
s_mov_b32 s23, 0x20000
s_mov_b32 s24, s70
s_mov_b32 s25, s71
s_mov_b32 s26, 256
s_mov_b32 s27, 0x20000
s_mov_b32 s76, s72
s_mov_b32 s77, s73
s_mov_b32 s78, 0x10000000
s_mov_b32 s79, 0x20000
s_mov_b64 s[72:73], s[30:31]
s_lshl_b32 s34, s81, 14
s_cmp_eq_u32 s3, 0
s_cselect_b32 s28, s54, s56
s_cselect_b32 s29, s55, s57
s_add_u32 s28, s28, s34
s_addc_u32 s29, s29, 0
s_mov_b32 s30, 16384
s_mov_b32 s31, 0x20000
s_lshl_b32 s98, s82, 17
s_sub_u32 s99, 0x1e0000, s98
s_lshl_b32 s34, s82, 16
s_lshl_b32 s35, s3, 15
s_add_u32 s34, s34, s35
s_lshl_b32 s35, s33, 13
s_add_u32 s88, s34, s35
s_add_u32 s89, s88, 4096
s_add_u32 s90, s88, 16384
s_add_u32 s91, s88, 20480
s_add_u32 s92, s88, 524288
s_add_u32 s93, s88, 528384
s_add_u32 s94, s88, 540672
s_add_u32 s95, s88, 544768
v_lshrrev_b32 v44, 2, v36
v_and_b32 v45, 1, v37
v_lshl_or_b32 v45, v45, 2, v44
v_lshl_add_u32 v46, v37, 3, v44
v_lshlrev_b32 v46, 8, v46
v_lshl_or_b32 v46, v45, 5, v46
v_and_b32 v47, 3, v36
v_lshl_or_b32 v46, v47, 3, v46
s_lshl_b32 s34, s33, 13
s_add_u32 s34, s34, 98304
v_add_u32 v2, s34, v46
v_xor_b32 v3, 32, v2
v_xor_b32 v4, 64, v2
v_xor_b32 v5, 96, v2
v_xor_b32 v6, 128, v2
v_xor_b32 v7, 160, v2
v_xor_b32 v8, 192, v2
v_xor_b32 v9, 224, v2
v_lshlrev_b32 v46, 4, v40
v_lshl_or_b32 v46, v36, 7, v46
s_mul_i32 s34, s3, 49216
s_lshl_b32 s35, s3, 6
v_xor_b32 v45, s35, v46
s_mul_i32 s34, s3, 49152
v_add_u32 v10, s34, v45
v_xor_b32 v11, 32, v10
v_xor_b32 v12, 64, v10
v_xor_b32 v13, 96, v10
s_lshl_b32 s35, s80, 5
v_xor_b32 v45, s35, v46
v_add_u32 v26, s97, v45
v_xor_b32 v27, 64, v26
s_mul_i32 s34, s3, 3
v_xor_b32 v44, s34, v44
v_lshrrev_b32 v45, 1, v47
v_xor_b32 v45, v45, v37
v_lshlrev_b32 v46, 1, v44
v_xor_b32 v45, v45, v46
v_lshlrev_b32 v45, 4, v45
v_lshl_or_b32 v45, v47, 7, v45
v_and_b32 v46, 1, v44
v_lshl_or_b32 v45, v46, 13, v45
v_lshrrev_b32 v46, 1, v44
v_mul_u32_u24 v46, 49152, v46
s_lshl_b32 s34, s80, 11
v_add3_u32 v28, v45, v46, s34
v_xor_b32 v29, 32, v28
v_xor_b32 v30, 64, v28
v_xor_b32 v31, 96, v28
v_add_u32 v32, 106496, v0
v_lshlrev_b32 v25, 4, v37
v_lshl_or_b32 v24, v36, 10, v25
v_and_b32 v45, 0x30, v0
v_lshl_or_b32 v25, v45, 8, v25
s_lshl_b32 s34, s80, 15
s_sub_u32 s34, 0x18000, s34
v_add_u32 v22, s34, v20
v_add_u32 v23, s34, v21
s_lshl_b32 s34, s3, 7
v_xor_b32 v45, s34, v42
s_lshl_b32 s34, s80, 16
v_add_u32 v33, s34, v45
v_add_u32 v34, 31744, v33
s_lshl_b32 s101, s3, 10
s_add_u32 s101, s101, 106496
s_mov_b32 s32, s66
s_mov_b32 s33, s67
s_mov_b32 s34, 1024
s_mov_b32 s35, 0x20000
s_lshl_b32 s38, s2, 2
s_add_u32 s38, s38, s80
s_lshl_b32 s38, s38, 14
s_add_u32 s38, s38, 67108864
s_lshl_b32 s42, s84, 3
s_add_u32 s42, s42, s82
s_lshl_b32 s42, s42, 8
s_add_u32 s42, s42, 55574528
s_lshl3_add_u32 s43, s80, s85
s_lshl2_add_u32 s43, s43, s42
s_lshl2_add_u32 s44, s85, s80
s_lshl2_add_u32 s44, s44, s42
s_lshl_b32 s40, s81, 7
s_add_u32 s40, s40, 55590912
s_lshr_b32 s41, s2, 3
s_lshl_b32 s41, s41, 7
s_add_u32 s41, s41, 55607296
s_lshl3_add_u32 s74, s80, s82
s_lshl2_add_u32 s74, s74, s40
s_lshl2_add_u32 s75, s84, s41
s_cmp_eq_u32 s80, 3
s_cselect_b32 s74, s75, s74
v_mov_b32 v1, 0
s_add_u32 m0, s96, 16384
s_nop 0
buffer_load_dwordx4 v14, s[12:15], s86 offen offset:0 lds
buffer_load_dwordx4 v15, s[12:15], s86 offen offset:1024 lds
buffer_load_dwordx4 v16, s[12:15], s86 offen offset:2048 lds
buffer_load_dwordx4 v17, s[12:15], s86 offen offset:3072 lds
s_add_u32 s86, s86, 0x40000
s_and_b32 s86, s86, 0x3c0000
s_lshl_b32 s75, s81, 5
v_bfe_u32 v72, v0, 4, 4
v_lshl_add_u32 v72, v72, 1, s75
global_load_ushort a180, v72, s[50:51]
global_load_ushort a181, v72, s[52:53]
global_load_ushort a182, v72, s[62:63]
s_mov_b64 exec, 1
buffer_store_dword v1, off, s[76:79], s74 sc1
buffer_store_dword v1, off, s[76:79], s43 sc1
buffer_store_dword v1, off, s[76:79], s44 offset:128 sc1
buffer_store_dword v1, off, s[76:79], s43 offset:16 sc1
s_mov_b64 exec, -1
v_accvgpr_write_b32 a164, -1
v_accvgpr_write_b32 a165, -1
v_accvgpr_write_b32 a166, -1
v_accvgpr_write_b32 a167, -1
s_waitcnt vmcnt(12)
s_barrier
ds_read_b128 a[68:71], v10 offset:0
ds_read_b64_tr_b16 a[36:37], v2 offset:0
ds_read_b64_tr_b16 a[38:39], v2 offset:1024
ds_read_b128 a[72:75], v10 offset:2048
ds_read_b64_tr_b16 a[40:41], v3 offset:0
ds_read_b64_tr_b16 a[42:43], v3 offset:1024
ds_read_b128 a[76:79], v10 offset:4096
ds_read_b64_tr_b16 a[44:45], v4 offset:0
ds_read_b64_tr_b16 a[46:47], v4 offset:1024
ds_read_b128 a[80:83], v10 offset:6144
ds_read_b64_tr_b16 a[48:49], v5 offset:0
ds_read_b64_tr_b16 a[50:51], v5 offset:1024
ds_read_b128 a[84:87], v11 offset:8192
ds_read_b64_tr_b16 a[52:53], v6 offset:0
ds_read_b64_tr_b16 a[54:55], v6 offset:1024
ds_read_b128 a[88:91], v11 offset:10240
ds_read_b64_tr_b16 a[56:57], v7 offset:0
ds_read_b64_tr_b16 a[58:59], v7 offset:1024
ds_read_b128 a[92:95], v11 offset:12288
ds_read_b64_tr_b16 a[60:61], v8 offset:0
ds_read_b64_tr_b16 a[62:63], v8 offset:1024
ds_read_b128 a[96:99], v11 offset:14336
ds_read_b64_tr_b16 a[64:65], v9 offset:0
ds_read_b64_tr_b16 a[66:67], v9 offset:1024
s_cmp_ge_u32 s80, 2
s_cbranch_scc1 LA_v
s_waitcnt lgkmcnt(15)
v_mfma_f32_16x16x32_bf16 v[36:39], a[36:39], a[68:71], 0
s_waitcnt lgkmcnt(15)
s_add_u32 m0, s97, 16384
s_add_u32 s74, s87, 0
v_mfma_f32_16x16x32_bf16 v[52:55], a[36:39], a[72:75], 0
s_waitcnt lgkmcnt(15)
buffer_load_dwordx4 v18, s[4:7], s74 offen offset:0 lds
v_mfma_f32_16x16x32_bf16 v[68:71], a[36:39], a[76:79], 0
s_waitcnt lgkmcnt(14)
v_mfma_f32_16x16x32_bf16 v[84:87], a[36:39], a[80:83], 0
s_waitcnt lgkmcnt(11)
v_mfma_f32_16x16x32_bf16 v[100:103], a[36:39], a[84:87], 0
s_waitcnt lgkmcnt(8)
v_mfma_f32_16x16x32_bf16 v[116:119], a[36:39], a[88:91], 0
s_waitcnt lgkmcnt(5)
buffer_load_dwordx4 v19, s[4:7], s74 offen offset:1024 lds
v_mfma_f32_16x16x32_bf16 v[132:135], a[36:39], a[92:95], 0
s_waitcnt lgkmcnt(2)
v_mfma_f32_16x16x32_bf16 v[148:151], a[36:39], a[96:99], 0
v_mfma_f32_16x16x32_bf16 v[240:243], a[40:43], a[96:99], 0
v_mfma_f32_16x16x32_bf16 v[224:227], a[40:43], a[92:95], 0
buffer_load_dwordx4 v20, s[4:7], s74 offen offset:2048 lds
v_mfma_f32_16x16x32_bf16 v[208:211], a[40:43], a[88:91], 0
v_mfma_f32_16x16x32_bf16 v[192:195], a[40:43], a[84:87], 0
v_mfma_f32_16x16x32_bf16 v[188:191], a[40:43], a[80:83], 0
v_mfma_f32_16x16x32_bf16 v[180:183], a[40:43], a[76:79], 0
buffer_load_dwordx4 v21, s[4:7], s74 offen offset:3072 lds
v_mfma_f32_16x16x32_bf16 v[172:175], a[40:43], a[72:75], 0
s_add_u32 m0, s97, 20480
s_add_u32 s74, s87, 32768
v_mfma_f32_16x16x32_bf16 v[164:167], a[40:43], a[68:71], 0
v_mfma_f32_16x16x32_bf16 v[40:43], a[44:47], a[68:71], 0
v_mfma_f32_16x16x32_bf16 v[56:59], a[44:47], a[72:75], 0
buffer_load_dwordx4 v18, s[4:7], s74 offen offset:0 lds
v_mfma_f32_16x16x32_bf16 v[72:75], a[44:47], a[76:79], 0
v_mfma_f32_16x16x32_bf16 v[88:91], a[44:47], a[80:83], 0
v_mfma_f32_16x16x32_bf16 v[104:107], a[44:47], a[84:87], 0
v_mfma_f32_16x16x32_bf16 v[120:123], a[44:47], a[88:91], 0
buffer_load_dwordx4 v19, s[4:7], s74 offen offset:1024 lds
v_mfma_f32_16x16x32_bf16 v[136:139], a[44:47], a[92:95], 0
v_mfma_f32_16x16x32_bf16 v[152:155], a[44:47], a[96:99], 0
v_mfma_f32_16x16x32_bf16 v[244:247], a[48:51], a[96:99], 0
s_waitcnt vmcnt(13) lgkmcnt(0)
s_barrier
v_mfma_f32_16x16x32_bf16 v[228:231], a[48:51], a[92:95], 0
buffer_load_dwordx4 v20, s[4:7], s74 offen offset:2048 lds
v_mfma_f32_16x16x32_bf16 v[212:215], a[48:51], a[88:91], 0
ds_read_b128 a[132:135], v12 offset:0
v_mfma_f32_16x16x32_bf16 v[196:199], a[48:51], a[84:87], 0
ds_read_b64_tr_b16 a[100:101], v2 offset:16384
v_mfma_f32_16x16x32_bf16 a[24:27], a[48:51], a[80:83], 0
ds_read_b64_tr_b16 a[102:103], v2 offset:17408
v_mfma_f32_16x16x32_bf16 a[16:19], a[48:51], a[76:79], 0
buffer_load_dwordx4 v21, s[4:7], s74 offen offset:3072 lds
v_mfma_f32_16x16x32_bf16 a[8:11], a[48:51], a[72:75], 0
s_add_u32 s87, s87, 128
s_and_b32 s87, s87, 1023
s_add_u32 m0, s96, 32768
v_mfma_f32_16x16x32_bf16 a[0:3], a[48:51], a[68:71], 0
ds_read_b128 a[136:139], v12 offset:2048
v_mfma_f32_16x16x32_bf16 v[44:47], a[52:55], a[68:71], 0
ds_read_b64_tr_b16 a[104:105], v3 offset:16384
v_mfma_f32_16x16x32_bf16 v[60:63], a[52:55], a[72:75], 0
buffer_load_dwordx4 v14, s[12:15], s86 offen offset:0 lds
v_mfma_f32_16x16x32_bf16 v[76:79], a[52:55], a[76:79], 0
ds_read_b64_tr_b16 a[106:107], v3 offset:17408
v_mfma_f32_16x16x32_bf16 v[92:95], a[52:55], a[80:83], 0
ds_read_b128 a[140:143], v12 offset:4096
v_mfma_f32_16x16x32_bf16 v[108:111], a[52:55], a[84:87], 0
ds_read_b64_tr_b16 a[108:109], v4 offset:16384
v_mfma_f32_16x16x32_bf16 v[124:127], a[52:55], a[88:91], 0
buffer_load_dwordx4 v15, s[12:15], s86 offen offset:1024 lds
v_mfma_f32_16x16x32_bf16 v[140:143], a[52:55], a[92:95], 0
ds_read_b64_tr_b16 a[110:111], v4 offset:17408
v_mfma_f32_16x16x32_bf16 v[156:159], a[52:55], a[96:99], 0
ds_read_b128 a[144:147], v12 offset:6144
v_mfma_f32_16x16x32_bf16 v[248:251], a[56:59], a[96:99], 0
ds_read_b64_tr_b16 a[112:113], v5 offset:16384
v_mfma_f32_16x16x32_bf16 v[232:235], a[56:59], a[92:95], 0
buffer_load_dwordx4 v16, s[12:15], s86 offen offset:2048 lds
v_mfma_f32_16x16x32_bf16 v[216:219], a[56:59], a[88:91], 0
ds_read_b64_tr_b16 a[114:115], v5 offset:17408
v_mfma_f32_16x16x32_bf16 v[200:203], a[56:59], a[84:87], 0
ds_read_b128 a[148:151], v13 offset:8192
v_mfma_f32_16x16x32_bf16 a[28:31], a[56:59], a[80:83], 0
ds_read_b64_tr_b16 a[116:117], v6 offset:16384
v_mfma_f32_16x16x32_bf16 v[184:187], a[56:59], a[76:79], 0
buffer_load_dwordx4 v17, s[12:15], s86 offen offset:3072 lds
v_mfma_f32_16x16x32_bf16 v[176:179], a[56:59], a[72:75], 0
s_add_u32 s86, s86, 0x40000
s_and_b32 s86, s86, 0x3c0000
s_add_u32 m0, s96, 49152
v_mfma_f32_16x16x32_bf16 v[168:171], a[56:59], a[68:71], 0
ds_read_b64_tr_b16 a[118:119], v6 offset:17408
v_mfma_f32_16x16x32_bf16 v[48:51], a[60:63], a[68:71], 0
ds_read_b128 a[152:155], v13 offset:10240
v_mfma_f32_16x16x32_bf16 v[64:67], a[60:63], a[72:75], 0
buffer_load_dwordx4 v14, s[12:15], s86 offen offset:0 lds
v_mfma_f32_16x16x32_bf16 v[80:83], a[60:63], a[76:79], 0
ds_read_b64_tr_b16 a[120:121], v7 offset:16384
v_mfma_f32_16x16x32_bf16 v[96:99], a[60:63], a[80:83], 0
ds_read_b64_tr_b16 a[122:123], v7 offset:17408
v_mfma_f32_16x16x32_bf16 v[112:115], a[60:63], a[84:87], 0
ds_read_b128 a[156:159], v13 offset:12288
v_mfma_f32_16x16x32_bf16 v[128:131], a[60:63], a[88:91], 0
buffer_load_dwordx4 v15, s[12:15], s86 offen offset:1024 lds
v_mfma_f32_16x16x32_bf16 v[144:147], a[60:63], a[92:95], 0
ds_read_b64_tr_b16 a[124:125], v8 offset:16384
v_mfma_f32_16x16x32_bf16 v[160:163], a[60:63], a[96:99], 0
ds_read_b64_tr_b16 a[126:127], v8 offset:17408
v_mfma_f32_16x16x32_bf16 v[252:255], a[64:67], a[96:99], 0
ds_read_b128 a[160:163], v13 offset:14336
v_mfma_f32_16x16x32_bf16 v[236:239], a[64:67], a[92:95], 0
buffer_load_dwordx4 v16, s[12:15], s86 offen offset:2048 lds
v_mfma_f32_16x16x32_bf16 v[220:223], a[64:67], a[88:91], 0
ds_read_b64_tr_b16 a[128:129], v9 offset:16384
v_mfma_f32_16x16x32_bf16 v[204:207], a[64:67], a[84:87], 0
ds_read_b64_tr_b16 a[130:131], v9 offset:17408
v_mfma_f32_16x16x32_bf16 a[32:35], a[64:67], a[80:83], 0
v_mfma_f32_16x16x32_bf16 a[20:23], a[64:67], a[76:79], 0
buffer_load_dwordx4 v17, s[12:15], s86 offen offset:3072 lds
v_mfma_f32_16x16x32_bf16 a[12:15], a[64:67], a[72:75], 0
s_add_u32 s86, s86, 0x40000
s_and_b32 s86, s86, 0x3c0000
v_mfma_f32_16x16x32_bf16 a[4:7], a[64:67], a[68:71], 0
s_waitcnt lgkmcnt(15)
v_mfma_f32_16x16x32_bf16 v[36:39], a[100:103], a[132:135], v[36:39]
s_waitcnt lgkmcnt(15)
s_add_u32 m0, s97, 32768
s_add_u32 s74, s87, 0
v_mfma_f32_16x16x32_bf16 v[52:55], a[100:103], a[136:139], v[52:55]
s_waitcnt lgkmcnt(15)
buffer_load_dwordx4 v18, s[4:7], s74 offen offset:0 lds
v_mfma_f32_16x16x32_bf16 v[68:71], a[100:103], a[140:143], v[68:71]
s_waitcnt lgkmcnt(14)
v_mfma_f32_16x16x32_bf16 v[84:87], a[100:103], a[144:147], v[84:87]
s_waitcnt lgkmcnt(11)
v_mfma_f32_16x16x32_bf16 v[100:103], a[100:103], a[148:151], v[100:103]
s_waitcnt lgkmcnt(8)
v_mfma_f32_16x16x32_bf16 v[116:119], a[100:103], a[152:155], v[116:119]
s_waitcnt lgkmcnt(5)
buffer_load_dwordx4 v19, s[4:7], s74 offen offset:1024 lds
v_mfma_f32_16x16x32_bf16 v[132:135], a[100:103], a[156:159], v[132:135]
s_waitcnt lgkmcnt(2)
v_mfma_f32_16x16x32_bf16 v[148:151], a[100:103], a[160:163], v[148:151]
v_mfma_f32_16x16x32_bf16 v[240:243], a[104:107], a[160:163], v[240:243]
v_mfma_f32_16x16x32_bf16 v[224:227], a[104:107], a[156:159], v[224:227]
buffer_load_dwordx4 v20, s[4:7], s74 offen offset:2048 lds
v_mfma_f32_16x16x32_bf16 v[208:211], a[104:107], a[152:155], v[208:211]
v_mfma_f32_16x16x32_bf16 v[192:195], a[104:107], a[148:151], v[192:195]
v_mfma_f32_16x16x32_bf16 v[188:191], a[104:107], a[144:147], v[188:191]
v_mfma_f32_16x16x32_bf16 v[180:183], a[104:107], a[140:143], v[180:183]
buffer_load_dwordx4 v21, s[4:7], s74 offen offset:3072 lds
v_mfma_f32_16x16x32_bf16 v[172:175], a[104:107], a[136:139], v[172:175]
s_add_u32 m0, s97, 36864
s_add_u32 s74, s87, 32768
v_mfma_f32_16x16x32_bf16 v[164:167], a[104:107], a[132:135], v[164:167]
v_mfma_f32_16x16x32_bf16 v[40:43], a[108:111], a[132:135], v[40:43]
v_mfma_f32_16x16x32_bf16 v[56:59], a[108:111], a[136:139], v[56:59]
buffer_load_dwordx4 v18, s[4:7], s74 offen offset:0 lds
v_mfma_f32_16x16x32_bf16 v[72:75], a[108:111], a[140:143], v[72:75]
v_mfma_f32_16x16x32_bf16 v[88:91], a[108:111], a[144:147], v[88:91]
v_mfma_f32_16x16x32_bf16 v[104:107], a[108:111], a[148:151], v[104:107]
v_mfma_f32_16x16x32_bf16 v[120:123], a[108:111], a[152:155], v[120:123]
buffer_load_dwordx4 v19, s[4:7], s74 offen offset:1024 lds
v_mfma_f32_16x16x32_bf16 v[136:139], a[108:111], a[156:159], v[136:139]
v_mfma_f32_16x16x32_bf16 v[152:155], a[108:111], a[160:163], v[152:155]
v_mfma_f32_16x16x32_bf16 v[244:247], a[112:115], a[160:163], v[244:247]
s_waitcnt vmcnt(10) lgkmcnt(0)
s_barrier
v_mfma_f32_16x16x32_bf16 v[228:231], a[112:115], a[156:159], v[228:231]
buffer_load_dwordx4 v20, s[4:7], s74 offen offset:2048 lds
v_mfma_f32_16x16x32_bf16 v[212:215], a[112:115], a[152:155], v[212:215]
ds_read_b128 a[68:71], v10 offset:16384
v_mfma_f32_16x16x32_bf16 v[196:199], a[112:115], a[148:151], v[196:199]
ds_read_b64_tr_b16 a[36:37], v2 offset:32768
v_mfma_f32_16x16x32_bf16 a[24:27], a[112:115], a[144:147], a[24:27]
ds_read_b64_tr_b16 a[38:39], v2 offset:33792
v_mfma_f32_16x16x32_bf16 a[16:19], a[112:115], a[140:143], a[16:19]
buffer_load_dwordx4 v21, s[4:7], s74 offen offset:3072 lds
v_mfma_f32_16x16x32_bf16 a[8:11], a[112:115], a[136:139], a[8:11]
s_add_u32 s87, s87, 128
s_and_b32 s87, s87, 1023
s_add_u32 m0, s96, 0
v_mfma_f32_16x16x32_bf16 a[0:3], a[112:115], a[132:135], a[0:3]
ds_read_b128 a[72:75], v10 offset:18432
v_mfma_f32_16x16x32_bf16 v[44:47], a[116:119], a[132:135], v[44:47]
ds_read_b64_tr_b16 a[40:41], v3 offset:32768
v_mfma_f32_16x16x32_bf16 v[60:63], a[116:119], a[136:139], v[60:63]
buffer_load_dwordx4 v14, s[12:15], s86 offen offset:0 lds
v_mfma_f32_16x16x32_bf16 v[76:79], a[116:119], a[140:143], v[76:79]
ds_read_b64_tr_b16 a[42:43], v3 offset:33792
v_mfma_f32_16x16x32_bf16 v[92:95], a[116:119], a[144:147], v[92:95]
ds_read_b128 a[76:79], v10 offset:20480
v_mfma_f32_16x16x32_bf16 v[108:111], a[116:119], a[148:151], v[108:111]
ds_read_b64_tr_b16 a[44:45], v4 offset:32768
v_mfma_f32_16x16x32_bf16 v[124:127], a[116:119], a[152:155], v[124:127]
buffer_load_dwordx4 v15, s[12:15], s86 offen offset:1024 lds
v_mfma_f32_16x16x32_bf16 v[140:143], a[116:119], a[156:159], v[140:143]
ds_read_b64_tr_b16 a[46:47], v4 offset:33792
v_mfma_f32_16x16x32_bf16 v[156:159], a[116:119], a[160:163], v[156:159]
ds_read_b128 a[80:83], v10 offset:22528
v_mfma_f32_16x16x32_bf16 v[248:251], a[120:123], a[160:163], v[248:251]
ds_read_b64_tr_b16 a[48:49], v5 offset:32768
v_mfma_f32_16x16x32_bf16 v[232:235], a[120:123], a[156:159], v[232:235]
buffer_load_dwordx4 v16, s[12:15], s86 offen offset:2048 lds
v_mfma_f32_16x16x32_bf16 v[216:219], a[120:123], a[152:155], v[216:219]
ds_read_b64_tr_b16 a[50:51], v5 offset:33792
v_mfma_f32_16x16x32_bf16 v[200:203], a[120:123], a[148:151], v[200:203]
ds_read_b128 a[84:87], v11 offset:24576
v_mfma_f32_16x16x32_bf16 a[28:31], a[120:123], a[144:147], a[28:31]
ds_read_b64_tr_b16 a[52:53], v6 offset:32768
v_mfma_f32_16x16x32_bf16 v[184:187], a[120:123], a[140:143], v[184:187]
buffer_load_dwordx4 v17, s[12:15], s86 offen offset:3072 lds
v_mfma_f32_16x16x32_bf16 v[176:179], a[120:123], a[136:139], v[176:179]
s_add_u32 s86, s86, 0x40000
s_and_b32 s86, s86, 0x3c0000
s_add_u32 m0, s96, 16384
v_mfma_f32_16x16x32_bf16 v[168:171], a[120:123], a[132:135], v[168:171]
ds_read_b64_tr_b16 a[54:55], v6 offset:33792
v_mfma_f32_16x16x32_bf16 v[48:51], a[124:127], a[132:135], v[48:51]
ds_read_b128 a[88:91], v11 offset:26624
v_mfma_f32_16x16x32_bf16 v[64:67], a[124:127], a[136:139], v[64:67]
buffer_load_dwordx4 v14, s[12:15], s86 offen offset:0 lds
v_mfma_f32_16x16x32_bf16 v[80:83], a[124:127], a[140:143], v[80:83]
ds_read_b64_tr_b16 a[56:57], v7 offset:32768
v_mfma_f32_16x16x32_bf16 v[96:99], a[124:127], a[144:147], v[96:99]
ds_read_b64_tr_b16 a[58:59], v7 offset:33792
v_mfma_f32_16x16x32_bf16 v[112:115], a[124:127], a[148:151], v[112:115]
ds_read_b128 a[92:95], v11 offset:28672
v_mfma_f32_16x16x32_bf16 v[128:131], a[124:127], a[152:155], v[128:131]
buffer_load_dwordx4 v15, s[12:15], s86 offen offset:1024 lds
v_mfma_f32_16x16x32_bf16 v[144:147], a[124:127], a[156:159], v[144:147]
ds_read_b64_tr_b16 a[60:61], v8 offset:32768
v_mfma_f32_16x16x32_bf16 v[160:163], a[124:127], a[160:163], v[160:163]
ds_read_b64_tr_b16 a[62:63], v8 offset:33792
v_mfma_f32_16x16x32_bf16 v[252:255], a[128:131], a[160:163], v[252:255]
ds_read_b128 a[96:99], v11 offset:30720
v_mfma_f32_16x16x32_bf16 v[236:239], a[128:131], a[156:159], v[236:239]
buffer_load_dwordx4 v16, s[12:15], s86 offen offset:2048 lds
v_mfma_f32_16x16x32_bf16 v[220:223], a[128:131], a[152:155], v[220:223]
ds_read_b64_tr_b16 a[64:65], v9 offset:32768
v_mfma_f32_16x16x32_bf16 v[204:207], a[128:131], a[148:151], v[204:207]
ds_read_b64_tr_b16 a[66:67], v9 offset:33792
v_mfma_f32_16x16x32_bf16 a[32:35], a[128:131], a[144:147], a[32:35]
v_mfma_f32_16x16x32_bf16 a[20:23], a[128:131], a[140:143], a[20:23]
buffer_load_dwordx4 v17, s[12:15], s86 offen offset:3072 lds
v_mfma_f32_16x16x32_bf16 a[12:15], a[128:131], a[136:139], a[12:15]
s_add_u32 s86, s86, 0x40000
s_and_b32 s86, s86, 0x3c0000
v_mfma_f32_16x16x32_bf16 a[4:7], a[128:131], a[132:135], a[4:7]
s_waitcnt lgkmcnt(0)
v_mfma_f32_16x16x32_bf16 a[4:7], a[64:67], a[68:71], a[4:7]
s_waitcnt vmcnt(16) lgkmcnt(0)
s_barrier
v_mfma_f32_16x16x32_bf16 a[12:15], a[64:67], a[72:75], a[12:15]
s_add_u32 m0, s97, 0
ds_read_b64_tr_b16 a[100:101], v2 offset:49152
v_mfma_f32_16x16x32_bf16 a[20:23], a[64:67], a[76:79], a[20:23]
s_add_u32 s74, s87, 0
ds_read_b64_tr_b16 a[102:103], v2 offset:50176
v_mfma_f32_16x16x32_bf16 a[32:35], a[64:67], a[80:83], a[32:35]
ds_read_b128 a[132:135], v12 offset:16384
v_mfma_f32_16x16x32_bf16 v[204:207], a[64:67], a[84:87], v[204:207]
ds_read_b128 a[136:139], v12 offset:18432
v_mfma_f32_16x16x32_bf16 v[220:223], a[64:67], a[88:91], v[220:223]
ds_read_b128 a[140:143], v12 offset:20480
v_mfma_f32_16x16x32_bf16 v[236:239], a[64:67], a[92:95], v[236:239]
ds_read_b128 a[144:147], v12 offset:22528
v_mfma_f32_16x16x32_bf16 v[252:255], a[64:67], a[96:99], v[252:255]
ds_read_b128 a[148:151], v13 offset:24576
v_mfma_f32_16x16x32_bf16 v[160:163], a[60:63], a[96:99], v[160:163]
ds_read_b128 a[152:155], v13 offset:26624
v_mfma_f32_16x16x32_bf16 v[144:147], a[60:63], a[92:95], v[144:147]
ds_read_b128 a[156:159], v13 offset:28672
v_mfma_f32_16x16x32_bf16 v[128:131], a[60:63], a[88:91], v[128:131]
ds_read_b128 a[160:163], v13 offset:30720
v_mfma_f32_16x16x32_bf16 v[112:115], a[60:63], a[84:87], v[112:115]
buffer_load_dwordx4 v18, s[4:7], s74 offen offset:0 lds
v_mfma_f32_16x16x32_bf16 v[96:99], a[60:63], a[80:83], v[96:99]
ds_read_b64_tr_b16 a[104:105], v3 offset:49152
v_mfma_f32_16x16x32_bf16 v[80:83], a[60:63], a[76:79], v[80:83]
v_mfma_f32_16x16x32_bf16 v[64:67], a[60:63], a[72:75], v[64:67]
ds_read_b64_tr_b16 a[106:107], v3 offset:50176
v_mfma_f32_16x16x32_bf16 v[48:51], a[60:63], a[68:71], v[48:51]
buffer_load_dwordx4 v19, s[4:7], s74 offen offset:1024 lds
v_mfma_f32_16x16x32_bf16 v[36:39], a[36:39], a[68:71], v[36:39]
s_waitcnt lgkmcnt(9)
ds_read_b64_tr_b16 a[108:109], v4 offset:49152
v_mfma_f32_16x16x32_bf16 v[36:39], a[100:103], a[132:135], v[36:39]
s_waitcnt lgkmcnt(9)
v_mfma_f32_16x16x32_bf16 v[52:55], a[100:103], a[136:139], v[52:55]
ds_read_b64_tr_b16 a[110:111], v4 offset:50176
v_mfma_f32_16x16x32_bf16 v[52:55], a[36:39], a[72:75], v[52:55]
buffer_load_dwordx4 v20, s[4:7], s74 offen offset:2048 lds
v_mfma_f32_16x16x32_bf16 v[68:71], a[36:39], a[76:79], v[68:71]
s_waitcnt lgkmcnt(9)
ds_read_b64_tr_b16 a[112:113], v5 offset:49152
v_mfma_f32_16x16x32_bf16 v[68:71], a[100:103], a[140:143], v[68:71]
s_waitcnt lgkmcnt(9)
v_mfma_f32_16x16x32_bf16 v[84:87], a[100:103], a[144:147], v[84:87]
ds_read_b64_tr_b16 a[114:115], v5 offset:50176
v_mfma_f32_16x16x32_bf16 v[84:87], a[36:39], a[80:83], v[84:87]
buffer_load_dwordx4 v21, s[4:7], s74 offen offset:3072 lds
v_mfma_f32_16x16x32_bf16 v[100:103], a[36:39], a[84:87], v[100:103]
s_waitcnt lgkmcnt(9)
s_add_u32 m0, s96, 32768
ds_read_b64_tr_b16 a[116:117], v6 offset:49152
v_mfma_f32_16x16x32_bf16 v[100:103], a[100:103], a[148:151], v[100:103]
s_waitcnt lgkmcnt(9)
v_mfma_f32_16x16x32_bf16 v[116:119], a[100:103], a[152:155], v[116:119]
ds_read_b64_tr_b16 a[118:119], v6 offset:50176
v_mfma_f32_16x16x32_bf16 v[116:119], a[36:39], a[88:91], v[116:119]
buffer_load_dwordx4 v14, s[12:15], s86 offen offset:0 lds
v_mfma_f32_16x16x32_bf16 v[132:135], a[36:39], a[92:95], v[132:135]
s_waitcnt lgkmcnt(9)
ds_read_b64_tr_b16 a[120:121], v7 offset:49152
v_mfma_f32_16x16x32_bf16 v[132:135], a[100:103], a[156:159], v[132:135]
s_waitcnt lgkmcnt(9)
v_mfma_f32_16x16x32_bf16 v[148:151], a[100:103], a[160:163], v[148:151]
ds_read_b64_tr_b16 a[122:123], v7 offset:50176
v_mfma_f32_16x16x32_bf16 v[148:151], a[36:39], a[96:99], v[148:151]
buffer_load_dwordx4 v15, s[12:15], s86 offen offset:1024 lds
v_mfma_f32_16x16x32_bf16 v[240:243], a[40:43], a[96:99], v[240:243]
s_waitcnt lgkmcnt(8)
ds_read_b64_tr_b16 a[124:125], v8 offset:49152
v_mfma_f32_16x16x32_bf16 v[240:243], a[104:107], a[160:163], v[240:243]
v_mfma_f32_16x16x32_bf16 v[224:227], a[104:107], a[156:159], v[224:227]
ds_read_b64_tr_b16 a[126:127], v8 offset:50176
v_mfma_f32_16x16x32_bf16 v[224:227], a[40:43], a[92:95], v[224:227]
buffer_load_dwordx4 v16, s[12:15], s86 offen offset:2048 lds
v_mfma_f32_16x16x32_bf16 v[208:211], a[40:43], a[88:91], v[208:211]
ds_read_b64_tr_b16 a[128:129], v9 offset:49152
v_mfma_f32_16x16x32_bf16 v[208:211], a[104:107], a[152:155], v[208:211]
v_mfma_f32_16x16x32_bf16 v[192:195], a[104:107], a[148:151], v[192:195]
ds_read_b64_tr_b16 a[130:131], v9 offset:50176
v_mfma_f32_16x16x32_bf16 v[192:195], a[40:43], a[84:87], v[192:195]
buffer_load_dwordx4 v17, s[12:15], s86 offen offset:3072 lds
v_mfma_f32_16x16x32_bf16 v[188:191], a[40:43], a[80:83], v[188:191]
s_add_u32 s86, s86, 0x40000
s_and_b32 s86, s86, 0x3c0000
s_add_u32 m0, s97, 4096
v_mfma_f32_16x16x32_bf16 v[188:191], a[104:107], a[144:147], v[188:191]
s_add_u32 s74, s87, 32768
v_mfma_f32_16x16x32_bf16 v[180:183], a[104:107], a[140:143], v[180:183]
v_mfma_f32_16x16x32_bf16 v[180:183], a[40:43], a[76:79], v[180:183]
buffer_load_dwordx4 v18, s[4:7], s74 offen offset:0 lds
v_mfma_f32_16x16x32_bf16 v[172:175], a[40:43], a[72:75], v[172:175]
v_mfma_f32_16x16x32_bf16 v[172:175], a[104:107], a[136:139], v[172:175]
v_mfma_f32_16x16x32_bf16 v[164:167], a[104:107], a[132:135], v[164:167]
v_mfma_f32_16x16x32_bf16 v[164:167], a[40:43], a[68:71], v[164:167]
buffer_load_dwordx4 v19, s[4:7], s74 offen offset:1024 lds
v_mfma_f32_16x16x32_bf16 v[40:43], a[44:47], a[68:71], v[40:43]
s_waitcnt lgkmcnt(10)
v_mfma_f32_16x16x32_bf16 v[40:43], a[108:111], a[132:135], v[40:43]
v_mfma_f32_16x16x32_bf16 v[56:59], a[108:111], a[136:139], v[56:59]
v_mfma_f32_16x16x32_bf16 v[56:59], a[44:47], a[72:75], v[56:59]
buffer_load_dwordx4 v20, s[4:7], s74 offen offset:2048 lds
v_mfma_f32_16x16x32_bf16 v[72:75], a[44:47], a[76:79], v[72:75]
v_mfma_f32_16x16x32_bf16 v[72:75], a[108:111], a[140:143], v[72:75]
v_mfma_f32_16x16x32_bf16 v[88:91], a[108:111], a[144:147], v[88:91]
v_mfma_f32_16x16x32_bf16 v[88:91], a[44:47], a[80:83], v[88:91]
buffer_load_dwordx4 v21, s[4:7], s74 offen offset:3072 lds
v_mfma_f32_16x16x32_bf16 v[104:107], a[44:47], a[84:87], v[104:107]
s_add_u32 s87, s87, 128
s_and_b32 s87, s87, 1023
v_mfma_f32_16x16x32_bf16 v[104:107], a[108:111], a[148:151], v[104:107]
v_mfma_f32_16x16x32_bf16 v[120:123], a[108:111], a[152:155], v[120:123]
v_mfma_f32_16x16x32_bf16 v[120:123], a[44:47], a[88:91], v[120:123]
buffer_store_dwordx4 a[164:167], v0, s[76:79], s38 offen sc1
v_mfma_f32_16x16x32_bf16 v[136:139], a[44:47], a[92:95], v[136:139]
s_add_u32 s38, s38, 1024
v_mfma_f32_16x16x32_bf16 v[136:139], a[108:111], a[156:159], v[136:139]
v_mfma_f32_16x16x32_bf16 v[152:155], a[108:111], a[160:163], v[152:155]
v_mfma_f32_16x16x32_bf16 v[152:155], a[44:47], a[96:99], v[152:155]
v_mfma_f32_16x16x32_bf16 v[244:247], a[48:51], a[96:99], v[244:247]
s_waitcnt vmcnt(17) lgkmcnt(0)
s_barrier
s_lshl3_add_u32 s75, s80, s82
s_cmp_lg_u32 s75, 0
s_cbranch_scc1 LA_f03
s_mov_b64 exec, 1
v_mov_b32 v1, 1
buffer_atomic_add v1, off, s[24:27], 0 sc1
s_mov_b64 exec, -1
LA_f03:
v_mfma_f32_16x16x32_bf16 v[244:247], a[112:115], a[160:163], v[244:247]
s_add_u32 m0, s96, 49152
ds_read_b64_tr_b16 a[64:65], v9 offset:0
v_mfma_f32_16x16x32_bf16 v[228:231], a[112:115], a[156:159], v[228:231]
buffer_load_dwordx4 v14, s[12:15], s86 offen offset:0 lds
v_mfma_f32_16x16x32_bf16 v[228:231], a[48:51], a[92:95], v[228:231]
ds_read_b64_tr_b16 a[66:67], v9 offset:1024
v_mfma_f32_16x16x32_bf16 v[212:215], a[48:51], a[88:91], v[212:215]
v_mfma_f32_16x16x32_bf16 v[212:215], a[112:115], a[152:155], v[212:215]
ds_read_b64_tr_b16 a[60:61], v8 offset:0
v_mfma_f32_16x16x32_bf16 v[196:199], a[112:115], a[148:151], v[196:199]
buffer_load_dwordx4 v15, s[12:15], s86 offen offset:1024 lds
v_mfma_f32_16x16x32_bf16 v[196:199], a[48:51], a[84:87], v[196:199]
ds_read_b64_tr_b16 a[62:63], v8 offset:1024
v_mfma_f32_16x16x32_bf16 a[24:27], a[48:51], a[80:83], a[24:27]
v_mfma_f32_16x16x32_bf16 a[24:27], a[112:115], a[144:147], a[24:27]
ds_read_b64_tr_b16 a[44:45], v4 offset:0
v_mfma_f32_16x16x32_bf16 a[16:19], a[112:115], a[140:143], a[16:19]
buffer_load_dwordx4 v16, s[12:15], s86 offen offset:2048 lds
v_mfma_f32_16x16x32_bf16 a[16:19], a[48:51], a[76:79], a[16:19]
ds_read_b64_tr_b16 a[46:47], v4 offset:1024
v_mfma_f32_16x16x32_bf16 a[8:11], a[48:51], a[72:75], a[8:11]
v_mfma_f32_16x16x32_bf16 a[8:11], a[112:115], a[136:139], a[8:11]
ds_read_b64_tr_b16 a[40:41], v3 offset:0
v_mfma_f32_16x16x32_bf16 a[0:3], a[112:115], a[132:135], a[0:3]
buffer_load_dwordx4 v17, s[12:15], s86 offen offset:3072 lds
v_mfma_f32_16x16x32_bf16 a[0:3], a[48:51], a[68:71], a[0:3]
s_add_u32 s86, s86, 0x40000
ds_read_b64_tr_b16 a[42:43], v3 offset:1024
v_mfma_f32_16x16x32_bf16 v[44:47], a[52:55], a[68:71], v[44:47]
s_and_b32 s86, s86, 0x3c0000
s_add_u32 m0, s97, 16384
s_add_u32 s74, s87, 0
v_mfma_f32_16x16x32_bf16 v[44:47], a[116:119], a[132:135], v[44:47]
ds_read_b64_tr_b16 a[36:37], v2 offset:0
v_mfma_f32_16x16x32_bf16 v[60:63], a[116:119], a[136:139], v[60:63]
buffer_load_dwordx4 v18, s[4:7], s74 offen offset:0 lds
v_mfma_f32_16x16x32_bf16 v[60:63], a[52:55], a[72:75], v[60:63]
ds_read_b64_tr_b16 a[38:39], v2 offset:1024
v_mfma_f32_16x16x32_bf16 v[76:79], a[52:55], a[76:79], v[76:79]
v_mfma_f32_16x16x32_bf16 v[76:79], a[116:119], a[140:143], v[76:79]
ds_read_b64_tr_b16 a[48:49], v5 offset:0
v_mfma_f32_16x16x32_bf16 v[92:95], a[116:119], a[144:147], v[92:95]
buffer_load_dwordx4 v19, s[4:7], s74 offen offset:1024 lds
v_mfma_f32_16x16x32_bf16 v[92:95], a[52:55], a[80:83], v[92:95]
ds_read_b64_tr_b16 a[50:51], v5 offset:1024
v_mfma_f32_16x16x32_bf16 v[108:111], a[52:55], a[84:87], v[108:111]
v_mfma_f32_16x16x32_bf16 v[108:111], a[116:119], a[148:151], v[108:111]
v_mfma_f32_16x16x32_bf16 v[124:127], a[116:119], a[152:155], v[124:127]
buffer_load_dwordx4 v20, s[4:7], s74 offen offset:2048 lds
v_mfma_f32_16x16x32_bf16 v[124:127], a[52:55], a[88:91], v[124:127]
v_mfma_f32_16x16x32_bf16 v[140:143], a[52:55], a[92:95], v[140:143]
v_mfma_f32_16x16x32_bf16 v[140:143], a[116:119], a[156:159], v[140:143]
v_mfma_f32_16x16x32_bf16 v[156:159], a[116:119], a[160:163], v[156:159]
buffer_load_dwordx4 v21, s[4:7], s74 offen offset:3072 lds
v_mfma_f32_16x16x32_bf16 v[156:159], a[52:55], a[96:99], v[156:159]
ds_read_b64_tr_b16 a[52:53], v6 offset:0
v_mfma_f32_16x16x32_bf16 v[248:251], a[56:59], a[96:99], v[248:251]
v_mfma_f32_16x16x32_bf16 v[248:251], a[120:123], a[160:163], v[248:251]
ds_read_b64_tr_b16 a[54:55], v6 offset:1024
v_mfma_f32_16x16x32_bf16 v[232:235], a[120:123], a[156:159], v[232:235]
buffer_store_dwordx4 a[164:167], v0, s[76:79], s38 offen sc1
v_mfma_f32_16x16x32_bf16 v[232:235], a[56:59], a[92:95], v[232:235]
s_add_u32 s38, s38, 1024
ds_read_b128 a[96:99], v11 offset:47104
v_mfma_f32_16x16x32_bf16 v[216:219], a[56:59], a[88:91], v[216:219]
v_mfma_f32_16x16x32_bf16 v[216:219], a[120:123], a[152:155], v[216:219]
ds_read_b128 a[92:95], v11 offset:45056
v_mfma_f32_16x16x32_bf16 v[200:203], a[120:123], a[148:151], v[200:203]
v_mfma_f32_16x16x32_bf16 v[200:203], a[56:59], a[84:87], v[200:203]
ds_read_b128 a[88:91], v11 offset:43008
v_mfma_f32_16x16x32_bf16 a[28:31], a[56:59], a[80:83], a[28:31]
v_mfma_f32_16x16x32_bf16 a[28:31], a[120:123], a[144:147], a[28:31]
ds_read_b128 a[84:87], v11 offset:40960
v_mfma_f32_16x16x32_bf16 v[184:187], a[120:123], a[140:143], v[184:187]
v_mfma_f32_16x16x32_bf16 v[184:187], a[56:59], a[76:79], v[184:187]
ds_read_b128 a[80:83], v10 offset:38912
v_mfma_f32_16x16x32_bf16 v[176:179], a[56:59], a[72:75], v[176:179]
v_mfma_f32_16x16x32_bf16 v[176:179], a[120:123], a[136:139], v[176:179]
ds_read_b128 a[76:79], v10 offset:36864
v_mfma_f32_16x16x32_bf16 v[168:171], a[120:123], a[132:135], v[168:171]
v_mfma_f32_16x16x32_bf16 v[168:171], a[56:59], a[68:71], v[168:171]
ds_read_b128 a[72:75], v10 offset:34816
v_mfma_f32_16x16x32_bf16 v[48:51], a[124:127], a[132:135], v[48:51]
v_mfma_f32_16x16x32_bf16 v[64:67], a[124:127], a[136:139], v[64:67]
ds_read_b128 a[68:71], v10 offset:32768
v_mfma_f32_16x16x32_bf16 v[80:83], a[124:127], a[140:143], v[80:83]
v_mfma_f32_16x16x32_bf16 v[96:99], a[124:127], a[144:147], v[96:99]
ds_read_b64_tr_b16 a[56:57], v7 offset:0
v_mfma_f32_16x16x32_bf16 v[112:115], a[124:127], a[148:151], v[112:115]
v_mfma_f32_16x16x32_bf16 v[128:131], a[124:127], a[152:155], v[128:131]
ds_read_b64_tr_b16 a[58:59], v7 offset:1024
v_mfma_f32_16x16x32_bf16 v[144:147], a[124:127], a[156:159], v[144:147]
v_mfma_f32_16x16x32_bf16 v[160:163], a[124:127], a[160:163], v[160:163]
v_mfma_f32_16x16x32_bf16 v[252:255], a[128:131], a[160:163], v[252:255]
v_mfma_f32_16x16x32_bf16 v[236:239], a[128:131], a[156:159], v[236:239]
v_mfma_f32_16x16x32_bf16 v[220:223], a[128:131], a[152:155], v[220:223]
v_mfma_f32_16x16x32_bf16 v[204:207], a[128:131], a[148:151], v[204:207]
v_mfma_f32_16x16x32_bf16 a[32:35], a[128:131], a[144:147], a[32:35]
v_mfma_f32_16x16x32_bf16 a[20:23], a[128:131], a[140:143], a[20:23]
v_mfma_f32_16x16x32_bf16 a[12:15], a[128:131], a[136:139], a[12:15]
v_mfma_f32_16x16x32_bf16 a[4:7], a[128:131], a[132:135], a[4:7]
s_waitcnt lgkmcnt(2)
v_mfma_f32_16x16x32_bf16 a[4:7], a[64:67], a[68:71], a[4:7]
s_waitcnt vmcnt(22) lgkmcnt(0)
s_barrier
s_lshl3_add_u32 s75, s80, s82
s_cmp_lg_u32 s75, 1
s_cbranch_scc1 LA_f04
s_mov_b64 exec, 1
v_mov_b32 v1, 1
buffer_atomic_add v1, off, s[24:27], 0 sc1
s_mov_b64 exec, -1
LA_f04:
v_mfma_f32_16x16x32_bf16 a[12:15], a[64:67], a[72:75], a[12:15]
s_add_u32 m0, s96, 0
ds_read_b64_tr_b16 a[100:101], v2 offset:16384
v_mfma_f32_16x16x32_bf16 a[20:23], a[64:67], a[76:79], a[20:23]
ds_read_b64_tr_b16 a[102:103], v2 offset:17408
v_mfma_f32_16x16x32_bf16 a[32:35], a[64:67], a[80:83], a[32:35]
ds_read_b128 a[132:135], v12 offset:32768
v_mfma_f32_16x16x32_bf16 v[204:207], a[64:67], a[84:87], v[204:207]
ds_read_b128 a[136:139], v12 offset:34816
v_mfma_f32_16x16x32_bf16 v[220:223], a[64:67], a[88:91], v[220:223]
ds_read_b128 a[140:143], v12 offset:36864
v_mfma_f32_16x16x32_bf16 v[236:239], a[64:67], a[92:95], v[236:239]
ds_read_b128 a[144:147], v12 offset:38912
v_mfma_f32_16x16x32_bf16 v[252:255], a[64:67], a[96:99], v[252:255]
ds_read_b128 a[148:151], v13 offset:40960
v_mfma_f32_16x16x32_bf16 v[160:163], a[60:63], a[96:99], v[160:163]
ds_read_b128 a[152:155], v13 offset:43008
v_mfma_f32_16x16x32_bf16 v[144:147], a[60:63], a[92:95], v[144:147]
ds_read_b128 a[156:159], v13 offset:45056
v_mfma_f32_16x16x32_bf16 v[128:131], a[60:63], a[88:91], v[128:131]
ds_read_b128 a[160:163], v13 offset:47104
v_mfma_f32_16x16x32_bf16 v[112:115], a[60:63], a[84:87], v[112:115]
buffer_load_dwordx4 v14, s[12:15], s86 offen offset:0 lds
v_mfma_f32_16x16x32_bf16 v[96:99], a[60:63], a[80:83], v[96:99]
ds_read_b64_tr_b16 a[104:105], v3 offset:16384
v_mfma_f32_16x16x32_bf16 v[80:83], a[60:63], a[76:79], v[80:83]
v_mfma_f32_16x16x32_bf16 v[64:67], a[60:63], a[72:75], v[64:67]
ds_read_b64_tr_b16 a[106:107], v3 offset:17408
v_mfma_f32_16x16x32_bf16 v[48:51], a[60:63], a[68:71], v[48:51]
buffer_load_dwordx4 v15, s[12:15], s86 offen offset:1024 lds
v_mfma_f32_16x16x32_bf16 v[36:39], a[36:39], a[68:71], v[36:39]
s_waitcnt lgkmcnt(9)
ds_read_b64_tr_b16 a[108:109], v4 offset:16384
v_mfma_f32_16x16x32_bf16 v[36:39], a[100:103], a[132:135], v[36:39]
s_waitcnt lgkmcnt(9)
v_mfma_f32_16x16x32_bf16 v[52:55], a[100:103], a[136:139], v[52:55]
ds_read_b64_tr_b16 a[110:111], v4 offset:17408
v_mfma_f32_16x16x32_bf16 v[52:55], a[36:39], a[72:75], v[52:55]
buffer_load_dwordx4 v16, s[12:15], s86 offen offset:2048 lds
v_mfma_f32_16x16x32_bf16 v[68:71], a[36:39], a[76:79], v[68:71]
s_waitcnt lgkmcnt(9)
ds_read_b64_tr_b16 a[112:113], v5 offset:16384
v_mfma_f32_16x16x32_bf16 v[68:71], a[100:103], a[140:143], v[68:71]
s_waitcnt lgkmcnt(9)
v_mfma_f32_16x16x32_bf16 v[84:87], a[100:103], a[144:147], v[84:87]
ds_read_b64_tr_b16 a[114:115], v5 offset:17408
v_mfma_f32_16x16x32_bf16 v[84:87], a[36:39], a[80:83], v[84:87]
buffer_load_dwordx4 v17, s[12:15], s86 offen offset:3072 lds
v_mfma_f32_16x16x32_bf16 v[100:103], a[36:39], a[84:87], v[100:103]
s_waitcnt lgkmcnt(9)
s_add_u32 s86, s86, 0x40000
ds_read_b64_tr_b16 a[116:117], v6 offset:16384
v_mfma_f32_16x16x32_bf16 v[100:103], a[100:103], a[148:151], v[100:103]
s_waitcnt lgkmcnt(9)
s_and_b32 s86, s86, 0x3c0000
s_add_u32 m0, s97, 20480
s_add_u32 s74, s87, 32768
v_mfma_f32_16x16x32_bf16 v[116:119], a[100:103], a[152:155], v[116:119]
ds_read_b64_tr_b16 a[118:119], v6 offset:17408
v_mfma_f32_16x16x32_bf16 v[116:119], a[36:39], a[88:91], v[116:119]
buffer_load_dwordx4 v18, s[4:7], s74 offen offset:0 lds
v_mfma_f32_16x16x32_bf16 v[132:135], a[36:39], a[92:95], v[132:135]
s_waitcnt lgkmcnt(9)
ds_read_b64_tr_b16 a[120:121], v7 offset:16384
v_mfma_f32_16x16x32_bf16 v[132:135], a[100:103], a[156:159], v[132:135]
s_waitcnt lgkmcnt(9)
v_mfma_f32_16x16x32_bf16 v[148:151], a[100:103], a[160:163], v[148:151]
ds_read_b64_tr_b16 a[122:123], v7 offset:17408
v_mfma_f32_16x16x32_bf16 v[148:151], a[36:39], a[96:99], v[148:151]
buffer_load_dwordx4 v19, s[4:7], s74 offen offset:1024 lds
v_mfma_f32_16x16x32_bf16 v[240:243], a[40:43], a[96:99], v[240:243]
s_waitcnt lgkmcnt(8)
ds_read_b64_tr_b16 a[124:125], v8 offset:16384
v_mfma_f32_16x16x32_bf16 v[240:243], a[104:107], a[160:163], v[240:243]
v_mfma_f32_16x16x32_bf16 v[224:227], a[104:107], a[156:159], v[224:227]
ds_read_b64_tr_b16 a[126:127], v8 offset:17408
v_mfma_f32_16x16x32_bf16 v[224:227], a[40:43], a[92:95], v[224:227]
buffer_load_dwordx4 v20, s[4:7], s74 offen offset:2048 lds
v_mfma_f32_16x16x32_bf16 v[208:211], a[40:43], a[88:91], v[208:211]
ds_read_b64_tr_b16 a[128:129], v9 offset:16384
v_mfma_f32_16x16x32_bf16 v[208:211], a[104:107], a[152:155], v[208:211]
v_mfma_f32_16x16x32_bf16 v[192:195], a[104:107], a[148:151], v[192:195]
ds_read_b64_tr_b16 a[130:131], v9 offset:17408
v_mfma_f32_16x16x32_bf16 v[192:195], a[40:43], a[84:87], v[192:195]
buffer_load_dwordx4 v21, s[4:7], s74 offen offset:3072 lds
v_mfma_f32_16x16x32_bf16 v[188:191], a[40:43], a[80:83], v[188:191]
s_add_u32 s87, s87, 128
s_and_b32 s87, s87, 1023
v_mfma_f32_16x16x32_bf16 v[188:191], a[104:107], a[144:147], v[188:191]
v_mfma_f32_16x16x32_bf16 v[180:183], a[104:107], a[140:143], v[180:183]
v_mfma_f32_16x16x32_bf16 v[180:183], a[40:43], a[76:79], v[180:183]
buffer_store_dwordx4 a[164:167], v0, s[76:79], s38 offen sc1
v_mfma_f32_16x16x32_bf16 v[172:175], a[40:43], a[72:75], v[172:175]
s_add_u32 s38, s38, 1024
v_mfma_f32_16x16x32_bf16 v[172:175], a[104:107], a[136:139], v[172:175]
v_mfma_f32_16x16x32_bf16 v[164:167], a[104:107], a[132:135], v[164:167]
v_mfma_f32_16x16x32_bf16 v[164:167], a[40:43], a[68:71], v[164:167]
buffer_store_dwordx4 a[164:167], v0, s[76:79], s38 offen sc1
v_mfma_f32_16x16x32_bf16 v[40:43], a[44:47], a[68:71], v[40:43]
s_waitcnt lgkmcnt(10)
s_add_u32 s38, s38, 1024
v_mfma_f32_16x16x32_bf16 v[40:43], a[108:111], a[132:135], v[40:43]
v_mfma_f32_16x16x32_bf16 v[56:59], a[108:111], a[136:139], v[56:59]
v_mfma_f32_16x16x32_bf16 v[56:59], a[44:47], a[72:75], v[56:59]
v_mfma_f32_16x16x32_bf16 v[72:75], a[44:47], a[76:79], v[72:75]
v_mfma_f32_16x16x32_bf16 v[72:75], a[108:111], a[140:143], v[72:75]
v_mfma_f32_16x16x32_bf16 v[88:91], a[108:111], a[144:147], v[88:91]
v_mfma_f32_16x16x32_bf16 v[88:91], a[44:47], a[80:83], v[88:91]
v_mfma_f32_16x16x32_bf16 v[104:107], a[44:47], a[84:87], v[104:107]
v_mfma_f32_16x16x32_bf16 v[104:107], a[108:111], a[148:151], v[104:107]
v_mfma_f32_16x16x32_bf16 v[120:123], a[108:111], a[152:155], v[120:123]
v_mfma_f32_16x16x32_bf16 v[120:123], a[44:47], a[88:91], v[120:123]
v_mfma_f32_16x16x32_bf16 v[136:139], a[44:47], a[92:95], v[136:139]
v_mfma_f32_16x16x32_bf16 v[136:139], a[108:111], a[156:159], v[136:139]
v_mfma_f32_16x16x32_bf16 v[152:155], a[108:111], a[160:163], v[152:155]
v_mfma_f32_16x16x32_bf16 v[152:155], a[44:47], a[96:99], v[152:155]
v_mfma_f32_16x16x32_bf16 v[244:247], a[48:51], a[96:99], v[244:247]
s_waitcnt vmcnt(19) lgkmcnt(0)
s_barrier
s_lshl3_add_u32 s75, s80, s82
s_cmp_lg_u32 s75, 2
s_cbranch_scc1 LA_f05
s_mov_b64 exec, 1
v_mov_b32 v1, 1
buffer_atomic_add v1, off, s[24:27], 0 sc1
s_mov_b64 exec, -1
LA_f05:
v_mfma_f32_16x16x32_bf16 v[244:247], a[112:115], a[160:163], v[244:247]
s_add_u32 m0, s96, 16384
ds_read_b64_tr_b16 a[64:65], v9 offset:32768
v_mfma_f32_16x16x32_bf16 v[228:231], a[112:115], a[156:159], v[228:231]
buffer_load_dwordx4 v14, s[12:15], s86 offen offset:0 lds
v_mfma_f32_16x16x32_bf16 v[228:231], a[48:51], a[92:95], v[228:231]
ds_read_b64_tr_b16 a[66:67], v9 offset:33792
v_mfma_f32_16x16x32_bf16 v[212:215], a[48:51], a[88:91], v[212:215]
v_mfma_f32_16x16x32_bf16 v[212:215], a[112:115], a[152:155], v[212:215]
ds_read_b64_tr_b16 a[60:61], v8 offset:32768
v_mfma_f32_16x16x32_bf16 v[196:199], a[112:115], a[148:151], v[196:199]
buffer_load_dwordx4 v15, s[12:15], s86 offen offset:1024 lds
v_mfma_f32_16x16x32_bf16 v[196:199], a[48:51], a[84:87], v[196:199]
ds_read_b64_tr_b16 a[62:63], v8 offset:33792
v_mfma_f32_16x16x32_bf16 a[24:27], a[48:51], a[80:83], a[24:27]
v_mfma_f32_16x16x32_bf16 a[24:27], a[112:115], a[144:147], a[24:27]
ds_read_b64_tr_b16 a[44:45], v4 offset:32768
v_mfma_f32_16x16x32_bf16 a[16:19], a[112:115], a[140:143], a[16:19]
buffer_load_dwordx4 v16, s[12:15], s86 offen offset:2048 lds
v_mfma_f32_16x16x32_bf16 a[16:19], a[48:51], a[76:79], a[16:19]
ds_read_b64_tr_b16 a[46:47], v4 offset:33792
v_mfma_f32_16x16x32_bf16 a[8:11], a[48:51], a[72:75], a[8:11]
v_mfma_f32_16x16x32_bf16 a[8:11], a[112:115], a[136:139], a[8:11]
ds_read_b64_tr_b16 a[40:41], v3 offset:32768
v_mfma_f32_16x16x32_bf16 a[0:3], a[112:115], a[132:135], a[0:3]
buffer_load_dwordx4 v17, s[12:15], s86 offen offset:3072 lds
v_mfma_f32_16x16x32_bf16 a[0:3], a[48:51], a[68:71], a[0:3]
s_add_u32 s86, s86, 0x40000
ds_read_b64_tr_b16 a[42:43], v3 offset:33792
v_mfma_f32_16x16x32_bf16 v[44:47], a[52:55], a[68:71], v[44:47]
s_and_b32 s86, s86, 0x3c0000
s_add_u32 m0, s97, 32768
s_add_u32 s74, s87, 0
v_mfma_f32_16x16x32_bf16 v[44:47], a[116:119], a[132:135], v[44:47]
ds_read_b64_tr_b16 a[36:37], v2 offset:32768
v_mfma_f32_16x16x32_bf16 v[60:63], a[116:119], a[136:139], v[60:63]
buffer_load_dwordx4 v18, s[4:7], s74 offen offset:0 lds
v_mfma_f32_16x16x32_bf16 v[60:63], a[52:55], a[72:75], v[60:63]
ds_read_b64_tr_b16 a[38:39], v2 offset:33792
v_mfma_f32_16x16x32_bf16 v[76:79], a[52:55], a[76:79], v[76:79]
v_mfma_f32_16x16x32_bf16 v[76:79], a[116:119], a[140:143], v[76:79]
ds_read_b64_tr_b16 a[48:49], v5 offset:32768
v_mfma_f32_16x16x32_bf16 v[92:95], a[116:119], a[144:147], v[92:95]
buffer_load_dwordx4 v19, s[4:7], s74 offen offset:1024 lds
v_mfma_f32_16x16x32_bf16 v[92:95], a[52:55], a[80:83], v[92:95]
ds_read_b64_tr_b16 a[50:51], v5 offset:33792
v_mfma_f32_16x16x32_bf16 v[108:111], a[52:55], a[84:87], v[108:111]
v_mfma_f32_16x16x32_bf16 v[108:111], a[116:119], a[148:151], v[108:111]
v_mfma_f32_16x16x32_bf16 v[124:127], a[116:119], a[152:155], v[124:127]
buffer_load_dwordx4 v20, s[4:7], s74 offen offset:2048 lds
v_mfma_f32_16x16x32_bf16 v[124:127], a[52:55], a[88:91], v[124:127]
v_mfma_f32_16x16x32_bf16 v[140:143], a[52:55], a[92:95], v[140:143]
v_mfma_f32_16x16x32_bf16 v[140:143], a[116:119], a[156:159], v[140:143]
v_mfma_f32_16x16x32_bf16 v[156:159], a[116:119], a[160:163], v[156:159]
buffer_load_dwordx4 v21, s[4:7], s74 offen offset:3072 lds
v_mfma_f32_16x16x32_bf16 v[156:159], a[52:55], a[96:99], v[156:159]
ds_read_b64_tr_b16 a[52:53], v6 offset:32768
v_mfma_f32_16x16x32_bf16 v[248:251], a[56:59], a[96:99], v[248:251]
v_mfma_f32_16x16x32_bf16 v[248:251], a[120:123], a[160:163], v[248:251]
ds_read_b64_tr_b16 a[54:55], v6 offset:33792
v_mfma_f32_16x16x32_bf16 v[232:235], a[120:123], a[156:159], v[232:235]
buffer_store_dwordx4 a[164:167], v0, s[76:79], s38 offen sc1
v_mfma_f32_16x16x32_bf16 v[232:235], a[56:59], a[92:95], v[232:235]
s_add_u32 s38, s38, 1024
ds_read_b128 a[96:99], v11 offset:14336
v_mfma_f32_16x16x32_bf16 v[216:219], a[56:59], a[88:91], v[216:219]
v_lshrrev_b32 v30, 6, v0
v_bfe_u32 v31, v0, 4, 2
v_mfma_f32_16x16x32_bf16 v[216:219], a[120:123], a[152:155], v[216:219]
ds_read_b128 a[92:95], v11 offset:12288
v_lshl_add_u32 v30, s80, 4, v30
v_mfma_f32_16x16x32_bf16 v[200:203], a[120:123], a[148:151], v[200:203]
v_lshlrev_b32 v31, 6, v31
v_lshl_or_b32 v30, v30, 13, v31
v_mfma_f32_16x16x32_bf16 v[200:203], a[56:59], a[84:87], v[200:203]
s_lshl_b32 s74, s83, 12
ds_read_b128 a[88:91], v11 offset:10240
v_mfma_f32_16x16x32_bf16 a[28:31], a[56:59], a[80:83], a[28:31]
buffer_load_dword a183, v30, s[16:19], s74 offen
v_mfma_f32_16x16x32_bf16 a[28:31], a[120:123], a[144:147], a[28:31]
ds_read_b128 a[84:87], v11 offset:8192
v_mfma_f32_16x16x32_bf16 v[184:187], a[120:123], a[140:143], v[184:187]
v_mfma_f32_16x16x32_bf16 v[184:187], a[56:59], a[76:79], v[184:187]
ds_read_b128 a[80:83], v10 offset:6144
v_mfma_f32_16x16x32_bf16 v[176:179], a[56:59], a[72:75], v[176:179]
v_mfma_f32_16x16x32_bf16 v[176:179], a[120:123], a[136:139], v[176:179]
ds_read_b128 a[76:79], v10 offset:4096
v_mfma_f32_16x16x32_bf16 v[168:171], a[120:123], a[132:135], v[168:171]
v_mfma_f32_16x16x32_bf16 v[168:171], a[56:59], a[68:71], v[168:171]
ds_read_b128 a[72:75], v10 offset:2048
v_mfma_f32_16x16x32_bf16 v[48:51], a[124:127], a[132:135], v[48:51]
v_mfma_f32_16x16x32_bf16 v[64:67], a[124:127], a[136:139], v[64:67]
ds_read_b128 a[68:71], v10 offset:0
v_mfma_f32_16x16x32_bf16 v[80:83], a[124:127], a[140:143], v[80:83]
v_mfma_f32_16x16x32_bf16 v[96:99], a[124:127], a[144:147], v[96:99]
ds_read_b64_tr_b16 a[56:57], v7 offset:32768
v_mfma_f32_16x16x32_bf16 v[112:115], a[124:127], a[148:151], v[112:115]
v_mfma_f32_16x16x32_bf16 v[128:131], a[124:127], a[152:155], v[128:131]
ds_read_b64_tr_b16 a[58:59], v7 offset:33792
v_mfma_f32_16x16x32_bf16 v[144:147], a[124:127], a[156:159], v[144:147]
v_mfma_f32_16x16x32_bf16 v[160:163], a[124:127], a[160:163], v[160:163]
v_mfma_f32_16x16x32_bf16 v[252:255], a[128:131], a[160:163], v[252:255]
v_mfma_f32_16x16x32_bf16 v[236:239], a[128:131], a[156:159], v[236:239]
v_mfma_f32_16x16x32_bf16 v[220:223], a[128:131], a[152:155], v[220:223]
v_mfma_f32_16x16x32_bf16 v[204:207], a[128:131], a[148:151], v[204:207]
v_mfma_f32_16x16x32_bf16 a[32:35], a[128:131], a[144:147], a[32:35]
v_mfma_f32_16x16x32_bf16 a[20:23], a[128:131], a[140:143], a[20:23]
v_mfma_f32_16x16x32_bf16 a[12:15], a[128:131], a[136:139], a[12:15]
v_mfma_f32_16x16x32_bf16 a[4:7], a[128:131], a[132:135], a[4:7]
s_waitcnt lgkmcnt(2)
v_mfma_f32_16x16x32_bf16 a[4:7], a[64:67], a[68:71], a[4:7]
s_waitcnt vmcnt(20) lgkmcnt(0)
s_barrier
s_lshl3_add_u32 s75, s80, s82
s_cmp_lg_u32 s75, 3
s_cbranch_scc1 LA_f06
s_mov_b64 exec, 1
v_mov_b32 v1, 1
buffer_atomic_add v1, off, s[24:27], 0 sc1
s_mov_b64 exec, -1
LA_f06:
v_mfma_f32_16x16x32_bf16 a[12:15], a[64:67], a[72:75], a[12:15]
s_add_u32 m0, s96, 32768
ds_read_b64_tr_b16 a[100:101], v2 offset:49152
v_mfma_f32_16x16x32_bf16 a[20:23], a[64:67], a[76:79], a[20:23]
ds_read_b64_tr_b16 a[102:103], v2 offset:50176
v_mfma_f32_16x16x32_bf16 a[32:35], a[64:67], a[80:83], a[32:35]
ds_read_b128 a[132:135], v12 offset:0
v_mfma_f32_16x16x32_bf16 v[204:207], a[64:67], a[84:87], v[204:207]
ds_read_b128 a[136:139], v12 offset:2048
v_mfma_f32_16x16x32_bf16 v[220:223], a[64:67], a[88:91], v[220:223]
ds_read_b128 a[140:143], v12 offset:4096
v_mfma_f32_16x16x32_bf16 v[236:239], a[64:67], a[92:95], v[236:239]
ds_read_b128 a[144:147], v12 offset:6144
v_mfma_f32_16x16x32_bf16 v[252:255], a[64:67], a[96:99], v[252:255]
ds_read_b128 a[148:151], v13 offset:8192
v_mfma_f32_16x16x32_bf16 v[160:163], a[60:63], a[96:99], v[160:163]
ds_read_b128 a[152:155], v13 offset:10240
v_mfma_f32_16x16x32_bf16 v[144:147], a[60:63], a[92:95], v[144:147]
ds_read_b128 a[156:159], v13 offset:12288
v_mfma_f32_16x16x32_bf16 v[128:131], a[60:63], a[88:91], v[128:131]
ds_read_b128 a[160:163], v13 offset:14336
v_mfma_f32_16x16x32_bf16 v[112:115], a[60:63], a[84:87], v[112:115]
buffer_load_dwordx4 v14, s[12:15], s86 offen offset:0 lds
v_mfma_f32_16x16x32_bf16 v[96:99], a[60:63], a[80:83], v[96:99]
ds_read_b64_tr_b16 a[104:105], v3 offset:49152
v_mfma_f32_16x16x32_bf16 v[80:83], a[60:63], a[76:79], v[80:83]
v_mfma_f32_16x16x32_bf16 v[64:67], a[60:63], a[72:75], v[64:67]
ds_read_b64_tr_b16 a[106:107], v3 offset:50176
v_mfma_f32_16x16x32_bf16 v[48:51], a[60:63], a[68:71], v[48:51]
buffer_load_dwordx4 v15, s[12:15], s86 offen offset:1024 lds
v_mfma_f32_16x16x32_bf16 v[36:39], a[36:39], a[68:71], v[36:39]
s_waitcnt lgkmcnt(9)
ds_read_b64_tr_b16 a[108:109], v4 offset:49152
v_mfma_f32_16x16x32_bf16 v[36:39], a[100:103], a[132:135], v[36:39]
s_waitcnt lgkmcnt(9)
v_mfma_f32_16x16x32_bf16 v[52:55], a[100:103], a[136:139], v[52:55]
ds_read_b64_tr_b16 a[110:111], v4 offset:50176
v_mfma_f32_16x16x32_bf16 v[52:55], a[36:39], a[72:75], v[52:55]
buffer_load_dwordx4 v16, s[12:15], s86 offen offset:2048 lds
v_mfma_f32_16x16x32_bf16 v[68:71], a[36:39], a[76:79], v[68:71]
s_waitcnt lgkmcnt(9)
ds_read_b64_tr_b16 a[112:113], v5 offset:49152
v_mfma_f32_16x16x32_bf16 v[68:71], a[100:103], a[140:143], v[68:71]
s_waitcnt lgkmcnt(9)
v_mfma_f32_16x16x32_bf16 v[84:87], a[100:103], a[144:147], v[84:87]
ds_read_b64_tr_b16 a[114:115], v5 offset:50176
v_mfma_f32_16x16x32_bf16 v[84:87], a[36:39], a[80:83], v[84:87]
buffer_load_dwordx4 v17, s[12:15], s86 offen offset:3072 lds
v_mfma_f32_16x16x32_bf16 v[100:103], a[36:39], a[84:87], v[100:103]
s_waitcnt lgkmcnt(9)
s_add_u32 s86, s86, 0x40000
ds_read_b64_tr_b16 a[116:117], v6 offset:49152
v_mfma_f32_16x16x32_bf16 v[100:103], a[100:103], a[148:151], v[100:103]
s_waitcnt lgkmcnt(9)
s_and_b32 s86, s86, 0x3c0000
s_add_u32 m0, s97, 36864
s_add_u32 s74, s87, 32768
v_mfma_f32_16x16x32_bf16 v[116:119], a[100:103], a[152:155], v[116:119]
ds_read_b64_tr_b16 a[118:119], v6 offset:50176
v_mfma_f32_16x16x32_bf16 v[116:119], a[36:39], a[88:91], v[116:119]
buffer_load_dwordx4 v18, s[4:7], s74 offen offset:0 lds
v_mfma_f32_16x16x32_bf16 v[132:135], a[36:39], a[92:95], v[132:135]
s_waitcnt lgkmcnt(9)
ds_read_b64_tr_b16 a[120:121], v7 offset:49152
v_mfma_f32_16x16x32_bf16 v[132:135], a[100:103], a[156:159], v[132:135]
s_waitcnt lgkmcnt(9)
v_mfma_f32_16x16x32_bf16 v[148:151], a[100:103], a[160:163], v[148:151]
ds_read_b64_tr_b16 a[122:123], v7 offset:50176
v_mfma_f32_16x16x32_bf16 v[148:151], a[36:39], a[96:99], v[148:151]
buffer_load_dwordx4 v19, s[4:7], s74 offen offset:1024 lds
v_mfma_f32_16x16x32_bf16 v[240:243], a[40:43], a[96:99], v[240:243]
s_waitcnt lgkmcnt(8)
ds_read_b64_tr_b16 a[124:125], v8 offset:49152
v_mfma_f32_16x16x32_bf16 v[240:243], a[104:107], a[160:163], v[240:243]
v_mfma_f32_16x16x32_bf16 v[224:227], a[104:107], a[156:159], v[224:227]
ds_read_b64_tr_b16 a[126:127], v8 offset:50176
v_mfma_f32_16x16x32_bf16 v[224:227], a[40:43], a[92:95], v[224:227]
buffer_load_dwordx4 v20, s[4:7], s74 offen offset:2048 lds
v_mfma_f32_16x16x32_bf16 v[208:211], a[40:43], a[88:91], v[208:211]
ds_read_b64_tr_b16 a[128:129], v9 offset:49152
v_mfma_f32_16x16x32_bf16 v[208:211], a[104:107], a[152:155], v[208:211]
v_mfma_f32_16x16x32_bf16 v[192:195], a[104:107], a[148:151], v[192:195]
ds_read_b64_tr_b16 a[130:131], v9 offset:50176
v_mfma_f32_16x16x32_bf16 v[192:195], a[40:43], a[84:87], v[192:195]
buffer_load_dwordx4 v21, s[4:7], s74 offen offset:3072 lds
v_mfma_f32_16x16x32_bf16 v[188:191], a[40:43], a[80:83], v[188:191]
s_add_u32 s87, s87, 128
s_and_b32 s87, s87, 1023
v_mfma_f32_16x16x32_bf16 v[188:191], a[104:107], a[144:147], v[188:191]
v_mfma_f32_16x16x32_bf16 v[180:183], a[104:107], a[140:143], v[180:183]
v_mfma_f32_16x16x32_bf16 v[180:183], a[40:43], a[76:79], v[180:183]
buffer_store_dwordx4 a[164:167], v0, s[76:79], s38 offen sc1
v_mfma_f32_16x16x32_bf16 v[172:175], a[40:43], a[72:75], v[172:175]
s_add_u32 s38, s38, 1024
v_mfma_f32_16x16x32_bf16 v[172:175], a[104:107], a[136:139], v[172:175]
v_mfma_f32_16x16x32_bf16 v[164:167], a[104:107], a[132:135], v[164:167]
v_mfma_f32_16x16x32_bf16 v[164:167], a[40:43], a[68:71], v[164:167]
buffer_store_dwordx4 a[164:167], v0, s[76:79], s38 offen sc1
v_mfma_f32_16x16x32_bf16 v[40:43], a[44:47], a[68:71], v[40:43]
s_waitcnt lgkmcnt(10)
s_add_u32 s38, s38, 1024
v_mfma_f32_16x16x32_bf16 v[40:43], a[108:111], a[132:135], v[40:43]
v_mfma_f32_16x16x32_bf16 v[56:59], a[108:111], a[136:139], v[56:59]
v_mfma_f32_16x16x32_bf16 v[56:59], a[44:47], a[72:75], v[56:59]
v_mfma_f32_16x16x32_bf16 v[72:75], a[44:47], a[76:79], v[72:75]
v_mfma_f32_16x16x32_bf16 v[72:75], a[108:111], a[140:143], v[72:75]
v_mfma_f32_16x16x32_bf16 v[88:91], a[108:111], a[144:147], v[88:91]
v_mfma_f32_16x16x32_bf16 v[88:91], a[44:47], a[80:83], v[88:91]
v_mfma_f32_16x16x32_bf16 v[104:107], a[44:47], a[84:87], v[104:107]
v_mfma_f32_16x16x32_bf16 v[104:107], a[108:111], a[148:151], v[104:107]
v_mfma_f32_16x16x32_bf16 v[120:123], a[108:111], a[152:155], v[120:123]
v_mfma_f32_16x16x32_bf16 v[120:123], a[44:47], a[88:91], v[120:123]
v_mfma_f32_16x16x32_bf16 v[136:139], a[44:47], a[92:95], v[136:139]
v_mfma_f32_16x16x32_bf16 v[136:139], a[108:111], a[156:159], v[136:139]
v_mfma_f32_16x16x32_bf16 v[152:155], a[108:111], a[160:163], v[152:155]
v_mfma_f32_16x16x32_bf16 v[152:155], a[44:47], a[96:99], v[152:155]
v_mfma_f32_16x16x32_bf16 v[244:247], a[48:51], a[96:99], v[244:247]
s_waitcnt vmcnt(20) lgkmcnt(0)
s_barrier
s_lshl3_add_u32 s75, s80, s82
s_cmp_lg_u32 s75, 4
s_cbranch_scc1 LA_f07
s_mov_b64 exec, 1
v_mov_b32 v1, 1
buffer_atomic_add v1, off, s[24:27], 0 sc1
s_mov_b64 exec, -1
LA_f07:
v_mfma_f32_16x16x32_bf16 v[244:247], a[112:115], a[160:163], v[244:247]
s_add_u32 m0, s96, 49152
ds_read_b64_tr_b16 a[64:65], v9 offset:0
v_mfma_f32_16x16x32_bf16 v[228:231], a[112:115], a[156:159], v[228:231]
buffer_load_dwordx4 v14, s[12:15], s86 offen offset:0 lds
v_mfma_f32_16x16x32_bf16 v[228:231], a[48:51], a[92:95], v[228:231]
ds_read_b64_tr_b16 a[66:67], v9 offset:1024
v_mfma_f32_16x16x32_bf16 v[212:215], a[48:51], a[88:91], v[212:215]
v_mfma_f32_16x16x32_bf16 v[212:215], a[112:115], a[152:155], v[212:215]
ds_read_b64_tr_b16 a[60:61], v8 offset:0
v_mfma_f32_16x16x32_bf16 v[196:199], a[112:115], a[148:151], v[196:199]
buffer_load_dwordx4 v15, s[12:15], s86 offen offset:1024 lds
v_mfma_f32_16x16x32_bf16 v[196:199], a[48:51], a[84:87], v[196:199]
ds_read_b64_tr_b16 a[62:63], v8 offset:1024
v_mfma_f32_16x16x32_bf16 a[24:27], a[48:51], a[80:83], a[24:27]
v_mfma_f32_16x16x32_bf16 a[24:27], a[112:115], a[144:147], a[24:27]
ds_read_b64_tr_b16 a[44:45], v4 offset:0
v_mfma_f32_16x16x32_bf16 a[16:19], a[112:115], a[140:143], a[16:19]
buffer_load_dwordx4 v16, s[12:15], s86 offen offset:2048 lds
v_mfma_f32_16x16x32_bf16 a[16:19], a[48:51], a[76:79], a[16:19]
ds_read_b64_tr_b16 a[46:47], v4 offset:1024
v_mfma_f32_16x16x32_bf16 a[8:11], a[48:51], a[72:75], a[8:11]
v_mfma_f32_16x16x32_bf16 a[8:11], a[112:115], a[136:139], a[8:11]
ds_read_b64_tr_b16 a[40:41], v3 offset:0
v_mfma_f32_16x16x32_bf16 a[0:3], a[112:115], a[132:135], a[0:3]
buffer_load_dwordx4 v17, s[12:15], s86 offen offset:3072 lds
v_mfma_f32_16x16x32_bf16 a[0:3], a[48:51], a[68:71], a[0:3]
s_add_u32 s86, s86, 0x40000
ds_read_b64_tr_b16 a[42:43], v3 offset:1024
v_mfma_f32_16x16x32_bf16 v[44:47], a[52:55], a[68:71], v[44:47]
s_and_b32 s86, s86, 0x3c0000
s_add_u32 m0, s97, 0
s_add_u32 s74, s87, 0
v_mfma_f32_16x16x32_bf16 v[44:47], a[116:119], a[132:135], v[44:47]
ds_read_b64_tr_b16 a[36:37], v2 offset:0
v_mfma_f32_16x16x32_bf16 v[60:63], a[116:119], a[136:139], v[60:63]
buffer_load_dwordx4 v18, s[4:7], s74 offen offset:0 lds
v_mfma_f32_16x16x32_bf16 v[60:63], a[52:55], a[72:75], v[60:63]
ds_read_b64_tr_b16 a[38:39], v2 offset:1024
v_mfma_f32_16x16x32_bf16 v[76:79], a[52:55], a[76:79], v[76:79]
v_mfma_f32_16x16x32_bf16 v[76:79], a[116:119], a[140:143], v[76:79]
ds_read_b64_tr_b16 a[48:49], v5 offset:0
v_mfma_f32_16x16x32_bf16 v[92:95], a[116:119], a[144:147], v[92:95]
buffer_load_dwordx4 v19, s[4:7], s74 offen offset:1024 lds
v_mfma_f32_16x16x32_bf16 v[92:95], a[52:55], a[80:83], v[92:95]
ds_read_b64_tr_b16 a[50:51], v5 offset:1024
v_mfma_f32_16x16x32_bf16 v[108:111], a[52:55], a[84:87], v[108:111]
v_mfma_f32_16x16x32_bf16 v[108:111], a[116:119], a[148:151], v[108:111]
v_mfma_f32_16x16x32_bf16 v[124:127], a[116:119], a[152:155], v[124:127]
buffer_load_dwordx4 v20, s[4:7], s74 offen offset:2048 lds
v_mfma_f32_16x16x32_bf16 v[124:127], a[52:55], a[88:91], v[124:127]
v_mfma_f32_16x16x32_bf16 v[140:143], a[52:55], a[92:95], v[140:143]
v_mfma_f32_16x16x32_bf16 v[140:143], a[116:119], a[156:159], v[140:143]
v_mfma_f32_16x16x32_bf16 v[156:159], a[116:119], a[160:163], v[156:159]
buffer_load_dwordx4 v21, s[4:7], s74 offen offset:3072 lds
v_mfma_f32_16x16x32_bf16 v[156:159], a[52:55], a[96:99], v[156:159]
ds_read_b64_tr_b16 a[52:53], v6 offset:0
v_mfma_f32_16x16x32_bf16 v[248:251], a[56:59], a[96:99], v[248:251]
v_mfma_f32_16x16x32_bf16 v[248:251], a[120:123], a[160:163], v[248:251]
ds_read_b64_tr_b16 a[54:55], v6 offset:1024
v_mfma_f32_16x16x32_bf16 v[232:235], a[120:123], a[156:159], v[232:235]
buffer_store_dwordx4 a[164:167], v0, s[76:79], s38 offen sc1
v_mfma_f32_16x16x32_bf16 v[232:235], a[56:59], a[92:95], v[232:235]
s_add_u32 s38, s38, 1024
ds_read_b128 a[96:99], v11 offset:30720
v_mfma_f32_16x16x32_bf16 v[216:219], a[56:59], a[88:91], v[216:219]
v_bfe_u32 v31, v0, 4, 2
v_lshl_add_u32 v31, v31, 6, s83
v_mfma_f32_16x16x32_bf16 v[216:219], a[120:123], a[152:155], v[216:219]
ds_read_b128 a[92:95], v11 offset:28672
v_and_b32 v31, 1023, v31
v_mfma_f32_16x16x32_bf16 v[200:203], a[120:123], a[148:151], v[200:203]
v_lshrrev_b32 v30, 6, v0
v_lshl_or_b32 v30, v30, 10, v31
v_mfma_f32_16x16x32_bf16 v[200:203], a[56:59], a[84:87], v[200:203]
s_lshl_b32 s74, s80, 15
ds_read_b128 a[88:91], v11 offset:26624
v_mfma_f32_16x16x32_bf16 a[28:31], a[56:59], a[80:83], a[28:31]
s_sub_u32 s74, 114688, s74
s_bitcmp1_b32 s85, 0
s_cselect_b32 s74, s74, 0
v_mfma_f32_16x16x32_bf16 a[28:31], a[120:123], a[144:147], a[28:31]
ds_read_b128 a[84:87], v11 offset:24576
v_mfma_f32_16x16x32_bf16 v[184:187], a[120:123], a[140:143], v[184:187]
s_bitcmp1_b32 s85, 1
s_cselect_b32 s75, s99, s98
s_add_u32 s74, s74, s75
v_mfma_f32_16x16x32_bf16 v[184:187], a[56:59], a[76:79], v[184:187]
ds_read_b128 a[80:83], v10 offset:22528
v_mfma_f32_16x16x32_bf16 v[176:179], a[56:59], a[72:75], v[176:179]
buffer_load_dword a185, v30, s[8:11], s74 offen
v_mfma_f32_16x16x32_bf16 v[176:179], a[120:123], a[136:139], v[176:179]
ds_read_b128 a[76:79], v10 offset:20480
v_mfma_f32_16x16x32_bf16 v[168:171], a[120:123], a[132:135], v[168:171]
v_mfma_f32_16x16x32_bf16 v[168:171], a[56:59], a[68:71], v[168:171]
ds_read_b128 a[72:75], v10 offset:18432
v_mfma_f32_16x16x32_bf16 v[48:51], a[124:127], a[132:135], v[48:51]
v_mfma_f32_16x16x32_bf16 v[64:67], a[124:127], a[136:139], v[64:67]
ds_read_b128 a[68:71], v10 offset:16384
v_mfma_f32_16x16x32_bf16 v[80:83], a[124:127], a[140:143], v[80:83]
v_mfma_f32_16x16x32_bf16 v[96:99], a[124:127], a[144:147], v[96:99]
ds_read_b64_tr_b16 a[56:57], v7 offset:0
v_mfma_f32_16x16x32_bf16 v[112:115], a[124:127], a[148:151], v[112:115]
v_mfma_f32_16x16x32_bf16 v[128:131], a[124:127], a[152:155], v[128:131]
ds_read_b64_tr_b16 a[58:59], v7 offset:1024
v_mfma_f32_16x16x32_bf16 v[144:147], a[124:127], a[156:159], v[144:147]
v_mfma_f32_16x16x32_bf16 v[160:163], a[124:127], a[160:163], v[160:163]
v_mfma_f32_16x16x32_bf16 v[252:255], a[128:131], a[160:163], v[252:255]
v_mfma_f32_16x16x32_bf16 v[236:239], a[128:131], a[156:159], v[236:239]
v_mfma_f32_16x16x32_bf16 v[220:223], a[128:131], a[152:155], v[220:223]
v_mfma_f32_16x16x32_bf16 v[204:207], a[128:131], a[148:151], v[204:207]
v_mfma_f32_16x16x32_bf16 a[32:35], a[128:131], a[144:147], a[32:35]
v_mfma_f32_16x16x32_bf16 a[20:23], a[128:131], a[140:143], a[20:23]
v_mfma_f32_16x16x32_bf16 a[12:15], a[128:131], a[136:139], a[12:15]
v_mfma_f32_16x16x32_bf16 a[4:7], a[128:131], a[132:135], a[4:7]
s_waitcnt lgkmcnt(2)
v_mfma_f32_16x16x32_bf16 a[4:7], a[64:67], a[68:71], a[4:7]
s_waitcnt vmcnt(20) lgkmcnt(0)
s_barrier
s_lshl3_add_u32 s75, s80, s82
s_cmp_lg_u32 s75, 5
s_cbranch_scc1 LA_f08
s_mov_b64 exec, 1
v_mov_b32 v1, 1
buffer_atomic_add v1, off, s[24:27], 0 sc1
s_mov_b64 exec, -1
LA_f08:
v_mfma_f32_16x16x32_bf16 a[12:15], a[64:67], a[72:75], a[12:15]
s_add_u32 m0, s96, 0
ds_read_b64_tr_b16 a[100:101], v2 offset:16384
v_mfma_f32_16x16x32_bf16 a[20:23], a[64:67], a[76:79], a[20:23]
ds_read_b64_tr_b16 a[102:103], v2 offset:17408
v_mfma_f32_16x16x32_bf16 a[32:35], a[64:67], a[80:83], a[32:35]
ds_read_b128 a[132:135], v12 offset:16384
v_mfma_f32_16x16x32_bf16 v[204:207], a[64:67], a[84:87], v[204:207]
ds_read_b128 a[136:139], v12 offset:18432
v_mfma_f32_16x16x32_bf16 v[220:223], a[64:67], a[88:91], v[220:223]
ds_read_b128 a[140:143], v12 offset:20480
v_mfma_f32_16x16x32_bf16 v[236:239], a[64:67], a[92:95], v[236:239]
ds_read_b128 a[144:147], v12 offset:22528
v_mfma_f32_16x16x32_bf16 v[252:255], a[64:67], a[96:99], v[252:255]
ds_read_b128 a[148:151], v13 offset:24576
v_mfma_f32_16x16x32_bf16 v[160:163], a[60:63], a[96:99], v[160:163]
ds_read_b128 a[152:155], v13 offset:26624
v_mfma_f32_16x16x32_bf16 v[144:147], a[60:63], a[92:95], v[144:147]
ds_read_b128 a[156:159], v13 offset:28672
v_mfma_f32_16x16x32_bf16 v[128:131], a[60:63], a[88:91], v[128:131]
ds_read_b128 a[160:163], v13 offset:30720
v_mfma_f32_16x16x32_bf16 v[112:115], a[60:63], a[84:87], v[112:115]
buffer_load_dwordx4 v14, s[12:15], s86 offen offset:0 lds
v_mfma_f32_16x16x32_bf16 v[96:99], a[60:63], a[80:83], v[96:99]
ds_read_b64_tr_b16 a[104:105], v3 offset:16384
v_mfma_f32_16x16x32_bf16 v[80:83], a[60:63], a[76:79], v[80:83]
v_mfma_f32_16x16x32_bf16 v[64:67], a[60:63], a[72:75], v[64:67]
ds_read_b64_tr_b16 a[106:107], v3 offset:17408
v_mfma_f32_16x16x32_bf16 v[48:51], a[60:63], a[68:71], v[48:51]
buffer_load_dwordx4 v15, s[12:15], s86 offen offset:1024 lds
v_mfma_f32_16x16x32_bf16 v[36:39], a[36:39], a[68:71], v[36:39]
s_waitcnt lgkmcnt(9)
ds_read_b64_tr_b16 a[108:109], v4 offset:16384
v_mfma_f32_16x16x32_bf16 v[36:39], a[100:103], a[132:135], v[36:39]
s_waitcnt lgkmcnt(9)
v_mfma_f32_16x16x32_bf16 v[52:55], a[100:103], a[136:139], v[52:55]
ds_read_b64_tr_b16 a[110:111], v4 offset:17408
v_mfma_f32_16x16x32_bf16 v[52:55], a[36:39], a[72:75], v[52:55]
buffer_load_dwordx4 v16, s[12:15], s86 offen offset:2048 lds
v_mfma_f32_16x16x32_bf16 v[68:71], a[36:39], a[76:79], v[68:71]
s_waitcnt lgkmcnt(9)
ds_read_b64_tr_b16 a[112:113], v5 offset:16384
v_mfma_f32_16x16x32_bf16 v[68:71], a[100:103], a[140:143], v[68:71]
s_waitcnt lgkmcnt(9)
v_mfma_f32_16x16x32_bf16 v[84:87], a[100:103], a[144:147], v[84:87]
ds_read_b64_tr_b16 a[114:115], v5 offset:17408
v_mfma_f32_16x16x32_bf16 v[84:87], a[36:39], a[80:83], v[84:87]
buffer_load_dwordx4 v17, s[12:15], s86 offen offset:3072 lds
v_mfma_f32_16x16x32_bf16 v[100:103], a[36:39], a[84:87], v[100:103]
s_waitcnt lgkmcnt(9)
s_add_u32 s86, s86, 0x40000
ds_read_b64_tr_b16 a[116:117], v6 offset:16384
v_mfma_f32_16x16x32_bf16 v[100:103], a[100:103], a[148:151], v[100:103]
s_waitcnt lgkmcnt(9)
s_and_b32 s86, s86, 0x3c0000
s_add_u32 m0, s97, 4096
s_add_u32 s74, s87, 32768
v_mfma_f32_16x16x32_bf16 v[116:119], a[100:103], a[152:155], v[116:119]
ds_read_b64_tr_b16 a[118:119], v6 offset:17408
v_mfma_f32_16x16x32_bf16 v[116:119], a[36:39], a[88:91], v[116:119]
buffer_load_dwordx4 v18, s[4:7], s74 offen offset:0 lds
v_mfma_f32_16x16x32_bf16 v[132:135], a[36:39], a[92:95], v[132:135]
s_waitcnt lgkmcnt(9)
ds_read_b64_tr_b16 a[120:121], v7 offset:16384
v_mfma_f32_16x16x32_bf16 v[132:135], a[100:103], a[156:159], v[132:135]
s_waitcnt lgkmcnt(9)
v_mfma_f32_16x16x32_bf16 v[148:151], a[100:103], a[160:163], v[148:151]
ds_read_b64_tr_b16 a[122:123], v7 offset:17408
v_mfma_f32_16x16x32_bf16 v[148:151], a[36:39], a[96:99], v[148:151]
buffer_load_dwordx4 v19, s[4:7], s74 offen offset:1024 lds
v_mfma_f32_16x16x32_bf16 v[240:243], a[40:43], a[96:99], v[240:243]
s_waitcnt lgkmcnt(8)
ds_read_b64_tr_b16 a[124:125], v8 offset:16384
v_mfma_f32_16x16x32_bf16 v[240:243], a[104:107], a[160:163], v[240:243]
v_mfma_f32_16x16x32_bf16 v[224:227], a[104:107], a[156:159], v[224:227]
ds_read_b64_tr_b16 a[126:127], v8 offset:17408
v_mfma_f32_16x16x32_bf16 v[224:227], a[40:43], a[92:95], v[224:227]
buffer_load_dwordx4 v20, s[4:7], s74 offen offset:2048 lds
v_mfma_f32_16x16x32_bf16 v[208:211], a[40:43], a[88:91], v[208:211]
ds_read_b64_tr_b16 a[128:129], v9 offset:16384
v_mfma_f32_16x16x32_bf16 v[208:211], a[104:107], a[152:155], v[208:211]
v_mfma_f32_16x16x32_bf16 v[192:195], a[104:107], a[148:151], v[192:195]
ds_read_b64_tr_b16 a[130:131], v9 offset:17408
v_mfma_f32_16x16x32_bf16 v[192:195], a[40:43], a[84:87], v[192:195]
buffer_load_dwordx4 v21, s[4:7], s74 offen offset:3072 lds
v_mfma_f32_16x16x32_bf16 v[188:191], a[40:43], a[80:83], v[188:191]
s_add_u32 s87, s87, 128
s_and_b32 s87, s87, 1023
v_mfma_f32_16x16x32_bf16 v[188:191], a[104:107], a[144:147], v[188:191]
v_mfma_f32_16x16x32_bf16 v[180:183], a[104:107], a[140:143], v[180:183]
v_mfma_f32_16x16x32_bf16 v[180:183], a[40:43], a[76:79], v[180:183]
buffer_store_dwordx4 a[164:167], v0, s[76:79], s38 offen sc1
v_mfma_f32_16x16x32_bf16 v[172:175], a[40:43], a[72:75], v[172:175]
s_add_u32 s38, s38, 1024
v_mfma_f32_16x16x32_bf16 v[172:175], a[104:107], a[136:139], v[172:175]
v_mfma_f32_16x16x32_bf16 v[164:167], a[104:107], a[132:135], v[164:167]
v_mfma_f32_16x16x32_bf16 v[164:167], a[40:43], a[68:71], v[164:167]
v_mfma_f32_16x16x32_bf16 v[40:43], a[44:47], a[68:71], v[40:43]
s_waitcnt lgkmcnt(10)
v_mfma_f32_16x16x32_bf16 v[40:43], a[108:111], a[132:135], v[40:43]
v_mfma_f32_16x16x32_bf16 v[56:59], a[108:111], a[136:139], v[56:59]
v_mfma_f32_16x16x32_bf16 v[56:59], a[44:47], a[72:75], v[56:59]
v_mfma_f32_16x16x32_bf16 v[72:75], a[44:47], a[76:79], v[72:75]
v_mfma_f32_16x16x32_bf16 v[72:75], a[108:111], a[140:143], v[72:75]
v_mfma_f32_16x16x32_bf16 v[88:91], a[108:111], a[144:147], v[88:91]
v_mfma_f32_16x16x32_bf16 v[88:91], a[44:47], a[80:83], v[88:91]
v_mfma_f32_16x16x32_bf16 v[104:107], a[44:47], a[84:87], v[104:107]
v_mfma_f32_16x16x32_bf16 v[104:107], a[108:111], a[148:151], v[104:107]
v_mfma_f32_16x16x32_bf16 v[120:123], a[108:111], a[152:155], v[120:123]
v_mfma_f32_16x16x32_bf16 v[120:123], a[44:47], a[88:91], v[120:123]
v_mfma_f32_16x16x32_bf16 v[136:139], a[44:47], a[92:95], v[136:139]
v_mfma_f32_16x16x32_bf16 v[136:139], a[108:111], a[156:159], v[136:139]
v_mfma_f32_16x16x32_bf16 v[152:155], a[108:111], a[160:163], v[152:155]
v_mfma_f32_16x16x32_bf16 v[152:155], a[44:47], a[96:99], v[152:155]
v_mfma_f32_16x16x32_bf16 v[244:247], a[48:51], a[96:99], v[244:247]
s_waitcnt vmcnt(19) lgkmcnt(0)
s_barrier
s_lshl3_add_u32 s75, s80, s82
s_cmp_lg_u32 s75, 6
s_cbranch_scc1 LA_f09
s_mov_b64 exec, 1
v_mov_b32 v1, 1
buffer_atomic_add v1, off, s[24:27], 0 sc1
s_mov_b64 exec, -1
LA_f09:
v_mfma_f32_16x16x32_bf16 v[244:247], a[112:115], a[160:163], v[244:247]
s_add_u32 m0, s96, 16384
ds_read_b64_tr_b16 a[64:65], v9 offset:32768
v_mfma_f32_16x16x32_bf16 v[228:231], a[112:115], a[156:159], v[228:231]
buffer_load_dwordx4 v14, s[12:15], s86 offen offset:0 lds
v_mfma_f32_16x16x32_bf16 v[228:231], a[48:51], a[92:95], v[228:231]
ds_read_b64_tr_b16 a[66:67], v9 offset:33792
v_mfma_f32_16x16x32_bf16 v[212:215], a[48:51], a[88:91], v[212:215]
v_mfma_f32_16x16x32_bf16 v[212:215], a[112:115], a[152:155], v[212:215]
ds_read_b64_tr_b16 a[60:61], v8 offset:32768
v_mfma_f32_16x16x32_bf16 v[196:199], a[112:115], a[148:151], v[196:199]
buffer_load_dwordx4 v15, s[12:15], s86 offen offset:1024 lds
v_mfma_f32_16x16x32_bf16 v[196:199], a[48:51], a[84:87], v[196:199]
ds_read_b64_tr_b16 a[62:63], v8 offset:33792
v_mfma_f32_16x16x32_bf16 a[24:27], a[48:51], a[80:83], a[24:27]
v_mfma_f32_16x16x32_bf16 a[24:27], a[112:115], a[144:147], a[24:27]
ds_read_b64_tr_b16 a[44:45], v4 offset:32768
v_mfma_f32_16x16x32_bf16 a[16:19], a[112:115], a[140:143], a[16:19]
buffer_load_dwordx4 v16, s[12:15], s86 offen offset:2048 lds
v_mfma_f32_16x16x32_bf16 a[16:19], a[48:51], a[76:79], a[16:19]
ds_read_b64_tr_b16 a[46:47], v4 offset:33792
v_mfma_f32_16x16x32_bf16 a[8:11], a[48:51], a[72:75], a[8:11]
v_mfma_f32_16x16x32_bf16 a[8:11], a[112:115], a[136:139], a[8:11]
ds_read_b64_tr_b16 a[40:41], v3 offset:32768
v_mfma_f32_16x16x32_bf16 a[0:3], a[112:115], a[132:135], a[0:3]
buffer_load_dwordx4 v17, s[12:15], s86 offen offset:3072 lds
v_mfma_f32_16x16x32_bf16 a[0:3], a[48:51], a[68:71], a[0:3]
s_add_u32 s86, s86, 0x40000
ds_read_b64_tr_b16 a[42:43], v3 offset:33792
v_mfma_f32_16x16x32_bf16 v[44:47], a[52:55], a[68:71], v[44:47]
s_and_b32 s86, s86, 0x3c0000
s_add_u32 m0, s97, 16384
s_add_u32 s74, s87, 0
v_mfma_f32_16x16x32_bf16 v[44:47], a[116:119], a[132:135], v[44:47]
ds_read_b64_tr_b16 a[36:37], v2 offset:32768
v_mfma_f32_16x16x32_bf16 v[60:63], a[116:119], a[136:139], v[60:63]
buffer_load_dwordx4 v18, s[4:7], s74 offen offset:0 lds
v_mfma_f32_16x16x32_bf16 v[60:63], a[52:55], a[72:75], v[60:63]
ds_read_b64_tr_b16 a[38:39], v2 offset:33792
v_mfma_f32_16x16x32_bf16 v[76:79], a[52:55], a[76:79], v[76:79]
v_mfma_f32_16x16x32_bf16 v[76:79], a[116:119], a[140:143], v[76:79]
ds_read_b64_tr_b16 a[48:49], v5 offset:32768
v_mfma_f32_16x16x32_bf16 v[92:95], a[116:119], a[144:147], v[92:95]
buffer_load_dwordx4 v19, s[4:7], s74 offen offset:1024 lds
v_mfma_f32_16x16x32_bf16 v[92:95], a[52:55], a[80:83], v[92:95]
ds_read_b64_tr_b16 a[50:51], v5 offset:33792
v_mfma_f32_16x16x32_bf16 v[108:111], a[52:55], a[84:87], v[108:111]
v_mfma_f32_16x16x32_bf16 v[108:111], a[116:119], a[148:151], v[108:111]
v_mfma_f32_16x16x32_bf16 v[124:127], a[116:119], a[152:155], v[124:127]
buffer_load_dwordx4 v20, s[4:7], s74 offen offset:2048 lds
v_mfma_f32_16x16x32_bf16 v[124:127], a[52:55], a[88:91], v[124:127]
v_mfma_f32_16x16x32_bf16 v[140:143], a[52:55], a[92:95], v[140:143]
v_mfma_f32_16x16x32_bf16 v[140:143], a[116:119], a[156:159], v[140:143]
v_mfma_f32_16x16x32_bf16 v[156:159], a[116:119], a[160:163], v[156:159]
buffer_load_dwordx4 v21, s[4:7], s74 offen offset:3072 lds
v_mfma_f32_16x16x32_bf16 v[156:159], a[52:55], a[96:99], v[156:159]
ds_read_b64_tr_b16 a[52:53], v6 offset:32768
v_mfma_f32_16x16x32_bf16 v[248:251], a[56:59], a[96:99], v[248:251]
v_mfma_f32_16x16x32_bf16 v[248:251], a[120:123], a[160:163], v[248:251]
ds_read_b64_tr_b16 a[54:55], v6 offset:33792
v_mfma_f32_16x16x32_bf16 v[232:235], a[120:123], a[156:159], v[232:235]
buffer_store_dwordx4 a[164:167], v0, s[76:79], s38 offen sc1
v_mfma_f32_16x16x32_bf16 v[232:235], a[56:59], a[92:95], v[232:235]
s_add_u32 s38, s38, 1024
ds_read_b128 a[96:99], v11 offset:47104
v_mfma_f32_16x16x32_bf16 v[216:219], a[56:59], a[88:91], v[216:219]
v_lshrrev_b32 v30, 5, v0
v_and_b32 v31, 16, v0
v_mfma_f32_16x16x32_bf16 v[216:219], a[120:123], a[152:155], v[216:219]
ds_read_b128 a[92:95], v11 offset:45056
v_lshlrev_b32 v31, 2, v31
v_mfma_f32_16x16x32_bf16 v[200:203], a[120:123], a[148:151], v[200:203]
v_lshl_or_b32 v30, v30, 10, v31
v_mfma_f32_16x16x32_bf16 v[200:203], a[56:59], a[84:87], v[200:203]
ds_read_b128 a[88:91], v11 offset:43008
v_mfma_f32_16x16x32_bf16 a[28:31], a[56:59], a[80:83], a[28:31]
buffer_load_dword a187, v30, s[28:31], s83 offen
v_mfma_f32_16x16x32_bf16 a[28:31], a[120:123], a[144:147], a[28:31]
ds_read_b128 a[84:87], v11 offset:40960
v_mfma_f32_16x16x32_bf16 v[184:187], a[120:123], a[140:143], v[184:187]
v_mfma_f32_16x16x32_bf16 v[184:187], a[56:59], a[76:79], v[184:187]
ds_read_b128 a[80:83], v10 offset:38912
v_mfma_f32_16x16x32_bf16 v[176:179], a[56:59], a[72:75], v[176:179]
v_mfma_f32_16x16x32_bf16 v[176:179], a[120:123], a[136:139], v[176:179]
ds_read_b128 a[76:79], v10 offset:36864
v_mfma_f32_16x16x32_bf16 v[168:171], a[120:123], a[132:135], v[168:171]
v_mfma_f32_16x16x32_bf16 v[168:171], a[56:59], a[68:71], v[168:171]
ds_read_b128 a[72:75], v10 offset:34816
v_mfma_f32_16x16x32_bf16 v[48:51], a[124:127], a[132:135], v[48:51]
v_mfma_f32_16x16x32_bf16 v[64:67], a[124:127], a[136:139], v[64:67]
ds_read_b128 a[68:71], v10 offset:32768
v_mfma_f32_16x16x32_bf16 v[80:83], a[124:127], a[140:143], v[80:83]
v_mfma_f32_16x16x32_bf16 v[96:99], a[124:127], a[144:147], v[96:99]
ds_read_b64_tr_b16 a[56:57], v7 offset:32768
v_mfma_f32_16x16x32_bf16 v[112:115], a[124:127], a[148:151], v[112:115]
v_mfma_f32_16x16x32_bf16 v[128:131], a[124:127], a[152:155], v[128:131]
ds_read_b64_tr_b16 a[58:59], v7 offset:33792
v_mfma_f32_16x16x32_bf16 v[144:147], a[124:127], a[156:159], v[144:147]
v_mfma_f32_16x16x32_bf16 v[160:163], a[124:127], a[160:163], v[160:163]
v_mfma_f32_16x16x32_bf16 v[252:255], a[128:131], a[160:163], v[252:255]
v_mfma_f32_16x16x32_bf16 v[236:239], a[128:131], a[156:159], v[236:239]
v_mfma_f32_16x16x32_bf16 v[220:223], a[128:131], a[152:155], v[220:223]
v_mfma_f32_16x16x32_bf16 v[204:207], a[128:131], a[148:151], v[204:207]
v_mfma_f32_16x16x32_bf16 a[32:35], a[128:131], a[144:147], a[32:35]
v_mfma_f32_16x16x32_bf16 a[20:23], a[128:131], a[140:143], a[20:23]
v_mfma_f32_16x16x32_bf16 a[12:15], a[128:131], a[136:139], a[12:15]
v_mfma_f32_16x16x32_bf16 a[4:7], a[128:131], a[132:135], a[4:7]
s_waitcnt lgkmcnt(2)
v_mfma_f32_16x16x32_bf16 a[4:7], a[64:67], a[68:71], a[4:7]
s_waitcnt vmcnt(19) lgkmcnt(0)
s_barrier
s_lshl3_add_u32 s75, s80, s82
s_cmp_lg_u32 s75, 7
s_cbranch_scc1 LA_f010
s_mov_b64 exec, 1
v_mov_b32 v1, 1
buffer_atomic_add v1, off, s[24:27], 0 sc1
s_mov_b64 exec, -1
LA_f010:
v_mfma_f32_16x16x32_bf16 a[12:15], a[64:67], a[72:75], a[12:15]
s_add_u32 m0, s96, 32768
ds_read_b64_tr_b16 a[100:101], v2 offset:49152
v_mfma_f32_16x16x32_bf16 a[20:23], a[64:67], a[76:79], a[20:23]
ds_read_b64_tr_b16 a[102:103], v2 offset:50176
v_mfma_f32_16x16x32_bf16 a[32:35], a[64:67], a[80:83], a[32:35]
ds_read_b128 a[132:135], v12 offset:32768
v_mfma_f32_16x16x32_bf16 v[204:207], a[64:67], a[84:87], v[204:207]
ds_read_b128 a[136:139], v12 offset:34816
v_mfma_f32_16x16x32_bf16 v[220:223], a[64:67], a[88:91], v[220:223]
ds_read_b128 a[140:143], v12 offset:36864
v_mfma_f32_16x16x32_bf16 v[236:239], a[64:67], a[92:95], v[236:239]
ds_read_b128 a[144:147], v12 offset:38912
v_mfma_f32_16x16x32_bf16 v[252:255], a[64:67], a[96:99], v[252:255]
ds_read_b128 a[148:151], v13 offset:40960
v_mfma_f32_16x16x32_bf16 v[160:163], a[60:63], a[96:99], v[160:163]
ds_read_b128 a[152:155], v13 offset:43008
v_mfma_f32_16x16x32_bf16 v[144:147], a[60:63], a[92:95], v[144:147]
ds_read_b128 a[156:159], v13 offset:45056
v_mfma_f32_16x16x32_bf16 v[128:131], a[60:63], a[88:91], v[128:131]
ds_read_b128 a[160:163], v13 offset:47104
v_mfma_f32_16x16x32_bf16 v[112:115], a[60:63], a[84:87], v[112:115]
buffer_load_dwordx4 v14, s[12:15], s86 offen offset:0 lds
v_mfma_f32_16x16x32_bf16 v[96:99], a[60:63], a[80:83], v[96:99]
ds_read_b64_tr_b16 a[104:105], v3 offset:49152
v_mfma_f32_16x16x32_bf16 v[80:83], a[60:63], a[76:79], v[80:83]
v_mfma_f32_16x16x32_bf16 v[64:67], a[60:63], a[72:75], v[64:67]
ds_read_b64_tr_b16 a[106:107], v3 offset:50176
v_mfma_f32_16x16x32_bf16 v[48:51], a[60:63], a[68:71], v[48:51]
buffer_load_dwordx4 v15, s[12:15], s86 offen offset:1024 lds
v_mfma_f32_16x16x32_bf16 v[36:39], a[36:39], a[68:71], v[36:39]
s_waitcnt lgkmcnt(9)
ds_read_b64_tr_b16 a[108:109], v4 offset:49152
v_mfma_f32_16x16x32_bf16 v[36:39], a[100:103], a[132:135], v[36:39]
s_waitcnt lgkmcnt(9)
v_mfma_f32_16x16x32_bf16 v[52:55], a[100:103], a[136:139], v[52:55]
ds_read_b64_tr_b16 a[110:111], v4 offset:50176
v_mfma_f32_16x16x32_bf16 v[52:55], a[36:39], a[72:75], v[52:55]
buffer_load_dwordx4 v16, s[12:15], s86 offen offset:2048 lds
v_mfma_f32_16x16x32_bf16 v[68:71], a[36:39], a[76:79], v[68:71]
s_waitcnt lgkmcnt(9)
ds_read_b64_tr_b16 a[112:113], v5 offset:49152
v_mfma_f32_16x16x32_bf16 v[68:71], a[100:103], a[140:143], v[68:71]
s_waitcnt lgkmcnt(9)
v_mfma_f32_16x16x32_bf16 v[84:87], a[100:103], a[144:147], v[84:87]
ds_read_b64_tr_b16 a[114:115], v5 offset:50176
v_mfma_f32_16x16x32_bf16 v[84:87], a[36:39], a[80:83], v[84:87]
buffer_load_dwordx4 v17, s[12:15], s86 offen offset:3072 lds
v_mfma_f32_16x16x32_bf16 v[100:103], a[36:39], a[84:87], v[100:103]
s_waitcnt lgkmcnt(9)
s_add_u32 s86, s86, 0x40000
ds_read_b64_tr_b16 a[116:117], v6 offset:49152
v_mfma_f32_16x16x32_bf16 v[100:103], a[100:103], a[148:151], v[100:103]
s_waitcnt lgkmcnt(9)
s_and_b32 s86, s86, 0x3c0000
s_add_u32 m0, s97, 20480
s_add_u32 s74, s87, 32768
v_mfma_f32_16x16x32_bf16 v[116:119], a[100:103], a[152:155], v[116:119]
ds_read_b64_tr_b16 a[118:119], v6 offset:50176
v_mfma_f32_16x16x32_bf16 v[116:119], a[36:39], a[88:91], v[116:119]
buffer_load_dwordx4 v18, s[4:7], s74 offen offset:0 lds
v_mfma_f32_16x16x32_bf16 v[132:135], a[36:39], a[92:95], v[132:135]
s_waitcnt lgkmcnt(9)
ds_read_b64_tr_b16 a[120:121], v7 offset:49152
v_mfma_f32_16x16x32_bf16 v[132:135], a[100:103], a[156:159], v[132:135]
s_waitcnt lgkmcnt(9)
v_mfma_f32_16x16x32_bf16 v[148:151], a[100:103], a[160:163], v[148:151]
ds_read_b64_tr_b16 a[122:123], v7 offset:50176
v_mfma_f32_16x16x32_bf16 v[148:151], a[36:39], a[96:99], v[148:151]
buffer_load_dwordx4 v19, s[4:7], s74 offen offset:1024 lds
v_mfma_f32_16x16x32_bf16 v[240:243], a[40:43], a[96:99], v[240:243]
s_waitcnt lgkmcnt(8)
ds_read_b64_tr_b16 a[124:125], v8 offset:49152
v_mfma_f32_16x16x32_bf16 v[240:243], a[104:107], a[160:163], v[240:243]
v_mfma_f32_16x16x32_bf16 v[224:227], a[104:107], a[156:159], v[224:227]
ds_read_b64_tr_b16 a[126:127], v8 offset:50176
v_mfma_f32_16x16x32_bf16 v[224:227], a[40:43], a[92:95], v[224:227]
buffer_load_dwordx4 v20, s[4:7], s74 offen offset:2048 lds
v_mfma_f32_16x16x32_bf16 v[208:211], a[40:43], a[88:91], v[208:211]
ds_read_b64_tr_b16 a[128:129], v9 offset:49152
v_mfma_f32_16x16x32_bf16 v[208:211], a[104:107], a[152:155], v[208:211]
v_mfma_f32_16x16x32_bf16 v[192:195], a[104:107], a[148:151], v[192:195]
ds_read_b64_tr_b16 a[130:131], v9 offset:50176
v_mfma_f32_16x16x32_bf16 v[192:195], a[40:43], a[84:87], v[192:195]
buffer_load_dwordx4 v21, s[4:7], s74 offen offset:3072 lds
v_mfma_f32_16x16x32_bf16 v[188:191], a[40:43], a[80:83], v[188:191]
s_add_u32 s87, s87, 128
s_and_b32 s87, s87, 1023
v_mfma_f32_16x16x32_bf16 v[188:191], a[104:107], a[144:147], v[188:191]
v_mfma_f32_16x16x32_bf16 v[180:183], a[104:107], a[140:143], v[180:183]
v_mfma_f32_16x16x32_bf16 v[180:183], a[40:43], a[76:79], v[180:183]
buffer_store_dwordx4 a[164:167], v0, s[76:79], s38 offen sc1
v_mfma_f32_16x16x32_bf16 v[172:175], a[40:43], a[72:75], v[172:175]
s_add_u32 s38, s38, 1024
v_mfma_f32_16x16x32_bf16 v[172:175], a[104:107], a[136:139], v[172:175]
v_mfma_f32_16x16x32_bf16 v[164:167], a[104:107], a[132:135], v[164:167]
v_mfma_f32_16x16x32_bf16 v[164:167], a[40:43], a[68:71], v[164:167]
v_mfma_f32_16x16x32_bf16 v[40:43], a[44:47], a[68:71], v[40:43]
s_waitcnt lgkmcnt(10)
v_mfma_f32_16x16x32_bf16 v[40:43], a[108:111], a[132:135], v[40:43]
v_mfma_f32_16x16x32_bf16 v[56:59], a[108:111], a[136:139], v[56:59]
v_mfma_f32_16x16x32_bf16 v[56:59], a[44:47], a[72:75], v[56:59]
v_mfma_f32_16x16x32_bf16 v[72:75], a[44:47], a[76:79], v[72:75]
v_mfma_f32_16x16x32_bf16 v[72:75], a[108:111], a[140:143], v[72:75]
v_mfma_f32_16x16x32_bf16 v[88:91], a[108:111], a[144:147], v[88:91]
v_mfma_f32_16x16x32_bf16 v[88:91], a[44:47], a[80:83], v[88:91]
v_mfma_f32_16x16x32_bf16 v[104:107], a[44:47], a[84:87], v[104:107]
v_mfma_f32_16x16x32_bf16 v[104:107], a[108:111], a[148:151], v[104:107]
v_mfma_f32_16x16x32_bf16 v[120:123], a[108:111], a[152:155], v[120:123]
v_mfma_f32_16x16x32_bf16 v[120:123], a[44:47], a[88:91], v[120:123]
v_mfma_f32_16x16x32_bf16 v[136:139], a[44:47], a[92:95], v[136:139]
v_mfma_f32_16x16x32_bf16 v[136:139], a[108:111], a[156:159], v[136:139]
v_mfma_f32_16x16x32_bf16 v[152:155], a[108:111], a[160:163], v[152:155]
v_mfma_f32_16x16x32_bf16 v[152:155], a[44:47], a[96:99], v[152:155]
v_mfma_f32_16x16x32_bf16 v[244:247], a[48:51], a[96:99], v[244:247]
s_waitcnt vmcnt(19) lgkmcnt(0)
s_barrier
v_mfma_f32_16x16x32_bf16 v[244:247], a[112:115], a[160:163], v[244:247]
s_add_u32 m0, s96, 49152
ds_read_b64_tr_b16 a[64:65], v9 offset:0
v_mfma_f32_16x16x32_bf16 v[228:231], a[112:115], a[156:159], v[228:231]
buffer_load_dwordx4 v14, s[12:15], s86 offen offset:0 lds
v_mfma_f32_16x16x32_bf16 v[228:231], a[48:51], a[92:95], v[228:231]
ds_read_b64_tr_b16 a[66:67], v9 offset:1024
v_mfma_f32_16x16x32_bf16 v[212:215], a[48:51], a[88:91], v[212:215]
v_mfma_f32_16x16x32_bf16 v[212:215], a[112:115], a[152:155], v[212:215]
ds_read_b64_tr_b16 a[60:61], v8 offset:0
v_mfma_f32_16x16x32_bf16 v[196:199], a[112:115], a[148:151], v[196:199]
buffer_load_dwordx4 v15, s[12:15], s86 offen offset:1024 lds
v_mfma_f32_16x16x32_bf16 v[196:199], a[48:51], a[84:87], v[196:199]
ds_read_b64_tr_b16 a[62:63], v8 offset:1024
v_mfma_f32_16x16x32_bf16 a[24:27], a[48:51], a[80:83], a[24:27]
v_mfma_f32_16x16x32_bf16 a[24:27], a[112:115], a[144:147], a[24:27]
ds_read_b64_tr_b16 a[44:45], v4 offset:0
v_mfma_f32_16x16x32_bf16 a[16:19], a[112:115], a[140:143], a[16:19]
buffer_load_dwordx4 v16, s[12:15], s86 offen offset:2048 lds
v_mfma_f32_16x16x32_bf16 a[16:19], a[48:51], a[76:79], a[16:19]
ds_read_b64_tr_b16 a[46:47], v4 offset:1024
v_mfma_f32_16x16x32_bf16 a[8:11], a[48:51], a[72:75], a[8:11]
v_mfma_f32_16x16x32_bf16 a[8:11], a[112:115], a[136:139], a[8:11]
ds_read_b64_tr_b16 a[40:41], v3 offset:0
v_mfma_f32_16x16x32_bf16 a[0:3], a[112:115], a[132:135], a[0:3]
buffer_load_dwordx4 v17, s[12:15], s86 offen offset:3072 lds
v_mfma_f32_16x16x32_bf16 a[0:3], a[48:51], a[68:71], a[0:3]
s_add_u32 s86, s86, 0x40000
ds_read_b64_tr_b16 a[42:43], v3 offset:1024
v_mfma_f32_16x16x32_bf16 v[44:47], a[52:55], a[68:71], v[44:47]
s_and_b32 s86, s86, 0x3c0000
s_add_u32 m0, s97, 32768
s_add_u32 s74, s87, s98
v_mfma_f32_16x16x32_bf16 v[44:47], a[116:119], a[132:135], v[44:47]
ds_read_b64_tr_b16 a[36:37], v2 offset:0
v_mfma_f32_16x16x32_bf16 v[60:63], a[116:119], a[136:139], v[60:63]
buffer_load_dwordx4 v18, s[8:11], s74 offen offset:0 lds
v_mfma_f32_16x16x32_bf16 v[60:63], a[52:55], a[72:75], v[60:63]
ds_read_b64_tr_b16 a[38:39], v2 offset:1024
v_mfma_f32_16x16x32_bf16 v[76:79], a[52:55], a[76:79], v[76:79]
v_mfma_f32_16x16x32_bf16 v[76:79], a[116:119], a[140:143], v[76:79]
ds_read_b64_tr_b16 a[48:49], v5 offset:0
v_mfma_f32_16x16x32_bf16 v[92:95], a[116:119], a[144:147], v[92:95]
buffer_load_dwordx4 v19, s[8:11], s74 offen offset:1024 lds
v_mfma_f32_16x16x32_bf16 v[92:95], a[52:55], a[80:83], v[92:95]
ds_read_b64_tr_b16 a[50:51], v5 offset:1024
v_mfma_f32_16x16x32_bf16 v[108:111], a[52:55], a[84:87], v[108:111]
v_mfma_f32_16x16x32_bf16 v[108:111], a[116:119], a[148:151], v[108:111]
v_mfma_f32_16x16x32_bf16 v[124:127], a[116:119], a[152:155], v[124:127]
buffer_load_dwordx4 v22, s[8:11], s74 offen offset:2048 lds
v_mfma_f32_16x16x32_bf16 v[124:127], a[52:55], a[88:91], v[124:127]
v_mfma_f32_16x16x32_bf16 v[140:143], a[52:55], a[92:95], v[140:143]
v_mfma_f32_16x16x32_bf16 v[140:143], a[116:119], a[156:159], v[140:143]
v_mfma_f32_16x16x32_bf16 v[156:159], a[116:119], a[160:163], v[156:159]
buffer_load_dwordx4 v23, s[8:11], s74 offen offset:3072 lds
v_mfma_f32_16x16x32_bf16 v[156:159], a[52:55], a[96:99], v[156:159]
ds_read_b64_tr_b16 a[52:53], v6 offset:0
v_mfma_f32_16x16x32_bf16 v[248:251], a[56:59], a[96:99], v[248:251]
v_mfma_f32_16x16x32_bf16 v[248:251], a[120:123], a[160:163], v[248:251]
ds_read_b64_tr_b16 a[54:55], v6 offset:1024
v_mfma_f32_16x16x32_bf16 v[232:235], a[120:123], a[156:159], v[232:235]
buffer_store_dwordx4 a[164:167], v0, s[76:79], s38 offen sc1
v_mfma_f32_16x16x32_bf16 v[232:235], a[56:59], a[92:95], v[232:235]
s_add_u32 s38, s38, 1024
ds_read_b128 a[96:99], v11 offset:14336
v_mfma_f32_16x16x32_bf16 v[216:219], a[56:59], a[88:91], v[216:219]
v_xor_b32 v30, 64, v28
v_xor_b32 v31, 96, v28
v_mfma_f32_16x16x32_bf16 v[216:219], a[120:123], a[152:155], v[216:219]
ds_read_b128 a[92:95], v11 offset:12288
v_mfma_f32_16x16x32_bf16 v[200:203], a[120:123], a[148:151], v[200:203]
v_mfma_f32_16x16x32_bf16 v[200:203], a[56:59], a[84:87], v[200:203]
ds_read_b128 a[88:91], v11 offset:10240
v_mfma_f32_16x16x32_bf16 a[28:31], a[56:59], a[80:83], a[28:31]
v_mfma_f32_16x16x32_bf16 a[28:31], a[120:123], a[144:147], a[28:31]
ds_read_b128 a[84:87], v11 offset:8192
v_mfma_f32_16x16x32_bf16 v[184:187], a[120:123], a[140:143], v[184:187]
v_mfma_f32_16x16x32_bf16 v[184:187], a[56:59], a[76:79], v[184:187]
ds_read_b128 a[80:83], v10 offset:6144
v_mfma_f32_16x16x32_bf16 v[176:179], a[56:59], a[72:75], v[176:179]
v_mfma_f32_16x16x32_bf16 v[176:179], a[120:123], a[136:139], v[176:179]
ds_read_b128 a[76:79], v10 offset:4096
v_mfma_f32_16x16x32_bf16 v[168:171], a[120:123], a[132:135], v[168:171]
v_mfma_f32_16x16x32_bf16 v[168:171], a[56:59], a[68:71], v[168:171]
ds_read_b128 a[72:75], v10 offset:2048
v_mfma_f32_16x16x32_bf16 v[48:51], a[124:127], a[132:135], v[48:51]
v_mfma_f32_16x16x32_bf16 v[64:67], a[124:127], a[136:139], v[64:67]
ds_read_b128 a[68:71], v10 offset:0
v_mfma_f32_16x16x32_bf16 v[80:83], a[124:127], a[140:143], v[80:83]
v_mfma_f32_16x16x32_bf16 v[96:99], a[124:127], a[144:147], v[96:99]
ds_read_b64_tr_b16 a[56:57], v7 offset:0
v_mfma_f32_16x16x32_bf16 v[112:115], a[124:127], a[148:151], v[112:115]
v_mfma_f32_16x16x32_bf16 v[128:131], a[124:127], a[152:155], v[128:131]
ds_read_b64_tr_b16 a[58:59], v7 offset:1024
v_mfma_f32_16x16x32_bf16 v[144:147], a[124:127], a[156:159], v[144:147]
v_mfma_f32_16x16x32_bf16 v[160:163], a[124:127], a[160:163], v[160:163]
v_mfma_f32_16x16x32_bf16 v[252:255], a[128:131], a[160:163], v[252:255]
v_mfma_f32_16x16x32_bf16 v[236:239], a[128:131], a[156:159], v[236:239]
v_mfma_f32_16x16x32_bf16 v[220:223], a[128:131], a[152:155], v[220:223]
v_mfma_f32_16x16x32_bf16 v[204:207], a[128:131], a[148:151], v[204:207]
v_mfma_f32_16x16x32_bf16 a[32:35], a[128:131], a[144:147], a[32:35]
v_mfma_f32_16x16x32_bf16 a[20:23], a[128:131], a[140:143], a[20:23]
v_mfma_f32_16x16x32_bf16 a[12:15], a[128:131], a[136:139], a[12:15]
v_mfma_f32_16x16x32_bf16 a[4:7], a[128:131], a[132:135], a[4:7]
s_waitcnt lgkmcnt(2)
v_mfma_f32_16x16x32_bf16 a[4:7], a[64:67], a[68:71], a[4:7]
s_waitcnt vmcnt(18) lgkmcnt(0)
s_barrier
v_mfma_f32_16x16x32_bf16 a[12:15], a[64:67], a[72:75], a[12:15]
s_add_u32 m0, s96, 0
ds_read_b64_tr_b16 a[100:101], v2 offset:16384
v_mfma_f32_16x16x32_bf16 a[20:23], a[64:67], a[76:79], a[20:23]
ds_read_b64_tr_b16 a[102:103], v2 offset:17408
v_mfma_f32_16x16x32_bf16 a[32:35], a[64:67], a[80:83], a[32:35]
ds_read_b128 a[132:135], v12 offset:0
v_mfma_f32_16x16x32_bf16 v[204:207], a[64:67], a[84:87], v[204:207]
ds_read_b128 a[136:139], v12 offset:2048
v_mfma_f32_16x16x32_bf16 v[220:223], a[64:67], a[88:91], v[220:223]
ds_read_b128 a[140:143], v12 offset:4096
v_mfma_f32_16x16x32_bf16 v[236:239], a[64:67], a[92:95], v[236:239]
ds_read_b128 a[144:147], v12 offset:6144
v_mfma_f32_16x16x32_bf16 v[252:255], a[64:67], a[96:99], v[252:255]
ds_read_b128 a[148:151], v13 offset:8192
v_mfma_f32_16x16x32_bf16 v[160:163], a[60:63], a[96:99], v[160:163]
ds_read_b128 a[152:155], v13 offset:10240
v_mfma_f32_16x16x32_bf16 v[144:147], a[60:63], a[92:95], v[144:147]
ds_read_b128 a[156:159], v13 offset:12288
v_mfma_f32_16x16x32_bf16 v[128:131], a[60:63], a[88:91], v[128:131]
ds_read_b128 a[160:163], v13 offset:14336
v_mfma_f32_16x16x32_bf16 v[112:115], a[60:63], a[84:87], v[112:115]
buffer_load_dwordx4 v14, s[16:19], s86 offen offset:0 lds
v_mfma_f32_16x16x32_bf16 v[96:99], a[60:63], a[80:83], v[96:99]
ds_read_b64_tr_b16 a[104:105], v3 offset:16384
v_mfma_f32_16x16x32_bf16 v[80:83], a[60:63], a[76:79], v[80:83]
v_mfma_f32_16x16x32_bf16 v[64:67], a[60:63], a[72:75], v[64:67]
ds_read_b64_tr_b16 a[106:107], v3 offset:17408
v_mfma_f32_16x16x32_bf16 v[48:51], a[60:63], a[68:71], v[48:51]
buffer_load_dwordx4 v15, s[16:19], s86 offen offset:1024 lds
v_mfma_f32_16x16x32_bf16 v[36:39], a[36:39], a[68:71], v[36:39]
s_waitcnt lgkmcnt(9)
ds_read_b64_tr_b16 a[108:109], v4 offset:16384
v_mfma_f32_16x16x32_bf16 v[36:39], a[100:103], a[132:135], v[36:39]
s_waitcnt lgkmcnt(9)
v_mfma_f32_16x16x32_bf16 v[52:55], a[100:103], a[136:139], v[52:55]
ds_read_b64_tr_b16 a[110:111], v4 offset:17408
v_mfma_f32_16x16x32_bf16 v[52:55], a[36:39], a[72:75], v[52:55]
buffer_load_dwordx4 v16, s[16:19], s86 offen offset:2048 lds
v_mfma_f32_16x16x32_bf16 v[68:71], a[36:39], a[76:79], v[68:71]
s_waitcnt lgkmcnt(9)
ds_read_b64_tr_b16 a[112:113], v5 offset:16384
v_mfma_f32_16x16x32_bf16 v[68:71], a[100:103], a[140:143], v[68:71]
s_waitcnt lgkmcnt(9)
v_mfma_f32_16x16x32_bf16 v[84:87], a[100:103], a[144:147], v[84:87]
ds_read_b64_tr_b16 a[114:115], v5 offset:17408
v_mfma_f32_16x16x32_bf16 v[84:87], a[36:39], a[80:83], v[84:87]
buffer_load_dwordx4 v17, s[16:19], s86 offen offset:3072 lds
v_mfma_f32_16x16x32_bf16 v[100:103], a[36:39], a[84:87], v[100:103]
s_waitcnt lgkmcnt(9)
s_add_u32 s86, s86, 0x40000
ds_read_b64_tr_b16 a[116:117], v6 offset:16384
v_mfma_f32_16x16x32_bf16 v[100:103], a[100:103], a[148:151], v[100:103]
s_waitcnt lgkmcnt(9)
s_and_b32 s86, s86, 0x3c0000
s_add_u32 m0, s97, 36864
s_add_u32 s74, s87, s99
v_mfma_f32_16x16x32_bf16 v[116:119], a[100:103], a[152:155], v[116:119]
ds_read_b64_tr_b16 a[118:119], v6 offset:17408
v_mfma_f32_16x16x32_bf16 v[116:119], a[36:39], a[88:91], v[116:119]
buffer_load_dwordx4 v18, s[8:11], s74 offen offset:0 lds
v_mfma_f32_16x16x32_bf16 v[132:135], a[36:39], a[92:95], v[132:135]
s_waitcnt lgkmcnt(9)
ds_read_b64_tr_b16 a[120:121], v7 offset:16384
v_mfma_f32_16x16x32_bf16 v[132:135], a[100:103], a[156:159], v[132:135]
s_waitcnt lgkmcnt(9)
v_mfma_f32_16x16x32_bf16 v[148:151], a[100:103], a[160:163], v[148:151]
ds_read_b64_tr_b16 a[122:123], v7 offset:17408
v_mfma_f32_16x16x32_bf16 v[148:151], a[36:39], a[96:99], v[148:151]
buffer_load_dwordx4 v19, s[8:11], s74 offen offset:1024 lds
v_mfma_f32_16x16x32_bf16 v[240:243], a[40:43], a[96:99], v[240:243]
s_waitcnt lgkmcnt(8)
ds_read_b64_tr_b16 a[124:125], v8 offset:16384
v_mfma_f32_16x16x32_bf16 v[240:243], a[104:107], a[160:163], v[240:243]
v_mfma_f32_16x16x32_bf16 v[224:227], a[104:107], a[156:159], v[224:227]
ds_read_b64_tr_b16 a[126:127], v8 offset:17408
v_mfma_f32_16x16x32_bf16 v[224:227], a[40:43], a[92:95], v[224:227]
buffer_load_dwordx4 v22, s[8:11], s74 offen offset:2048 lds
v_mfma_f32_16x16x32_bf16 v[208:211], a[40:43], a[88:91], v[208:211]
ds_read_b64_tr_b16 a[128:129], v9 offset:16384
v_mfma_f32_16x16x32_bf16 v[208:211], a[104:107], a[152:155], v[208:211]
v_mfma_f32_16x16x32_bf16 v[192:195], a[104:107], a[148:151], v[192:195]
ds_read_b64_tr_b16 a[130:131], v9 offset:17408
v_mfma_f32_16x16x32_bf16 v[192:195], a[40:43], a[84:87], v[192:195]
buffer_load_dwordx4 v23, s[8:11], s74 offen offset:3072 lds
v_mfma_f32_16x16x32_bf16 v[188:191], a[40:43], a[80:83], v[188:191]
s_add_u32 s87, s87, 128
s_and_b32 s87, s87, 1023
v_mfma_f32_16x16x32_bf16 v[188:191], a[104:107], a[144:147], v[188:191]
v_mfma_f32_16x16x32_bf16 v[180:183], a[104:107], a[140:143], v[180:183]
v_mfma_f32_16x16x32_bf16 v[180:183], a[40:43], a[76:79], v[180:183]
buffer_store_dwordx4 a[164:167], v0, s[76:79], s38 offen sc1
v_mfma_f32_16x16x32_bf16 v[172:175], a[40:43], a[72:75], v[172:175]
s_add_u32 s38, s38, 1024
v_mfma_f32_16x16x32_bf16 v[172:175], a[104:107], a[136:139], v[172:175]
v_mfma_f32_16x16x32_bf16 v[164:167], a[104:107], a[132:135], v[164:167]
v_mfma_f32_16x16x32_bf16 v[164:167], a[40:43], a[68:71], v[164:167]
v_mfma_f32_16x16x32_bf16 v[40:43], a[44:47], a[68:71], v[40:43]
s_waitcnt lgkmcnt(10)
v_mfma_f32_16x16x32_bf16 v[40:43], a[108:111], a[132:135], v[40:43]
v_mfma_f32_16x16x32_bf16 v[56:59], a[108:111], a[136:139], v[56:59]
v_mfma_f32_16x16x32_bf16 v[56:59], a[44:47], a[72:75], v[56:59]
v_mfma_f32_16x16x32_bf16 v[72:75], a[44:47], a[76:79], v[72:75]
v_mfma_f32_16x16x32_bf16 v[72:75], a[108:111], a[140:143], v[72:75]
v_mfma_f32_16x16x32_bf16 v[88:91], a[108:111], a[144:147], v[88:91]
v_mfma_f32_16x16x32_bf16 v[88:91], a[44:47], a[80:83], v[88:91]
v_mfma_f32_16x16x32_bf16 v[104:107], a[44:47], a[84:87], v[104:107]
v_mfma_f32_16x16x32_bf16 v[104:107], a[108:111], a[148:151], v[104:107]
v_mfma_f32_16x16x32_bf16 v[120:123], a[108:111], a[152:155], v[120:123]
v_mfma_f32_16x16x32_bf16 v[120:123], a[44:47], a[88:91], v[120:123]
v_mfma_f32_16x16x32_bf16 v[136:139], a[44:47], a[92:95], v[136:139]
v_mfma_f32_16x16x32_bf16 v[136:139], a[108:111], a[156:159], v[136:139]
v_mfma_f32_16x16x32_bf16 v[152:155], a[108:111], a[160:163], v[152:155]
v_mfma_f32_16x16x32_bf16 v[152:155], a[44:47], a[96:99], v[152:155]
v_mfma_f32_16x16x32_bf16 v[244:247], a[48:51], a[96:99], v[244:247]
s_waitcnt vmcnt(18) lgkmcnt(0)
s_barrier
v_mfma_f32_16x16x32_bf16 v[244:247], a[112:115], a[160:163], v[244:247]
s_add_u32 m0, s96, 16384
ds_read_b64_tr_b16 a[64:65], v9 offset:32768
v_mfma_f32_16x16x32_bf16 v[228:231], a[112:115], a[156:159], v[228:231]
buffer_load_dwordx4 v14, s[16:19], s86 offen offset:0 lds
v_mfma_f32_16x16x32_bf16 v[228:231], a[48:51], a[92:95], v[228:231]
ds_read_b64_tr_b16 a[66:67], v9 offset:33792
v_mfma_f32_16x16x32_bf16 v[212:215], a[48:51], a[88:91], v[212:215]
v_mfma_f32_16x16x32_bf16 v[212:215], a[112:115], a[152:155], v[212:215]
ds_read_b64_tr_b16 a[60:61], v8 offset:32768
v_mfma_f32_16x16x32_bf16 v[196:199], a[112:115], a[148:151], v[196:199]
buffer_load_dwordx4 v15, s[16:19], s86 offen offset:1024 lds
v_mfma_f32_16x16x32_bf16 v[196:199], a[48:51], a[84:87], v[196:199]
ds_read_b64_tr_b16 a[62:63], v8 offset:33792
v_mfma_f32_16x16x32_bf16 a[24:27], a[48:51], a[80:83], a[24:27]
v_mfma_f32_16x16x32_bf16 a[24:27], a[112:115], a[144:147], a[24:27]
ds_read_b64_tr_b16 a[44:45], v4 offset:32768
v_mfma_f32_16x16x32_bf16 a[16:19], a[112:115], a[140:143], a[16:19]
buffer_load_dwordx4 v16, s[16:19], s86 offen offset:2048 lds
v_mfma_f32_16x16x32_bf16 a[16:19], a[48:51], a[76:79], a[16:19]
ds_read_b64_tr_b16 a[46:47], v4 offset:33792
v_mfma_f32_16x16x32_bf16 a[8:11], a[48:51], a[72:75], a[8:11]
v_mfma_f32_16x16x32_bf16 a[8:11], a[112:115], a[136:139], a[8:11]
ds_read_b64_tr_b16 a[40:41], v3 offset:32768
v_mfma_f32_16x16x32_bf16 a[0:3], a[112:115], a[132:135], a[0:3]
buffer_load_dwordx4 v17, s[16:19], s86 offen offset:3072 lds
v_mfma_f32_16x16x32_bf16 a[0:3], a[48:51], a[68:71], a[0:3]
s_add_u32 s86, s86, 0x40000
ds_read_b64_tr_b16 a[42:43], v3 offset:33792
v_mfma_f32_16x16x32_bf16 v[44:47], a[52:55], a[68:71], v[44:47]
s_and_b32 s86, s86, 0x3c0000
s_add_u32 m0, s97, 0
s_add_u32 s74, s87, s98
v_mfma_f32_16x16x32_bf16 v[44:47], a[116:119], a[132:135], v[44:47]
ds_read_b64_tr_b16 a[36:37], v2 offset:32768
v_mfma_f32_16x16x32_bf16 v[60:63], a[116:119], a[136:139], v[60:63]
buffer_load_dwordx4 v18, s[8:11], s74 offen offset:0 lds
v_mfma_f32_16x16x32_bf16 v[60:63], a[52:55], a[72:75], v[60:63]
ds_read_b64_tr_b16 a[38:39], v2 offset:33792
v_mfma_f32_16x16x32_bf16 v[76:79], a[52:55], a[76:79], v[76:79]
v_mfma_f32_16x16x32_bf16 v[76:79], a[116:119], a[140:143], v[76:79]
ds_read_b64_tr_b16 a[48:49], v5 offset:32768
v_mfma_f32_16x16x32_bf16 v[92:95], a[116:119], a[144:147], v[92:95]
buffer_load_dwordx4 v19, s[8:11], s74 offen offset:1024 lds
v_mfma_f32_16x16x32_bf16 v[92:95], a[52:55], a[80:83], v[92:95]
ds_read_b64_tr_b16 a[50:51], v5 offset:33792
v_mfma_f32_16x16x32_bf16 v[108:111], a[52:55], a[84:87], v[108:111]
v_mfma_f32_16x16x32_bf16 v[108:111], a[116:119], a[148:151], v[108:111]
v_mfma_f32_16x16x32_bf16 v[124:127], a[116:119], a[152:155], v[124:127]
buffer_load_dwordx4 v22, s[8:11], s74 offen offset:2048 lds
v_mfma_f32_16x16x32_bf16 v[124:127], a[52:55], a[88:91], v[124:127]
v_mfma_f32_16x16x32_bf16 v[140:143], a[52:55], a[92:95], v[140:143]
v_mfma_f32_16x16x32_bf16 v[140:143], a[116:119], a[156:159], v[140:143]
v_mfma_f32_16x16x32_bf16 v[156:159], a[116:119], a[160:163], v[156:159]
buffer_load_dwordx4 v23, s[8:11], s74 offen offset:3072 lds
v_mfma_f32_16x16x32_bf16 v[156:159], a[52:55], a[96:99], v[156:159]
ds_read_b64_tr_b16 a[52:53], v6 offset:32768
v_mfma_f32_16x16x32_bf16 v[248:251], a[56:59], a[96:99], v[248:251]
v_mfma_f32_16x16x32_bf16 v[248:251], a[120:123], a[160:163], v[248:251]
ds_read_b64_tr_b16 a[54:55], v6 offset:33792
v_mfma_f32_16x16x32_bf16 v[232:235], a[120:123], a[156:159], v[232:235]
buffer_load_dwordx4 a[240:243], v25, s[32:35], s100 offen
v_mfma_f32_16x16x32_bf16 v[232:235], a[56:59], a[92:95], v[232:235]
s_add_u32 s100, s100, 64
ds_read_b128 a[96:99], v11 offset:30720
v_mfma_f32_16x16x32_bf16 v[216:219], a[56:59], a[88:91], v[216:219]
s_and_b32 s100, s100, 1023
v_mfma_f32_16x16x32_bf16 v[216:219], a[120:123], a[152:155], v[216:219]
ds_read_b128 a[92:95], v11 offset:28672
v_mfma_f32_16x16x32_bf16 v[200:203], a[120:123], a[148:151], v[200:203]
buffer_store_dwordx4 a[164:167], v0, s[76:79], s38 offen sc1
v_mfma_f32_16x16x32_bf16 v[200:203], a[56:59], a[84:87], v[200:203]
s_add_u32 s38, s38, 1024
ds_read_b128 a[88:91], v11 offset:26624
v_mfma_f32_16x16x32_bf16 a[28:31], a[56:59], a[80:83], a[28:31]
v_mfma_f32_16x16x32_bf16 a[28:31], a[120:123], a[144:147], a[28:31]
ds_read_b128 a[84:87], v11 offset:24576
v_mfma_f32_16x16x32_bf16 v[184:187], a[120:123], a[140:143], v[184:187]
v_mfma_f32_16x16x32_bf16 v[184:187], a[56:59], a[76:79], v[184:187]
ds_read_b128 a[80:83], v10 offset:22528
v_mfma_f32_16x16x32_bf16 v[176:179], a[56:59], a[72:75], v[176:179]
v_mfma_f32_16x16x32_bf16 v[176:179], a[120:123], a[136:139], v[176:179]
ds_read_b128 a[76:79], v10 offset:20480
v_mfma_f32_16x16x32_bf16 v[168:171], a[120:123], a[132:135], v[168:171]
v_mfma_f32_16x16x32_bf16 v[168:171], a[56:59], a[68:71], v[168:171]
ds_read_b128 a[72:75], v10 offset:18432
v_mfma_f32_16x16x32_bf16 v[48:51], a[124:127], a[132:135], v[48:51]
v_mfma_f32_16x16x32_bf16 v[64:67], a[124:127], a[136:139], v[64:67]
ds_read_b128 a[68:71], v10 offset:16384
v_mfma_f32_16x16x32_bf16 v[80:83], a[124:127], a[140:143], v[80:83]
v_mfma_f32_16x16x32_bf16 v[96:99], a[124:127], a[144:147], v[96:99]
ds_read_b64_tr_b16 a[56:57], v7 offset:32768
v_mfma_f32_16x16x32_bf16 v[112:115], a[124:127], a[148:151], v[112:115]
v_mfma_f32_16x16x32_bf16 v[128:131], a[124:127], a[152:155], v[128:131]
ds_read_b64_tr_b16 a[58:59], v7 offset:33792
v_mfma_f32_16x16x32_bf16 v[144:147], a[124:127], a[156:159], v[144:147]
v_mfma_f32_16x16x32_bf16 v[160:163], a[124:127], a[160:163], v[160:163]
v_mfma_f32_16x16x32_bf16 v[252:255], a[128:131], a[160:163], v[252:255]
v_mfma_f32_16x16x32_bf16 v[236:239], a[128:131], a[156:159], v[236:239]
v_mfma_f32_16x16x32_bf16 v[220:223], a[128:131], a[152:155], v[220:223]
v_mfma_f32_16x16x32_bf16 v[204:207], a[128:131], a[148:151], v[204:207]
v_mfma_f32_16x16x32_bf16 a[32:35], a[128:131], a[144:147], a[32:35]
v_mfma_f32_16x16x32_bf16 a[20:23], a[128:131], a[140:143], a[20:23]
v_mfma_f32_16x16x32_bf16 a[12:15], a[128:131], a[136:139], a[12:15]
v_mfma_f32_16x16x32_bf16 a[4:7], a[128:131], a[132:135], a[4:7]
s_waitcnt lgkmcnt(6)
v_mfma_f32_16x16x32_bf16 v[100:103], a[36:39], a[84:87], v[100:103]
s_waitcnt vmcnt(19) lgkmcnt(0)
s_barrier
v_mfma_f32_16x16x32_bf16 v[192:195], a[40:43], a[84:87], v[192:195]
ds_read_b128 a[132:135], v12 offset:16384
v_mfma_f32_16x16x32_bf16 v[104:107], a[44:47], a[84:87], v[104:107]
ds_read_b64_tr_b16 a[100:101], v2 offset:49152
v_mfma_f32_16x16x32_bf16 v[196:199], a[48:51], a[84:87], v[196:199]
ds_read_b64_tr_b16 a[102:103], v2 offset:50176
v_mfma_f32_16x16x32_bf16 v[108:111], a[52:55], a[84:87], v[108:111]
ds_read_b128 a[136:139], v12 offset:18432
v_mfma_f32_16x16x32_bf16 v[200:203], a[56:59], a[84:87], v[200:203]
ds_read_b64_tr_b16 a[104:105], v3 offset:49152
v_mfma_f32_16x16x32_bf16 v[112:115], a[60:63], a[84:87], v[112:115]
ds_read_b64_tr_b16 a[106:107], v3 offset:50176
v_mfma_f32_16x16x32_bf16 v[204:207], a[64:67], a[84:87], v[204:207]
ds_read_b128 a[140:143], v12 offset:20480
v_mfma_f32_16x16x32_bf16 v[116:119], a[36:39], a[88:91], v[116:119]
ds_read_b64_tr_b16 a[108:109], v4 offset:49152
v_mfma_f32_16x16x32_bf16 v[208:211], a[40:43], a[88:91], v[208:211]
ds_read_b64_tr_b16 a[110:111], v4 offset:50176
v_mfma_f32_16x16x32_bf16 v[120:123], a[44:47], a[88:91], v[120:123]
ds_read_b128 a[144:147], v12 offset:22528
v_mfma_f32_16x16x32_bf16 v[212:215], a[48:51], a[88:91], v[212:215]
ds_read_b64_tr_b16 a[112:113], v5 offset:49152
v_mfma_f32_16x16x32_bf16 v[124:127], a[52:55], a[88:91], v[124:127]
ds_read_b64_tr_b16 a[114:115], v5 offset:50176
v_mfma_f32_16x16x32_bf16 v[216:219], a[56:59], a[88:91], v[216:219]
ds_read_b128 a[148:151], v13 offset:24576
v_mfma_f32_16x16x32_bf16 v[128:131], a[60:63], a[88:91], v[128:131]
ds_read_b64_tr_b16 a[116:117], v6 offset:49152
v_mfma_f32_16x16x32_bf16 v[220:223], a[64:67], a[88:91], v[220:223]
ds_read_b64_tr_b16 a[118:119], v6 offset:50176
v_mfma_f32_16x16x32_bf16 v[132:135], a[36:39], a[92:95], v[132:135]
ds_read_b128 a[152:155], v13 offset:26624
v_mfma_f32_16x16x32_bf16 v[224:227], a[40:43], a[92:95], v[224:227]
ds_read_b64_tr_b16 a[120:121], v7 offset:49152
v_mfma_f32_16x16x32_bf16 v[136:139], a[44:47], a[92:95], v[136:139]
ds_read_b64_tr_b16 a[122:123], v7 offset:50176
v_mfma_f32_16x16x32_bf16 v[228:231], a[48:51], a[92:95], v[228:231]
ds_read_b128 a[156:159], v13 offset:28672
v_mfma_f32_16x16x32_bf16 v[140:143], a[52:55], a[92:95], v[140:143]
ds_read_b64_tr_b16 a[124:125], v8 offset:49152
v_mfma_f32_16x16x32_bf16 v[232:235], a[56:59], a[92:95], v[232:235]
ds_read_b64_tr_b16 a[126:127], v8 offset:50176
v_mfma_f32_16x16x32_bf16 v[144:147], a[60:63], a[92:95], v[144:147]
ds_read_b128 a[160:163], v13 offset:30720
v_mfma_f32_16x16x32_bf16 v[236:239], a[64:67], a[92:95], v[236:239]
ds_read_b64_tr_b16 a[128:129], v9 offset:49152
v_mfma_f32_16x16x32_bf16 v[148:151], a[36:39], a[96:99], v[148:151]
ds_read_b64_tr_b16 a[130:131], v9 offset:50176
v_mfma_f32_16x16x32_bf16 v[240:243], a[40:43], a[96:99], v[240:243]
s_add_u32 m0, s96, 32768
v_mfma_f32_16x16x32_bf16 v[152:155], a[44:47], a[96:99], v[152:155]
buffer_load_dwordx4 v14, s[16:19], s86 offen offset:0 lds
v_mfma_f32_16x16x32_bf16 v[244:247], a[48:51], a[96:99], v[244:247]
v_mfma_f32_16x16x32_bf16 v[156:159], a[52:55], a[96:99], v[156:159]
v_mfma_f32_16x16x32_bf16 v[248:251], a[56:59], a[96:99], v[248:251]
buffer_load_dwordx4 v15, s[16:19], s86 offen offset:1024 lds
v_mfma_f32_16x16x32_bf16 v[160:163], a[60:63], a[96:99], v[160:163]
v_mfma_f32_16x16x32_bf16 v[252:255], a[64:67], a[96:99], v[252:255]
v_mfma_f32_16x16x32_bf16 v[36:39], a[36:39], a[68:71], v[36:39]
s_waitcnt lgkmcnt(15)
buffer_load_dwordx4 v16, s[16:19], s86 offen offset:2048 lds
v_mfma_f32_16x16x32_bf16 v[36:39], a[100:103], a[132:135], v[36:39]
s_waitcnt lgkmcnt(15)
v_mfma_f32_16x16x32_bf16 v[164:167], a[104:107], a[132:135], v[164:167]
v_mfma_f32_16x16x32_bf16 v[164:167], a[40:43], a[68:71], v[164:167]
buffer_load_dwordx4 v17, s[16:19], s86 offen offset:3072 lds
v_mfma_f32_16x16x32_bf16 v[40:43], a[44:47], a[68:71], v[40:43]
s_waitcnt lgkmcnt(15)
s_add_u32 s86, s86, 0x40000
s_and_b32 s86, s86, 0x3c0000
s_add_u32 m0, s97, 4096
v_mfma_f32_16x16x32_bf16 v[40:43], a[108:111], a[132:135], v[40:43]
s_waitcnt lgkmcnt(12)
s_add_u32 s74, s87, s99
v_mfma_f32_16x16x32_bf16 a[0:3], a[112:115], a[132:135], a[0:3]
buffer_load_dwordx4 v18, s[8:11], s74 offen offset:0 lds
v_mfma_f32_16x16x32_bf16 a[0:3], a[48:51], a[68:71], a[0:3]
v_cvt_pk_bf16_f32 v36, v36, v37
v_cvt_pk_bf16_f32 v37, v38, v39
v_mfma_f32_16x16x32_bf16 v[44:47], a[52:55], a[68:71], v[44:47]
s_waitcnt lgkmcnt(9)
v_cvt_pk_bf16_f32 v38, v164, v165
v_cvt_pk_bf16_f32 v39, v166, v167
v_mfma_f32_16x16x32_bf16 v[44:47], a[116:119], a[132:135], v[44:47]
s_waitcnt lgkmcnt(6)
buffer_load_dwordx4 v19, s[8:11], s74 offen offset:1024 lds
v_mfma_f32_16x16x32_bf16 v[168:171], a[120:123], a[132:135], v[168:171]
v_mfma_f32_16x16x32_bf16 v[168:171], a[56:59], a[68:71], v[168:171]
v_cvt_pk_bf16_f32 v40, v40, v41
v_cvt_pk_bf16_f32 v41, v42, v43
v_mfma_f32_16x16x32_bf16 v[48:51], a[60:63], a[68:71], v[48:51]
s_waitcnt lgkmcnt(3)
buffer_load_dwordx4 v22, s[8:11], s74 offen offset:2048 lds
v_mfma_f32_16x16x32_bf16 v[48:51], a[124:127], a[132:135], v[48:51]
s_waitcnt lgkmcnt(0)
v_accvgpr_read_b32 v164, a0
v_accvgpr_read_b32 v165, a1
v_mfma_f32_16x16x32_bf16 a[4:7], a[128:131], a[132:135], a[4:7]
v_accvgpr_read_b32 v166, a2
v_accvgpr_read_b32 v167, a3
v_mfma_f32_16x16x32_bf16 a[4:7], a[64:67], a[68:71], a[4:7]
buffer_load_dwordx4 v23, s[8:11], s74 offen offset:3072 lds
v_mfma_f32_16x16x32_bf16 v[52:55], a[36:39], a[72:75], v[52:55]
s_add_u32 s87, s87, 128
s_and_b32 s87, s87, 1023
v_mfma_f32_16x16x32_bf16 v[52:55], a[100:103], a[136:139], v[52:55]
buffer_store_dwordx4 v[36:39], v0, s[20:23], s88 offen offset:0 sc1
v_mfma_f32_16x16x32_bf16 v[172:175], a[104:107], a[136:139], v[172:175]
buffer_load_dwordx4 a[244:247], v25, s[32:35], s100 offen
v_mfma_f32_16x16x32_bf16 v[172:175], a[40:43], a[72:75], v[172:175]
s_add_u32 s100, s100, 64
s_and_b32 s100, s100, 1023
v_mfma_f32_16x16x32_bf16 v[56:59], a[44:47], a[72:75], v[56:59]
v_cvt_pk_bf16_f32 v42, v164, v165
v_cvt_pk_bf16_f32 v43, v166, v167
v_mfma_f32_16x16x32_bf16 v[56:59], a[108:111], a[136:139], v[56:59]
v_cvt_pk_bf16_f32 v44, v44, v45
v_cvt_pk_bf16_f32 v45, v46, v47
v_mfma_f32_16x16x32_bf16 a[8:11], a[112:115], a[136:139], a[8:11]
v_cvt_pk_bf16_f32 v46, v168, v169
v_cvt_pk_bf16_f32 v47, v170, v171
v_mfma_f32_16x16x32_bf16 a[8:11], a[48:51], a[72:75], a[8:11]
v_cvt_pk_bf16_f32 v48, v48, v49
v_cvt_pk_bf16_f32 v49, v50, v51
v_mfma_f32_16x16x32_bf16 v[60:63], a[52:55], a[72:75], v[60:63]
v_accvgpr_read_b32 v168, a4
v_accvgpr_read_b32 v169, a5
v_mfma_f32_16x16x32_bf16 v[60:63], a[116:119], a[136:139], v[60:63]
v_accvgpr_read_b32 v170, a6
v_accvgpr_read_b32 v171, a7
v_mfma_f32_16x16x32_bf16 v[176:179], a[120:123], a[136:139], v[176:179]
v_cvt_pk_bf16_f32 v50, v168, v169
v_cvt_pk_bf16_f32 v51, v170, v171
v_mfma_f32_16x16x32_bf16 v[176:179], a[56:59], a[72:75], v[176:179]
v_cvt_pk_bf16_f32 v52, v52, v53
v_cvt_pk_bf16_f32 v53, v54, v55
v_mfma_f32_16x16x32_bf16 v[64:67], a[60:63], a[72:75], v[64:67]
v_cvt_pk_bf16_f32 v54, v172, v173
v_cvt_pk_bf16_f32 v55, v174, v175
v_mfma_f32_16x16x32_bf16 v[64:67], a[124:127], a[136:139], v[64:67]
buffer_store_dwordx4 v[40:43], v0, s[20:23], s88 offen offset:1024 sc1
v_mfma_f32_16x16x32_bf16 a[12:15], a[128:131], a[136:139], a[12:15]
s_waitcnt vmcnt(21) lgkmcnt(0)
s_barrier
v_mfma_f32_16x16x32_bf16 a[12:15], a[64:67], a[72:75], a[12:15]
s_add_u32 m0, s96, 49152
v_cvt_pk_bf16_f32 v56, v56, v57
v_mfma_f32_16x16x32_bf16 v[68:71], a[36:39], a[76:79], v[68:71]
buffer_load_dwordx4 v14, s[16:19], s86 offen offset:0 lds
v_mfma_f32_16x16x32_bf16 v[68:71], a[100:103], a[140:143], v[68:71]
v_cvt_pk_bf16_f32 v57, v58, v59
v_accvgpr_read_b32 v172, a8
v_mfma_f32_16x16x32_bf16 v[180:183], a[104:107], a[140:143], v[180:183]
v_accvgpr_read_b32 v173, a9
v_accvgpr_read_b32 v174, a10
v_mfma_f32_16x16x32_bf16 v[180:183], a[40:43], a[76:79], v[180:183]
buffer_load_dwordx4 v15, s[16:19], s86 offen offset:1024 lds
v_mfma_f32_16x16x32_bf16 v[72:75], a[44:47], a[76:79], v[72:75]
v_accvgpr_read_b32 v175, a11
v_cvt_pk_bf16_f32 v58, v172, v173
v_mfma_f32_16x16x32_bf16 v[72:75], a[108:111], a[140:143], v[72:75]
v_cvt_pk_bf16_f32 v59, v174, v175
v_cvt_pk_bf16_f32 v60, v60, v61
v_mfma_f32_16x16x32_bf16 a[16:19], a[112:115], a[140:143], a[16:19]
buffer_load_dwordx4 v16, s[16:19], s86 offen offset:2048 lds
v_mfma_f32_16x16x32_bf16 a[16:19], a[48:51], a[76:79], a[16:19]
v_cvt_pk_bf16_f32 v61, v62, v63
v_cvt_pk_bf16_f32 v62, v176, v177
v_mfma_f32_16x16x32_bf16 v[76:79], a[52:55], a[76:79], v[76:79]
v_cvt_pk_bf16_f32 v63, v178, v179
v_cvt_pk_bf16_f32 v64, v64, v65
v_mfma_f32_16x16x32_bf16 v[76:79], a[116:119], a[140:143], v[76:79]
buffer_load_dwordx4 v17, s[16:19], s86 offen offset:3072 lds
v_mfma_f32_16x16x32_bf16 v[184:187], a[120:123], a[140:143], v[184:187]
s_add_u32 s86, s86, 0x40000
s_and_b32 s86, s86, 0x3c0000
s_add_u32 m0, s97, 16384
buffer_store_dwordx4 v[44:47], v0, s[20:23], s88 offen offset:2048 sc1
v_mfma_f32_16x16x32_bf16 v[184:187], a[56:59], a[76:79], v[184:187]
s_add_u32 s74, s87, s98
v_cvt_pk_bf16_f32 v65, v66, v67
v_mfma_f32_16x16x32_bf16 v[80:83], a[60:63], a[76:79], v[80:83]
buffer_load_dwordx4 v18, s[8:11], s74 offen offset:0 lds
v_mfma_f32_16x16x32_bf16 v[80:83], a[124:127], a[140:143], v[80:83]
v_accvgpr_read_b32 v176, a12
v_accvgpr_read_b32 v177, a13
v_mfma_f32_16x16x32_bf16 a[20:23], a[128:131], a[140:143], a[20:23]
v_accvgpr_read_b32 v178, a14
v_accvgpr_read_b32 v179, a15
v_mfma_f32_16x16x32_bf16 a[20:23], a[64:67], a[76:79], a[20:23]
buffer_load_dwordx4 v19, s[8:11], s74 offen offset:1024 lds
v_mfma_f32_16x16x32_bf16 v[84:87], a[36:39], a[80:83], v[84:87]
v_cvt_pk_bf16_f32 v66, v176, v177
v_cvt_pk_bf16_f32 v67, v178, v179
v_mfma_f32_16x16x32_bf16 v[84:87], a[100:103], a[144:147], v[84:87]
v_cvt_pk_bf16_f32 v68, v68, v69
v_cvt_pk_bf16_f32 v69, v70, v71
v_mfma_f32_16x16x32_bf16 v[188:191], a[104:107], a[144:147], v[188:191]
buffer_load_dwordx4 v22, s[8:11], s74 offen offset:2048 lds
v_mfma_f32_16x16x32_bf16 v[188:191], a[40:43], a[80:83], v[188:191]
v_cvt_pk_bf16_f32 v70, v180, v181
v_cvt_pk_bf16_f32 v71, v182, v183
v_mfma_f32_16x16x32_bf16 v[88:91], a[44:47], a[80:83], v[88:91]
v_cvt_pk_bf16_f32 v72, v72, v73
v_cvt_pk_bf16_f32 v73, v74, v75
v_mfma_f32_16x16x32_bf16 v[88:91], a[108:111], a[144:147], v[88:91]
buffer_load_dwordx4 v23, s[8:11], s74 offen offset:3072 lds
v_mfma_f32_16x16x32_bf16 a[24:27], a[112:115], a[144:147], a[24:27]
v_accvgpr_read_b32 v180, a16
v_accvgpr_read_b32 v181, a17
v_mfma_f32_16x16x32_bf16 a[24:27], a[48:51], a[80:83], a[24:27]
buffer_store_dwordx4 v[48:51], v0, s[20:23], s88 offen offset:3072 sc1
v_mfma_f32_16x16x32_bf16 v[92:95], a[52:55], a[80:83], v[92:95]
buffer_load_dwordx4 a[248:251], v25, s[32:35], s100 offen
v_mfma_f32_16x16x32_bf16 v[92:95], a[116:119], a[144:147], v[92:95]
s_add_u32 s100, s100, 64
s_and_b32 s100, s100, 1023
v_mfma_f32_16x16x32_bf16 a[28:31], a[120:123], a[144:147], a[28:31]
v_accvgpr_read_b32 v182, a18
v_accvgpr_read_b32 v183, a19
v_mfma_f32_16x16x32_bf16 a[28:31], a[56:59], a[80:83], a[28:31]
v_cvt_pk_bf16_f32 v74, v180, v181
v_cvt_pk_bf16_f32 v75, v182, v183
v_mfma_f32_16x16x32_bf16 v[96:99], a[60:63], a[80:83], v[96:99]
v_cvt_pk_bf16_f32 v76, v76, v77
v_cvt_pk_bf16_f32 v77, v78, v79
v_mfma_f32_16x16x32_bf16 v[96:99], a[124:127], a[144:147], v[96:99]
v_cvt_pk_bf16_f32 v78, v184, v185
v_cvt_pk_bf16_f32 v79, v186, v187
v_mfma_f32_16x16x32_bf16 a[32:35], a[128:131], a[144:147], a[32:35]
v_cvt_pk_bf16_f32 v80, v80, v81
v_cvt_pk_bf16_f32 v81, v82, v83
v_mfma_f32_16x16x32_bf16 a[32:35], a[64:67], a[80:83], a[32:35]
v_accvgpr_read_b32 v184, a20
v_accvgpr_read_b32 v185, a21
v_mfma_f32_16x16x32_bf16 v[100:103], a[100:103], a[148:151], v[100:103]
ds_read_b128 a[68:71], v26 offset:32768
v_accvgpr_read_b32 v186, a22
v_mfma_f32_16x16x32_bf16 v[192:195], a[104:107], a[148:151], v[192:195]
ds_read_b128 a[72:75], v26 offset:34816
v_accvgpr_read_b32 v187, a23
v_mfma_f32_16x16x32_bf16 v[104:107], a[108:111], a[148:151], v[104:107]
ds_read_b128 a[76:79], v26 offset:36864
v_cvt_pk_bf16_f32 v82, v184, v185
v_mfma_f32_16x16x32_bf16 v[196:199], a[112:115], a[148:151], v[196:199]
ds_read_b128 a[80:83], v26 offset:38912
v_cvt_pk_bf16_f32 v83, v186, v187
v_mfma_f32_16x16x32_bf16 v[108:111], a[116:119], a[148:151], v[108:111]
ds_read_b64_tr_b16 a[36:37], v2 offset:0
buffer_store_dwordx4 v[52:55], v0, s[20:23], s89 offen offset:0 sc1
v_mfma_f32_16x16x32_bf16 v[200:203], a[120:123], a[148:151], v[200:203]
ds_read_b64_tr_b16 a[38:39], v2 offset:1024
v_cvt_pk_bf16_f32 v84, v84, v85
v_mfma_f32_16x16x32_bf16 v[112:115], a[124:127], a[148:151], v[112:115]
ds_read_b64_tr_b16 a[40:41], v3 offset:0
v_cvt_pk_bf16_f32 v85, v86, v87
v_mfma_f32_16x16x32_bf16 v[204:207], a[128:131], a[148:151], v[204:207]
ds_read_b64_tr_b16 a[42:43], v3 offset:1024
v_cvt_pk_bf16_f32 v86, v188, v189
v_mfma_f32_16x16x32_bf16 v[116:119], a[100:103], a[152:155], v[116:119]
ds_read_b64_tr_b16 a[44:45], v4 offset:0
v_cvt_pk_bf16_f32 v87, v190, v191
v_mfma_f32_16x16x32_bf16 v[208:211], a[104:107], a[152:155], v[208:211]
ds_read_b64_tr_b16 a[46:47], v4 offset:1024
v_cvt_pk_bf16_f32 v88, v88, v89
v_mfma_f32_16x16x32_bf16 v[120:123], a[108:111], a[152:155], v[120:123]
ds_read_b64_tr_b16 a[48:49], v5 offset:0
v_cvt_pk_bf16_f32 v89, v90, v91
v_mfma_f32_16x16x32_bf16 v[212:215], a[112:115], a[152:155], v[212:215]
ds_read_b64_tr_b16 a[50:51], v5 offset:1024
v_accvgpr_read_b32 v188, a24
v_mfma_f32_16x16x32_bf16 v[124:127], a[116:119], a[152:155], v[124:127]
ds_read_b64_tr_b16 a[52:53], v6 offset:0
v_accvgpr_read_b32 v189, a25
v_mfma_f32_16x16x32_bf16 v[216:219], a[120:123], a[152:155], v[216:219]
ds_read_b64_tr_b16 a[54:55], v6 offset:1024
v_accvgpr_read_b32 v190, a26
v_mfma_f32_16x16x32_bf16 v[128:131], a[124:127], a[152:155], v[128:131]
ds_read_b64_tr_b16 a[56:57], v7 offset:0
v_accvgpr_read_b32 v191, a27
v_mfma_f32_16x16x32_bf16 v[220:223], a[128:131], a[152:155], v[220:223]
ds_read_b64_tr_b16 a[58:59], v7 offset:1024
v_cvt_pk_bf16_f32 v90, v188, v189
v_mfma_f32_16x16x32_bf16 v[132:135], a[100:103], a[156:159], v[132:135]
ds_read_b64_tr_b16 a[60:61], v8 offset:0
v_cvt_pk_bf16_f32 v91, v190, v191
v_mfma_f32_16x16x32_bf16 v[224:227], a[104:107], a[156:159], v[224:227]
ds_read_b64_tr_b16 a[62:63], v8 offset:1024
buffer_store_dwordx4 v[56:59], v0, s[20:23], s89 offen offset:1024 sc1
v_mfma_f32_16x16x32_bf16 v[136:139], a[108:111], a[156:159], v[136:139]
ds_read_b64_tr_b16 a[64:65], v9 offset:0
v_cvt_pk_bf16_f32 v92, v92, v93
v_mfma_f32_16x16x32_bf16 v[228:231], a[112:115], a[156:159], v[228:231]
ds_read_b64_tr_b16 a[66:67], v9 offset:1024
v_cvt_pk_bf16_f32 v93, v94, v95
v_mfma_f32_16x16x32_bf16 v[140:143], a[116:119], a[156:159], v[140:143]
ds_read_b128 a[84:87], v28 offset:32768
v_accvgpr_read_b32 v188, a28
v_mfma_f32_16x16x32_bf16 v[232:235], a[120:123], a[156:159], v[232:235]
ds_read_b128 a[88:91], v29 offset:33280
v_accvgpr_read_b32 v189, a29
v_mfma_f32_16x16x32_bf16 v[144:147], a[124:127], a[156:159], v[144:147]
ds_read_b128 a[92:95], v30 offset:33792
v_accvgpr_read_b32 v190, a30
v_mfma_f32_16x16x32_bf16 v[236:239], a[128:131], a[156:159], v[236:239]
ds_read_b128 a[96:99], v31 offset:34304
v_accvgpr_read_b32 v191, a31
v_mfma_f32_16x16x32_bf16 v[148:151], a[100:103], a[160:163], v[148:151]
ds_read_b128 a[164:167], v32 offset:0
v_cvt_pk_bf16_f32 v94, v188, v189
v_mfma_f32_16x16x32_bf16 v[240:243], a[104:107], a[160:163], v[240:243]
ds_read_b128 a[168:171], v32 offset:1024
v_cvt_pk_bf16_f32 v95, v190, v191
v_mfma_f32_16x16x32_bf16 v[152:155], a[108:111], a[160:163], v[152:155]
v_cvt_pk_bf16_f32 v96, v96, v97
v_cvt_pk_bf16_f32 v97, v98, v99
v_mfma_f32_16x16x32_bf16 v[244:247], a[112:115], a[160:163], v[244:247]
v_accvgpr_read_b32 v188, a32
v_accvgpr_read_b32 v189, a33
v_mfma_f32_16x16x32_bf16 v[156:159], a[116:119], a[160:163], v[156:159]
v_accvgpr_read_b32 v190, a34
v_accvgpr_read_b32 v191, a35
v_mfma_f32_16x16x32_bf16 v[248:251], a[120:123], a[160:163], v[248:251]
v_cvt_pk_bf16_f32 v98, v188, v189
v_cvt_pk_bf16_f32 v99, v190, v191
v_mfma_f32_16x16x32_bf16 v[160:163], a[124:127], a[160:163], v[160:163]
v_cvt_pk_bf16_f32 v100, v100, v101
v_cvt_pk_bf16_f32 v101, v102, v103
v_mfma_f32_16x16x32_bf16 v[252:255], a[128:131], a[160:163], v[252:255]
v_cvt_pk_bf16_f32 v102, v192, v193
v_cvt_pk_bf16_f32 v103, v194, v195
v_cvt_pk_bf16_f32 v104, v104, v105
v_cvt_pk_bf16_f32 v105, v106, v107
v_cvt_pk_bf16_f32 v106, v196, v197
v_cvt_pk_bf16_f32 v107, v198, v199
v_cvt_pk_bf16_f32 v108, v108, v109
v_cvt_pk_bf16_f32 v109, v110, v111
v_cvt_pk_bf16_f32 v110, v200, v201
v_cvt_pk_bf16_f32 v111, v202, v203
v_cvt_pk_bf16_f32 v112, v112, v113
v_cvt_pk_bf16_f32 v113, v114, v115
v_cvt_pk_bf16_f32 v114, v204, v205
v_cvt_pk_bf16_f32 v115, v206, v207
v_cvt_pk_bf16_f32 v116, v116, v117
v_cvt_pk_bf16_f32 v117, v118, v119
v_cvt_pk_bf16_f32 v118, v208, v209
v_cvt_pk_bf16_f32 v119, v210, v211
v_cvt_pk_bf16_f32 v120, v120, v121
v_cvt_pk_bf16_f32 v121, v122, v123
v_cvt_pk_bf16_f32 v122, v212, v213
v_cvt_pk_bf16_f32 v123, v214, v215
v_cvt_pk_bf16_f32 v124, v124, v125
v_cvt_pk_bf16_f32 v125, v126, v127
v_cvt_pk_bf16_f32 v126, v216, v217
v_cvt_pk_bf16_f32 v127, v218, v219
v_cvt_pk_bf16_f32 v128, v128, v129
v_cvt_pk_bf16_f32 v129, v130, v131
v_cvt_pk_bf16_f32 v130, v220, v221
v_cvt_pk_bf16_f32 v131, v222, v223
v_cvt_pk_bf16_f32 v132, v132, v133
v_cvt_pk_bf16_f32 v133, v134, v135
v_cvt_pk_bf16_f32 v134, v224, v225
v_cvt_pk_bf16_f32 v135, v226, v227
v_cvt_pk_bf16_f32 v136, v136, v137
v_cvt_pk_bf16_f32 v137, v138, v139
v_cvt_pk_bf16_f32 v138, v228, v229
v_cvt_pk_bf16_f32 v139, v230, v231
v_cvt_pk_bf16_f32 v140, v140, v141
v_cvt_pk_bf16_f32 v141, v142, v143
v_cvt_pk_bf16_f32 v142, v232, v233
v_cvt_pk_bf16_f32 v143, v234, v235
v_cvt_pk_bf16_f32 v144, v144, v145
v_cvt_pk_bf16_f32 v145, v146, v147
v_cvt_pk_bf16_f32 v146, v236, v237
v_cvt_pk_bf16_f32 v147, v238, v239
v_cvt_pk_bf16_f32 v148, v148, v149
v_cvt_pk_bf16_f32 v149, v150, v151
v_cvt_pk_bf16_f32 v150, v240, v241
v_cvt_pk_bf16_f32 v151, v242, v243
v_cvt_pk_bf16_f32 v152, v152, v153
v_cvt_pk_bf16_f32 v153, v154, v155
v_cvt_pk_bf16_f32 v154, v244, v245
v_cvt_pk_bf16_f32 v155, v246, v247
v_cvt_pk_bf16_f32 v156, v156, v157
v_cvt_pk_bf16_f32 v157, v158, v159
v_cvt_pk_bf16_f32 v158, v248, v249
v_cvt_pk_bf16_f32 v159, v250, v251
v_cvt_pk_bf16_f32 v160, v160, v161
v_cvt_pk_bf16_f32 v161, v162, v163
v_cvt_pk_bf16_f32 v162, v252, v253
v_cvt_pk_bf16_f32 v163, v254, v255
s_branch LA_q
LA_end:
s_endpgm
LA_v:
s_waitcnt lgkmcnt(15)
v_mfma_f32_16x16x32_bf16 v[36:39], a[68:71], a[36:39], 0
s_waitcnt lgkmcnt(15)
s_add_u32 m0, s97, 16384
s_add_u32 s74, s87, 0
v_mfma_f32_16x16x32_bf16 v[40:43], a[68:71], a[40:43], 0
s_waitcnt lgkmcnt(15)
buffer_load_dwordx4 v18, s[4:7], s74 offen offset:0 lds
v_mfma_f32_16x16x32_bf16 v[44:47], a[68:71], a[44:47], 0
s_waitcnt lgkmcnt(12)
v_mfma_f32_16x16x32_bf16 v[48:51], a[68:71], a[48:51], 0
s_waitcnt lgkmcnt(9)
v_mfma_f32_16x16x32_bf16 v[52:55], a[68:71], a[52:55], 0
s_waitcnt lgkmcnt(6)
v_mfma_f32_16x16x32_bf16 v[56:59], a[68:71], a[56:59], 0
s_waitcnt lgkmcnt(3)
buffer_load_dwordx4 v19, s[4:7], s74 offen offset:1024 lds
v_mfma_f32_16x16x32_bf16 v[60:63], a[68:71], a[60:63], 0
s_waitcnt lgkmcnt(0)
v_mfma_f32_16x16x32_bf16 v[64:67], a[68:71], a[64:67], 0
v_mfma_f32_16x16x32_bf16 a[12:15], a[72:75], a[64:67], 0
v_mfma_f32_16x16x32_bf16 v[176:179], a[72:75], a[60:63], 0
buffer_load_dwordx4 v20, s[4:7], s74 offen offset:2048 lds
v_mfma_f32_16x16x32_bf16 a[8:11], a[72:75], a[56:59], 0
v_mfma_f32_16x16x32_bf16 v[172:175], a[72:75], a[52:55], 0
v_mfma_f32_16x16x32_bf16 a[4:7], a[72:75], a[48:51], 0
v_mfma_f32_16x16x32_bf16 v[168:171], a[72:75], a[44:47], 0
buffer_load_dwordx4 v21, s[4:7], s74 offen offset:3072 lds
v_mfma_f32_16x16x32_bf16 a[0:3], a[72:75], a[40:43], 0
s_add_u32 m0, s97, 20480
s_add_u32 s74, s87, 32768
v_mfma_f32_16x16x32_bf16 v[164:167], a[72:75], a[36:39], 0
v_mfma_f32_16x16x32_bf16 v[68:71], a[76:79], a[36:39], 0
v_mfma_f32_16x16x32_bf16 v[72:75], a[76:79], a[40:43], 0
buffer_load_dwordx4 v18, s[4:7], s74 offen offset:0 lds
v_mfma_f32_16x16x32_bf16 v[76:79], a[76:79], a[44:47], 0
v_mfma_f32_16x16x32_bf16 v[80:83], a[76:79], a[48:51], 0
v_mfma_f32_16x16x32_bf16 v[84:87], a[76:79], a[52:55], 0
v_mfma_f32_16x16x32_bf16 v[88:91], a[76:79], a[56:59], 0
buffer_load_dwordx4 v19, s[4:7], s74 offen offset:1024 lds
v_mfma_f32_16x16x32_bf16 v[92:95], a[76:79], a[60:63], 0
v_mfma_f32_16x16x32_bf16 v[96:99], a[76:79], a[64:67], 0
v_mfma_f32_16x16x32_bf16 a[32:35], a[80:83], a[64:67], 0
s_waitcnt vmcnt(13) lgkmcnt(0)
s_barrier
v_mfma_f32_16x16x32_bf16 a[28:31], a[80:83], a[60:63], 0
buffer_load_dwordx4 v20, s[4:7], s74 offen offset:2048 lds
v_mfma_f32_16x16x32_bf16 a[24:27], a[80:83], a[56:59], 0
ds_read_b128 a[132:135], v12 offset:0
v_mfma_f32_16x16x32_bf16 v[188:191], a[80:83], a[52:55], 0
ds_read_b64_tr_b16 a[100:101], v2 offset:16384
v_mfma_f32_16x16x32_bf16 a[20:23], a[80:83], a[48:51], 0
ds_read_b64_tr_b16 a[102:103], v2 offset:17408
v_mfma_f32_16x16x32_bf16 v[184:187], a[80:83], a[44:47], 0
buffer_load_dwordx4 v21, s[4:7], s74 offen offset:3072 lds
v_mfma_f32_16x16x32_bf16 a[16:19], a[80:83], a[40:43], 0
s_add_u32 s87, s87, 128
s_and_b32 s87, s87, 1023
s_add_u32 m0, s96, 32768
v_mfma_f32_16x16x32_bf16 v[180:183], a[80:83], a[36:39], 0
ds_read_b128 a[136:139], v12 offset:2048
v_mfma_f32_16x16x32_bf16 v[100:103], a[84:87], a[36:39], 0
ds_read_b64_tr_b16 a[104:105], v3 offset:16384
v_mfma_f32_16x16x32_bf16 v[104:107], a[84:87], a[40:43], 0
buffer_load_dwordx4 v14, s[12:15], s86 offen offset:0 lds
v_mfma_f32_16x16x32_bf16 v[108:111], a[84:87], a[44:47], 0
ds_read_b64_tr_b16 a[106:107], v3 offset:17408
v_mfma_f32_16x16x32_bf16 v[112:115], a[84:87], a[48:51], 0
ds_read_b128 a[140:143], v12 offset:4096
v_mfma_f32_16x16x32_bf16 v[116:119], a[84:87], a[52:55], 0
ds_read_b64_tr_b16 a[108:109], v4 offset:16384
v_mfma_f32_16x16x32_bf16 v[120:123], a[84:87], a[56:59], 0
buffer_load_dwordx4 v15, s[12:15], s86 offen offset:1024 lds
v_mfma_f32_16x16x32_bf16 v[124:127], a[84:87], a[60:63], 0
ds_read_b64_tr_b16 a[110:111], v4 offset:17408
v_mfma_f32_16x16x32_bf16 v[128:131], a[84:87], a[64:67], 0
ds_read_b128 a[144:147], v12 offset:6144
v_mfma_f32_16x16x32_bf16 v[220:223], a[88:91], a[64:67], 0
ds_read_b64_tr_b16 a[112:113], v5 offset:16384
v_mfma_f32_16x16x32_bf16 v[216:219], a[88:91], a[60:63], 0
buffer_load_dwordx4 v16, s[12:15], s86 offen offset:2048 lds
v_mfma_f32_16x16x32_bf16 v[212:215], a[88:91], a[56:59], 0
ds_read_b64_tr_b16 a[114:115], v5 offset:17408
v_mfma_f32_16x16x32_bf16 v[208:211], a[88:91], a[52:55], 0
ds_read_b128 a[148:151], v13 offset:8192
v_mfma_f32_16x16x32_bf16 v[204:207], a[88:91], a[48:51], 0
ds_read_b64_tr_b16 a[116:117], v6 offset:16384
v_mfma_f32_16x16x32_bf16 v[200:203], a[88:91], a[44:47], 0
buffer_load_dwordx4 v17, s[12:15], s86 offen offset:3072 lds
v_mfma_f32_16x16x32_bf16 v[196:199], a[88:91], a[40:43], 0
s_add_u32 s86, s86, 0x40000
s_and_b32 s86, s86, 0x3c0000
s_add_u32 m0, s96, 49152
v_mfma_f32_16x16x32_bf16 v[192:195], a[88:91], a[36:39], 0
ds_read_b64_tr_b16 a[118:119], v6 offset:17408
v_mfma_f32_16x16x32_bf16 v[132:135], a[92:95], a[36:39], 0
ds_read_b128 a[152:155], v13 offset:10240
v_mfma_f32_16x16x32_bf16 v[136:139], a[92:95], a[40:43], 0
buffer_load_dwordx4 v14, s[12:15], s86 offen offset:0 lds
v_mfma_f32_16x16x32_bf16 v[140:143], a[92:95], a[44:47], 0
ds_read_b64_tr_b16 a[120:121], v7 offset:16384
v_mfma_f32_16x16x32_bf16 v[144:147], a[92:95], a[48:51], 0
ds_read_b64_tr_b16 a[122:123], v7 offset:17408
v_mfma_f32_16x16x32_bf16 v[148:151], a[92:95], a[52:55], 0
ds_read_b128 a[156:159], v13 offset:12288
v_mfma_f32_16x16x32_bf16 v[152:155], a[92:95], a[56:59], 0
buffer_load_dwordx4 v15, s[12:15], s86 offen offset:1024 lds
v_mfma_f32_16x16x32_bf16 v[156:159], a[92:95], a[60:63], 0
ds_read_b64_tr_b16 a[124:125], v8 offset:16384
v_mfma_f32_16x16x32_bf16 v[160:163], a[92:95], a[64:67], 0
ds_read_b64_tr_b16 a[126:127], v8 offset:17408
v_mfma_f32_16x16x32_bf16 v[252:255], a[96:99], a[64:67], 0
ds_read_b128 a[160:163], v13 offset:14336
v_mfma_f32_16x16x32_bf16 v[248:251], a[96:99], a[60:63], 0
buffer_load_dwordx4 v16, s[12:15], s86 offen offset:2048 lds
v_mfma_f32_16x16x32_bf16 v[244:247], a[96:99], a[56:59], 0
ds_read_b64_tr_b16 a[128:129], v9 offset:16384
v_mfma_f32_16x16x32_bf16 v[240:243], a[96:99], a[52:55], 0
ds_read_b64_tr_b16 a[130:131], v9 offset:17408
v_mfma_f32_16x16x32_bf16 v[236:239], a[96:99], a[48:51], 0
v_mfma_f32_16x16x32_bf16 v[232:235], a[96:99], a[44:47], 0
buffer_load_dwordx4 v17, s[12:15], s86 offen offset:3072 lds
v_mfma_f32_16x16x32_bf16 v[228:231], a[96:99], a[40:43], 0
s_add_u32 s86, s86, 0x40000
s_and_b32 s86, s86, 0x3c0000
v_mfma_f32_16x16x32_bf16 v[224:227], a[96:99], a[36:39], 0
s_waitcnt lgkmcnt(15)
v_mfma_f32_16x16x32_bf16 v[36:39], a[132:135], a[100:103], v[36:39]
s_waitcnt lgkmcnt(15)
s_add_u32 m0, s97, 32768
s_add_u32 s74, s87, 0
v_mfma_f32_16x16x32_bf16 v[40:43], a[132:135], a[104:107], v[40:43]
s_waitcnt lgkmcnt(15)
buffer_load_dwordx4 v18, s[4:7], s74 offen offset:0 lds
v_mfma_f32_16x16x32_bf16 v[44:47], a[132:135], a[108:111], v[44:47]
s_waitcnt lgkmcnt(12)
v_mfma_f32_16x16x32_bf16 v[48:51], a[132:135], a[112:115], v[48:51]
s_waitcnt lgkmcnt(9)
v_mfma_f32_16x16x32_bf16 v[52:55], a[132:135], a[116:119], v[52:55]
s_waitcnt lgkmcnt(6)
v_mfma_f32_16x16x32_bf16 v[56:59], a[132:135], a[120:123], v[56:59]
s_waitcnt lgkmcnt(3)
buffer_load_dwordx4 v19, s[4:7], s74 offen offset:1024 lds
v_mfma_f32_16x16x32_bf16 v[60:63], a[132:135], a[124:127], v[60:63]
s_waitcnt lgkmcnt(0)
v_mfma_f32_16x16x32_bf16 v[64:67], a[132:135], a[128:131], v[64:67]
v_mfma_f32_16x16x32_bf16 a[12:15], a[136:139], a[128:131], a[12:15]
v_mfma_f32_16x16x32_bf16 v[176:179], a[136:139], a[124:127], v[176:179]
buffer_load_dwordx4 v20, s[4:7], s74 offen offset:2048 lds
v_mfma_f32_16x16x32_bf16 a[8:11], a[136:139], a[120:123], a[8:11]
v_mfma_f32_16x16x32_bf16 v[172:175], a[136:139], a[116:119], v[172:175]
v_mfma_f32_16x16x32_bf16 a[4:7], a[136:139], a[112:115], a[4:7]
v_mfma_f32_16x16x32_bf16 v[168:171], a[136:139], a[108:111], v[168:171]
buffer_load_dwordx4 v21, s[4:7], s74 offen offset:3072 lds
v_mfma_f32_16x16x32_bf16 a[0:3], a[136:139], a[104:107], a[0:3]
s_add_u32 m0, s97, 36864
s_add_u32 s74, s87, 32768
v_mfma_f32_16x16x32_bf16 v[164:167], a[136:139], a[100:103], v[164:167]
v_mfma_f32_16x16x32_bf16 v[68:71], a[140:143], a[100:103], v[68:71]
v_mfma_f32_16x16x32_bf16 v[72:75], a[140:143], a[104:107], v[72:75]
buffer_load_dwordx4 v18, s[4:7], s74 offen offset:0 lds
v_mfma_f32_16x16x32_bf16 v[76:79], a[140:143], a[108:111], v[76:79]
v_mfma_f32_16x16x32_bf16 v[80:83], a[140:143], a[112:115], v[80:83]
v_mfma_f32_16x16x32_bf16 v[84:87], a[140:143], a[116:119], v[84:87]
v_mfma_f32_16x16x32_bf16 v[88:91], a[140:143], a[120:123], v[88:91]
buffer_load_dwordx4 v19, s[4:7], s74 offen offset:1024 lds
v_mfma_f32_16x16x32_bf16 v[92:95], a[140:143], a[124:127], v[92:95]
v_mfma_f32_16x16x32_bf16 v[96:99], a[140:143], a[128:131], v[96:99]
v_mfma_f32_16x16x32_bf16 a[32:35], a[144:147], a[128:131], a[32:35]
s_waitcnt vmcnt(10) lgkmcnt(0)
s_barrier
v_mfma_f32_16x16x32_bf16 a[28:31], a[144:147], a[124:127], a[28:31]
buffer_load_dwordx4 v20, s[4:7], s74 offen offset:2048 lds
v_mfma_f32_16x16x32_bf16 a[24:27], a[144:147], a[120:123], a[24:27]
ds_read_b128 a[68:71], v10 offset:16384
v_mfma_f32_16x16x32_bf16 v[188:191], a[144:147], a[116:119], v[188:191]
ds_read_b64_tr_b16 a[36:37], v2 offset:32768
v_mfma_f32_16x16x32_bf16 a[20:23], a[144:147], a[112:115], a[20:23]
ds_read_b64_tr_b16 a[38:39], v2 offset:33792
v_mfma_f32_16x16x32_bf16 v[184:187], a[144:147], a[108:111], v[184:187]
buffer_load_dwordx4 v21, s[4:7], s74 offen offset:3072 lds
v_mfma_f32_16x16x32_bf16 a[16:19], a[144:147], a[104:107], a[16:19]
s_add_u32 s87, s87, 128
s_and_b32 s87, s87, 1023
s_add_u32 m0, s96, 0
v_mfma_f32_16x16x32_bf16 v[180:183], a[144:147], a[100:103], v[180:183]
ds_read_b128 a[72:75], v10 offset:18432
v_mfma_f32_16x16x32_bf16 v[100:103], a[148:151], a[100:103], v[100:103]
ds_read_b64_tr_b16 a[40:41], v3 offset:32768
v_mfma_f32_16x16x32_bf16 v[104:107], a[148:151], a[104:107], v[104:107]
buffer_load_dwordx4 v14, s[12:15], s86 offen offset:0 lds
v_mfma_f32_16x16x32_bf16 v[108:111], a[148:151], a[108:111], v[108:111]
ds_read_b64_tr_b16 a[42:43], v3 offset:33792
v_mfma_f32_16x16x32_bf16 v[112:115], a[148:151], a[112:115], v[112:115]
ds_read_b128 a[76:79], v10 offset:20480
v_mfma_f32_16x16x32_bf16 v[116:119], a[148:151], a[116:119], v[116:119]
ds_read_b64_tr_b16 a[44:45], v4 offset:32768
v_mfma_f32_16x16x32_bf16 v[120:123], a[148:151], a[120:123], v[120:123]
buffer_load_dwordx4 v15, s[12:15], s86 offen offset:1024 lds
v_mfma_f32_16x16x32_bf16 v[124:127], a[148:151], a[124:127], v[124:127]
ds_read_b64_tr_b16 a[46:47], v4 offset:33792
v_mfma_f32_16x16x32_bf16 v[128:131], a[148:151], a[128:131], v[128:131]
ds_read_b128 a[80:83], v10 offset:22528
v_mfma_f32_16x16x32_bf16 v[220:223], a[152:155], a[128:131], v[220:223]
ds_read_b64_tr_b16 a[48:49], v5 offset:32768
v_mfma_f32_16x16x32_bf16 v[216:219], a[152:155], a[124:127], v[216:219]
buffer_load_dwordx4 v16, s[12:15], s86 offen offset:2048 lds
v_mfma_f32_16x16x32_bf16 v[212:215], a[152:155], a[120:123], v[212:215]
ds_read_b64_tr_b16 a[50:51], v5 offset:33792
v_mfma_f32_16x16x32_bf16 v[208:211], a[152:155], a[116:119], v[208:211]
ds_read_b128 a[84:87], v11 offset:24576
v_mfma_f32_16x16x32_bf16 v[204:207], a[152:155], a[112:115], v[204:207]
ds_read_b64_tr_b16 a[52:53], v6 offset:32768
v_mfma_f32_16x16x32_bf16 v[200:203], a[152:155], a[108:111], v[200:203]
buffer_load_dwordx4 v17, s[12:15], s86 offen offset:3072 lds
v_mfma_f32_16x16x32_bf16 v[196:199], a[152:155], a[104:107], v[196:199]
s_add_u32 s86, s86, 0x40000
s_and_b32 s86, s86, 0x3c0000
s_add_u32 m0, s96, 16384
v_mfma_f32_16x16x32_bf16 v[192:195], a[152:155], a[100:103], v[192:195]
ds_read_b64_tr_b16 a[54:55], v6 offset:33792
v_mfma_f32_16x16x32_bf16 v[132:135], a[156:159], a[100:103], v[132:135]
ds_read_b128 a[88:91], v11 offset:26624
v_mfma_f32_16x16x32_bf16 v[136:139], a[156:159], a[104:107], v[136:139]
buffer_load_dwordx4 v14, s[12:15], s86 offen offset:0 lds
v_mfma_f32_16x16x32_bf16 v[140:143], a[156:159], a[108:111], v[140:143]
ds_read_b64_tr_b16 a[56:57], v7 offset:32768
v_mfma_f32_16x16x32_bf16 v[144:147], a[156:159], a[112:115], v[144:147]
ds_read_b64_tr_b16 a[58:59], v7 offset:33792
v_mfma_f32_16x16x32_bf16 v[148:151], a[156:159], a[116:119], v[148:151]
ds_read_b128 a[92:95], v11 offset:28672
v_mfma_f32_16x16x32_bf16 v[152:155], a[156:159], a[120:123], v[152:155]
buffer_load_dwordx4 v15, s[12:15], s86 offen offset:1024 lds
v_mfma_f32_16x16x32_bf16 v[156:159], a[156:159], a[124:127], v[156:159]
ds_read_b64_tr_b16 a[60:61], v8 offset:32768
v_mfma_f32_16x16x32_bf16 v[160:163], a[156:159], a[128:131], v[160:163]
ds_read_b64_tr_b16 a[62:63], v8 offset:33792
v_mfma_f32_16x16x32_bf16 v[252:255], a[160:163], a[128:131], v[252:255]
ds_read_b128 a[96:99], v11 offset:30720
v_mfma_f32_16x16x32_bf16 v[248:251], a[160:163], a[124:127], v[248:251]
buffer_load_dwordx4 v16, s[12:15], s86 offen offset:2048 lds
v_mfma_f32_16x16x32_bf16 v[244:247], a[160:163], a[120:123], v[244:247]
ds_read_b64_tr_b16 a[64:65], v9 offset:32768
v_mfma_f32_16x16x32_bf16 v[240:243], a[160:163], a[116:119], v[240:243]
ds_read_b64_tr_b16 a[66:67], v9 offset:33792
v_mfma_f32_16x16x32_bf16 v[236:239], a[160:163], a[112:115], v[236:239]
v_mfma_f32_16x16x32_bf16 v[232:235], a[160:163], a[108:111], v[232:235]
buffer_load_dwordx4 v17, s[12:15], s86 offen offset:3072 lds
v_mfma_f32_16x16x32_bf16 v[228:231], a[160:163], a[104:107], v[228:231]
s_add_u32 s86, s86, 0x40000
s_and_b32 s86, s86, 0x3c0000
v_mfma_f32_16x16x32_bf16 v[224:227], a[160:163], a[100:103], v[224:227]
s_waitcnt lgkmcnt(0)
v_mfma_f32_16x16x32_bf16 v[64:67], a[68:71], a[64:67], v[64:67]
s_waitcnt vmcnt(16) lgkmcnt(0)
s_barrier
v_mfma_f32_16x16x32_bf16 a[12:15], a[72:75], a[64:67], a[12:15]
s_add_u32 m0, s97, 0
ds_read_b64_tr_b16 a[100:101], v2 offset:49152
v_mfma_f32_16x16x32_bf16 v[96:99], a[76:79], a[64:67], v[96:99]
s_add_u32 s74, s87, 0
ds_read_b64_tr_b16 a[102:103], v2 offset:50176
v_mfma_f32_16x16x32_bf16 a[32:35], a[80:83], a[64:67], a[32:35]
ds_read_b128 a[132:135], v12 offset:16384
v_mfma_f32_16x16x32_bf16 v[128:131], a[84:87], a[64:67], v[128:131]
ds_read_b128 a[136:139], v12 offset:18432
v_mfma_f32_16x16x32_bf16 v[220:223], a[88:91], a[64:67], v[220:223]
ds_read_b128 a[140:143], v12 offset:20480
v_mfma_f32_16x16x32_bf16 v[160:163], a[92:95], a[64:67], v[160:163]
ds_read_b128 a[144:147], v12 offset:22528
v_mfma_f32_16x16x32_bf16 v[252:255], a[96:99], a[64:67], v[252:255]
ds_read_b128 a[148:151], v13 offset:24576
v_mfma_f32_16x16x32_bf16 v[248:251], a[96:99], a[60:63], v[248:251]
ds_read_b128 a[152:155], v13 offset:26624
v_mfma_f32_16x16x32_bf16 v[156:159], a[92:95], a[60:63], v[156:159]
ds_read_b128 a[156:159], v13 offset:28672
v_mfma_f32_16x16x32_bf16 v[216:219], a[88:91], a[60:63], v[216:219]
ds_read_b128 a[160:163], v13 offset:30720
v_mfma_f32_16x16x32_bf16 v[124:127], a[84:87], a[60:63], v[124:127]
buffer_load_dwordx4 v18, s[4:7], s74 offen offset:0 lds
v_mfma_f32_16x16x32_bf16 a[28:31], a[80:83], a[60:63], a[28:31]
ds_read_b64_tr_b16 a[104:105], v3 offset:49152
v_mfma_f32_16x16x32_bf16 v[92:95], a[76:79], a[60:63], v[92:95]
v_mfma_f32_16x16x32_bf16 v[176:179], a[72:75], a[60:63], v[176:179]
ds_read_b64_tr_b16 a[106:107], v3 offset:50176
v_mfma_f32_16x16x32_bf16 v[60:63], a[68:71], a[60:63], v[60:63]
buffer_load_dwordx4 v19, s[4:7], s74 offen offset:1024 lds
v_mfma_f32_16x16x32_bf16 v[36:39], a[68:71], a[36:39], v[36:39]
s_waitcnt lgkmcnt(9)
ds_read_b64_tr_b16 a[108:109], v4 offset:49152
v_mfma_f32_16x16x32_bf16 v[36:39], a[132:135], a[100:103], v[36:39]
s_waitcnt lgkmcnt(9)
v_mfma_f32_16x16x32_bf16 v[164:167], a[136:139], a[100:103], v[164:167]
ds_read_b64_tr_b16 a[110:111], v4 offset:50176
v_mfma_f32_16x16x32_bf16 v[164:167], a[72:75], a[36:39], v[164:167]
buffer_load_dwordx4 v20, s[4:7], s74 offen offset:2048 lds
v_mfma_f32_16x16x32_bf16 v[68:71], a[76:79], a[36:39], v[68:71]
s_waitcnt lgkmcnt(9)
ds_read_b64_tr_b16 a[112:113], v5 offset:49152
v_mfma_f32_16x16x32_bf16 v[68:71], a[140:143], a[100:103], v[68:71]
s_waitcnt lgkmcnt(9)
v_mfma_f32_16x16x32_bf16 v[180:183], a[144:147], a[100:103], v[180:183]
ds_read_b64_tr_b16 a[114:115], v5 offset:50176
v_mfma_f32_16x16x32_bf16 v[180:183], a[80:83], a[36:39], v[180:183]
buffer_load_dwordx4 v21, s[4:7], s74 offen offset:3072 lds
v_mfma_f32_16x16x32_bf16 v[100:103], a[84:87], a[36:39], v[100:103]
s_waitcnt lgkmcnt(9)
s_add_u32 m0, s96, 32768
ds_read_b64_tr_b16 a[116:117], v6 offset:49152
v_mfma_f32_16x16x32_bf16 v[100:103], a[148:151], a[100:103], v[100:103]
s_waitcnt lgkmcnt(9)
v_mfma_f32_16x16x32_bf16 v[192:195], a[152:155], a[100:103], v[192:195]
ds_read_b64_tr_b16 a[118:119], v6 offset:50176
v_mfma_f32_16x16x32_bf16 v[192:195], a[88:91], a[36:39], v[192:195]
buffer_load_dwordx4 v14, s[12:15], s86 offen offset:0 lds
v_mfma_f32_16x16x32_bf16 v[132:135], a[92:95], a[36:39], v[132:135]
s_waitcnt lgkmcnt(9)
ds_read_b64_tr_b16 a[120:121], v7 offset:49152
v_mfma_f32_16x16x32_bf16 v[132:135], a[156:159], a[100:103], v[132:135]
s_waitcnt lgkmcnt(9)
v_mfma_f32_16x16x32_bf16 v[224:227], a[160:163], a[100:103], v[224:227]
ds_read_b64_tr_b16 a[122:123], v7 offset:50176
v_mfma_f32_16x16x32_bf16 v[224:227], a[96:99], a[36:39], v[224:227]
buffer_load_dwordx4 v15, s[12:15], s86 offen offset:1024 lds
v_mfma_f32_16x16x32_bf16 v[228:231], a[96:99], a[40:43], v[228:231]
s_waitcnt lgkmcnt(8)
ds_read_b64_tr_b16 a[124:125], v8 offset:49152
v_mfma_f32_16x16x32_bf16 v[228:231], a[160:163], a[104:107], v[228:231]
v_mfma_f32_16x16x32_bf16 v[136:139], a[156:159], a[104:107], v[136:139]
ds_read_b64_tr_b16 a[126:127], v8 offset:50176
v_mfma_f32_16x16x32_bf16 v[136:139], a[92:95], a[40:43], v[136:139]
buffer_load_dwordx4 v16, s[12:15], s86 offen offset:2048 lds
v_mfma_f32_16x16x32_bf16 v[196:199], a[88:91], a[40:43], v[196:199]
ds_read_b64_tr_b16 a[128:129], v9 offset:49152
v_mfma_f32_16x16x32_bf16 v[196:199], a[152:155], a[104:107], v[196:199]
v_mfma_f32_16x16x32_bf16 v[104:107], a[148:151], a[104:107], v[104:107]
ds_read_b64_tr_b16 a[130:131], v9 offset:50176
v_mfma_f32_16x16x32_bf16 v[104:107], a[84:87], a[40:43], v[104:107]
buffer_load_dwordx4 v17, s[12:15], s86 offen offset:3072 lds
v_mfma_f32_16x16x32_bf16 a[16:19], a[80:83], a[40:43], a[16:19]
s_add_u32 s86, s86, 0x40000
s_and_b32 s86, s86, 0x3c0000
s_add_u32 m0, s97, 4096
v_mfma_f32_16x16x32_bf16 a[16:19], a[144:147], a[104:107], a[16:19]
s_add_u32 s74, s87, 32768
v_mfma_f32_16x16x32_bf16 v[72:75], a[140:143], a[104:107], v[72:75]
v_mfma_f32_16x16x32_bf16 v[72:75], a[76:79], a[40:43], v[72:75]
buffer_load_dwordx4 v18, s[4:7], s74 offen offset:0 lds
v_mfma_f32_16x16x32_bf16 a[0:3], a[72:75], a[40:43], a[0:3]
v_mfma_f32_16x16x32_bf16 a[0:3], a[136:139], a[104:107], a[0:3]
v_mfma_f32_16x16x32_bf16 v[40:43], a[132:135], a[104:107], v[40:43]
v_mfma_f32_16x16x32_bf16 v[40:43], a[68:71], a[40:43], v[40:43]
buffer_load_dwordx4 v19, s[4:7], s74 offen offset:1024 lds
v_mfma_f32_16x16x32_bf16 v[44:47], a[68:71], a[44:47], v[44:47]
s_waitcnt lgkmcnt(10)
v_mfma_f32_16x16x32_bf16 v[44:47], a[132:135], a[108:111], v[44:47]
v_mfma_f32_16x16x32_bf16 v[168:171], a[136:139], a[108:111], v[168:171]
v_mfma_f32_16x16x32_bf16 v[168:171], a[72:75], a[44:47], v[168:171]
buffer_load_dwordx4 v20, s[4:7], s74 offen offset:2048 lds
v_mfma_f32_16x16x32_bf16 v[76:79], a[76:79], a[44:47], v[76:79]
v_mfma_f32_16x16x32_bf16 v[76:79], a[140:143], a[108:111], v[76:79]
v_mfma_f32_16x16x32_bf16 v[184:187], a[144:147], a[108:111], v[184:187]
v_mfma_f32_16x16x32_bf16 v[184:187], a[80:83], a[44:47], v[184:187]
buffer_load_dwordx4 v21, s[4:7], s74 offen offset:3072 lds
v_mfma_f32_16x16x32_bf16 v[108:111], a[84:87], a[44:47], v[108:111]
s_add_u32 s87, s87, 128
s_and_b32 s87, s87, 1023
v_mfma_f32_16x16x32_bf16 v[108:111], a[148:151], a[108:111], v[108:111]
v_mfma_f32_16x16x32_bf16 v[200:203], a[152:155], a[108:111], v[200:203]
v_mfma_f32_16x16x32_bf16 v[200:203], a[88:91], a[44:47], v[200:203]
buffer_store_dwordx4 a[164:167], v0, s[76:79], s38 offen sc1
v_mfma_f32_16x16x32_bf16 v[140:143], a[92:95], a[44:47], v[140:143]
s_add_u32 s38, s38, 1024
v_mfma_f32_16x16x32_bf16 v[140:143], a[156:159], a[108:111], v[140:143]
v_mfma_f32_16x16x32_bf16 v[232:235], a[160:163], a[108:111], v[232:235]
v_mfma_f32_16x16x32_bf16 v[232:235], a[96:99], a[44:47], v[232:235]
v_mfma_f32_16x16x32_bf16 v[236:239], a[96:99], a[48:51], v[236:239]
s_waitcnt vmcnt(17) lgkmcnt(0)
s_barrier
v_mfma_f32_16x16x32_bf16 v[236:239], a[160:163], a[112:115], v[236:239]
s_add_u32 m0, s96, 49152
ds_read_b64_tr_b16 a[64:65], v9 offset:0
v_mfma_f32_16x16x32_bf16 v[144:147], a[156:159], a[112:115], v[144:147]
buffer_load_dwordx4 v14, s[12:15], s86 offen offset:0 lds
v_mfma_f32_16x16x32_bf16 v[144:147], a[92:95], a[48:51], v[144:147]
ds_read_b64_tr_b16 a[66:67], v9 offset:1024
v_mfma_f32_16x16x32_bf16 v[204:207], a[88:91], a[48:51], v[204:207]
v_mfma_f32_16x16x32_bf16 v[204:207], a[152:155], a[112:115], v[204:207]
ds_read_b64_tr_b16 a[60:61], v8 offset:0
v_mfma_f32_16x16x32_bf16 v[112:115], a[148:151], a[112:115], v[112:115]
buffer_load_dwordx4 v15, s[12:15], s86 offen offset:1024 lds
v_mfma_f32_16x16x32_bf16 v[112:115], a[84:87], a[48:51], v[112:115]
ds_read_b64_tr_b16 a[62:63], v8 offset:1024
v_mfma_f32_16x16x32_bf16 a[20:23], a[80:83], a[48:51], a[20:23]
v_mfma_f32_16x16x32_bf16 a[20:23], a[144:147], a[112:115], a[20:23]
ds_read_b64_tr_b16 a[44:45], v4 offset:0
v_mfma_f32_16x16x32_bf16 v[80:83], a[140:143], a[112:115], v[80:83]
buffer_load_dwordx4 v16, s[12:15], s86 offen offset:2048 lds
v_mfma_f32_16x16x32_bf16 v[80:83], a[76:79], a[48:51], v[80:83]
ds_read_b64_tr_b16 a[46:47], v4 offset:1024
v_mfma_f32_16x16x32_bf16 a[4:7], a[72:75], a[48:51], a[4:7]
v_mfma_f32_16x16x32_bf16 a[4:7], a[136:139], a[112:115], a[4:7]
ds_read_b64_tr_b16 a[40:41], v3 offset:0
v_mfma_f32_16x16x32_bf16 v[48:51], a[132:135], a[112:115], v[48:51]
buffer_load_dwordx4 v17, s[12:15], s86 offen offset:3072 lds
v_mfma_f32_16x16x32_bf16 v[48:51], a[68:71], a[48:51], v[48:51]
s_add_u32 s86, s86, 0x40000
ds_read_b64_tr_b16 a[42:43], v3 offset:1024
v_mfma_f32_16x16x32_bf16 v[52:55], a[68:71], a[52:55], v[52:55]
s_and_b32 s86, s86, 0x3c0000
s_add_u32 m0, s97, 16384
s_add_u32 s74, s87, 0
v_mfma_f32_16x16x32_bf16 v[52:55], a[132:135], a[116:119], v[52:55]
ds_read_b64_tr_b16 a[36:37], v2 offset:0
v_mfma_f32_16x16x32_bf16 v[172:175], a[136:139], a[116:119], v[172:175]
buffer_load_dwordx4 v18, s[4:7], s74 offen offset:0 lds
v_mfma_f32_16x16x32_bf16 v[172:175], a[72:75], a[52:55], v[172:175]
ds_read_b64_tr_b16 a[38:39], v2 offset:1024
v_mfma_f32_16x16x32_bf16 v[84:87], a[76:79], a[52:55], v[84:87]
v_mfma_f32_16x16x32_bf16 v[84:87], a[140:143], a[116:119], v[84:87]
ds_read_b64_tr_b16 a[48:49], v5 offset:0
v_mfma_f32_16x16x32_bf16 v[188:191], a[144:147], a[116:119], v[188:191]
buffer_load_dwordx4 v19, s[4:7], s74 offen offset:1024 lds
v_mfma_f32_16x16x32_bf16 v[188:191], a[80:83], a[52:55], v[188:191]
ds_read_b64_tr_b16 a[50:51], v5 offset:1024
v_mfma_f32_16x16x32_bf16 v[116:119], a[84:87], a[52:55], v[116:119]
v_mfma_f32_16x16x32_bf16 v[116:119], a[148:151], a[116:119], v[116:119]
v_mfma_f32_16x16x32_bf16 v[208:211], a[152:155], a[116:119], v[208:211]
buffer_load_dwordx4 v20, s[4:7], s74 offen offset:2048 lds
v_mfma_f32_16x16x32_bf16 v[208:211], a[88:91], a[52:55], v[208:211]
v_mfma_f32_16x16x32_bf16 v[148:151], a[92:95], a[52:55], v[148:151]
v_mfma_f32_16x16x32_bf16 v[148:151], a[156:159], a[116:119], v[148:151]
v_mfma_f32_16x16x32_bf16 v[240:243], a[160:163], a[116:119], v[240:243]
buffer_load_dwordx4 v21, s[4:7], s74 offen offset:3072 lds
v_mfma_f32_16x16x32_bf16 v[240:243], a[96:99], a[52:55], v[240:243]
ds_read_b64_tr_b16 a[52:53], v6 offset:0
v_mfma_f32_16x16x32_bf16 v[244:247], a[96:99], a[56:59], v[244:247]
v_mfma_f32_16x16x32_bf16 v[244:247], a[160:163], a[120:123], v[244:247]
ds_read_b64_tr_b16 a[54:55], v6 offset:1024
v_mfma_f32_16x16x32_bf16 v[152:155], a[156:159], a[120:123], v[152:155]
buffer_store_dwordx4 a[164:167], v0, s[76:79], s38 offen sc1
v_mfma_f32_16x16x32_bf16 v[152:155], a[92:95], a[56:59], v[152:155]
s_add_u32 s38, s38, 1024
ds_read_b128 a[96:99], v11 offset:47104
v_mfma_f32_16x16x32_bf16 v[212:215], a[88:91], a[56:59], v[212:215]
v_mfma_f32_16x16x32_bf16 v[212:215], a[152:155], a[120:123], v[212:215]
ds_read_b128 a[92:95], v11 offset:45056
v_mfma_f32_16x16x32_bf16 v[120:123], a[148:151], a[120:123], v[120:123]
v_mfma_f32_16x16x32_bf16 v[120:123], a[84:87], a[56:59], v[120:123]
ds_read_b128 a[88:91], v11 offset:43008
v_mfma_f32_16x16x32_bf16 a[24:27], a[80:83], a[56:59], a[24:27]
v_mfma_f32_16x16x32_bf16 a[24:27], a[144:147], a[120:123], a[24:27]
ds_read_b128 a[84:87], v11 offset:40960
v_mfma_f32_16x16x32_bf16 v[88:91], a[140:143], a[120:123], v[88:91]
v_mfma_f32_16x16x32_bf16 v[88:91], a[76:79], a[56:59], v[88:91]
ds_read_b128 a[80:83], v10 offset:38912
v_mfma_f32_16x16x32_bf16 a[8:11], a[72:75], a[56:59], a[8:11]
v_mfma_f32_16x16x32_bf16 a[8:11], a[136:139], a[120:123], a[8:11]
ds_read_b128 a[76:79], v10 offset:36864
v_mfma_f32_16x16x32_bf16 v[56:59], a[132:135], a[120:123], v[56:59]
v_mfma_f32_16x16x32_bf16 v[56:59], a[68:71], a[56:59], v[56:59]
ds_read_b128 a[72:75], v10 offset:34816
v_mfma_f32_16x16x32_bf16 v[60:63], a[132:135], a[124:127], v[60:63]
v_mfma_f32_16x16x32_bf16 v[176:179], a[136:139], a[124:127], v[176:179]
ds_read_b128 a[68:71], v10 offset:32768
v_mfma_f32_16x16x32_bf16 v[92:95], a[140:143], a[124:127], v[92:95]
v_mfma_f32_16x16x32_bf16 a[28:31], a[144:147], a[124:127], a[28:31]
ds_read_b64_tr_b16 a[56:57], v7 offset:0
v_mfma_f32_16x16x32_bf16 v[124:127], a[148:151], a[124:127], v[124:127]
v_mfma_f32_16x16x32_bf16 v[216:219], a[152:155], a[124:127], v[216:219]
ds_read_b64_tr_b16 a[58:59], v7 offset:1024
v_mfma_f32_16x16x32_bf16 v[156:159], a[156:159], a[124:127], v[156:159]
v_mfma_f32_16x16x32_bf16 v[248:251], a[160:163], a[124:127], v[248:251]
v_mfma_f32_16x16x32_bf16 v[252:255], a[160:163], a[128:131], v[252:255]
v_mfma_f32_16x16x32_bf16 v[160:163], a[156:159], a[128:131], v[160:163]
v_mfma_f32_16x16x32_bf16 v[220:223], a[152:155], a[128:131], v[220:223]
v_mfma_f32_16x16x32_bf16 v[128:131], a[148:151], a[128:131], v[128:131]
v_mfma_f32_16x16x32_bf16 a[32:35], a[144:147], a[128:131], a[32:35]
v_mfma_f32_16x16x32_bf16 v[96:99], a[140:143], a[128:131], v[96:99]
v_mfma_f32_16x16x32_bf16 a[12:15], a[136:139], a[128:131], a[12:15]
v_mfma_f32_16x16x32_bf16 v[64:67], a[132:135], a[128:131], v[64:67]
s_waitcnt lgkmcnt(2)
v_mfma_f32_16x16x32_bf16 v[64:67], a[68:71], a[64:67], v[64:67]
s_waitcnt vmcnt(22) lgkmcnt(0)
s_barrier
v_mfma_f32_16x16x32_bf16 a[12:15], a[72:75], a[64:67], a[12:15]
s_add_u32 m0, s96, 0
ds_read_b64_tr_b16 a[100:101], v2 offset:16384
v_mfma_f32_16x16x32_bf16 v[96:99], a[76:79], a[64:67], v[96:99]
ds_read_b64_tr_b16 a[102:103], v2 offset:17408
v_mfma_f32_16x16x32_bf16 a[32:35], a[80:83], a[64:67], a[32:35]
ds_read_b128 a[132:135], v12 offset:32768
v_mfma_f32_16x16x32_bf16 v[128:131], a[84:87], a[64:67], v[128:131]
ds_read_b128 a[136:139], v12 offset:34816
v_mfma_f32_16x16x32_bf16 v[220:223], a[88:91], a[64:67], v[220:223]
ds_read_b128 a[140:143], v12 offset:36864
v_mfma_f32_16x16x32_bf16 v[160:163], a[92:95], a[64:67], v[160:163]
ds_read_b128 a[144:147], v12 offset:38912
v_mfma_f32_16x16x32_bf16 v[252:255], a[96:99], a[64:67], v[252:255]
ds_read_b128 a[148:151], v13 offset:40960
v_mfma_f32_16x16x32_bf16 v[248:251], a[96:99], a[60:63], v[248:251]
ds_read_b128 a[152:155], v13 offset:43008
v_mfma_f32_16x16x32_bf16 v[156:159], a[92:95], a[60:63], v[156:159]
ds_read_b128 a[156:159], v13 offset:45056
v_mfma_f32_16x16x32_bf16 v[216:219], a[88:91], a[60:63], v[216:219]
ds_read_b128 a[160:163], v13 offset:47104
v_mfma_f32_16x16x32_bf16 v[124:127], a[84:87], a[60:63], v[124:127]
buffer_load_dwordx4 v14, s[12:15], s86 offen offset:0 lds
v_mfma_f32_16x16x32_bf16 a[28:31], a[80:83], a[60:63], a[28:31]
ds_read_b64_tr_b16 a[104:105], v3 offset:16384
v_mfma_f32_16x16x32_bf16 v[92:95], a[76:79], a[60:63], v[92:95]
v_mfma_f32_16x16x32_bf16 v[176:179], a[72:75], a[60:63], v[176:179]
ds_read_b64_tr_b16 a[106:107], v3 offset:17408
v_mfma_f32_16x16x32_bf16 v[60:63], a[68:71], a[60:63], v[60:63]
buffer_load_dwordx4 v15, s[12:15], s86 offen offset:1024 lds
v_mfma_f32_16x16x32_bf16 v[36:39], a[68:71], a[36:39], v[36:39]
s_waitcnt lgkmcnt(9)
ds_read_b64_tr_b16 a[108:109], v4 offset:16384
v_mfma_f32_16x16x32_bf16 v[36:39], a[132:135], a[100:103], v[36:39]
s_waitcnt lgkmcnt(9)
v_mfma_f32_16x16x32_bf16 v[164:167], a[136:139], a[100:103], v[164:167]
ds_read_b64_tr_b16 a[110:111], v4 offset:17408
v_mfma_f32_16x16x32_bf16 v[164:167], a[72:75], a[36:39], v[164:167]
buffer_load_dwordx4 v16, s[12:15], s86 offen offset:2048 lds
v_mfma_f32_16x16x32_bf16 v[68:71], a[76:79], a[36:39], v[68:71]
s_waitcnt lgkmcnt(9)
ds_read_b64_tr_b16 a[112:113], v5 offset:16384
v_mfma_f32_16x16x32_bf16 v[68:71], a[140:143], a[100:103], v[68:71]
s_waitcnt lgkmcnt(9)
v_mfma_f32_16x16x32_bf16 v[180:183], a[144:147], a[100:103], v[180:183]
ds_read_b64_tr_b16 a[114:115], v5 offset:17408
v_mfma_f32_16x16x32_bf16 v[180:183], a[80:83], a[36:39], v[180:183]
buffer_load_dwordx4 v17, s[12:15], s86 offen offset:3072 lds
v_mfma_f32_16x16x32_bf16 v[100:103], a[84:87], a[36:39], v[100:103]
s_waitcnt lgkmcnt(9)
s_add_u32 s86, s86, 0x40000
ds_read_b64_tr_b16 a[116:117], v6 offset:16384
v_mfma_f32_16x16x32_bf16 v[100:103], a[148:151], a[100:103], v[100:103]
s_waitcnt lgkmcnt(9)
s_and_b32 s86, s86, 0x3c0000
s_add_u32 m0, s97, 20480
s_add_u32 s74, s87, 32768
v_mfma_f32_16x16x32_bf16 v[192:195], a[152:155], a[100:103], v[192:195]
ds_read_b64_tr_b16 a[118:119], v6 offset:17408
v_mfma_f32_16x16x32_bf16 v[192:195], a[88:91], a[36:39], v[192:195]
buffer_load_dwordx4 v18, s[4:7], s74 offen offset:0 lds
v_mfma_f32_16x16x32_bf16 v[132:135], a[92:95], a[36:39], v[132:135]
s_waitcnt lgkmcnt(9)
ds_read_b64_tr_b16 a[120:121], v7 offset:16384
v_mfma_f32_16x16x32_bf16 v[132:135], a[156:159], a[100:103], v[132:135]
s_waitcnt lgkmcnt(9)
v_mfma_f32_16x16x32_bf16 v[224:227], a[160:163], a[100:103], v[224:227]
ds_read_b64_tr_b16 a[122:123], v7 offset:17408
v_mfma_f32_16x16x32_bf16 v[224:227], a[96:99], a[36:39], v[224:227]
buffer_load_dwordx4 v19, s[4:7], s74 offen offset:1024 lds
v_mfma_f32_16x16x32_bf16 v[228:231], a[96:99], a[40:43], v[228:231]
s_waitcnt lgkmcnt(8)
ds_read_b64_tr_b16 a[124:125], v8 offset:16384
v_mfma_f32_16x16x32_bf16 v[228:231], a[160:163], a[104:107], v[228:231]
v_mfma_f32_16x16x32_bf16 v[136:139], a[156:159], a[104:107], v[136:139]
ds_read_b64_tr_b16 a[126:127], v8 offset:17408
v_mfma_f32_16x16x32_bf16 v[136:139], a[92:95], a[40:43], v[136:139]
buffer_load_dwordx4 v20, s[4:7], s74 offen offset:2048 lds
v_mfma_f32_16x16x32_bf16 v[196:199], a[88:91], a[40:43], v[196:199]
ds_read_b64_tr_b16 a[128:129], v9 offset:16384
v_mfma_f32_16x16x32_bf16 v[196:199], a[152:155], a[104:107], v[196:199]
v_mfma_f32_16x16x32_bf16 v[104:107], a[148:151], a[104:107], v[104:107]
ds_read_b64_tr_b16 a[130:131], v9 offset:17408
v_mfma_f32_16x16x32_bf16 v[104:107], a[84:87], a[40:43], v[104:107]
buffer_load_dwordx4 v21, s[4:7], s74 offen offset:3072 lds
v_mfma_f32_16x16x32_bf16 a[16:19], a[80:83], a[40:43], a[16:19]
s_add_u32 s87, s87, 128
s_and_b32 s87, s87, 1023
v_mfma_f32_16x16x32_bf16 a[16:19], a[144:147], a[104:107], a[16:19]
v_mfma_f32_16x16x32_bf16 v[72:75], a[140:143], a[104:107], v[72:75]
v_mfma_f32_16x16x32_bf16 v[72:75], a[76:79], a[40:43], v[72:75]
buffer_store_dwordx4 a[164:167], v0, s[76:79], s38 offen sc1
v_mfma_f32_16x16x32_bf16 a[0:3], a[72:75], a[40:43], a[0:3]
s_add_u32 s38, s38, 1024
v_mfma_f32_16x16x32_bf16 a[0:3], a[136:139], a[104:107], a[0:3]
v_mfma_f32_16x16x32_bf16 v[40:43], a[132:135], a[104:107], v[40:43]
v_mfma_f32_16x16x32_bf16 v[40:43], a[68:71], a[40:43], v[40:43]
buffer_store_dwordx4 a[164:167], v0, s[76:79], s38 offen sc1
v_mfma_f32_16x16x32_bf16 v[44:47], a[68:71], a[44:47], v[44:47]
s_waitcnt lgkmcnt(10)
s_add_u32 s38, s38, 1024
v_mfma_f32_16x16x32_bf16 v[44:47], a[132:135], a[108:111], v[44:47]
v_mfma_f32_16x16x32_bf16 v[168:171], a[136:139], a[108:111], v[168:171]
v_mfma_f32_16x16x32_bf16 v[168:171], a[72:75], a[44:47], v[168:171]
v_mfma_f32_16x16x32_bf16 v[76:79], a[76:79], a[44:47], v[76:79]
v_mfma_f32_16x16x32_bf16 v[76:79], a[140:143], a[108:111], v[76:79]
v_mfma_f32_16x16x32_bf16 v[184:187], a[144:147], a[108:111], v[184:187]
v_mfma_f32_16x16x32_bf16 v[184:187], a[80:83], a[44:47], v[184:187]
v_mfma_f32_16x16x32_bf16 v[108:111], a[84:87], a[44:47], v[108:111]
v_mfma_f32_16x16x32_bf16 v[108:111], a[148:151], a[108:111], v[108:111]
v_mfma_f32_16x16x32_bf16 v[200:203], a[152:155], a[108:111], v[200:203]
v_mfma_f32_16x16x32_bf16 v[200:203], a[88:91], a[44:47], v[200:203]
v_mfma_f32_16x16x32_bf16 v[140:143], a[92:95], a[44:47], v[140:143]
v_mfma_f32_16x16x32_bf16 v[140:143], a[156:159], a[108:111], v[140:143]
v_mfma_f32_16x16x32_bf16 v[232:235], a[160:163], a[108:111], v[232:235]
v_mfma_f32_16x16x32_bf16 v[232:235], a[96:99], a[44:47], v[232:235]
v_mfma_f32_16x16x32_bf16 v[236:239], a[96:99], a[48:51], v[236:239]
s_waitcnt vmcnt(19) lgkmcnt(0)
s_barrier
v_mfma_f32_16x16x32_bf16 v[236:239], a[160:163], a[112:115], v[236:239]
s_add_u32 m0, s96, 16384
ds_read_b64_tr_b16 a[64:65], v9 offset:32768
v_mfma_f32_16x16x32_bf16 v[144:147], a[156:159], a[112:115], v[144:147]
buffer_load_dwordx4 v14, s[12:15], s86 offen offset:0 lds
v_mfma_f32_16x16x32_bf16 v[144:147], a[92:95], a[48:51], v[144:147]
ds_read_b64_tr_b16 a[66:67], v9 offset:33792
v_mfma_f32_16x16x32_bf16 v[204:207], a[88:91], a[48:51], v[204:207]
v_mfma_f32_16x16x32_bf16 v[204:207], a[152:155], a[112:115], v[204:207]
ds_read_b64_tr_b16 a[60:61], v8 offset:32768
v_mfma_f32_16x16x32_bf16 v[112:115], a[148:151], a[112:115], v[112:115]
buffer_load_dwordx4 v15, s[12:15], s86 offen offset:1024 lds
v_mfma_f32_16x16x32_bf16 v[112:115], a[84:87], a[48:51], v[112:115]
ds_read_b64_tr_b16 a[62:63], v8 offset:33792
v_mfma_f32_16x16x32_bf16 a[20:23], a[80:83], a[48:51], a[20:23]
v_mfma_f32_16x16x32_bf16 a[20:23], a[144:147], a[112:115], a[20:23]
ds_read_b64_tr_b16 a[44:45], v4 offset:32768
v_mfma_f32_16x16x32_bf16 v[80:83], a[140:143], a[112:115], v[80:83]
buffer_load_dwordx4 v16, s[12:15], s86 offen offset:2048 lds
v_mfma_f32_16x16x32_bf16 v[80:83], a[76:79], a[48:51], v[80:83]
ds_read_b64_tr_b16 a[46:47], v4 offset:33792
v_mfma_f32_16x16x32_bf16 a[4:7], a[72:75], a[48:51], a[4:7]
v_mfma_f32_16x16x32_bf16 a[4:7], a[136:139], a[112:115], a[4:7]
ds_read_b64_tr_b16 a[40:41], v3 offset:32768
v_mfma_f32_16x16x32_bf16 v[48:51], a[132:135], a[112:115], v[48:51]
buffer_load_dwordx4 v17, s[12:15], s86 offen offset:3072 lds
v_mfma_f32_16x16x32_bf16 v[48:51], a[68:71], a[48:51], v[48:51]
s_add_u32 s86, s86, 0x40000
ds_read_b64_tr_b16 a[42:43], v3 offset:33792
v_mfma_f32_16x16x32_bf16 v[52:55], a[68:71], a[52:55], v[52:55]
s_and_b32 s86, s86, 0x3c0000
s_add_u32 m0, s97, 32768
s_add_u32 s74, s87, 0
v_mfma_f32_16x16x32_bf16 v[52:55], a[132:135], a[116:119], v[52:55]
ds_read_b64_tr_b16 a[36:37], v2 offset:32768
v_mfma_f32_16x16x32_bf16 v[172:175], a[136:139], a[116:119], v[172:175]
buffer_load_dwordx4 v18, s[4:7], s74 offen offset:0 lds
v_mfma_f32_16x16x32_bf16 v[172:175], a[72:75], a[52:55], v[172:175]
ds_read_b64_tr_b16 a[38:39], v2 offset:33792
v_mfma_f32_16x16x32_bf16 v[84:87], a[76:79], a[52:55], v[84:87]
v_mfma_f32_16x16x32_bf16 v[84:87], a[140:143], a[116:119], v[84:87]
ds_read_b64_tr_b16 a[48:49], v5 offset:32768
v_mfma_f32_16x16x32_bf16 v[188:191], a[144:147], a[116:119], v[188:191]
buffer_load_dwordx4 v19, s[4:7], s74 offen offset:1024 lds
v_mfma_f32_16x16x32_bf16 v[188:191], a[80:83], a[52:55], v[188:191]
ds_read_b64_tr_b16 a[50:51], v5 offset:33792
v_mfma_f32_16x16x32_bf16 v[116:119], a[84:87], a[52:55], v[116:119]
v_mfma_f32_16x16x32_bf16 v[116:119], a[148:151], a[116:119], v[116:119]
v_mfma_f32_16x16x32_bf16 v[208:211], a[152:155], a[116:119], v[208:211]
buffer_load_dwordx4 v20, s[4:7], s74 offen offset:2048 lds
v_mfma_f32_16x16x32_bf16 v[208:211], a[88:91], a[52:55], v[208:211]
v_mfma_f32_16x16x32_bf16 v[148:151], a[92:95], a[52:55], v[148:151]
v_mfma_f32_16x16x32_bf16 v[148:151], a[156:159], a[116:119], v[148:151]
v_mfma_f32_16x16x32_bf16 v[240:243], a[160:163], a[116:119], v[240:243]
buffer_load_dwordx4 v21, s[4:7], s74 offen offset:3072 lds
v_mfma_f32_16x16x32_bf16 v[240:243], a[96:99], a[52:55], v[240:243]
ds_read_b64_tr_b16 a[52:53], v6 offset:32768
v_mfma_f32_16x16x32_bf16 v[244:247], a[96:99], a[56:59], v[244:247]
v_mfma_f32_16x16x32_bf16 v[244:247], a[160:163], a[120:123], v[244:247]
ds_read_b64_tr_b16 a[54:55], v6 offset:33792
v_mfma_f32_16x16x32_bf16 v[152:155], a[156:159], a[120:123], v[152:155]
buffer_store_dwordx4 a[164:167], v0, s[76:79], s38 offen sc1
v_mfma_f32_16x16x32_bf16 v[152:155], a[92:95], a[56:59], v[152:155]
s_add_u32 s38, s38, 1024
ds_read_b128 a[96:99], v11 offset:14336
v_mfma_f32_16x16x32_bf16 v[212:215], a[88:91], a[56:59], v[212:215]
v_lshrrev_b32 v30, 6, v0
v_bfe_u32 v31, v0, 4, 2
v_mfma_f32_16x16x32_bf16 v[212:215], a[152:155], a[120:123], v[212:215]
ds_read_b128 a[92:95], v11 offset:12288
v_lshl_add_u32 v30, s80, 4, v30
v_mfma_f32_16x16x32_bf16 v[120:123], a[148:151], a[120:123], v[120:123]
v_lshlrev_b32 v31, 6, v31
v_lshl_or_b32 v30, v30, 13, v31
v_mfma_f32_16x16x32_bf16 v[120:123], a[84:87], a[56:59], v[120:123]
s_lshl_b32 s74, s83, 12
ds_read_b128 a[88:91], v11 offset:10240
v_mfma_f32_16x16x32_bf16 a[24:27], a[80:83], a[56:59], a[24:27]
buffer_load_dword a183, v30, s[16:19], s74 offen
v_mfma_f32_16x16x32_bf16 a[24:27], a[144:147], a[120:123], a[24:27]
ds_read_b128 a[84:87], v11 offset:8192
v_mfma_f32_16x16x32_bf16 v[88:91], a[140:143], a[120:123], v[88:91]
v_mfma_f32_16x16x32_bf16 v[88:91], a[76:79], a[56:59], v[88:91]
ds_read_b128 a[80:83], v10 offset:6144
v_mfma_f32_16x16x32_bf16 a[8:11], a[72:75], a[56:59], a[8:11]
v_mfma_f32_16x16x32_bf16 a[8:11], a[136:139], a[120:123], a[8:11]
ds_read_b128 a[76:79], v10 offset:4096
v_mfma_f32_16x16x32_bf16 v[56:59], a[132:135], a[120:123], v[56:59]
v_mfma_f32_16x16x32_bf16 v[56:59], a[68:71], a[56:59], v[56:59]
ds_read_b128 a[72:75], v10 offset:2048
v_mfma_f32_16x16x32_bf16 v[60:63], a[132:135], a[124:127], v[60:63]
v_mfma_f32_16x16x32_bf16 v[176:179], a[136:139], a[124:127], v[176:179]
ds_read_b128 a[68:71], v10 offset:0
v_mfma_f32_16x16x32_bf16 v[92:95], a[140:143], a[124:127], v[92:95]
v_mfma_f32_16x16x32_bf16 a[28:31], a[144:147], a[124:127], a[28:31]
ds_read_b64_tr_b16 a[56:57], v7 offset:32768
v_mfma_f32_16x16x32_bf16 v[124:127], a[148:151], a[124:127], v[124:127]
v_mfma_f32_16x16x32_bf16 v[216:219], a[152:155], a[124:127], v[216:219]
ds_read_b64_tr_b16 a[58:59], v7 offset:33792
v_mfma_f32_16x16x32_bf16 v[156:159], a[156:159], a[124:127], v[156:159]
v_mfma_f32_16x16x32_bf16 v[248:251], a[160:163], a[124:127], v[248:251]
v_mfma_f32_16x16x32_bf16 v[252:255], a[160:163], a[128:131], v[252:255]
v_mfma_f32_16x16x32_bf16 v[160:163], a[156:159], a[128:131], v[160:163]
v_mfma_f32_16x16x32_bf16 v[220:223], a[152:155], a[128:131], v[220:223]
v_mfma_f32_16x16x32_bf16 v[128:131], a[148:151], a[128:131], v[128:131]
v_mfma_f32_16x16x32_bf16 a[32:35], a[144:147], a[128:131], a[32:35]
v_mfma_f32_16x16x32_bf16 v[96:99], a[140:143], a[128:131], v[96:99]
v_mfma_f32_16x16x32_bf16 a[12:15], a[136:139], a[128:131], a[12:15]
v_mfma_f32_16x16x32_bf16 v[64:67], a[132:135], a[128:131], v[64:67]
s_waitcnt lgkmcnt(2)
v_mfma_f32_16x16x32_bf16 v[64:67], a[68:71], a[64:67], v[64:67]
s_waitcnt vmcnt(20) lgkmcnt(0)
s_barrier
v_mfma_f32_16x16x32_bf16 a[12:15], a[72:75], a[64:67], a[12:15]
s_add_u32 m0, s96, 32768
ds_read_b64_tr_b16 a[100:101], v2 offset:49152
v_mfma_f32_16x16x32_bf16 v[96:99], a[76:79], a[64:67], v[96:99]
ds_read_b64_tr_b16 a[102:103], v2 offset:50176
v_mfma_f32_16x16x32_bf16 a[32:35], a[80:83], a[64:67], a[32:35]
ds_read_b128 a[132:135], v12 offset:0
v_mfma_f32_16x16x32_bf16 v[128:131], a[84:87], a[64:67], v[128:131]
ds_read_b128 a[136:139], v12 offset:2048
v_mfma_f32_16x16x32_bf16 v[220:223], a[88:91], a[64:67], v[220:223]
ds_read_b128 a[140:143], v12 offset:4096
v_mfma_f32_16x16x32_bf16 v[160:163], a[92:95], a[64:67], v[160:163]
ds_read_b128 a[144:147], v12 offset:6144
v_mfma_f32_16x16x32_bf16 v[252:255], a[96:99], a[64:67], v[252:255]
ds_read_b128 a[148:151], v13 offset:8192
v_mfma_f32_16x16x32_bf16 v[248:251], a[96:99], a[60:63], v[248:251]
ds_read_b128 a[152:155], v13 offset:10240
v_mfma_f32_16x16x32_bf16 v[156:159], a[92:95], a[60:63], v[156:159]
ds_read_b128 a[156:159], v13 offset:12288
v_mfma_f32_16x16x32_bf16 v[216:219], a[88:91], a[60:63], v[216:219]
ds_read_b128 a[160:163], v13 offset:14336
v_mfma_f32_16x16x32_bf16 v[124:127], a[84:87], a[60:63], v[124:127]
buffer_load_dwordx4 v14, s[12:15], s86 offen offset:0 lds
v_mfma_f32_16x16x32_bf16 a[28:31], a[80:83], a[60:63], a[28:31]
ds_read_b64_tr_b16 a[104:105], v3 offset:49152
v_mfma_f32_16x16x32_bf16 v[92:95], a[76:79], a[60:63], v[92:95]
v_mfma_f32_16x16x32_bf16 v[176:179], a[72:75], a[60:63], v[176:179]
ds_read_b64_tr_b16 a[106:107], v3 offset:50176
v_mfma_f32_16x16x32_bf16 v[60:63], a[68:71], a[60:63], v[60:63]
buffer_load_dwordx4 v15, s[12:15], s86 offen offset:1024 lds
v_mfma_f32_16x16x32_bf16 v[36:39], a[68:71], a[36:39], v[36:39]
s_waitcnt lgkmcnt(9)
ds_read_b64_tr_b16 a[108:109], v4 offset:49152
v_mfma_f32_16x16x32_bf16 v[36:39], a[132:135], a[100:103], v[36:39]
s_waitcnt lgkmcnt(9)
v_mfma_f32_16x16x32_bf16 v[164:167], a[136:139], a[100:103], v[164:167]
ds_read_b64_tr_b16 a[110:111], v4 offset:50176
v_mfma_f32_16x16x32_bf16 v[164:167], a[72:75], a[36:39], v[164:167]
buffer_load_dwordx4 v16, s[12:15], s86 offen offset:2048 lds
v_mfma_f32_16x16x32_bf16 v[68:71], a[76:79], a[36:39], v[68:71]
s_waitcnt lgkmcnt(9)
ds_read_b64_tr_b16 a[112:113], v5 offset:49152
v_mfma_f32_16x16x32_bf16 v[68:71], a[140:143], a[100:103], v[68:71]
s_waitcnt lgkmcnt(9)
v_mfma_f32_16x16x32_bf16 v[180:183], a[144:147], a[100:103], v[180:183]
ds_read_b64_tr_b16 a[114:115], v5 offset:50176
v_mfma_f32_16x16x32_bf16 v[180:183], a[80:83], a[36:39], v[180:183]
buffer_load_dwordx4 v17, s[12:15], s86 offen offset:3072 lds
v_mfma_f32_16x16x32_bf16 v[100:103], a[84:87], a[36:39], v[100:103]
s_waitcnt lgkmcnt(9)
s_add_u32 s86, s86, 0x40000
ds_read_b64_tr_b16 a[116:117], v6 offset:49152
v_mfma_f32_16x16x32_bf16 v[100:103], a[148:151], a[100:103], v[100:103]
s_waitcnt lgkmcnt(9)
s_and_b32 s86, s86, 0x3c0000
s_add_u32 m0, s97, 36864
s_add_u32 s74, s87, 32768
v_mfma_f32_16x16x32_bf16 v[192:195], a[152:155], a[100:103], v[192:195]
ds_read_b64_tr_b16 a[118:119], v6 offset:50176
v_mfma_f32_16x16x32_bf16 v[192:195], a[88:91], a[36:39], v[192:195]
buffer_load_dwordx4 v18, s[4:7], s74 offen offset:0 lds
v_mfma_f32_16x16x32_bf16 v[132:135], a[92:95], a[36:39], v[132:135]
s_waitcnt lgkmcnt(9)
ds_read_b64_tr_b16 a[120:121], v7 offset:49152
v_mfma_f32_16x16x32_bf16 v[132:135], a[156:159], a[100:103], v[132:135]
s_waitcnt lgkmcnt(9)
v_mfma_f32_16x16x32_bf16 v[224:227], a[160:163], a[100:103], v[224:227]
ds_read_b64_tr_b16 a[122:123], v7 offset:50176
v_mfma_f32_16x16x32_bf16 v[224:227], a[96:99], a[36:39], v[224:227]
buffer_load_dwordx4 v19, s[4:7], s74 offen offset:1024 lds
v_mfma_f32_16x16x32_bf16 v[228:231], a[96:99], a[40:43], v[228:231]
s_waitcnt lgkmcnt(8)
ds_read_b64_tr_b16 a[124:125], v8 offset:49152
v_mfma_f32_16x16x32_bf16 v[228:231], a[160:163], a[104:107], v[228:231]
v_mfma_f32_16x16x32_bf16 v[136:139], a[156:159], a[104:107], v[136:139]
ds_read_b64_tr_b16 a[126:127], v8 offset:50176
v_mfma_f32_16x16x32_bf16 v[136:139], a[92:95], a[40:43], v[136:139]
buffer_load_dwordx4 v20, s[4:7], s74 offen offset:2048 lds
v_mfma_f32_16x16x32_bf16 v[196:199], a[88:91], a[40:43], v[196:199]
ds_read_b64_tr_b16 a[128:129], v9 offset:49152
v_mfma_f32_16x16x32_bf16 v[196:199], a[152:155], a[104:107], v[196:199]
v_mfma_f32_16x16x32_bf16 v[104:107], a[148:151], a[104:107], v[104:107]
ds_read_b64_tr_b16 a[130:131], v9 offset:50176
v_mfma_f32_16x16x32_bf16 v[104:107], a[84:87], a[40:43], v[104:107]
buffer_load_dwordx4 v21, s[4:7], s74 offen offset:3072 lds
v_mfma_f32_16x16x32_bf16 a[16:19], a[80:83], a[40:43], a[16:19]
s_add_u32 s87, s87, 128
s_and_b32 s87, s87, 1023
v_mfma_f32_16x16x32_bf16 a[16:19], a[144:147], a[104:107], a[16:19]
v_mfma_f32_16x16x32_bf16 v[72:75], a[140:143], a[104:107], v[72:75]
v_mfma_f32_16x16x32_bf16 v[72:75], a[76:79], a[40:43], v[72:75]
buffer_store_dwordx4 a[164:167], v0, s[76:79], s38 offen sc1
v_mfma_f32_16x16x32_bf16 a[0:3], a[72:75], a[40:43], a[0:3]
s_add_u32 s38, s38, 1024
v_mfma_f32_16x16x32_bf16 a[0:3], a[136:139], a[104:107], a[0:3]
v_mfma_f32_16x16x32_bf16 v[40:43], a[132:135], a[104:107], v[40:43]
v_mfma_f32_16x16x32_bf16 v[40:43], a[68:71], a[40:43], v[40:43]
buffer_store_dwordx4 a[164:167], v0, s[76:79], s38 offen sc1
v_mfma_f32_16x16x32_bf16 v[44:47], a[68:71], a[44:47], v[44:47]
s_waitcnt lgkmcnt(10)
s_add_u32 s38, s38, 1024
v_mfma_f32_16x16x32_bf16 v[44:47], a[132:135], a[108:111], v[44:47]
v_mfma_f32_16x16x32_bf16 v[168:171], a[136:139], a[108:111], v[168:171]
v_mfma_f32_16x16x32_bf16 v[168:171], a[72:75], a[44:47], v[168:171]
v_mfma_f32_16x16x32_bf16 v[76:79], a[76:79], a[44:47], v[76:79]
v_mfma_f32_16x16x32_bf16 v[76:79], a[140:143], a[108:111], v[76:79]
v_mfma_f32_16x16x32_bf16 v[184:187], a[144:147], a[108:111], v[184:187]
v_mfma_f32_16x16x32_bf16 v[184:187], a[80:83], a[44:47], v[184:187]
v_mfma_f32_16x16x32_bf16 v[108:111], a[84:87], a[44:47], v[108:111]
v_mfma_f32_16x16x32_bf16 v[108:111], a[148:151], a[108:111], v[108:111]
v_mfma_f32_16x16x32_bf16 v[200:203], a[152:155], a[108:111], v[200:203]
v_mfma_f32_16x16x32_bf16 v[200:203], a[88:91], a[44:47], v[200:203]
v_mfma_f32_16x16x32_bf16 v[140:143], a[92:95], a[44:47], v[140:143]
v_mfma_f32_16x16x32_bf16 v[140:143], a[156:159], a[108:111], v[140:143]
v_mfma_f32_16x16x32_bf16 v[232:235], a[160:163], a[108:111], v[232:235]
v_mfma_f32_16x16x32_bf16 v[232:235], a[96:99], a[44:47], v[232:235]
v_mfma_f32_16x16x32_bf16 v[236:239], a[96:99], a[48:51], v[236:239]
s_waitcnt vmcnt(20) lgkmcnt(0)
s_barrier
v_mfma_f32_16x16x32_bf16 v[236:239], a[160:163], a[112:115], v[236:239]
s_add_u32 m0, s96, 49152
ds_read_b64_tr_b16 a[64:65], v9 offset:0
v_mfma_f32_16x16x32_bf16 v[144:147], a[156:159], a[112:115], v[144:147]
buffer_load_dwordx4 v14, s[12:15], s86 offen offset:0 lds
v_mfma_f32_16x16x32_bf16 v[144:147], a[92:95], a[48:51], v[144:147]
ds_read_b64_tr_b16 a[66:67], v9 offset:1024
v_mfma_f32_16x16x32_bf16 v[204:207], a[88:91], a[48:51], v[204:207]
v_mfma_f32_16x16x32_bf16 v[204:207], a[152:155], a[112:115], v[204:207]
ds_read_b64_tr_b16 a[60:61], v8 offset:0
v_mfma_f32_16x16x32_bf16 v[112:115], a[148:151], a[112:115], v[112:115]
buffer_load_dwordx4 v15, s[12:15], s86 offen offset:1024 lds
v_mfma_f32_16x16x32_bf16 v[112:115], a[84:87], a[48:51], v[112:115]
ds_read_b64_tr_b16 a[62:63], v8 offset:1024
v_mfma_f32_16x16x32_bf16 a[20:23], a[80:83], a[48:51], a[20:23]
v_mfma_f32_16x16x32_bf16 a[20:23], a[144:147], a[112:115], a[20:23]
ds_read_b64_tr_b16 a[44:45], v4 offset:0
v_mfma_f32_16x16x32_bf16 v[80:83], a[140:143], a[112:115], v[80:83]
buffer_load_dwordx4 v16, s[12:15], s86 offen offset:2048 lds
v_mfma_f32_16x16x32_bf16 v[80:83], a[76:79], a[48:51], v[80:83]
ds_read_b64_tr_b16 a[46:47], v4 offset:1024
v_mfma_f32_16x16x32_bf16 a[4:7], a[72:75], a[48:51], a[4:7]
v_mfma_f32_16x16x32_bf16 a[4:7], a[136:139], a[112:115], a[4:7]
ds_read_b64_tr_b16 a[40:41], v3 offset:0
v_mfma_f32_16x16x32_bf16 v[48:51], a[132:135], a[112:115], v[48:51]
buffer_load_dwordx4 v17, s[12:15], s86 offen offset:3072 lds
v_mfma_f32_16x16x32_bf16 v[48:51], a[68:71], a[48:51], v[48:51]
s_add_u32 s86, s86, 0x40000
ds_read_b64_tr_b16 a[42:43], v3 offset:1024
v_mfma_f32_16x16x32_bf16 v[52:55], a[68:71], a[52:55], v[52:55]
s_and_b32 s86, s86, 0x3c0000
s_add_u32 m0, s97, 0
s_add_u32 s74, s87, 0
v_mfma_f32_16x16x32_bf16 v[52:55], a[132:135], a[116:119], v[52:55]
ds_read_b64_tr_b16 a[36:37], v2 offset:0
v_mfma_f32_16x16x32_bf16 v[172:175], a[136:139], a[116:119], v[172:175]
buffer_load_dwordx4 v18, s[4:7], s74 offen offset:0 lds
v_mfma_f32_16x16x32_bf16 v[172:175], a[72:75], a[52:55], v[172:175]
ds_read_b64_tr_b16 a[38:39], v2 offset:1024
v_mfma_f32_16x16x32_bf16 v[84:87], a[76:79], a[52:55], v[84:87]
v_mfma_f32_16x16x32_bf16 v[84:87], a[140:143], a[116:119], v[84:87]
ds_read_b64_tr_b16 a[48:49], v5 offset:0
v_mfma_f32_16x16x32_bf16 v[188:191], a[144:147], a[116:119], v[188:191]
buffer_load_dwordx4 v19, s[4:7], s74 offen offset:1024 lds
v_mfma_f32_16x16x32_bf16 v[188:191], a[80:83], a[52:55], v[188:191]
ds_read_b64_tr_b16 a[50:51], v5 offset:1024
v_mfma_f32_16x16x32_bf16 v[116:119], a[84:87], a[52:55], v[116:119]
v_mfma_f32_16x16x32_bf16 v[116:119], a[148:151], a[116:119], v[116:119]
v_mfma_f32_16x16x32_bf16 v[208:211], a[152:155], a[116:119], v[208:211]
buffer_load_dwordx4 v20, s[4:7], s74 offen offset:2048 lds
v_mfma_f32_16x16x32_bf16 v[208:211], a[88:91], a[52:55], v[208:211]
v_mfma_f32_16x16x32_bf16 v[148:151], a[92:95], a[52:55], v[148:151]
v_mfma_f32_16x16x32_bf16 v[148:151], a[156:159], a[116:119], v[148:151]
v_mfma_f32_16x16x32_bf16 v[240:243], a[160:163], a[116:119], v[240:243]
buffer_load_dwordx4 v21, s[4:7], s74 offen offset:3072 lds
v_mfma_f32_16x16x32_bf16 v[240:243], a[96:99], a[52:55], v[240:243]
ds_read_b64_tr_b16 a[52:53], v6 offset:0
v_mfma_f32_16x16x32_bf16 v[244:247], a[96:99], a[56:59], v[244:247]
v_mfma_f32_16x16x32_bf16 v[244:247], a[160:163], a[120:123], v[244:247]
ds_read_b64_tr_b16 a[54:55], v6 offset:1024
v_mfma_f32_16x16x32_bf16 v[152:155], a[156:159], a[120:123], v[152:155]
buffer_store_dwordx4 a[164:167], v0, s[76:79], s38 offen sc1
v_mfma_f32_16x16x32_bf16 v[152:155], a[92:95], a[56:59], v[152:155]
s_add_u32 s38, s38, 1024
ds_read_b128 a[96:99], v11 offset:30720
v_mfma_f32_16x16x32_bf16 v[212:215], a[88:91], a[56:59], v[212:215]
v_bfe_u32 v31, v0, 4, 2
v_lshl_add_u32 v31, v31, 6, s83
v_mfma_f32_16x16x32_bf16 v[212:215], a[152:155], a[120:123], v[212:215]
ds_read_b128 a[92:95], v11 offset:28672
v_and_b32 v31, 1023, v31
v_mfma_f32_16x16x32_bf16 v[120:123], a[148:151], a[120:123], v[120:123]
v_lshrrev_b32 v30, 6, v0
v_lshl_or_b32 v30, v30, 10, v31
v_mfma_f32_16x16x32_bf16 v[120:123], a[84:87], a[56:59], v[120:123]
s_lshl_b32 s74, s80, 15
ds_read_b128 a[88:91], v11 offset:26624
v_mfma_f32_16x16x32_bf16 a[24:27], a[80:83], a[56:59], a[24:27]
s_sub_u32 s74, 114688, s74
s_bitcmp1_b32 s85, 0
s_cselect_b32 s74, s74, 0
v_mfma_f32_16x16x32_bf16 a[24:27], a[144:147], a[120:123], a[24:27]
ds_read_b128 a[84:87], v11 offset:24576
v_mfma_f32_16x16x32_bf16 v[88:91], a[140:143], a[120:123], v[88:91]
s_bitcmp1_b32 s85, 1
s_cselect_b32 s75, s99, s98
s_add_u32 s74, s74, s75
v_mfma_f32_16x16x32_bf16 v[88:91], a[76:79], a[56:59], v[88:91]
ds_read_b128 a[80:83], v10 offset:22528
v_mfma_f32_16x16x32_bf16 a[8:11], a[72:75], a[56:59], a[8:11]
buffer_load_dword a185, v30, s[8:11], s74 offen
v_mfma_f32_16x16x32_bf16 a[8:11], a[136:139], a[120:123], a[8:11]
ds_read_b128 a[76:79], v10 offset:20480
v_mfma_f32_16x16x32_bf16 v[56:59], a[132:135], a[120:123], v[56:59]
v_mfma_f32_16x16x32_bf16 v[56:59], a[68:71], a[56:59], v[56:59]
ds_read_b128 a[72:75], v10 offset:18432
v_mfma_f32_16x16x32_bf16 v[60:63], a[132:135], a[124:127], v[60:63]
v_mfma_f32_16x16x32_bf16 v[176:179], a[136:139], a[124:127], v[176:179]
ds_read_b128 a[68:71], v10 offset:16384
v_mfma_f32_16x16x32_bf16 v[92:95], a[140:143], a[124:127], v[92:95]
v_mfma_f32_16x16x32_bf16 a[28:31], a[144:147], a[124:127], a[28:31]
ds_read_b64_tr_b16 a[56:57], v7 offset:0
v_mfma_f32_16x16x32_bf16 v[124:127], a[148:151], a[124:127], v[124:127]
v_mfma_f32_16x16x32_bf16 v[216:219], a[152:155], a[124:127], v[216:219]
ds_read_b64_tr_b16 a[58:59], v7 offset:1024
v_mfma_f32_16x16x32_bf16 v[156:159], a[156:159], a[124:127], v[156:159]
v_mfma_f32_16x16x32_bf16 v[248:251], a[160:163], a[124:127], v[248:251]
v_mfma_f32_16x16x32_bf16 v[252:255], a[160:163], a[128:131], v[252:255]
v_mfma_f32_16x16x32_bf16 v[160:163], a[156:159], a[128:131], v[160:163]
v_mfma_f32_16x16x32_bf16 v[220:223], a[152:155], a[128:131], v[220:223]
v_mfma_f32_16x16x32_bf16 v[128:131], a[148:151], a[128:131], v[128:131]
v_mfma_f32_16x16x32_bf16 a[32:35], a[144:147], a[128:131], a[32:35]
v_mfma_f32_16x16x32_bf16 v[96:99], a[140:143], a[128:131], v[96:99]
v_mfma_f32_16x16x32_bf16 a[12:15], a[136:139], a[128:131], a[12:15]
v_mfma_f32_16x16x32_bf16 v[64:67], a[132:135], a[128:131], v[64:67]
s_waitcnt lgkmcnt(2)
v_mfma_f32_16x16x32_bf16 v[64:67], a[68:71], a[64:67], v[64:67]
s_waitcnt vmcnt(20) lgkmcnt(0)
s_barrier
v_mfma_f32_16x16x32_bf16 a[12:15], a[72:75], a[64:67], a[12:15]
s_add_u32 m0, s96, 0
ds_read_b64_tr_b16 a[100:101], v2 offset:16384
v_mfma_f32_16x16x32_bf16 v[96:99], a[76:79], a[64:67], v[96:99]
ds_read_b64_tr_b16 a[102:103], v2 offset:17408
v_mfma_f32_16x16x32_bf16 a[32:35], a[80:83], a[64:67], a[32:35]
ds_read_b128 a[132:135], v12 offset:16384
v_mfma_f32_16x16x32_bf16 v[128:131], a[84:87], a[64:67], v[128:131]
ds_read_b128 a[136:139], v12 offset:18432
v_mfma_f32_16x16x32_bf16 v[220:223], a[88:91], a[64:67], v[220:223]
ds_read_b128 a[140:143], v12 offset:20480
v_mfma_f32_16x16x32_bf16 v[160:163], a[92:95], a[64:67], v[160:163]
ds_read_b128 a[144:147], v12 offset:22528
v_mfma_f32_16x16x32_bf16 v[252:255], a[96:99], a[64:67], v[252:255]
ds_read_b128 a[148:151], v13 offset:24576
v_mfma_f32_16x16x32_bf16 v[248:251], a[96:99], a[60:63], v[248:251]
ds_read_b128 a[152:155], v13 offset:26624
v_mfma_f32_16x16x32_bf16 v[156:159], a[92:95], a[60:63], v[156:159]
ds_read_b128 a[156:159], v13 offset:28672
v_mfma_f32_16x16x32_bf16 v[216:219], a[88:91], a[60:63], v[216:219]
ds_read_b128 a[160:163], v13 offset:30720
v_mfma_f32_16x16x32_bf16 v[124:127], a[84:87], a[60:63], v[124:127]
buffer_load_dwordx4 v14, s[12:15], s86 offen offset:0 lds
v_mfma_f32_16x16x32_bf16 a[28:31], a[80:83], a[60:63], a[28:31]
ds_read_b64_tr_b16 a[104:105], v3 offset:16384
v_mfma_f32_16x16x32_bf16 v[92:95], a[76:79], a[60:63], v[92:95]
v_mfma_f32_16x16x32_bf16 v[176:179], a[72:75], a[60:63], v[176:179]
ds_read_b64_tr_b16 a[106:107], v3 offset:17408
v_mfma_f32_16x16x32_bf16 v[60:63], a[68:71], a[60:63], v[60:63]
buffer_load_dwordx4 v15, s[12:15], s86 offen offset:1024 lds
v_mfma_f32_16x16x32_bf16 v[36:39], a[68:71], a[36:39], v[36:39]
s_waitcnt lgkmcnt(9)
ds_read_b64_tr_b16 a[108:109], v4 offset:16384
v_mfma_f32_16x16x32_bf16 v[36:39], a[132:135], a[100:103], v[36:39]
s_waitcnt lgkmcnt(9)
v_mfma_f32_16x16x32_bf16 v[164:167], a[136:139], a[100:103], v[164:167]
ds_read_b64_tr_b16 a[110:111], v4 offset:17408
v_mfma_f32_16x16x32_bf16 v[164:167], a[72:75], a[36:39], v[164:167]
buffer_load_dwordx4 v16, s[12:15], s86 offen offset:2048 lds
v_mfma_f32_16x16x32_bf16 v[68:71], a[76:79], a[36:39], v[68:71]
s_waitcnt lgkmcnt(9)
ds_read_b64_tr_b16 a[112:113], v5 offset:16384
v_mfma_f32_16x16x32_bf16 v[68:71], a[140:143], a[100:103], v[68:71]
s_waitcnt lgkmcnt(9)
v_mfma_f32_16x16x32_bf16 v[180:183], a[144:147], a[100:103], v[180:183]
ds_read_b64_tr_b16 a[114:115], v5 offset:17408
v_mfma_f32_16x16x32_bf16 v[180:183], a[80:83], a[36:39], v[180:183]
buffer_load_dwordx4 v17, s[12:15], s86 offen offset:3072 lds
v_mfma_f32_16x16x32_bf16 v[100:103], a[84:87], a[36:39], v[100:103]
s_waitcnt lgkmcnt(9)
s_add_u32 s86, s86, 0x40000
ds_read_b64_tr_b16 a[116:117], v6 offset:16384
v_mfma_f32_16x16x32_bf16 v[100:103], a[148:151], a[100:103], v[100:103]
s_waitcnt lgkmcnt(9)
s_and_b32 s86, s86, 0x3c0000
s_add_u32 m0, s97, 4096
s_add_u32 s74, s87, 32768
v_mfma_f32_16x16x32_bf16 v[192:195], a[152:155], a[100:103], v[192:195]
ds_read_b64_tr_b16 a[118:119], v6 offset:17408
v_mfma_f32_16x16x32_bf16 v[192:195], a[88:91], a[36:39], v[192:195]
buffer_load_dwordx4 v18, s[4:7], s74 offen offset:0 lds
v_mfma_f32_16x16x32_bf16 v[132:135], a[92:95], a[36:39], v[132:135]
s_waitcnt lgkmcnt(9)
ds_read_b64_tr_b16 a[120:121], v7 offset:16384
v_mfma_f32_16x16x32_bf16 v[132:135], a[156:159], a[100:103], v[132:135]
s_waitcnt lgkmcnt(9)
v_mfma_f32_16x16x32_bf16 v[224:227], a[160:163], a[100:103], v[224:227]
ds_read_b64_tr_b16 a[122:123], v7 offset:17408
v_mfma_f32_16x16x32_bf16 v[224:227], a[96:99], a[36:39], v[224:227]
buffer_load_dwordx4 v19, s[4:7], s74 offen offset:1024 lds
v_mfma_f32_16x16x32_bf16 v[228:231], a[96:99], a[40:43], v[228:231]
s_waitcnt lgkmcnt(8)
ds_read_b64_tr_b16 a[124:125], v8 offset:16384
v_mfma_f32_16x16x32_bf16 v[228:231], a[160:163], a[104:107], v[228:231]
v_mfma_f32_16x16x32_bf16 v[136:139], a[156:159], a[104:107], v[136:139]
ds_read_b64_tr_b16 a[126:127], v8 offset:17408
v_mfma_f32_16x16x32_bf16 v[136:139], a[92:95], a[40:43], v[136:139]
buffer_load_dwordx4 v20, s[4:7], s74 offen offset:2048 lds
v_mfma_f32_16x16x32_bf16 v[196:199], a[88:91], a[40:43], v[196:199]
ds_read_b64_tr_b16 a[128:129], v9 offset:16384
v_mfma_f32_16x16x32_bf16 v[196:199], a[152:155], a[104:107], v[196:199]
v_mfma_f32_16x16x32_bf16 v[104:107], a[148:151], a[104:107], v[104:107]
ds_read_b64_tr_b16 a[130:131], v9 offset:17408
v_mfma_f32_16x16x32_bf16 v[104:107], a[84:87], a[40:43], v[104:107]
buffer_load_dwordx4 v21, s[4:7], s74 offen offset:3072 lds
v_mfma_f32_16x16x32_bf16 a[16:19], a[80:83], a[40:43], a[16:19]
s_add_u32 s87, s87, 128
s_and_b32 s87, s87, 1023
v_mfma_f32_16x16x32_bf16 a[16:19], a[144:147], a[104:107], a[16:19]
v_mfma_f32_16x16x32_bf16 v[72:75], a[140:143], a[104:107], v[72:75]
v_mfma_f32_16x16x32_bf16 v[72:75], a[76:79], a[40:43], v[72:75]
buffer_store_dwordx4 a[164:167], v0, s[76:79], s38 offen sc1
v_mfma_f32_16x16x32_bf16 a[0:3], a[72:75], a[40:43], a[0:3]
s_add_u32 s38, s38, 1024
v_mfma_f32_16x16x32_bf16 a[0:3], a[136:139], a[104:107], a[0:3]
v_mfma_f32_16x16x32_bf16 v[40:43], a[132:135], a[104:107], v[40:43]
v_mfma_f32_16x16x32_bf16 v[40:43], a[68:71], a[40:43], v[40:43]
v_mfma_f32_16x16x32_bf16 v[44:47], a[68:71], a[44:47], v[44:47]
s_waitcnt lgkmcnt(10)
v_mfma_f32_16x16x32_bf16 v[44:47], a[132:135], a[108:111], v[44:47]
v_mfma_f32_16x16x32_bf16 v[168:171], a[136:139], a[108:111], v[168:171]
v_mfma_f32_16x16x32_bf16 v[168:171], a[72:75], a[44:47], v[168:171]
v_mfma_f32_16x16x32_bf16 v[76:79], a[76:79], a[44:47], v[76:79]
v_mfma_f32_16x16x32_bf16 v[76:79], a[140:143], a[108:111], v[76:79]
v_mfma_f32_16x16x32_bf16 v[184:187], a[144:147], a[108:111], v[184:187]
v_mfma_f32_16x16x32_bf16 v[184:187], a[80:83], a[44:47], v[184:187]
v_mfma_f32_16x16x32_bf16 v[108:111], a[84:87], a[44:47], v[108:111]
v_mfma_f32_16x16x32_bf16 v[108:111], a[148:151], a[108:111], v[108:111]
v_mfma_f32_16x16x32_bf16 v[200:203], a[152:155], a[108:111], v[200:203]
v_mfma_f32_16x16x32_bf16 v[200:203], a[88:91], a[44:47], v[200:203]
v_mfma_f32_16x16x32_bf16 v[140:143], a[92:95], a[44:47], v[140:143]
v_mfma_f32_16x16x32_bf16 v[140:143], a[156:159], a[108:111], v[140:143]
v_mfma_f32_16x16x32_bf16 v[232:235], a[160:163], a[108:111], v[232:235]
v_mfma_f32_16x16x32_bf16 v[232:235], a[96:99], a[44:47], v[232:235]
v_mfma_f32_16x16x32_bf16 v[236:239], a[96:99], a[48:51], v[236:239]
s_waitcnt vmcnt(19) lgkmcnt(0)
s_barrier
v_mfma_f32_16x16x32_bf16 v[236:239], a[160:163], a[112:115], v[236:239]
s_add_u32 m0, s96, 16384
ds_read_b64_tr_b16 a[64:65], v9 offset:32768
v_mfma_f32_16x16x32_bf16 v[144:147], a[156:159], a[112:115], v[144:147]
buffer_load_dwordx4 v14, s[12:15], s86 offen offset:0 lds
v_mfma_f32_16x16x32_bf16 v[144:147], a[92:95], a[48:51], v[144:147]
ds_read_b64_tr_b16 a[66:67], v9 offset:33792
v_mfma_f32_16x16x32_bf16 v[204:207], a[88:91], a[48:51], v[204:207]
v_mfma_f32_16x16x32_bf16 v[204:207], a[152:155], a[112:115], v[204:207]
ds_read_b64_tr_b16 a[60:61], v8 offset:32768
v_mfma_f32_16x16x32_bf16 v[112:115], a[148:151], a[112:115], v[112:115]
buffer_load_dwordx4 v15, s[12:15], s86 offen offset:1024 lds
v_mfma_f32_16x16x32_bf16 v[112:115], a[84:87], a[48:51], v[112:115]
ds_read_b64_tr_b16 a[62:63], v8 offset:33792
v_mfma_f32_16x16x32_bf16 a[20:23], a[80:83], a[48:51], a[20:23]
v_mfma_f32_16x16x32_bf16 a[20:23], a[144:147], a[112:115], a[20:23]
ds_read_b64_tr_b16 a[44:45], v4 offset:32768
v_mfma_f32_16x16x32_bf16 v[80:83], a[140:143], a[112:115], v[80:83]
buffer_load_dwordx4 v16, s[12:15], s86 offen offset:2048 lds
v_mfma_f32_16x16x32_bf16 v[80:83], a[76:79], a[48:51], v[80:83]
ds_read_b64_tr_b16 a[46:47], v4 offset:33792
v_mfma_f32_16x16x32_bf16 a[4:7], a[72:75], a[48:51], a[4:7]
v_mfma_f32_16x16x32_bf16 a[4:7], a[136:139], a[112:115], a[4:7]
ds_read_b64_tr_b16 a[40:41], v3 offset:32768
v_mfma_f32_16x16x32_bf16 v[48:51], a[132:135], a[112:115], v[48:51]
buffer_load_dwordx4 v17, s[12:15], s86 offen offset:3072 lds
v_mfma_f32_16x16x32_bf16 v[48:51], a[68:71], a[48:51], v[48:51]
s_add_u32 s86, s86, 0x40000
ds_read_b64_tr_b16 a[42:43], v3 offset:33792
v_mfma_f32_16x16x32_bf16 v[52:55], a[68:71], a[52:55], v[52:55]
s_and_b32 s86, s86, 0x3c0000
s_add_u32 m0, s97, 16384
s_add_u32 s74, s87, 0
v_mfma_f32_16x16x32_bf16 v[52:55], a[132:135], a[116:119], v[52:55]
ds_read_b64_tr_b16 a[36:37], v2 offset:32768
v_mfma_f32_16x16x32_bf16 v[172:175], a[136:139], a[116:119], v[172:175]
buffer_load_dwordx4 v18, s[4:7], s74 offen offset:0 lds
v_mfma_f32_16x16x32_bf16 v[172:175], a[72:75], a[52:55], v[172:175]
ds_read_b64_tr_b16 a[38:39], v2 offset:33792
v_mfma_f32_16x16x32_bf16 v[84:87], a[76:79], a[52:55], v[84:87]
v_mfma_f32_16x16x32_bf16 v[84:87], a[140:143], a[116:119], v[84:87]
ds_read_b64_tr_b16 a[48:49], v5 offset:32768
v_mfma_f32_16x16x32_bf16 v[188:191], a[144:147], a[116:119], v[188:191]
buffer_load_dwordx4 v19, s[4:7], s74 offen offset:1024 lds
v_mfma_f32_16x16x32_bf16 v[188:191], a[80:83], a[52:55], v[188:191]
ds_read_b64_tr_b16 a[50:51], v5 offset:33792
v_mfma_f32_16x16x32_bf16 v[116:119], a[84:87], a[52:55], v[116:119]
v_mfma_f32_16x16x32_bf16 v[116:119], a[148:151], a[116:119], v[116:119]
v_mfma_f32_16x16x32_bf16 v[208:211], a[152:155], a[116:119], v[208:211]
buffer_load_dwordx4 v20, s[4:7], s74 offen offset:2048 lds
v_mfma_f32_16x16x32_bf16 v[208:211], a[88:91], a[52:55], v[208:211]
v_mfma_f32_16x16x32_bf16 v[148:151], a[92:95], a[52:55], v[148:151]
v_mfma_f32_16x16x32_bf16 v[148:151], a[156:159], a[116:119], v[148:151]
v_mfma_f32_16x16x32_bf16 v[240:243], a[160:163], a[116:119], v[240:243]
buffer_load_dwordx4 v21, s[4:7], s74 offen offset:3072 lds
v_mfma_f32_16x16x32_bf16 v[240:243], a[96:99], a[52:55], v[240:243]
ds_read_b64_tr_b16 a[52:53], v6 offset:32768
v_mfma_f32_16x16x32_bf16 v[244:247], a[96:99], a[56:59], v[244:247]
v_mfma_f32_16x16x32_bf16 v[244:247], a[160:163], a[120:123], v[244:247]
ds_read_b64_tr_b16 a[54:55], v6 offset:33792
v_mfma_f32_16x16x32_bf16 v[152:155], a[156:159], a[120:123], v[152:155]
buffer_store_dwordx4 a[164:167], v0, s[76:79], s38 offen sc1
v_mfma_f32_16x16x32_bf16 v[152:155], a[92:95], a[56:59], v[152:155]
s_add_u32 s38, s38, 1024
ds_read_b128 a[96:99], v11 offset:47104
v_mfma_f32_16x16x32_bf16 v[212:215], a[88:91], a[56:59], v[212:215]
v_lshrrev_b32 v30, 5, v0
v_and_b32 v31, 16, v0
v_mfma_f32_16x16x32_bf16 v[212:215], a[152:155], a[120:123], v[212:215]
ds_read_b128 a[92:95], v11 offset:45056
v_lshlrev_b32 v31, 2, v31
v_mfma_f32_16x16x32_bf16 v[120:123], a[148:151], a[120:123], v[120:123]
v_lshl_or_b32 v30, v30, 10, v31
v_mfma_f32_16x16x32_bf16 v[120:123], a[84:87], a[56:59], v[120:123]
ds_read_b128 a[88:91], v11 offset:43008
v_mfma_f32_16x16x32_bf16 a[24:27], a[80:83], a[56:59], a[24:27]
buffer_load_dword a187, v30, s[28:31], s83 offen
v_mfma_f32_16x16x32_bf16 a[24:27], a[144:147], a[120:123], a[24:27]
ds_read_b128 a[84:87], v11 offset:40960
v_mfma_f32_16x16x32_bf16 v[88:91], a[140:143], a[120:123], v[88:91]
v_mfma_f32_16x16x32_bf16 v[88:91], a[76:79], a[56:59], v[88:91]
ds_read_b128 a[80:83], v10 offset:38912
v_mfma_f32_16x16x32_bf16 a[8:11], a[72:75], a[56:59], a[8:11]
v_mfma_f32_16x16x32_bf16 a[8:11], a[136:139], a[120:123], a[8:11]
ds_read_b128 a[76:79], v10 offset:36864
v_mfma_f32_16x16x32_bf16 v[56:59], a[132:135], a[120:123], v[56:59]
v_mfma_f32_16x16x32_bf16 v[56:59], a[68:71], a[56:59], v[56:59]
ds_read_b128 a[72:75], v10 offset:34816
v_mfma_f32_16x16x32_bf16 v[60:63], a[132:135], a[124:127], v[60:63]
v_mfma_f32_16x16x32_bf16 v[176:179], a[136:139], a[124:127], v[176:179]
ds_read_b128 a[68:71], v10 offset:32768
v_mfma_f32_16x16x32_bf16 v[92:95], a[140:143], a[124:127], v[92:95]
v_mfma_f32_16x16x32_bf16 a[28:31], a[144:147], a[124:127], a[28:31]
ds_read_b64_tr_b16 a[56:57], v7 offset:32768
v_mfma_f32_16x16x32_bf16 v[124:127], a[148:151], a[124:127], v[124:127]
v_mfma_f32_16x16x32_bf16 v[216:219], a[152:155], a[124:127], v[216:219]
ds_read_b64_tr_b16 a[58:59], v7 offset:33792
v_mfma_f32_16x16x32_bf16 v[156:159], a[156:159], a[124:127], v[156:159]
v_mfma_f32_16x16x32_bf16 v[248:251], a[160:163], a[124:127], v[248:251]
v_mfma_f32_16x16x32_bf16 v[252:255], a[160:163], a[128:131], v[252:255]
v_mfma_f32_16x16x32_bf16 v[160:163], a[156:159], a[128:131], v[160:163]
v_mfma_f32_16x16x32_bf16 v[220:223], a[152:155], a[128:131], v[220:223]
v_mfma_f32_16x16x32_bf16 v[128:131], a[148:151], a[128:131], v[128:131]
v_mfma_f32_16x16x32_bf16 a[32:35], a[144:147], a[128:131], a[32:35]
v_mfma_f32_16x16x32_bf16 v[96:99], a[140:143], a[128:131], v[96:99]
v_mfma_f32_16x16x32_bf16 a[12:15], a[136:139], a[128:131], a[12:15]
v_mfma_f32_16x16x32_bf16 v[64:67], a[132:135], a[128:131], v[64:67]
s_waitcnt lgkmcnt(2)
v_mfma_f32_16x16x32_bf16 v[64:67], a[68:71], a[64:67], v[64:67]
s_waitcnt vmcnt(19) lgkmcnt(0)
s_barrier
v_mfma_f32_16x16x32_bf16 a[12:15], a[72:75], a[64:67], a[12:15]
s_add_u32 m0, s96, 32768
ds_read_b64_tr_b16 a[100:101], v2 offset:49152
v_mfma_f32_16x16x32_bf16 v[96:99], a[76:79], a[64:67], v[96:99]
ds_read_b64_tr_b16 a[102:103], v2 offset:50176
v_mfma_f32_16x16x32_bf16 a[32:35], a[80:83], a[64:67], a[32:35]
ds_read_b128 a[132:135], v12 offset:32768
v_mfma_f32_16x16x32_bf16 v[128:131], a[84:87], a[64:67], v[128:131]
ds_read_b128 a[136:139], v12 offset:34816
v_mfma_f32_16x16x32_bf16 v[220:223], a[88:91], a[64:67], v[220:223]
ds_read_b128 a[140:143], v12 offset:36864
v_mfma_f32_16x16x32_bf16 v[160:163], a[92:95], a[64:67], v[160:163]
ds_read_b128 a[144:147], v12 offset:38912
v_mfma_f32_16x16x32_bf16 v[252:255], a[96:99], a[64:67], v[252:255]
ds_read_b128 a[148:151], v13 offset:40960
v_mfma_f32_16x16x32_bf16 v[248:251], a[96:99], a[60:63], v[248:251]
ds_read_b128 a[152:155], v13 offset:43008
v_mfma_f32_16x16x32_bf16 v[156:159], a[92:95], a[60:63], v[156:159]
ds_read_b128 a[156:159], v13 offset:45056
v_mfma_f32_16x16x32_bf16 v[216:219], a[88:91], a[60:63], v[216:219]
ds_read_b128 a[160:163], v13 offset:47104
v_mfma_f32_16x16x32_bf16 v[124:127], a[84:87], a[60:63], v[124:127]
buffer_load_dwordx4 v14, s[12:15], s86 offen offset:0 lds
v_mfma_f32_16x16x32_bf16 a[28:31], a[80:83], a[60:63], a[28:31]
ds_read_b64_tr_b16 a[104:105], v3 offset:49152
v_mfma_f32_16x16x32_bf16 v[92:95], a[76:79], a[60:63], v[92:95]
v_mfma_f32_16x16x32_bf16 v[176:179], a[72:75], a[60:63], v[176:179]
ds_read_b64_tr_b16 a[106:107], v3 offset:50176
v_mfma_f32_16x16x32_bf16 v[60:63], a[68:71], a[60:63], v[60:63]
buffer_load_dwordx4 v15, s[12:15], s86 offen offset:1024 lds
v_mfma_f32_16x16x32_bf16 v[36:39], a[68:71], a[36:39], v[36:39]
s_waitcnt lgkmcnt(9)
ds_read_b64_tr_b16 a[108:109], v4 offset:49152
v_mfma_f32_16x16x32_bf16 v[36:39], a[132:135], a[100:103], v[36:39]
s_waitcnt lgkmcnt(9)
v_mfma_f32_16x16x32_bf16 v[164:167], a[136:139], a[100:103], v[164:167]
ds_read_b64_tr_b16 a[110:111], v4 offset:50176
v_mfma_f32_16x16x32_bf16 v[164:167], a[72:75], a[36:39], v[164:167]
buffer_load_dwordx4 v16, s[12:15], s86 offen offset:2048 lds
v_mfma_f32_16x16x32_bf16 v[68:71], a[76:79], a[36:39], v[68:71]
s_waitcnt lgkmcnt(9)
ds_read_b64_tr_b16 a[112:113], v5 offset:49152
v_mfma_f32_16x16x32_bf16 v[68:71], a[140:143], a[100:103], v[68:71]
s_waitcnt lgkmcnt(9)
v_mfma_f32_16x16x32_bf16 v[180:183], a[144:147], a[100:103], v[180:183]
ds_read_b64_tr_b16 a[114:115], v5 offset:50176
v_mfma_f32_16x16x32_bf16 v[180:183], a[80:83], a[36:39], v[180:183]
buffer_load_dwordx4 v17, s[12:15], s86 offen offset:3072 lds
v_mfma_f32_16x16x32_bf16 v[100:103], a[84:87], a[36:39], v[100:103]
s_waitcnt lgkmcnt(9)
s_add_u32 s86, s86, 0x40000
ds_read_b64_tr_b16 a[116:117], v6 offset:49152
v_mfma_f32_16x16x32_bf16 v[100:103], a[148:151], a[100:103], v[100:103]
s_waitcnt lgkmcnt(9)
s_and_b32 s86, s86, 0x3c0000
s_add_u32 m0, s97, 20480
s_add_u32 s74, s87, 32768
v_mfma_f32_16x16x32_bf16 v[192:195], a[152:155], a[100:103], v[192:195]
ds_read_b64_tr_b16 a[118:119], v6 offset:50176
v_mfma_f32_16x16x32_bf16 v[192:195], a[88:91], a[36:39], v[192:195]
buffer_load_dwordx4 v18, s[4:7], s74 offen offset:0 lds
v_mfma_f32_16x16x32_bf16 v[132:135], a[92:95], a[36:39], v[132:135]
s_waitcnt lgkmcnt(9)
ds_read_b64_tr_b16 a[120:121], v7 offset:49152
v_mfma_f32_16x16x32_bf16 v[132:135], a[156:159], a[100:103], v[132:135]
s_waitcnt lgkmcnt(9)
v_mfma_f32_16x16x32_bf16 v[224:227], a[160:163], a[100:103], v[224:227]
ds_read_b64_tr_b16 a[122:123], v7 offset:50176
v_mfma_f32_16x16x32_bf16 v[224:227], a[96:99], a[36:39], v[224:227]
buffer_load_dwordx4 v19, s[4:7], s74 offen offset:1024 lds
v_mfma_f32_16x16x32_bf16 v[228:231], a[96:99], a[40:43], v[228:231]
s_waitcnt lgkmcnt(8)
ds_read_b64_tr_b16 a[124:125], v8 offset:49152
v_mfma_f32_16x16x32_bf16 v[228:231], a[160:163], a[104:107], v[228:231]
v_mfma_f32_16x16x32_bf16 v[136:139], a[156:159], a[104:107], v[136:139]
ds_read_b64_tr_b16 a[126:127], v8 offset:50176
v_mfma_f32_16x16x32_bf16 v[136:139], a[92:95], a[40:43], v[136:139]
buffer_load_dwordx4 v20, s[4:7], s74 offen offset:2048 lds
v_mfma_f32_16x16x32_bf16 v[196:199], a[88:91], a[40:43], v[196:199]
ds_read_b64_tr_b16 a[128:129], v9 offset:49152
v_mfma_f32_16x16x32_bf16 v[196:199], a[152:155], a[104:107], v[196:199]
v_mfma_f32_16x16x32_bf16 v[104:107], a[148:151], a[104:107], v[104:107]
ds_read_b64_tr_b16 a[130:131], v9 offset:50176
v_mfma_f32_16x16x32_bf16 v[104:107], a[84:87], a[40:43], v[104:107]
buffer_load_dwordx4 v21, s[4:7], s74 offen offset:3072 lds
v_mfma_f32_16x16x32_bf16 a[16:19], a[80:83], a[40:43], a[16:19]
s_add_u32 s87, s87, 128
s_and_b32 s87, s87, 1023
v_mfma_f32_16x16x32_bf16 a[16:19], a[144:147], a[104:107], a[16:19]
v_mfma_f32_16x16x32_bf16 v[72:75], a[140:143], a[104:107], v[72:75]
v_mfma_f32_16x16x32_bf16 v[72:75], a[76:79], a[40:43], v[72:75]
buffer_store_dwordx4 a[164:167], v0, s[76:79], s38 offen sc1
v_mfma_f32_16x16x32_bf16 a[0:3], a[72:75], a[40:43], a[0:3]
s_add_u32 s38, s38, 1024
v_mfma_f32_16x16x32_bf16 a[0:3], a[136:139], a[104:107], a[0:3]
v_mfma_f32_16x16x32_bf16 v[40:43], a[132:135], a[104:107], v[40:43]
v_mfma_f32_16x16x32_bf16 v[40:43], a[68:71], a[40:43], v[40:43]
v_mfma_f32_16x16x32_bf16 v[44:47], a[68:71], a[44:47], v[44:47]
s_waitcnt lgkmcnt(10)
v_mfma_f32_16x16x32_bf16 v[44:47], a[132:135], a[108:111], v[44:47]
v_mfma_f32_16x16x32_bf16 v[168:171], a[136:139], a[108:111], v[168:171]
v_mfma_f32_16x16x32_bf16 v[168:171], a[72:75], a[44:47], v[168:171]
v_mfma_f32_16x16x32_bf16 v[76:79], a[76:79], a[44:47], v[76:79]
v_mfma_f32_16x16x32_bf16 v[76:79], a[140:143], a[108:111], v[76:79]
v_mfma_f32_16x16x32_bf16 v[184:187], a[144:147], a[108:111], v[184:187]
v_mfma_f32_16x16x32_bf16 v[184:187], a[80:83], a[44:47], v[184:187]
v_mfma_f32_16x16x32_bf16 v[108:111], a[84:87], a[44:47], v[108:111]
v_mfma_f32_16x16x32_bf16 v[108:111], a[148:151], a[108:111], v[108:111]
v_mfma_f32_16x16x32_bf16 v[200:203], a[152:155], a[108:111], v[200:203]
v_mfma_f32_16x16x32_bf16 v[200:203], a[88:91], a[44:47], v[200:203]
v_mfma_f32_16x16x32_bf16 v[140:143], a[92:95], a[44:47], v[140:143]
v_mfma_f32_16x16x32_bf16 v[140:143], a[156:159], a[108:111], v[140:143]
v_mfma_f32_16x16x32_bf16 v[232:235], a[160:163], a[108:111], v[232:235]
v_mfma_f32_16x16x32_bf16 v[232:235], a[96:99], a[44:47], v[232:235]
v_mfma_f32_16x16x32_bf16 v[236:239], a[96:99], a[48:51], v[236:239]
s_waitcnt vmcnt(19) lgkmcnt(0)
s_barrier
v_mfma_f32_16x16x32_bf16 v[236:239], a[160:163], a[112:115], v[236:239]
s_add_u32 m0, s96, 49152
ds_read_b64_tr_b16 a[64:65], v9 offset:0
v_mfma_f32_16x16x32_bf16 v[144:147], a[156:159], a[112:115], v[144:147]
buffer_load_dwordx4 v14, s[12:15], s86 offen offset:0 lds
v_mfma_f32_16x16x32_bf16 v[144:147], a[92:95], a[48:51], v[144:147]
ds_read_b64_tr_b16 a[66:67], v9 offset:1024
v_mfma_f32_16x16x32_bf16 v[204:207], a[88:91], a[48:51], v[204:207]
v_mfma_f32_16x16x32_bf16 v[204:207], a[152:155], a[112:115], v[204:207]
ds_read_b64_tr_b16 a[60:61], v8 offset:0
v_mfma_f32_16x16x32_bf16 v[112:115], a[148:151], a[112:115], v[112:115]
buffer_load_dwordx4 v15, s[12:15], s86 offen offset:1024 lds
v_mfma_f32_16x16x32_bf16 v[112:115], a[84:87], a[48:51], v[112:115]
ds_read_b64_tr_b16 a[62:63], v8 offset:1024
v_mfma_f32_16x16x32_bf16 a[20:23], a[80:83], a[48:51], a[20:23]
v_mfma_f32_16x16x32_bf16 a[20:23], a[144:147], a[112:115], a[20:23]
ds_read_b64_tr_b16 a[44:45], v4 offset:0
v_mfma_f32_16x16x32_bf16 v[80:83], a[140:143], a[112:115], v[80:83]
buffer_load_dwordx4 v16, s[12:15], s86 offen offset:2048 lds
v_mfma_f32_16x16x32_bf16 v[80:83], a[76:79], a[48:51], v[80:83]
ds_read_b64_tr_b16 a[46:47], v4 offset:1024
v_mfma_f32_16x16x32_bf16 a[4:7], a[72:75], a[48:51], a[4:7]
v_mfma_f32_16x16x32_bf16 a[4:7], a[136:139], a[112:115], a[4:7]
ds_read_b64_tr_b16 a[40:41], v3 offset:0
v_mfma_f32_16x16x32_bf16 v[48:51], a[132:135], a[112:115], v[48:51]
buffer_load_dwordx4 v17, s[12:15], s86 offen offset:3072 lds
v_mfma_f32_16x16x32_bf16 v[48:51], a[68:71], a[48:51], v[48:51]
s_add_u32 s86, s86, 0x40000
ds_read_b64_tr_b16 a[42:43], v3 offset:1024
v_mfma_f32_16x16x32_bf16 v[52:55], a[68:71], a[52:55], v[52:55]
s_and_b32 s86, s86, 0x3c0000
s_add_u32 m0, s97, 32768
s_add_u32 s74, s87, s98
v_mfma_f32_16x16x32_bf16 v[52:55], a[132:135], a[116:119], v[52:55]
ds_read_b64_tr_b16 a[36:37], v2 offset:0
v_mfma_f32_16x16x32_bf16 v[172:175], a[136:139], a[116:119], v[172:175]
buffer_load_dwordx4 v18, s[8:11], s74 offen offset:0 lds
v_mfma_f32_16x16x32_bf16 v[172:175], a[72:75], a[52:55], v[172:175]
ds_read_b64_tr_b16 a[38:39], v2 offset:1024
v_mfma_f32_16x16x32_bf16 v[84:87], a[76:79], a[52:55], v[84:87]
v_mfma_f32_16x16x32_bf16 v[84:87], a[140:143], a[116:119], v[84:87]
ds_read_b64_tr_b16 a[48:49], v5 offset:0
v_mfma_f32_16x16x32_bf16 v[188:191], a[144:147], a[116:119], v[188:191]
buffer_load_dwordx4 v19, s[8:11], s74 offen offset:1024 lds
v_mfma_f32_16x16x32_bf16 v[188:191], a[80:83], a[52:55], v[188:191]
ds_read_b64_tr_b16 a[50:51], v5 offset:1024
v_mfma_f32_16x16x32_bf16 v[116:119], a[84:87], a[52:55], v[116:119]
v_mfma_f32_16x16x32_bf16 v[116:119], a[148:151], a[116:119], v[116:119]
v_mfma_f32_16x16x32_bf16 v[208:211], a[152:155], a[116:119], v[208:211]
buffer_load_dwordx4 v22, s[8:11], s74 offen offset:2048 lds
v_mfma_f32_16x16x32_bf16 v[208:211], a[88:91], a[52:55], v[208:211]
v_mfma_f32_16x16x32_bf16 v[148:151], a[92:95], a[52:55], v[148:151]
v_mfma_f32_16x16x32_bf16 v[148:151], a[156:159], a[116:119], v[148:151]
v_mfma_f32_16x16x32_bf16 v[240:243], a[160:163], a[116:119], v[240:243]
buffer_load_dwordx4 v23, s[8:11], s74 offen offset:3072 lds
v_mfma_f32_16x16x32_bf16 v[240:243], a[96:99], a[52:55], v[240:243]
ds_read_b64_tr_b16 a[52:53], v6 offset:0
v_mfma_f32_16x16x32_bf16 v[244:247], a[96:99], a[56:59], v[244:247]
v_mfma_f32_16x16x32_bf16 v[244:247], a[160:163], a[120:123], v[244:247]
ds_read_b64_tr_b16 a[54:55], v6 offset:1024
v_mfma_f32_16x16x32_bf16 v[152:155], a[156:159], a[120:123], v[152:155]
buffer_store_dwordx4 a[164:167], v0, s[76:79], s38 offen sc1
v_mfma_f32_16x16x32_bf16 v[152:155], a[92:95], a[56:59], v[152:155]
s_add_u32 s38, s38, 1024
ds_read_b128 a[96:99], v11 offset:14336
v_mfma_f32_16x16x32_bf16 v[212:215], a[88:91], a[56:59], v[212:215]
v_xor_b32 v30, 64, v28
v_xor_b32 v31, 96, v28
v_mfma_f32_16x16x32_bf16 v[212:215], a[152:155], a[120:123], v[212:215]
ds_read_b128 a[92:95], v11 offset:12288
v_mfma_f32_16x16x32_bf16 v[120:123], a[148:151], a[120:123], v[120:123]
v_mfma_f32_16x16x32_bf16 v[120:123], a[84:87], a[56:59], v[120:123]
ds_read_b128 a[88:91], v11 offset:10240
v_mfma_f32_16x16x32_bf16 a[24:27], a[80:83], a[56:59], a[24:27]
v_mfma_f32_16x16x32_bf16 a[24:27], a[144:147], a[120:123], a[24:27]
ds_read_b128 a[84:87], v11 offset:8192
v_mfma_f32_16x16x32_bf16 v[88:91], a[140:143], a[120:123], v[88:91]
v_mfma_f32_16x16x32_bf16 v[88:91], a[76:79], a[56:59], v[88:91]
ds_read_b128 a[80:83], v10 offset:6144
v_mfma_f32_16x16x32_bf16 a[8:11], a[72:75], a[56:59], a[8:11]
v_mfma_f32_16x16x32_bf16 a[8:11], a[136:139], a[120:123], a[8:11]
ds_read_b128 a[76:79], v10 offset:4096
v_mfma_f32_16x16x32_bf16 v[56:59], a[132:135], a[120:123], v[56:59]
v_mfma_f32_16x16x32_bf16 v[56:59], a[68:71], a[56:59], v[56:59]
ds_read_b128 a[72:75], v10 offset:2048
v_mfma_f32_16x16x32_bf16 v[60:63], a[132:135], a[124:127], v[60:63]
v_mfma_f32_16x16x32_bf16 v[176:179], a[136:139], a[124:127], v[176:179]
ds_read_b128 a[68:71], v10 offset:0
v_mfma_f32_16x16x32_bf16 v[92:95], a[140:143], a[124:127], v[92:95]
v_mfma_f32_16x16x32_bf16 a[28:31], a[144:147], a[124:127], a[28:31]
ds_read_b64_tr_b16 a[56:57], v7 offset:0
v_mfma_f32_16x16x32_bf16 v[124:127], a[148:151], a[124:127], v[124:127]
v_mfma_f32_16x16x32_bf16 v[216:219], a[152:155], a[124:127], v[216:219]
ds_read_b64_tr_b16 a[58:59], v7 offset:1024
v_mfma_f32_16x16x32_bf16 v[156:159], a[156:159], a[124:127], v[156:159]
v_mfma_f32_16x16x32_bf16 v[248:251], a[160:163], a[124:127], v[248:251]
v_mfma_f32_16x16x32_bf16 v[252:255], a[160:163], a[128:131], v[252:255]
v_mfma_f32_16x16x32_bf16 v[160:163], a[156:159], a[128:131], v[160:163]
v_mfma_f32_16x16x32_bf16 v[220:223], a[152:155], a[128:131], v[220:223]
v_mfma_f32_16x16x32_bf16 v[128:131], a[148:151], a[128:131], v[128:131]
v_mfma_f32_16x16x32_bf16 a[32:35], a[144:147], a[128:131], a[32:35]
v_mfma_f32_16x16x32_bf16 v[96:99], a[140:143], a[128:131], v[96:99]
v_mfma_f32_16x16x32_bf16 a[12:15], a[136:139], a[128:131], a[12:15]
v_mfma_f32_16x16x32_bf16 v[64:67], a[132:135], a[128:131], v[64:67]
s_waitcnt lgkmcnt(2)
v_mfma_f32_16x16x32_bf16 v[64:67], a[68:71], a[64:67], v[64:67]
s_waitcnt vmcnt(18) lgkmcnt(0)
s_barrier
v_mfma_f32_16x16x32_bf16 a[12:15], a[72:75], a[64:67], a[12:15]
s_add_u32 m0, s101, 0
ds_read_b64_tr_b16 a[100:101], v2 offset:16384
v_mfma_f32_16x16x32_bf16 v[96:99], a[76:79], a[64:67], v[96:99]
s_add_u32 s75, s83, 0
ds_read_b64_tr_b16 a[102:103], v2 offset:17408
v_mfma_f32_16x16x32_bf16 a[32:35], a[80:83], a[64:67], a[32:35]
s_and_b32 s75, s75, 1023
ds_read_b128 a[132:135], v12 offset:0
v_mfma_f32_16x16x32_bf16 v[128:131], a[84:87], a[64:67], v[128:131]
ds_read_b128 a[136:139], v12 offset:2048
v_mfma_f32_16x16x32_bf16 v[220:223], a[88:91], a[64:67], v[220:223]
ds_read_b128 a[140:143], v12 offset:4096
v_mfma_f32_16x16x32_bf16 v[160:163], a[92:95], a[64:67], v[160:163]
ds_read_b128 a[144:147], v12 offset:6144
v_mfma_f32_16x16x32_bf16 v[252:255], a[96:99], a[64:67], v[252:255]
ds_read_b128 a[148:151], v13 offset:8192
v_mfma_f32_16x16x32_bf16 v[248:251], a[96:99], a[60:63], v[248:251]
ds_read_b128 a[152:155], v13 offset:10240
v_mfma_f32_16x16x32_bf16 v[156:159], a[92:95], a[60:63], v[156:159]
ds_read_b128 a[156:159], v13 offset:12288
v_mfma_f32_16x16x32_bf16 v[216:219], a[88:91], a[60:63], v[216:219]
ds_read_b128 a[160:163], v13 offset:14336
v_mfma_f32_16x16x32_bf16 v[124:127], a[84:87], a[60:63], v[124:127]
buffer_load_dwordx4 v24, s[28:31], s75 offen lds
v_mfma_f32_16x16x32_bf16 a[28:31], a[80:83], a[60:63], a[28:31]
s_add_u32 m0, s101, 2048
ds_read_b64_tr_b16 a[104:105], v3 offset:16384
v_mfma_f32_16x16x32_bf16 v[92:95], a[76:79], a[60:63], v[92:95]
s_add_u32 s75, s83, 64
s_and_b32 s75, s75, 1023
v_mfma_f32_16x16x32_bf16 v[176:179], a[72:75], a[60:63], v[176:179]
ds_read_b64_tr_b16 a[106:107], v3 offset:17408
v_mfma_f32_16x16x32_bf16 v[60:63], a[68:71], a[60:63], v[60:63]
buffer_load_dwordx4 v24, s[28:31], s75 offen lds
v_mfma_f32_16x16x32_bf16 v[36:39], a[68:71], a[36:39], v[36:39]
s_waitcnt lgkmcnt(9)
s_add_u32 m0, s101, 4096
ds_read_b64_tr_b16 a[108:109], v4 offset:16384
v_mfma_f32_16x16x32_bf16 v[36:39], a[132:135], a[100:103], v[36:39]
s_waitcnt lgkmcnt(9)
s_add_u32 s75, s83, 128
s_and_b32 s75, s75, 1023
v_mfma_f32_16x16x32_bf16 v[164:167], a[136:139], a[100:103], v[164:167]
ds_read_b64_tr_b16 a[110:111], v4 offset:17408
v_mfma_f32_16x16x32_bf16 v[164:167], a[72:75], a[36:39], v[164:167]
buffer_load_dwordx4 v24, s[28:31], s75 offen lds
v_mfma_f32_16x16x32_bf16 v[68:71], a[76:79], a[36:39], v[68:71]
s_waitcnt lgkmcnt(9)
s_add_u32 m0, s101, 6144
ds_read_b64_tr_b16 a[112:113], v5 offset:16384
v_mfma_f32_16x16x32_bf16 v[68:71], a[140:143], a[100:103], v[68:71]
s_waitcnt lgkmcnt(9)
s_add_u32 s75, s83, 192
s_and_b32 s75, s75, 1023
v_mfma_f32_16x16x32_bf16 v[180:183], a[144:147], a[100:103], v[180:183]
ds_read_b64_tr_b16 a[114:115], v5 offset:17408
v_mfma_f32_16x16x32_bf16 v[180:183], a[80:83], a[36:39], v[180:183]
buffer_load_dwordx4 v24, s[28:31], s75 offen lds
v_mfma_f32_16x16x32_bf16 v[100:103], a[84:87], a[36:39], v[100:103]
s_waitcnt lgkmcnt(9)
s_add_u32 s86, s86, 0x40000
ds_read_b64_tr_b16 a[116:117], v6 offset:16384
v_mfma_f32_16x16x32_bf16 v[100:103], a[148:151], a[100:103], v[100:103]
s_waitcnt lgkmcnt(9)
s_and_b32 s86, s86, 0x3c0000
s_add_u32 m0, s97, 36864
s_add_u32 s74, s87, s99
v_mfma_f32_16x16x32_bf16 v[192:195], a[152:155], a[100:103], v[192:195]
ds_read_b64_tr_b16 a[118:119], v6 offset:17408
v_mfma_f32_16x16x32_bf16 v[192:195], a[88:91], a[36:39], v[192:195]
buffer_load_dwordx4 v18, s[8:11], s74 offen offset:0 lds
v_mfma_f32_16x16x32_bf16 v[132:135], a[92:95], a[36:39], v[132:135]
s_waitcnt lgkmcnt(9)
ds_read_b64_tr_b16 a[120:121], v7 offset:16384
v_mfma_f32_16x16x32_bf16 v[132:135], a[156:159], a[100:103], v[132:135]
s_waitcnt lgkmcnt(9)
v_mfma_f32_16x16x32_bf16 v[224:227], a[160:163], a[100:103], v[224:227]
ds_read_b64_tr_b16 a[122:123], v7 offset:17408
v_mfma_f32_16x16x32_bf16 v[224:227], a[96:99], a[36:39], v[224:227]
buffer_load_dwordx4 v19, s[8:11], s74 offen offset:1024 lds
v_mfma_f32_16x16x32_bf16 v[228:231], a[96:99], a[40:43], v[228:231]
s_waitcnt lgkmcnt(8)
ds_read_b64_tr_b16 a[124:125], v8 offset:16384
v_mfma_f32_16x16x32_bf16 v[228:231], a[160:163], a[104:107], v[228:231]
v_mfma_f32_16x16x32_bf16 v[136:139], a[156:159], a[104:107], v[136:139]
ds_read_b64_tr_b16 a[126:127], v8 offset:17408
v_mfma_f32_16x16x32_bf16 v[136:139], a[92:95], a[40:43], v[136:139]
buffer_load_dwordx4 v22, s[8:11], s74 offen offset:2048 lds
v_mfma_f32_16x16x32_bf16 v[196:199], a[88:91], a[40:43], v[196:199]
ds_read_b64_tr_b16 a[128:129], v9 offset:16384
v_mfma_f32_16x16x32_bf16 v[196:199], a[152:155], a[104:107], v[196:199]
v_mfma_f32_16x16x32_bf16 v[104:107], a[148:151], a[104:107], v[104:107]
ds_read_b64_tr_b16 a[130:131], v9 offset:17408
v_mfma_f32_16x16x32_bf16 v[104:107], a[84:87], a[40:43], v[104:107]
buffer_load_dwordx4 v23, s[8:11], s74 offen offset:3072 lds
v_mfma_f32_16x16x32_bf16 a[16:19], a[80:83], a[40:43], a[16:19]
s_add_u32 s87, s87, 128
s_and_b32 s87, s87, 1023
v_mfma_f32_16x16x32_bf16 a[16:19], a[144:147], a[104:107], a[16:19]
v_mfma_f32_16x16x32_bf16 v[72:75], a[140:143], a[104:107], v[72:75]
v_mfma_f32_16x16x32_bf16 v[72:75], a[76:79], a[40:43], v[72:75]
buffer_store_dwordx4 a[164:167], v0, s[76:79], s38 offen sc1
v_mfma_f32_16x16x32_bf16 a[0:3], a[72:75], a[40:43], a[0:3]
s_add_u32 s38, s38, 1024
v_mfma_f32_16x16x32_bf16 a[0:3], a[136:139], a[104:107], a[0:3]
v_mfma_f32_16x16x32_bf16 v[40:43], a[132:135], a[104:107], v[40:43]
v_mfma_f32_16x16x32_bf16 v[40:43], a[68:71], a[40:43], v[40:43]
v_mfma_f32_16x16x32_bf16 v[44:47], a[68:71], a[44:47], v[44:47]
s_waitcnt lgkmcnt(10)
v_mfma_f32_16x16x32_bf16 v[44:47], a[132:135], a[108:111], v[44:47]
v_mfma_f32_16x16x32_bf16 v[168:171], a[136:139], a[108:111], v[168:171]
v_mfma_f32_16x16x32_bf16 v[168:171], a[72:75], a[44:47], v[168:171]
v_mfma_f32_16x16x32_bf16 v[76:79], a[76:79], a[44:47], v[76:79]
v_mfma_f32_16x16x32_bf16 v[76:79], a[140:143], a[108:111], v[76:79]
v_mfma_f32_16x16x32_bf16 v[184:187], a[144:147], a[108:111], v[184:187]
v_mfma_f32_16x16x32_bf16 v[184:187], a[80:83], a[44:47], v[184:187]
v_mfma_f32_16x16x32_bf16 v[108:111], a[84:87], a[44:47], v[108:111]
v_mfma_f32_16x16x32_bf16 v[108:111], a[148:151], a[108:111], v[108:111]
v_mfma_f32_16x16x32_bf16 v[200:203], a[152:155], a[108:111], v[200:203]
v_mfma_f32_16x16x32_bf16 v[200:203], a[88:91], a[44:47], v[200:203]
v_mfma_f32_16x16x32_bf16 v[140:143], a[92:95], a[44:47], v[140:143]
v_mfma_f32_16x16x32_bf16 v[140:143], a[156:159], a[108:111], v[140:143]
v_mfma_f32_16x16x32_bf16 v[232:235], a[160:163], a[108:111], v[232:235]
v_mfma_f32_16x16x32_bf16 v[232:235], a[96:99], a[44:47], v[232:235]
v_mfma_f32_16x16x32_bf16 v[236:239], a[96:99], a[48:51], v[236:239]
s_waitcnt vmcnt(18) lgkmcnt(0)
s_barrier
v_mfma_f32_16x16x32_bf16 v[236:239], a[160:163], a[112:115], v[236:239]
s_add_u32 m0, s101, 16384
ds_read_b64_tr_b16 a[64:65], v9 offset:32768
v_mfma_f32_16x16x32_bf16 v[144:147], a[156:159], a[112:115], v[144:147]
s_add_u32 s75, s83, 256
s_and_b32 s75, s75, 1023
v_mfma_f32_16x16x32_bf16 v[144:147], a[92:95], a[48:51], v[144:147]
ds_read_b64_tr_b16 a[66:67], v9 offset:33792
v_mfma_f32_16x16x32_bf16 v[204:207], a[88:91], a[48:51], v[204:207]
buffer_load_dwordx4 v24, s[28:31], s75 offen lds
v_mfma_f32_16x16x32_bf16 v[204:207], a[152:155], a[112:115], v[204:207]
s_add_u32 m0, s101, 18432
ds_read_b64_tr_b16 a[60:61], v8 offset:32768
v_mfma_f32_16x16x32_bf16 v[112:115], a[148:151], a[112:115], v[112:115]
s_add_u32 s75, s83, 320
s_and_b32 s75, s75, 1023
v_mfma_f32_16x16x32_bf16 v[112:115], a[84:87], a[48:51], v[112:115]
ds_read_b64_tr_b16 a[62:63], v8 offset:33792
v_mfma_f32_16x16x32_bf16 a[20:23], a[80:83], a[48:51], a[20:23]
buffer_load_dwordx4 v24, s[28:31], s75 offen lds
v_mfma_f32_16x16x32_bf16 a[20:23], a[144:147], a[112:115], a[20:23]
s_add_u32 m0, s101, 20480
ds_read_b64_tr_b16 a[44:45], v4 offset:32768
v_mfma_f32_16x16x32_bf16 v[80:83], a[140:143], a[112:115], v[80:83]
s_add_u32 s75, s83, 384
s_and_b32 s75, s75, 1023
v_mfma_f32_16x16x32_bf16 v[80:83], a[76:79], a[48:51], v[80:83]
ds_read_b64_tr_b16 a[46:47], v4 offset:33792
v_mfma_f32_16x16x32_bf16 a[4:7], a[72:75], a[48:51], a[4:7]
buffer_load_dwordx4 v24, s[28:31], s75 offen lds
v_mfma_f32_16x16x32_bf16 a[4:7], a[136:139], a[112:115], a[4:7]
s_add_u32 m0, s101, 22528
ds_read_b64_tr_b16 a[40:41], v3 offset:32768
v_mfma_f32_16x16x32_bf16 v[48:51], a[132:135], a[112:115], v[48:51]
s_add_u32 s75, s83, 448
s_and_b32 s75, s75, 1023
v_mfma_f32_16x16x32_bf16 v[48:51], a[68:71], a[48:51], v[48:51]
ds_read_b64_tr_b16 a[42:43], v3 offset:33792
v_mfma_f32_16x16x32_bf16 v[52:55], a[68:71], a[52:55], v[52:55]
buffer_load_dwordx4 v24, s[28:31], s75 offen lds
v_mfma_f32_16x16x32_bf16 v[52:55], a[132:135], a[116:119], v[52:55]
s_add_u32 s86, s86, 0x40000
ds_read_b64_tr_b16 a[36:37], v2 offset:32768
v_mfma_f32_16x16x32_bf16 v[172:175], a[136:139], a[116:119], v[172:175]
s_and_b32 s86, s86, 0x3c0000
s_add_u32 m0, s97, 0
s_add_u32 s74, s87, s98
v_mfma_f32_16x16x32_bf16 v[172:175], a[72:75], a[52:55], v[172:175]
ds_read_b64_tr_b16 a[38:39], v2 offset:33792
v_mfma_f32_16x16x32_bf16 v[84:87], a[76:79], a[52:55], v[84:87]
buffer_load_dwordx4 v18, s[8:11], s74 offen offset:0 lds
v_mfma_f32_16x16x32_bf16 v[84:87], a[140:143], a[116:119], v[84:87]
ds_read_b64_tr_b16 a[48:49], v5 offset:32768
v_mfma_f32_16x16x32_bf16 v[188:191], a[144:147], a[116:119], v[188:191]
v_mfma_f32_16x16x32_bf16 v[188:191], a[80:83], a[52:55], v[188:191]
ds_read_b64_tr_b16 a[50:51], v5 offset:33792
v_mfma_f32_16x16x32_bf16 v[116:119], a[84:87], a[52:55], v[116:119]
buffer_load_dwordx4 v19, s[8:11], s74 offen offset:1024 lds
v_mfma_f32_16x16x32_bf16 v[116:119], a[148:151], a[116:119], v[116:119]
v_mfma_f32_16x16x32_bf16 v[208:211], a[152:155], a[116:119], v[208:211]
v_mfma_f32_16x16x32_bf16 v[208:211], a[88:91], a[52:55], v[208:211]
v_mfma_f32_16x16x32_bf16 v[148:151], a[92:95], a[52:55], v[148:151]
buffer_load_dwordx4 v22, s[8:11], s74 offen offset:2048 lds
v_mfma_f32_16x16x32_bf16 v[148:151], a[156:159], a[116:119], v[148:151]
v_mfma_f32_16x16x32_bf16 v[240:243], a[160:163], a[116:119], v[240:243]
v_mfma_f32_16x16x32_bf16 v[240:243], a[96:99], a[52:55], v[240:243]
ds_read_b64_tr_b16 a[52:53], v6 offset:32768
v_mfma_f32_16x16x32_bf16 v[244:247], a[96:99], a[56:59], v[244:247]
buffer_load_dwordx4 v23, s[8:11], s74 offen offset:3072 lds
v_mfma_f32_16x16x32_bf16 v[244:247], a[160:163], a[120:123], v[244:247]
ds_read_b64_tr_b16 a[54:55], v6 offset:33792
v_mfma_f32_16x16x32_bf16 v[152:155], a[156:159], a[120:123], v[152:155]
v_mfma_f32_16x16x32_bf16 v[152:155], a[92:95], a[56:59], v[152:155]
ds_read_b128 a[96:99], v11 offset:30720
v_mfma_f32_16x16x32_bf16 v[212:215], a[88:91], a[56:59], v[212:215]
buffer_load_dwordx4 a[240:243], v25, s[32:35], s100 offen
v_mfma_f32_16x16x32_bf16 v[212:215], a[152:155], a[120:123], v[212:215]
s_add_u32 s100, s100, 64
ds_read_b128 a[92:95], v11 offset:28672
v_mfma_f32_16x16x32_bf16 v[120:123], a[148:151], a[120:123], v[120:123]
s_and_b32 s100, s100, 1023
v_mfma_f32_16x16x32_bf16 v[120:123], a[84:87], a[56:59], v[120:123]
ds_read_b128 a[88:91], v11 offset:26624
v_mfma_f32_16x16x32_bf16 a[24:27], a[80:83], a[56:59], a[24:27]
buffer_store_dwordx4 a[164:167], v0, s[76:79], s38 offen sc1
v_mfma_f32_16x16x32_bf16 a[24:27], a[144:147], a[120:123], a[24:27]
s_add_u32 s38, s38, 1024
ds_read_b128 a[84:87], v11 offset:24576
v_mfma_f32_16x16x32_bf16 v[88:91], a[140:143], a[120:123], v[88:91]
v_mfma_f32_16x16x32_bf16 v[88:91], a[76:79], a[56:59], v[88:91]
ds_read_b128 a[80:83], v10 offset:22528
v_mfma_f32_16x16x32_bf16 a[8:11], a[72:75], a[56:59], a[8:11]
v_mfma_f32_16x16x32_bf16 a[8:11], a[136:139], a[120:123], a[8:11]
ds_read_b128 a[76:79], v10 offset:20480
v_mfma_f32_16x16x32_bf16 v[56:59], a[132:135], a[120:123], v[56:59]
v_mfma_f32_16x16x32_bf16 v[56:59], a[68:71], a[56:59], v[56:59]
ds_read_b128 a[72:75], v10 offset:18432
v_mfma_f32_16x16x32_bf16 v[60:63], a[132:135], a[124:127], v[60:63]
v_mfma_f32_16x16x32_bf16 v[176:179], a[136:139], a[124:127], v[176:179]
ds_read_b128 a[68:71], v10 offset:16384
v_mfma_f32_16x16x32_bf16 v[92:95], a[140:143], a[124:127], v[92:95]
v_mfma_f32_16x16x32_bf16 a[28:31], a[144:147], a[124:127], a[28:31]
ds_read_b64_tr_b16 a[56:57], v7 offset:32768
v_mfma_f32_16x16x32_bf16 v[124:127], a[148:151], a[124:127], v[124:127]
v_mfma_f32_16x16x32_bf16 v[216:219], a[152:155], a[124:127], v[216:219]
ds_read_b64_tr_b16 a[58:59], v7 offset:33792
v_mfma_f32_16x16x32_bf16 v[156:159], a[156:159], a[124:127], v[156:159]
v_mfma_f32_16x16x32_bf16 v[248:251], a[160:163], a[124:127], v[248:251]
v_mfma_f32_16x16x32_bf16 v[252:255], a[160:163], a[128:131], v[252:255]
v_mfma_f32_16x16x32_bf16 v[160:163], a[156:159], a[128:131], v[160:163]
v_mfma_f32_16x16x32_bf16 v[220:223], a[152:155], a[128:131], v[220:223]
v_mfma_f32_16x16x32_bf16 v[128:131], a[148:151], a[128:131], v[128:131]
v_mfma_f32_16x16x32_bf16 a[32:35], a[144:147], a[128:131], a[32:35]
v_mfma_f32_16x16x32_bf16 v[96:99], a[140:143], a[128:131], v[96:99]
v_mfma_f32_16x16x32_bf16 a[12:15], a[136:139], a[128:131], a[12:15]
v_mfma_f32_16x16x32_bf16 v[64:67], a[132:135], a[128:131], v[64:67]
s_waitcnt lgkmcnt(6)
v_mfma_f32_16x16x32_bf16 v[100:103], a[84:87], a[36:39], v[100:103]
s_waitcnt vmcnt(19) lgkmcnt(0)
s_barrier
v_mfma_f32_16x16x32_bf16 v[192:195], a[88:91], a[36:39], v[192:195]
ds_read_b128 a[132:135], v12 offset:16384
v_mfma_f32_16x16x32_bf16 v[104:107], a[84:87], a[40:43], v[104:107]
ds_read_b64_tr_b16 a[100:101], v2 offset:49152
v_mfma_f32_16x16x32_bf16 v[196:199], a[88:91], a[40:43], v[196:199]
ds_read_b64_tr_b16 a[102:103], v2 offset:50176
v_mfma_f32_16x16x32_bf16 v[108:111], a[84:87], a[44:47], v[108:111]
ds_read_b128 a[136:139], v12 offset:18432
v_mfma_f32_16x16x32_bf16 v[200:203], a[88:91], a[44:47], v[200:203]
ds_read_b64_tr_b16 a[104:105], v3 offset:49152
v_mfma_f32_16x16x32_bf16 v[112:115], a[84:87], a[48:51], v[112:115]
ds_read_b64_tr_b16 a[106:107], v3 offset:50176
v_mfma_f32_16x16x32_bf16 v[204:207], a[88:91], a[48:51], v[204:207]
ds_read_b128 a[140:143], v12 offset:20480
v_mfma_f32_16x16x32_bf16 v[116:119], a[84:87], a[52:55], v[116:119]
ds_read_b64_tr_b16 a[108:109], v4 offset:49152
v_mfma_f32_16x16x32_bf16 v[208:211], a[88:91], a[52:55], v[208:211]
ds_read_b64_tr_b16 a[110:111], v4 offset:50176
v_mfma_f32_16x16x32_bf16 v[120:123], a[84:87], a[56:59], v[120:123]
ds_read_b128 a[144:147], v12 offset:22528
v_mfma_f32_16x16x32_bf16 v[212:215], a[88:91], a[56:59], v[212:215]
ds_read_b64_tr_b16 a[112:113], v5 offset:49152
v_mfma_f32_16x16x32_bf16 v[124:127], a[84:87], a[60:63], v[124:127]
ds_read_b64_tr_b16 a[114:115], v5 offset:50176
v_mfma_f32_16x16x32_bf16 v[216:219], a[88:91], a[60:63], v[216:219]
ds_read_b128 a[148:151], v13 offset:24576
v_mfma_f32_16x16x32_bf16 v[128:131], a[84:87], a[64:67], v[128:131]
ds_read_b64_tr_b16 a[116:117], v6 offset:49152
v_mfma_f32_16x16x32_bf16 v[220:223], a[88:91], a[64:67], v[220:223]
ds_read_b64_tr_b16 a[118:119], v6 offset:50176
v_mfma_f32_16x16x32_bf16 v[132:135], a[92:95], a[36:39], v[132:135]
ds_read_b128 a[152:155], v13 offset:26624
v_mfma_f32_16x16x32_bf16 v[224:227], a[96:99], a[36:39], v[224:227]
ds_read_b64_tr_b16 a[120:121], v7 offset:49152
v_mfma_f32_16x16x32_bf16 v[136:139], a[92:95], a[40:43], v[136:139]
ds_read_b64_tr_b16 a[122:123], v7 offset:50176
v_mfma_f32_16x16x32_bf16 v[228:231], a[96:99], a[40:43], v[228:231]
ds_read_b128 a[156:159], v13 offset:28672
v_mfma_f32_16x16x32_bf16 v[140:143], a[92:95], a[44:47], v[140:143]
ds_read_b64_tr_b16 a[124:125], v8 offset:49152
v_mfma_f32_16x16x32_bf16 v[232:235], a[96:99], a[44:47], v[232:235]
ds_read_b64_tr_b16 a[126:127], v8 offset:50176
v_mfma_f32_16x16x32_bf16 v[144:147], a[92:95], a[48:51], v[144:147]
ds_read_b128 a[160:163], v13 offset:30720
v_mfma_f32_16x16x32_bf16 v[236:239], a[96:99], a[48:51], v[236:239]
ds_read_b64_tr_b16 a[128:129], v9 offset:49152
v_mfma_f32_16x16x32_bf16 v[148:151], a[92:95], a[52:55], v[148:151]
ds_read_b64_tr_b16 a[130:131], v9 offset:50176
v_mfma_f32_16x16x32_bf16 v[240:243], a[96:99], a[52:55], v[240:243]
s_add_u32 m0, s101, 32768
s_add_u32 s75, s83, 512
s_and_b32 s75, s75, 1023
v_mfma_f32_16x16x32_bf16 v[152:155], a[92:95], a[56:59], v[152:155]
buffer_load_dwordx4 v24, s[28:31], s75 offen lds
v_mfma_f32_16x16x32_bf16 v[244:247], a[96:99], a[56:59], v[244:247]
s_add_u32 m0, s101, 34816
s_add_u32 s75, s83, 576
s_and_b32 s75, s75, 1023
v_mfma_f32_16x16x32_bf16 v[156:159], a[92:95], a[60:63], v[156:159]
v_subrev_u32 v2, 8192, v2
v_subrev_u32 v3, 8192, v3
v_mfma_f32_16x16x32_bf16 v[248:251], a[96:99], a[60:63], v[248:251]
buffer_load_dwordx4 v24, s[28:31], s75 offen lds
v_mfma_f32_16x16x32_bf16 v[160:163], a[92:95], a[64:67], v[160:163]
s_add_u32 m0, s101, 36864
s_add_u32 s75, s83, 640
s_and_b32 s75, s75, 1023
v_mfma_f32_16x16x32_bf16 v[252:255], a[96:99], a[64:67], v[252:255]
v_subrev_u32 v4, 8192, v4
v_subrev_u32 v5, 8192, v5
v_mfma_f32_16x16x32_bf16 v[36:39], a[68:71], a[36:39], v[36:39]
s_waitcnt lgkmcnt(15)
buffer_load_dwordx4 v24, s[28:31], s75 offen lds
v_mfma_f32_16x16x32_bf16 v[36:39], a[132:135], a[100:103], v[36:39]
s_waitcnt lgkmcnt(15)
s_add_u32 m0, s101, 38912
s_add_u32 s75, s83, 704
s_and_b32 s75, s75, 1023
v_mfma_f32_16x16x32_bf16 v[164:167], a[136:139], a[100:103], v[164:167]
v_subrev_u32 v6, 8192, v6
v_subrev_u32 v7, 8192, v7
v_mfma_f32_16x16x32_bf16 v[164:167], a[72:75], a[36:39], v[164:167]
buffer_load_dwordx4 v24, s[28:31], s75 offen lds
v_mfma_f32_16x16x32_bf16 v[40:43], a[68:71], a[40:43], v[40:43]
s_waitcnt lgkmcnt(15)
s_add_u32 s86, s86, 0x40000
s_and_b32 s86, s86, 0x3c0000
s_add_u32 m0, s97, 4096
v_mfma_f32_16x16x32_bf16 v[40:43], a[132:135], a[104:107], v[40:43]
s_add_u32 s74, s87, s99
v_subrev_u32 v8, 8192, v8
v_mfma_f32_16x16x32_bf16 a[0:3], a[136:139], a[104:107], a[0:3]
buffer_load_dwordx4 v18, s[8:11], s74 offen offset:0 lds
v_mfma_f32_16x16x32_bf16 a[0:3], a[72:75], a[40:43], a[0:3]
v_subrev_u32 v9, 8192, v9
v_cvt_pk_bf16_f32 v36, v36, v37
v_mfma_f32_16x16x32_bf16 v[44:47], a[68:71], a[44:47], v[44:47]
s_waitcnt lgkmcnt(15)
v_cvt_pk_bf16_f32 v37, v38, v39
v_cvt_pk_bf16_f32 v38, v164, v165
v_mfma_f32_16x16x32_bf16 v[44:47], a[132:135], a[108:111], v[44:47]
buffer_load_dwordx4 v19, s[8:11], s74 offen offset:1024 lds
v_mfma_f32_16x16x32_bf16 v[168:171], a[136:139], a[108:111], v[168:171]
v_cvt_pk_bf16_f32 v39, v166, v167
v_mfma_f32_16x16x32_bf16 v[168:171], a[72:75], a[44:47], v[168:171]
v_cvt_pk_bf16_f32 v40, v40, v41
v_cvt_pk_bf16_f32 v41, v42, v43
v_mfma_f32_16x16x32_bf16 v[48:51], a[68:71], a[48:51], v[48:51]
s_waitcnt lgkmcnt(12)
buffer_load_dwordx4 v22, s[8:11], s74 offen offset:2048 lds
v_mfma_f32_16x16x32_bf16 v[48:51], a[132:135], a[112:115], v[48:51]
v_accvgpr_read_b32 v164, a0
v_accvgpr_read_b32 v165, a1
v_mfma_f32_16x16x32_bf16 a[4:7], a[136:139], a[112:115], a[4:7]
v_accvgpr_read_b32 v166, a2
v_accvgpr_read_b32 v167, a3
v_mfma_f32_16x16x32_bf16 a[4:7], a[72:75], a[48:51], a[4:7]
buffer_load_dwordx4 v23, s[8:11], s74 offen offset:3072 lds
v_mfma_f32_16x16x32_bf16 v[52:55], a[68:71], a[52:55], v[52:55]
s_waitcnt lgkmcnt(9)
s_add_u32 s87, s87, 128
s_and_b32 s87, s87, 1023
v_mfma_f32_16x16x32_bf16 v[52:55], a[132:135], a[116:119], v[52:55]
buffer_store_dwordx4 v[36:39], v0, s[20:23], s88 offen offset:0 sc1
v_mfma_f32_16x16x32_bf16 v[172:175], a[136:139], a[116:119], v[172:175]
buffer_load_dwordx4 a[244:247], v25, s[32:35], s100 offen
v_mfma_f32_16x16x32_bf16 v[172:175], a[72:75], a[52:55], v[172:175]
s_add_u32 s100, s100, 64
s_and_b32 s100, s100, 1023
v_mfma_f32_16x16x32_bf16 v[56:59], a[68:71], a[56:59], v[56:59]
s_waitcnt lgkmcnt(6)
v_cvt_pk_bf16_f32 v42, v164, v165
v_cvt_pk_bf16_f32 v43, v166, v167
v_mfma_f32_16x16x32_bf16 v[56:59], a[132:135], a[120:123], v[56:59]
v_cvt_pk_bf16_f32 v44, v44, v45
v_cvt_pk_bf16_f32 v45, v46, v47
v_mfma_f32_16x16x32_bf16 a[8:11], a[136:139], a[120:123], a[8:11]
v_cvt_pk_bf16_f32 v46, v168, v169
v_cvt_pk_bf16_f32 v47, v170, v171
v_mfma_f32_16x16x32_bf16 a[8:11], a[72:75], a[56:59], a[8:11]
v_cvt_pk_bf16_f32 v48, v48, v49
v_cvt_pk_bf16_f32 v49, v50, v51
v_mfma_f32_16x16x32_bf16 v[60:63], a[68:71], a[60:63], v[60:63]
s_waitcnt lgkmcnt(3)
v_accvgpr_read_b32 v168, a4
v_accvgpr_read_b32 v169, a5
v_mfma_f32_16x16x32_bf16 v[60:63], a[132:135], a[124:127], v[60:63]
v_accvgpr_read_b32 v170, a6
v_accvgpr_read_b32 v171, a7
v_mfma_f32_16x16x32_bf16 v[176:179], a[136:139], a[124:127], v[176:179]
v_cvt_pk_bf16_f32 v50, v168, v169
v_cvt_pk_bf16_f32 v51, v170, v171
v_mfma_f32_16x16x32_bf16 v[176:179], a[72:75], a[60:63], v[176:179]
v_cvt_pk_bf16_f32 v52, v52, v53
v_cvt_pk_bf16_f32 v53, v54, v55
v_mfma_f32_16x16x32_bf16 v[64:67], a[68:71], a[64:67], v[64:67]
s_waitcnt lgkmcnt(0)
v_cvt_pk_bf16_f32 v54, v172, v173
v_cvt_pk_bf16_f32 v55, v174, v175
v_mfma_f32_16x16x32_bf16 v[64:67], a[132:135], a[128:131], v[64:67]
buffer_store_dwordx4 v[40:43], v0, s[20:23], s88 offen offset:1024 sc1
v_mfma_f32_16x16x32_bf16 a[12:15], a[136:139], a[128:131], a[12:15]
s_waitcnt vmcnt(21) lgkmcnt(0)
s_barrier
v_mfma_f32_16x16x32_bf16 a[12:15], a[72:75], a[64:67], a[12:15]
s_add_u32 m0, s101, 49152
s_add_u32 s75, s83, 768
s_and_b32 s75, s75, 1023
v_mfma_f32_16x16x32_bf16 v[68:71], a[76:79], a[36:39], v[68:71]
buffer_load_dwordx4 v24, s[28:31], s75 offen lds
v_mfma_f32_16x16x32_bf16 v[68:71], a[140:143], a[100:103], v[68:71]
s_add_u32 m0, s101, 51200
s_add_u32 s75, s83, 832
s_and_b32 s75, s75, 1023
v_mfma_f32_16x16x32_bf16 v[180:183], a[144:147], a[100:103], v[180:183]
v_cvt_pk_bf16_f32 v56, v56, v57
v_cvt_pk_bf16_f32 v57, v58, v59
v_mfma_f32_16x16x32_bf16 v[180:183], a[80:83], a[36:39], v[180:183]
buffer_load_dwordx4 v24, s[28:31], s75 offen lds
v_mfma_f32_16x16x32_bf16 v[72:75], a[76:79], a[40:43], v[72:75]
s_add_u32 m0, s101, 53248
s_add_u32 s75, s83, 896
s_and_b32 s75, s75, 1023
v_mfma_f32_16x16x32_bf16 v[72:75], a[140:143], a[104:107], v[72:75]
v_accvgpr_read_b32 v172, a8
v_accvgpr_read_b32 v173, a9
v_mfma_f32_16x16x32_bf16 a[16:19], a[144:147], a[104:107], a[16:19]
buffer_load_dwordx4 v24, s[28:31], s75 offen lds
v_mfma_f32_16x16x32_bf16 a[16:19], a[80:83], a[40:43], a[16:19]
s_add_u32 m0, s101, 55296
s_add_u32 s75, s83, 960
s_and_b32 s75, s75, 1023
v_mfma_f32_16x16x32_bf16 v[76:79], a[76:79], a[44:47], v[76:79]
v_accvgpr_read_b32 v174, a10
v_accvgpr_read_b32 v175, a11
v_mfma_f32_16x16x32_bf16 v[76:79], a[140:143], a[108:111], v[76:79]
buffer_load_dwordx4 v24, s[28:31], s75 offen lds
v_mfma_f32_16x16x32_bf16 v[184:187], a[144:147], a[108:111], v[184:187]
s_add_u32 s86, s86, 0x40000
s_and_b32 s86, s86, 0x3c0000
s_add_u32 m0, s97, 16384
buffer_store_dwordx4 v[44:47], v0, s[20:23], s88 offen offset:2048 sc1
v_mfma_f32_16x16x32_bf16 v[184:187], a[80:83], a[44:47], v[184:187]
s_add_u32 s74, s87, s98
v_cvt_pk_bf16_f32 v58, v172, v173
v_mfma_f32_16x16x32_bf16 v[80:83], a[76:79], a[48:51], v[80:83]
buffer_load_dwordx4 v18, s[8:11], s74 offen offset:0 lds
v_mfma_f32_16x16x32_bf16 v[80:83], a[140:143], a[112:115], v[80:83]
v_cvt_pk_bf16_f32 v59, v174, v175
v_cvt_pk_bf16_f32 v60, v60, v61
v_mfma_f32_16x16x32_bf16 a[20:23], a[144:147], a[112:115], a[20:23]
v_cvt_pk_bf16_f32 v61, v62, v63
v_cvt_pk_bf16_f32 v62, v176, v177
v_mfma_f32_16x16x32_bf16 a[20:23], a[80:83], a[48:51], a[20:23]
buffer_load_dwordx4 v19, s[8:11], s74 offen offset:1024 lds
v_mfma_f32_16x16x32_bf16 v[84:87], a[76:79], a[52:55], v[84:87]
v_cvt_pk_bf16_f32 v63, v178, v179
v_cvt_pk_bf16_f32 v64, v64, v65
v_mfma_f32_16x16x32_bf16 v[84:87], a[140:143], a[116:119], v[84:87]
v_cvt_pk_bf16_f32 v65, v66, v67
v_accvgpr_read_b32 v176, a12
v_mfma_f32_16x16x32_bf16 v[188:191], a[144:147], a[116:119], v[188:191]
buffer_load_dwordx4 v22, s[8:11], s74 offen offset:2048 lds
v_mfma_f32_16x16x32_bf16 v[188:191], a[80:83], a[52:55], v[188:191]
v_accvgpr_read_b32 v177, a13
v_accvgpr_read_b32 v178, a14
v_mfma_f32_16x16x32_bf16 v[88:91], a[76:79], a[56:59], v[88:91]
v_accvgpr_read_b32 v179, a15
v_cvt_pk_bf16_f32 v66, v176, v177
v_mfma_f32_16x16x32_bf16 v[88:91], a[140:143], a[120:123], v[88:91]
buffer_load_dwordx4 v23, s[8:11], s74 offen offset:3072 lds
v_mfma_f32_16x16x32_bf16 a[24:27], a[144:147], a[120:123], a[24:27]
v_cvt_pk_bf16_f32 v67, v178, v179
v_cvt_pk_bf16_f32 v68, v68, v69
v_mfma_f32_16x16x32_bf16 a[24:27], a[80:83], a[56:59], a[24:27]
buffer_store_dwordx4 v[48:51], v0, s[20:23], s88 offen offset:3072 sc1
v_mfma_f32_16x16x32_bf16 v[92:95], a[76:79], a[60:63], v[92:95]
buffer_load_dwordx4 a[248:251], v25, s[32:35], s100 offen
v_mfma_f32_16x16x32_bf16 v[92:95], a[140:143], a[124:127], v[92:95]
s_add_u32 s100, s100, 64
s_and_b32 s100, s100, 1023
v_mfma_f32_16x16x32_bf16 a[28:31], a[144:147], a[124:127], a[28:31]
v_cvt_pk_bf16_f32 v69, v70, v71
v_cvt_pk_bf16_f32 v70, v180, v181
v_mfma_f32_16x16x32_bf16 a[28:31], a[80:83], a[60:63], a[28:31]
v_cvt_pk_bf16_f32 v71, v182, v183
v_cvt_pk_bf16_f32 v72, v72, v73
v_mfma_f32_16x16x32_bf16 v[96:99], a[76:79], a[64:67], v[96:99]
v_cvt_pk_bf16_f32 v73, v74, v75
v_accvgpr_read_b32 v180, a16
v_mfma_f32_16x16x32_bf16 v[96:99], a[140:143], a[128:131], v[96:99]
v_accvgpr_read_b32 v181, a17
v_accvgpr_read_b32 v182, a18
v_mfma_f32_16x16x32_bf16 a[32:35], a[144:147], a[128:131], a[32:35]
v_accvgpr_read_b32 v183, a19
v_cvt_pk_bf16_f32 v74, v180, v181
v_mfma_f32_16x16x32_bf16 a[32:35], a[80:83], a[64:67], a[32:35]
v_cvt_pk_bf16_f32 v75, v182, v183
v_cvt_pk_bf16_f32 v76, v76, v77
v_mfma_f32_16x16x32_bf16 v[100:103], a[148:151], a[100:103], v[100:103]
ds_read_b128 a[68:71], v26 offset:32768
v_cvt_pk_bf16_f32 v77, v78, v79
v_mfma_f32_16x16x32_bf16 v[192:195], a[152:155], a[100:103], v[192:195]
ds_read_b128 a[72:75], v26 offset:34816
v_cvt_pk_bf16_f32 v78, v184, v185
v_mfma_f32_16x16x32_bf16 v[104:107], a[148:151], a[104:107], v[104:107]
ds_read_b128 a[76:79], v26 offset:36864
v_cvt_pk_bf16_f32 v79, v186, v187
v_mfma_f32_16x16x32_bf16 v[196:199], a[152:155], a[104:107], v[196:199]
ds_read_b128 a[80:83], v26 offset:38912
v_cvt_pk_bf16_f32 v80, v80, v81
v_mfma_f32_16x16x32_bf16 v[108:111], a[148:151], a[108:111], v[108:111]
ds_read_b64_tr_b16 a[36:37], v2 offset:0
buffer_store_dwordx4 v[52:55], v0, s[20:23], s89 offen offset:0 sc1
v_mfma_f32_16x16x32_bf16 v[200:203], a[152:155], a[108:111], v[200:203]
ds_read_b64_tr_b16 a[38:39], v2 offset:1024
v_cvt_pk_bf16_f32 v81, v82, v83
v_mfma_f32_16x16x32_bf16 v[112:115], a[148:151], a[112:115], v[112:115]
ds_read_b64_tr_b16 a[40:41], v3 offset:0
v_accvgpr_read_b32 v184, a20
v_mfma_f32_16x16x32_bf16 v[204:207], a[152:155], a[112:115], v[204:207]
ds_read_b64_tr_b16 a[42:43], v3 offset:1024
v_accvgpr_read_b32 v185, a21
v_mfma_f32_16x16x32_bf16 v[116:119], a[148:151], a[116:119], v[116:119]
ds_read_b64_tr_b16 a[44:45], v4 offset:0
v_accvgpr_read_b32 v186, a22
v_mfma_f32_16x16x32_bf16 v[208:211], a[152:155], a[116:119], v[208:211]
ds_read_b64_tr_b16 a[46:47], v4 offset:1024
v_accvgpr_read_b32 v187, a23
v_mfma_f32_16x16x32_bf16 v[120:123], a[148:151], a[120:123], v[120:123]
ds_read_b64_tr_b16 a[48:49], v5 offset:0
v_cvt_pk_bf16_f32 v82, v184, v185
v_mfma_f32_16x16x32_bf16 v[212:215], a[152:155], a[120:123], v[212:215]
ds_read_b64_tr_b16 a[50:51], v5 offset:1024
v_cvt_pk_bf16_f32 v83, v186, v187
v_mfma_f32_16x16x32_bf16 v[124:127], a[148:151], a[124:127], v[124:127]
ds_read_b64_tr_b16 a[52:53], v6 offset:0
v_cvt_pk_bf16_f32 v84, v84, v85
v_mfma_f32_16x16x32_bf16 v[216:219], a[152:155], a[124:127], v[216:219]
ds_read_b64_tr_b16 a[54:55], v6 offset:1024
v_cvt_pk_bf16_f32 v85, v86, v87
v_mfma_f32_16x16x32_bf16 v[128:131], a[148:151], a[128:131], v[128:131]
ds_read_b64_tr_b16 a[56:57], v7 offset:0
v_cvt_pk_bf16_f32 v86, v188, v189
v_mfma_f32_16x16x32_bf16 v[220:223], a[152:155], a[128:131], v[220:223]
ds_read_b64_tr_b16 a[58:59], v7 offset:1024
v_cvt_pk_bf16_f32 v87, v190, v191
v_mfma_f32_16x16x32_bf16 v[132:135], a[156:159], a[100:103], v[132:135]
ds_read_b64_tr_b16 a[60:61], v8 offset:0
v_cvt_pk_bf16_f32 v88, v88, v89
v_mfma_f32_16x16x32_bf16 v[224:227], a[160:163], a[100:103], v[224:227]
ds_read_b64_tr_b16 a[62:63], v8 offset:1024
buffer_store_dwordx4 v[56:59], v0, s[20:23], s89 offen offset:1024 sc1
v_mfma_f32_16x16x32_bf16 v[136:139], a[156:159], a[104:107], v[136:139]
ds_read_b64_tr_b16 a[64:65], v9 offset:0
v_cvt_pk_bf16_f32 v89, v90, v91
v_mfma_f32_16x16x32_bf16 v[228:231], a[160:163], a[104:107], v[228:231]
ds_read_b64_tr_b16 a[66:67], v9 offset:1024
v_accvgpr_read_b32 v188, a24
v_mfma_f32_16x16x32_bf16 v[140:143], a[156:159], a[108:111], v[140:143]
ds_read_b128 a[84:87], v28 offset:32768
v_accvgpr_read_b32 v189, a25
v_mfma_f32_16x16x32_bf16 v[232:235], a[160:163], a[108:111], v[232:235]
ds_read_b128 a[88:91], v29 offset:33280
v_accvgpr_read_b32 v190, a26
v_mfma_f32_16x16x32_bf16 v[144:147], a[156:159], a[112:115], v[144:147]
ds_read_b128 a[92:95], v30 offset:33792
v_accvgpr_read_b32 v191, a27
v_mfma_f32_16x16x32_bf16 v[236:239], a[160:163], a[112:115], v[236:239]
ds_read_b128 a[96:99], v31 offset:34304
v_cvt_pk_bf16_f32 v90, v188, v189
v_mfma_f32_16x16x32_bf16 v[148:151], a[156:159], a[116:119], v[148:151]
ds_read_b128 a[164:167], v32 offset:0
v_cvt_pk_bf16_f32 v91, v190, v191
v_mfma_f32_16x16x32_bf16 v[240:243], a[160:163], a[116:119], v[240:243]
ds_read_b128 a[168:171], v32 offset:1024
v_cvt_pk_bf16_f32 v92, v92, v93
v_mfma_f32_16x16x32_bf16 v[152:155], a[156:159], a[120:123], v[152:155]
v_cvt_pk_bf16_f32 v93, v94, v95
v_accvgpr_read_b32 v188, a28
v_mfma_f32_16x16x32_bf16 v[244:247], a[160:163], a[120:123], v[244:247]
v_accvgpr_read_b32 v189, a29
v_accvgpr_read_b32 v190, a30
v_mfma_f32_16x16x32_bf16 v[156:159], a[156:159], a[124:127], v[156:159]
v_accvgpr_read_b32 v191, a31
v_cvt_pk_bf16_f32 v94, v188, v189
v_mfma_f32_16x16x32_bf16 v[248:251], a[160:163], a[124:127], v[248:251]
v_cvt_pk_bf16_f32 v95, v190, v191
v_cvt_pk_bf16_f32 v96, v96, v97
v_mfma_f32_16x16x32_bf16 v[160:163], a[156:159], a[128:131], v[160:163]
v_cvt_pk_bf16_f32 v97, v98, v99
v_accvgpr_read_b32 v188, a32
v_mfma_f32_16x16x32_bf16 v[252:255], a[160:163], a[128:131], v[252:255]
v_accvgpr_read_b32 v189, a33
v_accvgpr_read_b32 v190, a34
v_accvgpr_read_b32 v191, a35
v_cvt_pk_bf16_f32 v98, v188, v189
v_cvt_pk_bf16_f32 v99, v190, v191
v_cvt_pk_bf16_f32 v100, v100, v101
v_cvt_pk_bf16_f32 v101, v102, v103
v_cvt_pk_bf16_f32 v102, v192, v193
v_cvt_pk_bf16_f32 v103, v194, v195
v_cvt_pk_bf16_f32 v104, v104, v105
v_cvt_pk_bf16_f32 v105, v106, v107
v_cvt_pk_bf16_f32 v106, v196, v197
v_cvt_pk_bf16_f32 v107, v198, v199
v_cvt_pk_bf16_f32 v108, v108, v109
v_cvt_pk_bf16_f32 v109, v110, v111
v_cvt_pk_bf16_f32 v110, v200, v201
v_cvt_pk_bf16_f32 v111, v202, v203
v_cvt_pk_bf16_f32 v112, v112, v113
v_cvt_pk_bf16_f32 v113, v114, v115
v_cvt_pk_bf16_f32 v114, v204, v205
v_cvt_pk_bf16_f32 v115, v206, v207
v_cvt_pk_bf16_f32 v116, v116, v117
v_cvt_pk_bf16_f32 v117, v118, v119
v_cvt_pk_bf16_f32 v118, v208, v209
v_cvt_pk_bf16_f32 v119, v210, v211
v_cvt_pk_bf16_f32 v120, v120, v121
v_cvt_pk_bf16_f32 v121, v122, v123
v_cvt_pk_bf16_f32 v122, v212, v213
v_cvt_pk_bf16_f32 v123, v214, v215
v_cvt_pk_bf16_f32 v124, v124, v125
v_cvt_pk_bf16_f32 v125, v126, v127
v_cvt_pk_bf16_f32 v126, v216, v217
v_cvt_pk_bf16_f32 v127, v218, v219
v_cvt_pk_bf16_f32 v128, v128, v129
v_cvt_pk_bf16_f32 v129, v130, v131
v_cvt_pk_bf16_f32 v130, v220, v221
v_cvt_pk_bf16_f32 v131, v222, v223
v_cvt_pk_bf16_f32 v132, v132, v133
v_cvt_pk_bf16_f32 v133, v134, v135
v_cvt_pk_bf16_f32 v134, v224, v225
v_cvt_pk_bf16_f32 v135, v226, v227
v_cvt_pk_bf16_f32 v136, v136, v137
v_cvt_pk_bf16_f32 v137, v138, v139
v_cvt_pk_bf16_f32 v138, v228, v229
v_cvt_pk_bf16_f32 v139, v230, v231
v_cvt_pk_bf16_f32 v140, v140, v141
v_cvt_pk_bf16_f32 v141, v142, v143
v_cvt_pk_bf16_f32 v142, v232, v233
v_cvt_pk_bf16_f32 v143, v234, v235
v_cvt_pk_bf16_f32 v144, v144, v145
v_cvt_pk_bf16_f32 v145, v146, v147
v_cvt_pk_bf16_f32 v146, v236, v237
v_cvt_pk_bf16_f32 v147, v238, v239
v_cvt_pk_bf16_f32 v148, v148, v149
v_cvt_pk_bf16_f32 v149, v150, v151
v_cvt_pk_bf16_f32 v150, v240, v241
v_cvt_pk_bf16_f32 v151, v242, v243
v_cvt_pk_bf16_f32 v152, v152, v153
v_cvt_pk_bf16_f32 v153, v154, v155
v_cvt_pk_bf16_f32 v154, v244, v245
v_cvt_pk_bf16_f32 v155, v246, v247
v_cvt_pk_bf16_f32 v156, v156, v157
v_cvt_pk_bf16_f32 v157, v158, v159
v_cvt_pk_bf16_f32 v158, v248, v249
v_cvt_pk_bf16_f32 v159, v250, v251
v_cvt_pk_bf16_f32 v160, v160, v161
v_cvt_pk_bf16_f32 v161, v162, v163
v_cvt_pk_bf16_f32 v162, v252, v253
v_cvt_pk_bf16_f32 v163, v254, v255
LA_q:
s_lshl_b32 s101, s80, 11
s_add_u32 s101, s101, 98304
s_waitcnt lgkmcnt(15)
v_mfma_f32_16x16x32_bf16 v[192:195], a[40:43], a[80:83], 0
s_waitcnt vmcnt(24) lgkmcnt(0)
s_barrier
v_mfma_f32_16x16x32_bf16 v[188:191], a[40:43], a[76:79], 0
s_add_u32 m0, s101, 0
ds_read_b64_tr_b16 a[8:9], v4 offset:16384
v_mfma_f32_16x16x32_bf16 v[184:187], a[40:43], a[72:75], 0
ds_read_b64_tr_b16 a[10:11], v4 offset:17408
v_mfma_f32_16x16x32_bf16 v[180:183], a[40:43], a[68:71], 0
ds_read_b128 a[100:103], v27 offset:32768
v_mfma_f32_16x16x32_bf16 v[164:167], a[36:39], a[68:71], 0
ds_read_b128 a[104:107], v27 offset:34816
v_mfma_f32_16x16x32_bf16 v[168:171], a[36:39], a[72:75], 0
ds_read_b128 a[108:111], v27 offset:36864
v_mfma_f32_16x16x32_bf16 v[172:175], a[36:39], a[76:79], 0
ds_read_b128 a[112:115], v27 offset:38912
v_mfma_f32_16x16x32_bf16 v[176:179], a[36:39], a[80:83], 0
ds_read_b64_tr_b16 a[12:13], v5 offset:16384
v_mfma_f32_16x16x32_bf16 a[144:147], a[240:243], a[80:83], 0
ds_read_b64_tr_b16 a[14:15], v5 offset:17408
v_mfma_f32_16x16x32_bf16 a[140:143], a[240:243], a[76:79], 0
buffer_store_dwordx4 v[60:63], v0, s[20:23], s89 offen offset:2048 sc1
v_mfma_f32_16x16x32_bf16 a[136:139], a[240:243], a[72:75], 0
ds_read_b64_tr_b16 a[16:17], v6 offset:16384
v_mfma_f32_16x16x32_bf16 a[132:135], a[240:243], a[68:71], 0
ds_read_b64_tr_b16 a[18:19], v6 offset:17408
v_mfma_f32_16x16x32_bf16 v[196:199], a[44:47], a[68:71], 0
s_waitcnt lgkmcnt(7)
buffer_store_dwordx4 v[64:67], v0, s[20:23], s89 offen offset:3072 sc1
v_mfma_f32_16x16x32_bf16 v[196:199], a[8:11], a[100:103], v[196:199]
s_waitcnt lgkmcnt(6)
ds_read_b128 a[116:119], v30 offset:32768
v_mfma_f32_16x16x32_bf16 v[200:203], a[8:11], a[104:107], 0
ds_read_b128 a[172:175], v32 offset:2048
v_mfma_f32_16x16x32_bf16 v[200:203], a[44:47], a[72:75], v[200:203]
buffer_load_dwordx4 v33, s[16:19], s86 offen offset:0 lds
v_mfma_f32_16x16x32_bf16 v[204:207], a[44:47], a[76:79], 0
s_waitcnt lgkmcnt(7)
ds_read_b128 a[176:179], v32 offset:3072
v_mfma_f32_16x16x32_bf16 v[204:207], a[8:11], a[108:111], v[204:207]
s_waitcnt lgkmcnt(7)
ds_read_b128 a[120:123], v31 offset:33280
v_mfma_f32_16x16x32_bf16 v[208:211], a[8:11], a[112:115], 0
buffer_load_dwordx4 v34, s[16:19], s86 offen offset:1024 lds
v_mfma_f32_16x16x32_bf16 v[208:211], a[44:47], a[80:83], v[208:211]
s_add_u32 s86, s86, 0x40000
ds_read_b64_tr_b16 a[0:1], v2 offset:16384
v_mfma_f32_16x16x32_bf16 v[224:227], a[48:51], a[80:83], 0
s_waitcnt lgkmcnt(7)
s_and_b32 s86, s86, 0x3c0000
ds_read_b64_tr_b16 a[2:3], v2 offset:17408
v_mfma_f32_16x16x32_bf16 v[224:227], a[12:15], a[112:115], v[224:227]
s_add_u32 m0, s97, 20480
s_add_u32 s74, s87, s99
v_mfma_f32_16x16x32_bf16 v[220:223], a[12:15], a[108:111], 0
ds_read_b64_tr_b16 a[4:5], v3 offset:16384
v_mfma_f32_16x16x32_bf16 v[220:223], a[48:51], a[76:79], v[220:223]
ds_read_b64_tr_b16 a[6:7], v3 offset:17408
v_mfma_f32_16x16x32_bf16 v[216:219], a[48:51], a[72:75], 0
buffer_store_dwordx4 v[68:71], v0, s[20:23], s90 offen offset:0 sc1
v_mfma_f32_16x16x32_bf16 v[216:219], a[12:15], a[104:107], v[216:219]
ds_read_b64_tr_b16 a[20:21], v7 offset:16384
v_mfma_f32_16x16x32_bf16 v[212:215], a[12:15], a[100:103], 0
ds_read_b64_tr_b16 a[22:23], v7 offset:17408
v_mfma_f32_16x16x32_bf16 v[212:215], a[48:51], a[68:71], v[212:215]
buffer_load_dwordx4 v18, s[8:11], s74 offen offset:0 lds
v_mfma_f32_16x16x32_bf16 v[228:231], a[52:55], a[68:71], 0
s_waitcnt lgkmcnt(10)
ds_read_b64_tr_b16 a[24:25], v8 offset:16384
v_mfma_f32_16x16x32_bf16 v[228:231], a[16:19], a[100:103], v[228:231]
ds_read_b64_tr_b16 a[26:27], v8 offset:17408
v_mfma_f32_16x16x32_bf16 v[232:235], a[16:19], a[104:107], 0
buffer_load_dwordx4 v19, s[8:11], s74 offen offset:1024 lds
v_mfma_f32_16x16x32_bf16 v[232:235], a[52:55], a[72:75], v[232:235]
ds_read_b64_tr_b16 a[28:29], v9 offset:16384
v_mfma_f32_16x16x32_bf16 v[236:239], a[52:55], a[76:79], 0
ds_read_b64_tr_b16 a[30:31], v9 offset:17408
v_mfma_f32_16x16x32_bf16 v[236:239], a[16:19], a[108:111], v[236:239]
buffer_load_dwordx4 v22, s[8:11], s74 offen offset:2048 lds
v_mfma_f32_16x16x32_bf16 v[240:243], a[16:19], a[112:115], 0
ds_read_b128 a[124:127], v28 offset:33792
v_mfma_f32_16x16x32_bf16 v[240:243], a[52:55], a[80:83], v[240:243]
ds_read_b128 a[128:131], v29 offset:34304
v_mfma_f32_16x16x32_bf16 a[192:195], a[84:87], a[164:167], 0
s_waitcnt lgkmcnt(14)
buffer_load_dwordx4 v23, s[8:11], s74 offen offset:3072 lds
v_mfma_f32_16x16x32_bf16 a[192:195], a[116:119], a[172:175], a[192:195]
s_waitcnt lgkmcnt(13)
s_add_u32 s87, s87, 128
s_and_b32 s87, s87, 1023
v_mfma_f32_16x16x32_bf16 a[196:199], a[116:119], a[176:179], 0
buffer_load_dwordx4 a[252:255], v25, s[32:35], s100 offen
v_mfma_f32_16x16x32_bf16 a[196:199], a[84:87], a[168:171], a[196:199]
s_add_u32 s100, s100, 64
s_and_b32 s100, s100, 1023
v_mfma_f32_16x16x32_bf16 a[204:207], a[88:91], a[168:171], 0
s_waitcnt lgkmcnt(12)
v_mfma_f32_16x16x32_bf16 a[204:207], a[120:123], a[176:179], a[204:207]
v_mfma_f32_16x16x32_bf16 a[200:203], a[120:123], a[172:175], 0
v_mfma_f32_16x16x32_bf16 a[200:203], a[88:91], a[164:167], a[200:203]
v_mfma_f32_16x16x32_bf16 a[208:211], a[92:95], a[164:167], 0
s_waitcnt vmcnt(23) lgkmcnt(0)
s_barrier
v_mfma_f32_16x16x32_bf16 a[208:211], a[124:127], a[172:175], a[208:211]
s_add_u32 m0, s101, 16384
ds_read_b64_tr_b16 a[36:37], v2 offset:32768
v_mfma_f32_16x16x32_bf16 a[212:215], a[124:127], a[176:179], 0
ds_read_b64_tr_b16 a[38:39], v2 offset:33792
v_mfma_f32_16x16x32_bf16 a[212:215], a[92:95], a[168:171], a[212:215]
buffer_store_dwordx4 v[72:75], v0, s[20:23], s90 offen offset:1024 sc1
v_mfma_f32_16x16x32_bf16 a[220:223], a[96:99], a[168:171], 0
ds_read_b64_tr_b16 a[40:41], v3 offset:32768
v_mfma_f32_16x16x32_bf16 a[220:223], a[128:131], a[176:179], a[220:223]
ds_read_b64_tr_b16 a[42:43], v3 offset:33792
v_mfma_f32_16x16x32_bf16 a[216:219], a[128:131], a[172:175], 0
buffer_load_dwordx4 v33, s[16:19], s86 offen offset:0 lds
v_mfma_f32_16x16x32_bf16 a[216:219], a[96:99], a[164:167], a[216:219]
ds_read_b64_tr_b16 a[44:45], v4 offset:32768
v_mfma_f32_16x16x32_bf16 v[36:39], a[56:59], a[80:83], 0
ds_read_b64_tr_b16 a[46:47], v4 offset:33792
v_mfma_f32_16x16x32_bf16 v[36:39], a[20:23], a[112:115], v[36:39]
buffer_load_dwordx4 v34, s[16:19], s86 offen offset:1024 lds
v_mfma_f32_16x16x32_bf16 v[252:255], a[20:23], a[108:111], 0
s_add_u32 s86, s86, 0x40000
ds_read_b64_tr_b16 a[48:49], v5 offset:32768
v_mfma_f32_16x16x32_bf16 v[252:255], a[56:59], a[76:79], v[252:255]
s_and_b32 s86, s86, 0x3c0000
ds_read_b64_tr_b16 a[50:51], v5 offset:33792
v_mfma_f32_16x16x32_bf16 v[248:251], a[56:59], a[72:75], 0
s_add_u32 m0, s97, 32768
s_add_u32 s74, s87, s98
v_mfma_f32_16x16x32_bf16 v[248:251], a[20:23], a[104:107], v[248:251]
ds_read_b64_tr_b16 a[52:53], v6 offset:32768
v_mfma_f32_16x16x32_bf16 v[244:247], a[20:23], a[100:103], 0
ds_read_b64_tr_b16 a[54:55], v6 offset:33792
v_mfma_f32_16x16x32_bf16 v[244:247], a[56:59], a[68:71], v[244:247]
buffer_load_dwordx4 v18, s[8:11], s74 offen offset:0 lds
v_mfma_f32_16x16x32_bf16 v[40:43], a[60:63], a[68:71], 0
ds_read_b128 a[84:87], v28 offset:0
v_mfma_f32_16x16x32_bf16 v[40:43], a[24:27], a[100:103], v[40:43]
ds_read_b128 a[88:91], v29 offset:512
v_mfma_f32_16x16x32_bf16 v[44:47], a[24:27], a[104:107], 0
buffer_store_dwordx4 v[76:79], v0, s[20:23], s90 offen offset:2048 sc1
v_mfma_f32_16x16x32_bf16 v[44:47], a[60:63], a[72:75], v[44:47]
ds_read_b128 a[92:95], v30 offset:1024
v_mfma_f32_16x16x32_bf16 v[48:51], a[60:63], a[76:79], 0
ds_read_b128 a[168:171], v32 offset:5120
v_mfma_f32_16x16x32_bf16 v[48:51], a[24:27], a[108:111], v[48:51]
buffer_load_dwordx4 v19, s[8:11], s74 offen offset:1024 lds
v_mfma_f32_16x16x32_bf16 v[52:55], a[24:27], a[112:115], 0
ds_read_b128 a[96:99], v31 offset:1536
v_mfma_f32_16x16x32_bf16 v[52:55], a[60:63], a[80:83], v[52:55]
ds_read_b128 a[164:167], v32 offset:4096
v_mfma_f32_16x16x32_bf16 v[68:71], a[64:67], a[80:83], 0
buffer_load_dwordx4 v22, s[8:11], s74 offen offset:2048 lds
v_mfma_f32_16x16x32_bf16 v[68:71], a[28:31], a[112:115], v[68:71]
ds_read_b64_tr_b16 a[56:57], v7 offset:32768
v_mfma_f32_16x16x32_bf16 v[64:67], a[28:31], a[108:111], 0
ds_read_b64_tr_b16 a[58:59], v7 offset:33792
v_mfma_f32_16x16x32_bf16 v[64:67], a[64:67], a[76:79], v[64:67]
buffer_load_dwordx4 v23, s[8:11], s74 offen offset:3072 lds
v_mfma_f32_16x16x32_bf16 v[60:63], a[64:67], a[72:75], 0
ds_read_b64_tr_b16 a[60:61], v8 offset:32768
v_mfma_f32_16x16x32_bf16 v[60:63], a[28:31], a[104:107], v[60:63]
ds_read_b64_tr_b16 a[62:63], v8 offset:33792
v_mfma_f32_16x16x32_bf16 v[56:59], a[28:31], a[100:103], 0
buffer_store_dwordx4 v[80:83], v0, s[20:23], s90 offen offset:3072 sc1
v_mfma_f32_16x16x32_bf16 v[56:59], a[64:67], a[68:71], v[56:59]
ds_read_b128 a[80:83], v26 offset:6144
v_mfma_f32_16x16x32_bf16 a[132:135], a[244:247], a[100:103], a[132:135]
ds_read_b128 a[76:79], v26 offset:4096
v_mfma_f32_16x16x32_bf16 a[136:139], a[244:247], a[104:107], a[136:139]
buffer_load_dwordx4 a[240:243], v25, s[32:35], s100 offen
v_mfma_f32_16x16x32_bf16 a[140:143], a[244:247], a[108:111], a[140:143]
s_add_u32 s100, s100, 64
ds_read_b128 a[72:75], v26 offset:2048
v_mfma_f32_16x16x32_bf16 a[144:147], a[244:247], a[112:115], a[144:147]
s_and_b32 s100, s100, 1023
ds_read_b64_tr_b16 a[64:65], v9 offset:32768
v_mfma_f32_16x16x32_bf16 v[176:179], a[0:3], a[112:115], v[176:179]
v_mfma_f32_16x16x32_bf16 v[172:175], a[0:3], a[108:111], v[172:175]
ds_read_b64_tr_b16 a[66:67], v9 offset:33792
v_mfma_f32_16x16x32_bf16 v[168:171], a[0:3], a[104:107], v[168:171]
ds_read_b128 a[68:71], v26 offset:0
v_mfma_f32_16x16x32_bf16 v[164:167], a[0:3], a[100:103], v[164:167]
v_mfma_f32_16x16x32_bf16 v[180:183], a[4:7], a[100:103], v[180:183]
v_mfma_f32_16x16x32_bf16 v[184:187], a[4:7], a[104:107], v[184:187]
v_mfma_f32_16x16x32_bf16 v[188:191], a[4:7], a[108:111], v[188:191]
v_mfma_f32_16x16x32_bf16 v[192:195], a[4:7], a[112:115], v[192:195]
s_waitcnt lgkmcnt(5)
v_mfma_f32_16x16x32_bf16 v[192:195], a[40:43], a[80:83], v[192:195]
s_waitcnt vmcnt(20) lgkmcnt(0)
s_barrier
v_mfma_f32_16x16x32_bf16 v[188:191], a[40:43], a[76:79], v[188:191]
s_add_u32 m0, s101, 32768
ds_read_b64_tr_b16 a[8:9], v4 offset:49152
v_mfma_f32_16x16x32_bf16 v[184:187], a[40:43], a[72:75], v[184:187]
ds_read_b64_tr_b16 a[10:11], v4 offset:50176
v_mfma_f32_16x16x32_bf16 v[180:183], a[40:43], a[68:71], v[180:183]
ds_read_b128 a[100:103], v27 offset:0
v_mfma_f32_16x16x32_bf16 v[164:167], a[36:39], a[68:71], v[164:167]
ds_read_b128 a[104:107], v27 offset:2048
v_mfma_f32_16x16x32_bf16 v[168:171], a[36:39], a[72:75], v[168:171]
ds_read_b128 a[108:111], v27 offset:4096
v_mfma_f32_16x16x32_bf16 v[172:175], a[36:39], a[76:79], v[172:175]
ds_read_b128 a[112:115], v27 offset:6144
v_mfma_f32_16x16x32_bf16 v[176:179], a[36:39], a[80:83], v[176:179]
ds_read_b64_tr_b16 a[12:13], v5 offset:49152
v_mfma_f32_16x16x32_bf16 a[144:147], a[248:251], a[80:83], a[144:147]
ds_read_b64_tr_b16 a[14:15], v5 offset:50176
v_mfma_f32_16x16x32_bf16 a[140:143], a[248:251], a[76:79], a[140:143]
buffer_store_dwordx4 v[84:87], v0, s[20:23], s91 offen offset:0 sc1
v_mfma_f32_16x16x32_bf16 a[136:139], a[248:251], a[72:75], a[136:139]
ds_read_b64_tr_b16 a[16:17], v6 offset:49152
v_mfma_f32_16x16x32_bf16 a[132:135], a[248:251], a[68:71], a[132:135]
ds_read_b64_tr_b16 a[18:19], v6 offset:50176
v_mfma_f32_16x16x32_bf16 v[196:199], a[44:47], a[68:71], v[196:199]
s_waitcnt lgkmcnt(7)
buffer_load_dwordx4 v33, s[16:19], s86 offen offset:0 lds
v_mfma_f32_16x16x32_bf16 v[196:199], a[8:11], a[100:103], v[196:199]
s_waitcnt lgkmcnt(6)
ds_read_b128 a[116:119], v30 offset:0
v_mfma_f32_16x16x32_bf16 v[200:203], a[8:11], a[104:107], v[200:203]
ds_read_b128 a[172:175], v32 offset:6144
v_mfma_f32_16x16x32_bf16 v[200:203], a[44:47], a[72:75], v[200:203]
buffer_load_dwordx4 v34, s[16:19], s86 offen offset:1024 lds
v_mfma_f32_16x16x32_bf16 v[204:207], a[44:47], a[76:79], v[204:207]
s_waitcnt lgkmcnt(7)
s_add_u32 s86, s86, 0x40000
ds_read_b128 a[176:179], v32 offset:7168
v_mfma_f32_16x16x32_bf16 v[204:207], a[8:11], a[108:111], v[204:207]
s_waitcnt lgkmcnt(7)
s_and_b32 s86, s86, 0x3c0000
ds_read_b128 a[120:123], v31 offset:512
v_mfma_f32_16x16x32_bf16 v[208:211], a[8:11], a[112:115], v[208:211]
s_add_u32 m0, s97, 36864
s_add_u32 s74, s87, s99
v_mfma_f32_16x16x32_bf16 v[208:211], a[44:47], a[80:83], v[208:211]
ds_read_b64_tr_b16 a[0:1], v2 offset:49152
v_mfma_f32_16x16x32_bf16 v[224:227], a[48:51], a[80:83], v[224:227]
s_waitcnt lgkmcnt(7)
ds_read_b64_tr_b16 a[2:3], v2 offset:50176
v_mfma_f32_16x16x32_bf16 v[224:227], a[12:15], a[112:115], v[224:227]
buffer_load_dwordx4 v18, s[8:11], s74 offen offset:0 lds
v_mfma_f32_16x16x32_bf16 v[220:223], a[12:15], a[108:111], v[220:223]
ds_read_b64_tr_b16 a[4:5], v3 offset:49152
v_mfma_f32_16x16x32_bf16 v[220:223], a[48:51], a[76:79], v[220:223]
ds_read_b64_tr_b16 a[6:7], v3 offset:50176
v_mfma_f32_16x16x32_bf16 v[216:219], a[48:51], a[72:75], v[216:219]
buffer_store_dwordx4 v[88:91], v0, s[20:23], s91 offen offset:1024 sc1
v_mfma_f32_16x16x32_bf16 v[216:219], a[12:15], a[104:107], v[216:219]
ds_read_b64_tr_b16 a[20:21], v7 offset:49152
v_mfma_f32_16x16x32_bf16 v[212:215], a[12:15], a[100:103], v[212:215]
ds_read_b64_tr_b16 a[22:23], v7 offset:50176
v_mfma_f32_16x16x32_bf16 v[212:215], a[48:51], a[68:71], v[212:215]
buffer_load_dwordx4 v19, s[8:11], s74 offen offset:1024 lds
v_mfma_f32_16x16x32_bf16 v[228:231], a[52:55], a[68:71], v[228:231]
s_waitcnt lgkmcnt(10)
ds_read_b64_tr_b16 a[24:25], v8 offset:49152
v_mfma_f32_16x16x32_bf16 v[228:231], a[16:19], a[100:103], v[228:231]
ds_read_b64_tr_b16 a[26:27], v8 offset:50176
v_mfma_f32_16x16x32_bf16 v[232:235], a[16:19], a[104:107], v[232:235]
buffer_load_dwordx4 v22, s[8:11], s74 offen offset:2048 lds
v_mfma_f32_16x16x32_bf16 v[232:235], a[52:55], a[72:75], v[232:235]
ds_read_b64_tr_b16 a[28:29], v9 offset:49152
v_mfma_f32_16x16x32_bf16 v[236:239], a[52:55], a[76:79], v[236:239]
ds_read_b64_tr_b16 a[30:31], v9 offset:50176
v_mfma_f32_16x16x32_bf16 v[236:239], a[16:19], a[108:111], v[236:239]
buffer_load_dwordx4 v23, s[8:11], s74 offen offset:3072 lds
v_mfma_f32_16x16x32_bf16 v[240:243], a[16:19], a[112:115], v[240:243]
s_add_u32 s87, s87, 128
ds_read_b128 a[124:127], v28 offset:1024
v_mfma_f32_16x16x32_bf16 v[240:243], a[52:55], a[80:83], v[240:243]
s_and_b32 s87, s87, 1023
ds_read_b128 a[128:131], v29 offset:1536
v_mfma_f32_16x16x32_bf16 a[192:195], a[84:87], a[164:167], a[192:195]
s_waitcnt lgkmcnt(14)
buffer_load_dwordx4 a[244:247], v25, s[32:35], s100 offen
v_mfma_f32_16x16x32_bf16 a[192:195], a[116:119], a[172:175], a[192:195]
s_waitcnt lgkmcnt(13)
s_add_u32 s100, s100, 64
s_and_b32 s100, s100, 1023
v_mfma_f32_16x16x32_bf16 a[196:199], a[116:119], a[176:179], a[196:199]
v_mfma_f32_16x16x32_bf16 a[196:199], a[84:87], a[168:171], a[196:199]
v_mfma_f32_16x16x32_bf16 a[204:207], a[88:91], a[168:171], a[204:207]
s_waitcnt lgkmcnt(12)
v_mfma_f32_16x16x32_bf16 a[204:207], a[120:123], a[176:179], a[204:207]
v_mfma_f32_16x16x32_bf16 a[200:203], a[120:123], a[172:175], a[200:203]
v_mfma_f32_16x16x32_bf16 a[200:203], a[88:91], a[164:167], a[200:203]
v_mfma_f32_16x16x32_bf16 a[208:211], a[92:95], a[164:167], a[208:211]
s_waitcnt vmcnt(19) lgkmcnt(0)
s_barrier
v_mfma_f32_16x16x32_bf16 a[208:211], a[124:127], a[172:175], a[208:211]
s_add_u32 m0, s101, 49152
ds_read_b64_tr_b16 a[36:37], v2 offset:0
v_mfma_f32_16x16x32_bf16 a[212:215], a[124:127], a[176:179], a[212:215]
ds_read_b64_tr_b16 a[38:39], v2 offset:1024
v_mfma_f32_16x16x32_bf16 a[212:215], a[92:95], a[168:171], a[212:215]
buffer_store_dwordx4 v[92:95], v0, s[20:23], s91 offen offset:2048 sc1
v_mfma_f32_16x16x32_bf16 a[220:223], a[96:99], a[168:171], a[220:223]
ds_read_b64_tr_b16 a[40:41], v3 offset:0
v_mfma_f32_16x16x32_bf16 a[220:223], a[128:131], a[176:179], a[220:223]
ds_read_b64_tr_b16 a[42:43], v3 offset:1024
v_mfma_f32_16x16x32_bf16 a[216:219], a[128:131], a[172:175], a[216:219]
buffer_load_dwordx4 v33, s[16:19], s86 offen offset:0 lds
v_mfma_f32_16x16x32_bf16 a[216:219], a[96:99], a[164:167], a[216:219]
ds_read_b64_tr_b16 a[44:45], v4 offset:0
v_mfma_f32_16x16x32_bf16 v[36:39], a[56:59], a[80:83], v[36:39]
ds_read_b64_tr_b16 a[46:47], v4 offset:1024
v_mfma_f32_16x16x32_bf16 v[36:39], a[20:23], a[112:115], v[36:39]
buffer_load_dwordx4 v34, s[16:19], s86 offen offset:1024 lds
v_mfma_f32_16x16x32_bf16 v[252:255], a[20:23], a[108:111], v[252:255]
s_add_u32 s86, s86, 0x40000
ds_read_b64_tr_b16 a[48:49], v5 offset:0
v_mfma_f32_16x16x32_bf16 v[252:255], a[56:59], a[76:79], v[252:255]
s_and_b32 s86, s86, 0x3c0000
ds_read_b64_tr_b16 a[50:51], v5 offset:1024
v_mfma_f32_16x16x32_bf16 v[248:251], a[56:59], a[72:75], v[248:251]
s_add_u32 m0, s97, 0
s_add_u32 s74, s87, s98
v_mfma_f32_16x16x32_bf16 v[248:251], a[20:23], a[104:107], v[248:251]
ds_read_b64_tr_b16 a[52:53], v6 offset:0
v_mfma_f32_16x16x32_bf16 v[244:247], a[20:23], a[100:103], v[244:247]
ds_read_b64_tr_b16 a[54:55], v6 offset:1024
v_mfma_f32_16x16x32_bf16 v[244:247], a[56:59], a[68:71], v[244:247]
buffer_load_dwordx4 v18, s[8:11], s74 offen offset:0 lds
v_mfma_f32_16x16x32_bf16 v[40:43], a[60:63], a[68:71], v[40:43]
ds_read_b128 a[84:87], v28 offset:16384
v_mfma_f32_16x16x32_bf16 v[40:43], a[24:27], a[100:103], v[40:43]
ds_read_b128 a[88:91], v29 offset:16896
v_mfma_f32_16x16x32_bf16 v[44:47], a[24:27], a[104:107], v[44:47]
buffer_load_dwordx4 v19, s[8:11], s74 offen offset:1024 lds
v_mfma_f32_16x16x32_bf16 v[44:47], a[60:63], a[72:75], v[44:47]
ds_read_b128 a[92:95], v30 offset:17408
v_mfma_f32_16x16x32_bf16 v[48:51], a[60:63], a[76:79], v[48:51]
ds_read_b128 a[168:171], v32 offset:17408
v_mfma_f32_16x16x32_bf16 v[48:51], a[24:27], a[108:111], v[48:51]
buffer_load_dwordx4 v22, s[8:11], s74 offen offset:2048 lds
v_mfma_f32_16x16x32_bf16 v[52:55], a[24:27], a[112:115], v[52:55]
ds_read_b128 a[96:99], v31 offset:17920
v_mfma_f32_16x16x32_bf16 v[52:55], a[60:63], a[80:83], v[52:55]
ds_read_b128 a[164:167], v32 offset:16384
v_mfma_f32_16x16x32_bf16 v[68:71], a[64:67], a[80:83], v[68:71]
buffer_store_dwordx4 v[96:99], v0, s[20:23], s91 offen offset:3072 sc1
v_mfma_f32_16x16x32_bf16 v[68:71], a[28:31], a[112:115], v[68:71]
ds_read_b64_tr_b16 a[56:57], v7 offset:0
v_mfma_f32_16x16x32_bf16 v[64:67], a[28:31], a[108:111], v[64:67]
ds_read_b64_tr_b16 a[58:59], v7 offset:1024
v_mfma_f32_16x16x32_bf16 v[64:67], a[64:67], a[76:79], v[64:67]
buffer_load_dwordx4 v23, s[8:11], s74 offen offset:3072 lds
v_mfma_f32_16x16x32_bf16 v[60:63], a[64:67], a[72:75], v[60:63]
ds_read_b64_tr_b16 a[60:61], v8 offset:0
v_mfma_f32_16x16x32_bf16 v[60:63], a[28:31], a[104:107], v[60:63]
ds_read_b64_tr_b16 a[62:63], v8 offset:1024
v_mfma_f32_16x16x32_bf16 v[56:59], a[28:31], a[100:103], v[56:59]
buffer_load_dwordx4 a[248:251], v25, s[32:35], s100 offen
v_mfma_f32_16x16x32_bf16 v[56:59], a[64:67], a[68:71], v[56:59]
s_add_u32 s100, s100, 64
ds_read_b128 a[80:83], v26 offset:22528
v_mfma_f32_16x16x32_bf16 a[132:135], a[252:255], a[100:103], a[132:135]
s_and_b32 s100, s100, 1023
ds_read_b128 a[76:79], v26 offset:20480
v_mfma_f32_16x16x32_bf16 a[136:139], a[252:255], a[104:107], a[136:139]
v_mfma_f32_16x16x32_bf16 a[140:143], a[252:255], a[108:111], a[140:143]
ds_read_b128 a[72:75], v26 offset:18432
v_mfma_f32_16x16x32_bf16 a[144:147], a[252:255], a[112:115], a[144:147]
ds_read_b64_tr_b16 a[64:65], v9 offset:0
v_mfma_f32_16x16x32_bf16 v[176:179], a[0:3], a[112:115], v[176:179]
v_mfma_f32_16x16x32_bf16 v[172:175], a[0:3], a[108:111], v[172:175]
ds_read_b64_tr_b16 a[66:67], v9 offset:1024
v_mfma_f32_16x16x32_bf16 v[168:171], a[0:3], a[104:107], v[168:171]
ds_read_b128 a[68:71], v26 offset:16384
v_mfma_f32_16x16x32_bf16 v[164:167], a[0:3], a[100:103], v[164:167]
v_mfma_f32_16x16x32_bf16 v[180:183], a[4:7], a[100:103], v[180:183]
v_mfma_f32_16x16x32_bf16 v[184:187], a[4:7], a[104:107], v[184:187]
v_mfma_f32_16x16x32_bf16 v[188:191], a[4:7], a[108:111], v[188:191]
v_mfma_f32_16x16x32_bf16 v[192:195], a[4:7], a[112:115], v[192:195]
s_waitcnt lgkmcnt(5)
v_mfma_f32_16x16x32_bf16 v[192:195], a[40:43], a[80:83], v[192:195]
s_waitcnt vmcnt(18) lgkmcnt(0)
s_barrier
v_mfma_f32_16x16x32_bf16 v[188:191], a[40:43], a[76:79], v[188:191]
s_add_u32 m0, s101, 0
ds_read_b64_tr_b16 a[8:9], v4 offset:16384
v_mfma_f32_16x16x32_bf16 v[184:187], a[40:43], a[72:75], v[184:187]
ds_read_b64_tr_b16 a[10:11], v4 offset:17408
v_mfma_f32_16x16x32_bf16 v[180:183], a[40:43], a[68:71], v[180:183]
ds_read_b128 a[100:103], v27 offset:16384
v_mfma_f32_16x16x32_bf16 v[164:167], a[36:39], a[68:71], v[164:167]
ds_read_b128 a[104:107], v27 offset:18432
v_mfma_f32_16x16x32_bf16 v[168:171], a[36:39], a[72:75], v[168:171]
ds_read_b128 a[108:111], v27 offset:20480
v_mfma_f32_16x16x32_bf16 v[172:175], a[36:39], a[76:79], v[172:175]
ds_read_b128 a[112:115], v27 offset:22528
v_mfma_f32_16x16x32_bf16 v[176:179], a[36:39], a[80:83], v[176:179]
ds_read_b64_tr_b16 a[12:13], v5 offset:16384
v_mfma_f32_16x16x32_bf16 a[144:147], a[240:243], a[80:83], a[144:147]
ds_read_b64_tr_b16 a[14:15], v5 offset:17408
v_mfma_f32_16x16x32_bf16 a[140:143], a[240:243], a[76:79], a[140:143]
buffer_store_dwordx4 v[100:103], v0, s[20:23], s92 offen offset:0 sc1
v_mfma_f32_16x16x32_bf16 a[136:139], a[240:243], a[72:75], a[136:139]
ds_read_b64_tr_b16 a[16:17], v6 offset:16384
v_mfma_f32_16x16x32_bf16 a[132:135], a[240:243], a[68:71], a[132:135]
ds_read_b64_tr_b16 a[18:19], v6 offset:17408
v_mfma_f32_16x16x32_bf16 v[196:199], a[44:47], a[68:71], v[196:199]
s_waitcnt lgkmcnt(7)
buffer_load_dwordx4 v33, s[16:19], s86 offen offset:0 lds
v_mfma_f32_16x16x32_bf16 v[196:199], a[8:11], a[100:103], v[196:199]
s_waitcnt lgkmcnt(6)
ds_read_b128 a[116:119], v30 offset:16384
v_mfma_f32_16x16x32_bf16 v[200:203], a[8:11], a[104:107], v[200:203]
ds_read_b128 a[172:175], v32 offset:18432
v_mfma_f32_16x16x32_bf16 v[200:203], a[44:47], a[72:75], v[200:203]
buffer_load_dwordx4 v34, s[16:19], s86 offen offset:1024 lds
v_mfma_f32_16x16x32_bf16 v[204:207], a[44:47], a[76:79], v[204:207]
s_waitcnt lgkmcnt(7)
s_add_u32 s86, s86, 0x40000
ds_read_b128 a[176:179], v32 offset:19456
v_mfma_f32_16x16x32_bf16 v[204:207], a[8:11], a[108:111], v[204:207]
s_waitcnt lgkmcnt(7)
s_and_b32 s86, s86, 0x3c0000
ds_read_b128 a[120:123], v31 offset:16896
v_mfma_f32_16x16x32_bf16 v[208:211], a[8:11], a[112:115], v[208:211]
s_add_u32 m0, s97, 4096
s_add_u32 s74, s87, s99
v_mfma_f32_16x16x32_bf16 v[208:211], a[44:47], a[80:83], v[208:211]
ds_read_b64_tr_b16 a[0:1], v2 offset:16384
v_mfma_f32_16x16x32_bf16 v[224:227], a[48:51], a[80:83], v[224:227]
s_waitcnt lgkmcnt(7)
ds_read_b64_tr_b16 a[2:3], v2 offset:17408
v_mfma_f32_16x16x32_bf16 v[224:227], a[12:15], a[112:115], v[224:227]
buffer_load_dwordx4 v18, s[8:11], s74 offen offset:0 lds
v_mfma_f32_16x16x32_bf16 v[220:223], a[12:15], a[108:111], v[220:223]
ds_read_b64_tr_b16 a[4:5], v3 offset:16384
v_mfma_f32_16x16x32_bf16 v[220:223], a[48:51], a[76:79], v[220:223]
ds_read_b64_tr_b16 a[6:7], v3 offset:17408
v_mfma_f32_16x16x32_bf16 v[216:219], a[48:51], a[72:75], v[216:219]
buffer_store_dwordx4 v[104:107], v0, s[20:23], s92 offen offset:1024 sc1
v_mfma_f32_16x16x32_bf16 v[216:219], a[12:15], a[104:107], v[216:219]
ds_read_b64_tr_b16 a[20:21], v7 offset:16384
v_mfma_f32_16x16x32_bf16 v[212:215], a[12:15], a[100:103], v[212:215]
ds_read_b64_tr_b16 a[22:23], v7 offset:17408
v_mfma_f32_16x16x32_bf16 v[212:215], a[48:51], a[68:71], v[212:215]
buffer_load_dwordx4 v19, s[8:11], s74 offen offset:1024 lds
v_mfma_f32_16x16x32_bf16 v[228:231], a[52:55], a[68:71], v[228:231]
s_waitcnt lgkmcnt(10)
ds_read_b64_tr_b16 a[24:25], v8 offset:16384
v_mfma_f32_16x16x32_bf16 v[228:231], a[16:19], a[100:103], v[228:231]
ds_read_b64_tr_b16 a[26:27], v8 offset:17408
v_mfma_f32_16x16x32_bf16 v[232:235], a[16:19], a[104:107], v[232:235]
buffer_load_dwordx4 v22, s[8:11], s74 offen offset:2048 lds
v_mfma_f32_16x16x32_bf16 v[232:235], a[52:55], a[72:75], v[232:235]
ds_read_b64_tr_b16 a[28:29], v9 offset:16384
v_mfma_f32_16x16x32_bf16 v[236:239], a[52:55], a[76:79], v[236:239]
ds_read_b64_tr_b16 a[30:31], v9 offset:17408
v_mfma_f32_16x16x32_bf16 v[236:239], a[16:19], a[108:111], v[236:239]
buffer_load_dwordx4 v23, s[8:11], s74 offen offset:3072 lds
v_mfma_f32_16x16x32_bf16 v[240:243], a[16:19], a[112:115], v[240:243]
s_add_u32 s87, s87, 128
ds_read_b128 a[124:127], v28 offset:17408
v_mfma_f32_16x16x32_bf16 v[240:243], a[52:55], a[80:83], v[240:243]
s_and_b32 s87, s87, 1023
ds_read_b128 a[128:131], v29 offset:17920
v_mfma_f32_16x16x32_bf16 a[192:195], a[84:87], a[164:167], a[192:195]
s_waitcnt lgkmcnt(14)
buffer_load_dwordx4 a[252:255], v25, s[32:35], s100 offen
v_mfma_f32_16x16x32_bf16 a[192:195], a[116:119], a[172:175], a[192:195]
s_waitcnt lgkmcnt(13)
s_add_u32 s100, s100, 64
s_and_b32 s100, s100, 1023
v_mfma_f32_16x16x32_bf16 a[196:199], a[116:119], a[176:179], a[196:199]
buffer_load_dword v35, off, s[24:27], 0 sc1
v_mfma_f32_16x16x32_bf16 a[196:199], a[84:87], a[168:171], a[196:199]
v_mfma_f32_16x16x32_bf16 a[204:207], a[88:91], a[168:171], a[204:207]
s_waitcnt lgkmcnt(12)
v_mfma_f32_16x16x32_bf16 a[204:207], a[120:123], a[176:179], a[204:207]
v_mfma_f32_16x16x32_bf16 a[200:203], a[120:123], a[172:175], a[200:203]
v_mfma_f32_16x16x32_bf16 a[200:203], a[88:91], a[164:167], a[200:203]
v_mfma_f32_16x16x32_bf16 a[208:211], a[92:95], a[164:167], a[208:211]
s_waitcnt vmcnt(19) lgkmcnt(0)
s_barrier
v_mfma_f32_16x16x32_bf16 a[208:211], a[124:127], a[172:175], a[208:211]
s_add_u32 m0, s101, 16384
ds_read_b64_tr_b16 a[36:37], v2 offset:32768
v_mfma_f32_16x16x32_bf16 a[212:215], a[124:127], a[176:179], a[212:215]
ds_read_b64_tr_b16 a[38:39], v2 offset:33792
v_mfma_f32_16x16x32_bf16 a[212:215], a[92:95], a[168:171], a[212:215]
buffer_store_dwordx4 v[108:111], v0, s[20:23], s92 offen offset:2048 sc1
v_mfma_f32_16x16x32_bf16 a[220:223], a[96:99], a[168:171], a[220:223]
ds_read_b64_tr_b16 a[40:41], v3 offset:32768
v_mfma_f32_16x16x32_bf16 a[220:223], a[128:131], a[176:179], a[220:223]
ds_read_b64_tr_b16 a[42:43], v3 offset:33792
v_mfma_f32_16x16x32_bf16 a[216:219], a[128:131], a[172:175], a[216:219]
buffer_load_dwordx4 v33, s[16:19], s86 offen offset:0 lds
v_mfma_f32_16x16x32_bf16 a[216:219], a[96:99], a[164:167], a[216:219]
ds_read_b64_tr_b16 a[44:45], v4 offset:32768
v_mfma_f32_16x16x32_bf16 v[36:39], a[56:59], a[80:83], v[36:39]
ds_read_b64_tr_b16 a[46:47], v4 offset:33792
v_mfma_f32_16x16x32_bf16 v[36:39], a[20:23], a[112:115], v[36:39]
buffer_load_dwordx4 v34, s[16:19], s86 offen offset:1024 lds
v_mfma_f32_16x16x32_bf16 v[252:255], a[20:23], a[108:111], v[252:255]
s_add_u32 s86, s86, 0x40000
ds_read_b64_tr_b16 a[48:49], v5 offset:32768
v_mfma_f32_16x16x32_bf16 v[252:255], a[56:59], a[76:79], v[252:255]
s_and_b32 s86, s86, 0x3c0000
ds_read_b64_tr_b16 a[50:51], v5 offset:33792
v_mfma_f32_16x16x32_bf16 v[248:251], a[56:59], a[72:75], v[248:251]
s_add_u32 m0, s97, 16384
s_add_u32 s74, s87, s98
v_mfma_f32_16x16x32_bf16 v[248:251], a[20:23], a[104:107], v[248:251]
ds_read_b64_tr_b16 a[52:53], v6 offset:32768
v_mfma_f32_16x16x32_bf16 v[244:247], a[20:23], a[100:103], v[244:247]
ds_read_b64_tr_b16 a[54:55], v6 offset:33792
v_mfma_f32_16x16x32_bf16 v[244:247], a[56:59], a[68:71], v[244:247]
buffer_load_dwordx4 v18, s[8:11], s74 offen offset:0 lds
v_mfma_f32_16x16x32_bf16 v[40:43], a[60:63], a[68:71], v[40:43]
ds_read_b128 a[84:87], v28 offset:32768
v_mfma_f32_16x16x32_bf16 v[40:43], a[24:27], a[100:103], v[40:43]
ds_read_b128 a[88:91], v29 offset:33280
v_mfma_f32_16x16x32_bf16 v[44:47], a[24:27], a[104:107], v[44:47]
buffer_load_dwordx4 v19, s[8:11], s74 offen offset:1024 lds
v_mfma_f32_16x16x32_bf16 v[44:47], a[60:63], a[72:75], v[44:47]
ds_read_b128 a[92:95], v30 offset:33792
v_mfma_f32_16x16x32_bf16 v[48:51], a[60:63], a[76:79], v[48:51]
ds_read_b128 a[168:171], v32 offset:21504
v_mfma_f32_16x16x32_bf16 v[48:51], a[24:27], a[108:111], v[48:51]
buffer_load_dwordx4 v22, s[8:11], s74 offen offset:2048 lds
v_mfma_f32_16x16x32_bf16 v[52:55], a[24:27], a[112:115], v[52:55]
ds_read_b128 a[96:99], v31 offset:34304
v_mfma_f32_16x16x32_bf16 v[52:55], a[60:63], a[80:83], v[52:55]
ds_read_b128 a[164:167], v32 offset:20480
v_mfma_f32_16x16x32_bf16 v[68:71], a[64:67], a[80:83], v[68:71]
buffer_store_dwordx4 v[112:115], v0, s[20:23], s92 offen offset:3072 sc1
v_mfma_f32_16x16x32_bf16 v[68:71], a[28:31], a[112:115], v[68:71]
ds_read_b64_tr_b16 a[56:57], v7 offset:32768
v_mfma_f32_16x16x32_bf16 v[64:67], a[28:31], a[108:111], v[64:67]
ds_read_b64_tr_b16 a[58:59], v7 offset:33792
v_mfma_f32_16x16x32_bf16 v[64:67], a[64:67], a[76:79], v[64:67]
buffer_load_dwordx4 v23, s[8:11], s74 offen offset:3072 lds
v_mfma_f32_16x16x32_bf16 v[60:63], a[64:67], a[72:75], v[60:63]
ds_read_b64_tr_b16 a[60:61], v8 offset:32768
v_mfma_f32_16x16x32_bf16 v[60:63], a[28:31], a[104:107], v[60:63]
ds_read_b64_tr_b16 a[62:63], v8 offset:33792
v_mfma_f32_16x16x32_bf16 v[56:59], a[28:31], a[100:103], v[56:59]
buffer_load_dwordx4 a[240:243], v25, s[32:35], s100 offen
v_mfma_f32_16x16x32_bf16 v[56:59], a[64:67], a[68:71], v[56:59]
s_add_u32 s100, s100, 64
ds_read_b128 a[80:83], v26 offset:38912
v_mfma_f32_16x16x32_bf16 a[132:135], a[244:247], a[100:103], a[132:135]
s_and_b32 s100, s100, 1023
ds_read_b128 a[76:79], v26 offset:36864
v_mfma_f32_16x16x32_bf16 a[136:139], a[244:247], a[104:107], a[136:139]
v_mfma_f32_16x16x32_bf16 a[140:143], a[244:247], a[108:111], a[140:143]
ds_read_b128 a[72:75], v26 offset:34816
v_mfma_f32_16x16x32_bf16 a[144:147], a[244:247], a[112:115], a[144:147]
ds_read_b64_tr_b16 a[64:65], v9 offset:32768
v_mfma_f32_16x16x32_bf16 v[176:179], a[0:3], a[112:115], v[176:179]
v_mfma_f32_16x16x32_bf16 v[172:175], a[0:3], a[108:111], v[172:175]
ds_read_b64_tr_b16 a[66:67], v9 offset:33792
v_mfma_f32_16x16x32_bf16 v[168:171], a[0:3], a[104:107], v[168:171]
ds_read_b128 a[68:71], v26 offset:32768
v_mfma_f32_16x16x32_bf16 v[164:167], a[0:3], a[100:103], v[164:167]
v_mfma_f32_16x16x32_bf16 v[180:183], a[4:7], a[100:103], v[180:183]
v_mfma_f32_16x16x32_bf16 v[184:187], a[4:7], a[104:107], v[184:187]
v_mfma_f32_16x16x32_bf16 v[188:191], a[4:7], a[108:111], v[188:191]
v_mfma_f32_16x16x32_bf16 v[192:195], a[4:7], a[112:115], v[192:195]
s_waitcnt lgkmcnt(5)
v_mfma_f32_16x16x32_bf16 v[192:195], a[40:43], a[80:83], v[192:195]
s_waitcnt vmcnt(19) lgkmcnt(0)
s_barrier
s_cmp_lg_u32 s80, 0
s_cbranch_scc1 LA_f1
s_mov_b64 exec, 1
v_mov_b32 v1, 1
s_lshl2_add_u32 s75, s82, s40
buffer_store_dword v1, off, s[76:79], s75 offset:0 sc1
s_lshl2_add_u32 s75, s84, s41
buffer_store_dword v1, off, s[76:79], s75 sc1
s_mov_b64 exec, -1
LA_f1:
v_mfma_f32_16x16x32_bf16 v[188:191], a[40:43], a[76:79], v[188:191]
s_add_u32 m0, s101, 32768
ds_read_b64_tr_b16 a[8:9], v4 offset:49152
v_mfma_f32_16x16x32_bf16 v[184:187], a[40:43], a[72:75], v[184:187]
ds_read_b64_tr_b16 a[10:11], v4 offset:50176
v_mfma_f32_16x16x32_bf16 v[180:183], a[40:43], a[68:71], v[180:183]
ds_read_b128 a[100:103], v27 offset:32768
v_mfma_f32_16x16x32_bf16 v[164:167], a[36:39], a[68:71], v[164:167]
ds_read_b128 a[104:107], v27 offset:34816
v_mfma_f32_16x16x32_bf16 v[168:171], a[36:39], a[72:75], v[168:171]
ds_read_b128 a[108:111], v27 offset:36864
v_mfma_f32_16x16x32_bf16 v[172:175], a[36:39], a[76:79], v[172:175]
ds_read_b128 a[112:115], v27 offset:38912
v_mfma_f32_16x16x32_bf16 v[176:179], a[36:39], a[80:83], v[176:179]
ds_read_b64_tr_b16 a[12:13], v5 offset:49152
v_mfma_f32_16x16x32_bf16 a[144:147], a[248:251], a[80:83], a[144:147]
ds_read_b64_tr_b16 a[14:15], v5 offset:50176
v_mfma_f32_16x16x32_bf16 a[140:143], a[248:251], a[76:79], a[140:143]
buffer_store_dwordx4 v[116:119], v0, s[20:23], s93 offen offset:0 sc1
v_mfma_f32_16x16x32_bf16 a[136:139], a[248:251], a[72:75], a[136:139]
ds_read_b64_tr_b16 a[16:17], v6 offset:49152
v_mfma_f32_16x16x32_bf16 a[132:135], a[248:251], a[68:71], a[132:135]
ds_read_b64_tr_b16 a[18:19], v6 offset:50176
v_mfma_f32_16x16x32_bf16 v[196:199], a[44:47], a[68:71], v[196:199]
s_waitcnt lgkmcnt(7)
buffer_load_dwordx4 v33, s[16:19], s86 offen offset:0 lds
v_mfma_f32_16x16x32_bf16 v[196:199], a[8:11], a[100:103], v[196:199]
s_waitcnt lgkmcnt(6)
ds_read_b128 a[116:119], v30 offset:32768
v_mfma_f32_16x16x32_bf16 v[200:203], a[8:11], a[104:107], v[200:203]
ds_read_b128 a[172:175], v32 offset:22528
v_mfma_f32_16x16x32_bf16 v[200:203], a[44:47], a[72:75], v[200:203]
buffer_load_dwordx4 v34, s[16:19], s86 offen offset:1024 lds
v_mfma_f32_16x16x32_bf16 v[204:207], a[44:47], a[76:79], v[204:207]
s_waitcnt lgkmcnt(7)
s_add_u32 s86, s86, 0x40000
ds_read_b128 a[176:179], v32 offset:23552
v_mfma_f32_16x16x32_bf16 v[204:207], a[8:11], a[108:111], v[204:207]
s_waitcnt lgkmcnt(7)
s_and_b32 s86, s86, 0x3c0000
ds_read_b128 a[120:123], v31 offset:33280
v_mfma_f32_16x16x32_bf16 v[208:211], a[8:11], a[112:115], v[208:211]
s_add_u32 m0, s97, 20480
s_add_u32 s74, s87, s99
v_mfma_f32_16x16x32_bf16 v[208:211], a[44:47], a[80:83], v[208:211]
ds_read_b64_tr_b16 a[0:1], v2 offset:49152
v_mfma_f32_16x16x32_bf16 v[224:227], a[48:51], a[80:83], v[224:227]
s_waitcnt lgkmcnt(7)
ds_read_b64_tr_b16 a[2:3], v2 offset:50176
v_mfma_f32_16x16x32_bf16 v[224:227], a[12:15], a[112:115], v[224:227]
buffer_load_dwordx4 v18, s[8:11], s74 offen offset:0 lds
v_mfma_f32_16x16x32_bf16 v[220:223], a[12:15], a[108:111], v[220:223]
ds_read_b64_tr_b16 a[4:5], v3 offset:49152
v_mfma_f32_16x16x32_bf16 v[220:223], a[48:51], a[76:79], v[220:223]
ds_read_b64_tr_b16 a[6:7], v3 offset:50176
v_mfma_f32_16x16x32_bf16 v[216:219], a[48:51], a[72:75], v[216:219]
buffer_store_dwordx4 v[120:123], v0, s[20:23], s93 offen offset:1024 sc1
v_mfma_f32_16x16x32_bf16 v[216:219], a[12:15], a[104:107], v[216:219]
ds_read_b64_tr_b16 a[20:21], v7 offset:49152
v_mfma_f32_16x16x32_bf16 v[212:215], a[12:15], a[100:103], v[212:215]
ds_read_b64_tr_b16 a[22:23], v7 offset:50176
v_mfma_f32_16x16x32_bf16 v[212:215], a[48:51], a[68:71], v[212:215]
buffer_load_dwordx4 v19, s[8:11], s74 offen offset:1024 lds
v_mfma_f32_16x16x32_bf16 v[228:231], a[52:55], a[68:71], v[228:231]
s_waitcnt lgkmcnt(10)
ds_read_b64_tr_b16 a[24:25], v8 offset:49152
v_mfma_f32_16x16x32_bf16 v[228:231], a[16:19], a[100:103], v[228:231]
ds_read_b64_tr_b16 a[26:27], v8 offset:50176
v_mfma_f32_16x16x32_bf16 v[232:235], a[16:19], a[104:107], v[232:235]
buffer_load_dwordx4 v22, s[8:11], s74 offen offset:2048 lds
v_mfma_f32_16x16x32_bf16 v[232:235], a[52:55], a[72:75], v[232:235]
ds_read_b64_tr_b16 a[28:29], v9 offset:49152
v_mfma_f32_16x16x32_bf16 v[236:239], a[52:55], a[76:79], v[236:239]
ds_read_b64_tr_b16 a[30:31], v9 offset:50176
v_mfma_f32_16x16x32_bf16 v[236:239], a[16:19], a[108:111], v[236:239]
buffer_load_dwordx4 v23, s[8:11], s74 offen offset:3072 lds
v_mfma_f32_16x16x32_bf16 v[240:243], a[16:19], a[112:115], v[240:243]
s_add_u32 s87, s87, 128
ds_read_b128 a[124:127], v28 offset:33792
v_mfma_f32_16x16x32_bf16 v[240:243], a[52:55], a[80:83], v[240:243]
s_and_b32 s87, s87, 1023
ds_read_b128 a[128:131], v29 offset:34304
v_mfma_f32_16x16x32_bf16 a[192:195], a[84:87], a[164:167], a[192:195]
s_waitcnt lgkmcnt(14)
buffer_load_dwordx4 a[244:247], v25, s[32:35], s100 offen
v_mfma_f32_16x16x32_bf16 a[192:195], a[116:119], a[172:175], a[192:195]
s_waitcnt lgkmcnt(13)
s_add_u32 s100, s100, 64
s_and_b32 s100, s100, 1023
v_mfma_f32_16x16x32_bf16 a[196:199], a[116:119], a[176:179], a[196:199]
v_mfma_f32_16x16x32_bf16 a[196:199], a[84:87], a[168:171], a[196:199]
v_mfma_f32_16x16x32_bf16 a[204:207], a[88:91], a[168:171], a[204:207]
s_waitcnt lgkmcnt(12)
v_mfma_f32_16x16x32_bf16 a[204:207], a[120:123], a[176:179], a[204:207]
v_mfma_f32_16x16x32_bf16 a[200:203], a[120:123], a[172:175], a[200:203]
v_mfma_f32_16x16x32_bf16 a[200:203], a[88:91], a[164:167], a[200:203]
v_mfma_f32_16x16x32_bf16 a[208:211], a[92:95], a[164:167], a[208:211]
s_waitcnt vmcnt(18) lgkmcnt(0)
s_barrier
v_mfma_f32_16x16x32_bf16 a[208:211], a[124:127], a[172:175], a[208:211]
s_add_u32 m0, s101, 49152
ds_read_b64_tr_b16 a[36:37], v2 offset:0
v_mfma_f32_16x16x32_bf16 a[212:215], a[124:127], a[176:179], a[212:215]
ds_read_b64_tr_b16 a[38:39], v2 offset:1024
v_accvgpr_read_b32 v73, a180
v_mfma_f32_16x16x32_bf16 a[212:215], a[92:95], a[168:171], a[212:215]
buffer_store_dwordx4 v[124:127], v0, s[20:23], s93 offen offset:2048 sc1
v_mfma_f32_16x16x32_bf16 a[220:223], a[96:99], a[168:171], a[220:223]
ds_read_b64_tr_b16 a[40:41], v3 offset:0
v_accvgpr_read_b32 v74, a181
v_mfma_f32_16x16x32_bf16 a[220:223], a[128:131], a[176:179], a[220:223]
ds_read_b64_tr_b16 a[42:43], v3 offset:1024
v_accvgpr_read_b32 v75, a182
v_mfma_f32_16x16x32_bf16 a[216:219], a[128:131], a[172:175], a[216:219]
buffer_load_dwordx4 v33, s[16:19], s86 offen offset:0 lds
v_mfma_f32_16x16x32_bf16 a[216:219], a[96:99], a[164:167], a[216:219]
ds_read_b64_tr_b16 a[44:45], v4 offset:0
v_lshlrev_b32 v73, 16, v73
v_mfma_f32_16x16x32_bf16 v[36:39], a[56:59], a[80:83], v[36:39]
ds_read_b64_tr_b16 a[46:47], v4 offset:1024
v_lshlrev_b32 v74, 16, v74
v_mfma_f32_16x16x32_bf16 v[36:39], a[20:23], a[112:115], v[36:39]
buffer_load_dwordx4 v34, s[16:19], s86 offen offset:1024 lds
v_mfma_f32_16x16x32_bf16 v[252:255], a[20:23], a[108:111], v[252:255]
s_add_u32 s86, s86, 0x40000
ds_read_b64_tr_b16 a[48:49], v5 offset:0
v_mfma_f32_16x16x32_bf16 v[252:255], a[56:59], a[76:79], v[252:255]
s_and_b32 s86, s86, 0x3c0000
ds_read_b64_tr_b16 a[50:51], v5 offset:1024
v_mfma_f32_16x16x32_bf16 v[248:251], a[56:59], a[72:75], v[248:251]
s_add_u32 m0, s97, 32768
s_add_u32 s74, s87, s98
v_mfma_f32_16x16x32_bf16 v[248:251], a[20:23], a[104:107], v[248:251]
ds_read_b64_tr_b16 a[52:53], v6 offset:0
v_lshlrev_b32 v75, 16, v75
v_mfma_f32_16x16x32_bf16 v[244:247], a[20:23], a[100:103], v[244:247]
ds_read_b64_tr_b16 a[54:55], v6 offset:1024
v_mul_f32 v75, 0x3fb8aa3b, v75
v_mfma_f32_16x16x32_bf16 v[244:247], a[56:59], a[68:71], v[244:247]
buffer_load_dwordx4 v18, s[8:11], s74 offen offset:0 lds
v_mfma_f32_16x16x32_bf16 v[40:43], a[60:63], a[68:71], v[40:43]
ds_read_b128 a[84:87], v28 offset:0
v_mfma_f32_16x16x32_bf16 v[40:43], a[24:27], a[100:103], v[40:43]
ds_read_b128 a[88:91], v29 offset:512
v_mfma_f32_16x16x32_bf16 v[44:47], a[24:27], a[104:107], v[44:47]
buffer_load_dwordx4 v19, s[8:11], s74 offen offset:1024 lds
v_mfma_f32_16x16x32_bf16 v[44:47], a[60:63], a[72:75], v[44:47]
ds_read_b128 a[92:95], v30 offset:1024
v_mfma_f32_16x16x32_bf16 v[48:51], a[60:63], a[76:79], v[48:51]
ds_read_b128 a[168:171], v32 offset:33792
v_mfma_f32_16x16x32_bf16 v[48:51], a[24:27], a[108:111], v[48:51]
buffer_load_dwordx4 v22, s[8:11], s74 offen offset:2048 lds
v_mfma_f32_16x16x32_bf16 v[52:55], a[24:27], a[112:115], v[52:55]
ds_read_b128 a[96:99], v31 offset:1536
v_mfma_f32_16x16x32_bf16 v[52:55], a[60:63], a[80:83], v[52:55]
ds_read_b128 a[164:167], v32 offset:32768
v_mfma_f32_16x16x32_bf16 v[68:71], a[64:67], a[80:83], v[68:71]
buffer_store_dwordx4 v[128:131], v0, s[20:23], s93 offen offset:3072 sc1
v_mfma_f32_16x16x32_bf16 v[68:71], a[28:31], a[112:115], v[68:71]
ds_read_b64_tr_b16 a[56:57], v7 offset:0
v_mfma_f32_16x16x32_bf16 v[64:67], a[28:31], a[108:111], v[64:67]
ds_read_b64_tr_b16 a[58:59], v7 offset:1024
v_mfma_f32_16x16x32_bf16 v[64:67], a[64:67], a[76:79], v[64:67]
buffer_load_dwordx4 v23, s[8:11], s74 offen offset:3072 lds
v_mfma_f32_16x16x32_bf16 v[60:63], a[64:67], a[72:75], v[60:63]
ds_read_b64_tr_b16 a[60:61], v8 offset:0
v_mfma_f32_16x16x32_bf16 v[60:63], a[28:31], a[104:107], v[60:63]
ds_read_b64_tr_b16 a[62:63], v8 offset:1024
v_mfma_f32_16x16x32_bf16 v[56:59], a[28:31], a[100:103], v[56:59]
buffer_load_dwordx4 a[248:251], v25, s[32:35], s100 offen
v_mfma_f32_16x16x32_bf16 v[56:59], a[64:67], a[68:71], v[56:59]
s_add_u32 s100, s100, 64
ds_read_b128 a[80:83], v26 offset:6144
v_mfma_f32_16x16x32_bf16 a[132:135], a[252:255], a[100:103], a[132:135]
s_and_b32 s100, s100, 1023
ds_read_b128 a[76:79], v26 offset:4096
v_mfma_f32_16x16x32_bf16 a[136:139], a[252:255], a[104:107], a[136:139]
v_exp_f32 v75, v75
v_mfma_f32_16x16x32_bf16 a[140:143], a[252:255], a[108:111], a[140:143]
ds_read_b128 a[72:75], v26 offset:2048
v_mul_f32 v80, v73, v73
v_mfma_f32_16x16x32_bf16 a[144:147], a[252:255], a[112:115], a[144:147]
ds_read_b64_tr_b16 a[64:65], v9 offset:0
v_cvt_pk_bf16_f32 v75, v75, v75
v_mfma_f32_16x16x32_bf16 v[176:179], a[0:3], a[112:115], v[176:179]
v_lshlrev_b32 v75, 16, v75
v_mul_f32 v76, v75, v73
v_mfma_f32_16x16x32_bf16 v[172:175], a[0:3], a[108:111], v[172:175]
ds_read_b64_tr_b16 a[66:67], v9 offset:1024
v_mul_f32 v77, v75, v74
v_mfma_f32_16x16x32_bf16 v[168:171], a[0:3], a[104:107], v[168:171]
ds_read_b128 a[68:71], v26 offset:0
v_mul_f32 v76, 0x3fb8aa3b, v76
v_mfma_f32_16x16x32_bf16 v[164:167], a[0:3], a[100:103], v[164:167]
v_mul_f32 v77, 0.15915494, v77
v_mfma_f32_16x16x32_bf16 v[180:183], a[4:7], a[100:103], v[180:183]
v_exp_f32 v76, v76
v_mfma_f32_16x16x32_bf16 v[184:187], a[4:7], a[104:107], v[184:187]
v_rndne_f32 v78, v77
v_sub_f32 v77, v77, v78
v_mfma_f32_16x16x32_bf16 v[188:191], a[4:7], a[108:111], v[188:191]
v_cos_f32 v78, v77
v_mfma_f32_16x16x32_bf16 v[192:195], a[4:7], a[112:115], v[192:195]
v_sin_f32 v79, v77
v_fmac_f32 v80, v74, v74
v_rcp_f32 v80, v80
v_mul_f32 v10, v78, v76
v_mul_f32 v11, v79, v76
v_add_f32 v81, -1.0, v10
v_mul_f32 v16, v81, v73
v_fmac_f32 v16, v11, v74
v_mul_f32 v17, v11, v73
s_waitcnt lgkmcnt(5)
v_mfma_f32_16x16x32_bf16 v[192:195], a[40:43], a[80:83], v[192:195]
s_waitcnt vmcnt(18) lgkmcnt(0)
s_barrier
LA_p0_r:
v_cmp_lt_u32 vcc, 255, v35
s_nop 0
s_and_b32 s74, vcc_lo, 1
s_cmp_eq_u32 s74, 1
s_cbranch_scc1 LA_p0
s_sleep 2
buffer_load_dword v35, off, s[24:27], 0 sc1
s_waitcnt vmcnt(0)
s_branch LA_p0_r
LA_p0:
v_mfma_f32_16x16x32_bf16 v[188:191], a[40:43], a[76:79], v[188:191]
s_add_u32 m0, s101, 0
ds_read_b64_tr_b16 a[8:9], v4 offset:16384
v_mfma_f32_16x16x32_bf16 v[184:187], a[40:43], a[72:75], v[184:187]
ds_read_b64_tr_b16 a[10:11], v4 offset:17408
v_fma_f32 v17, -v81, v74, v17
v_mfma_f32_16x16x32_bf16 v[180:183], a[40:43], a[68:71], v[180:183]
ds_read_b128 a[100:103], v27 offset:0
v_mul_f32 v16, v16, v80
v_mfma_f32_16x16x32_bf16 v[164:167], a[36:39], a[68:71], v[164:167]
ds_read_b128 a[104:107], v27 offset:2048
v_mul_f32 v17, v17, v80
v_mfma_f32_16x16x32_bf16 v[168:171], a[36:39], a[72:75], v[168:171]
ds_read_b128 a[108:111], v27 offset:4096
v_mul_f32 v81, v11, v11
v_mfma_f32_16x16x32_bf16 v[172:175], a[36:39], a[76:79], v[172:175]
ds_read_b128 a[112:115], v27 offset:6144
v_mul_f32 v13, v10, v11
v_mfma_f32_16x16x32_bf16 v[176:179], a[36:39], a[80:83], v[176:179]
ds_read_b64_tr_b16 a[12:13], v5 offset:16384
v_fma_f32 v12, v10, v10, -v81
v_mfma_f32_16x16x32_bf16 a[144:147], a[240:243], a[80:83], a[144:147]
ds_read_b64_tr_b16 a[14:15], v5 offset:17408
v_add_f32 v13, v13, v13
v_mfma_f32_16x16x32_bf16 a[140:143], a[240:243], a[76:79], a[140:143]
buffer_store_dwordx4 v[132:135], v0, s[20:23], s94 offen offset:0 sc1
v_mfma_f32_16x16x32_bf16 a[136:139], a[240:243], a[72:75], a[136:139]
ds_read_b64_tr_b16 a[16:17], v6 offset:16384
v_mul_f32 v81, v13, v13
v_mfma_f32_16x16x32_bf16 a[132:135], a[240:243], a[68:71], a[132:135]
ds_read_b64_tr_b16 a[18:19], v6 offset:17408
v_mul_f32 v13, v12, v13
v_mfma_f32_16x16x32_bf16 v[196:199], a[44:47], a[68:71], v[196:199]
s_waitcnt lgkmcnt(7)
buffer_load_dwordx4 v33, s[16:19], s86 offen offset:0 lds
v_mfma_f32_16x16x32_bf16 v[196:199], a[8:11], a[100:103], v[196:199]
s_waitcnt lgkmcnt(6)
ds_read_b128 a[116:119], v30 offset:0
v_fma_f32 v12, v12, v12, -v81
v_mfma_f32_16x16x32_bf16 v[200:203], a[8:11], a[104:107], v[200:203]
ds_read_b128 a[172:175], v32 offset:34816
v_add_f32 v13, v13, v13
v_mfma_f32_16x16x32_bf16 v[200:203], a[44:47], a[72:75], v[200:203]
buffer_load_dwordx4 v34, s[16:19], s86 offen offset:1024 lds
v_mfma_f32_16x16x32_bf16 v[204:207], a[44:47], a[76:79], v[204:207]
s_waitcnt lgkmcnt(7)
s_add_u32 s86, s86, 0x40000
ds_read_b128 a[176:179], v32 offset:35840
v_mfma_f32_16x16x32_bf16 v[204:207], a[8:11], a[108:111], v[204:207]
s_waitcnt lgkmcnt(7)
s_and_b32 s86, s86, 0x3c0000
ds_read_b128 a[120:123], v31 offset:512
v_mfma_f32_16x16x32_bf16 v[208:211], a[8:11], a[112:115], v[208:211]
s_add_u32 m0, s97, 36864
s_add_u32 s74, s87, s99
v_mfma_f32_16x16x32_bf16 v[208:211], a[44:47], a[80:83], v[208:211]
ds_read_b64_tr_b16 a[0:1], v2 offset:16384
v_mul_f32 v81, v13, v13
v_mfma_f32_16x16x32_bf16 v[224:227], a[48:51], a[80:83], v[224:227]
s_waitcnt lgkmcnt(7)
ds_read_b64_tr_b16 a[2:3], v2 offset:17408
v_mul_f32 v13, v12, v13
v_mfma_f32_16x16x32_bf16 v[224:227], a[12:15], a[112:115], v[224:227]
buffer_load_dwordx4 v18, s[8:11], s74 offen offset:0 lds
v_mfma_f32_16x16x32_bf16 v[220:223], a[12:15], a[108:111], v[220:223]
ds_read_b64_tr_b16 a[4:5], v3 offset:16384
v_fma_f32 v12, v12, v12, -v81
v_mfma_f32_16x16x32_bf16 v[220:223], a[48:51], a[76:79], v[220:223]
ds_read_b64_tr_b16 a[6:7], v3 offset:17408
v_add_f32 v13, v13, v13
v_mfma_f32_16x16x32_bf16 v[216:219], a[48:51], a[72:75], v[216:219]
buffer_store_dwordx4 v[136:139], v0, s[20:23], s94 offen offset:1024 sc1
v_mfma_f32_16x16x32_bf16 v[216:219], a[12:15], a[104:107], v[216:219]
ds_read_b64_tr_b16 a[20:21], v7 offset:16384
v_mul_f32 v81, v13, v13
v_mfma_f32_16x16x32_bf16 v[212:215], a[12:15], a[100:103], v[212:215]
ds_read_b64_tr_b16 a[22:23], v7 offset:17408
v_mul_f32 v13, v12, v13
v_mfma_f32_16x16x32_bf16 v[212:215], a[48:51], a[68:71], v[212:215]
buffer_load_dwordx4 v19, s[8:11], s74 offen offset:1024 lds
v_mfma_f32_16x16x32_bf16 v[228:231], a[52:55], a[68:71], v[228:231]
s_waitcnt lgkmcnt(10)
ds_read_b64_tr_b16 a[24:25], v8 offset:16384
v_fma_f32 v12, v12, v12, -v81
v_mfma_f32_16x16x32_bf16 v[228:231], a[16:19], a[100:103], v[228:231]
ds_read_b64_tr_b16 a[26:27], v8 offset:17408
v_add_f32 v13, v13, v13
v_mfma_f32_16x16x32_bf16 v[232:235], a[16:19], a[104:107], v[232:235]
buffer_load_dwordx4 v22, s[8:11], s74 offen offset:2048 lds
v_mfma_f32_16x16x32_bf16 v[232:235], a[52:55], a[72:75], v[232:235]
ds_read_b64_tr_b16 a[28:29], v9 offset:16384
v_mul_f32 v81, v13, v13
v_mfma_f32_16x16x32_bf16 v[236:239], a[52:55], a[76:79], v[236:239]
ds_read_b64_tr_b16 a[30:31], v9 offset:17408
v_mul_f32 v15, v12, v13
v_mfma_f32_16x16x32_bf16 v[236:239], a[16:19], a[108:111], v[236:239]
buffer_load_dwordx4 v23, s[8:11], s74 offen offset:3072 lds
v_mfma_f32_16x16x32_bf16 v[240:243], a[16:19], a[112:115], v[240:243]
s_add_u32 s87, s87, 128
ds_read_b128 a[124:127], v28 offset:1024
v_mfma_f32_16x16x32_bf16 v[240:243], a[52:55], a[80:83], v[240:243]
s_and_b32 s87, s87, 1023
ds_read_b128 a[128:131], v29 offset:1536
v_mfma_f32_16x16x32_bf16 a[192:195], a[84:87], a[164:167], a[192:195]
s_waitcnt lgkmcnt(14)
buffer_load_dwordx4 a[252:255], v25, s[32:35], s100 offen
v_mfma_f32_16x16x32_bf16 a[192:195], a[116:119], a[172:175], a[192:195]
s_waitcnt lgkmcnt(13)
s_add_u32 s100, s100, 64
s_and_b32 s100, s100, 1023
v_mfma_f32_16x16x32_bf16 a[196:199], a[116:119], a[176:179], a[196:199]
v_fma_f32 v14, v12, v12, -v81
v_add_f32 v15, v15, v15
v_mfma_f32_16x16x32_bf16 a[196:199], a[84:87], a[168:171], a[196:199]
v_mul_f32 v81, v15, v15
v_mul_f32 v15, v14, v15
v_mfma_f32_16x16x32_bf16 a[204:207], a[88:91], a[168:171], a[204:207]
s_waitcnt lgkmcnt(12)
v_fma_f32 v14, v14, v14, -v81
v_add_f32 v15, v15, v15
v_mfma_f32_16x16x32_bf16 a[204:207], a[120:123], a[176:179], a[204:207]
v_mfma_f32_16x16x32_bf16 a[200:203], a[120:123], a[172:175], a[200:203]
v_mfma_f32_16x16x32_bf16 a[200:203], a[88:91], a[164:167], a[200:203]
v_mfma_f32_16x16x32_bf16 a[208:211], a[92:95], a[164:167], a[208:211]
s_waitcnt vmcnt(18) lgkmcnt(0)
s_barrier
v_mfma_f32_16x16x32_bf16 a[208:211], a[124:127], a[172:175], a[208:211]
s_add_u32 m0, s101, 16384
ds_read_b64_tr_b16 a[36:37], v2 offset:32768
v_mfma_f32_16x16x32_bf16 a[212:215], a[124:127], a[176:179], a[212:215]
ds_read_b64_tr_b16 a[38:39], v2 offset:33792
v_mfma_f32_16x16x32_bf16 a[212:215], a[92:95], a[168:171], a[212:215]
buffer_store_dwordx4 v[140:143], v0, s[20:23], s94 offen offset:2048 sc1
v_mfma_f32_16x16x32_bf16 a[220:223], a[96:99], a[168:171], a[220:223]
ds_read_b64_tr_b16 a[40:41], v3 offset:32768
v_mfma_f32_16x16x32_bf16 a[220:223], a[128:131], a[176:179], a[220:223]
ds_read_b64_tr_b16 a[42:43], v3 offset:33792
v_mfma_f32_16x16x32_bf16 a[216:219], a[128:131], a[172:175], a[216:219]
buffer_load_dwordx4 v33, s[16:19], s86 offen offset:0 lds
v_mfma_f32_16x16x32_bf16 a[216:219], a[96:99], a[164:167], a[216:219]
ds_read_b64_tr_b16 a[44:45], v4 offset:32768
v_mfma_f32_16x16x32_bf16 v[36:39], a[56:59], a[80:83], v[36:39]
ds_read_b64_tr_b16 a[46:47], v4 offset:33792
v_mfma_f32_16x16x32_bf16 v[36:39], a[20:23], a[112:115], v[36:39]
buffer_load_dwordx4 v34, s[16:19], s86 offen offset:1024 lds
v_mfma_f32_16x16x32_bf16 v[252:255], a[20:23], a[108:111], v[252:255]
s_add_u32 s86, s86, 0x40000
ds_read_b64_tr_b16 a[48:49], v5 offset:32768
v_mfma_f32_16x16x32_bf16 v[252:255], a[56:59], a[76:79], v[252:255]
s_and_b32 s86, s86, 0x3c0000
ds_read_b64_tr_b16 a[50:51], v5 offset:33792
v_mfma_f32_16x16x32_bf16 v[248:251], a[56:59], a[72:75], v[248:251]
s_add_u32 m0, s97, 0
s_add_u32 s74, s87, s98
v_mfma_f32_16x16x32_bf16 v[248:251], a[20:23], a[104:107], v[248:251]
ds_read_b64_tr_b16 a[52:53], v6 offset:32768
v_mfma_f32_16x16x32_bf16 v[244:247], a[20:23], a[100:103], v[244:247]
ds_read_b64_tr_b16 a[54:55], v6 offset:33792
v_mfma_f32_16x16x32_bf16 v[244:247], a[56:59], a[68:71], v[244:247]
buffer_load_dwordx4 v18, s[8:11], s74 offen offset:0 lds
v_mfma_f32_16x16x32_bf16 v[40:43], a[60:63], a[68:71], v[40:43]
ds_read_b128 a[84:87], v28 offset:16384
v_mfma_f32_16x16x32_bf16 v[40:43], a[24:27], a[100:103], v[40:43]
ds_read_b128 a[88:91], v29 offset:16896
v_mfma_f32_16x16x32_bf16 v[44:47], a[24:27], a[104:107], v[44:47]
buffer_load_dwordx4 v19, s[8:11], s74 offen offset:1024 lds
v_mfma_f32_16x16x32_bf16 v[44:47], a[60:63], a[72:75], v[44:47]
ds_read_b128 a[92:95], v30 offset:17408
v_mfma_f32_16x16x32_bf16 v[48:51], a[60:63], a[76:79], v[48:51]
ds_read_b128 a[168:171], v32 offset:37888
v_mfma_f32_16x16x32_bf16 v[48:51], a[24:27], a[108:111], v[48:51]
buffer_load_dwordx4 v22, s[8:11], s74 offen offset:2048 lds
v_mfma_f32_16x16x32_bf16 v[52:55], a[24:27], a[112:115], v[52:55]
ds_read_b128 a[96:99], v31 offset:17920
v_mfma_f32_16x16x32_bf16 v[52:55], a[60:63], a[80:83], v[52:55]
ds_read_b128 a[164:167], v32 offset:36864
v_mfma_f32_16x16x32_bf16 v[68:71], a[64:67], a[80:83], v[68:71]
buffer_store_dwordx4 v[144:147], v0, s[20:23], s94 offen offset:3072 sc1
v_mfma_f32_16x16x32_bf16 v[68:71], a[28:31], a[112:115], v[68:71]
ds_read_b64_tr_b16 a[56:57], v7 offset:32768
v_mfma_f32_16x16x32_bf16 v[64:67], a[28:31], a[108:111], v[64:67]
ds_read_b64_tr_b16 a[58:59], v7 offset:33792
v_mfma_f32_16x16x32_bf16 v[64:67], a[64:67], a[76:79], v[64:67]
buffer_load_dwordx4 v23, s[8:11], s74 offen offset:3072 lds
v_mfma_f32_16x16x32_bf16 v[60:63], a[64:67], a[72:75], v[60:63]
ds_read_b64_tr_b16 a[60:61], v8 offset:32768
v_mfma_f32_16x16x32_bf16 v[60:63], a[28:31], a[104:107], v[60:63]
ds_read_b64_tr_b16 a[62:63], v8 offset:33792
v_mfma_f32_16x16x32_bf16 v[56:59], a[28:31], a[100:103], v[56:59]
buffer_load_dwordx4 a[240:243], v25, s[32:35], s100 offen
v_mfma_f32_16x16x32_bf16 v[56:59], a[64:67], a[68:71], v[56:59]
s_add_u32 s100, s100, 64
ds_read_b128 a[80:83], v26 offset:22528
v_mfma_f32_16x16x32_bf16 a[132:135], a[244:247], a[100:103], a[132:135]
s_and_b32 s100, s100, 1023
ds_read_b128 a[76:79], v26 offset:20480
v_mfma_f32_16x16x32_bf16 a[136:139], a[244:247], a[104:107], a[136:139]
v_bfe_u32 v35, v0, 2, 7
v_mfma_f32_16x16x32_bf16 a[140:143], a[244:247], a[108:111], a[140:143]
ds_read_b128 a[72:75], v26 offset:18432
v_mfma_f32_16x16x32_bf16 a[144:147], a[244:247], a[112:115], a[144:147]
ds_read_b64_tr_b16 a[64:65], v9 offset:32768
v_mfma_f32_16x16x32_bf16 v[176:179], a[0:3], a[112:115], v[176:179]
buffer_load_dword v35, v35, s[76:79], s40 offen offset:0 sc1
v_mfma_f32_16x16x32_bf16 v[172:175], a[0:3], a[108:111], v[172:175]
ds_read_b64_tr_b16 a[66:67], v9 offset:33792
v_mfma_f32_16x16x32_bf16 v[168:171], a[0:3], a[104:107], v[168:171]
ds_read_b128 a[68:71], v26 offset:16384
v_mfma_f32_16x16x32_bf16 v[164:167], a[0:3], a[100:103], v[164:167]
v_mfma_f32_16x16x32_bf16 v[180:183], a[4:7], a[100:103], v[180:183]
v_mfma_f32_16x16x32_bf16 v[184:187], a[4:7], a[104:107], v[184:187]
v_mfma_f32_16x16x32_bf16 v[188:191], a[4:7], a[108:111], v[188:191]
v_mfma_f32_16x16x32_bf16 v[192:195], a[4:7], a[112:115], v[192:195]
s_waitcnt lgkmcnt(5)
v_mfma_f32_16x16x32_bf16 v[192:195], a[40:43], a[80:83], v[192:195]
s_waitcnt vmcnt(19) lgkmcnt(0)
s_barrier
v_mfma_f32_16x16x32_bf16 v[188:191], a[40:43], a[76:79], v[188:191]
s_add_u32 m0, s101, 32768
ds_read_b64_tr_b16 a[8:9], v4 offset:49152
v_mfma_f32_16x16x32_bf16 v[184:187], a[40:43], a[72:75], v[184:187]
ds_read_b64_tr_b16 a[10:11], v4 offset:50176
v_mfma_f32_16x16x32_bf16 v[180:183], a[40:43], a[68:71], v[180:183]
ds_read_b128 a[100:103], v27 offset:16384
v_mfma_f32_16x16x32_bf16 v[164:167], a[36:39], a[68:71], v[164:167]
ds_read_b128 a[104:107], v27 offset:18432
v_mfma_f32_16x16x32_bf16 v[168:171], a[36:39], a[72:75], v[168:171]
ds_read_b128 a[108:111], v27 offset:20480
v_mfma_f32_16x16x32_bf16 v[172:175], a[36:39], a[76:79], v[172:175]
ds_read_b128 a[112:115], v27 offset:22528
v_mfma_f32_16x16x32_bf16 v[176:179], a[36:39], a[80:83], v[176:179]
ds_read_b64_tr_b16 a[12:13], v5 offset:49152
v_mfma_f32_16x16x32_bf16 a[144:147], a[248:251], a[80:83], a[144:147]
ds_read_b64_tr_b16 a[14:15], v5 offset:50176
v_mfma_f32_16x16x32_bf16 a[140:143], a[248:251], a[76:79], a[140:143]
buffer_store_dwordx4 v[148:151], v0, s[20:23], s95 offen offset:0 sc1
v_mfma_f32_16x16x32_bf16 a[136:139], a[248:251], a[72:75], a[136:139]
ds_read_b64_tr_b16 a[16:17], v6 offset:49152
v_mfma_f32_16x16x32_bf16 a[132:135], a[248:251], a[68:71], a[132:135]
ds_read_b64_tr_b16 a[18:19], v6 offset:50176
v_mfma_f32_16x16x32_bf16 v[196:199], a[44:47], a[68:71], v[196:199]
s_waitcnt lgkmcnt(7)
buffer_load_dwordx4 v33, s[16:19], s86 offen offset:0 lds
v_mfma_f32_16x16x32_bf16 v[196:199], a[8:11], a[100:103], v[196:199]
s_waitcnt lgkmcnt(6)
ds_read_b128 a[116:119], v30 offset:16384
v_mfma_f32_16x16x32_bf16 v[200:203], a[8:11], a[104:107], v[200:203]
ds_read_b128 a[172:175], v32 offset:38912
v_mfma_f32_16x16x32_bf16 v[200:203], a[44:47], a[72:75], v[200:203]
buffer_load_dwordx4 v34, s[16:19], s86 offen offset:1024 lds
v_mfma_f32_16x16x32_bf16 v[204:207], a[44:47], a[76:79], v[204:207]
s_waitcnt lgkmcnt(7)
s_add_u32 s86, s86, 0x40000
ds_read_b128 a[176:179], v32 offset:39936
v_mfma_f32_16x16x32_bf16 v[204:207], a[8:11], a[108:111], v[204:207]
s_waitcnt lgkmcnt(7)
s_and_b32 s86, s86, 0x3c0000
ds_read_b128 a[120:123], v31 offset:16896
v_mfma_f32_16x16x32_bf16 v[208:211], a[8:11], a[112:115], v[208:211]
s_add_u32 m0, s97, 4096
s_add_u32 s74, s87, s99
v_mfma_f32_16x16x32_bf16 v[208:211], a[44:47], a[80:83], v[208:211]
ds_read_b64_tr_b16 a[0:1], v2 offset:49152
v_mfma_f32_16x16x32_bf16 v[224:227], a[48:51], a[80:83], v[224:227]
s_waitcnt lgkmcnt(7)
ds_read_b64_tr_b16 a[2:3], v2 offset:50176
v_mfma_f32_16x16x32_bf16 v[224:227], a[12:15], a[112:115], v[224:227]
buffer_load_dwordx4 v18, s[8:11], s74 offen offset:0 lds
v_mfma_f32_16x16x32_bf16 v[220:223], a[12:15], a[108:111], v[220:223]
ds_read_b64_tr_b16 a[4:5], v3 offset:49152
v_mfma_f32_16x16x32_bf16 v[220:223], a[48:51], a[76:79], v[220:223]
ds_read_b64_tr_b16 a[6:7], v3 offset:50176
v_mfma_f32_16x16x32_bf16 v[216:219], a[48:51], a[72:75], v[216:219]
buffer_store_dwordx4 v[152:155], v0, s[20:23], s95 offen offset:1024 sc1
v_mfma_f32_16x16x32_bf16 v[216:219], a[12:15], a[104:107], v[216:219]
ds_read_b64_tr_b16 a[20:21], v7 offset:49152
v_mfma_f32_16x16x32_bf16 v[212:215], a[12:15], a[100:103], v[212:215]
ds_read_b64_tr_b16 a[22:23], v7 offset:50176
v_mfma_f32_16x16x32_bf16 v[212:215], a[48:51], a[68:71], v[212:215]
buffer_load_dwordx4 v19, s[8:11], s74 offen offset:1024 lds
v_mfma_f32_16x16x32_bf16 v[228:231], a[52:55], a[68:71], v[228:231]
s_waitcnt lgkmcnt(10)
ds_read_b64_tr_b16 a[24:25], v8 offset:49152
v_mfma_f32_16x16x32_bf16 v[228:231], a[16:19], a[100:103], v[228:231]
ds_read_b64_tr_b16 a[26:27], v8 offset:50176
v_mfma_f32_16x16x32_bf16 v[232:235], a[16:19], a[104:107], v[232:235]
buffer_load_dwordx4 v22, s[8:11], s74 offen offset:2048 lds
v_mfma_f32_16x16x32_bf16 v[232:235], a[52:55], a[72:75], v[232:235]
ds_read_b64_tr_b16 a[28:29], v9 offset:49152
v_mfma_f32_16x16x32_bf16 v[236:239], a[52:55], a[76:79], v[236:239]
ds_read_b64_tr_b16 a[30:31], v9 offset:50176
v_mfma_f32_16x16x32_bf16 v[236:239], a[16:19], a[108:111], v[236:239]
buffer_load_dwordx4 v23, s[8:11], s74 offen offset:3072 lds
v_mfma_f32_16x16x32_bf16 v[240:243], a[16:19], a[112:115], v[240:243]
s_add_u32 s87, s87, 128
ds_read_b128 a[124:127], v28 offset:17408
v_mfma_f32_16x16x32_bf16 v[240:243], a[52:55], a[80:83], v[240:243]
s_and_b32 s87, s87, 1023
ds_read_b128 a[128:131], v29 offset:17920
v_mfma_f32_16x16x32_bf16 a[192:195], a[84:87], a[164:167], a[192:195]
s_waitcnt lgkmcnt(14)
buffer_load_dwordx4 a[244:247], v25, s[32:35], s100 offen
v_mfma_f32_16x16x32_bf16 a[192:195], a[116:119], a[172:175], a[192:195]
s_waitcnt lgkmcnt(13)
s_add_u32 s100, s100, 64
s_and_b32 s100, s100, 1023
v_mfma_f32_16x16x32_bf16 a[196:199], a[116:119], a[176:179], a[196:199]
v_mfma_f32_16x16x32_bf16 a[196:199], a[84:87], a[168:171], a[196:199]
v_mfma_f32_16x16x32_bf16 a[204:207], a[88:91], a[168:171], a[204:207]
s_waitcnt lgkmcnt(12)
v_mfma_f32_16x16x32_bf16 a[204:207], a[120:123], a[176:179], a[204:207]
v_mfma_f32_16x16x32_bf16 a[200:203], a[120:123], a[172:175], a[200:203]
v_mfma_f32_16x16x32_bf16 a[200:203], a[88:91], a[164:167], a[200:203]
v_mfma_f32_16x16x32_bf16 a[208:211], a[92:95], a[164:167], a[208:211]
s_waitcnt vmcnt(19) lgkmcnt(0)
s_barrier
v_mfma_f32_16x16x32_bf16 a[208:211], a[124:127], a[172:175], a[208:211]
ds_read_b64_tr_b16 a[36:37], v2 offset:0
v_mov_b32 v88, (LA_pm3-LA_pm0)/12
v_mfma_f32_16x16x32_bf16 a[212:215], a[124:127], a[176:179], a[212:215]
s_add_u32 m0, s101, 49152
ds_read_b64_tr_b16 a[38:39], v2 offset:1024
v_mfma_f32_16x16x32_bf16 a[212:215], a[92:95], a[168:171], a[212:215]
buffer_store_dwordx4 v[156:159], v0, s[20:23], s95 offen offset:2048 sc1
v_mfma_f32_16x16x32_bf16 a[220:223], a[96:99], a[168:171], a[220:223]
ds_read_b64_tr_b16 a[40:41], v3 offset:0
v_mfma_f32_16x16x32_bf16 a[220:223], a[128:131], a[176:179], a[220:223]
ds_read_b64_tr_b16 a[42:43], v3 offset:1024
v_mfma_f32_16x16x32_bf16 a[216:219], a[128:131], a[172:175], a[216:219]
buffer_load_dwordx4 v33, s[16:19], s86 offen offset:0 lds
v_mfma_f32_16x16x32_bf16 a[216:219], a[96:99], a[164:167], a[216:219]
ds_read_b64_tr_b16 a[44:45], v4 offset:0
v_mfma_f32_16x16x32_bf16 v[36:39], a[56:59], a[80:83], v[36:39]
ds_read_b64_tr_b16 a[46:47], v4 offset:1024
v_mfma_f32_16x16x32_bf16 v[36:39], a[20:23], a[112:115], v[36:39]
buffer_load_dwordx4 v34, s[16:19], s86 offen offset:1024 lds
v_mfma_f32_16x16x32_bf16 v[252:255], a[20:23], a[108:111], v[252:255]
s_add_u32 s86, s86, 0x40000
ds_read_b64_tr_b16 a[48:49], v5 offset:0
v_mfma_f32_16x16x32_bf16 v[252:255], a[56:59], a[76:79], v[252:255]
s_and_b32 s86, s86, 0x3c0000
ds_read_b64_tr_b16 a[50:51], v5 offset:1024
v_mfma_f32_16x16x32_bf16 v[248:251], a[56:59], a[72:75], v[248:251]
buffer_load_dwordx4 a[248:251], v25, s[32:35], s100 offen
v_mfma_f32_16x16x32_bf16 v[248:251], a[20:23], a[104:107], v[248:251]
s_add_u32 s100, s100, 64
ds_read_b64_tr_b16 a[52:53], v6 offset:0
v_mfma_f32_16x16x32_bf16 v[244:247], a[20:23], a[100:103], v[244:247]
s_and_b32 s100, s100, 1023
ds_read_b64_tr_b16 a[54:55], v6 offset:1024
v_mfma_f32_16x16x32_bf16 v[244:247], a[56:59], a[68:71], v[244:247]
v_mfma_f32_16x16x32_bf16 v[40:43], a[60:63], a[68:71], v[40:43]
ds_read_b128 a[84:87], v28 offset:32768
v_mfma_f32_16x16x32_bf16 v[40:43], a[24:27], a[100:103], v[40:43]
ds_read_b128 a[88:91], v29 offset:33280
v_mfma_f32_16x16x32_bf16 v[44:47], a[24:27], a[104:107], v[44:47]
v_mfma_f32_16x16x32_bf16 v[44:47], a[60:63], a[72:75], v[44:47]
ds_read_b128 a[92:95], v30 offset:33792
v_mfma_f32_16x16x32_bf16 v[48:51], a[60:63], a[76:79], v[48:51]
ds_read_b128 a[168:171], v32 offset:50176
v_mfma_f32_16x16x32_bf16 v[48:51], a[24:27], a[108:111], v[48:51]
v_mfma_f32_16x16x32_bf16 v[52:55], a[24:27], a[112:115], v[52:55]
ds_read_b128 a[96:99], v31 offset:34304
v_mfma_f32_16x16x32_bf16 v[52:55], a[60:63], a[80:83], v[52:55]
ds_read_b128 a[164:167], v32 offset:49152
v_mfma_f32_16x16x32_bf16 v[68:71], a[64:67], a[80:83], v[68:71]
v_mfma_f32_16x16x32_bf16 v[68:71], a[28:31], a[112:115], v[68:71]
ds_read_b64_tr_b16 a[56:57], v7 offset:0
v_mfma_f32_16x16x32_bf16 v[64:67], a[28:31], a[108:111], v[64:67]
ds_read_b64_tr_b16 a[58:59], v7 offset:1024
v_mfma_f32_16x16x32_bf16 v[64:67], a[64:67], a[76:79], v[64:67]
v_mfma_f32_16x16x32_bf16 v[60:63], a[64:67], a[72:75], v[60:63]
ds_read_b64_tr_b16 a[60:61], v8 offset:0
v_mfma_f32_16x16x32_bf16 v[60:63], a[28:31], a[104:107], v[60:63]
ds_read_b64_tr_b16 a[62:63], v8 offset:1024
v_mfma_f32_16x16x32_bf16 v[56:59], a[28:31], a[100:103], v[56:59]
v_mfma_f32_16x16x32_bf16 v[56:59], a[64:67], a[68:71], v[56:59]
ds_read_b128 a[80:83], v26 offset:38912
v_mfma_f32_16x16x32_bf16 a[132:135], a[252:255], a[100:103], a[132:135]
ds_read_b128 a[76:79], v26 offset:36864
v_mfma_f32_16x16x32_bf16 a[136:139], a[252:255], a[104:107], a[136:139]
v_mfma_f32_16x16x32_bf16 a[140:143], a[252:255], a[108:111], a[140:143]
ds_read_b128 a[72:75], v26 offset:34816
v_mfma_f32_16x16x32_bf16 a[144:147], a[252:255], a[112:115], a[144:147]
ds_read_b64_tr_b16 a[64:65], v9 offset:0
v_mfma_f32_16x16x32_bf16 v[176:179], a[0:3], a[112:115], v[176:179]
v_mfma_f32_16x16x32_bf16 v[172:175], a[0:3], a[108:111], v[172:175]
ds_read_b64_tr_b16 a[66:67], v9 offset:1024
v_mfma_f32_16x16x32_bf16 v[168:171], a[0:3], a[104:107], v[168:171]
ds_read_b128 a[68:71], v26 offset:32768
v_mfma_f32_16x16x32_bf16 v[164:167], a[0:3], a[100:103], v[164:167]
v_mfma_f32_16x16x32_bf16 v[180:183], a[4:7], a[100:103], v[180:183]
v_mfma_f32_16x16x32_bf16 v[184:187], a[4:7], a[104:107], v[184:187]
v_mfma_f32_16x16x32_bf16 v[188:191], a[4:7], a[108:111], v[188:191]
v_mfma_f32_16x16x32_bf16 v[192:195], a[4:7], a[112:115], v[192:195]
s_waitcnt lgkmcnt(5)
v_mfma_f32_16x16x32_bf16 v[192:195], a[40:43], a[80:83], v[192:195]
s_waitcnt vmcnt(13) lgkmcnt(0)
s_barrier
LA_p1_r:
v_cmp_lt_u32 vcc, 0, v35
s_nop 0
s_and_b32 s74, vcc_lo, 255
s_cmp_eq_u32 s74, 255
s_cbranch_scc1 LA_p1
s_sleep 2
v_bfe_u32 v35, v0, 2, 7
buffer_load_dword v35, v35, s[76:79], s40 offen offset:0 sc1
s_waitcnt vmcnt(0)
s_branch LA_p1_r
LA_p1:
v_mfma_f32_16x16x32_bf16 v[188:191], a[40:43], a[76:79], v[188:191]
ds_read_b64_tr_b16 a[8:9], v4 offset:16384
v_mfma_f32_16x16x32_bf16 v[184:187], a[40:43], a[72:75], v[184:187]
ds_read_b64_tr_b16 a[10:11], v4 offset:17408
v_mfma_f32_16x16x32_bf16 v[180:183], a[40:43], a[68:71], v[180:183]
ds_read_b128 a[100:103], v27 offset:32768
v_mfma_f32_16x16x32_bf16 v[164:167], a[36:39], a[68:71], v[164:167]
ds_read_b128 a[104:107], v27 offset:34816
v_mfma_f32_16x16x32_bf16 v[168:171], a[36:39], a[72:75], v[168:171]
ds_read_b128 a[108:111], v27 offset:36864
v_mfma_f32_16x16x32_bf16 v[172:175], a[36:39], a[76:79], v[172:175]
ds_read_b128 a[112:115], v27 offset:38912
v_mfma_f32_16x16x32_bf16 v[176:179], a[36:39], a[80:83], v[176:179]
ds_read_b64_tr_b16 a[12:13], v5 offset:16384
v_mfma_f32_16x16x32_bf16 a[144:147], a[240:243], a[80:83], a[144:147]
ds_read_b64_tr_b16 a[14:15], v5 offset:17408
v_mfma_f32_16x16x32_bf16 a[140:143], a[240:243], a[76:79], a[140:143]
buffer_store_dwordx4 v[160:163], v0, s[20:23], s95 offen offset:3072 sc1
v_mfma_f32_16x16x32_bf16 a[136:139], a[240:243], a[72:75], a[136:139]
ds_read_b64_tr_b16 a[16:17], v6 offset:16384
v_mfma_f32_16x16x32_bf16 a[132:135], a[240:243], a[68:71], a[132:135]
ds_read_b64_tr_b16 a[18:19], v6 offset:17408
v_mfma_f32_16x16x32_bf16 v[196:199], a[44:47], a[68:71], v[196:199]
s_waitcnt lgkmcnt(7)
buffer_load_dwordx4 a[252:255], v25, s[32:35], s100 offen
v_mfma_f32_16x16x32_bf16 v[196:199], a[8:11], a[100:103], v[196:199]
s_waitcnt lgkmcnt(6)
s_add_u32 s100, s100, 64
ds_read_b128 a[116:119], v30 offset:32768
v_mfma_f32_16x16x32_bf16 v[200:203], a[8:11], a[104:107], v[200:203]
s_and_b32 s100, s100, 1023
ds_read_b128 a[172:175], v32 offset:51200
v_mfma_f32_16x16x32_bf16 v[200:203], a[44:47], a[72:75], v[200:203]
s_add_u32 m0, s101, -81920
s_add_u32 s74, s101, 4294868992
v_mfma_f32_16x16x32_bf16 v[204:207], a[44:47], a[76:79], v[204:207]
s_waitcnt lgkmcnt(7)
ds_read_b128 a[176:179], v32 offset:52224
v_mfma_f32_16x16x32_bf16 v[204:207], a[8:11], a[108:111], v[204:207]
s_waitcnt lgkmcnt(7)
ds_read_b128 a[120:123], v31 offset:33280
v_mfma_f32_16x16x32_bf16 v[208:211], a[8:11], a[112:115], v[208:211]
buffer_load_dwordx4 v0, s[20:23], s74 offen offset:0 sc1 lds
v_mfma_f32_16x16x32_bf16 v[208:211], a[44:47], a[80:83], v[208:211]
ds_read_b64_tr_b16 a[0:1], v2 offset:16384
v_mfma_f32_16x16x32_bf16 v[224:227], a[48:51], a[80:83], v[224:227]
s_waitcnt lgkmcnt(7)
ds_read_b64_tr_b16 a[2:3], v2 offset:17408
v_mfma_f32_16x16x32_bf16 v[224:227], a[12:15], a[112:115], v[224:227]
buffer_load_dwordx4 v0, s[20:23], s74 offen offset:1024 sc1 lds
v_mfma_f32_16x16x32_bf16 v[220:223], a[12:15], a[108:111], v[220:223]
s_add_u32 m0, s101, -73728
ds_read_b64_tr_b16 a[4:5], v3 offset:16384
v_mfma_f32_16x16x32_bf16 v[220:223], a[48:51], a[76:79], v[220:223]
s_add_u32 s74, s101, 4294885376
ds_read_b64_tr_b16 a[6:7], v3 offset:17408
v_mfma_f32_16x16x32_bf16 v[216:219], a[48:51], a[72:75], v[216:219]
buffer_load_dwordx4 v0, s[20:23], s74 offen offset:0 sc1 lds
v_mfma_f32_16x16x32_bf16 v[216:219], a[12:15], a[104:107], v[216:219]
ds_read_b64_tr_b16 a[20:21], v7 offset:16384
v_mfma_f32_16x16x32_bf16 v[212:215], a[12:15], a[100:103], v[212:215]
ds_read_b64_tr_b16 a[22:23], v7 offset:17408
v_mfma_f32_16x16x32_bf16 v[212:215], a[48:51], a[68:71], v[212:215]
buffer_load_dwordx4 v0, s[20:23], s74 offen offset:1024 sc1 lds
v_mfma_f32_16x16x32_bf16 v[228:231], a[52:55], a[68:71], v[228:231]
s_waitcnt lgkmcnt(10)
s_add_u32 m0, s101, -32768
ds_read_b64_tr_b16 a[24:25], v8 offset:16384
v_mfma_f32_16x16x32_bf16 v[228:231], a[16:19], a[100:103], v[228:231]
s_add_u32 s74, s101, 0
ds_read_b64_tr_b16 a[26:27], v8 offset:17408
v_mfma_f32_16x16x32_bf16 v[232:235], a[16:19], a[104:107], v[232:235]
buffer_load_dwordx4 v0, s[20:23], s74 offen offset:0 sc1 lds
v_mfma_f32_16x16x32_bf16 v[232:235], a[52:55], a[72:75], v[232:235]
ds_read_b64_tr_b16 a[28:29], v9 offset:16384
v_mfma_f32_16x16x32_bf16 v[236:239], a[52:55], a[76:79], v[236:239]
ds_read_b64_tr_b16 a[30:31], v9 offset:17408
v_mfma_f32_16x16x32_bf16 v[236:239], a[16:19], a[108:111], v[236:239]
buffer_load_dwordx4 v0, s[20:23], s74 offen offset:1024 sc1 lds
v_mfma_f32_16x16x32_bf16 v[240:243], a[16:19], a[112:115], v[240:243]
ds_read_b128 a[124:127], v28 offset:33792
v_mfma_f32_16x16x32_bf16 v[240:243], a[52:55], a[80:83], v[240:243]
ds_read_b128 a[128:131], v29 offset:34304
v_mfma_f32_16x16x32_bf16 a[192:195], a[84:87], a[164:167], a[192:195]
s_waitcnt lgkmcnt(14)
v_mfma_f32_16x16x32_bf16 a[192:195], a[116:119], a[172:175], a[192:195]
s_waitcnt lgkmcnt(13)
v_mfma_f32_16x16x32_bf16 a[196:199], a[116:119], a[176:179], a[196:199]
v_mfma_f32_16x16x32_bf16 a[196:199], a[84:87], a[168:171], a[196:199]
v_mfma_f32_16x16x32_bf16 a[204:207], a[88:91], a[168:171], a[204:207]
s_waitcnt lgkmcnt(12)
v_mfma_f32_16x16x32_bf16 a[204:207], a[120:123], a[176:179], a[204:207]
v_mfma_f32_16x16x32_bf16 a[200:203], a[120:123], a[172:175], a[200:203]
v_mfma_f32_16x16x32_bf16 a[200:203], a[88:91], a[164:167], a[200:203]
v_mfma_f32_16x16x32_bf16 a[208:211], a[92:95], a[164:167], a[208:211]
s_waitcnt vmcnt(12) lgkmcnt(0)
s_barrier
v_mfma_f32_16x16x32_bf16 a[208:211], a[124:127], a[172:175], a[208:211]
s_add_u32 m0, s101, -16384
ds_read_b64_tr_b16 a[36:37], v2 offset:32768
v_mfma_f32_16x16x32_bf16 a[212:215], a[124:127], a[176:179], a[212:215]
s_add_u32 s74, s101, 4294877184
ds_read_b64_tr_b16 a[38:39], v2 offset:33792
v_mfma_f32_16x16x32_bf16 a[212:215], a[92:95], a[168:171], a[212:215]
buffer_load_dwordx4 v0, s[20:23], s74 offen offset:0 sc1 lds
v_mfma_f32_16x16x32_bf16 a[220:223], a[96:99], a[168:171], a[220:223]
ds_read_b64_tr_b16 a[40:41], v3 offset:32768
v_mfma_f32_16x16x32_bf16 a[220:223], a[128:131], a[176:179], a[220:223]
ds_read_b64_tr_b16 a[42:43], v3 offset:33792
v_mfma_f32_16x16x32_bf16 a[216:219], a[128:131], a[172:175], a[216:219]
buffer_load_dwordx4 v0, s[20:23], s74 offen offset:1024 sc1 lds
v_mfma_f32_16x16x32_bf16 a[216:219], a[96:99], a[164:167], a[216:219]
s_add_u32 m0, s101, -65536
ds_read_b64_tr_b16 a[44:45], v4 offset:32768
v_mfma_f32_16x16x32_bf16 v[36:39], a[56:59], a[80:83], v[36:39]
s_add_u32 s74, s101, 4294901760
ds_read_b64_tr_b16 a[46:47], v4 offset:33792
v_mfma_f32_16x16x32_bf16 v[36:39], a[20:23], a[112:115], v[36:39]
buffer_load_dwordx4 v0, s[20:23], s74 offen offset:0 sc1 lds
v_mfma_f32_16x16x32_bf16 v[252:255], a[20:23], a[108:111], v[252:255]
ds_read_b64_tr_b16 a[48:49], v5 offset:32768
v_mfma_f32_16x16x32_bf16 v[252:255], a[56:59], a[76:79], v[252:255]
ds_read_b64_tr_b16 a[50:51], v5 offset:33792
v_mfma_f32_16x16x32_bf16 v[248:251], a[56:59], a[72:75], v[248:251]
buffer_load_dwordx4 v0, s[20:23], s74 offen offset:1024 sc1 lds
v_mfma_f32_16x16x32_bf16 v[248:251], a[20:23], a[104:107], v[248:251]
s_add_u32 m0, s101, -8192
ds_read_b64_tr_b16 a[52:53], v6 offset:32768
v_mfma_f32_16x16x32_bf16 v[244:247], a[20:23], a[100:103], v[244:247]
s_add_u32 s74, s101, 4294893568
ds_read_b64_tr_b16 a[54:55], v6 offset:33792
v_mfma_f32_16x16x32_bf16 v[244:247], a[56:59], a[68:71], v[244:247]
buffer_load_dwordx4 v0, s[20:23], s74 offen offset:0 sc1 lds
v_mfma_f32_16x16x32_bf16 v[40:43], a[60:63], a[68:71], v[40:43]
ds_read_b128 a[84:87], v28 offset:0
v_mfma_f32_16x16x32_bf16 v[40:43], a[24:27], a[100:103], v[40:43]
ds_read_b128 a[88:91], v29 offset:512
v_mfma_f32_16x16x32_bf16 v[44:47], a[24:27], a[104:107], v[44:47]
buffer_load_dwordx4 v0, s[20:23], s74 offen offset:1024 sc1 lds
v_mfma_f32_16x16x32_bf16 v[44:47], a[60:63], a[72:75], v[44:47]
ds_read_b128 a[92:95], v30 offset:1024
v_mfma_f32_16x16x32_bf16 v[48:51], a[60:63], a[76:79], v[48:51]
ds_read_b128 a[168:171], v32 offset:54272
v_mfma_f32_16x16x32_bf16 v[48:51], a[24:27], a[108:111], v[48:51]
v_mfma_f32_16x16x32_bf16 v[52:55], a[24:27], a[112:115], v[52:55]
ds_read_b128 a[96:99], v31 offset:1536
v_mfma_f32_16x16x32_bf16 v[52:55], a[60:63], a[80:83], v[52:55]
ds_read_b128 a[164:167], v32 offset:53248
v_mfma_f32_16x16x32_bf16 v[68:71], a[64:67], a[80:83], v[68:71]
v_mfma_f32_16x16x32_bf16 v[68:71], a[28:31], a[112:115], v[68:71]
ds_read_b64_tr_b16 a[56:57], v7 offset:32768
v_mfma_f32_16x16x32_bf16 v[64:67], a[28:31], a[108:111], v[64:67]
ds_read_b64_tr_b16 a[58:59], v7 offset:33792
v_mfma_f32_16x16x32_bf16 v[64:67], a[64:67], a[76:79], v[64:67]
v_mfma_f32_16x16x32_bf16 v[60:63], a[64:67], a[72:75], v[60:63]
ds_read_b64_tr_b16 a[60:61], v8 offset:32768
v_mfma_f32_16x16x32_bf16 v[60:63], a[28:31], a[104:107], v[60:63]
ds_read_b64_tr_b16 a[62:63], v8 offset:33792
v_mfma_f32_16x16x32_bf16 v[56:59], a[28:31], a[100:103], v[56:59]
v_mfma_f32_16x16x32_bf16 v[56:59], a[64:67], a[68:71], v[56:59]
ds_read_b128 a[80:83], v26 offset:6144
v_mfma_f32_16x16x32_bf16 a[132:135], a[244:247], a[100:103], a[132:135]
ds_read_b128 a[76:79], v26 offset:4096
v_mfma_f32_16x16x32_bf16 a[136:139], a[244:247], a[104:107], a[136:139]
v_mfma_f32_16x16x32_bf16 a[140:143], a[244:247], a[108:111], a[140:143]
ds_read_b128 a[72:75], v26 offset:2048
v_mfma_f32_16x16x32_bf16 a[144:147], a[244:247], a[112:115], a[144:147]
ds_read_b64_tr_b16 a[64:65], v9 offset:32768
v_mfma_f32_16x16x32_bf16 v[176:179], a[0:3], a[112:115], v[176:179]
v_mfma_f32_16x16x32_bf16 v[172:175], a[0:3], a[108:111], v[172:175]
ds_read_b64_tr_b16 a[66:67], v9 offset:33792
v_mfma_f32_16x16x32_bf16 v[168:171], a[0:3], a[104:107], v[168:171]
ds_read_b128 a[68:71], v26 offset:0
v_mfma_f32_16x16x32_bf16 v[164:167], a[0:3], a[100:103], v[164:167]
v_mfma_f32_16x16x32_bf16 v[180:183], a[4:7], a[100:103], v[180:183]
v_mfma_f32_16x16x32_bf16 v[184:187], a[4:7], a[104:107], v[184:187]
v_mfma_f32_16x16x32_bf16 v[188:191], a[4:7], a[108:111], v[188:191]
v_mfma_f32_16x16x32_bf16 v[192:195], a[4:7], a[112:115], v[192:195]
s_waitcnt lgkmcnt(5)
v_mfma_f32_16x16x32_bf16 v[192:195], a[40:43], a[80:83], v[192:195]
s_waitcnt vmcnt(14) lgkmcnt(0)
s_barrier
v_mfma_f32_16x16x32_bf16 v[188:191], a[40:43], a[76:79], v[188:191]
s_add_u32 m0, s101, -57344
ds_read_b64_tr_b16 a[8:9], v4 offset:49152
v_mfma_f32_16x16x32_bf16 v[184:187], a[40:43], a[72:75], v[184:187]
s_add_u32 s74, s101, 4294918144
ds_read_b64_tr_b16 a[10:11], v4 offset:50176
v_mfma_f32_16x16x32_bf16 v[180:183], a[40:43], a[68:71], v[180:183]
ds_read_b128 a[100:103], v27 offset:0
v_accvgpr_write_b32 a224, 0
v_mfma_f32_16x16x32_bf16 v[164:167], a[36:39], a[68:71], v[164:167]
ds_read_b128 a[104:107], v27 offset:2048
v_accvgpr_write_b32 a225, 0
v_mfma_f32_16x16x32_bf16 v[168:171], a[36:39], a[72:75], v[168:171]
ds_read_b128 a[108:111], v27 offset:4096
v_accvgpr_write_b32 a226, 0
v_mfma_f32_16x16x32_bf16 v[172:175], a[36:39], a[76:79], v[172:175]
ds_read_b128 a[112:115], v27 offset:6144
v_accvgpr_write_b32 a227, 0
v_mfma_f32_16x16x32_bf16 v[176:179], a[36:39], a[80:83], v[176:179]
ds_read_b64_tr_b16 a[12:13], v5 offset:49152
v_accvgpr_write_b32 a228, 0
v_mfma_f32_16x16x32_bf16 a[144:147], a[248:251], a[80:83], a[144:147]
ds_read_b64_tr_b16 a[14:15], v5 offset:50176
v_accvgpr_write_b32 a229, 0
v_mfma_f32_16x16x32_bf16 a[140:143], a[248:251], a[76:79], a[140:143]
buffer_load_dwordx4 v0, s[20:23], s74 offen offset:0 sc1 lds
v_mfma_f32_16x16x32_bf16 a[136:139], a[248:251], a[72:75], a[136:139]
ds_read_b64_tr_b16 a[16:17], v6 offset:49152
v_accvgpr_write_b32 a230, 0
v_mfma_f32_16x16x32_bf16 a[132:135], a[248:251], a[68:71], a[132:135]
ds_read_b64_tr_b16 a[18:19], v6 offset:50176
v_accvgpr_write_b32 a231, 0
v_mfma_f32_16x16x32_bf16 v[196:199], a[44:47], a[68:71], v[196:199]
s_waitcnt lgkmcnt(7)
buffer_load_dwordx4 v0, s[20:23], s74 offen offset:1024 sc1 lds
v_mfma_f32_16x16x32_bf16 v[196:199], a[8:11], a[100:103], v[196:199]
s_waitcnt lgkmcnt(6)
s_add_u32 m0, s101, 0
ds_read_b128 a[116:119], v30 offset:0
v_mfma_f32_16x16x32_bf16 v[200:203], a[8:11], a[104:107], v[200:203]
s_add_u32 s74, s101, 4294909952
ds_read_b128 a[172:175], v32 offset:55296
v_mfma_f32_16x16x32_bf16 v[200:203], a[44:47], a[72:75], v[200:203]
buffer_load_dwordx4 v0, s[20:23], s74 offen offset:0 sc1 lds
v_mfma_f32_16x16x32_bf16 v[204:207], a[44:47], a[76:79], v[204:207]
s_waitcnt lgkmcnt(7)
ds_read_b128 a[176:179], v32 offset:56320
v_accvgpr_write_b32 a232, 0
v_mfma_f32_16x16x32_bf16 v[204:207], a[8:11], a[108:111], v[204:207]
s_waitcnt lgkmcnt(7)
ds_read_b128 a[120:123], v31 offset:512
v_accvgpr_write_b32 a233, 0
v_mfma_f32_16x16x32_bf16 v[208:211], a[8:11], a[112:115], v[208:211]
buffer_load_dwordx4 v0, s[20:23], s74 offen offset:1024 sc1 lds
v_mfma_f32_16x16x32_bf16 v[208:211], a[44:47], a[80:83], v[208:211]
s_add_u32 m0, s101, 8192
ds_read_b64_tr_b16 a[0:1], v2 offset:49152
v_mfma_f32_16x16x32_bf16 v[224:227], a[48:51], a[80:83], v[224:227]
s_waitcnt lgkmcnt(7)
s_add_u32 s74, s101, 4294926336
ds_read_b64_tr_b16 a[2:3], v2 offset:50176
v_mfma_f32_16x16x32_bf16 v[224:227], a[12:15], a[112:115], v[224:227]
buffer_load_dwordx4 v0, s[20:23], s74 offen offset:0 sc1 lds
v_mfma_f32_16x16x32_bf16 v[220:223], a[12:15], a[108:111], v[220:223]
ds_read_b64_tr_b16 a[4:5], v3 offset:49152
v_accvgpr_write_b32 a234, 0
v_mfma_f32_16x16x32_bf16 v[220:223], a[48:51], a[76:79], v[220:223]
ds_read_b64_tr_b16 a[6:7], v3 offset:50176
v_accvgpr_write_b32 a235, 0
v_mfma_f32_16x16x32_bf16 v[216:219], a[48:51], a[72:75], v[216:219]
buffer_load_dwordx4 v0, s[20:23], s74 offen offset:1024 sc1 lds
v_mfma_f32_16x16x32_bf16 v[216:219], a[12:15], a[104:107], v[216:219]
ds_read_b64_tr_b16 a[20:21], v7 offset:49152
v_accvgpr_write_b32 a236, 0
v_mfma_f32_16x16x32_bf16 v[212:215], a[12:15], a[100:103], v[212:215]
ds_read_b64_tr_b16 a[22:23], v7 offset:50176
v_accvgpr_write_b32 a237, 0
v_mfma_f32_16x16x32_bf16 v[212:215], a[48:51], a[68:71], v[212:215]
v_accvgpr_write_b32 a238, 0
v_accvgpr_write_b32 a239, 0
v_mfma_f32_16x16x32_bf16 v[228:231], a[52:55], a[68:71], v[228:231]
s_waitcnt lgkmcnt(10)
ds_read_b64_tr_b16 a[24:25], v8 offset:49152
v_mov_b32 v72, 0
v_mfma_f32_16x16x32_bf16 v[228:231], a[16:19], a[100:103], v[228:231]
ds_read_b64_tr_b16 a[26:27], v8 offset:50176
v_mov_b32 v73, 0
v_mfma_f32_16x16x32_bf16 v[232:235], a[16:19], a[104:107], v[232:235]
v_mov_b32 v74, 0
v_mov_b32 v75, 0
v_mfma_f32_16x16x32_bf16 v[232:235], a[52:55], a[72:75], v[232:235]
ds_read_b64_tr_b16 a[28:29], v9 offset:49152
v_mov_b32 v76, 0
v_mfma_f32_16x16x32_bf16 v[236:239], a[52:55], a[76:79], v[236:239]
ds_read_b64_tr_b16 a[30:31], v9 offset:50176
v_mov_b32 v77, 0
v_mfma_f32_16x16x32_bf16 v[236:239], a[16:19], a[108:111], v[236:239]
v_mov_b32 v78, 0
v_mov_b32 v79, 0
v_mfma_f32_16x16x32_bf16 v[240:243], a[16:19], a[112:115], v[240:243]
ds_read_b128 a[124:127], v28 offset:1024
v_mov_b32 v80, 0
v_mfma_f32_16x16x32_bf16 v[240:243], a[52:55], a[80:83], v[240:243]
ds_read_b128 a[128:131], v29 offset:1536
v_mov_b32 v81, 0
v_mfma_f32_16x16x32_bf16 a[192:195], a[84:87], a[164:167], a[192:195]
s_waitcnt lgkmcnt(14)
v_mov_b32 v82, 0
v_mov_b32 v83, 0
v_mfma_f32_16x16x32_bf16 a[192:195], a[116:119], a[172:175], a[192:195]
s_waitcnt lgkmcnt(13)
v_mov_b32 v84, 0
v_mov_b32 v85, 0
v_mfma_f32_16x16x32_bf16 a[196:199], a[116:119], a[176:179], a[196:199]
v_mov_b32 v86, 0
v_mov_b32 v87, 0
v_mfma_f32_16x16x32_bf16 a[196:199], a[84:87], a[168:171], a[196:199]
v_mov_b32 v88, 0
v_mov_b32 v89, 0
v_mfma_f32_16x16x32_bf16 a[204:207], a[88:91], a[168:171], a[204:207]
s_waitcnt lgkmcnt(12)
v_mov_b32 v90, 0
v_mov_b32 v91, 0
v_mfma_f32_16x16x32_bf16 a[204:207], a[120:123], a[176:179], a[204:207]
v_mov_b32 v92, 0
v_mov_b32 v93, 0
v_mfma_f32_16x16x32_bf16 a[200:203], a[120:123], a[172:175], a[200:203]
v_mov_b32 v94, 0
v_mov_b32 v95, 0
v_mfma_f32_16x16x32_bf16 a[200:203], a[88:91], a[164:167], a[200:203]
v_mfma_f32_16x16x32_bf16 a[208:211], a[92:95], a[164:167], a[208:211]
s_waitcnt vmcnt(12) lgkmcnt(0)
s_barrier
s_cmp_lg_u32 s80, 0
s_cbranch_scc1 LA_f2
s_mov_b64 exec, 1
v_mov_b32 v1, 1
s_lshl2_add_u32 s75, s82, s40
buffer_store_dword v1, off, s[76:79], s75 offset:32 sc1
s_mov_b64 exec, -1
LA_f2:
v_mfma_f32_16x16x32_bf16 a[208:211], a[124:127], a[172:175], a[208:211]
s_add_u32 m0, s101, -49152
s_add_u32 s74, s101, 4294934528
v_mfma_f32_16x16x32_bf16 a[212:215], a[124:127], a[176:179], a[212:215]
buffer_load_dwordx4 v0, s[20:23], s74 offen offset:0 sc1 lds
v_mfma_f32_16x16x32_bf16 a[212:215], a[92:95], a[168:171], a[212:215]
v_mov_b32 v96, 0
v_mov_b32 v97, 0
v_mfma_f32_16x16x32_bf16 a[220:223], a[96:99], a[168:171], a[220:223]
buffer_load_dwordx4 v0, s[20:23], s74 offen offset:1024 sc1 lds
v_mfma_f32_16x16x32_bf16 a[220:223], a[128:131], a[176:179], a[220:223]
s_add_u32 m0, s101, -40960
s_add_u32 s74, s101, 4294950912
v_mfma_f32_16x16x32_bf16 a[216:219], a[128:131], a[172:175], a[216:219]
buffer_load_dwordx4 v0, s[20:23], s74 offen offset:0 sc1 lds
v_mfma_f32_16x16x32_bf16 a[216:219], a[96:99], a[164:167], a[216:219]
v_mov_b32 v98, 0
v_mov_b32 v99, 0
v_mfma_f32_16x16x32_bf16 v[36:39], a[56:59], a[80:83], v[36:39]
buffer_load_dwordx4 v0, s[20:23], s74 offen offset:1024 sc1 lds
v_mfma_f32_16x16x32_bf16 v[36:39], a[20:23], a[112:115], v[36:39]
s_add_u32 m0, s101, 16384
s_add_u32 s74, s101, 4294942720
v_mfma_f32_16x16x32_bf16 v[252:255], a[20:23], a[108:111], v[252:255]
buffer_load_dwordx4 v0, s[20:23], s74 offen offset:0 sc1 lds
v_mfma_f32_16x16x32_bf16 v[252:255], a[56:59], a[76:79], v[252:255]
v_mov_b32 v100, 0
v_mov_b32 v101, 0
v_mfma_f32_16x16x32_bf16 v[248:251], a[56:59], a[72:75], v[248:251]
buffer_load_dwordx4 v0, s[20:23], s74 offen offset:1024 sc1 lds
v_mfma_f32_16x16x32_bf16 v[248:251], a[20:23], a[104:107], v[248:251]
s_add_u32 m0, s101, -24576
s_add_u32 s74, s101, 16384
v_mfma_f32_16x16x32_bf16 v[244:247], a[20:23], a[100:103], v[244:247]
buffer_load_dwordx4 v0, s[20:23], s74 offen offset:0 sc1 lds
v_mfma_f32_16x16x32_bf16 v[244:247], a[56:59], a[68:71], v[244:247]
v_mov_b32 v102, 0
v_mov_b32 v103, 0
v_mfma_f32_16x16x32_bf16 v[40:43], a[60:63], a[68:71], v[40:43]
buffer_load_dwordx4 v0, s[20:23], s74 offen offset:1024 sc1 lds
v_mfma_f32_16x16x32_bf16 v[40:43], a[24:27], a[100:103], v[40:43]
v_mov_b32 v104, 0
v_mov_b32 v105, 0
v_mfma_f32_16x16x32_bf16 v[44:47], a[24:27], a[104:107], v[44:47]
v_mov_b32 v106, 0
v_mov_b32 v107, 0
v_mfma_f32_16x16x32_bf16 v[44:47], a[60:63], a[72:75], v[44:47]
v_mov_b32 v108, 0
v_mov_b32 v109, 0
v_mfma_f32_16x16x32_bf16 v[48:51], a[60:63], a[76:79], v[48:51]
v_mov_b32 v110, 0
v_mov_b32 v111, 0
v_mfma_f32_16x16x32_bf16 v[48:51], a[24:27], a[108:111], v[48:51]
v_mov_b32 v112, 0
v_mov_b32 v113, 0
v_mfma_f32_16x16x32_bf16 v[52:55], a[24:27], a[112:115], v[52:55]
v_mov_b32 v114, 0
v_mov_b32 v115, 0
v_mfma_f32_16x16x32_bf16 v[52:55], a[60:63], a[80:83], v[52:55]
v_mov_b32 v116, 0
v_mov_b32 v117, 0
v_mfma_f32_16x16x32_bf16 v[68:71], a[64:67], a[80:83], v[68:71]
v_mov_b32 v118, 0
v_mov_b32 v119, 0
v_mfma_f32_16x16x32_bf16 v[68:71], a[28:31], a[112:115], v[68:71]
v_mov_b32 v120, 0
v_mov_b32 v121, 0
v_mfma_f32_16x16x32_bf16 v[64:67], a[28:31], a[108:111], v[64:67]
v_mov_b32 v122, 0
v_mov_b32 v123, 0
v_mfma_f32_16x16x32_bf16 v[64:67], a[64:67], a[76:79], v[64:67]
v_mov_b32 v124, 0
v_mov_b32 v125, 0
v_mfma_f32_16x16x32_bf16 v[60:63], a[64:67], a[72:75], v[60:63]
v_mov_b32 v126, 0
v_mov_b32 v127, 0
v_mfma_f32_16x16x32_bf16 v[60:63], a[28:31], a[104:107], v[60:63]
v_mov_b32 v128, 0
v_mov_b32 v129, 0
v_mfma_f32_16x16x32_bf16 v[56:59], a[28:31], a[100:103], v[56:59]
v_mov_b32 v130, 0
v_mov_b32 v131, 0
v_mfma_f32_16x16x32_bf16 v[56:59], a[64:67], a[68:71], v[56:59]
v_mov_b32 v132, 0
v_mov_b32 v133, 0
v_mfma_f32_16x16x32_bf16 a[132:135], a[252:255], a[100:103], a[132:135]
v_mov_b32 v134, 0
v_mov_b32 v135, 0
v_mfma_f32_16x16x32_bf16 a[136:139], a[252:255], a[104:107], a[136:139]
v_mov_b32 v136, 0
v_mov_b32 v137, 0
v_mfma_f32_16x16x32_bf16 a[140:143], a[252:255], a[108:111], a[140:143]
v_mov_b32 v138, 0
v_mov_b32 v139, 0
v_mfma_f32_16x16x32_bf16 a[144:147], a[252:255], a[112:115], a[144:147]
v_mov_b32 v140, 0
v_mov_b32 v141, 0
v_mfma_f32_16x16x32_bf16 v[176:179], a[0:3], a[112:115], v[176:179]
v_mov_b32 v142, 0
v_mov_b32 v143, 0
v_mfma_f32_16x16x32_bf16 v[172:175], a[0:3], a[108:111], v[172:175]
v_mov_b32 v144, 0
v_mov_b32 v145, 0
v_mfma_f32_16x16x32_bf16 v[168:171], a[0:3], a[104:107], v[168:171]
v_mov_b32 v146, 0
v_mov_b32 v147, 0
v_mfma_f32_16x16x32_bf16 v[164:167], a[0:3], a[100:103], v[164:167]
v_mov_b32 v148, 0
v_mov_b32 v149, 0
v_mfma_f32_16x16x32_bf16 v[180:183], a[4:7], a[100:103], v[180:183]
v_mov_b32 v150, 0
v_mov_b32 v151, 0
v_mfma_f32_16x16x32_bf16 v[184:187], a[4:7], a[104:107], v[184:187]
v_mov_b32 v152, 0
v_mov_b32 v153, 0
v_mfma_f32_16x16x32_bf16 v[188:191], a[4:7], a[108:111], v[188:191]
v_mov_b32 v154, 0
v_mov_b32 v155, 0
v_mfma_f32_16x16x32_bf16 v[192:195], a[4:7], a[112:115], v[192:195]
v_mov_b32 v156, 0
v_mov_b32 v157, 0
v_mov_b32 v158, 0
v_mov_b32 v159, 0
v_mov_b32 v160, 0
v_mov_b32 v161, 0
v_mov_b32 v162, 0
v_mov_b32 v163, 0
s_lshl2_add_u32 s34, s85, s80
v_add_u32 v22, (LA_att-LA_pc)/4, v0
v_lshl_add_u32 v22, s34, 10, v22
v_mad_u64_u32 v[22:23], vcc, v22, 4, s[72:73]
global_load_dword a183, v[22:23], off
v_accvgpr_read_b32 v24, a192
v_accvgpr_read_b32 v25, a196
v_accvgpr_read_b32 v26, a193
v_accvgpr_read_b32 v27, a197
v_pk_fma_f32 v[26:27], v[24:25], v[10:11], v[26:27] op_sel_hi:[1,0,1]
v_accvgpr_read_b32 v28, a194
v_pk_fma_f32 v[26:27], v[24:25], v[10:11], v[26:27] op_sel:[1,1,0] op_sel_hi:[0,1,1] neg_lo:[0,1,0]
v_accvgpr_read_b32 v29, a198
v_pk_fma_f32 v[28:29], v[26:27], v[10:11], v[28:29] op_sel_hi:[1,0,1]
v_accvgpr_read_b32 v30, a195
v_pk_fma_f32 v[28:29], v[26:27], v[10:11], v[28:29] op_sel:[1,1,0] op_sel_hi:[0,1,1] neg_lo:[0,1,0]
v_accvgpr_read_b32 v31, a199
v_pk_fma_f32 v[30:31], v[28:29], v[10:11], v[30:31] op_sel_hi:[1,0,1]
v_accvgpr_read_b32 v24, a200
v_pk_fma_f32 v[30:31], v[28:29], v[10:11], v[30:31] op_sel:[1,1,0] op_sel_hi:[0,1,1] neg_lo:[0,1,0]
v_accvgpr_read_b32 v25, a204
v_pk_fma_f32 v[24:25], v[30:31], v[10:11], v[24:25] op_sel_hi:[1,0,1]
v_accvgpr_read_b32 v26, a201
v_pk_fma_f32 v[24:25], v[30:31], v[10:11], v[24:25] op_sel:[1,1,0] op_sel_hi:[0,1,1] neg_lo:[0,1,0]
v_accvgpr_read_b32 v27, a205
v_pk_fma_f32 v[26:27], v[24:25], v[10:11], v[26:27] op_sel_hi:[1,0,1]
v_accvgpr_read_b32 v28, a202
v_pk_fma_f32 v[26:27], v[24:25], v[10:11], v[26:27] op_sel:[1,1,0] op_sel_hi:[0,1,1] neg_lo:[0,1,0]
v_accvgpr_read_b32 v29, a206
v_pk_fma_f32 v[28:29], v[26:27], v[10:11], v[28:29] op_sel_hi:[1,0,1]
v_accvgpr_read_b32 v30, a203
v_pk_fma_f32 v[28:29], v[26:27], v[10:11], v[28:29] op_sel:[1,1,0] op_sel_hi:[0,1,1] neg_lo:[0,1,0]
v_accvgpr_read_b32 v31, a207
v_pk_fma_f32 v[30:31], v[28:29], v[10:11], v[30:31] op_sel_hi:[1,0,1]
v_accvgpr_read_b32 v24, a208
v_pk_fma_f32 v[30:31], v[28:29], v[10:11], v[30:31] op_sel:[1,1,0] op_sel_hi:[0,1,1] neg_lo:[0,1,0]
v_accvgpr_read_b32 v25, a212
v_pk_fma_f32 v[24:25], v[30:31], v[10:11], v[24:25] op_sel_hi:[1,0,1]
v_accvgpr_read_b32 v26, a209
v_pk_fma_f32 v[24:25], v[30:31], v[10:11], v[24:25] op_sel:[1,1,0] op_sel_hi:[0,1,1] neg_lo:[0,1,0]
v_accvgpr_read_b32 v27, a213
v_pk_fma_f32 v[26:27], v[24:25], v[10:11], v[26:27] op_sel_hi:[1,0,1]
v_accvgpr_read_b32 v28, a210
v_pk_fma_f32 v[26:27], v[24:25], v[10:11], v[26:27] op_sel:[1,1,0] op_sel_hi:[0,1,1] neg_lo:[0,1,0]
v_accvgpr_read_b32 v29, a214
v_pk_fma_f32 v[28:29], v[26:27], v[10:11], v[28:29] op_sel_hi:[1,0,1]
v_accvgpr_read_b32 v30, a211
v_pk_fma_f32 v[28:29], v[26:27], v[10:11], v[28:29] op_sel:[1,1,0] op_sel_hi:[0,1,1] neg_lo:[0,1,0]
v_accvgpr_read_b32 v31, a215
v_pk_fma_f32 v[30:31], v[28:29], v[10:11], v[30:31] op_sel_hi:[1,0,1]
v_accvgpr_read_b32 v24, a216
v_pk_fma_f32 v[30:31], v[28:29], v[10:11], v[30:31] op_sel:[1,1,0] op_sel_hi:[0,1,1] neg_lo:[0,1,0]
v_accvgpr_read_b32 v25, a220
v_pk_fma_f32 v[24:25], v[30:31], v[10:11], v[24:25] op_sel_hi:[1,0,1]
v_accvgpr_read_b32 v26, a217
v_pk_fma_f32 v[24:25], v[30:31], v[10:11], v[24:25] op_sel:[1,1,0] op_sel_hi:[0,1,1] neg_lo:[0,1,0]
v_accvgpr_read_b32 v27, a221
v_pk_fma_f32 v[26:27], v[24:25], v[10:11], v[26:27] op_sel_hi:[1,0,1]
v_accvgpr_read_b32 v28, a218
v_pk_fma_f32 v[26:27], v[24:25], v[10:11], v[26:27] op_sel:[1,1,0] op_sel_hi:[0,1,1] neg_lo:[0,1,0]
v_accvgpr_read_b32 v29, a222
v_pk_fma_f32 v[28:29], v[26:27], v[10:11], v[28:29] op_sel_hi:[1,0,1]
v_accvgpr_read_b32 v30, a219
v_pk_fma_f32 v[28:29], v[26:27], v[10:11], v[28:29] op_sel:[1,1,0] op_sel_hi:[0,1,1] neg_lo:[0,1,0]
v_accvgpr_read_b32 v31, a223
v_pk_fma_f32 v[30:31], v[28:29], v[10:11], v[30:31] op_sel_hi:[1,0,1]
v_pk_fma_f32 v[30:31], v[28:29], v[10:11], v[30:31] op_sel:[1,1,0] op_sel_hi:[0,1,1] neg_lo:[0,1,0]
s_and_b32 s3, s80, 1
s_lshr_b32 s33, s80, 1
s_mul_i32 s93, s33, 147456
s_lshl_b32 s34, s3, 13
s_add_u32 s93, s93, s34
v_lshrrev_b32 v22, 1, v0
v_and_b32 v23, 0x78, v22
v_add_u32 v22, s93, v22
v_add_u32 v21, s93, v23
ds_write_b64 v22, v[30:31]
ds_read_b64 v[24:25], v21
ds_read_b64 v[26:27], v21 offset:128
ds_read_b64 v[28:29], v21 offset:256
s_sub_u32 s34, 15, s82
s_cmp_lt_u32 s80, 2
s_cselect_b32 s34, s82, s34
s_lshl1_add_u32 s92, s34, s3
s_lshl_b32 s34, s81, 6
s_add_u32 s34, s34, s92
s_lshl_b32 s34, s34, 7
s_add_u32 s86, s34, 54525952
v_and_b32 v22, 256, v0
v_lshl_or_b32 v23, v22, 4, v23
v_mul_f32 v22, v15, v15
v_mul_f32 v9, v14, v15
v_fma_f32 v8, v14, v14, -v22
v_add_f32 v9, v9, v9
v_mul_f32 v22, v9, v9
v_mul_f32 v9, v8, v9
v_fma_f32 v8, v8, v8, -v22
v_add_f32 v9, v9, v9
v_accvgpr_read_b32 v4, a132
v_accvgpr_read_b32 v5, a136
v_accvgpr_read_b32 v6, a140
v_accvgpr_read_b32 v7, a144
v_cvt_pk_bf16_f32 v4, v4, v4
v_cvt_pk_bf16_f32 v5, v5, v5
v_cvt_pk_bf16_f32 v6, v6, v6
v_cvt_pk_bf16_f32 v7, v7, v7
v_lshlrev_b32 v4, 16, v4
v_lshlrev_b32 v5, 16, v5
v_lshlrev_b32 v6, 16, v6
v_lshlrev_b32 v7, 16, v7
v_mul_f32 v4, 0xbfb8aa3b, v4
v_mul_f32 v5, 0xbfb8aa3b, v5
v_mul_f32 v6, 0xbfb8aa3b, v6
v_mul_f32 v7, 0xbfb8aa3b, v7
v_exp_f32 v4, v4
v_exp_f32 v5, v5
v_exp_f32 v6, v6
v_exp_f32 v7, v7
v_add_f32 v4, 1.0, v4
v_add_f32 v5, 1.0, v5
v_add_f32 v6, 1.0, v6
v_add_f32 v7, 1.0, v7
v_rcp_f32 v4, v4
v_rcp_f32 v5, v5
v_rcp_f32 v6, v6
v_rcp_f32 v7, v7
v_cvt_pk_bf16_f32 v4, v4, v4
v_cvt_pk_bf16_f32 v5, v5, v5
v_cvt_pk_bf16_f32 v6, v6, v6
v_cvt_pk_bf16_f32 v7, v7, v7
v_lshlrev_b32 v4, 16, v4
v_lshlrev_b32 v5, 16, v5
v_lshlrev_b32 v6, 16, v6
v_lshlrev_b32 v7, 16, v7
s_mov_b64 exec, 0xffff
s_waitcnt lgkmcnt(2)
v_mov_b64 v[24:25], 0
s_lshl_b64 exec, -1, 32
s_waitcnt lgkmcnt(1)
v_pk_fma_f32 v[26:27], v[24:25], v[12:13], v[26:27] op_sel_hi:[1,0,1]
v_pk_fma_f32 v[26:27], v[24:25], v[12:13], v[26:27] op_sel:[1,1,0] op_sel_hi:[0,1,1] neg_lo:[0,1,0]
v_mov_b64 v[24:25], v[26:27]
s_lshl_b64 exec, -1, 48
s_waitcnt lgkmcnt(0)
v_pk_fma_f32 v[28:29], v[24:25], v[12:13], v[28:29] op_sel_hi:[1,0,1]
v_pk_fma_f32 v[28:29], v[24:25], v[12:13], v[28:29] op_sel:[1,1,0] op_sel_hi:[0,1,1] neg_lo:[0,1,0]
v_mov_b64 v[24:25], v[28:29]
v_pk_fma_f32 v[30:31], v[24:25], v[12:13], v[30:31] op_sel_hi:[1,0,1]
v_pk_fma_f32 v[30:31], v[24:25], v[12:13], v[30:31] op_sel:[1,1,0] op_sel_hi:[0,1,1] neg_lo:[0,1,0]
s_lshl_b64 exec, 0xffff, 32
v_mov_b64 v[30:31], 0
s_lshl_b64 exec, -1, 32
buffer_store_dwordx2 v[30:31], v23, s[76:79], s86 offen sc1
s_mov_b64 exec, -1
v_accvgpr_write_b32 a188, v24
v_accvgpr_write_b32 a189, v25
s_mul_i32 s34, s84, 2621440
s_lshl_b32 s35, s85, 12
s_add_u32 s34, s34, s35
s_add_u32 s34, s34, 33554432
s_mul_i32 s35, s82, 163840
s_mul_i32 s32, s80, 20480
s_add_u32 s33, s34, s35
s_add_u32 s88, s33, s32
s_sub_u32 s89, s33, s32
s_add_u32 s89, s89, 143360
s_sub_u32 s33, s34, s35
s_add_u32 s33, s33, 2457600
s_add_u32 s90, s33, s32
s_sub_u32 s91, s33, s32
s_add_u32 s91, s91, 143360
v_add_u32 v22, s93, v0
s_lshl_b32 s34, s3, 14
s_add_u32 s34, s34, 147456
s_sub_u32 s34, s34, s93
v_add_u32 v23, s34, v0
s_lshl_b32 s94, s2, 2
s_add_u32 s94, s94, s80
s_lshl_b32 s94, s94, 13
s_add_u32 s94, s94, 58720256
s_add_u32 s95, s94, 4096
s_lshl_b32 s34, s82, 16
s_sub_u32 s22, 0x100000, s34
s_mov_b32 s34, 0x3e0293ee
s_mov_b32 s35, 0x3e0293ee
s_mov_b32 s16, 0
v_pk_mul_f32 v[172:173], v[172:173], s[34:35]
v_pk_mul_f32 v[174:175], v[174:175], s[34:35]
v_pk_mul_f32 v[188:189], v[188:189], s[34:35]
v_pk_mul_f32 v[190:191], v[190:191], s[34:35]
v_cvt_pk_bf16_f32 v172, v172, v173
v_cvt_pk_bf16_f32 v173, v174, v175
v_cvt_pk_bf16_f32 v174, v188, v189
v_cvt_pk_bf16_f32 v175, v190, v191
ds_write_b128 v22, v[172:175] offset:0
v_pk_mul_f32 v[204:205], v[204:205], s[34:35]
v_pk_mul_f32 v[206:207], v[206:207], s[34:35]
v_pk_mul_f32 v[220:221], v[220:221], s[34:35]
v_pk_mul_f32 v[222:223], v[222:223], s[34:35]
v_cvt_pk_bf16_f32 v204, v204, v205
v_cvt_pk_bf16_f32 v205, v206, v207
v_cvt_pk_bf16_f32 v206, v220, v221
v_cvt_pk_bf16_f32 v207, v222, v223
ds_write_b128 v22, v[204:207] offset:1024
v_pk_mul_f32 v[236:237], v[236:237], s[34:35]
v_pk_mul_f32 v[238:239], v[238:239], s[34:35]
v_pk_mul_f32 v[252:253], v[252:253], s[34:35]
v_pk_mul_f32 v[254:255], v[254:255], s[34:35]
v_cvt_pk_bf16_f32 v236, v236, v237
v_cvt_pk_bf16_f32 v237, v238, v239
v_cvt_pk_bf16_f32 v238, v252, v253
v_cvt_pk_bf16_f32 v239, v254, v255
ds_write_b128 v22, v[236:239] offset:2048
v_pk_mul_f32 v[48:49], v[48:49], s[34:35]
v_pk_mul_f32 v[50:51], v[50:51], s[34:35]
v_pk_mul_f32 v[64:65], v[64:65], s[34:35]
v_pk_mul_f32 v[66:67], v[66:67], s[34:35]
v_cvt_pk_bf16_f32 v48, v48, v49
v_cvt_pk_bf16_f32 v49, v50, v51
v_cvt_pk_bf16_f32 v50, v64, v65
v_cvt_pk_bf16_f32 v51, v66, v67
ds_write_b128 v22, v[48:51] offset:3072
v_pk_mul_f32 v[176:177], v[176:177], s[34:35]
v_pk_mul_f32 v[178:179], v[178:179], s[34:35]
v_pk_mul_f32 v[192:193], v[192:193], s[34:35]
v_pk_mul_f32 v[194:195], v[194:195], s[34:35]
v_cvt_pk_bf16_f32 v176, v176, v177
v_cvt_pk_bf16_f32 v177, v178, v179
v_cvt_pk_bf16_f32 v178, v192, v193
v_cvt_pk_bf16_f32 v179, v194, v195
ds_write_b128 v22, v[176:179] offset:4096
v_pk_mul_f32 v[208:209], v[208:209], s[34:35]
v_pk_mul_f32 v[210:211], v[210:211], s[34:35]
v_pk_mul_f32 v[224:225], v[224:225], s[34:35]
v_pk_mul_f32 v[226:227], v[226:227], s[34:35]
v_cvt_pk_bf16_f32 v208, v208, v209
v_cvt_pk_bf16_f32 v209, v210, v211
v_cvt_pk_bf16_f32 v210, v224, v225
v_cvt_pk_bf16_f32 v211, v226, v227
ds_write_b128 v22, v[208:211] offset:5120
v_pk_mul_f32 v[240:241], v[240:241], s[34:35]
v_pk_mul_f32 v[242:243], v[242:243], s[34:35]
v_pk_mul_f32 v[36:37], v[36:37], s[34:35]
v_pk_mul_f32 v[38:39], v[38:39], s[34:35]
v_cvt_pk_bf16_f32 v240, v240, v241
v_cvt_pk_bf16_f32 v241, v242, v243
v_cvt_pk_bf16_f32 v242, v36, v37
v_cvt_pk_bf16_f32 v243, v38, v39
ds_write_b128 v22, v[240:243] offset:6144
v_pk_mul_f32 v[52:53], v[52:53], s[34:35]
v_pk_mul_f32 v[54:55], v[54:55], s[34:35]
v_pk_mul_f32 v[68:69], v[68:69], s[34:35]
v_pk_mul_f32 v[70:71], v[70:71], s[34:35]
v_cvt_pk_bf16_f32 v52, v52, v53
v_cvt_pk_bf16_f32 v53, v54, v55
v_cvt_pk_bf16_f32 v54, v68, v69
v_cvt_pk_bf16_f32 v55, v70, v71
ds_write_b128 v22, v[52:55] offset:7168
v_pk_mul_f32 v[164:165], v[164:165], s[34:35]
v_pk_mul_f32 v[166:167], v[166:167], s[34:35]
v_pk_mul_f32 v[180:181], v[180:181], s[34:35]
v_pk_mul_f32 v[182:183], v[182:183], s[34:35]
v_cvt_pk_bf16_f32 v164, v164, v165
v_cvt_pk_bf16_f32 v165, v166, v167
v_cvt_pk_bf16_f32 v166, v180, v181
v_cvt_pk_bf16_f32 v167, v182, v183
buffer_store_dwordx4 v[164:167], v0, s[76:79], s94 offen offset:0
v_accvgpr_write_b32 a0, v164
v_accvgpr_write_b32 a1, v165
v_accvgpr_write_b32 a2, v166
v_accvgpr_write_b32 a3, v167
v_pk_mul_f32 v[196:197], v[196:197], s[34:35]
v_pk_mul_f32 v[198:199], v[198:199], s[34:35]
v_pk_mul_f32 v[212:213], v[212:213], s[34:35]
v_pk_mul_f32 v[214:215], v[214:215], s[34:35]
v_cvt_pk_bf16_f32 v196, v196, v197
v_cvt_pk_bf16_f32 v197, v198, v199
v_cvt_pk_bf16_f32 v198, v212, v213
v_cvt_pk_bf16_f32 v199, v214, v215
buffer_store_dwordx4 v[196:199], v0, s[76:79], s94 offen offset:1024
v_accvgpr_write_b32 a4, v196
v_accvgpr_write_b32 a5, v197
v_accvgpr_write_b32 a6, v198
v_accvgpr_write_b32 a7, v199
v_pk_mul_f32 v[228:229], v[228:229], s[34:35]
v_pk_mul_f32 v[230:231], v[230:231], s[34:35]
v_pk_mul_f32 v[244:245], v[244:245], s[34:35]
v_pk_mul_f32 v[246:247], v[246:247], s[34:35]
v_cvt_pk_bf16_f32 v228, v228, v229
v_cvt_pk_bf16_f32 v229, v230, v231
v_cvt_pk_bf16_f32 v230, v244, v245
v_cvt_pk_bf16_f32 v231, v246, v247
buffer_store_dwordx4 v[228:231], v0, s[76:79], s94 offen offset:2048
v_accvgpr_write_b32 a8, v228
v_accvgpr_write_b32 a9, v229
v_accvgpr_write_b32 a10, v230
v_accvgpr_write_b32 a11, v231
v_pk_mul_f32 v[40:41], v[40:41], s[34:35]
v_pk_mul_f32 v[42:43], v[42:43], s[34:35]
v_pk_mul_f32 v[56:57], v[56:57], s[34:35]
v_pk_mul_f32 v[58:59], v[58:59], s[34:35]
v_cvt_pk_bf16_f32 v40, v40, v41
v_cvt_pk_bf16_f32 v41, v42, v43
v_cvt_pk_bf16_f32 v42, v56, v57
v_cvt_pk_bf16_f32 v43, v58, v59
buffer_store_dwordx4 v[40:43], v0, s[76:79], s94 offen offset:3072
v_accvgpr_write_b32 a12, v40
v_accvgpr_write_b32 a13, v41
v_accvgpr_write_b32 a14, v42
v_accvgpr_write_b32 a15, v43
v_pk_mul_f32 v[168:169], v[168:169], s[34:35]
v_pk_mul_f32 v[170:171], v[170:171], s[34:35]
v_pk_mul_f32 v[184:185], v[184:185], s[34:35]
v_pk_mul_f32 v[186:187], v[186:187], s[34:35]
v_cvt_pk_bf16_f32 v168, v168, v169
v_cvt_pk_bf16_f32 v169, v170, v171
v_cvt_pk_bf16_f32 v170, v184, v185
v_cvt_pk_bf16_f32 v171, v186, v187
buffer_store_dwordx4 v[168:171], v0, s[76:79], s95 offen offset:0
v_accvgpr_write_b32 a16, v168
v_accvgpr_write_b32 a17, v169
v_accvgpr_write_b32 a18, v170
v_accvgpr_write_b32 a19, v171
v_pk_mul_f32 v[200:201], v[200:201], s[34:35]
v_pk_mul_f32 v[202:203], v[202:203], s[34:35]
v_pk_mul_f32 v[216:217], v[216:217], s[34:35]
v_pk_mul_f32 v[218:219], v[218:219], s[34:35]
v_cvt_pk_bf16_f32 v200, v200, v201
v_cvt_pk_bf16_f32 v201, v202, v203
v_cvt_pk_bf16_f32 v202, v216, v217
v_cvt_pk_bf16_f32 v203, v218, v219
buffer_store_dwordx4 v[200:203], v0, s[76:79], s95 offen offset:1024
v_accvgpr_write_b32 a20, v200
v_accvgpr_write_b32 a21, v201
v_accvgpr_write_b32 a22, v202
v_accvgpr_write_b32 a23, v203
v_pk_mul_f32 v[232:233], v[232:233], s[34:35]
v_pk_mul_f32 v[234:235], v[234:235], s[34:35]
v_pk_mul_f32 v[248:249], v[248:249], s[34:35]
v_pk_mul_f32 v[250:251], v[250:251], s[34:35]
v_cvt_pk_bf16_f32 v232, v232, v233
v_cvt_pk_bf16_f32 v233, v234, v235
v_cvt_pk_bf16_f32 v234, v248, v249
v_cvt_pk_bf16_f32 v235, v250, v251
buffer_store_dwordx4 v[232:235], v0, s[76:79], s95 offen offset:2048
v_accvgpr_write_b32 a24, v232
v_accvgpr_write_b32 a25, v233
v_accvgpr_write_b32 a26, v234
v_accvgpr_write_b32 a27, v235
v_pk_mul_f32 v[44:45], v[44:45], s[34:35]
v_pk_mul_f32 v[46:47], v[46:47], s[34:35]
v_pk_mul_f32 v[60:61], v[60:61], s[34:35]
v_pk_mul_f32 v[62:63], v[62:63], s[34:35]
v_cvt_pk_bf16_f32 v44, v44, v45
v_cvt_pk_bf16_f32 v45, v46, v47
v_cvt_pk_bf16_f32 v46, v60, v61
v_cvt_pk_bf16_f32 v47, v62, v63
buffer_store_dwordx4 v[44:47], v0, s[76:79], s95 offen offset:3072
v_accvgpr_write_b32 a28, v44
v_accvgpr_write_b32 a29, v45
v_accvgpr_write_b32 a30, v46
v_accvgpr_write_b32 a31, v47
s_lshl_b32 s34, s84, 19
s_lshl_b32 s35, s85, 8
s_add_u32 s34, s34, s35
s_and_b32 s17, s82, 1
s_lshl_b32 s17, s17, 15
s_add_u32 s17, s17, 81920
s_cmp_eq_u32 s3, 0
s_cselect_b32 s52, s58, s60
s_cselect_b32 s53, s59, s61
s_mov_b32 s54, 0x80000
s_mov_b32 s55, 0x20000
s_mov_b32 s38, 0x200000
s_mov_b32 s39, 0x20000
s_mov_b32 s66, 1024
s_mov_b32 s67, 0x20000
s_mov_b32 s70, 0x400000
s_mov_b32 s71, 0x20000
s_add_u32 s28, s46, s34
s_addc_u32 s29, s47, 0
s_mov_b32 s30, 0x7fd00
s_mov_b32 s31, 0x20000
s_and_b32 s3, s80, 1
s_lshr_b32 s33, s80, 1
s_lshl_b32 s34, s3, 12
s_add_u32 s9, s34, 16384
s_add_u32 s10, s34, 81920
s_cmp_eq_u32 s33, 0
s_cselect_b32 s6, s9, s10
s_cselect_b32 s5, 0, 40960
s_cselect_b32 s4, 40960, 0
s_cselect_b32 s14, 16384, 0
s_add_u32 s14, s14, 8192
s_add_u32 s4, s4, s34
s_add_u32 s4, s4, 90112
s_cmp_eq_u32 s82, 7
s_cselect_b32 s15, s14, 16384
s_lshl_b32 s35, s82, 2
s_add_u32 s35, s35, s33
s_add_u32 s35, s35, 14
s_lshl_b32 s7, s35, 14
s_add_u32 s7, s7, s34
s_lshl_b32 s8, s35, 13
s_and_b32 s8, s8, 0xffff
s_mov_b32 s11, 8192
s_mov_b32 s12, 0
v_add_u32 v1, 8192, v0
v_add_u32 v3, 81920, v0
v_add_u32 v2, 81920, v0
v_bfe_u32 v24, v0, 4, 4
v_lshrrev_b32 v25, 8, v0
v_lshlrev_b32 v25, 2, v25
v_sub_u32 v24, v24, v25
v_mov_b32 v26, 0xffff
v_cmp_le_i32 vcc, 0, v24
s_nop 1
v_cndmask_b32 v18, 0, v26, vcc
v_cmp_le_i32 vcc, 1, v24
s_nop 1
v_cndmask_b32 v18, v18, -1, vcc
v_cmp_le_i32 vcc, 2, v24
s_nop 1
v_cndmask_b32 v19, 0, v26, vcc
v_cmp_le_i32 vcc, 3, v24
s_nop 1
v_cndmask_b32 v19, v19, -1, vcc
v_mov_b32 v26, 0x3f803f80
v_and_b32 v25, 0x30, v0
v_cmp_eq_u32 vcc, 0, v25
s_nop 1
v_cndmask_b32 v26, 0, v26, vcc
v_accvgpr_write_b32 a184, v26
v_accvgpr_write_b32 a185, v26
v_accvgpr_write_b32 a186, v26
v_accvgpr_write_b32 a187, v26
v_mov_b64 v[40:41], 0
v_mov_b64 v[42:43], 0
v_mov_b64 v[44:45], 0
v_mov_b64 v[46:47], 0
v_mov_b64 v[48:49], 0
v_mov_b64 v[50:51], 0
v_mov_b64 v[52:53], 0
v_mov_b64 v[54:55], 0
v_mov_b64 v[56:57], 0
v_mov_b64 v[58:59], 0
v_mov_b64 v[60:61], 0
v_mov_b64 v[62:63], 0
s_waitcnt vmcnt(8) lgkmcnt(0)
s_barrier
s_cmp_lg_u32 s80, 0
s_cbranch_scc1 LA_f3
s_mov_b64 exec, 1
v_mov_b32 v24, 1
s_lshl2_add_u32 s75, s82, s40
buffer_store_dword v24, off, s[76:79], s75 offset:64 sc1
s_mov_b64 exec, -1
LA_f3:
ds_read_b128 a[32:35], v22 offset:0
ds_read_b128 a[36:39], v22 offset:1024
ds_read_b128 a[40:43], v22 offset:2048
ds_read_b128 a[44:47], v22 offset:3072
ds_read_b128 a[48:51], v22 offset:4096
ds_read_b128 a[52:55], v22 offset:5120
ds_read_b128 a[56:59], v22 offset:6144
ds_read_b128 a[60:63], v22 offset:7168
LA_att:
s_lshl2_add_u32 s34, s82, s80
s_lshl_b32 s35, s34, 14
v_lshrrev_b32 v24, 6, v0
v_bfe_u32 v25, v0, 4, 2
v_lshlrev_b32 v25, 6, v25
v_lshl_or_b32 v24, v24, 10, v25
v_add_u32 v24, s35, v24
s_lshr_b32 s34, s34, 1
s_lshl4_add_u32 s34, s85, s34
s_lshl_b32 s34, s34, 6
s_add_u32 s34, s34, s84
s_lshl_b32 s34, s34, 7
v_lshrrev_b32 v25, 7, v0
v_and_b32 v26, 0x70, v0
v_lshl_or_b32 v25, v25, 10, v26
v_add_u32 v25, s34, v25
ds_read_b128 a[96:99], v0 offset:16384
ds_read_b128 a[100:103], v0 offset:17408
ds_read_b128 a[104:107], v0 offset:18432
ds_read_b128 a[108:111], v0 offset:19456
ds_read_b128 a[112:115], v0 offset:20480
ds_read_b128 a[116:119], v0 offset:21504
ds_read_b128 a[120:123], v0 offset:22528
ds_read_b128 a[124:127], v0 offset:23552
v_mfma_f32_32x32x16_bf16 v[164:179], v[72:75], v[72:75], 0
v_mfma_f32_32x32x16_bf16 a[160:175], v[72:75], v[72:75], 0
v_mfma_f32_32x32x16_bf16 v[180:195], v[72:75], v[72:75], 0
v_mfma_f32_32x32x16_bf16 a[240:255], v[72:75], v[72:75], 0
v_mfma_f32_32x32x16_bf16 a[168:183], v[72:75], v[72:75], 0
v_mfma_f32_32x32x16_bf16 v[184:199], v[72:75], v[72:75], 0
s_cmp_eq_u32 s82, 0
s_cbranch_scc1 LA_j0
s_waitcnt lgkmcnt(7)
v_mfma_f32_16x16x32_bf16 v[200:203], a[96:99], a[0:3], v[40:43]
s_waitcnt vmcnt(63) lgkmcnt(0)
s_barrier
v_mfma_f32_16x16x32_bf16 v[200:203], a[100:103], a[4:7], v[200:203]
s_add_u32 s11, s11, 8192
v_bfe_u32 v20, v0, 2, 7
v_mfma_f32_16x16x32_bf16 v[200:203], a[104:107], a[8:11], v[200:203]
s_and_b32 s11, s11, 0xffff
ds_read_b128 a[64:67], v23 offset:0
v_mfma_f32_16x16x32_bf16 v[200:203], a[108:111], a[12:15], v[200:203]
buffer_load_dword v20, v20, s[76:79], s40 offen offset:0 sc1
v_mfma_f32_16x16x32_bf16 v[204:207], a[108:111], a[28:31], v[44:47]
s_add_u32 m0, s5, s6
ds_read_b128 a[68:71], v23 offset:1024
v_mfma_f32_16x16x32_bf16 v[204:207], a[104:107], a[24:27], v[204:207]
buffer_load_dwordx4 v0, s[20:23], s4 offen offset:0 sc1 lds
v_mfma_f32_16x16x32_bf16 v[204:207], a[100:103], a[20:23], v[204:207]
ds_read_b128 a[72:75], v23 offset:2048
v_mfma_f32_16x16x32_bf16 v[204:207], a[96:99], a[16:19], v[204:207]
v_exp_f32 v200, v200
v_mfma_f32_16x16x32_bf16 v[208:211], a[96:99], a[32:35], v[48:51]
v_exp_f32 v201, v201
v_mfma_f32_16x16x32_bf16 v[208:211], a[100:103], a[36:39], v[208:211]
buffer_load_dwordx4 v0, s[20:23], s4 offen offset:1024 sc1 lds
v_cvt_pk_bf16_f32 v232, v200, v201
v_mfma_f32_16x16x32_bf16 v[208:211], a[104:107], a[40:43], v[208:211]
v_exp_f32 v202, v202
v_mfma_f32_16x16x32_bf16 v[208:211], a[108:111], a[44:47], v[208:211]
v_exp_f32 v203, v203
v_mfma_f32_16x16x32_bf16 v[212:215], a[108:111], a[60:63], v[52:55]
ds_read_b128 a[76:79], v23 offset:3072
v_cvt_pk_bf16_f32 v233, v202, v203
v_mfma_f32_16x16x32_bf16 v[212:215], a[104:107], a[56:59], v[212:215]
v_exp_f32 v204, v204
v_mfma_f32_16x16x32_bf16 v[212:215], a[100:103], a[52:55], v[212:215]
v_exp_f32 v205, v205
v_mfma_f32_16x16x32_bf16 v[212:215], a[96:99], a[48:51], v[212:215]
ds_read_b128 a[96:99], v1 offset:16384
v_cvt_pk_bf16_f32 v236, v204, v205
v_mfma_f32_16x16x32_bf16 v[216:219], a[112:115], a[0:3], v[40:43]
v_exp_f32 v206, v206
v_mfma_f32_16x16x32_bf16 v[216:219], a[116:119], a[4:7], v[216:219]
v_exp_f32 v207, v207
v_mfma_f32_16x16x32_bf16 v[216:219], a[120:123], a[8:11], v[216:219]
ds_read_b128 a[100:103], v1 offset:17408
v_cvt_pk_bf16_f32 v237, v206, v207
v_mfma_f32_16x16x32_bf16 v[216:219], a[124:127], a[12:15], v[216:219]
v_exp_f32 v208, v208
v_mfma_f32_16x16x32_bf16 v[220:223], a[124:127], a[28:31], v[44:47]
v_exp_f32 v209, v209
v_mfma_f32_16x16x32_bf16 v[220:223], a[120:123], a[24:27], v[220:223]
ds_read_b128 a[104:107], v1 offset:18432
v_cvt_pk_bf16_f32 v240, v208, v209
v_mfma_f32_16x16x32_bf16 v[220:223], a[116:119], a[20:23], v[220:223]
v_exp_f32 v210, v210
v_mfma_f32_16x16x32_bf16 v[220:223], a[112:115], a[16:19], v[220:223]
v_exp_f32 v211, v211
v_mfma_f32_16x16x32_bf16 v[224:227], a[112:115], a[32:35], v[48:51]
ds_read_b128 a[108:111], v1 offset:19456
v_cvt_pk_bf16_f32 v241, v210, v211
v_mfma_f32_16x16x32_bf16 v[224:227], a[116:119], a[36:39], v[224:227]
v_exp_f32 v212, v212
v_mfma_f32_16x16x32_bf16 v[224:227], a[120:123], a[40:43], v[224:227]
v_exp_f32 v213, v213
v_mfma_f32_16x16x32_bf16 v[224:227], a[124:127], a[44:47], v[224:227]
buffer_load_dwordx4 v0, s[20:23], s4 offen offset:2048 sc1 lds
v_cvt_pk_bf16_f32 v244, v212, v213
v_mfma_f32_16x16x32_bf16 v[228:231], a[124:127], a[60:63], v[52:55]
v_exp_f32 v214, v214
v_mfma_f32_16x16x32_bf16 v[228:231], a[120:123], a[56:59], v[228:231]
v_exp_f32 v215, v215
v_mfma_f32_16x16x32_bf16 v[228:231], a[116:119], a[52:55], v[228:231]
ds_read_b128 a[80:83], v23 offset:4096
v_cvt_pk_bf16_f32 v245, v214, v215
v_mfma_f32_16x16x32_bf16 v[228:231], a[112:115], a[48:51], v[228:231]
ds_read_b128 a[112:115], v1 offset:20480
ds_read_b128 a[116:119], v1 offset:21504
ds_read_b128 a[120:123], v1 offset:22528
ds_read_b128 a[124:127], v1 offset:23552
v_exp_f32 v216, v216
v_exp_f32 v217, v217
s_nop 0
v_cvt_pk_bf16_f32 v234, v216, v217
v_exp_f32 v218, v218
v_exp_f32 v219, v219
s_nop 0
v_cvt_pk_bf16_f32 v235, v218, v219
v_exp_f32 v220, v220
v_exp_f32 v221, v221
s_nop 0
v_cvt_pk_bf16_f32 v238, v220, v221
v_exp_f32 v222, v222
v_exp_f32 v223, v223
s_nop 0
v_cvt_pk_bf16_f32 v239, v222, v223
v_add_u32 v1, s11, v0
buffer_load_dwordx4 v0, s[20:23], s4 offen offset:3072 sc1 lds
s_add_u32 s4, s4, 16384
s_add_u32 s5, s5, 8192
s_and_b32 s5, s5, 0xffff
buffer_load_dword v34, v24, s[28:31], 0 offen
buffer_load_dword v35, v25, s[52:55], 0 offen
ds_read_b128 a[84:87], v23 offset:5120
ds_read_b128 a[88:91], v23 offset:6144
ds_read_b128 a[92:95], v23 offset:7168
s_lshl_b32 s13, s82, 1
s_sub_u32 s13, s13, 1
LA_l1:
s_waitcnt lgkmcnt(11)
v_mfma_f32_16x16x32_bf16 v[200:203], a[96:99], a[0:3], v[40:43]
s_waitcnt vmcnt(8) lgkmcnt(0)
s_barrier
v_mfma_f32_16x16x32_bf16 v[200:203], a[100:103], a[4:7], v[200:203]
s_add_u32 s12, s12, 8192
v_exp_f32 v224, v224
v_mfma_f32_16x16x32_bf16 v[200:203], a[104:107], a[8:11], v[200:203]
s_and_b32 s12, s12, 0xffff
s_add_u32 s11, s11, 8192
s_add_u32 m0, s5, s6
v_mfma_f32_16x16x32_bf16 v[200:203], a[108:111], a[12:15], v[200:203]
s_and_b32 s11, s11, 0xffff
v_exp_f32 v225, v225
v_mfma_f32_16x16x32_bf16 v[204:207], a[108:111], a[28:31], v[44:47]
ds_read_b128 a[128:131], v2 offset:0
v_cvt_pk_bf16_f32 v242, v224, v225
v_mfma_f32_16x16x32_bf16 v[204:207], a[104:107], a[24:27], v[204:207]
v_exp_f32 v226, v226
v_mfma_f32_16x16x32_bf16 v[204:207], a[100:103], a[20:23], v[204:207]
buffer_load_dwordx4 v0, s[20:23], s4 offen offset:0 sc1 lds
v_mfma_f32_16x16x32_bf16 v[204:207], a[96:99], a[16:19], v[204:207]
v_exp_f32 v227, v227
v_mfma_f32_16x16x32_bf16 v[208:211], a[96:99], a[32:35], v[48:51]
ds_read_b128 a[132:135], v2 offset:1024
v_cvt_pk_bf16_f32 v243, v226, v227
v_mfma_f32_16x16x32_bf16 v[208:211], a[100:103], a[36:39], v[208:211]
v_exp_f32 v228, v228
v_mfma_f32_16x16x32_bf16 v[208:211], a[104:107], a[40:43], v[208:211]
ds_read_b128 a[136:139], v2 offset:2048
v_mfma_f32_16x16x32_bf16 v[208:211], a[108:111], a[44:47], v[208:211]
v_exp_f32 v229, v229
v_mfma_f32_16x16x32_bf16 v[212:215], a[108:111], a[60:63], v[52:55]
ds_read_b128 a[140:143], v2 offset:3072
v_cvt_pk_bf16_f32 v246, v228, v229
v_mfma_f32_16x16x32_bf16 v[212:215], a[104:107], a[56:59], v[212:215]
v_exp_f32 v230, v230
v_mfma_f32_16x16x32_bf16 v[212:215], a[100:103], a[52:55], v[212:215]
buffer_load_dwordx4 v0, s[20:23], s4 offen offset:1024 sc1 lds
v_mfma_f32_16x16x32_bf16 v[212:215], a[96:99], a[48:51], v[212:215]
v_exp_f32 v231, v231
v_mfma_f32_16x16x32_bf16 v[216:219], a[112:115], a[0:3], v[40:43]
ds_read_b128 a[144:147], v2 offset:4096
v_cvt_pk_bf16_f32 v247, v230, v231
v_mfma_f32_16x16x32_bf16 v[216:219], a[116:119], a[4:7], v[216:219]
v_exp_f32 v200, v200
v_mfma_f32_16x16x32_bf16 v[216:219], a[120:123], a[8:11], v[216:219]
ds_read_b128 a[148:151], v2 offset:5120
v_mfma_f32_16x16x32_bf16 v[216:219], a[124:127], a[12:15], v[216:219]
v_exp_f32 v201, v201
v_mfma_f32_16x16x32_bf16 v[220:223], a[124:127], a[28:31], v[44:47]
ds_read_b128 a[152:155], v2 offset:6144
v_cvt_pk_bf16_f32 v248, v200, v201
v_mfma_f32_16x16x32_bf16 v[220:223], a[120:123], a[24:27], v[220:223]
v_exp_f32 v202, v202
v_mfma_f32_16x16x32_bf16 v[220:223], a[116:119], a[20:23], v[220:223]
buffer_load_dwordx4 v0, s[20:23], s4 offen offset:2048 sc1 lds
v_mfma_f32_16x16x32_bf16 v[220:223], a[112:115], a[16:19], v[220:223]
v_exp_f32 v203, v203
v_mfma_f32_16x16x32_bf16 v[224:227], a[112:115], a[32:35], v[48:51]
ds_read_b128 a[156:159], v2 offset:7168
v_cvt_pk_bf16_f32 v249, v202, v203
v_mfma_f32_16x16x32_bf16 v[224:227], a[116:119], a[36:39], v[224:227]
v_exp_f32 v204, v204
v_mfma_f32_16x16x32_bf16 v[224:227], a[120:123], a[40:43], v[224:227]
buffer_load_dwordx4 v0, s[20:23], s4 offen offset:3072 sc1 lds
v_mfma_f32_16x16x32_bf16 v[224:227], a[124:127], a[44:47], v[224:227]
s_add_u32 s4, s4, 16384
v_exp_f32 v205, v205
v_mfma_f32_16x16x32_bf16 v[228:231], a[124:127], a[60:63], v[52:55]
v_cvt_pk_bf16_f32 v252, v204, v205
v_add_u32 v2, s12, v3
v_mfma_f32_16x16x32_bf16 v[228:231], a[120:123], a[56:59], v[228:231]
s_waitcnt lgkmcnt(0)
v_exp_f32 v206, v206
v_mfma_f32_16x16x32_bf16 v[228:231], a[116:119], a[52:55], v[228:231]
s_add_u32 s5, s5, 8192
s_and_b32 s5, s5, 0xffff
v_mfma_f32_16x16x32_bf16 v[228:231], a[112:115], a[48:51], v[228:231]
v_exp_f32 v207, v207
v_mfma_f32_16x16x32_bf16 v[72:75], a[128:131], v[232:235], v[72:75]
ds_read_b128 a[96:99], v1 offset:16384
v_cvt_pk_bf16_f32 v253, v206, v207
v_mfma_f32_16x16x32_bf16 v[104:107], a[128:131], v[236:239], v[104:107]
v_exp_f32 v208, v208
v_mfma_f32_16x16x32_bf16 v[136:139], a[128:131], v[240:243], v[136:139]
v_mfma_f32_16x16x32_bf16 v[168:171], a[128:131], v[244:247], v[168:171]
v_exp_f32 v209, v209
v_mfma_f32_16x16x32_bf16 v[172:175], a[132:135], v[244:247], v[172:175]
ds_read_b128 a[100:103], v1 offset:17408
v_cvt_pk_bf16_f32 v64, v208, v209
v_mfma_f32_16x16x32_bf16 v[140:143], a[132:135], v[240:243], v[140:143]
v_exp_f32 v210, v210
v_mfma_f32_16x16x32_bf16 v[108:111], a[132:135], v[236:239], v[108:111]
v_mfma_f32_16x16x32_bf16 v[76:79], a[132:135], v[232:235], v[76:79]
v_exp_f32 v211, v211
v_mfma_f32_16x16x32_bf16 v[80:83], a[136:139], v[232:235], v[80:83]
ds_read_b128 a[104:107], v1 offset:18432
v_cvt_pk_bf16_f32 v65, v210, v211
v_mfma_f32_16x16x32_bf16 v[112:115], a[136:139], v[236:239], v[112:115]
v_exp_f32 v212, v212
v_mfma_f32_16x16x32_bf16 v[144:147], a[136:139], v[240:243], v[144:147]
v_mfma_f32_16x16x32_bf16 v[176:179], a[136:139], v[244:247], v[176:179]
v_exp_f32 v213, v213
v_mfma_f32_16x16x32_bf16 v[180:183], a[140:143], v[244:247], v[180:183]
ds_read_b128 a[108:111], v1 offset:19456
v_cvt_pk_bf16_f32 v68, v212, v213
v_mfma_f32_16x16x32_bf16 v[148:151], a[140:143], v[240:243], v[148:151]
v_exp_f32 v214, v214
v_mfma_f32_16x16x32_bf16 v[116:119], a[140:143], v[236:239], v[116:119]
v_mfma_f32_16x16x32_bf16 v[84:87], a[140:143], v[232:235], v[84:87]
v_exp_f32 v215, v215
v_mfma_f32_16x16x32_bf16 v[88:91], a[144:147], v[232:235], v[88:91]
ds_read_b128 a[112:115], v1 offset:20480
v_cvt_pk_bf16_f32 v69, v214, v215
v_mfma_f32_16x16x32_bf16 v[120:123], a[144:147], v[236:239], v[120:123]
v_exp_f32 v216, v216
v_mfma_f32_16x16x32_bf16 v[152:155], a[144:147], v[240:243], v[152:155]
v_mfma_f32_16x16x32_bf16 v[184:187], a[144:147], v[244:247], v[184:187]
v_exp_f32 v217, v217
v_mfma_f32_16x16x32_bf16 v[188:191], a[148:151], v[244:247], v[188:191]
ds_read_b128 a[116:119], v1 offset:21504
v_cvt_pk_bf16_f32 v250, v216, v217
v_mfma_f32_16x16x32_bf16 v[156:159], a[148:151], v[240:243], v[156:159]
v_exp_f32 v218, v218
v_mfma_f32_16x16x32_bf16 v[124:127], a[148:151], v[236:239], v[124:127]
v_mfma_f32_16x16x32_bf16 v[92:95], a[148:151], v[232:235], v[92:95]
v_exp_f32 v219, v219
v_mfma_f32_16x16x32_bf16 v[96:99], a[152:155], v[232:235], v[96:99]
ds_read_b128 a[120:123], v1 offset:22528
v_cvt_pk_bf16_f32 v251, v218, v219
v_mfma_f32_16x16x32_bf16 v[128:131], a[152:155], v[236:239], v[128:131]
v_exp_f32 v220, v220
v_mfma_f32_16x16x32_bf16 v[160:163], a[152:155], v[240:243], v[160:163]
v_mfma_f32_16x16x32_bf16 v[192:195], a[152:155], v[244:247], v[192:195]
v_exp_f32 v221, v221
v_mfma_f32_16x16x32_bf16 v[196:199], a[156:159], v[244:247], v[196:199]
ds_read_b128 a[124:127], v1 offset:23552
v_cvt_pk_bf16_f32 v254, v220, v221
v_mfma_f32_16x16x32_bf16 v[164:167], a[156:159], v[240:243], v[164:167]
v_exp_f32 v222, v222
v_mfma_f32_16x16x32_bf16 v[132:135], a[156:159], v[236:239], v[132:135]
v_mfma_f32_16x16x32_bf16 v[100:103], a[156:159], v[232:235], v[100:103]
v_exp_f32 v223, v223
v_mfma_f32_16x16x32_bf16 a[160:163], a[184:187], v[232:235], a[160:163]
v_cvt_pk_bf16_f32 v255, v222, v223
v_add_u32 v1, s11, v0
v_mfma_f32_16x16x32_bf16 a[164:167], a[184:187], v[236:239], a[164:167]
v_mfma_f32_16x16x32_bf16 a[168:171], a[184:187], v[240:243], a[168:171]
v_mfma_f32_16x16x32_bf16 a[172:175], a[184:187], v[244:247], a[172:175]
s_waitcnt lgkmcnt(7)
v_mfma_f32_16x16x32_bf16 v[200:203], a[96:99], a[0:3], v[40:43]
s_waitcnt vmcnt(8) lgkmcnt(0)
s_barrier
v_mfma_f32_16x16x32_bf16 v[200:203], a[100:103], a[4:7], v[200:203]
s_add_u32 s12, s12, 8192
v_exp_f32 v224, v224
v_mfma_f32_16x16x32_bf16 v[200:203], a[104:107], a[8:11], v[200:203]
s_and_b32 s12, s12, 0xffff
s_add_u32 s11, s11, 8192
s_add_u32 m0, s5, s6
v_mfma_f32_16x16x32_bf16 v[200:203], a[108:111], a[12:15], v[200:203]
s_and_b32 s11, s11, 0xffff
v_exp_f32 v225, v225
v_mfma_f32_16x16x32_bf16 v[204:207], a[108:111], a[28:31], v[44:47]
ds_read_b128 a[128:131], v2 offset:0
v_cvt_pk_bf16_f32 v66, v224, v225
v_mfma_f32_16x16x32_bf16 v[204:207], a[104:107], a[24:27], v[204:207]
s_sub_u32 s13, s13, 1
v_exp_f32 v226, v226
v_mfma_f32_16x16x32_bf16 v[204:207], a[100:103], a[20:23], v[204:207]
buffer_load_dwordx4 v0, s[20:23], s4 offen offset:0 sc1 lds
v_mfma_f32_16x16x32_bf16 v[204:207], a[96:99], a[16:19], v[204:207]
v_exp_f32 v227, v227
v_mfma_f32_16x16x32_bf16 v[208:211], a[96:99], a[32:35], v[48:51]
ds_read_b128 a[132:135], v2 offset:1024
v_cvt_pk_bf16_f32 v67, v226, v227
v_mfma_f32_16x16x32_bf16 v[208:211], a[100:103], a[36:39], v[208:211]
v_exp_f32 v228, v228
v_mfma_f32_16x16x32_bf16 v[208:211], a[104:107], a[40:43], v[208:211]
ds_read_b128 a[136:139], v2 offset:2048
v_mfma_f32_16x16x32_bf16 v[208:211], a[108:111], a[44:47], v[208:211]
v_exp_f32 v229, v229
v_mfma_f32_16x16x32_bf16 v[212:215], a[108:111], a[60:63], v[52:55]
ds_read_b128 a[140:143], v2 offset:3072
v_cvt_pk_bf16_f32 v70, v228, v229
v_mfma_f32_16x16x32_bf16 v[212:215], a[104:107], a[56:59], v[212:215]
v_exp_f32 v230, v230
v_mfma_f32_16x16x32_bf16 v[212:215], a[100:103], a[52:55], v[212:215]
buffer_load_dwordx4 v0, s[20:23], s4 offen offset:1024 sc1 lds
v_mfma_f32_16x16x32_bf16 v[212:215], a[96:99], a[48:51], v[212:215]
v_exp_f32 v231, v231
v_mfma_f32_16x16x32_bf16 v[216:219], a[112:115], a[0:3], v[40:43]
ds_read_b128 a[144:147], v2 offset:4096
v_cvt_pk_bf16_f32 v71, v230, v231
v_mfma_f32_16x16x32_bf16 v[216:219], a[116:119], a[4:7], v[216:219]
v_exp_f32 v200, v200
v_mfma_f32_16x16x32_bf16 v[216:219], a[120:123], a[8:11], v[216:219]
ds_read_b128 a[148:151], v2 offset:5120
v_mfma_f32_16x16x32_bf16 v[216:219], a[124:127], a[12:15], v[216:219]
v_exp_f32 v201, v201
v_mfma_f32_16x16x32_bf16 v[220:223], a[124:127], a[28:31], v[44:47]
ds_read_b128 a[152:155], v2 offset:6144
v_cvt_pk_bf16_f32 v232, v200, v201
v_mfma_f32_16x16x32_bf16 v[220:223], a[120:123], a[24:27], v[220:223]
v_exp_f32 v202, v202
v_mfma_f32_16x16x32_bf16 v[220:223], a[116:119], a[20:23], v[220:223]
buffer_load_dwordx4 v0, s[20:23], s4 offen offset:2048 sc1 lds
v_mfma_f32_16x16x32_bf16 v[220:223], a[112:115], a[16:19], v[220:223]
v_exp_f32 v203, v203
v_mfma_f32_16x16x32_bf16 v[224:227], a[112:115], a[32:35], v[48:51]
ds_read_b128 a[156:159], v2 offset:7168
v_cvt_pk_bf16_f32 v233, v202, v203
v_mfma_f32_16x16x32_bf16 v[224:227], a[116:119], a[36:39], v[224:227]
v_exp_f32 v204, v204
v_mfma_f32_16x16x32_bf16 v[224:227], a[120:123], a[40:43], v[224:227]
buffer_load_dwordx4 v0, s[20:23], s4 offen offset:3072 sc1 lds
v_mfma_f32_16x16x32_bf16 v[224:227], a[124:127], a[44:47], v[224:227]
s_add_u32 s4, s4, 16384
v_exp_f32 v205, v205
v_mfma_f32_16x16x32_bf16 v[228:231], a[124:127], a[60:63], v[52:55]
v_cvt_pk_bf16_f32 v236, v204, v205
v_add_u32 v2, s12, v3
v_mfma_f32_16x16x32_bf16 v[228:231], a[120:123], a[56:59], v[228:231]
s_waitcnt lgkmcnt(0)
v_exp_f32 v206, v206
v_mfma_f32_16x16x32_bf16 v[228:231], a[116:119], a[52:55], v[228:231]
s_add_u32 s5, s5, 8192
s_and_b32 s5, s5, 0xffff
v_mfma_f32_16x16x32_bf16 v[228:231], a[112:115], a[48:51], v[228:231]
v_exp_f32 v207, v207
v_mfma_f32_16x16x32_bf16 v[72:75], a[128:131], v[248:251], v[72:75]
ds_read_b128 a[96:99], v1 offset:16384
v_cvt_pk_bf16_f32 v237, v206, v207
v_mfma_f32_16x16x32_bf16 v[104:107], a[128:131], v[252:255], v[104:107]
v_exp_f32 v208, v208
v_mfma_f32_16x16x32_bf16 v[136:139], a[128:131], v[64:67], v[136:139]
v_mfma_f32_16x16x32_bf16 v[168:171], a[128:131], v[68:71], v[168:171]
v_exp_f32 v209, v209
v_mfma_f32_16x16x32_bf16 v[172:175], a[132:135], v[68:71], v[172:175]
ds_read_b128 a[100:103], v1 offset:17408
v_cvt_pk_bf16_f32 v240, v208, v209
v_mfma_f32_16x16x32_bf16 v[140:143], a[132:135], v[64:67], v[140:143]
v_exp_f32 v210, v210
v_mfma_f32_16x16x32_bf16 v[108:111], a[132:135], v[252:255], v[108:111]
v_mfma_f32_16x16x32_bf16 v[76:79], a[132:135], v[248:251], v[76:79]
v_exp_f32 v211, v211
v_mfma_f32_16x16x32_bf16 v[80:83], a[136:139], v[248:251], v[80:83]
ds_read_b128 a[104:107], v1 offset:18432
v_cvt_pk_bf16_f32 v241, v210, v211
v_mfma_f32_16x16x32_bf16 v[112:115], a[136:139], v[252:255], v[112:115]
v_exp_f32 v212, v212
v_mfma_f32_16x16x32_bf16 v[144:147], a[136:139], v[64:67], v[144:147]
v_mfma_f32_16x16x32_bf16 v[176:179], a[136:139], v[68:71], v[176:179]
v_exp_f32 v213, v213
v_mfma_f32_16x16x32_bf16 v[180:183], a[140:143], v[68:71], v[180:183]
ds_read_b128 a[108:111], v1 offset:19456
v_cvt_pk_bf16_f32 v244, v212, v213
v_mfma_f32_16x16x32_bf16 v[148:151], a[140:143], v[64:67], v[148:151]
v_exp_f32 v214, v214
v_mfma_f32_16x16x32_bf16 v[116:119], a[140:143], v[252:255], v[116:119]
v_mfma_f32_16x16x32_bf16 v[84:87], a[140:143], v[248:251], v[84:87]
v_exp_f32 v215, v215
v_mfma_f32_16x16x32_bf16 v[88:91], a[144:147], v[248:251], v[88:91]
ds_read_b128 a[112:115], v1 offset:20480
v_cvt_pk_bf16_f32 v245, v214, v215
v_mfma_f32_16x16x32_bf16 v[120:123], a[144:147], v[252:255], v[120:123]
v_exp_f32 v216, v216
v_mfma_f32_16x16x32_bf16 v[152:155], a[144:147], v[64:67], v[152:155]
v_mfma_f32_16x16x32_bf16 v[184:187], a[144:147], v[68:71], v[184:187]
v_exp_f32 v217, v217
v_mfma_f32_16x16x32_bf16 v[188:191], a[148:151], v[68:71], v[188:191]
ds_read_b128 a[116:119], v1 offset:21504
v_cvt_pk_bf16_f32 v234, v216, v217
v_mfma_f32_16x16x32_bf16 v[156:159], a[148:151], v[64:67], v[156:159]
v_exp_f32 v218, v218
v_mfma_f32_16x16x32_bf16 v[124:127], a[148:151], v[252:255], v[124:127]
v_mfma_f32_16x16x32_bf16 v[92:95], a[148:151], v[248:251], v[92:95]
v_exp_f32 v219, v219
v_mfma_f32_16x16x32_bf16 v[96:99], a[152:155], v[248:251], v[96:99]
ds_read_b128 a[120:123], v1 offset:22528
v_cvt_pk_bf16_f32 v235, v218, v219
v_mfma_f32_16x16x32_bf16 v[128:131], a[152:155], v[252:255], v[128:131]
v_exp_f32 v220, v220
v_mfma_f32_16x16x32_bf16 v[160:163], a[152:155], v[64:67], v[160:163]
v_mfma_f32_16x16x32_bf16 v[192:195], a[152:155], v[68:71], v[192:195]
v_exp_f32 v221, v221
v_mfma_f32_16x16x32_bf16 v[196:199], a[156:159], v[68:71], v[196:199]
ds_read_b128 a[124:127], v1 offset:23552
v_cvt_pk_bf16_f32 v238, v220, v221
v_mfma_f32_16x16x32_bf16 v[164:167], a[156:159], v[64:67], v[164:167]
v_exp_f32 v222, v222
v_mfma_f32_16x16x32_bf16 v[132:135], a[156:159], v[252:255], v[132:135]
s_waitcnt vmcnt(14)
v_cmp_lt_u32 vcc, 0, v20
v_mfma_f32_16x16x32_bf16 v[100:103], a[156:159], v[248:251], v[100:103]
v_exp_f32 v223, v223
v_mfma_f32_16x16x32_bf16 a[160:163], a[184:187], v[248:251], a[160:163]
v_cvt_pk_bf16_f32 v239, v222, v223
v_add_u32 v1, s11, v0
v_mfma_f32_16x16x32_bf16 a[164:167], a[184:187], v[252:255], a[164:167]
s_andn2_b32 s33, 65280, vcc_lo
s_cbranch_scc1 LA_p2_s
LA_p2:
v_mfma_f32_16x16x32_bf16 a[168:171], a[184:187], v[64:67], a[168:171]
s_waitcnt lgkmcnt(0)
s_cmp_lg_u32 s13, 0
v_mfma_f32_16x16x32_bf16 a[172:175], a[184:187], v[68:71], a[172:175]
s_cbranch_scc1 LA_l1
v_mfma_f32_16x16x32_bf16 v[200:203], a[96:99], a[0:3], v[40:43]
s_waitcnt vmcnt(8) lgkmcnt(0)
s_barrier
v_mfma_f32_16x16x32_bf16 v[200:203], a[100:103], a[4:7], v[200:203]
s_add_u32 s12, s12, 8192
v_exp_f32 v224, v224
v_mfma_f32_16x16x32_bf16 v[200:203], a[104:107], a[8:11], v[200:203]
s_and_b32 s12, s12, 0xffff
s_add_u32 s11, s11, 8192
s_add_u32 m0, s5, s6
v_mfma_f32_16x16x32_bf16 v[200:203], a[108:111], a[12:15], v[200:203]
s_and_b32 s11, s11, 0xffff
v_exp_f32 v225, v225
v_mfma_f32_16x16x32_bf16 v[204:207], a[108:111], a[28:31], v[44:47]
ds_read_b128 a[128:131], v2 offset:0
v_cvt_pk_bf16_f32 v242, v224, v225
v_mfma_f32_16x16x32_bf16 v[204:207], a[104:107], a[24:27], v[204:207]
v_exp_f32 v226, v226
v_mfma_f32_16x16x32_bf16 v[204:207], a[100:103], a[20:23], v[204:207]
buffer_load_dwordx4 v0, s[20:23], s4 offen offset:0 sc1 lds
v_mfma_f32_16x16x32_bf16 v[204:207], a[96:99], a[16:19], v[204:207]
v_exp_f32 v227, v227
v_mfma_f32_16x16x32_bf16 v[208:211], a[96:99], a[32:35], v[48:51]
ds_read_b128 a[132:135], v2 offset:1024
v_cvt_pk_bf16_f32 v243, v226, v227
v_mfma_f32_16x16x32_bf16 v[208:211], a[100:103], a[36:39], v[208:211]
v_exp_f32 v228, v228
v_mfma_f32_16x16x32_bf16 v[208:211], a[104:107], a[40:43], v[208:211]
ds_read_b128 a[136:139], v2 offset:2048
v_mfma_f32_16x16x32_bf16 v[208:211], a[108:111], a[44:47], v[208:211]
v_exp_f32 v229, v229
v_mfma_f32_16x16x32_bf16 v[212:215], a[108:111], a[60:63], v[52:55]
ds_read_b128 a[140:143], v2 offset:3072
v_cvt_pk_bf16_f32 v246, v228, v229
v_mfma_f32_16x16x32_bf16 v[212:215], a[104:107], a[56:59], v[212:215]
v_exp_f32 v230, v230
v_mfma_f32_16x16x32_bf16 v[212:215], a[100:103], a[52:55], v[212:215]
buffer_load_dwordx4 v0, s[20:23], s4 offen offset:1024 sc1 lds
v_mfma_f32_16x16x32_bf16 v[212:215], a[96:99], a[48:51], v[212:215]
v_exp_f32 v231, v231
v_mfma_f32_16x16x32_bf16 v[216:219], a[112:115], a[0:3], v[40:43]
ds_read_b128 a[144:147], v2 offset:4096
v_cvt_pk_bf16_f32 v247, v230, v231
v_mfma_f32_16x16x32_bf16 v[216:219], a[116:119], a[4:7], v[216:219]
v_exp_f32 v200, v200
v_mfma_f32_16x16x32_bf16 v[216:219], a[120:123], a[8:11], v[216:219]
ds_read_b128 a[148:151], v2 offset:5120
v_mfma_f32_16x16x32_bf16 v[216:219], a[124:127], a[12:15], v[216:219]
v_exp_f32 v201, v201
v_mfma_f32_16x16x32_bf16 v[220:223], a[124:127], a[28:31], v[44:47]
ds_read_b128 a[152:155], v2 offset:6144
v_cvt_pk_bf16_f32 v248, v200, v201
v_mfma_f32_16x16x32_bf16 v[220:223], a[120:123], a[24:27], v[220:223]
v_exp_f32 v202, v202
v_mfma_f32_16x16x32_bf16 v[220:223], a[116:119], a[20:23], v[220:223]
buffer_load_dwordx4 v0, s[20:23], s4 offen offset:2048 sc1 lds
v_mfma_f32_16x16x32_bf16 v[220:223], a[112:115], a[16:19], v[220:223]
v_exp_f32 v203, v203
v_mfma_f32_16x16x32_bf16 v[224:227], a[112:115], a[32:35], v[48:51]
ds_read_b128 a[156:159], v2 offset:7168
v_cvt_pk_bf16_f32 v249, v202, v203
v_mfma_f32_16x16x32_bf16 v[224:227], a[116:119], a[36:39], v[224:227]
v_exp_f32 v204, v204
v_mfma_f32_16x16x32_bf16 v[224:227], a[120:123], a[40:43], v[224:227]
buffer_load_dwordx4 v0, s[20:23], s4 offen offset:3072 sc1 lds
v_mfma_f32_16x16x32_bf16 v[224:227], a[124:127], a[44:47], v[224:227]
s_add_u32 s4, s4, 16384
v_exp_f32 v205, v205
v_mfma_f32_16x16x32_bf16 v[228:231], a[124:127], a[60:63], v[52:55]
v_cvt_pk_bf16_f32 v252, v204, v205
v_add_u32 v2, s12, v3
v_mfma_f32_16x16x32_bf16 v[228:231], a[120:123], a[56:59], v[228:231]
s_waitcnt lgkmcnt(0)
v_exp_f32 v206, v206
v_mfma_f32_16x16x32_bf16 v[228:231], a[116:119], a[52:55], v[228:231]
s_add_u32 s5, s5, 8192
s_and_b32 s5, s5, 0xffff
v_mfma_f32_16x16x32_bf16 v[228:231], a[112:115], a[48:51], v[228:231]
v_exp_f32 v207, v207
v_mfma_f32_16x16x32_bf16 v[72:75], a[128:131], v[232:235], v[72:75]
ds_read_b128 a[96:99], v1 offset:16384
v_cvt_pk_bf16_f32 v253, v206, v207
v_mfma_f32_16x16x32_bf16 v[104:107], a[128:131], v[236:239], v[104:107]
v_exp_f32 v208, v208
v_mfma_f32_16x16x32_bf16 v[136:139], a[128:131], v[240:243], v[136:139]
v_mfma_f32_16x16x32_bf16 v[168:171], a[128:131], v[244:247], v[168:171]
v_exp_f32 v209, v209
v_mfma_f32_16x16x32_bf16 v[172:175], a[132:135], v[244:247], v[172:175]
ds_read_b128 a[100:103], v1 offset:17408
v_cvt_pk_bf16_f32 v64, v208, v209
v_mfma_f32_16x16x32_bf16 v[140:143], a[132:135], v[240:243], v[140:143]
v_exp_f32 v210, v210
v_mfma_f32_16x16x32_bf16 v[108:111], a[132:135], v[236:239], v[108:111]
v_mfma_f32_16x16x32_bf16 v[76:79], a[132:135], v[232:235], v[76:79]
v_exp_f32 v211, v211
v_mfma_f32_16x16x32_bf16 v[80:83], a[136:139], v[232:235], v[80:83]
ds_read_b128 a[104:107], v1 offset:18432
v_cvt_pk_bf16_f32 v65, v210, v211
v_mfma_f32_16x16x32_bf16 v[112:115], a[136:139], v[236:239], v[112:115]
v_exp_f32 v212, v212
v_mfma_f32_16x16x32_bf16 v[144:147], a[136:139], v[240:243], v[144:147]
v_mfma_f32_16x16x32_bf16 v[176:179], a[136:139], v[244:247], v[176:179]
v_exp_f32 v213, v213
v_mfma_f32_16x16x32_bf16 v[180:183], a[140:143], v[244:247], v[180:183]
ds_read_b128 a[108:111], v1 offset:19456
v_cvt_pk_bf16_f32 v68, v212, v213
v_mfma_f32_16x16x32_bf16 v[148:151], a[140:143], v[240:243], v[148:151]
v_exp_f32 v214, v214
v_mfma_f32_16x16x32_bf16 v[116:119], a[140:143], v[236:239], v[116:119]
v_mfma_f32_16x16x32_bf16 v[84:87], a[140:143], v[232:235], v[84:87]
v_exp_f32 v215, v215
v_mfma_f32_16x16x32_bf16 v[88:91], a[144:147], v[232:235], v[88:91]
ds_read_b128 a[112:115], v1 offset:20480
v_cvt_pk_bf16_f32 v69, v214, v215
v_mfma_f32_16x16x32_bf16 v[120:123], a[144:147], v[236:239], v[120:123]
v_exp_f32 v216, v216
v_mfma_f32_16x16x32_bf16 v[152:155], a[144:147], v[240:243], v[152:155]
v_mfma_f32_16x16x32_bf16 v[184:187], a[144:147], v[244:247], v[184:187]
v_exp_f32 v217, v217
v_mfma_f32_16x16x32_bf16 v[188:191], a[148:151], v[244:247], v[188:191]
ds_read_b128 a[116:119], v1 offset:21504
v_cvt_pk_bf16_f32 v250, v216, v217
v_mfma_f32_16x16x32_bf16 v[156:159], a[148:151], v[240:243], v[156:159]
v_exp_f32 v218, v218
v_mfma_f32_16x16x32_bf16 v[124:127], a[148:151], v[236:239], v[124:127]
v_mfma_f32_16x16x32_bf16 v[92:95], a[148:151], v[232:235], v[92:95]
v_exp_f32 v219, v219
v_mfma_f32_16x16x32_bf16 v[96:99], a[152:155], v[232:235], v[96:99]
ds_read_b128 a[120:123], v1 offset:22528
v_cvt_pk_bf16_f32 v251, v218, v219
v_mfma_f32_16x16x32_bf16 v[128:131], a[152:155], v[236:239], v[128:131]
v_exp_f32 v220, v220
v_mfma_f32_16x16x32_bf16 v[160:163], a[152:155], v[240:243], v[160:163]
v_mfma_f32_16x16x32_bf16 v[192:195], a[152:155], v[244:247], v[192:195]
v_exp_f32 v221, v221
v_mfma_f32_16x16x32_bf16 v[196:199], a[156:159], v[244:247], v[196:199]
ds_read_b128 a[124:127], v1 offset:23552
v_cvt_pk_bf16_f32 v254, v220, v221
v_mfma_f32_16x16x32_bf16 v[164:167], a[156:159], v[240:243], v[164:167]
v_exp_f32 v222, v222
v_mfma_f32_16x16x32_bf16 v[132:135], a[156:159], v[236:239], v[132:135]
v_mfma_f32_16x16x32_bf16 v[100:103], a[156:159], v[232:235], v[100:103]
v_exp_f32 v223, v223
v_mfma_f32_16x16x32_bf16 a[160:163], a[184:187], v[232:235], a[160:163]
v_cvt_pk_bf16_f32 v255, v222, v223
v_add_u32 v1, s11, v0
v_mfma_f32_16x16x32_bf16 a[164:167], a[184:187], v[236:239], a[164:167]
v_exp_f32 v224, v224
v_mfma_f32_16x16x32_bf16 a[168:171], a[184:187], v[240:243], a[168:171]
v_mfma_f32_16x16x32_bf16 a[172:175], a[184:187], v[244:247], a[172:175]
v_exp_f32 v225, v225
s_nop 0
v_cvt_pk_bf16_f32 v66, v224, v225
s_cmp_eq_u32 s80, 0
s_cbranch_scc1 LA_ma0
s_cmp_eq_u32 s80, 1
s_cbranch_scc1 LA_ma1
s_cmp_eq_u32 s80, 2
s_cbranch_scc1 LA_ma2
s_branch LA_ma3
LA_j0:
s_cmp_eq_u32 s80, 0
s_cbranch_scc1 LA_pm0
s_cmp_eq_u32 s80, 1
s_cbranch_scc1 LA_pm1
s_cmp_eq_u32 s80, 2
s_cbranch_scc1 LA_pm2
s_branch LA_pm3
LA_l2p:
v_accvgpr_read_b32 v24, a160
v_accvgpr_read_b32 v25, a164
v_subrev_u32 v21, 0x30800000, v24
v_rcp_f32 v24, v24
s_nop 0
v_mul_f32 v24, v24, v4
v_subrev_u32 v22, 0x30800000, v25
v_max_u32 v21, v21, v22
v_rcp_f32 v25, v25
s_nop 0
v_mul_f32 v25, v25, v5
v_cmp_lt_u32 vcc, 0x23000000, v21
v_pk_mul_f32 v[72:73], v[72:73], v[24:25] op_sel:[0,0] op_sel_hi:[1,0]
v_pk_mul_f32 v[74:75], v[74:75], v[24:25] op_sel:[0,0] op_sel_hi:[1,0]
v_pk_mul_f32 v[76:77], v[76:77], v[24:25] op_sel:[0,0] op_sel_hi:[1,0]
v_pk_mul_f32 v[78:79], v[78:79], v[24:25] op_sel:[0,0] op_sel_hi:[1,0]
v_cvt_pk_bf16_f32 v72, v72, v73
v_cvt_pk_bf16_f32 v73, v74, v75
v_cvt_pk_bf16_f32 v74, v76, v77
v_cvt_pk_bf16_f32 v75, v78, v79
v_pk_mul_f32 v[80:81], v[80:81], v[24:25] op_sel:[0,0] op_sel_hi:[1,0]
v_pk_mul_f32 v[82:83], v[82:83], v[24:25] op_sel:[0,0] op_sel_hi:[1,0]
v_pk_mul_f32 v[84:85], v[84:85], v[24:25] op_sel:[0,0] op_sel_hi:[1,0]
v_pk_mul_f32 v[86:87], v[86:87], v[24:25] op_sel:[0,0] op_sel_hi:[1,0]
v_cvt_pk_bf16_f32 v76, v80, v81
v_cvt_pk_bf16_f32 v77, v82, v83
v_cvt_pk_bf16_f32 v78, v84, v85
v_cvt_pk_bf16_f32 v79, v86, v87
v_pk_mul_f32 v[88:89], v[88:89], v[24:25] op_sel:[0,0] op_sel_hi:[1,0]
v_pk_mul_f32 v[90:91], v[90:91], v[24:25] op_sel:[0,0] op_sel_hi:[1,0]
v_pk_mul_f32 v[92:93], v[92:93], v[24:25] op_sel:[0,0] op_sel_hi:[1,0]
v_pk_mul_f32 v[94:95], v[94:95], v[24:25] op_sel:[0,0] op_sel_hi:[1,0]
v_cvt_pk_bf16_f32 v80, v88, v89
v_cvt_pk_bf16_f32 v81, v90, v91
v_cvt_pk_bf16_f32 v82, v92, v93
v_cvt_pk_bf16_f32 v83, v94, v95
v_pk_mul_f32 v[96:97], v[96:97], v[24:25] op_sel:[0,0] op_sel_hi:[1,0]
v_pk_mul_f32 v[98:99], v[98:99], v[24:25] op_sel:[0,0] op_sel_hi:[1,0]
v_pk_mul_f32 v[100:101], v[100:101], v[24:25] op_sel:[0,0] op_sel_hi:[1,0]
v_pk_mul_f32 v[102:103], v[102:103], v[24:25] op_sel:[0,0] op_sel_hi:[1,0]
v_cvt_pk_bf16_f32 v84, v96, v97
v_cvt_pk_bf16_f32 v85, v98, v99
v_cvt_pk_bf16_f32 v86, v100, v101
v_cvt_pk_bf16_f32 v87, v102, v103
v_pk_mul_f32 v[104:105], v[104:105], v[24:25] op_sel:[0,1] op_sel_hi:[1,1]
v_pk_mul_f32 v[106:107], v[106:107], v[24:25] op_sel:[0,1] op_sel_hi:[1,1]
v_pk_mul_f32 v[108:109], v[108:109], v[24:25] op_sel:[0,1] op_sel_hi:[1,1]
v_pk_mul_f32 v[110:111], v[110:111], v[24:25] op_sel:[0,1] op_sel_hi:[1,1]
v_cvt_pk_bf16_f32 v88, v104, v105
v_cvt_pk_bf16_f32 v89, v106, v107
v_cvt_pk_bf16_f32 v90, v108, v109
v_cvt_pk_bf16_f32 v91, v110, v111
v_pk_mul_f32 v[112:113], v[112:113], v[24:25] op_sel:[0,1] op_sel_hi:[1,1]
v_pk_mul_f32 v[114:115], v[114:115], v[24:25] op_sel:[0,1] op_sel_hi:[1,1]
v_pk_mul_f32 v[116:117], v[116:117], v[24:25] op_sel:[0,1] op_sel_hi:[1,1]
v_pk_mul_f32 v[118:119], v[118:119], v[24:25] op_sel:[0,1] op_sel_hi:[1,1]
v_cvt_pk_bf16_f32 v92, v112, v113
v_cvt_pk_bf16_f32 v93, v114, v115
v_cvt_pk_bf16_f32 v94, v116, v117
v_cvt_pk_bf16_f32 v95, v118, v119
v_pk_mul_f32 v[120:121], v[120:121], v[24:25] op_sel:[0,1] op_sel_hi:[1,1]
v_pk_mul_f32 v[122:123], v[122:123], v[24:25] op_sel:[0,1] op_sel_hi:[1,1]
v_pk_mul_f32 v[124:125], v[124:125], v[24:25] op_sel:[0,1] op_sel_hi:[1,1]
v_pk_mul_f32 v[126:127], v[126:127], v[24:25] op_sel:[0,1] op_sel_hi:[1,1]
v_cvt_pk_bf16_f32 v96, v120, v121
v_cvt_pk_bf16_f32 v97, v122, v123
v_cvt_pk_bf16_f32 v98, v124, v125
v_cvt_pk_bf16_f32 v99, v126, v127
v_pk_mul_f32 v[128:129], v[128:129], v[24:25] op_sel:[0,1] op_sel_hi:[1,1]
v_pk_mul_f32 v[130:131], v[130:131], v[24:25] op_sel:[0,1] op_sel_hi:[1,1]
v_pk_mul_f32 v[132:133], v[132:133], v[24:25] op_sel:[0,1] op_sel_hi:[1,1]
v_pk_mul_f32 v[134:135], v[134:135], v[24:25] op_sel:[0,1] op_sel_hi:[1,1]
v_cvt_pk_bf16_f32 v100, v128, v129
v_cvt_pk_bf16_f32 v101, v130, v131
v_cvt_pk_bf16_f32 v102, v132, v133
v_cvt_pk_bf16_f32 v103, v134, v135
s_cmp_eq_u64 vcc, 0
s_cselect_b32 s87, 1, s16
v_mfma_f32_16x16x32_bf16 v[200:203], a[96:99], a[64:67], v[56:59]
s_waitcnt vmcnt(63) lgkmcnt(0)
s_barrier
v_mfma_f32_16x16x32_bf16 v[200:203], a[100:103], a[68:71], v[200:203]
s_add_u32 s12, s12, 16384
v_exp_f32 v224, v224
v_mfma_f32_16x16x32_bf16 v[200:203], a[104:107], a[72:75], v[200:203]
s_and_b32 s12, s12, 0xffff
s_add_u32 s11, s11, 16384
v_mfma_f32_16x16x32_bf16 v[200:203], a[108:111], a[76:79], v[200:203]
s_and_b32 s11, s11, 0xffff
v_exp_f32 v225, v225
v_mfma_f32_16x16x32_bf16 v[204:207], a[108:111], a[92:95], v[60:63]
ds_read_b128 a[128:131], v2 offset:0
v_cvt_pk_bf16_f32 v242, v224, v225
v_mfma_f32_16x16x32_bf16 v[204:207], a[104:107], a[88:91], v[204:207]
v_exp_f32 v226, v226
v_mfma_f32_16x16x32_bf16 v[204:207], a[100:103], a[84:87], v[204:207]
buffer_store_dwordx4 v[72:75], v0, s[76:79], s88 offen offset:0 sc1
v_mfma_f32_16x16x32_bf16 v[204:207], a[96:99], a[80:83], v[204:207]
s_add_u32 m0, s8, s9
v_exp_f32 v227, v227
v_mfma_f32_16x16x32_bf16 v[208:211], a[96:99], a[32:35], v[48:51]
s_xor_b32 s75, s8, 0x8000
ds_read_b128 a[132:135], v2 offset:1024
v_cvt_pk_bf16_f32 v243, v226, v227
v_mfma_f32_16x16x32_bf16 v[208:211], a[100:103], a[36:39], v[208:211]
s_sub_u32 s74, s7, 57344
v_exp_f32 v228, v228
v_mfma_f32_16x16x32_bf16 v[208:211], a[104:107], a[40:43], v[208:211]
buffer_load_dwordx4 v0, s[20:23], s7 offen offset:0 sc1 lds
v_mfma_f32_16x16x32_bf16 v[208:211], a[108:111], a[44:47], v[208:211]
v_exp_f32 v229, v229
v_mfma_f32_16x16x32_bf16 v[212:215], a[108:111], a[60:63], v[52:55]
ds_read_b128 a[136:139], v2 offset:2048
v_cvt_pk_bf16_f32 v246, v228, v229
v_mfma_f32_16x16x32_bf16 v[212:215], a[104:107], a[56:59], v[212:215]
v_exp_f32 v230, v230
v_mfma_f32_16x16x32_bf16 v[212:215], a[100:103], a[52:55], v[212:215]
buffer_load_dwordx4 v0, s[20:23], s7 offen offset:1024 sc1 lds
v_mfma_f32_16x16x32_bf16 v[212:215], a[96:99], a[48:51], v[212:215]
v_exp_f32 v231, v231
v_mfma_f32_16x16x32_bf16 v[216:219], a[112:115], a[64:67], v[56:59]
ds_read_b128 a[140:143], v2 offset:3072
v_cvt_pk_bf16_f32 v247, v230, v231
v_mfma_f32_16x16x32_bf16 v[216:219], a[116:119], a[68:71], v[216:219]
v_exp_f32 v200, v200
v_mfma_f32_16x16x32_bf16 v[216:219], a[120:123], a[72:75], v[216:219]
buffer_load_dwordx4 v0, s[20:23], s7 offen offset:2048 sc1 lds
v_mfma_f32_16x16x32_bf16 v[216:219], a[124:127], a[76:79], v[216:219]
v_exp_f32 v201, v201
v_mfma_f32_16x16x32_bf16 v[220:223], a[124:127], a[92:95], v[60:63]
ds_read_b128 a[144:147], v2 offset:4096
v_cvt_pk_bf16_f32 v248, v200, v201
v_mfma_f32_16x16x32_bf16 v[220:223], a[120:123], a[88:91], v[220:223]
v_exp_f32 v202, v202
v_mfma_f32_16x16x32_bf16 v[220:223], a[116:119], a[84:87], v[220:223]
buffer_load_dwordx4 v0, s[20:23], s7 offen offset:3072 sc1 lds
v_mfma_f32_16x16x32_bf16 v[220:223], a[112:115], a[80:83], v[220:223]
v_exp_f32 v203, v203
v_mfma_f32_16x16x32_bf16 v[224:227], a[112:115], a[32:35], v[48:51]
ds_read_b128 a[148:151], v2 offset:5120
v_cvt_pk_bf16_f32 v249, v202, v203
v_mfma_f32_16x16x32_bf16 v[224:227], a[116:119], a[36:39], v[224:227]
v_exp_f32 v204, v204
v_mfma_f32_16x16x32_bf16 v[224:227], a[120:123], a[40:43], v[224:227]
buffer_store_dwordx4 v[76:79], v0, s[76:79], s88 offen offset:1024 sc1
v_mfma_f32_16x16x32_bf16 v[224:227], a[124:127], a[44:47], v[224:227]
s_add_u32 m0, s19, 4096
v_exp_f32 v205, v205
v_mfma_f32_16x16x32_bf16 v[228:231], a[124:127], a[60:63], v[52:55]
ds_read_b128 a[152:155], v2 offset:6144
v_cvt_pk_bf16_f32 v252, v204, v205
v_mfma_f32_16x16x32_bf16 v[228:231], a[120:123], a[56:59], v[228:231]
v_exp_f32 v206, v206
v_mfma_f32_16x16x32_bf16 v[228:231], a[116:119], a[52:55], v[228:231]
buffer_load_dwordx4 v38, s[52:55], s18 offen offset:0 lds
v_mfma_f32_16x16x32_bf16 v[228:231], a[112:115], a[48:51], v[228:231]
s_waitcnt lgkmcnt(6)
s_add_u32 m0, s19, 5056
v_exp_f32 v207, v207
v_mfma_f32_16x16x32_bf16 a[0:3], a[128:131], v[232:235], 0
ds_read_b128 a[156:159], v2 offset:7168
v_cvt_pk_bf16_f32 v253, v206, v207
v_mfma_f32_16x16x32_bf16 a[224:227], a[128:131], v[236:239], a[224:227]
v_exp_f32 v208, v208
v_mfma_f32_16x16x32_bf16 v[136:139], a[128:131], v[240:243], v[136:139]
ds_read_b128 a[96:99], v1 offset:16384
buffer_load_dwordx4 v38, s[52:55], s18 offen offset:64 lds
v_mfma_f32_16x16x32_bf16 v[168:171], a[128:131], v[244:247], v[168:171]
s_waitcnt lgkmcnt(7)
s_add_u32 s18, s18, 16384
v_exp_f32 v209, v209
v_mfma_f32_16x16x32_bf16 v[172:175], a[132:135], v[244:247], v[172:175]
v_cvt_pk_bf16_f32 v64, v208, v209
v_add_u32 v2, s12, v3
v_mfma_f32_16x16x32_bf16 v[140:143], a[132:135], v[240:243], v[140:143]
v_exp_f32 v210, v210
v_mfma_f32_16x16x32_bf16 a[228:231], a[132:135], v[236:239], a[228:231]
ds_read_b128 a[100:103], v1 offset:17408
buffer_store_dwordx4 v[80:83], v0, s[76:79], s88 offen offset:2048 sc1
v_mfma_f32_16x16x32_bf16 a[4:7], a[132:135], v[232:235], 0
s_waitcnt lgkmcnt(7)
s_add_u32 m0, s75, s10
v_exp_f32 v211, v211
v_mfma_f32_16x16x32_bf16 a[8:11], a[136:139], v[232:235], 0
ds_read_b128 a[104:107], v1 offset:18432
v_cvt_pk_bf16_f32 v65, v210, v211
v_mfma_f32_16x16x32_bf16 a[232:235], a[136:139], v[236:239], a[232:235]
v_exp_f32 v212, v212
v_mfma_f32_16x16x32_bf16 v[144:147], a[136:139], v[240:243], v[144:147]
buffer_load_dwordx4 v0, s[20:23], s74 offen offset:0 sc1 lds
v_mfma_f32_16x16x32_bf16 v[176:179], a[136:139], v[244:247], v[176:179]
s_waitcnt lgkmcnt(7)
v_exp_f32 v213, v213
v_mfma_f32_16x16x32_bf16 v[180:183], a[140:143], v[244:247], v[180:183]
ds_read_b128 a[108:111], v1 offset:19456
v_cvt_pk_bf16_f32 v68, v212, v213
v_mfma_f32_16x16x32_bf16 v[148:151], a[140:143], v[240:243], v[148:151]
v_exp_f32 v214, v214
v_mfma_f32_16x16x32_bf16 a[236:239], a[140:143], v[236:239], a[236:239]
buffer_load_dwordx4 v0, s[20:23], s74 offen offset:1024 sc1 lds
v_mfma_f32_16x16x32_bf16 a[12:15], a[140:143], v[232:235], 0
s_waitcnt lgkmcnt(7)
v_exp_f32 v215, v215
v_mfma_f32_16x16x32_bf16 a[16:19], a[144:147], v[232:235], 0
ds_read_b128 a[112:115], v1 offset:20480
v_cvt_pk_bf16_f32 v69, v214, v215
v_mfma_f32_16x16x32_bf16 a[240:243], a[144:147], v[236:239], a[240:243]
v_exp_f32 v216, v216
v_mfma_f32_16x16x32_bf16 v[152:155], a[144:147], v[240:243], v[152:155]
buffer_load_dwordx4 v0, s[20:23], s74 offen offset:2048 sc1 lds
v_mfma_f32_16x16x32_bf16 v[184:187], a[144:147], v[244:247], v[184:187]
s_waitcnt lgkmcnt(7)
v_exp_f32 v217, v217
v_mfma_f32_16x16x32_bf16 v[188:191], a[148:151], v[244:247], v[188:191]
ds_read_b128 a[116:119], v1 offset:21504
v_cvt_pk_bf16_f32 v250, v216, v217
v_mfma_f32_16x16x32_bf16 v[156:159], a[148:151], v[240:243], v[156:159]
v_exp_f32 v218, v218
v_mfma_f32_16x16x32_bf16 a[244:247], a[148:151], v[236:239], a[244:247]
buffer_load_dwordx4 v0, s[20:23], s74 offen offset:3072 sc1 lds
v_mfma_f32_16x16x32_bf16 a[20:23], a[148:151], v[232:235], 0
s_waitcnt lgkmcnt(7)
s_add_u32 s7, s7, 32768
v_exp_f32 v219, v219
v_mfma_f32_16x16x32_bf16 a[24:27], a[152:155], v[232:235], 0
s_add_u32 s8, s8, 16384
ds_read_b128 a[120:123], v1 offset:22528
v_cvt_pk_bf16_f32 v251, v218, v219
v_mfma_f32_16x16x32_bf16 a[248:251], a[152:155], v[236:239], a[248:251]
s_and_b32 s8, s8, 0xffff
v_exp_f32 v220, v220
v_mfma_f32_16x16x32_bf16 v[160:163], a[152:155], v[240:243], v[160:163]
buffer_store_dwordx4 v[84:87], v0, s[76:79], s88 offen offset:3072 sc1
v_mfma_f32_16x16x32_bf16 v[192:195], a[152:155], v[244:247], v[192:195]
s_waitcnt lgkmcnt(7)
v_exp_f32 v221, v221
v_mfma_f32_16x16x32_bf16 v[196:199], a[156:159], v[244:247], v[196:199]
ds_read_b128 a[124:127], v1 offset:23552
v_cvt_pk_bf16_f32 v254, v220, v221
v_mfma_f32_16x16x32_bf16 v[164:167], a[156:159], v[240:243], v[164:167]
v_exp_f32 v222, v222
v_mfma_f32_16x16x32_bf16 a[252:255], a[156:159], v[236:239], a[252:255]
v_lshrrev_b32 v24, 6, v0
v_and_b32 v25, 7, v24
v_mfma_f32_16x16x32_bf16 a[28:31], a[156:159], v[232:235], 0
v_exp_f32 v223, v223
v_mfma_f32_16x16x32_bf16 a[176:179], a[184:187], v[232:235], a[176:179]
v_cvt_pk_bf16_f32 v255, v222, v223
v_add_u32 v1, s11, v0
v_mfma_f32_16x16x32_bf16 a[180:183], a[184:187], v[236:239], a[180:183]
v_lshlrev_b32 v25, 5, v25
v_lshl_or_b32 v25, v24, 8, v25
v_mfma_f32_16x16x32_bf16 a[168:171], a[184:187], v[240:243], a[168:171]
v_bfe_u32 v24, v0, 4, 2
v_lshl_or_b32 v25, v24, 3, v25
v_mfma_f32_16x16x32_bf16 a[172:175], a[184:187], v[244:247], a[172:175]
s_waitcnt lgkmcnt(7)
v_add_u32 v17, s17, v25
v_and_b32 v24, 511, v0
v_lshrrev_b32 v25, 9, v0
v_mul_u32_u24 v25, 147456, v25
v_add_u32 v16, v24, v25
v_mov_b32 v31, s50
v_mfma_f32_16x16x32_bf16 v[200:203], a[96:99], a[64:67], v[56:59]
s_waitcnt vmcnt(25) lgkmcnt(0)
s_barrier
v_mfma_f32_16x16x32_bf16 v[200:203], a[100:103], a[68:71], v[200:203]
s_add_u32 s12, s12, 16384
v_exp_f32 v224, v224
v_mfma_f32_16x16x32_bf16 v[200:203], a[104:107], a[72:75], v[200:203]
s_and_b32 s12, s12, 0xffff
v_bfe_u32 v20, v0, 2, 7
v_mfma_f32_16x16x32_bf16 v[200:203], a[108:111], a[76:79], v[200:203]
s_add_u32 s11, s11, 16384
v_exp_f32 v225, v225
v_mfma_f32_16x16x32_bf16 v[204:207], a[108:111], a[92:95], v[60:63]
ds_read_b128 a[128:131], v2 offset:0
v_cvt_pk_bf16_f32 v66, v224, v225
v_mfma_f32_16x16x32_bf16 v[204:207], a[104:107], a[88:91], v[204:207]
s_and_b32 s11, s11, 0xffff
v_exp_f32 v226, v226
v_mfma_f32_16x16x32_bf16 v[204:207], a[100:103], a[84:87], v[204:207]
buffer_load_dword v20, v20, s[76:79], s42 offen offset:128 sc1
v_mfma_f32_16x16x32_bf16 v[204:207], a[96:99], a[80:83], v[204:207]
v_exp_f32 v227, v227
v_mfma_f32_16x16x32_bf16 v[208:211], a[96:99], a[32:35], v[48:51]
ds_read_b128 a[132:135], v2 offset:1024
v_cvt_pk_bf16_f32 v67, v226, v227
v_mfma_f32_16x16x32_bf16 v[208:211], a[100:103], a[36:39], v[208:211]
v_exp_f32 v228, v228
v_mfma_f32_16x16x32_bf16 v[208:211], a[104:107], a[40:43], v[208:211]
buffer_store_dwordx4 v[88:91], v0, s[76:79], s89 offen offset:0 sc1
v_mfma_f32_16x16x32_bf16 v[208:211], a[108:111], a[44:47], v[208:211]
s_add_u32 m0, s8, s9
v_exp_f32 v229, v229
v_mfma_f32_16x16x32_bf16 v[212:215], a[108:111], a[60:63], v[52:55]
s_xor_b32 s75, s8, 0x8000
ds_read_b128 a[136:139], v2 offset:2048
v_cvt_pk_bf16_f32 v70, v228, v229
v_mfma_f32_16x16x32_bf16 v[212:215], a[104:107], a[56:59], v[212:215]
s_sub_u32 s74, s7, 57344
v_exp_f32 v230, v230
v_mfma_f32_16x16x32_bf16 v[212:215], a[100:103], a[52:55], v[212:215]
buffer_load_dwordx4 v0, s[20:23], s7 offen offset:0 sc1 lds
v_mfma_f32_16x16x32_bf16 v[212:215], a[96:99], a[48:51], v[212:215]
v_exp_f32 v231, v231
v_mfma_f32_16x16x32_bf16 v[216:219], a[112:115], a[64:67], v[56:59]
ds_read_b128 a[140:143], v2 offset:3072
v_cvt_pk_bf16_f32 v71, v230, v231
v_mfma_f32_16x16x32_bf16 v[216:219], a[116:119], a[68:71], v[216:219]
v_exp_f32 v200, v200
v_mfma_f32_16x16x32_bf16 v[216:219], a[120:123], a[72:75], v[216:219]
buffer_load_dwordx4 v0, s[20:23], s7 offen offset:1024 sc1 lds
v_mfma_f32_16x16x32_bf16 v[216:219], a[124:127], a[76:79], v[216:219]
v_exp_f32 v201, v201
v_mfma_f32_16x16x32_bf16 v[220:223], a[124:127], a[92:95], v[60:63]
ds_read_b128 a[144:147], v2 offset:4096
v_cvt_pk_bf16_f32 v232, v200, v201
v_mfma_f32_16x16x32_bf16 v[220:223], a[120:123], a[88:91], v[220:223]
v_exp_f32 v202, v202
v_mfma_f32_16x16x32_bf16 v[220:223], a[116:119], a[84:87], v[220:223]
buffer_load_dwordx4 v0, s[20:23], s7 offen offset:2048 sc1 lds
v_mfma_f32_16x16x32_bf16 v[220:223], a[112:115], a[80:83], v[220:223]
v_exp_f32 v203, v203
v_mfma_f32_16x16x32_bf16 v[224:227], a[112:115], a[32:35], v[48:51]
ds_read_b128 a[148:151], v2 offset:5120
v_cvt_pk_bf16_f32 v233, v202, v203
v_mfma_f32_16x16x32_bf16 v[224:227], a[116:119], a[36:39], v[224:227]
v_exp_f32 v204, v204
v_mfma_f32_16x16x32_bf16 v[224:227], a[120:123], a[40:43], v[224:227]
buffer_load_dwordx4 v0, s[20:23], s7 offen offset:3072 sc1 lds
v_mfma_f32_16x16x32_bf16 v[224:227], a[124:127], a[44:47], v[224:227]
v_exp_f32 v205, v205
v_mfma_f32_16x16x32_bf16 v[228:231], a[124:127], a[60:63], v[52:55]
ds_read_b128 a[152:155], v2 offset:6144
v_cvt_pk_bf16_f32 v236, v204, v205
v_mfma_f32_16x16x32_bf16 v[228:231], a[120:123], a[56:59], v[228:231]
v_exp_f32 v206, v206
v_mfma_f32_16x16x32_bf16 v[228:231], a[116:119], a[52:55], v[228:231]
buffer_store_dwordx4 v[92:95], v0, s[76:79], s89 offen offset:1024 sc1
v_mfma_f32_16x16x32_bf16 v[228:231], a[112:115], a[48:51], v[228:231]
s_waitcnt lgkmcnt(6)
s_add_u32 m0, s19, 6144
v_exp_f32 v207, v207
v_mfma_f32_16x16x32_bf16 a[0:3], a[128:131], v[248:251], a[0:3]
ds_read_b128 a[156:159], v2 offset:7168
v_cvt_pk_bf16_f32 v237, v206, v207
v_mfma_f32_16x16x32_bf16 a[224:227], a[128:131], v[252:255], a[224:227]
v_exp_f32 v208, v208
v_mfma_f32_16x16x32_bf16 v[136:139], a[128:131], v[64:67], v[136:139]
ds_read_b128 a[96:99], v1 offset:16384
buffer_load_dwordx4 v38, s[52:55], s18 offen offset:0 lds
v_mfma_f32_16x16x32_bf16 v[168:171], a[128:131], v[68:71], v[168:171]
s_waitcnt lgkmcnt(7)
s_add_u32 m0, s19, 7104
v_exp_f32 v209, v209
v_mfma_f32_16x16x32_bf16 v[172:175], a[132:135], v[68:71], v[172:175]
v_cvt_pk_bf16_f32 v240, v208, v209
v_add_u32 v2, s12, v3
v_mfma_f32_16x16x32_bf16 v[140:143], a[132:135], v[64:67], v[140:143]
v_exp_f32 v210, v210
v_mfma_f32_16x16x32_bf16 a[228:231], a[132:135], v[252:255], a[228:231]
ds_read_b128 a[100:103], v1 offset:17408
buffer_load_dwordx4 v38, s[52:55], s18 offen offset:64 lds
v_mfma_f32_16x16x32_bf16 a[4:7], a[132:135], v[248:251], a[4:7]
s_waitcnt lgkmcnt(7)
s_add_u32 s18, s18, 16384
v_exp_f32 v211, v211
v_mfma_f32_16x16x32_bf16 a[8:11], a[136:139], v[248:251], a[8:11]
ds_read_b128 a[104:107], v1 offset:18432
v_cvt_pk_bf16_f32 v241, v210, v211
v_mfma_f32_16x16x32_bf16 a[232:235], a[136:139], v[252:255], a[232:235]
v_exp_f32 v212, v212
v_mfma_f32_16x16x32_bf16 v[144:147], a[136:139], v[64:67], v[144:147]
buffer_store_dwordx4 v[96:99], v0, s[76:79], s89 offen offset:2048 sc1
v_mfma_f32_16x16x32_bf16 v[176:179], a[136:139], v[68:71], v[176:179]
s_waitcnt lgkmcnt(7)
s_add_u32 m0, s75, s10
v_exp_f32 v213, v213
v_mfma_f32_16x16x32_bf16 v[180:183], a[140:143], v[68:71], v[180:183]
ds_read_b128 a[108:111], v1 offset:19456
v_cvt_pk_bf16_f32 v244, v212, v213
v_mfma_f32_16x16x32_bf16 v[148:151], a[140:143], v[64:67], v[148:151]
v_exp_f32 v214, v214
v_mfma_f32_16x16x32_bf16 a[236:239], a[140:143], v[252:255], a[236:239]
buffer_load_dwordx4 v0, s[20:23], s74 offen offset:0 sc1 lds
v_mfma_f32_16x16x32_bf16 a[12:15], a[140:143], v[248:251], a[12:15]
s_waitcnt lgkmcnt(7)
v_exp_f32 v215, v215
v_mfma_f32_16x16x32_bf16 a[16:19], a[144:147], v[248:251], a[16:19]
ds_read_b128 a[112:115], v1 offset:20480
v_cvt_pk_bf16_f32 v245, v214, v215
v_mfma_f32_16x16x32_bf16 a[240:243], a[144:147], v[252:255], a[240:243]
v_exp_f32 v216, v216
v_mfma_f32_16x16x32_bf16 v[152:155], a[144:147], v[64:67], v[152:155]
buffer_load_dwordx4 v0, s[20:23], s74 offen offset:1024 sc1 lds
v_mfma_f32_16x16x32_bf16 v[184:187], a[144:147], v[68:71], v[184:187]
s_waitcnt lgkmcnt(7)
v_exp_f32 v217, v217
v_mfma_f32_16x16x32_bf16 v[188:191], a[148:151], v[68:71], v[188:191]
ds_read_b128 a[116:119], v1 offset:21504
v_cvt_pk_bf16_f32 v234, v216, v217
v_mfma_f32_16x16x32_bf16 v[156:159], a[148:151], v[64:67], v[156:159]
v_exp_f32 v218, v218
v_mfma_f32_16x16x32_bf16 a[244:247], a[148:151], v[252:255], a[244:247]
buffer_load_dwordx4 v0, s[20:23], s74 offen offset:2048 sc1 lds
v_mfma_f32_16x16x32_bf16 a[20:23], a[148:151], v[248:251], a[20:23]
s_waitcnt lgkmcnt(7)
v_exp_f32 v219, v219
v_mfma_f32_16x16x32_bf16 a[24:27], a[152:155], v[248:251], a[24:27]
ds_read_b128 a[120:123], v1 offset:22528
v_cvt_pk_bf16_f32 v235, v218, v219
v_mfma_f32_16x16x32_bf16 a[248:251], a[152:155], v[252:255], a[248:251]
v_exp_f32 v220, v220
v_mfma_f32_16x16x32_bf16 v[160:163], a[152:155], v[64:67], v[160:163]
buffer_load_dwordx4 v0, s[20:23], s74 offen offset:3072 sc1 lds
v_mfma_f32_16x16x32_bf16 v[192:195], a[152:155], v[68:71], v[192:195]
s_waitcnt lgkmcnt(7)
s_add_u32 s7, s7, 32768
v_exp_f32 v221, v221
v_mfma_f32_16x16x32_bf16 v[196:199], a[156:159], v[68:71], v[196:199]
s_waitcnt vmcnt(13)
s_add_u32 s8, s8, 16384
ds_read_b128 a[124:127], v1 offset:23552
v_cvt_pk_bf16_f32 v238, v220, v221
v_cmp_lt_u32 vcc, 0, v20
v_mfma_f32_16x16x32_bf16 v[164:167], a[156:159], v[64:67], v[164:167]
s_and_b32 s8, s8, 0xffff
v_exp_f32 v222, v222
v_mfma_f32_16x16x32_bf16 a[252:255], a[156:159], v[252:255], a[252:255]
buffer_store_dwordx4 v[100:103], v0, s[76:79], s89 offen offset:3072 sc1
v_mfma_f32_16x16x32_bf16 a[28:31], a[156:159], v[248:251], a[28:31]
v_exp_f32 v223, v223
v_mfma_f32_16x16x32_bf16 a[176:179], a[184:187], v[248:251], a[176:179]
v_cvt_pk_bf16_f32 v239, v222, v223
v_add_u32 v1, s11, v0
v_mfma_f32_16x16x32_bf16 a[180:183], a[184:187], v[252:255], a[180:183]
s_add_u32 s35, s84, 1
s_and_b32 s35, s35, 7
v_mfma_f32_16x16x32_bf16 a[168:171], a[184:187], v[64:67], a[168:171]
v_lshl_add_u32 v8, s35, 11, v16
v_mfma_f32_16x16x32_bf16 a[172:175], a[184:187], v[68:71], a[172:175]
s_andn2_b32 s33, 65535, vcc_lo
s_cbranch_scc1 LA_p6_s
LA_p6:
s_add_u32 s35, s84, 2
s_and_b32 s35, s35, 7
v_lshl_add_u32 v9, s35, 11, v16
s_add_u32 s35, s84, 3
s_and_b32 s35, s35, 7
v_lshl_add_u32 v10, s35, 11, v16
s_add_u32 s35, s84, 4
s_and_b32 s35, s35, 7
v_lshl_add_u32 v11, s35, 11, v16
s_add_u32 s35, s84, 5
s_and_b32 s35, s35, 7
v_lshl_add_u32 v12, s35, 11, v16
s_add_u32 s35, s84, 6
s_and_b32 s35, s35, 7
v_lshl_add_u32 v13, s35, 11, v16
s_add_u32 s35, s84, 7
s_and_b32 s35, s35, 7
v_lshl_add_u32 v14, s35, 11, v16
s_add_u32 s35, s84, 8
s_and_b32 s35, s35, 7
v_lshl_add_u32 v15, s35, 11, v16
s_cmp_eq_u32 s82, 6
s_cbranch_scc1 LA_l2t
LA_l2:
s_waitcnt lgkmcnt(7)
v_mfma_f32_16x16x32_bf16 v[200:203], a[96:99], a[64:67], v[56:59]
s_waitcnt vmcnt(16) lgkmcnt(0)
s_barrier
v_mfma_f32_16x16x32_bf16 v[200:203], a[100:103], a[68:71], v[200:203]
s_add_u32 s12, s12, 16384
v_exp_f32 v224, v224
v_mfma_f32_16x16x32_bf16 v[200:203], a[104:107], a[72:75], v[200:203]
s_and_b32 s12, s12, 0xffff
s_add_u32 s11, s11, 16384
s_add_u32 m0, s8, s9
v_mfma_f32_16x16x32_bf16 v[200:203], a[108:111], a[76:79], v[200:203]
s_and_b32 s11, s11, 0xffff
v_exp_f32 v225, v225
v_mfma_f32_16x16x32_bf16 v[204:207], a[108:111], a[92:95], v[60:63]
ds_read_b128 a[128:131], v2 offset:0
v_cvt_pk_bf16_f32 v242, v224, v225
v_mfma_f32_16x16x32_bf16 v[204:207], a[104:107], a[88:91], v[204:207]
s_xor_b32 s75, s8, 0x8000
v_exp_f32 v226, v226
v_mfma_f32_16x16x32_bf16 v[204:207], a[100:103], a[84:87], v[204:207]
s_sub_u32 s74, s7, 57344
v_mfma_f32_16x16x32_bf16 v[204:207], a[96:99], a[80:83], v[204:207]
v_exp_f32 v227, v227
v_mfma_f32_16x16x32_bf16 v[208:211], a[96:99], a[32:35], v[48:51]
ds_read_b128 a[132:135], v2 offset:1024
v_cvt_pk_bf16_f32 v243, v226, v227
v_mfma_f32_16x16x32_bf16 v[208:211], a[100:103], a[36:39], v[208:211]
v_exp_f32 v228, v228
v_mfma_f32_16x16x32_bf16 v[208:211], a[104:107], a[40:43], v[208:211]
ds_read_b128 a[136:139], v2 offset:2048
v_mfma_f32_16x16x32_bf16 v[208:211], a[108:111], a[44:47], v[208:211]
v_exp_f32 v229, v229
v_mfma_f32_16x16x32_bf16 v[212:215], a[108:111], a[60:63], v[52:55]
ds_read_b128 a[140:143], v2 offset:3072
v_cvt_pk_bf16_f32 v246, v228, v229
v_mfma_f32_16x16x32_bf16 v[212:215], a[104:107], a[56:59], v[212:215]
v_exp_f32 v230, v230
v_mfma_f32_16x16x32_bf16 v[212:215], a[100:103], a[52:55], v[212:215]
buffer_load_dwordx4 v0, s[20:23], s7 offen offset:0 sc1 lds
v_mfma_f32_16x16x32_bf16 v[212:215], a[96:99], a[48:51], v[212:215]
v_exp_f32 v231, v231
v_mfma_f32_16x16x32_bf16 v[216:219], a[112:115], a[64:67], v[56:59]
ds_read_b128 a[144:147], v2 offset:4096
v_cvt_pk_bf16_f32 v247, v230, v231
v_mfma_f32_16x16x32_bf16 v[216:219], a[116:119], a[68:71], v[216:219]
v_exp_f32 v200, v200
v_mfma_f32_16x16x32_bf16 v[216:219], a[120:123], a[72:75], v[216:219]
ds_read_b128 a[148:151], v2 offset:5120
v_mfma_f32_16x16x32_bf16 v[216:219], a[124:127], a[76:79], v[216:219]
v_exp_f32 v201, v201
v_mfma_f32_16x16x32_bf16 v[220:223], a[124:127], a[92:95], v[60:63]
ds_read_b128 a[152:155], v2 offset:6144
v_cvt_pk_bf16_f32 v248, v200, v201
v_mfma_f32_16x16x32_bf16 v[220:223], a[120:123], a[88:91], v[220:223]
v_exp_f32 v202, v202
v_mfma_f32_16x16x32_bf16 v[220:223], a[116:119], a[84:87], v[220:223]
buffer_load_dwordx4 v0, s[20:23], s7 offen offset:1024 sc1 lds
v_mfma_f32_16x16x32_bf16 v[220:223], a[112:115], a[80:83], v[220:223]
v_exp_f32 v203, v203
v_mfma_f32_16x16x32_bf16 v[224:227], a[112:115], a[32:35], v[48:51]
ds_read_b128 a[156:159], v2 offset:7168
v_cvt_pk_bf16_f32 v249, v202, v203
v_mfma_f32_16x16x32_bf16 v[224:227], a[116:119], a[36:39], v[224:227]
v_exp_f32 v204, v204
v_mfma_f32_16x16x32_bf16 v[224:227], a[120:123], a[40:43], v[224:227]
buffer_load_dwordx4 v0, s[20:23], s7 offen offset:2048 sc1 lds
v_mfma_f32_16x16x32_bf16 v[224:227], a[124:127], a[44:47], v[224:227]
v_exp_f32 v205, v205
v_mfma_f32_16x16x32_bf16 v[228:231], a[124:127], a[60:63], v[52:55]
v_cvt_pk_bf16_f32 v252, v204, v205
v_add_u32 v2, s12, v3
v_mfma_f32_16x16x32_bf16 v[228:231], a[120:123], a[56:59], v[228:231]
s_waitcnt lgkmcnt(0)
v_exp_f32 v206, v206
v_mfma_f32_16x16x32_bf16 v[228:231], a[116:119], a[52:55], v[228:231]
buffer_load_dwordx4 v0, s[20:23], s7 offen offset:3072 sc1 lds
v_mfma_f32_16x16x32_bf16 v[228:231], a[112:115], a[48:51], v[228:231]
s_add_u32 m0, s75, s10
v_exp_f32 v207, v207
v_mfma_f32_16x16x32_bf16 a[0:3], a[128:131], v[232:235], a[0:3]
ds_read_b128 a[96:99], v1 offset:16384
v_cvt_pk_bf16_f32 v253, v206, v207
v_mfma_f32_16x16x32_bf16 a[224:227], a[128:131], v[236:239], a[224:227]
v_exp_f32 v208, v208
v_mfma_f32_16x16x32_bf16 v[136:139], a[128:131], v[240:243], v[136:139]
buffer_load_dwordx4 v0, s[20:23], s74 offen offset:0 sc1 lds
v_mfma_f32_16x16x32_bf16 v[168:171], a[128:131], v[244:247], v[168:171]
v_exp_f32 v209, v209
v_mfma_f32_16x16x32_bf16 v[172:175], a[132:135], v[244:247], v[172:175]
ds_read_b128 a[100:103], v1 offset:17408
v_cvt_pk_bf16_f32 v64, v208, v209
v_mfma_f32_16x16x32_bf16 v[140:143], a[132:135], v[240:243], v[140:143]
v_exp_f32 v210, v210
v_mfma_f32_16x16x32_bf16 a[228:231], a[132:135], v[236:239], a[228:231]
buffer_load_dwordx4 v0, s[20:23], s74 offen offset:1024 sc1 lds
v_mfma_f32_16x16x32_bf16 a[4:7], a[132:135], v[232:235], a[4:7]
v_exp_f32 v211, v211
v_mfma_f32_16x16x32_bf16 a[8:11], a[136:139], v[232:235], a[8:11]
ds_read_b128 a[104:107], v1 offset:18432
v_cvt_pk_bf16_f32 v65, v210, v211
v_mfma_f32_16x16x32_bf16 a[232:235], a[136:139], v[236:239], a[232:235]
v_exp_f32 v212, v212
v_mfma_f32_16x16x32_bf16 v[144:147], a[136:139], v[240:243], v[144:147]
buffer_load_dwordx4 v0, s[20:23], s74 offen offset:2048 sc1 lds
v_mfma_f32_16x16x32_bf16 v[176:179], a[136:139], v[244:247], v[176:179]
v_exp_f32 v213, v213
v_mfma_f32_16x16x32_bf16 v[180:183], a[140:143], v[244:247], v[180:183]
ds_read_b128 a[108:111], v1 offset:19456
v_cvt_pk_bf16_f32 v68, v212, v213
v_mfma_f32_16x16x32_bf16 v[148:151], a[140:143], v[240:243], v[148:151]
v_exp_f32 v214, v214
v_mfma_f32_16x16x32_bf16 a[236:239], a[140:143], v[236:239], a[236:239]
buffer_load_dwordx4 v0, s[20:23], s74 offen offset:3072 sc1 lds
v_mfma_f32_16x16x32_bf16 a[12:15], a[140:143], v[232:235], a[12:15]
s_add_u32 s7, s7, 32768
v_exp_f32 v215, v215
v_mfma_f32_16x16x32_bf16 a[16:19], a[144:147], v[232:235], a[16:19]
ds_read_b128 a[112:115], v1 offset:20480
v_cvt_pk_bf16_f32 v69, v214, v215
v_mfma_f32_16x16x32_bf16 a[240:243], a[144:147], v[236:239], a[240:243]
s_add_u32 s8, s8, 16384
v_exp_f32 v216, v216
v_mfma_f32_16x16x32_bf16 v[152:155], a[144:147], v[240:243], v[152:155]
s_and_b32 s8, s8, 0xffff
v_mfma_f32_16x16x32_bf16 v[184:187], a[144:147], v[244:247], v[184:187]
v_exp_f32 v217, v217
v_mfma_f32_16x16x32_bf16 v[188:191], a[148:151], v[244:247], v[188:191]
ds_read_b128 a[116:119], v1 offset:21504
v_cvt_pk_bf16_f32 v250, v216, v217
v_mfma_f32_16x16x32_bf16 v[156:159], a[148:151], v[240:243], v[156:159]
v_exp_f32 v218, v218
v_mfma_f32_16x16x32_bf16 a[244:247], a[148:151], v[236:239], a[244:247]
v_mfma_f32_16x16x32_bf16 a[20:23], a[148:151], v[232:235], a[20:23]
v_exp_f32 v219, v219
v_mfma_f32_16x16x32_bf16 a[24:27], a[152:155], v[232:235], a[24:27]
ds_read_b128 a[120:123], v1 offset:22528
v_cvt_pk_bf16_f32 v251, v218, v219
v_mfma_f32_16x16x32_bf16 a[248:251], a[152:155], v[236:239], a[248:251]
v_exp_f32 v220, v220
v_mfma_f32_16x16x32_bf16 v[160:163], a[152:155], v[240:243], v[160:163]
v_mfma_f32_16x16x32_bf16 v[192:195], a[152:155], v[244:247], v[192:195]
v_exp_f32 v221, v221
v_mfma_f32_16x16x32_bf16 v[196:199], a[156:159], v[244:247], v[196:199]
ds_read_b128 a[124:127], v1 offset:23552
v_cvt_pk_bf16_f32 v254, v220, v221
v_mfma_f32_16x16x32_bf16 v[164:167], a[156:159], v[240:243], v[164:167]
v_exp_f32 v222, v222
v_mfma_f32_16x16x32_bf16 a[252:255], a[156:159], v[236:239], a[252:255]
v_mfma_f32_16x16x32_bf16 a[28:31], a[156:159], v[232:235], a[28:31]
v_exp_f32 v223, v223
v_mfma_f32_16x16x32_bf16 a[176:179], a[184:187], v[232:235], a[176:179]
v_cvt_pk_bf16_f32 v255, v222, v223
v_add_u32 v1, s11, v0
v_mfma_f32_16x16x32_bf16 a[180:183], a[184:187], v[236:239], a[180:183]
v_mfma_f32_16x16x32_bf16 a[168:171], a[184:187], v[240:243], a[168:171]
v_mfma_f32_16x16x32_bf16 a[172:175], a[184:187], v[244:247], a[172:175]
s_waitcnt lgkmcnt(7)
v_mfma_f32_16x16x32_bf16 v[200:203], a[96:99], a[64:67], v[56:59]
s_waitcnt vmcnt(16) lgkmcnt(0)
s_barrier
v_mfma_f32_16x16x32_bf16 v[200:203], a[100:103], a[68:71], v[200:203]
s_add_u32 s12, s12, 16384
v_exp_f32 v224, v224
v_mfma_f32_16x16x32_bf16 v[200:203], a[104:107], a[72:75], v[200:203]
s_and_b32 s12, s12, 0xffff
s_add_u32 s11, s11, 16384
s_add_u32 m0, s8, s9
v_mfma_f32_16x16x32_bf16 v[200:203], a[108:111], a[76:79], v[200:203]
s_and_b32 s11, s11, 0xffff
v_exp_f32 v225, v225
v_mfma_f32_16x16x32_bf16 v[204:207], a[108:111], a[92:95], v[60:63]
ds_read_b128 a[128:131], v2 offset:0
v_cvt_pk_bf16_f32 v66, v224, v225
v_mfma_f32_16x16x32_bf16 v[204:207], a[104:107], a[88:91], v[204:207]
s_xor_b32 s75, s8, 0x8000
v_exp_f32 v226, v226
v_mfma_f32_16x16x32_bf16 v[204:207], a[100:103], a[84:87], v[204:207]
s_sub_u32 s74, s7, 57344
s_sub_u32 s13, s13, 1
v_mfma_f32_16x16x32_bf16 v[204:207], a[96:99], a[80:83], v[204:207]
v_exp_f32 v227, v227
v_mfma_f32_16x16x32_bf16 v[208:211], a[96:99], a[32:35], v[48:51]
ds_read_b128 a[132:135], v2 offset:1024
v_cvt_pk_bf16_f32 v67, v226, v227
v_mfma_f32_16x16x32_bf16 v[208:211], a[100:103], a[36:39], v[208:211]
v_exp_f32 v228, v228
v_mfma_f32_16x16x32_bf16 v[208:211], a[104:107], a[40:43], v[208:211]
ds_read_b128 a[136:139], v2 offset:2048
v_mfma_f32_16x16x32_bf16 v[208:211], a[108:111], a[44:47], v[208:211]
v_exp_f32 v229, v229
v_mfma_f32_16x16x32_bf16 v[212:215], a[108:111], a[60:63], v[52:55]
ds_read_b128 a[140:143], v2 offset:3072
v_cvt_pk_bf16_f32 v70, v228, v229
v_mfma_f32_16x16x32_bf16 v[212:215], a[104:107], a[56:59], v[212:215]
v_exp_f32 v230, v230
v_mfma_f32_16x16x32_bf16 v[212:215], a[100:103], a[52:55], v[212:215]
buffer_load_dwordx4 v0, s[20:23], s7 offen offset:0 sc1 lds
v_mfma_f32_16x16x32_bf16 v[212:215], a[96:99], a[48:51], v[212:215]
v_exp_f32 v231, v231
v_mfma_f32_16x16x32_bf16 v[216:219], a[112:115], a[64:67], v[56:59]
ds_read_b128 a[144:147], v2 offset:4096
v_cvt_pk_bf16_f32 v71, v230, v231
v_mfma_f32_16x16x32_bf16 v[216:219], a[116:119], a[68:71], v[216:219]
v_exp_f32 v200, v200
v_mfma_f32_16x16x32_bf16 v[216:219], a[120:123], a[72:75], v[216:219]
ds_read_b128 a[148:151], v2 offset:5120
v_mfma_f32_16x16x32_bf16 v[216:219], a[124:127], a[76:79], v[216:219]
v_exp_f32 v201, v201
v_mfma_f32_16x16x32_bf16 v[220:223], a[124:127], a[92:95], v[60:63]
ds_read_b128 a[152:155], v2 offset:6144
v_cvt_pk_bf16_f32 v232, v200, v201
v_mfma_f32_16x16x32_bf16 v[220:223], a[120:123], a[88:91], v[220:223]
v_exp_f32 v202, v202
v_mfma_f32_16x16x32_bf16 v[220:223], a[116:119], a[84:87], v[220:223]
buffer_load_dwordx4 v0, s[20:23], s7 offen offset:1024 sc1 lds
v_mfma_f32_16x16x32_bf16 v[220:223], a[112:115], a[80:83], v[220:223]
v_exp_f32 v203, v203
v_mfma_f32_16x16x32_bf16 v[224:227], a[112:115], a[32:35], v[48:51]
ds_read_b128 a[156:159], v2 offset:7168
v_cvt_pk_bf16_f32 v233, v202, v203
v_mfma_f32_16x16x32_bf16 v[224:227], a[116:119], a[36:39], v[224:227]
v_exp_f32 v204, v204
v_mfma_f32_16x16x32_bf16 v[224:227], a[120:123], a[40:43], v[224:227]
buffer_load_dwordx4 v0, s[20:23], s7 offen offset:2048 sc1 lds
v_mfma_f32_16x16x32_bf16 v[224:227], a[124:127], a[44:47], v[224:227]
v_exp_f32 v205, v205
v_mfma_f32_16x16x32_bf16 v[228:231], a[124:127], a[60:63], v[52:55]
v_cvt_pk_bf16_f32 v236, v204, v205
v_add_u32 v2, s12, v3
v_mfma_f32_16x16x32_bf16 v[228:231], a[120:123], a[56:59], v[228:231]
s_waitcnt lgkmcnt(0)
v_exp_f32 v206, v206
v_mfma_f32_16x16x32_bf16 v[228:231], a[116:119], a[52:55], v[228:231]
buffer_load_dwordx4 v0, s[20:23], s7 offen offset:3072 sc1 lds
v_mfma_f32_16x16x32_bf16 v[228:231], a[112:115], a[48:51], v[228:231]
s_add_u32 m0, s75, s10
v_exp_f32 v207, v207
v_mfma_f32_16x16x32_bf16 a[0:3], a[128:131], v[248:251], a[0:3]
ds_read_b128 a[96:99], v1 offset:16384
v_cvt_pk_bf16_f32 v237, v206, v207
v_mfma_f32_16x16x32_bf16 a[224:227], a[128:131], v[252:255], a[224:227]
v_exp_f32 v208, v208
v_mfma_f32_16x16x32_bf16 v[136:139], a[128:131], v[64:67], v[136:139]
buffer_load_dwordx4 v0, s[20:23], s74 offen offset:0 sc1 lds
v_mfma_f32_16x16x32_bf16 v[168:171], a[128:131], v[68:71], v[168:171]
v_exp_f32 v209, v209
v_mfma_f32_16x16x32_bf16 v[172:175], a[132:135], v[68:71], v[172:175]
ds_read_b128 a[100:103], v1 offset:17408
v_cvt_pk_bf16_f32 v240, v208, v209
v_mfma_f32_16x16x32_bf16 v[140:143], a[132:135], v[64:67], v[140:143]
v_exp_f32 v210, v210
v_mfma_f32_16x16x32_bf16 a[228:231], a[132:135], v[252:255], a[228:231]
buffer_load_dwordx4 v0, s[20:23], s74 offen offset:1024 sc1 lds
v_mfma_f32_16x16x32_bf16 a[4:7], a[132:135], v[248:251], a[4:7]
v_exp_f32 v211, v211
v_mfma_f32_16x16x32_bf16 a[8:11], a[136:139], v[248:251], a[8:11]
ds_read_b128 a[104:107], v1 offset:18432
v_cvt_pk_bf16_f32 v241, v210, v211
v_mfma_f32_16x16x32_bf16 a[232:235], a[136:139], v[252:255], a[232:235]
v_exp_f32 v212, v212
v_mfma_f32_16x16x32_bf16 v[144:147], a[136:139], v[64:67], v[144:147]
buffer_load_dwordx4 v0, s[20:23], s74 offen offset:2048 sc1 lds
v_mfma_f32_16x16x32_bf16 v[176:179], a[136:139], v[68:71], v[176:179]
v_exp_f32 v213, v213
v_mfma_f32_16x16x32_bf16 v[180:183], a[140:143], v[68:71], v[180:183]
ds_read_b128 a[108:111], v1 offset:19456
v_cvt_pk_bf16_f32 v244, v212, v213
v_mfma_f32_16x16x32_bf16 v[148:151], a[140:143], v[64:67], v[148:151]
v_exp_f32 v214, v214
v_mfma_f32_16x16x32_bf16 a[236:239], a[140:143], v[252:255], a[236:239]
buffer_load_dwordx4 v0, s[20:23], s74 offen offset:3072 sc1 lds
v_mfma_f32_16x16x32_bf16 a[12:15], a[140:143], v[248:251], a[12:15]
s_add_u32 s7, s7, 32768
v_exp_f32 v215, v215
v_mfma_f32_16x16x32_bf16 a[16:19], a[144:147], v[248:251], a[16:19]
ds_read_b128 a[112:115], v1 offset:20480
v_cvt_pk_bf16_f32 v245, v214, v215
v_mfma_f32_16x16x32_bf16 a[240:243], a[144:147], v[252:255], a[240:243]
s_add_u32 s8, s8, 16384
v_exp_f32 v216, v216
v_mfma_f32_16x16x32_bf16 v[152:155], a[144:147], v[64:67], v[152:155]
s_and_b32 s8, s8, 0xffff
v_mfma_f32_16x16x32_bf16 v[184:187], a[144:147], v[68:71], v[184:187]
v_exp_f32 v217, v217
v_mfma_f32_16x16x32_bf16 v[188:191], a[148:151], v[68:71], v[188:191]
ds_read_b128 a[116:119], v1 offset:21504
v_cvt_pk_bf16_f32 v234, v216, v217
v_mfma_f32_16x16x32_bf16 v[156:159], a[148:151], v[64:67], v[156:159]
v_exp_f32 v218, v218
v_mfma_f32_16x16x32_bf16 a[244:247], a[148:151], v[252:255], a[244:247]
v_mfma_f32_16x16x32_bf16 a[20:23], a[148:151], v[248:251], a[20:23]
v_exp_f32 v219, v219
v_mfma_f32_16x16x32_bf16 a[24:27], a[152:155], v[248:251], a[24:27]
ds_read_b128 a[120:123], v1 offset:22528
v_cvt_pk_bf16_f32 v235, v218, v219
v_mfma_f32_16x16x32_bf16 a[248:251], a[152:155], v[252:255], a[248:251]
v_exp_f32 v220, v220
v_mfma_f32_16x16x32_bf16 v[160:163], a[152:155], v[64:67], v[160:163]
v_mfma_f32_16x16x32_bf16 v[192:195], a[152:155], v[68:71], v[192:195]
v_exp_f32 v221, v221
v_mfma_f32_16x16x32_bf16 v[196:199], a[156:159], v[68:71], v[196:199]
ds_read_b128 a[124:127], v1 offset:23552
v_cvt_pk_bf16_f32 v238, v220, v221
v_mfma_f32_16x16x32_bf16 v[164:167], a[156:159], v[64:67], v[164:167]
v_exp_f32 v222, v222
v_mfma_f32_16x16x32_bf16 a[252:255], a[156:159], v[252:255], a[252:255]
v_mfma_f32_16x16x32_bf16 a[28:31], a[156:159], v[248:251], a[28:31]
v_exp_f32 v223, v223
v_mfma_f32_16x16x32_bf16 a[176:179], a[184:187], v[248:251], a[176:179]
v_cvt_pk_bf16_f32 v239, v222, v223
v_add_u32 v1, s11, v0
v_mfma_f32_16x16x32_bf16 a[180:183], a[184:187], v[252:255], a[180:183]
v_mfma_f32_16x16x32_bf16 a[168:171], a[184:187], v[64:67], a[168:171]
s_waitcnt lgkmcnt(0)
s_cmp_lg_u32 s13, 0
v_mfma_f32_16x16x32_bf16 a[172:175], a[184:187], v[68:71], a[172:175]
s_cbranch_scc1 LA_l2
LA_l2t:
s_waitcnt lgkmcnt(7)
v_mfma_f32_16x16x32_bf16 v[200:203], a[96:99], a[64:67], v[56:59]
s_waitcnt vmcnt(16) lgkmcnt(0)
s_barrier
v_mfma_f32_16x16x32_bf16 v[200:203], a[100:103], a[68:71], v[200:203]
s_add_u32 s12, s12, 16384
v_exp_f32 v224, v224
v_mfma_f32_16x16x32_bf16 v[200:203], a[104:107], a[72:75], v[200:203]
s_and_b32 s12, s12, 0xffff
s_add_u32 s11, s11, s14
s_xor_b32 s75, s8, 0x8000
v_mfma_f32_16x16x32_bf16 v[200:203], a[108:111], a[76:79], v[200:203]
s_and_b32 s11, s11, 0xffff
v_exp_f32 v225, v225
v_mfma_f32_16x16x32_bf16 v[204:207], a[108:111], a[92:95], v[60:63]
ds_read_b128 a[128:131], v2 offset:0
v_cvt_pk_bf16_f32 v242, v224, v225
v_mfma_f32_16x16x32_bf16 v[204:207], a[104:107], a[88:91], v[204:207]
s_sub_u32 s74, s7, 57344
v_exp_f32 v226, v226
v_mfma_f32_16x16x32_bf16 v[204:207], a[100:103], a[84:87], v[204:207]
s_add_u32 m0, s75, s10
v_mfma_f32_16x16x32_bf16 v[204:207], a[96:99], a[80:83], v[204:207]
v_exp_f32 v227, v227
v_mfma_f32_16x16x32_bf16 v[208:211], a[96:99], a[32:35], v[48:51]
ds_read_b128 a[132:135], v2 offset:1024
v_cvt_pk_bf16_f32 v243, v226, v227
v_mfma_f32_16x16x32_bf16 v[208:211], a[100:103], a[36:39], v[208:211]
v_exp_f32 v228, v228
v_mfma_f32_16x16x32_bf16 v[208:211], a[104:107], a[40:43], v[208:211]
buffer_load_dwordx4 v0, s[20:23], s74 offen offset:0 sc1 lds
v_mfma_f32_16x16x32_bf16 v[208:211], a[108:111], a[44:47], v[208:211]
v_exp_f32 v229, v229
v_mfma_f32_16x16x32_bf16 v[212:215], a[108:111], a[60:63], v[52:55]
ds_read_b128 a[136:139], v2 offset:2048
v_cvt_pk_bf16_f32 v246, v228, v229
v_mfma_f32_16x16x32_bf16 v[212:215], a[104:107], a[56:59], v[212:215]
v_exp_f32 v230, v230
v_mfma_f32_16x16x32_bf16 v[212:215], a[100:103], a[52:55], v[212:215]
buffer_load_dwordx4 v0, s[20:23], s74 offen offset:1024 sc1 lds
v_mfma_f32_16x16x32_bf16 v[212:215], a[96:99], a[48:51], v[212:215]
v_exp_f32 v231, v231
v_mfma_f32_16x16x32_bf16 v[216:219], a[112:115], a[64:67], v[56:59]
ds_read_b128 a[140:143], v2 offset:3072
v_cvt_pk_bf16_f32 v247, v230, v231
v_mfma_f32_16x16x32_bf16 v[216:219], a[116:119], a[68:71], v[216:219]
v_exp_f32 v200, v200
v_mfma_f32_16x16x32_bf16 v[216:219], a[120:123], a[72:75], v[216:219]
buffer_load_dwordx4 v0, s[20:23], s74 offen offset:2048 sc1 lds
v_mfma_f32_16x16x32_bf16 v[216:219], a[124:127], a[76:79], v[216:219]
v_exp_f32 v201, v201
v_mfma_f32_16x16x32_bf16 v[220:223], a[124:127], a[92:95], v[60:63]
ds_read_b128 a[144:147], v2 offset:4096
v_cvt_pk_bf16_f32 v248, v200, v201
v_mfma_f32_16x16x32_bf16 v[220:223], a[120:123], a[88:91], v[220:223]
v_exp_f32 v202, v202
v_mfma_f32_16x16x32_bf16 v[220:223], a[116:119], a[84:87], v[220:223]
buffer_load_dwordx4 v0, s[20:23], s74 offen offset:3072 sc1 lds
v_mfma_f32_16x16x32_bf16 v[220:223], a[112:115], a[80:83], v[220:223]
v_exp_f32 v203, v203
v_mfma_f32_16x16x32_bf16 v[224:227], a[112:115], a[32:35], v[48:51]
ds_read_b128 a[148:151], v2 offset:5120
v_cvt_pk_bf16_f32 v249, v202, v203
v_mfma_f32_16x16x32_bf16 v[224:227], a[116:119], a[36:39], v[224:227]
v_exp_f32 v204, v204
v_mfma_f32_16x16x32_bf16 v[224:227], a[120:123], a[40:43], v[224:227]
buffer_load_dwordx4 a[192:195], v0, s[76:79], s96 offen offset:0 sc1
v_mfma_f32_16x16x32_bf16 v[224:227], a[124:127], a[44:47], v[224:227]
v_exp_f32 v205, v205
v_mfma_f32_16x16x32_bf16 v[228:231], a[124:127], a[60:63], v[52:55]
ds_read_b128 a[152:155], v2 offset:6144
v_cvt_pk_bf16_f32 v252, v204, v205
v_mfma_f32_16x16x32_bf16 v[228:231], a[120:123], a[56:59], v[228:231]
v_exp_f32 v206, v206
v_mfma_f32_16x16x32_bf16 v[228:231], a[116:119], a[52:55], v[228:231]
buffer_load_dwordx4 a[196:199], v0, s[76:79], s97 offen offset:0 sc1
v_mfma_f32_16x16x32_bf16 v[228:231], a[112:115], a[48:51], v[228:231]
s_waitcnt lgkmcnt(6)
v_exp_f32 v207, v207
v_mfma_f32_16x16x32_bf16 a[0:3], a[128:131], v[232:235], a[0:3]
ds_read_b128 a[156:159], v2 offset:7168
v_cvt_pk_bf16_f32 v253, v206, v207
v_mfma_f32_16x16x32_bf16 a[224:227], a[128:131], v[236:239], a[224:227]
v_exp_f32 v208, v208
v_mfma_f32_16x16x32_bf16 v[136:139], a[128:131], v[240:243], v[136:139]
ds_read_b128 a[96:99], v1 offset:16384
v_mfma_f32_16x16x32_bf16 v[168:171], a[128:131], v[244:247], v[168:171]
s_waitcnt lgkmcnt(7)
v_exp_f32 v209, v209
v_mfma_f32_16x16x32_bf16 v[172:175], a[132:135], v[244:247], v[172:175]
v_cvt_pk_bf16_f32 v64, v208, v209
v_add_u32 v2, s12, v3
v_mfma_f32_16x16x32_bf16 v[140:143], a[132:135], v[240:243], v[140:143]
v_exp_f32 v210, v210
v_mfma_f32_16x16x32_bf16 a[228:231], a[132:135], v[236:239], a[228:231]
ds_read_b128 a[100:103], v1 offset:17408
v_mfma_f32_16x16x32_bf16 a[4:7], a[132:135], v[232:235], a[4:7]
s_waitcnt lgkmcnt(7)
v_exp_f32 v211, v211
v_mfma_f32_16x16x32_bf16 a[8:11], a[136:139], v[232:235], a[8:11]
ds_read_b128 a[104:107], v1 offset:18432
v_cvt_pk_bf16_f32 v65, v210, v211
v_mfma_f32_16x16x32_bf16 a[232:235], a[136:139], v[236:239], a[232:235]
v_exp_f32 v212, v212
v_mfma_f32_16x16x32_bf16 v[144:147], a[136:139], v[240:243], v[144:147]
buffer_load_dwordx4 a[200:203], v0, s[76:79], s98 offen offset:0 sc1
v_mfma_f32_16x16x32_bf16 v[176:179], a[136:139], v[244:247], v[176:179]
s_waitcnt lgkmcnt(7)
v_exp_f32 v213, v213
v_mfma_f32_16x16x32_bf16 v[180:183], a[140:143], v[244:247], v[180:183]
ds_read_b128 a[108:111], v1 offset:19456
v_cvt_pk_bf16_f32 v68, v212, v213
v_mfma_f32_16x16x32_bf16 v[148:151], a[140:143], v[240:243], v[148:151]
v_exp_f32 v214, v214
v_mfma_f32_16x16x32_bf16 a[236:239], a[140:143], v[236:239], a[236:239]
buffer_load_dwordx4 a[204:207], v0, s[76:79], s99 offen offset:0 sc1
v_mfma_f32_16x16x32_bf16 a[12:15], a[140:143], v[232:235], a[12:15]
s_waitcnt lgkmcnt(7)
v_exp_f32 v215, v215
v_mfma_f32_16x16x32_bf16 a[16:19], a[144:147], v[232:235], a[16:19]
ds_read_b128 a[112:115], v1 offset:20480
v_cvt_pk_bf16_f32 v69, v214, v215
v_mfma_f32_16x16x32_bf16 a[240:243], a[144:147], v[236:239], a[240:243]
v_exp_f32 v216, v216
v_mfma_f32_16x16x32_bf16 v[152:155], a[144:147], v[240:243], v[152:155]
buffer_load_dwordx4 a[208:211], v0, s[76:79], s96 offen offset:1024 sc1
v_mfma_f32_16x16x32_bf16 v[184:187], a[144:147], v[244:247], v[184:187]
s_waitcnt lgkmcnt(7)
v_exp_f32 v217, v217
v_mfma_f32_16x16x32_bf16 v[188:191], a[148:151], v[244:247], v[188:191]
ds_read_b128 a[116:119], v1 offset:21504
v_cvt_pk_bf16_f32 v250, v216, v217
v_mfma_f32_16x16x32_bf16 v[156:159], a[148:151], v[240:243], v[156:159]
v_exp_f32 v218, v218
v_mfma_f32_16x16x32_bf16 a[244:247], a[148:151], v[236:239], a[244:247]
buffer_load_dwordx4 a[212:215], v0, s[76:79], s97 offen offset:1024 sc1
v_mfma_f32_16x16x32_bf16 a[20:23], a[148:151], v[232:235], a[20:23]
s_waitcnt lgkmcnt(7)
v_exp_f32 v219, v219
v_mfma_f32_16x16x32_bf16 a[24:27], a[152:155], v[232:235], a[24:27]
ds_read_b128 a[120:123], v1 offset:22528
v_cvt_pk_bf16_f32 v251, v218, v219
v_mfma_f32_16x16x32_bf16 a[248:251], a[152:155], v[236:239], a[248:251]
v_exp_f32 v220, v220
v_mfma_f32_16x16x32_bf16 v[160:163], a[152:155], v[240:243], v[160:163]
buffer_load_dwordx4 a[216:219], v0, s[76:79], s98 offen offset:1024 sc1
v_mfma_f32_16x16x32_bf16 v[192:195], a[152:155], v[244:247], v[192:195]
s_waitcnt lgkmcnt(7)
v_exp_f32 v221, v221
v_mfma_f32_16x16x32_bf16 v[196:199], a[156:159], v[244:247], v[196:199]
ds_read_b128 a[124:127], v1 offset:23552
v_cvt_pk_bf16_f32 v254, v220, v221
v_mfma_f32_16x16x32_bf16 v[164:167], a[156:159], v[240:243], v[164:167]
v_exp_f32 v222, v222
v_mfma_f32_16x16x32_bf16 a[252:255], a[156:159], v[236:239], a[252:255]
buffer_load_dwordx4 a[220:223], v0, s[76:79], s99 offen offset:1024 sc1
v_mfma_f32_16x16x32_bf16 a[28:31], a[156:159], v[232:235], a[28:31]
v_exp_f32 v223, v223
v_mfma_f32_16x16x32_bf16 a[176:179], a[184:187], v[232:235], a[176:179]
v_cvt_pk_bf16_f32 v255, v222, v223
v_add_u32 v1, s11, v0
v_mfma_f32_16x16x32_bf16 a[180:183], a[184:187], v[236:239], a[180:183]
v_exp_f32 v224, v224
v_mfma_f32_16x16x32_bf16 a[168:171], a[184:187], v[240:243], a[168:171]
v_mfma_f32_16x16x32_bf16 a[172:175], a[184:187], v[244:247], a[172:175]
v_exp_f32 v225, v225
s_nop 0
v_cvt_pk_bf16_f32 v66, v224, v225
s_waitcnt vmcnt(12)
s_mov_b32 exec_lo, s87
s_mov_b32 exec_hi, 0
buffer_store_dword v3, off, s[76:79], s43 offset:16 sc1
s_mov_b64 exec, -1
buffer_load_dword v38, v30, s[76:79], s88 offen sc1
buffer_load_dword v38, v30, s[76:79], s89 offen sc1
s_cmp_eq_u32 s80, 0
s_cbranch_scc1 LA_d10
s_cmp_eq_u32 s80, 1
s_cbranch_scc1 LA_d11
s_cmp_eq_u32 s80, 2
s_cbranch_scc1 LA_d12
s_branch LA_d13
LA_p6_s:
s_sleep 2
v_bfe_u32 v20, v0, 2, 7
buffer_load_dword v20, v20, s[76:79], s42 offen offset:128 sc1
s_waitcnt vmcnt(0)
v_cmp_lt_u32 s[32:33], 0, v20
s_nop 0
s_andn2_b32 s33, 65535, s32
s_cbranch_scc1 LA_p6_s
s_branch LA_p6
LA_p2_s:
s_sleep 2
v_bfe_u32 v20, v0, 2, 7
buffer_load_dword v20, v20, s[76:79], s40 offen offset:0 sc1
s_waitcnt vmcnt(0)
v_cmp_lt_u32 s[32:33], 0, v20
s_nop 0
s_andn2_b32 s33, 65280, s32
s_cbranch_scc1 LA_p2_s
s_branch LA_p2
LA_ssm:
v_lshrrev_b32 v225, 8, v0
s_lshl_b32 s35, s80, 8
v_lshl_add_u32 v21, v225, 6, s35
ds_read_b128 v[208:211], v21 offset:6144
ds_read_b128 v[212:215], v21 offset:6160
ds_read_b128 v[216:219], v21 offset:6176
ds_read_b128 v[220:223], v21 offset:6192
s_waitcnt vmcnt(10)
v_pk_fma_f32 v[26:27], v[24:25], v[8:9], v[26:27] op_sel_hi:[1,0,1]
v_and_b32 v21, 0x78, v22
v_pk_fma_f32 v[26:27], v[24:25], v[8:9], v[26:27] op_sel:[1,1,0] op_sel_hi:[0,1,1] neg_lo:[0,1,0]
v_add_u32 v22, s93, v22
s_waitcnt vmcnt(9)
v_pk_fma_f32 v[28:29], v[26:27], v[8:9], v[28:29] op_sel_hi:[1,0,1]
v_add_u32 v21, s93, v21
v_pk_fma_f32 v[28:29], v[26:27], v[8:9], v[28:29] op_sel:[1,1,0] op_sel_hi:[0,1,1] neg_lo:[0,1,0]
v_bfe_u32 v64, v0, 4, 4
s_waitcnt vmcnt(8)
v_pk_fma_f32 v[30:31], v[28:29], v[8:9], v[30:31] op_sel_hi:[1,0,1]
v_mul_u32_u24 v224, 144, v64
v_pk_fma_f32 v[30:31], v[28:29], v[8:9], v[30:31] op_sel:[1,1,0] op_sel_hi:[0,1,1] neg_lo:[0,1,0]
v_lshl_add_u32 v224, v225, 5, v224
s_waitcnt vmcnt(7)
v_pk_fma_f32 v[32:33], v[30:31], v[8:9], v[32:33] op_sel_hi:[1,0,1]
v_add_u32 v224, s93, v224
v_pk_fma_f32 v[32:33], v[30:31], v[8:9], v[32:33] op_sel:[1,1,0] op_sel_hi:[0,1,1] neg_lo:[0,1,0]
v_lshrrev_b32 v65, 2, v64
s_waitcnt vmcnt(6)
v_pk_fma_f32 v[34:35], v[32:33], v[8:9], v[34:35] op_sel_hi:[1,0,1]
v_lshl_add_u32 v225, v225, 3, v65
v_pk_fma_f32 v[34:35], v[32:33], v[8:9], v[34:35] op_sel:[1,1,0] op_sel_hi:[0,1,1] neg_lo:[0,1,0]
v_mul_u32_u24 v225, 144, v225
s_waitcnt vmcnt(5)
v_pk_fma_f32 v[36:37], v[34:35], v[8:9], v[36:37] op_sel_hi:[1,0,1]
v_and_b32 v64, 3, v64
v_pk_fma_f32 v[36:37], v[34:35], v[8:9], v[36:37] op_sel:[1,1,0] op_sel_hi:[0,1,1] neg_lo:[0,1,0]
v_lshl_add_u32 v225, v64, 3, v225
s_waitcnt vmcnt(4)
v_pk_fma_f32 v[38:39], v[36:37], v[8:9], v[38:39] op_sel_hi:[1,0,1]
v_add_u32 v225, s93, v225
v_pk_fma_f32 v[38:39], v[36:37], v[8:9], v[38:39] op_sel:[1,1,0] op_sel_hi:[0,1,1] neg_lo:[0,1,0]
s_mul_i32 s34, s84, 2621440
ds_write_b64 v22, v[38:39]
ds_read_b64 v[200:201], v21 offset:0
ds_read_b64 v[202:203], v21 offset:128
ds_read_b64 v[204:205], v21 offset:256
ds_read_b64 v[206:207], v21 offset:384
s_lshl_b32 s35, s85, 10
s_add_u32 s34, s34, s35
s_mul_i32 s35, s92, 81920
s_add_u32 s34, s34, s35
v_accvgpr_read_b32 v36, a188
v_accvgpr_read_b32 v37, a189
v_accvgpr_read_b32 v24, a192
v_accvgpr_read_b32 v25, a196
v_accvgpr_read_b32 v26, a193
v_accvgpr_read_b32 v27, a197
v_accvgpr_read_b32 v28, a194
v_accvgpr_read_b32 v29, a198
s_waitcnt lgkmcnt(2)
v_pk_fma_f32 v[202:203], v[200:201], v[14:15], v[202:203] op_sel_hi:[1,0,1]
v_pk_fma_f32 v[202:203], v[200:201], v[14:15], v[202:203] op_sel:[1,1,0] op_sel_hi:[0,1,1] neg_lo:[0,1,0]
s_waitcnt lgkmcnt(1)
v_pk_fma_f32 v[204:205], v[202:203], v[14:15], v[204:205] op_sel_hi:[1,0,1]
v_pk_fma_f32 v[204:205], v[202:203], v[14:15], v[204:205] op_sel:[1,1,0] op_sel_hi:[0,1,1] neg_lo:[0,1,0]
s_waitcnt lgkmcnt(0)
v_pk_fma_f32 v[206:207], v[204:205], v[14:15], v[206:207] op_sel_hi:[1,0,1]
v_pk_fma_f32 v[206:207], v[204:205], v[14:15], v[206:207] op_sel:[1,1,0] op_sel_hi:[0,1,1] neg_lo:[0,1,0]
s_lshl_b64 exec, -1, 16
v_pk_mul_f32 v[204:205], v[206:207], v[12:13] op_sel_hi:[1,0]
v_pk_fma_f32 v[206:207], v[206:207], v[12:13], v[204:205] op_sel:[1,1,0] op_sel_hi:[0,1,1] neg_lo:[0,1,0]
s_lshl_b64 exec, -1, 32
v_pk_mul_f32 v[204:205], v[206:207], v[12:13] op_sel_hi:[1,0]
v_pk_fma_f32 v[206:207], v[206:207], v[12:13], v[204:205] op_sel:[1,1,0] op_sel_hi:[0,1,1] neg_lo:[0,1,0]
s_lshl_b64 exec, -1, 48
v_pk_mul_f32 v[204:205], v[206:207], v[12:13] op_sel_hi:[1,0]
v_pk_fma_f32 v[206:207], v[206:207], v[12:13], v[204:205] op_sel:[1,1,0] op_sel_hi:[0,1,1] neg_lo:[0,1,0]
s_mov_b64 exec, -1
v_pk_add_f32 v[30:31], v[206:207], v[36:37]
v_pk_fma_f32 v[24:25], v[30:31], v[10:11], v[24:25] op_sel_hi:[1,0,1]
v_pk_fma_f32 v[24:25], v[30:31], v[10:11], v[24:25] op_sel:[1,1,0] op_sel_hi:[0,1,1] neg_lo:[0,1,0]
v_pk_fma_f32 v[26:27], v[24:25], v[10:11], v[26:27] op_sel_hi:[1,0,1]
v_pk_mul_f32 v[32:33], v[24:25], v[16:17] op_sel_hi:[1,0] neg_hi:[0,1]
v_accvgpr_read_b32 v30, a195
v_pk_fma_f32 v[26:27], v[24:25], v[10:11], v[26:27] op_sel:[1,1,0] op_sel_hi:[0,1,1] neg_lo:[0,1,0]
v_pk_fma_f32 v[32:33], v[24:25], v[16:17], v[32:33] op_sel:[1,1,0] op_sel_hi:[0,1,1] neg_lo:[0,1,0] neg_hi:[0,1,0]
v_accvgpr_read_b32 v31, a199
v_pk_mul_f32 v[32:33], v[32:33], v[208:209] op_sel:[0,0] op_sel_hi:[1,0]
v_pk_fma_f32 v[28:29], v[26:27], v[10:11], v[28:29] op_sel_hi:[1,0,1]
v_pk_mul_f32 v[34:35], v[26:27], v[16:17] op_sel_hi:[1,0] neg_hi:[0,1]
v_accvgpr_read_b32 v24, a200
v_pk_fma_f32 v[28:29], v[26:27], v[10:11], v[28:29] op_sel:[1,1,0] op_sel_hi:[0,1,1] neg_lo:[0,1,0]
v_pk_fma_f32 v[34:35], v[26:27], v[16:17], v[34:35] op_sel:[1,1,0] op_sel_hi:[0,1,1] neg_lo:[0,1,0] neg_hi:[0,1,0]
v_accvgpr_read_b32 v25, a204
v_pk_mul_f32 v[34:35], v[34:35], v[208:209] op_sel:[0,1] op_sel_hi:[1,1]
v_cvt_pk_bf16_f32 v248, v32, v34
v_cvt_pk_bf16_f32 v64, v33, v35
v_pk_fma_f32 v[30:31], v[28:29], v[10:11], v[30:31] op_sel_hi:[1,0,1]
v_pk_mul_f32 v[36:37], v[28:29], v[16:17] op_sel_hi:[1,0] neg_hi:[0,1]
v_accvgpr_read_b32 v26, a201
v_pk_fma_f32 v[30:31], v[28:29], v[10:11], v[30:31] op_sel:[1,1,0] op_sel_hi:[0,1,1] neg_lo:[0,1,0]
v_pk_fma_f32 v[36:37], v[28:29], v[16:17], v[36:37] op_sel:[1,1,0] op_sel_hi:[0,1,1] neg_lo:[0,1,0] neg_hi:[0,1,0]
v_accvgpr_read_b32 v27, a205
v_pk_mul_f32 v[36:37], v[36:37], v[210:211] op_sel:[0,0] op_sel_hi:[1,0]
v_pk_fma_f32 v[24:25], v[30:31], v[10:11], v[24:25] op_sel_hi:[1,0,1]
v_pk_mul_f32 v[38:39], v[30:31], v[16:17] op_sel_hi:[1,0] neg_hi:[0,1]
v_accvgpr_read_b32 v28, a202
v_pk_fma_f32 v[24:25], v[30:31], v[10:11], v[24:25] op_sel:[1,1,0] op_sel_hi:[0,1,1] neg_lo:[0,1,0]
v_pk_fma_f32 v[38:39], v[30:31], v[16:17], v[38:39] op_sel:[1,1,0] op_sel_hi:[0,1,1] neg_lo:[0,1,0] neg_hi:[0,1,0]
v_accvgpr_read_b32 v29, a206
v_pk_mul_f32 v[38:39], v[38:39], v[210:211] op_sel:[0,1] op_sel_hi:[1,1]
v_cvt_pk_bf16_f32 v249, v36, v38
v_cvt_pk_bf16_f32 v65, v37, v39
v_pk_fma_f32 v[26:27], v[24:25], v[10:11], v[26:27] op_sel_hi:[1,0,1]
v_pk_mul_f32 v[32:33], v[24:25], v[16:17] op_sel_hi:[1,0] neg_hi:[0,1]
v_accvgpr_read_b32 v30, a203
v_pk_fma_f32 v[26:27], v[24:25], v[10:11], v[26:27] op_sel:[1,1,0] op_sel_hi:[0,1,1] neg_lo:[0,1,0]
v_pk_fma_f32 v[32:33], v[24:25], v[16:17], v[32:33] op_sel:[1,1,0] op_sel_hi:[0,1,1] neg_lo:[0,1,0] neg_hi:[0,1,0]
v_accvgpr_read_b32 v31, a207
v_pk_mul_f32 v[32:33], v[32:33], v[212:213] op_sel:[0,0] op_sel_hi:[1,0]
v_pk_fma_f32 v[28:29], v[26:27], v[10:11], v[28:29] op_sel_hi:[1,0,1]
v_pk_mul_f32 v[34:35], v[26:27], v[16:17] op_sel_hi:[1,0] neg_hi:[0,1]
v_accvgpr_read_b32 v24, a208
v_pk_fma_f32 v[28:29], v[26:27], v[10:11], v[28:29] op_sel:[1,1,0] op_sel_hi:[0,1,1] neg_lo:[0,1,0]
v_pk_fma_f32 v[34:35], v[26:27], v[16:17], v[34:35] op_sel:[1,1,0] op_sel_hi:[0,1,1] neg_lo:[0,1,0] neg_hi:[0,1,0]
v_accvgpr_read_b32 v25, a212
v_pk_mul_f32 v[34:35], v[34:35], v[212:213] op_sel:[0,1] op_sel_hi:[1,1]
v_cvt_pk_bf16_f32 v250, v32, v34
v_cvt_pk_bf16_f32 v66, v33, v35
v_pk_fma_f32 v[30:31], v[28:29], v[10:11], v[30:31] op_sel_hi:[1,0,1]
v_pk_mul_f32 v[36:37], v[28:29], v[16:17] op_sel_hi:[1,0] neg_hi:[0,1]
v_accvgpr_read_b32 v26, a209
v_pk_fma_f32 v[30:31], v[28:29], v[10:11], v[30:31] op_sel:[1,1,0] op_sel_hi:[0,1,1] neg_lo:[0,1,0]
v_pk_fma_f32 v[36:37], v[28:29], v[16:17], v[36:37] op_sel:[1,1,0] op_sel_hi:[0,1,1] neg_lo:[0,1,0] neg_hi:[0,1,0]
v_accvgpr_read_b32 v27, a213
v_pk_mul_f32 v[36:37], v[36:37], v[214:215] op_sel:[0,0] op_sel_hi:[1,0]
v_pk_fma_f32 v[24:25], v[30:31], v[10:11], v[24:25] op_sel_hi:[1,0,1]
v_pk_mul_f32 v[38:39], v[30:31], v[16:17] op_sel_hi:[1,0] neg_hi:[0,1]
v_accvgpr_read_b32 v28, a210
v_pk_fma_f32 v[24:25], v[30:31], v[10:11], v[24:25] op_sel:[1,1,0] op_sel_hi:[0,1,1] neg_lo:[0,1,0]
v_pk_fma_f32 v[38:39], v[30:31], v[16:17], v[38:39] op_sel:[1,1,0] op_sel_hi:[0,1,1] neg_lo:[0,1,0] neg_hi:[0,1,0]
v_accvgpr_read_b32 v29, a214
v_pk_mul_f32 v[38:39], v[38:39], v[214:215] op_sel:[0,1] op_sel_hi:[1,1]
v_cvt_pk_bf16_f32 v251, v36, v38
v_cvt_pk_bf16_f32 v67, v37, v39
ds_write_b128 v224, v[248:251] offset:1024
ds_write_b128 v224, v[64:67] offset:3328
v_pk_fma_f32 v[26:27], v[24:25], v[10:11], v[26:27] op_sel_hi:[1,0,1]
v_pk_mul_f32 v[32:33], v[24:25], v[16:17] op_sel_hi:[1,0] neg_hi:[0,1]
v_accvgpr_read_b32 v30, a211
v_pk_fma_f32 v[26:27], v[24:25], v[10:11], v[26:27] op_sel:[1,1,0] op_sel_hi:[0,1,1] neg_lo:[0,1,0]
v_pk_fma_f32 v[32:33], v[24:25], v[16:17], v[32:33] op_sel:[1,1,0] op_sel_hi:[0,1,1] neg_lo:[0,1,0] neg_hi:[0,1,0]
v_accvgpr_read_b32 v31, a215
v_pk_mul_f32 v[32:33], v[32:33], v[216:217] op_sel:[0,0] op_sel_hi:[1,0]
v_pk_fma_f32 v[28:29], v[26:27], v[10:11], v[28:29] op_sel_hi:[1,0,1]
v_pk_mul_f32 v[34:35], v[26:27], v[16:17] op_sel_hi:[1,0] neg_hi:[0,1]
v_accvgpr_read_b32 v24, a216
v_pk_fma_f32 v[28:29], v[26:27], v[10:11], v[28:29] op_sel:[1,1,0] op_sel_hi:[0,1,1] neg_lo:[0,1,0]
v_pk_fma_f32 v[34:35], v[26:27], v[16:17], v[34:35] op_sel:[1,1,0] op_sel_hi:[0,1,1] neg_lo:[0,1,0] neg_hi:[0,1,0]
v_accvgpr_read_b32 v25, a220
v_pk_mul_f32 v[34:35], v[34:35], v[216:217] op_sel:[0,1] op_sel_hi:[1,1]
v_cvt_pk_bf16_f32 v252, v32, v34
v_cvt_pk_bf16_f32 v68, v33, v35
v_pk_fma_f32 v[30:31], v[28:29], v[10:11], v[30:31] op_sel_hi:[1,0,1]
v_pk_mul_f32 v[36:37], v[28:29], v[16:17] op_sel_hi:[1,0] neg_hi:[0,1]
v_accvgpr_read_b32 v26, a217
v_pk_fma_f32 v[30:31], v[28:29], v[10:11], v[30:31] op_sel:[1,1,0] op_sel_hi:[0,1,1] neg_lo:[0,1,0]
v_pk_fma_f32 v[36:37], v[28:29], v[16:17], v[36:37] op_sel:[1,1,0] op_sel_hi:[0,1,1] neg_lo:[0,1,0] neg_hi:[0,1,0]
v_accvgpr_read_b32 v27, a221
v_pk_mul_f32 v[36:37], v[36:37], v[218:219] op_sel:[0,0] op_sel_hi:[1,0]
v_pk_fma_f32 v[24:25], v[30:31], v[10:11], v[24:25] op_sel_hi:[1,0,1]
v_pk_mul_f32 v[38:39], v[30:31], v[16:17] op_sel_hi:[1,0] neg_hi:[0,1]
v_accvgpr_read_b32 v28, a218
v_pk_fma_f32 v[24:25], v[30:31], v[10:11], v[24:25] op_sel:[1,1,0] op_sel_hi:[0,1,1] neg_lo:[0,1,0]
v_pk_fma_f32 v[38:39], v[30:31], v[16:17], v[38:39] op_sel:[1,1,0] op_sel_hi:[0,1,1] neg_lo:[0,1,0] neg_hi:[0,1,0]
v_accvgpr_read_b32 v29, a222
v_pk_mul_f32 v[38:39], v[38:39], v[218:219] op_sel:[0,1] op_sel_hi:[1,1]
v_cvt_pk_bf16_f32 v253, v36, v38
v_cvt_pk_bf16_f32 v69, v37, v39
v_pk_fma_f32 v[26:27], v[24:25], v[10:11], v[26:27] op_sel_hi:[1,0,1]
v_pk_mul_f32 v[32:33], v[24:25], v[16:17] op_sel_hi:[1,0] neg_hi:[0,1]
v_accvgpr_read_b32 v30, a219
v_pk_fma_f32 v[26:27], v[24:25], v[10:11], v[26:27] op_sel:[1,1,0] op_sel_hi:[0,1,1] neg_lo:[0,1,0]
v_pk_fma_f32 v[32:33], v[24:25], v[16:17], v[32:33] op_sel:[1,1,0] op_sel_hi:[0,1,1] neg_lo:[0,1,0] neg_hi:[0,1,0]
v_accvgpr_read_b32 v31, a223
v_pk_mul_f32 v[32:33], v[32:33], v[220:221] op_sel:[0,0] op_sel_hi:[1,0]
v_pk_fma_f32 v[28:29], v[26:27], v[10:11], v[28:29] op_sel_hi:[1,0,1]
v_pk_mul_f32 v[34:35], v[26:27], v[16:17] op_sel_hi:[1,0] neg_hi:[0,1]
v_pk_fma_f32 v[28:29], v[26:27], v[10:11], v[28:29] op_sel:[1,1,0] op_sel_hi:[0,1,1] neg_lo:[0,1,0]
v_pk_fma_f32 v[34:35], v[26:27], v[16:17], v[34:35] op_sel:[1,1,0] op_sel_hi:[0,1,1] neg_lo:[0,1,0] neg_hi:[0,1,0]
v_pk_mul_f32 v[34:35], v[34:35], v[220:221] op_sel:[0,1] op_sel_hi:[1,1]
v_cvt_pk_bf16_f32 v254, v32, v34
v_cvt_pk_bf16_f32 v70, v33, v35
v_pk_fma_f32 v[30:31], v[28:29], v[10:11], v[30:31] op_sel_hi:[1,0,1]
v_pk_mul_f32 v[36:37], v[28:29], v[16:17] op_sel_hi:[1,0] neg_hi:[0,1]
v_pk_fma_f32 v[30:31], v[28:29], v[10:11], v[30:31] op_sel:[1,1,0] op_sel_hi:[0,1,1] neg_lo:[0,1,0]
v_pk_fma_f32 v[36:37], v[28:29], v[16:17], v[36:37] op_sel:[1,1,0] op_sel_hi:[0,1,1] neg_lo:[0,1,0] neg_hi:[0,1,0]
v_pk_mul_f32 v[36:37], v[36:37], v[222:223] op_sel:[0,0] op_sel_hi:[1,0]
v_pk_mul_f32 v[38:39], v[30:31], v[16:17] op_sel_hi:[1,0] neg_hi:[0,1]
v_pk_fma_f32 v[38:39], v[30:31], v[16:17], v[38:39] op_sel:[1,1,0] op_sel_hi:[0,1,1] neg_lo:[0,1,0] neg_hi:[0,1,0]
v_pk_mul_f32 v[38:39], v[38:39], v[222:223] op_sel:[0,1] op_sel_hi:[1,1]
v_cvt_pk_bf16_f32 v255, v36, v38
v_cvt_pk_bf16_f32 v71, v37, v39
ds_write_b128 v224, v[252:255] offset:1040
ds_write_b128 v224, v[68:71] offset:3344
ds_read_b64_tr_b16 v[200:201], v225 offset:1024
ds_read_b64_tr_b16 v[202:203], v225 offset:1600
ds_read_b64_tr_b16 v[204:205], v225 offset:1056
ds_read_b64_tr_b16 v[206:207], v225 offset:1632
ds_read_b64_tr_b16 v[208:209], v225 offset:1088
ds_read_b64_tr_b16 v[210:211], v225 offset:1664
ds_read_b64_tr_b16 v[212:213], v225 offset:1120
ds_read_b64_tr_b16 v[214:215], v225 offset:1696
s_add_u32 s35, s34, 33570816
s_waitcnt lgkmcnt(6)
buffer_store_dwordx4 v[200:203], v0, s[76:79], s35 offen sc1
s_add_u32 s35, s34, 33591296
s_waitcnt lgkmcnt(4)
buffer_store_dwordx4 v[204:207], v0, s[76:79], s35 offen sc1
s_add_u32 s35, s34, 33611776
s_waitcnt lgkmcnt(2)
buffer_store_dwordx4 v[208:211], v0, s[76:79], s35 offen sc1
s_add_u32 s35, s34, 33632256
s_waitcnt lgkmcnt(0)
buffer_store_dwordx4 v[212:215], v0, s[76:79], s35 offen sc1
s_cmp_eq_u32 s80, 0
s_cbranch_scc1 LA_c30
s_cmp_eq_u32 s80, 1
s_cbranch_scc1 LA_c31
s_cmp_eq_u32 s80, 2
s_cbranch_scc1 LA_c32
s_branch LA_c33
LA_pm0:
s_waitcnt lgkmcnt(7)
v_mfma_f32_16x16x32_bf16 v[200:203], a[96:99], a[0:3], v[40:43]
s_waitcnt vmcnt(63) lgkmcnt(0)
s_barrier
v_mfma_f32_16x16x32_bf16 v[200:203], a[100:103], a[4:7], v[200:203]
s_add_u32 s11, s11, 8192
v_bfe_u32 v20, v0, 2, 7
v_mfma_f32_16x16x32_bf16 v[200:203], a[104:107], a[8:11], v[200:203]
s_and_b32 s11, s11, 0xffff
ds_read_b128 a[64:67], v23 offset:0
v_mfma_f32_16x16x32_bf16 v[200:203], a[108:111], a[12:15], v[200:203]
buffer_load_dword v20, v20, s[76:79], s40 offen offset:0 sc1
v_mfma_f32_16x16x32_bf16 v[204:207], a[108:111], a[28:31], v[44:47]
s_add_u32 m0, s5, s6
ds_read_b128 a[68:71], v23 offset:1024
v_mfma_f32_16x16x32_bf16 v[204:207], a[104:107], a[24:27], v[204:207]
buffer_load_dwordx4 v0, s[20:23], s4 offen offset:0 sc1 lds
v_mfma_f32_16x16x32_bf16 v[204:207], a[100:103], a[20:23], v[204:207]
ds_read_b128 a[72:75], v23 offset:2048
v_mfma_f32_16x16x32_bf16 v[204:207], a[96:99], a[16:19], v[204:207]
v_exp_f32 v200, v200
v_mfma_f32_16x16x32_bf16 v[208:211], a[96:99], a[32:35], v[48:51]
v_exp_f32 v201, v201
v_mfma_f32_16x16x32_bf16 v[208:211], a[100:103], a[36:39], v[208:211]
v_cvt_pk_bf16_f32 v232, v200, v201
v_and_b32 v232, v232, v18
v_mfma_f32_16x16x32_bf16 v[208:211], a[104:107], a[40:43], v[208:211]
v_exp_f32 v202, v202
v_mfma_f32_16x16x32_bf16 v[208:211], a[108:111], a[44:47], v[208:211]
v_exp_f32 v203, v203
v_mfma_f32_16x16x32_bf16 v[212:215], a[108:111], a[60:63], v[52:55]
v_cvt_pk_bf16_f32 v233, v202, v203
v_and_b32 v233, v233, v19
v_mfma_f32_16x16x32_bf16 v[212:215], a[104:107], a[56:59], v[212:215]
v_exp_f32 v204, v204
v_mfma_f32_16x16x32_bf16 v[212:215], a[100:103], a[52:55], v[212:215]
v_exp_f32 v205, v205
v_mfma_f32_16x16x32_bf16 v[212:215], a[96:99], a[48:51], v[212:215]
ds_read_b128 a[96:99], v1 offset:16384
v_cvt_pk_bf16_f32 v236, v204, v205
v_mfma_f32_16x16x32_bf16 v[220:223], a[112:115], a[16:19], v[44:47]
v_exp_f32 v206, v206
v_mfma_f32_16x16x32_bf16 v[220:223], a[116:119], a[20:23], v[220:223]
v_exp_f32 v207, v207
v_mfma_f32_16x16x32_bf16 v[220:223], a[120:123], a[24:27], v[220:223]
ds_read_b128 a[100:103], v1 offset:17408
v_cvt_pk_bf16_f32 v237, v206, v207
v_mfma_f32_16x16x32_bf16 v[220:223], a[124:127], a[28:31], v[220:223]
v_exp_f32 v208, v208
v_mfma_f32_16x16x32_bf16 v[224:227], a[124:127], a[44:47], v[48:51]
v_exp_f32 v209, v209
v_mfma_f32_16x16x32_bf16 v[224:227], a[120:123], a[40:43], v[224:227]
ds_read_b128 a[104:107], v1 offset:18432
v_cvt_pk_bf16_f32 v240, v208, v209
v_mfma_f32_16x16x32_bf16 v[224:227], a[116:119], a[36:39], v[224:227]
v_exp_f32 v210, v210
v_mfma_f32_16x16x32_bf16 v[224:227], a[112:115], a[32:35], v[224:227]
v_exp_f32 v211, v211
v_mfma_f32_16x16x32_bf16 v[228:231], a[112:115], a[48:51], v[52:55]
ds_read_b128 a[108:111], v1 offset:19456
v_cvt_pk_bf16_f32 v241, v210, v211
v_mfma_f32_16x16x32_bf16 v[228:231], a[116:119], a[52:55], v[228:231]
v_exp_f32 v212, v212
v_mfma_f32_16x16x32_bf16 v[228:231], a[120:123], a[56:59], v[228:231]
v_exp_f32 v213, v213
v_mfma_f32_16x16x32_bf16 v[228:231], a[124:127], a[60:63], v[228:231]
ds_read_b128 a[112:115], v1 offset:20480
ds_read_b128 a[116:119], v1 offset:21504
ds_read_b128 a[120:123], v1 offset:22528
ds_read_b128 a[124:127], v1 offset:23552
v_cvt_pk_bf16_f32 v244, v212, v213
v_exp_f32 v214, v214
v_exp_f32 v215, v215
s_nop 0
v_cvt_pk_bf16_f32 v245, v214, v215
v_mov_b32 v234, 0
v_mov_b32 v235, 0
v_exp_f32 v220, v220
v_exp_f32 v221, v221
s_nop 0
v_cvt_pk_bf16_f32 v238, v220, v221
v_exp_f32 v222, v222
v_exp_f32 v223, v223
s_nop 0
v_cvt_pk_bf16_f32 v239, v222, v223
v_exp_f32 v224, v224
v_exp_f32 v225, v225
s_nop 0
v_cvt_pk_bf16_f32 v242, v224, v225
v_add_u32 v1, s11, v0
buffer_load_dwordx4 v0, s[20:23], s4 offen offset:1024 sc1 lds
buffer_load_dwordx4 v0, s[20:23], s4 offen offset:2048 sc1 lds
buffer_load_dwordx4 v0, s[20:23], s4 offen offset:3072 sc1 lds
s_add_u32 s4, s4, 16384
s_add_u32 s5, s5, 8192
s_and_b32 s5, s5, 0xffff
buffer_load_dword v34, v24, s[28:31], 0 offen
buffer_load_dword v35, v25, s[52:55], 0 offen
ds_read_b128 a[76:79], v23 offset:3072
ds_read_b128 a[80:83], v23 offset:4096
ds_read_b128 a[84:87], v23 offset:5120
ds_read_b128 a[88:91], v23 offset:6144
ds_read_b128 a[92:95], v23 offset:7168
s_branch LA_b10
LA_ma0:
s_waitcnt lgkmcnt(7)
v_mfma_f32_16x16x32_bf16 v[200:203], a[96:99], a[0:3], v[40:43]
s_waitcnt vmcnt(8) lgkmcnt(0)
s_barrier
v_mfma_f32_16x16x32_bf16 v[200:203], a[100:103], a[4:7], v[200:203]
s_add_u32 s12, s12, 8192
v_exp_f32 v226, v226
v_mfma_f32_16x16x32_bf16 v[200:203], a[104:107], a[8:11], v[200:203]
s_and_b32 s12, s12, 0xffff
s_add_u32 s11, s11, 8192
s_add_u32 m0, s5, s6
v_mfma_f32_16x16x32_bf16 v[200:203], a[108:111], a[12:15], v[200:203]
s_and_b32 s11, s11, 0xffff
v_exp_f32 v227, v227
v_mfma_f32_16x16x32_bf16 v[204:207], a[108:111], a[28:31], v[44:47]
ds_read_b128 a[128:131], v2 offset:0
v_cvt_pk_bf16_f32 v67, v226, v227
v_mfma_f32_16x16x32_bf16 v[204:207], a[104:107], a[24:27], v[204:207]
v_exp_f32 v228, v228
v_mfma_f32_16x16x32_bf16 v[204:207], a[100:103], a[20:23], v[204:207]
buffer_load_dwordx4 v0, s[20:23], s4 offen offset:0 sc1 lds
v_mfma_f32_16x16x32_bf16 v[204:207], a[96:99], a[16:19], v[204:207]
v_exp_f32 v229, v229
v_mfma_f32_16x16x32_bf16 v[208:211], a[96:99], a[32:35], v[48:51]
ds_read_b128 a[132:135], v2 offset:1024
v_cvt_pk_bf16_f32 v70, v228, v229
v_mfma_f32_16x16x32_bf16 v[208:211], a[100:103], a[36:39], v[208:211]
v_exp_f32 v230, v230
v_mfma_f32_16x16x32_bf16 v[208:211], a[104:107], a[40:43], v[208:211]
buffer_load_dwordx4 v0, s[20:23], s4 offen offset:1024 sc1 lds
v_mfma_f32_16x16x32_bf16 v[208:211], a[108:111], a[44:47], v[208:211]
v_exp_f32 v231, v231
v_mfma_f32_16x16x32_bf16 v[212:215], a[108:111], a[60:63], v[52:55]
ds_read_b128 a[136:139], v2 offset:2048
v_cvt_pk_bf16_f32 v71, v230, v231
v_mfma_f32_16x16x32_bf16 v[212:215], a[104:107], a[56:59], v[212:215]
v_exp_f32 v200, v200
v_mfma_f32_16x16x32_bf16 v[212:215], a[100:103], a[52:55], v[212:215]
ds_read_b128 a[140:143], v2 offset:3072
buffer_load_dwordx4 v0, s[20:23], s4 offen offset:2048 sc1 lds
v_mfma_f32_16x16x32_bf16 v[212:215], a[96:99], a[48:51], v[212:215]
v_exp_f32 v201, v201
v_mfma_f32_16x16x32_bf16 v[220:223], a[112:115], a[16:19], v[44:47]
v_cvt_pk_bf16_f32 v232, v200, v201
v_and_b32 v232, v232, v18
v_mfma_f32_16x16x32_bf16 v[220:223], a[116:119], a[20:23], v[220:223]
v_exp_f32 v202, v202
v_mfma_f32_16x16x32_bf16 v[220:223], a[120:123], a[24:27], v[220:223]
ds_read_b128 a[144:147], v2 offset:4096
buffer_load_dwordx4 v0, s[20:23], s4 offen offset:3072 sc1 lds
v_mfma_f32_16x16x32_bf16 v[220:223], a[124:127], a[28:31], v[220:223]
s_add_u32 s4, s4, 16384
v_exp_f32 v203, v203
v_mfma_f32_16x16x32_bf16 v[224:227], a[124:127], a[44:47], v[48:51]
s_add_u32 s5, s5, 8192
v_cvt_pk_bf16_f32 v233, v202, v203
v_and_b32 v233, v233, v19
v_mfma_f32_16x16x32_bf16 v[224:227], a[120:123], a[40:43], v[224:227]
s_and_b32 s5, s5, 0xffff
v_exp_f32 v204, v204
v_mfma_f32_16x16x32_bf16 v[224:227], a[116:119], a[36:39], v[224:227]
ds_read_b128 a[148:151], v2 offset:5120
v_add_u32 v30, (LA_fin+0-LA_pc+4096)/4, v0
v_mad_u64_u32 v[30:31], vcc, v30, 4, s[72:73]
v_mfma_f32_16x16x32_bf16 v[224:227], a[112:115], a[32:35], v[224:227]
v_exp_f32 v205, v205
v_mfma_f32_16x16x32_bf16 v[228:231], a[112:115], a[48:51], v[52:55]
ds_read_b128 a[152:155], v2 offset:6144
v_cvt_pk_bf16_f32 v236, v204, v205
v_mfma_f32_16x16x32_bf16 v[228:231], a[116:119], a[52:55], v[228:231]
v_exp_f32 v206, v206
v_mfma_f32_16x16x32_bf16 v[228:231], a[120:123], a[56:59], v[228:231]
global_load_dword v30, v[30:31], off offset:-4096
v_mfma_f32_16x16x32_bf16 v[228:231], a[124:127], a[60:63], v[228:231]
s_waitcnt lgkmcnt(6)
v_exp_f32 v207, v207
v_mfma_f32_16x16x32_bf16 v[72:75], a[128:131], v[248:251], v[72:75]
ds_read_b128 a[156:159], v2 offset:7168
v_cvt_pk_bf16_f32 v237, v206, v207
v_mfma_f32_16x16x32_bf16 v[104:107], a[128:131], v[252:255], v[104:107]
v_exp_f32 v208, v208
v_mfma_f32_16x16x32_bf16 v[136:139], a[128:131], v[64:67], v[136:139]
ds_read_b128 a[96:99], v1 offset:16384
v_mfma_f32_16x16x32_bf16 v[168:171], a[128:131], v[68:71], v[168:171]
s_waitcnt lgkmcnt(7)
v_exp_f32 v209, v209
v_mfma_f32_16x16x32_bf16 v[172:175], a[132:135], v[68:71], v[172:175]
v_cvt_pk_bf16_f32 v240, v208, v209
v_add_u32 v2, s12, v3
v_mfma_f32_16x16x32_bf16 v[140:143], a[132:135], v[64:67], v[140:143]
v_exp_f32 v210, v210
v_mfma_f32_16x16x32_bf16 v[108:111], a[132:135], v[252:255], v[108:111]
ds_read_b128 a[100:103], v1 offset:17408
v_mfma_f32_16x16x32_bf16 v[76:79], a[132:135], v[248:251], v[76:79]
s_waitcnt lgkmcnt(7)
v_exp_f32 v211, v211
v_mfma_f32_16x16x32_bf16 v[80:83], a[136:139], v[248:251], v[80:83]
ds_read_b128 a[104:107], v1 offset:18432
v_cvt_pk_bf16_f32 v241, v210, v211
v_mfma_f32_16x16x32_bf16 v[112:115], a[136:139], v[252:255], v[112:115]
v_exp_f32 v212, v212
v_mfma_f32_16x16x32_bf16 v[144:147], a[136:139], v[64:67], v[144:147]
v_mfma_f32_16x16x32_bf16 v[176:179], a[136:139], v[68:71], v[176:179]
s_waitcnt lgkmcnt(7)
v_exp_f32 v213, v213
v_mfma_f32_16x16x32_bf16 v[180:183], a[140:143], v[68:71], v[180:183]
ds_read_b128 a[108:111], v1 offset:19456
v_cvt_pk_bf16_f32 v244, v212, v213
v_mfma_f32_16x16x32_bf16 v[148:151], a[140:143], v[64:67], v[148:151]
v_exp_f32 v214, v214
v_mfma_f32_16x16x32_bf16 v[116:119], a[140:143], v[252:255], v[116:119]
v_mfma_f32_16x16x32_bf16 v[84:87], a[140:143], v[248:251], v[84:87]
s_waitcnt lgkmcnt(7)
v_exp_f32 v215, v215
v_mfma_f32_16x16x32_bf16 v[88:91], a[144:147], v[248:251], v[88:91]
ds_read_b128 a[112:115], v1 offset:20480
v_cvt_pk_bf16_f32 v245, v214, v215
v_mfma_f32_16x16x32_bf16 v[120:123], a[144:147], v[252:255], v[120:123]
v_mov_b32 v234, 0
v_mov_b32 v235, 0
v_mfma_f32_16x16x32_bf16 v[152:155], a[144:147], v[64:67], v[152:155]
v_exp_f32 v220, v220
v_mfma_f32_16x16x32_bf16 v[184:187], a[144:147], v[68:71], v[184:187]
s_waitcnt lgkmcnt(7)
v_mfma_f32_16x16x32_bf16 v[188:191], a[148:151], v[68:71], v[188:191]
v_exp_f32 v221, v221
v_mfma_f32_16x16x32_bf16 v[156:159], a[148:151], v[64:67], v[156:159]
ds_read_b128 a[116:119], v1 offset:21504
v_cvt_pk_bf16_f32 v238, v220, v221
v_mfma_f32_16x16x32_bf16 v[124:127], a[148:151], v[252:255], v[124:127]
v_exp_f32 v222, v222
v_mfma_f32_16x16x32_bf16 v[92:95], a[148:151], v[248:251], v[92:95]
s_waitcnt lgkmcnt(7)
v_mfma_f32_16x16x32_bf16 v[96:99], a[152:155], v[248:251], v[96:99]
v_exp_f32 v223, v223
v_mfma_f32_16x16x32_bf16 v[128:131], a[152:155], v[252:255], v[128:131]
ds_read_b128 a[120:123], v1 offset:22528
v_cvt_pk_bf16_f32 v239, v222, v223
v_mfma_f32_16x16x32_bf16 v[160:163], a[152:155], v[64:67], v[160:163]
v_exp_f32 v224, v224
v_mfma_f32_16x16x32_bf16 v[192:195], a[152:155], v[68:71], v[192:195]
s_waitcnt lgkmcnt(7)
v_mfma_f32_16x16x32_bf16 v[196:199], a[156:159], v[68:71], v[196:199]
v_exp_f32 v225, v225
v_mfma_f32_16x16x32_bf16 v[164:167], a[156:159], v[64:67], v[164:167]
ds_read_b128 a[124:127], v1 offset:23552
v_cvt_pk_bf16_f32 v242, v224, v225
v_mfma_f32_16x16x32_bf16 v[132:135], a[156:159], v[252:255], v[132:135]
v_add_u32 v1, s11, v0
v_mfma_f32_16x16x32_bf16 v[100:103], a[156:159], v[248:251], v[100:103]
v_mfma_f32_16x16x32_bf16 a[160:163], a[184:187], v[248:251], a[160:163]
v_mfma_f32_16x16x32_bf16 a[164:167], a[184:187], v[252:255], a[164:167]
v_mfma_f32_16x16x32_bf16 a[168:171], a[184:187], v[64:67], a[168:171]
v_mfma_f32_16x16x32_bf16 a[172:175], a[184:187], v[68:71], a[172:175]
LA_b10:
s_waitcnt lgkmcnt(7)
v_mfma_f32_16x16x32_bf16 v[204:207], a[96:99], a[16:19], v[44:47]
s_waitcnt vmcnt(9) lgkmcnt(0)
s_barrier
v_mfma_f32_16x16x32_bf16 v[204:207], a[100:103], a[20:23], v[204:207]
s_add_u32 s12, s12, 8192
v_exp_f32 v226, v226
v_mfma_f32_16x16x32_bf16 v[204:207], a[104:107], a[24:27], v[204:207]
s_waitcnt vmcnt(6)
s_and_b32 s12, s12, 0xffff
s_add_u32 m0, s5, s6
v_bfe_u32 v20, v0, 2, 7
v_mfma_f32_16x16x32_bf16 v[204:207], a[108:111], a[28:31], v[204:207]
s_add_u32 s11, s11, 8192
v_exp_f32 v227, v227
v_mfma_f32_16x16x32_bf16 v[208:211], a[108:111], a[44:47], v[48:51]
ds_read_b128 a[128:131], v2 offset:0
v_cvt_pk_bf16_f32 v243, v226, v227
v_mfma_f32_16x16x32_bf16 v[208:211], a[104:107], a[40:43], v[208:211]
s_and_b32 s11, s11, 0xffff
v_exp_f32 v228, v228
v_mfma_f32_16x16x32_bf16 v[208:211], a[100:103], a[36:39], v[208:211]
buffer_load_dword v20, v20, s[76:79], s40 offen offset:0 sc1
v_mfma_f32_16x16x32_bf16 v[208:211], a[96:99], a[32:35], v[208:211]
v_exp_f32 v229, v229
v_mfma_f32_16x16x32_bf16 v[212:215], a[96:99], a[48:51], v[52:55]
v_cvt_pk_bf16_f32 v246, v228, v229
v_bfe_u32 v22, v0, 2, 7
v_mfma_f32_16x16x32_bf16 v[212:215], a[100:103], a[52:55], v[212:215]
v_exp_f32 v230, v230
v_mfma_f32_16x16x32_bf16 v[212:215], a[104:107], a[56:59], v[212:215]
buffer_load_dword v22, v22, s[76:79], s41 offen offset:0 sc1
v_mfma_f32_16x16x32_bf16 v[212:215], a[108:111], a[60:63], v[212:215]
v_exp_f32 v231, v231
v_mfma_f32_16x16x32_bf16 v[220:223], a[112:115], a[16:19], v[44:47]
ds_read_b128 a[132:135], v2 offset:1024
v_cvt_pk_bf16_f32 v247, v230, v231
v_mfma_f32_16x16x32_bf16 v[220:223], a[116:119], a[20:23], v[220:223]
v_exp_f32 v204, v204
v_mfma_f32_16x16x32_bf16 v[220:223], a[120:123], a[24:27], v[220:223]
buffer_load_dwordx4 v0, s[20:23], s4 offen offset:0 sc1 lds
v_mfma_f32_16x16x32_bf16 v[220:223], a[124:127], a[28:31], v[220:223]
v_exp_f32 v205, v205
v_mfma_f32_16x16x32_bf16 v[224:227], a[124:127], a[44:47], v[48:51]
ds_read_b128 a[136:139], v2 offset:2048
v_cvt_pk_bf16_f32 v252, v204, v205
v_mfma_f32_16x16x32_bf16 v[224:227], a[120:123], a[40:43], v[224:227]
v_exp_f32 v206, v206
v_mfma_f32_16x16x32_bf16 v[224:227], a[116:119], a[36:39], v[224:227]
buffer_load_dwordx4 v0, s[20:23], s4 offen offset:1024 sc1 lds
v_mfma_f32_16x16x32_bf16 v[224:227], a[112:115], a[32:35], v[224:227]
v_exp_f32 v207, v207
v_mfma_f32_16x16x32_bf16 v[228:231], a[112:115], a[48:51], v[52:55]
ds_read_b128 a[140:143], v2 offset:3072
v_cvt_pk_bf16_f32 v253, v206, v207
v_mfma_f32_16x16x32_bf16 v[228:231], a[116:119], a[52:55], v[228:231]
v_exp_f32 v208, v208
v_mfma_f32_16x16x32_bf16 v[228:231], a[120:123], a[56:59], v[228:231]
buffer_load_dwordx4 v0, s[20:23], s4 offen offset:2048 sc1 lds
v_mfma_f32_16x16x32_bf16 v[228:231], a[124:127], a[60:63], v[228:231]
s_waitcnt lgkmcnt(3)
v_exp_f32 v209, v209
v_mfma_f32_16x16x32_bf16 v[72:75], a[128:131], v[232:235], v[72:75]
ds_read_b128 a[144:147], v2 offset:4096
v_cvt_pk_bf16_f32 v64, v208, v209
v_mfma_f32_16x16x32_bf16 v[104:107], a[128:131], v[236:239], v[104:107]
v_exp_f32 v210, v210
v_mfma_f32_16x16x32_bf16 v[136:139], a[128:131], v[240:243], v[136:139]
ds_read_b128 a[96:99], v1 offset:16384
buffer_load_dwordx4 v0, s[20:23], s4 offen offset:3072 sc1 lds
v_mfma_f32_16x16x32_bf16 v[168:171], a[128:131], v[244:247], v[168:171]
s_waitcnt lgkmcnt(4)
s_add_u32 s4, s4, 16384
v_exp_f32 v211, v211
v_mfma_f32_16x16x32_bf16 v[172:175], a[132:135], v[244:247], v[172:175]
s_add_u32 s5, s5, 8192
ds_read_b128 a[148:151], v2 offset:5120
v_cvt_pk_bf16_f32 v65, v210, v211
v_mfma_f32_16x16x32_bf16 v[140:143], a[132:135], v[240:243], v[140:143]
s_and_b32 s5, s5, 0xffff
v_exp_f32 v212, v212
v_mfma_f32_16x16x32_bf16 v[108:111], a[132:135], v[236:239], v[108:111]
ds_read_b128 a[100:103], v1 offset:17408
v_bfe_u32 v21, v0, 4, 4
v_mfma_f32_16x16x32_bf16 v[76:79], a[132:135], v[232:235], v[76:79]
s_waitcnt lgkmcnt(5)
s_lshl_b32 s34, s80, 6
v_exp_f32 v213, v213
v_mfma_f32_16x16x32_bf16 v[80:83], a[136:139], v[232:235], v[80:83]
ds_read_b128 a[152:155], v2 offset:6144
v_cvt_pk_bf16_f32 v68, v212, v213
v_mfma_f32_16x16x32_bf16 v[112:115], a[136:139], v[236:239], v[112:115]
s_sub_u32 s35, 448, s34
v_exp_f32 v214, v214
v_mfma_f32_16x16x32_bf16 v[144:147], a[136:139], v[240:243], v[144:147]
ds_read_b128 a[104:107], v1 offset:18432
v_lshl_add_u32 v29, v21, 2, s34
v_mfma_f32_16x16x32_bf16 v[176:179], a[136:139], v[244:247], v[176:179]
s_waitcnt lgkmcnt(6)
v_exp_f32 v215, v215
v_mfma_f32_16x16x32_bf16 v[180:183], a[140:143], v[244:247], v[180:183]
ds_read_b128 a[156:159], v2 offset:7168
v_cvt_pk_bf16_f32 v69, v214, v215
v_mfma_f32_16x16x32_bf16 v[148:151], a[140:143], v[240:243], v[148:151]
v_exp_f32 v220, v220
v_mfma_f32_16x16x32_bf16 v[116:119], a[140:143], v[236:239], v[116:119]
ds_read_b128 a[108:111], v1 offset:19456
v_lshl_add_u32 v28, v21, 2, s35
v_mfma_f32_16x16x32_bf16 v[84:87], a[140:143], v[232:235], v[84:87]
s_waitcnt lgkmcnt(7)
v_exp_f32 v221, v221
v_mfma_f32_16x16x32_bf16 v[88:91], a[144:147], v[232:235], v[88:91]
v_cvt_pk_bf16_f32 v254, v220, v221
v_add_u32 v2, s12, v3
v_mfma_f32_16x16x32_bf16 v[120:123], a[144:147], v[236:239], v[120:123]
v_exp_f32 v222, v222
v_mfma_f32_16x16x32_bf16 v[152:155], a[144:147], v[240:243], v[152:155]
ds_read_b128 a[112:115], v1 offset:20480
v_sub_f32 v24, 1.0, v4
v_mfma_f32_16x16x32_bf16 v[184:187], a[144:147], v[244:247], v[184:187]
s_waitcnt lgkmcnt(6)
v_exp_f32 v223, v223
v_mfma_f32_16x16x32_bf16 v[188:191], a[148:151], v[244:247], v[188:191]
ds_read_b128 a[116:119], v1 offset:21504
v_cvt_pk_bf16_f32 v255, v222, v223
v_mfma_f32_16x16x32_bf16 v[156:159], a[148:151], v[240:243], v[156:159]
v_exp_f32 v224, v224
v_mfma_f32_16x16x32_bf16 v[124:127], a[148:151], v[236:239], v[124:127]
v_sub_f32 v25, 1.0, v5
v_sub_f32 v26, 1.0, v6
v_mfma_f32_16x16x32_bf16 v[92:95], a[148:151], v[232:235], v[92:95]
s_waitcnt lgkmcnt(5)
v_exp_f32 v225, v225
v_mfma_f32_16x16x32_bf16 v[96:99], a[152:155], v[232:235], v[96:99]
ds_read_b128 a[120:123], v1 offset:22528
v_cvt_pk_bf16_f32 v66, v224, v225
v_mfma_f32_16x16x32_bf16 v[128:131], a[152:155], v[236:239], v[128:131]
v_sub_f32 v27, 1.0, v7
v_cvt_pk_bf16_f32 v24, v24, v24
v_mfma_f32_16x16x32_bf16 v[160:163], a[152:155], v[240:243], v[160:163]
s_waitcnt vmcnt(5)
v_cvt_pk_bf16_f32 v25, v25, v25
v_cvt_pk_bf16_f32 v26, v26, v26
v_cmp_lt_u32 vcc, 0, v20
v_mfma_f32_16x16x32_bf16 v[192:195], a[152:155], v[244:247], v[192:195]
s_waitcnt vmcnt(4) lgkmcnt(4)
ds_read_b128 a[124:127], v1 offset:23552
v_cvt_pk_bf16_f32 v27, v27, v27
v_cmp_lt_u32 s[32:33], 0, v22
v_mfma_f32_16x16x32_bf16 v[196:199], a[156:159], v[244:247], v[196:199]
v_add_u32 v1, s11, v0
v_lshlrev_b32 v24, 16, v24
v_mfma_f32_16x16x32_bf16 v[164:167], a[156:159], v[240:243], v[164:167]
v_lshlrev_b32 v25, 16, v25
v_lshlrev_b32 v26, 16, v26
v_mfma_f32_16x16x32_bf16 v[132:135], a[156:159], v[236:239], v[132:135]
v_lshlrev_b32 v27, 16, v27
v_add_f32 v24, v24, v24
v_mfma_f32_16x16x32_bf16 v[100:103], a[156:159], v[232:235], v[100:103]
v_add_f32 v25, v25, v25
v_add_f32 v26, v26, v26
v_mfma_f32_16x16x32_bf16 a[160:163], a[184:187], v[232:235], a[160:163]
v_add_f32 v27, v27, v27
v_mfma_f32_16x16x32_bf16 a[164:167], a[184:187], v[236:239], a[164:167]
ds_write_b32 v29, v24 offset:6144
v_mfma_f32_16x16x32_bf16 a[168:171], a[184:187], v[240:243], a[168:171]
s_andn2_b32 s33, 255, s32
s_cbranch_scc1 LA_p40_s
LA_p40:
v_mfma_f32_16x16x32_bf16 a[172:175], a[184:187], v[244:247], a[172:175]
s_andn2_b32 s33, 16776960, vcc_lo
s_cbranch_scc1 LA_p20_s
LA_p20:
ds_write_b32 v28, v25 offset:6144
ds_write_b32 v29, v26 offset:6656
ds_write_b32 v28, v27 offset:6656
v_mfma_f32_16x16x32_bf16 v[204:207], a[96:99], a[16:19], v[44:47]
s_waitcnt vmcnt(63) lgkmcnt(0)
s_barrier
v_mfma_f32_16x16x32_bf16 v[204:207], a[100:103], a[20:23], v[204:207]
s_add_u32 s12, s12, 8192
v_exp_f32 v226, v226
v_mfma_f32_16x16x32_bf16 v[204:207], a[104:107], a[24:27], v[204:207]
s_and_b32 s12, s12, 0xffff
s_add_u32 s11, s11, 8192
v_lshrrev_b32 v22, 1, v0
v_mfma_f32_16x16x32_bf16 v[204:207], a[108:111], a[28:31], v[204:207]
s_and_b32 s11, s11, 0xffff
v_exp_f32 v227, v227
v_mfma_f32_16x16x32_bf16 v[208:211], a[108:111], a[44:47], v[48:51]
ds_read_b128 a[128:131], v2 offset:0
v_cvt_pk_bf16_f32 v67, v226, v227
v_mfma_f32_16x16x32_bf16 v[208:211], a[104:107], a[40:43], v[208:211]
v_exp_f32 v228, v228
v_mfma_f32_16x16x32_bf16 v[208:211], a[100:103], a[36:39], v[208:211]
buffer_load_dwordx2 v[24:25], v22, s[76:79], s86 offen offset:0 sc1
v_mfma_f32_16x16x32_bf16 v[208:211], a[96:99], a[32:35], v[208:211]
v_exp_f32 v229, v229
v_mfma_f32_16x16x32_bf16 v[212:215], a[96:99], a[48:51], v[52:55]
ds_read_b128 a[132:135], v2 offset:1024
v_cvt_pk_bf16_f32 v70, v228, v229
v_mfma_f32_16x16x32_bf16 v[212:215], a[100:103], a[52:55], v[212:215]
v_exp_f32 v230, v230
v_mfma_f32_16x16x32_bf16 v[212:215], a[104:107], a[56:59], v[212:215]
buffer_load_dwordx2 v[26:27], v22, s[76:79], s86 offen offset:512 sc1
v_mfma_f32_16x16x32_bf16 v[212:215], a[108:111], a[60:63], v[212:215]
v_exp_f32 v231, v231
v_mfma_f32_16x16x32_bf16 v[220:223], a[112:115], a[16:19], v[44:47]
ds_read_b128 a[136:139], v2 offset:2048
v_cvt_pk_bf16_f32 v71, v230, v231
v_mfma_f32_16x16x32_bf16 v[220:223], a[116:119], a[20:23], v[220:223]
v_exp_f32 v204, v204
v_mfma_f32_16x16x32_bf16 v[220:223], a[120:123], a[24:27], v[220:223]
ds_read_b128 a[96:99], v1 offset:16384
buffer_load_dwordx2 v[28:29], v22, s[76:79], s86 offen offset:1024 sc1
v_mfma_f32_16x16x32_bf16 v[220:223], a[124:127], a[28:31], v[220:223]
v_exp_f32 v205, v205
v_mfma_f32_16x16x32_bf16 v[224:227], a[124:127], a[44:47], v[48:51]
ds_read_b128 a[140:143], v2 offset:3072
v_cvt_pk_bf16_f32 v236, v204, v205
v_mfma_f32_16x16x32_bf16 v[224:227], a[120:123], a[40:43], v[224:227]
v_exp_f32 v206, v206
v_mfma_f32_16x16x32_bf16 v[224:227], a[116:119], a[36:39], v[224:227]
ds_read_b128 a[100:103], v1 offset:17408
buffer_load_dwordx2 v[30:31], v22, s[76:79], s86 offen offset:1536 sc1
v_mfma_f32_16x16x32_bf16 v[224:227], a[112:115], a[32:35], v[224:227]
v_exp_f32 v207, v207
v_mfma_f32_16x16x32_bf16 v[228:231], a[112:115], a[48:51], v[52:55]
ds_read_b128 a[144:147], v2 offset:4096
v_cvt_pk_bf16_f32 v237, v206, v207
v_mfma_f32_16x16x32_bf16 v[228:231], a[116:119], a[52:55], v[228:231]
v_exp_f32 v208, v208
v_mfma_f32_16x16x32_bf16 v[228:231], a[120:123], a[56:59], v[228:231]
ds_read_b128 a[104:107], v1 offset:18432
buffer_load_dwordx2 v[32:33], v22, s[76:79], s86 offen offset:2048 sc1
v_mfma_f32_16x16x32_bf16 v[228:231], a[124:127], a[60:63], v[228:231]
s_waitcnt lgkmcnt(7)
v_exp_f32 v209, v209
v_mfma_f32_16x16x32_bf16 v[104:107], a[128:131], v[252:255], v[104:107]
ds_read_b128 a[148:151], v2 offset:5120
v_cvt_pk_bf16_f32 v240, v208, v209
v_mfma_f32_16x16x32_bf16 v[136:139], a[128:131], v[64:67], v[136:139]
v_exp_f32 v210, v210
v_mfma_f32_16x16x32_bf16 v[168:171], a[128:131], v[68:71], v[168:171]
s_waitcnt lgkmcnt(7)
ds_read_b128 a[108:111], v1 offset:19456
buffer_load_dwordx2 v[34:35], v22, s[76:79], s86 offen offset:2560 sc1
v_mfma_f32_16x16x32_bf16 v[172:175], a[132:135], v[68:71], v[172:175]
v_exp_f32 v211, v211
v_mfma_f32_16x16x32_bf16 v[140:143], a[132:135], v[64:67], v[140:143]
ds_read_b128 a[152:155], v2 offset:6144
v_cvt_pk_bf16_f32 v241, v210, v211
v_mfma_f32_16x16x32_bf16 v[108:111], a[132:135], v[252:255], v[108:111]
s_waitcnt lgkmcnt(8)
v_exp_f32 v212, v212
v_mfma_f32_16x16x32_bf16 v[112:115], a[136:139], v[252:255], v[112:115]
ds_read_b128 a[112:115], v1 offset:20480
buffer_load_dwordx2 v[36:37], v22, s[76:79], s86 offen offset:3072 sc1
v_mfma_f32_16x16x32_bf16 v[144:147], a[136:139], v[64:67], v[144:147]
v_exp_f32 v213, v213
v_mfma_f32_16x16x32_bf16 v[176:179], a[136:139], v[68:71], v[176:179]
s_waitcnt lgkmcnt(7)
ds_read_b128 a[156:159], v2 offset:7168
v_cvt_pk_bf16_f32 v244, v212, v213
v_mfma_f32_16x16x32_bf16 v[180:183], a[140:143], v[68:71], v[180:183]
v_exp_f32 v214, v214
v_mfma_f32_16x16x32_bf16 v[148:151], a[140:143], v[64:67], v[148:151]
ds_read_b128 a[116:119], v1 offset:21504
buffer_load_dwordx2 v[38:39], v22, s[76:79], s86 offen offset:3584 sc1
v_mfma_f32_16x16x32_bf16 v[116:119], a[140:143], v[252:255], v[116:119]
s_waitcnt lgkmcnt(7)
s_add_u32 m0, s5, s6
v_exp_f32 v215, v215
v_mfma_f32_16x16x32_bf16 v[120:123], a[144:147], v[252:255], v[120:123]
v_cvt_pk_bf16_f32 v245, v214, v215
v_add_u32 v2, s12, v3
v_mfma_f32_16x16x32_bf16 v[152:155], a[144:147], v[64:67], v[152:155]
v_exp_f32 v220, v220
v_mfma_f32_16x16x32_bf16 v[184:187], a[144:147], v[68:71], v[184:187]
s_waitcnt lgkmcnt(5)
buffer_load_dwordx4 v0, s[20:23], s4 offen offset:0 sc1 lds
v_mfma_f32_16x16x32_bf16 v[188:191], a[148:151], v[68:71], v[188:191]
v_exp_f32 v221, v221
v_mfma_f32_16x16x32_bf16 v[156:159], a[148:151], v[64:67], v[156:159]
ds_read_b128 a[120:123], v1 offset:22528
v_cvt_pk_bf16_f32 v238, v220, v221
v_mfma_f32_16x16x32_bf16 v[124:127], a[148:151], v[252:255], v[124:127]
s_waitcnt lgkmcnt(4)
v_exp_f32 v222, v222
v_mfma_f32_16x16x32_bf16 v[128:131], a[152:155], v[252:255], v[128:131]
buffer_load_dwordx4 v0, s[20:23], s4 offen offset:1024 sc1 lds
v_mfma_f32_16x16x32_bf16 v[160:163], a[152:155], v[64:67], v[160:163]
v_exp_f32 v223, v223
v_mfma_f32_16x16x32_bf16 v[192:195], a[152:155], v[68:71], v[192:195]
s_waitcnt lgkmcnt(2)
ds_read_b128 a[124:127], v1 offset:23552
v_cvt_pk_bf16_f32 v239, v222, v223
v_mfma_f32_16x16x32_bf16 v[196:199], a[156:159], v[68:71], v[196:199]
v_exp_f32 v224, v224
v_mfma_f32_16x16x32_bf16 v[164:167], a[156:159], v[64:67], v[164:167]
buffer_load_dwordx4 v0, s[20:23], s4 offen offset:2048 sc1 lds
v_mfma_f32_16x16x32_bf16 v[132:135], a[156:159], v[252:255], v[132:135]
v_exp_f32 v225, v225
v_mfma_f32_16x16x32_bf16 a[164:167], a[184:187], v[252:255], a[164:167]
v_cvt_pk_bf16_f32 v242, v224, v225
v_add_u32 v1, s11, v0
v_mfma_f32_16x16x32_bf16 a[168:171], a[184:187], v[64:67], a[168:171]
buffer_load_dwordx4 v0, s[20:23], s4 offen offset:3072 sc1 lds
v_mfma_f32_16x16x32_bf16 a[172:175], a[184:187], v[68:71], a[172:175]
s_add_u32 s4, s4, 16384
s_add_u32 s5, s5, 8192
s_and_b32 s5, s5, 0xffff
s_cmp_eq_u32 s16, 0
s_cbranch_scc1 LA_ssm
LA_c30:
v_mfma_f32_16x16x32_bf16 v[204:207], a[96:99], a[16:19], v[44:47]
s_waitcnt vmcnt(63) lgkmcnt(0)
s_barrier
v_mfma_f32_16x16x32_bf16 v[204:207], a[100:103], a[20:23], v[204:207]
s_add_u32 s12, s12, 8192
v_exp_f32 v226, v226
v_mfma_f32_16x16x32_bf16 v[204:207], a[104:107], a[24:27], v[204:207]
s_and_b32 s12, s12, 0xffff
s_add_u32 s11, s11, s15
s_add_u32 m0, s5, s6
v_mfma_f32_16x16x32_bf16 v[204:207], a[108:111], a[28:31], v[204:207]
s_and_b32 s11, s11, 0xffff
v_exp_f32 v227, v227
v_mfma_f32_16x16x32_bf16 v[208:211], a[108:111], a[44:47], v[48:51]
ds_read_b128 a[128:131], v2 offset:0
v_cvt_pk_bf16_f32 v243, v226, v227
v_mfma_f32_16x16x32_bf16 v[208:211], a[104:107], a[40:43], v[208:211]
s_lshl_b32 s34, s80, 13
v_exp_f32 v228, v228
v_mfma_f32_16x16x32_bf16 v[208:211], a[100:103], a[36:39], v[208:211]
buffer_load_dwordx4 v0, s[20:23], s4 offen offset:0 sc1 lds
v_mfma_f32_16x16x32_bf16 v[208:211], a[96:99], a[32:35], v[208:211]
s_lshl_b32 s35, s80, 14
v_exp_f32 v229, v229
v_mfma_f32_16x16x32_bf16 v[212:215], a[96:99], a[48:51], v[52:55]
ds_read_b128 a[132:135], v2 offset:1024
v_cvt_pk_bf16_f32 v246, v228, v229
v_mfma_f32_16x16x32_bf16 v[212:215], a[100:103], a[52:55], v[212:215]
s_xor_b32 s50, s17, 0x8000
v_exp_f32 v230, v230
v_mfma_f32_16x16x32_bf16 v[212:215], a[104:107], a[56:59], v[212:215]
buffer_load_dwordx4 v0, s[20:23], s4 offen offset:1024 sc1 lds
v_mfma_f32_16x16x32_bf16 v[212:215], a[108:111], a[60:63], v[212:215]
s_lshl_b32 s33, s80, 9
v_exp_f32 v231, v231
v_mfma_f32_16x16x32_bf16 v[220:223], a[112:115], a[16:19], v[44:47]
ds_read_b128 a[136:139], v2 offset:2048
v_cvt_pk_bf16_f32 v247, v230, v231
v_mfma_f32_16x16x32_bf16 v[220:223], a[116:119], a[20:23], v[220:223]
s_add_u32 s33, s33, s50
v_exp_f32 v204, v204
v_mfma_f32_16x16x32_bf16 v[220:223], a[120:123], a[24:27], v[220:223]
ds_read_b128 a[96:99], v1 offset:16384
buffer_load_dwordx4 v0, s[20:23], s4 offen offset:2048 sc1 lds
v_mfma_f32_16x16x32_bf16 v[220:223], a[124:127], a[28:31], v[220:223]
s_sub_u32 s32, 4, s85
v_exp_f32 v205, v205
v_mfma_f32_16x16x32_bf16 v[224:227], a[124:127], a[44:47], v[48:51]
ds_read_b128 a[140:143], v2 offset:3072
v_cvt_pk_bf16_f32 v252, v204, v205
v_mfma_f32_16x16x32_bf16 v[224:227], a[120:123], a[40:43], v[224:227]
s_lshl_b32 s32, s32, 12
v_exp_f32 v206, v206
v_mfma_f32_16x16x32_bf16 v[224:227], a[116:119], a[36:39], v[224:227]
ds_read_b128 a[100:103], v1 offset:17408
buffer_load_dwordx4 v0, s[20:23], s4 offen offset:3072 sc1 lds
v_mfma_f32_16x16x32_bf16 v[224:227], a[112:115], a[32:35], v[224:227]
s_add_u32 s4, s4, 16384
v_exp_f32 v207, v207
v_mfma_f32_16x16x32_bf16 v[228:231], a[112:115], a[48:51], v[52:55]
s_add_u32 s5, s5, 8192
ds_read_b128 a[144:147], v2 offset:4096
v_cvt_pk_bf16_f32 v253, v206, v207
v_mfma_f32_16x16x32_bf16 v[228:231], a[116:119], a[52:55], v[228:231]
s_and_b32 s5, s5, 0xffff
v_exp_f32 v208, v208
v_mfma_f32_16x16x32_bf16 v[228:231], a[120:123], a[56:59], v[228:231]
s_add_u32 s96, s88, s32
ds_read_b128 a[104:107], v1 offset:18432
v_mfma_f32_16x16x32_bf16 v[228:231], a[124:127], a[60:63], v[228:231]
s_waitcnt lgkmcnt(7)
s_add_u32 s97, s89, s32
v_exp_f32 v209, v209
v_mfma_f32_16x16x32_bf16 v[104:107], a[128:131], v[236:239], v[104:107]
ds_read_b128 a[148:151], v2 offset:5120
v_cvt_pk_bf16_f32 v64, v208, v209
v_mfma_f32_16x16x32_bf16 v[136:139], a[128:131], v[240:243], v[136:139]
s_add_u32 s98, s90, s32
v_exp_f32 v210, v210
v_mfma_f32_16x16x32_bf16 v[168:171], a[128:131], v[244:247], v[168:171]
s_waitcnt lgkmcnt(7)
s_add_u32 s99, s91, s32
ds_read_b128 a[108:111], v1 offset:19456
v_mfma_f32_16x16x32_bf16 v[172:175], a[132:135], v[244:247], v[172:175]
v_exp_f32 v211, v211
v_mfma_f32_16x16x32_bf16 v[140:143], a[132:135], v[240:243], v[140:143]
ds_read_b128 a[152:155], v2 offset:6144
v_cvt_pk_bf16_f32 v65, v210, v211
v_mfma_f32_16x16x32_bf16 v[108:111], a[132:135], v[236:239], v[108:111]
s_waitcnt lgkmcnt(8)
v_exp_f32 v212, v212
v_mfma_f32_16x16x32_bf16 v[112:115], a[136:139], v[236:239], v[112:115]
s_waitcnt vmcnt(15)
ds_read_b128 a[112:115], v1 offset:20480
v_bfe_u32 v24, v0, 4, 4
v_mfma_f32_16x16x32_bf16 v[144:147], a[136:139], v[240:243], v[144:147]
v_exp_f32 v213, v213
v_mfma_f32_16x16x32_bf16 v[176:179], a[136:139], v[244:247], v[176:179]
s_waitcnt lgkmcnt(7)
ds_read_b128 a[156:159], v2 offset:7168
v_cvt_pk_bf16_f32 v68, v212, v213
v_mfma_f32_16x16x32_bf16 v[180:183], a[140:143], v[244:247], v[180:183]
v_exp_f32 v214, v214
v_mfma_f32_16x16x32_bf16 v[148:151], a[140:143], v[240:243], v[148:151]
ds_read_b128 a[116:119], v1 offset:21504
v_lshrrev_b32 v25, 8, v0
v_mfma_f32_16x16x32_bf16 v[116:119], a[140:143], v[236:239], v[116:119]
s_waitcnt lgkmcnt(7)
v_exp_f32 v215, v215
v_mfma_f32_16x16x32_bf16 v[120:123], a[144:147], v[236:239], v[120:123]
v_cvt_pk_bf16_f32 v69, v214, v215
v_add_u32 v2, s12, v3
v_mfma_f32_16x16x32_bf16 v[152:155], a[144:147], v[240:243], v[152:155]
v_exp_f32 v220, v220
v_mfma_f32_16x16x32_bf16 v[184:187], a[144:147], v[244:247], v[184:187]
s_waitcnt vmcnt(14) lgkmcnt(5)
ds_read_b128 a[120:123], v1 offset:22528
v_lshrrev_b32 v26, 1, v24
v_mfma_f32_16x16x32_bf16 v[188:191], a[148:151], v[244:247], v[188:191]
v_exp_f32 v221, v221
v_mfma_f32_16x16x32_bf16 v[156:159], a[148:151], v[240:243], v[156:159]
v_cvt_pk_bf16_f32 v254, v220, v221
v_and_b32 v254, v254, v18
v_mfma_f32_16x16x32_bf16 v[124:127], a[148:151], v[236:239], v[124:127]
s_waitcnt lgkmcnt(4)
v_exp_f32 v222, v222
v_mfma_f32_16x16x32_bf16 v[128:131], a[152:155], v[236:239], v[128:131]
ds_read_b128 a[124:127], v1 offset:23552
v_xor_b32 v26, v26, v25
v_mfma_f32_16x16x32_bf16 v[160:163], a[152:155], v[240:243], v[160:163]
v_exp_f32 v223, v223
v_mfma_f32_16x16x32_bf16 v[192:195], a[152:155], v[244:247], v[192:195]
s_waitcnt lgkmcnt(3)
v_cvt_pk_bf16_f32 v255, v222, v223
v_and_b32 v255, v255, v19
v_mfma_f32_16x16x32_bf16 v[196:199], a[156:159], v[244:247], v[196:199]
v_exp_f32 v224, v224
v_mfma_f32_16x16x32_bf16 v[164:167], a[156:159], v[240:243], v[164:167]
v_and_b32 v27, 16, v0
v_lshl_or_b32 v27, v25, 10, v27
v_mfma_f32_16x16x32_bf16 v[132:135], a[156:159], v[236:239], v[132:135]
v_exp_f32 v225, v225
v_mfma_f32_16x16x32_bf16 a[164:167], a[184:187], v[236:239], a[164:167]
v_cvt_pk_bf16_f32 v66, v224, v225
v_add_u32 v1, s11, v0
v_mfma_f32_16x16x32_bf16 a[168:171], a[184:187], v[240:243], a[168:171]
s_waitcnt vmcnt(9)
v_lshl_or_b32 v27, v26, 5, v27
v_add_u32 v36, s34, v27
v_mfma_f32_16x16x32_bf16 a[172:175], a[184:187], v[244:247], a[172:175]
s_waitcnt vmcnt(8)
v_xor_b32 v27, 128, v36
v_add_u32 v37, 3072, v27
v_lshlrev_b32 v25, 4, v25
v_lshl_or_b32 v38, v24, 10, v25
v_add_u32 v26, s35, v0
v_xor_b32 v27, 0x8000, v26
v_lshrrev_b32 v28, 2, v0
v_add_u32 v28, s33, v28
v_xor_b32 v29, 1024, v28
v_lshlrev_b32 v30, 2, v0
s_waitcnt vmcnt(4)
s_mov_b64 exec, 1
buffer_store_dword v3, off, s[76:79], s44 offset:128 sc1
s_mov_b64 exec, -1
s_cmp_eq_u32 s82, 7
s_cbranch_scc1 LA_t70
v_mfma_f32_16x16x32_bf16 v[200:203], a[96:99], a[64:67], v[56:59]
s_waitcnt vmcnt(63) lgkmcnt(0)
s_barrier
v_mfma_f32_16x16x32_bf16 v[200:203], a[100:103], a[68:71], v[200:203]
s_add_u32 s12, s12, 8192
v_exp_f32 v226, v226
v_mfma_f32_16x16x32_bf16 v[200:203], a[104:107], a[72:75], v[200:203]
s_and_b32 s12, s12, 0xffff
s_add_u32 s11, s11, 16384
s_add_u32 m0, s5, s6
v_mfma_f32_16x16x32_bf16 v[200:203], a[108:111], a[76:79], v[200:203]
s_and_b32 s11, s11, 0xffff
v_exp_f32 v227, v227
v_mfma_f32_16x16x32_bf16 v[204:207], a[108:111], a[92:95], v[60:63]
ds_read_b128 a[128:131], v2 offset:0
v_cvt_pk_bf16_f32 v67, v226, v227
v_mfma_f32_16x16x32_bf16 v[204:207], a[104:107], a[88:91], v[204:207]
v_exp_f32 v228, v228
v_mfma_f32_16x16x32_bf16 v[204:207], a[100:103], a[84:87], v[204:207]
buffer_load_dwordx4 v0, s[20:23], s4 offen offset:0 sc1 lds
v_mfma_f32_16x16x32_bf16 v[204:207], a[96:99], a[80:83], v[204:207]
v_exp_f32 v229, v229
v_mfma_f32_16x16x32_bf16 v[208:211], a[96:99], a[32:35], v[48:51]
ds_read_b128 a[132:135], v2 offset:1024
v_cvt_pk_bf16_f32 v70, v228, v229
v_mfma_f32_16x16x32_bf16 v[208:211], a[100:103], a[36:39], v[208:211]
v_exp_f32 v230, v230
v_mfma_f32_16x16x32_bf16 v[208:211], a[104:107], a[40:43], v[208:211]
buffer_load_dwordx4 v0, s[20:23], s4 offen offset:1024 sc1 lds
v_mfma_f32_16x16x32_bf16 v[208:211], a[108:111], a[44:47], v[208:211]
v_exp_f32 v231, v231
v_mfma_f32_16x16x32_bf16 v[212:215], a[108:111], a[60:63], v[52:55]
ds_read_b128 a[136:139], v2 offset:2048
v_cvt_pk_bf16_f32 v71, v230, v231
v_mfma_f32_16x16x32_bf16 v[212:215], a[104:107], a[56:59], v[212:215]
v_exp_f32 v200, v200
v_mfma_f32_16x16x32_bf16 v[212:215], a[100:103], a[52:55], v[212:215]
buffer_load_dwordx4 v0, s[20:23], s4 offen offset:2048 sc1 lds
v_mfma_f32_16x16x32_bf16 v[212:215], a[96:99], a[48:51], v[212:215]
v_exp_f32 v201, v201
v_mfma_f32_16x16x32_bf16 v[216:219], a[112:115], a[64:67], v[56:59]
ds_read_b128 a[140:143], v2 offset:3072
v_cvt_pk_bf16_f32 v232, v200, v201
v_mfma_f32_16x16x32_bf16 v[216:219], a[116:119], a[68:71], v[216:219]
v_exp_f32 v202, v202
v_mfma_f32_16x16x32_bf16 v[216:219], a[120:123], a[72:75], v[216:219]
buffer_load_dwordx4 v0, s[20:23], s4 offen offset:3072 sc1 lds
v_mfma_f32_16x16x32_bf16 v[216:219], a[124:127], a[76:79], v[216:219]
s_add_u32 s4, s4, 16384
v_exp_f32 v203, v203
v_mfma_f32_16x16x32_bf16 v[220:223], a[124:127], a[92:95], v[60:63]
s_add_u32 s5, s5, 8192
ds_read_b128 a[144:147], v2 offset:4096
v_cvt_pk_bf16_f32 v233, v202, v203
v_mfma_f32_16x16x32_bf16 v[220:223], a[120:123], a[88:91], v[220:223]
s_and_b32 s5, s5, 0xffff
v_exp_f32 v204, v204
v_mfma_f32_16x16x32_bf16 v[220:223], a[116:119], a[84:87], v[220:223]
s_lshl_b32 s74, s82, 15
s_add_u32 s75, s74, 106496
ds_read_b128 a[96:99], v1 offset:16384
v_mfma_f32_16x16x32_bf16 v[220:223], a[112:115], a[80:83], v[220:223]
s_and_b32 s75, s75, 0xffff
v_exp_f32 v205, v205
v_mfma_f32_16x16x32_bf16 v[224:227], a[112:115], a[32:35], v[48:51]
s_add_u32 m0, s75, 16384
ds_read_b128 a[148:151], v2 offset:5120
v_cvt_pk_bf16_f32 v236, v204, v205
v_mfma_f32_16x16x32_bf16 v[224:227], a[116:119], a[36:39], v[224:227]
s_lshl_b32 s74, s74, 1
v_exp_f32 v206, v206
v_mfma_f32_16x16x32_bf16 v[224:227], a[120:123], a[40:43], v[224:227]
s_add_u32 s74, s74, 212992
ds_read_b128 a[100:103], v1 offset:17408
v_mfma_f32_16x16x32_bf16 v[224:227], a[124:127], a[44:47], v[224:227]
v_exp_f32 v207, v207
v_mfma_f32_16x16x32_bf16 v[228:231], a[124:127], a[60:63], v[52:55]
ds_read_b128 a[152:155], v2 offset:6144
v_cvt_pk_bf16_f32 v237, v206, v207
v_mfma_f32_16x16x32_bf16 v[228:231], a[120:123], a[56:59], v[228:231]
v_exp_f32 v208, v208
v_mfma_f32_16x16x32_bf16 v[228:231], a[116:119], a[52:55], v[228:231]
ds_read_b128 a[104:107], v1 offset:18432
buffer_load_dwordx4 v0, s[20:23], s74 offen offset:0 sc1 lds
v_mfma_f32_16x16x32_bf16 v[228:231], a[112:115], a[48:51], v[228:231]
s_waitcnt lgkmcnt(9)
v_exp_f32 v209, v209
v_mfma_f32_16x16x32_bf16 v[104:107], a[128:131], v[252:255], v[104:107]
ds_read_b128 a[156:159], v2 offset:7168
v_cvt_pk_bf16_f32 v240, v208, v209
v_mfma_f32_16x16x32_bf16 v[136:139], a[128:131], v[64:67], v[136:139]
v_exp_f32 v210, v210
v_mfma_f32_16x16x32_bf16 v[168:171], a[128:131], v[68:71], v[168:171]
s_waitcnt lgkmcnt(9)
ds_read_b128 a[108:111], v1 offset:19456
buffer_load_dwordx4 v0, s[20:23], s74 offen offset:1024 sc1 lds
v_mfma_f32_16x16x32_bf16 v[172:175], a[132:135], v[68:71], v[172:175]
s_lshl_b32 s13, s82, 1
v_exp_f32 v211, v211
v_mfma_f32_16x16x32_bf16 v[140:143], a[132:135], v[64:67], v[140:143]
s_sub_u32 s13, 12, s13
v_cvt_pk_bf16_f32 v241, v210, v211
v_add_u32 v2, s12, v3
v_mfma_f32_16x16x32_bf16 v[108:111], a[132:135], v[252:255], v[108:111]
s_waitcnt lgkmcnt(9)
s_lshr_b32 s19, s80, 1
v_exp_f32 v212, v212
v_mfma_f32_16x16x32_bf16 v[112:115], a[136:139], v[252:255], v[112:115]
s_lshl1_add_u32 s18, s85, s19
s_lshl_b32 s18, s18, 9
s_add_u32 s18, s18, s84
v_mfma_f32_16x16x32_bf16 v[144:147], a[136:139], v[64:67], v[144:147]
s_lshl_b32 s18, s18, 7
v_exp_f32 v213, v213
v_mfma_f32_16x16x32_bf16 v[176:179], a[136:139], v[68:71], v[176:179]
s_waitcnt lgkmcnt(8)
s_lshl_b32 s19, s19, 13
ds_read_b128 a[112:115], v1 offset:20480
v_cvt_pk_bf16_f32 v244, v212, v213
v_mfma_f32_16x16x32_bf16 v[180:183], a[140:143], v[68:71], v[180:183]
s_mul_i32 s34, s3, 147456
v_exp_f32 v214, v214
v_mfma_f32_16x16x32_bf16 v[148:151], a[140:143], v[64:67], v[148:151]
s_add_u32 s19, s19, s34
s_add_u32 m0, s19, 0
v_mfma_f32_16x16x32_bf16 v[116:119], a[140:143], v[252:255], v[116:119]
s_waitcnt lgkmcnt(8)
v_exp_f32 v215, v215
v_mfma_f32_16x16x32_bf16 v[120:123], a[144:147], v[252:255], v[120:123]
ds_read_b128 a[116:119], v1 offset:21504
v_cvt_pk_bf16_f32 v245, v214, v215
v_mfma_f32_16x16x32_bf16 v[152:155], a[144:147], v[64:67], v[152:155]
v_exp_f32 v216, v216
v_mfma_f32_16x16x32_bf16 v[184:187], a[144:147], v[68:71], v[184:187]
s_waitcnt lgkmcnt(7)
buffer_load_dwordx4 v38, s[52:55], s18 offen offset:0 lds
v_mfma_f32_16x16x32_bf16 v[188:191], a[148:151], v[68:71], v[188:191]
s_add_u32 m0, s19, 960
v_exp_f32 v217, v217
v_mfma_f32_16x16x32_bf16 v[156:159], a[148:151], v[64:67], v[156:159]
ds_read_b128 a[120:123], v1 offset:22528
v_cvt_pk_bf16_f32 v234, v216, v217
v_mfma_f32_16x16x32_bf16 v[124:127], a[148:151], v[252:255], v[124:127]
s_waitcnt lgkmcnt(6)
v_exp_f32 v218, v218
v_mfma_f32_16x16x32_bf16 v[128:131], a[152:155], v[252:255], v[128:131]
buffer_load_dwordx4 v38, s[52:55], s18 offen offset:64 lds
v_mfma_f32_16x16x32_bf16 v[160:163], a[152:155], v[64:67], v[160:163]
s_add_u32 s18, s18, 16384
v_exp_f32 v219, v219
v_mfma_f32_16x16x32_bf16 v[192:195], a[152:155], v[68:71], v[192:195]
s_waitcnt lgkmcnt(4)
s_add_u32 m0, s19, 2048
ds_read_b128 a[124:127], v1 offset:23552
v_cvt_pk_bf16_f32 v235, v218, v219
v_mfma_f32_16x16x32_bf16 v[196:199], a[156:159], v[68:71], v[196:199]
v_exp_f32 v220, v220
v_mfma_f32_16x16x32_bf16 v[164:167], a[156:159], v[64:67], v[164:167]
buffer_load_dwordx4 v38, s[52:55], s18 offen offset:0 lds
v_mfma_f32_16x16x32_bf16 v[132:135], a[156:159], v[252:255], v[132:135]
s_add_u32 m0, s19, 3008
v_exp_f32 v221, v221
v_mfma_f32_16x16x32_bf16 a[164:167], a[184:187], v[252:255], a[164:167]
v_cvt_pk_bf16_f32 v238, v220, v221
v_add_u32 v1, s11, v0
v_mfma_f32_16x16x32_bf16 a[168:171], a[184:187], v[64:67], a[168:171]
v_exp_f32 v222, v222
v_mfma_f32_16x16x32_bf16 a[172:175], a[184:187], v[68:71], a[172:175]
buffer_load_dwordx4 v38, s[52:55], s18 offen offset:64 lds
v_exp_f32 v223, v223
s_nop 0
v_cvt_pk_bf16_f32 v239, v222, v223
s_add_u32 s18, s18, 16384
s_branch LA_l2p
LA_p20_s:
s_sleep 2
v_bfe_u32 v20, v0, 2, 7
buffer_load_dword v20, v20, s[76:79], s40 offen offset:0 sc1
s_waitcnt vmcnt(0)
v_cmp_lt_u32 s[32:33], 0, v20
s_nop 0
s_andn2_b32 s33, 16776960, s32
s_cbranch_scc1 LA_p20_s
s_branch LA_p20
LA_p40_s:
s_sleep 2
v_bfe_u32 v22, v0, 2, 7
buffer_load_dword v22, v22, s[76:79], s41 offen offset:0 sc1
s_waitcnt vmcnt(0)
v_cmp_lt_u32 s[32:33], 0, v22
s_nop 0
s_andn2_b32 s33, 255, s32
s_cbranch_scc1 LA_p40_s
s_branch LA_p40
LA_t70:
v_mfma_f32_32x32x16_bf16 a[0:15], a[224:227], a[224:227], 0
v_mfma_f32_32x32x16_bf16 a[16:31], a[224:227], a[224:227], 0
v_mfma_f32_16x16x32_bf16 v[200:203], a[96:99], a[64:67], v[56:59]
s_waitcnt vmcnt(63) lgkmcnt(0)
s_barrier
v_mfma_f32_16x16x32_bf16 v[200:203], a[100:103], a[68:71], v[200:203]
s_add_u32 s12, s12, 8192
v_exp_f32 v226, v226
v_mfma_f32_16x16x32_bf16 v[200:203], a[104:107], a[72:75], v[200:203]
s_and_b32 s12, s12, 0xffff
s_add_u32 s11, s11, 8192
s_lshr_b32 s19, s80, 1
v_mfma_f32_16x16x32_bf16 v[200:203], a[108:111], a[76:79], v[200:203]
s_and_b32 s11, s11, 0xffff
v_exp_f32 v227, v227
v_mfma_f32_16x16x32_bf16 v[204:207], a[108:111], a[92:95], v[60:63]
s_lshl1_add_u32 s18, s85, s19
ds_read_b128 a[128:131], v2 offset:0
v_cvt_pk_bf16_f32 v67, v226, v227
v_mfma_f32_16x16x32_bf16 v[204:207], a[104:107], a[88:91], v[204:207]
s_lshl_b32 s18, s18, 9
v_exp_f32 v228, v228
v_mfma_f32_16x16x32_bf16 v[204:207], a[100:103], a[84:87], v[204:207]
s_add_u32 s18, s18, s84
s_lshl_b32 s18, s18, 7
s_lshl_b32 s19, s19, 13
v_mfma_f32_16x16x32_bf16 v[204:207], a[96:99], a[80:83], v[204:207]
s_mul_i32 s34, s3, 147456
v_exp_f32 v229, v229
v_mfma_f32_16x16x32_bf16 v[208:211], a[96:99], a[32:35], v[48:51]
s_add_u32 s19, s19, s34
ds_read_b128 a[132:135], v2 offset:1024
v_cvt_pk_bf16_f32 v70, v228, v229
v_mfma_f32_16x16x32_bf16 v[208:211], a[100:103], a[36:39], v[208:211]
s_add_u32 m0, s19, 0
v_exp_f32 v230, v230
v_mfma_f32_16x16x32_bf16 v[208:211], a[104:107], a[40:43], v[208:211]
buffer_load_dwordx4 v38, s[52:55], s18 offen offset:0 lds
v_mfma_f32_16x16x32_bf16 v[208:211], a[108:111], a[44:47], v[208:211]
s_add_u32 m0, s19, 960
v_exp_f32 v231, v231
v_mfma_f32_16x16x32_bf16 v[212:215], a[108:111], a[60:63], v[52:55]
ds_read_b128 a[136:139], v2 offset:2048
v_cvt_pk_bf16_f32 v71, v230, v231
v_mfma_f32_16x16x32_bf16 v[212:215], a[104:107], a[56:59], v[212:215]
v_exp_f32 v200, v200
v_mfma_f32_16x16x32_bf16 v[212:215], a[100:103], a[52:55], v[212:215]
buffer_load_dwordx4 v38, s[52:55], s18 offen offset:64 lds
v_mfma_f32_16x16x32_bf16 v[212:215], a[96:99], a[48:51], v[212:215]
s_add_u32 s18, s18, 16384
v_exp_f32 v201, v201
v_mfma_f32_16x16x32_bf16 v[216:219], a[112:115], a[64:67], v[56:59]
s_add_u32 m0, s19, 2048
ds_read_b128 a[140:143], v2 offset:3072
v_cvt_pk_bf16_f32 v232, v200, v201
v_mfma_f32_16x16x32_bf16 v[216:219], a[116:119], a[68:71], v[216:219]
v_exp_f32 v202, v202
v_mfma_f32_16x16x32_bf16 v[216:219], a[120:123], a[72:75], v[216:219]
ds_read_b128 a[96:99], v1 offset:16384
buffer_load_dwordx4 v38, s[52:55], s18 offen offset:0 lds
v_mfma_f32_16x16x32_bf16 v[216:219], a[124:127], a[76:79], v[216:219]
s_add_u32 m0, s19, 3008
v_exp_f32 v203, v203
v_mfma_f32_16x16x32_bf16 v[220:223], a[124:127], a[92:95], v[60:63]
ds_read_b128 a[144:147], v2 offset:4096
v_cvt_pk_bf16_f32 v233, v202, v203
v_mfma_f32_16x16x32_bf16 v[220:223], a[120:123], a[88:91], v[220:223]
v_exp_f32 v204, v204
v_mfma_f32_16x16x32_bf16 v[220:223], a[116:119], a[84:87], v[220:223]
ds_read_b128 a[100:103], v1 offset:17408
buffer_load_dwordx4 v38, s[52:55], s18 offen offset:64 lds
v_mfma_f32_16x16x32_bf16 v[220:223], a[112:115], a[80:83], v[220:223]
s_add_u32 s18, s18, 16384
v_exp_f32 v205, v205
v_mfma_f32_16x16x32_bf16 v[228:231], a[112:115], a[48:51], v[52:55]
ds_read_b128 a[148:151], v2 offset:5120
v_cvt_pk_bf16_f32 v236, v204, v205
v_bfe_u32 v20, v0, 2, 7
v_mfma_f32_16x16x32_bf16 v[228:231], a[116:119], a[52:55], v[228:231]
v_exp_f32 v206, v206
v_mfma_f32_16x16x32_bf16 v[228:231], a[120:123], a[56:59], v[228:231]
ds_read_b128 a[104:107], v1 offset:18432
buffer_load_dword v20, v20, s[76:79], s42 offen offset:128 sc1
v_mfma_f32_16x16x32_bf16 v[228:231], a[124:127], a[60:63], v[228:231]
s_waitcnt lgkmcnt(8)
s_add_u32 m0, s19, 4096
v_exp_f32 v207, v207
v_mfma_f32_16x16x32_bf16 v[104:107], a[128:131], v[252:255], v[104:107]
ds_read_b128 a[152:155], v2 offset:6144
v_cvt_pk_bf16_f32 v237, v206, v207
v_mfma_f32_16x16x32_bf16 v[136:139], a[128:131], v[64:67], v[136:139]
v_exp_f32 v208, v208
v_mfma_f32_16x16x32_bf16 v[168:171], a[128:131], v[68:71], v[168:171]
s_waitcnt lgkmcnt(8)
ds_read_b128 a[156:159], v2 offset:7168
buffer_load_dwordx4 v38, s[52:55], s18 offen offset:0 lds
v_mfma_f32_16x16x32_bf16 v[172:175], a[132:135], v[68:71], v[172:175]
s_add_u32 m0, s19, 5056
v_exp_f32 v209, v209
v_mfma_f32_16x16x32_bf16 v[140:143], a[132:135], v[64:67], v[140:143]
v_cvt_pk_bf16_f32 v240, v208, v209
v_and_b32 v240, v240, v18
v_mfma_f32_16x16x32_bf16 v[108:111], a[132:135], v[252:255], v[108:111]
s_waitcnt lgkmcnt(8)
v_exp_f32 v210, v210
v_mfma_f32_16x16x32_bf16 v[112:115], a[136:139], v[252:255], v[112:115]
ds_read_b128 a[108:111], v1 offset:19456
v_add_u32 v2, s12, v3
v_mfma_f32_16x16x32_bf16 v[144:147], a[136:139], v[64:67], v[144:147]
v_exp_f32 v211, v211
v_mfma_f32_16x16x32_bf16 v[176:179], a[136:139], v[68:71], v[176:179]
s_waitcnt lgkmcnt(8)
v_cvt_pk_bf16_f32 v241, v210, v211
v_and_b32 v241, v241, v19
v_mfma_f32_16x16x32_bf16 v[180:183], a[140:143], v[68:71], v[180:183]
v_exp_f32 v212, v212
v_mfma_f32_16x16x32_bf16 v[148:151], a[140:143], v[64:67], v[148:151]
ds_read_b128 a[112:115], v1 offset:20480
buffer_load_dwordx4 v38, s[52:55], s18 offen offset:64 lds
v_mfma_f32_16x16x32_bf16 v[116:119], a[140:143], v[252:255], v[116:119]
s_waitcnt lgkmcnt(7)
s_add_u32 s18, s18, 16384
v_exp_f32 v213, v213
v_mfma_f32_16x16x32_bf16 v[120:123], a[144:147], v[252:255], v[120:123]
s_add_u32 m0, s19, 6144
ds_read_b128 a[116:119], v1 offset:21504
v_cvt_pk_bf16_f32 v244, v212, v213
v_mfma_f32_16x16x32_bf16 v[152:155], a[144:147], v[64:67], v[152:155]
v_exp_f32 v214, v214
v_mfma_f32_16x16x32_bf16 v[184:187], a[144:147], v[68:71], v[184:187]
s_waitcnt lgkmcnt(6)
buffer_load_dwordx4 v38, s[52:55], s18 offen offset:0 lds
v_mfma_f32_16x16x32_bf16 v[188:191], a[148:151], v[68:71], v[188:191]
s_add_u32 m0, s19, 7104
v_exp_f32 v215, v215
v_mfma_f32_16x16x32_bf16 v[156:159], a[148:151], v[64:67], v[156:159]
ds_read_b128 a[120:123], v1 offset:22528
v_cvt_pk_bf16_f32 v245, v214, v215
v_mfma_f32_16x16x32_bf16 v[124:127], a[148:151], v[252:255], v[124:127]
s_waitcnt lgkmcnt(5)
v_exp_f32 v216, v216
v_mfma_f32_16x16x32_bf16 v[128:131], a[152:155], v[252:255], v[128:131]
buffer_load_dwordx4 v38, s[52:55], s18 offen offset:64 lds
v_mfma_f32_16x16x32_bf16 v[160:163], a[152:155], v[64:67], v[160:163]
s_add_u32 s18, s18, 16384
v_exp_f32 v217, v217
v_mfma_f32_16x16x32_bf16 v[192:195], a[152:155], v[68:71], v[192:195]
s_waitcnt lgkmcnt(4)
ds_read_b128 a[124:127], v1 offset:23552
v_cvt_pk_bf16_f32 v234, v216, v217
v_mfma_f32_16x16x32_bf16 v[196:199], a[156:159], v[68:71], v[196:199]
v_exp_f32 v218, v218
v_mfma_f32_16x16x32_bf16 v[164:167], a[156:159], v[64:67], v[164:167]
v_lshrrev_b32 v24, 6, v0
v_and_b32 v25, 7, v24
v_mfma_f32_16x16x32_bf16 v[132:135], a[156:159], v[252:255], v[132:135]
v_exp_f32 v219, v219
v_mfma_f32_16x16x32_bf16 a[164:167], a[184:187], v[252:255], a[164:167]
v_cvt_pk_bf16_f32 v235, v218, v219
v_add_u32 v1, s11, v0
v_mfma_f32_16x16x32_bf16 a[168:171], a[184:187], v[64:67], a[168:171]
v_exp_f32 v220, v220
v_mfma_f32_16x16x32_bf16 a[172:175], a[184:187], v[68:71], a[172:175]
v_lshlrev_b32 v25, 5, v25
v_lshl_or_b32 v25, v24, 8, v25
v_exp_f32 v221, v221
s_nop 0
v_cvt_pk_bf16_f32 v238, v220, v221
v_exp_f32 v222, v222
v_exp_f32 v223, v223
s_nop 0
v_cvt_pk_bf16_f32 v239, v222, v223
v_mov_b32 v242, 0
v_bfe_u32 v24, v0, 4, 2
v_lshl_or_b32 v25, v24, 3, v25
v_add_u32 v17, s17, v25
v_and_b32 v24, 511, v0
v_lshrrev_b32 v25, 9, v0
v_mul_u32_u24 v25, 147456, v25
v_add_u32 v16, v24, v25
v_mov_b32 v31, s50
s_add_u32 s35, s84, 1
s_and_b32 s35, s35, 7
v_lshl_add_u32 v8, s35, 11, v16
s_add_u32 s35, s84, 2
s_and_b32 s35, s35, 7
v_lshl_add_u32 v9, s35, 11, v16
s_add_u32 s35, s84, 3
s_and_b32 s35, s35, 7
v_lshl_add_u32 v10, s35, 11, v16
s_add_u32 s35, s84, 4
s_and_b32 s35, s35, 7
v_lshl_add_u32 v11, s35, 11, v16
s_add_u32 s35, s84, 5
s_and_b32 s35, s35, 7
v_lshl_add_u32 v12, s35, 11, v16
s_add_u32 s35, s84, 6
s_and_b32 s35, s35, 7
v_lshl_add_u32 v13, s35, 11, v16
s_add_u32 s35, s84, 7
s_and_b32 s35, s35, 7
v_lshl_add_u32 v14, s35, 11, v16
s_add_u32 s35, s84, 8
s_and_b32 s35, s35, 7
v_lshl_add_u32 v15, s35, 11, v16
v_accvgpr_read_b32 v24, a160
v_accvgpr_read_b32 v25, a164
v_subrev_u32 v21, 0x30800000, v24
v_rcp_f32 v24, v24
s_nop 0
v_mul_f32 v24, v24, v4
v_subrev_u32 v22, 0x30800000, v25
v_max_u32 v21, v21, v22
v_rcp_f32 v25, v25
s_nop 0
v_mul_f32 v25, v25, v5
v_cmp_lt_u32 vcc, 0x23000000, v21
v_pk_mul_f32 v[72:73], v[72:73], v[24:25] op_sel:[0,0] op_sel_hi:[1,0]
v_pk_mul_f32 v[74:75], v[74:75], v[24:25] op_sel:[0,0] op_sel_hi:[1,0]
v_pk_mul_f32 v[76:77], v[76:77], v[24:25] op_sel:[0,0] op_sel_hi:[1,0]
v_pk_mul_f32 v[78:79], v[78:79], v[24:25] op_sel:[0,0] op_sel_hi:[1,0]
v_cvt_pk_bf16_f32 v72, v72, v73
v_cvt_pk_bf16_f32 v73, v74, v75
v_cvt_pk_bf16_f32 v74, v76, v77
v_cvt_pk_bf16_f32 v75, v78, v79
buffer_store_dwordx4 v[72:75], v0, s[76:79], s88 offen offset:0 sc1
v_pk_mul_f32 v[80:81], v[80:81], v[24:25] op_sel:[0,0] op_sel_hi:[1,0]
v_pk_mul_f32 v[82:83], v[82:83], v[24:25] op_sel:[0,0] op_sel_hi:[1,0]
v_pk_mul_f32 v[84:85], v[84:85], v[24:25] op_sel:[0,0] op_sel_hi:[1,0]
v_pk_mul_f32 v[86:87], v[86:87], v[24:25] op_sel:[0,0] op_sel_hi:[1,0]
v_cvt_pk_bf16_f32 v76, v80, v81
v_cvt_pk_bf16_f32 v77, v82, v83
v_cvt_pk_bf16_f32 v78, v84, v85
v_cvt_pk_bf16_f32 v79, v86, v87
buffer_store_dwordx4 v[76:79], v0, s[76:79], s88 offen offset:1024 sc1
v_pk_mul_f32 v[88:89], v[88:89], v[24:25] op_sel:[0,0] op_sel_hi:[1,0]
v_pk_mul_f32 v[90:91], v[90:91], v[24:25] op_sel:[0,0] op_sel_hi:[1,0]
v_pk_mul_f32 v[92:93], v[92:93], v[24:25] op_sel:[0,0] op_sel_hi:[1,0]
v_pk_mul_f32 v[94:95], v[94:95], v[24:25] op_sel:[0,0] op_sel_hi:[1,0]
v_cvt_pk_bf16_f32 v80, v88, v89
v_cvt_pk_bf16_f32 v81, v90, v91
v_cvt_pk_bf16_f32 v82, v92, v93
v_cvt_pk_bf16_f32 v83, v94, v95
buffer_store_dwordx4 v[80:83], v0, s[76:79], s88 offen offset:2048 sc1
v_pk_mul_f32 v[96:97], v[96:97], v[24:25] op_sel:[0,0] op_sel_hi:[1,0]
v_pk_mul_f32 v[98:99], v[98:99], v[24:25] op_sel:[0,0] op_sel_hi:[1,0]
v_pk_mul_f32 v[100:101], v[100:101], v[24:25] op_sel:[0,0] op_sel_hi:[1,0]
v_pk_mul_f32 v[102:103], v[102:103], v[24:25] op_sel:[0,0] op_sel_hi:[1,0]
v_cvt_pk_bf16_f32 v84, v96, v97
v_cvt_pk_bf16_f32 v85, v98, v99
v_cvt_pk_bf16_f32 v86, v100, v101
v_cvt_pk_bf16_f32 v87, v102, v103
buffer_store_dwordx4 v[84:87], v0, s[76:79], s88 offen offset:3072 sc1
v_pk_mul_f32 v[104:105], v[104:105], v[24:25] op_sel:[0,1] op_sel_hi:[1,1]
v_pk_mul_f32 v[106:107], v[106:107], v[24:25] op_sel:[0,1] op_sel_hi:[1,1]
v_pk_mul_f32 v[108:109], v[108:109], v[24:25] op_sel:[0,1] op_sel_hi:[1,1]
v_pk_mul_f32 v[110:111], v[110:111], v[24:25] op_sel:[0,1] op_sel_hi:[1,1]
v_cvt_pk_bf16_f32 v88, v104, v105
v_cvt_pk_bf16_f32 v89, v106, v107
v_cvt_pk_bf16_f32 v90, v108, v109
v_cvt_pk_bf16_f32 v91, v110, v111
buffer_store_dwordx4 v[88:91], v0, s[76:79], s89 offen offset:0 sc1
v_pk_mul_f32 v[112:113], v[112:113], v[24:25] op_sel:[0,1] op_sel_hi:[1,1]
v_pk_mul_f32 v[114:115], v[114:115], v[24:25] op_sel:[0,1] op_sel_hi:[1,1]
v_pk_mul_f32 v[116:117], v[116:117], v[24:25] op_sel:[0,1] op_sel_hi:[1,1]
v_pk_mul_f32 v[118:119], v[118:119], v[24:25] op_sel:[0,1] op_sel_hi:[1,1]
v_cvt_pk_bf16_f32 v92, v112, v113
v_cvt_pk_bf16_f32 v93, v114, v115
v_cvt_pk_bf16_f32 v94, v116, v117
v_cvt_pk_bf16_f32 v95, v118, v119
buffer_store_dwordx4 v[92:95], v0, s[76:79], s89 offen offset:1024 sc1
v_pk_mul_f32 v[120:121], v[120:121], v[24:25] op_sel:[0,1] op_sel_hi:[1,1]
v_pk_mul_f32 v[122:123], v[122:123], v[24:25] op_sel:[0,1] op_sel_hi:[1,1]
v_pk_mul_f32 v[124:125], v[124:125], v[24:25] op_sel:[0,1] op_sel_hi:[1,1]
v_pk_mul_f32 v[126:127], v[126:127], v[24:25] op_sel:[0,1] op_sel_hi:[1,1]
v_cvt_pk_bf16_f32 v96, v120, v121
v_cvt_pk_bf16_f32 v97, v122, v123
v_cvt_pk_bf16_f32 v98, v124, v125
v_cvt_pk_bf16_f32 v99, v126, v127
buffer_store_dwordx4 v[96:99], v0, s[76:79], s89 offen offset:2048 sc1
v_pk_mul_f32 v[128:129], v[128:129], v[24:25] op_sel:[0,1] op_sel_hi:[1,1]
v_pk_mul_f32 v[130:131], v[130:131], v[24:25] op_sel:[0,1] op_sel_hi:[1,1]
v_pk_mul_f32 v[132:133], v[132:133], v[24:25] op_sel:[0,1] op_sel_hi:[1,1]
v_pk_mul_f32 v[134:135], v[134:135], v[24:25] op_sel:[0,1] op_sel_hi:[1,1]
v_cvt_pk_bf16_f32 v100, v128, v129
v_cvt_pk_bf16_f32 v101, v130, v131
v_cvt_pk_bf16_f32 v102, v132, v133
v_cvt_pk_bf16_f32 v103, v134, v135
buffer_store_dwordx4 v[100:103], v0, s[76:79], s89 offen offset:3072 sc1
s_cmp_eq_u64 vcc, 0
s_cselect_b32 s87, 1, s16
LA_p50_r:
s_waitcnt vmcnt(12)
v_cmp_lt_u32 vcc, 0, v20
s_nop 0
s_and_b32 s74, vcc_lo, 65535
s_cmp_eq_u32 s74, 65535
s_cbranch_scc1 LA_p50
s_sleep 2
v_bfe_u32 v20, v0, 2, 7
buffer_load_dword v20, v20, s[76:79], s42 offen offset:128 sc1
s_waitcnt vmcnt(0)
s_branch LA_p50_r
LA_p50:
buffer_load_dwordx4 a[192:195], v0, s[76:79], s96 offen offset:0 sc1
buffer_load_dwordx4 a[196:199], v0, s[76:79], s97 offen offset:0 sc1
buffer_load_dwordx4 a[200:203], v0, s[76:79], s98 offen offset:0 sc1
buffer_load_dwordx4 a[204:207], v0, s[76:79], s99 offen offset:0 sc1
buffer_load_dwordx4 a[208:211], v0, s[76:79], s96 offen offset:1024 sc1
buffer_load_dwordx4 a[212:215], v0, s[76:79], s97 offen offset:1024 sc1
buffer_load_dwordx4 a[216:219], v0, s[76:79], s98 offen offset:1024 sc1
buffer_load_dwordx4 a[220:223], v0, s[76:79], s99 offen offset:1024 sc1
buffer_load_dwordx4 v[104:107], v0, s[76:79], s96 offen offset:2048 sc1
buffer_load_dwordx4 v[108:111], v0, s[76:79], s97 offen offset:2048 sc1
buffer_load_dwordx4 v[112:115], v0, s[76:79], s98 offen offset:2048 sc1
buffer_load_dwordx4 v[116:119], v0, s[76:79], s99 offen offset:2048 sc1
buffer_load_dwordx4 v[120:123], v0, s[76:79], s96 offen offset:3072 sc1
buffer_load_dwordx4 v[124:127], v0, s[76:79], s97 offen offset:3072 sc1
buffer_load_dwordx4 v[128:131], v0, s[76:79], s98 offen offset:3072 sc1
buffer_load_dwordx4 v[132:135], v0, s[76:79], s99 offen offset:3072 sc1
s_waitcnt vmcnt(24)
s_branch LA_d20
LA_d10:
s_waitcnt lgkmcnt(7)
v_mfma_f32_16x16x32_bf16 v[200:203], a[96:99], a[64:67], v[56:59]
s_waitcnt vmcnt(23) lgkmcnt(0)
s_barrier
v_mfma_f32_16x16x32_bf16 v[200:203], a[100:103], a[68:71], v[200:203]
s_add_u32 s12, s12, 16384
v_exp_f32 v226, v226
v_mfma_f32_16x16x32_bf16 v[200:203], a[104:107], a[72:75], v[200:203]
s_and_b32 s12, s12, 0xffff
s_add_u32 s11, s11, 8192
v_mfma_f32_16x16x32_bf16 v[200:203], a[108:111], a[76:79], v[200:203]
s_and_b32 s11, s11, 0xffff
v_exp_f32 v227, v227
v_mfma_f32_16x16x32_bf16 v[204:207], a[108:111], a[92:95], v[60:63]
ds_read_b128 a[128:131], v2 offset:0
v_cvt_pk_bf16_f32 v67, v226, v227
v_mfma_f32_16x16x32_bf16 v[204:207], a[104:107], a[88:91], v[204:207]
v_exp_f32 v228, v228
v_mfma_f32_16x16x32_bf16 v[204:207], a[100:103], a[84:87], v[204:207]
buffer_load_dwordx4 v[104:107], v0, s[76:79], s96 offen offset:2048 sc1
v_mfma_f32_16x16x32_bf16 v[204:207], a[96:99], a[80:83], v[204:207]
v_exp_f32 v229, v229
v_mfma_f32_16x16x32_bf16 v[208:211], a[96:99], a[32:35], v[48:51]
ds_read_b128 a[132:135], v2 offset:1024
v_cvt_pk_bf16_f32 v70, v228, v229
v_mfma_f32_16x16x32_bf16 v[208:211], a[100:103], a[36:39], v[208:211]
v_exp_f32 v230, v230
v_mfma_f32_16x16x32_bf16 v[208:211], a[104:107], a[40:43], v[208:211]
buffer_load_dwordx4 v[108:111], v0, s[76:79], s97 offen offset:2048 sc1
v_mfma_f32_16x16x32_bf16 v[208:211], a[108:111], a[44:47], v[208:211]
v_exp_f32 v231, v231
v_mfma_f32_16x16x32_bf16 v[212:215], a[108:111], a[60:63], v[52:55]
ds_read_b128 a[136:139], v2 offset:2048
v_cvt_pk_bf16_f32 v71, v230, v231
v_mfma_f32_16x16x32_bf16 v[212:215], a[104:107], a[56:59], v[212:215]
v_exp_f32 v200, v200
v_mfma_f32_16x16x32_bf16 v[212:215], a[100:103], a[52:55], v[212:215]
buffer_load_dwordx4 v[112:115], v0, s[76:79], s98 offen offset:2048 sc1
v_mfma_f32_16x16x32_bf16 v[212:215], a[96:99], a[48:51], v[212:215]
v_exp_f32 v201, v201
v_mfma_f32_16x16x32_bf16 v[216:219], a[112:115], a[64:67], v[56:59]
ds_read_b128 a[140:143], v2 offset:3072
v_cvt_pk_bf16_f32 v232, v200, v201
v_mfma_f32_16x16x32_bf16 v[216:219], a[116:119], a[68:71], v[216:219]
v_exp_f32 v202, v202
v_mfma_f32_16x16x32_bf16 v[216:219], a[120:123], a[72:75], v[216:219]
buffer_load_dwordx4 v[116:119], v0, s[76:79], s99 offen offset:2048 sc1
v_mfma_f32_16x16x32_bf16 v[216:219], a[124:127], a[76:79], v[216:219]
v_exp_f32 v203, v203
v_mfma_f32_16x16x32_bf16 v[220:223], a[124:127], a[92:95], v[60:63]
ds_read_b128 a[144:147], v2 offset:4096
v_cvt_pk_bf16_f32 v233, v202, v203
v_mfma_f32_16x16x32_bf16 v[220:223], a[120:123], a[88:91], v[220:223]
v_exp_f32 v204, v204
v_mfma_f32_16x16x32_bf16 v[220:223], a[116:119], a[84:87], v[220:223]
buffer_load_dwordx4 v[120:123], v0, s[76:79], s96 offen offset:3072 sc1
v_mfma_f32_16x16x32_bf16 v[220:223], a[112:115], a[80:83], v[220:223]
v_exp_f32 v205, v205
v_mfma_f32_16x16x32_bf16 v[228:231], a[112:115], a[48:51], v[52:55]
ds_read_b128 a[148:151], v2 offset:5120
v_cvt_pk_bf16_f32 v236, v204, v205
v_mfma_f32_16x16x32_bf16 v[228:231], a[116:119], a[52:55], v[228:231]
v_exp_f32 v206, v206
v_mfma_f32_16x16x32_bf16 v[228:231], a[120:123], a[56:59], v[228:231]
buffer_load_dwordx4 v[124:127], v0, s[76:79], s97 offen offset:3072 sc1
v_mfma_f32_16x16x32_bf16 v[228:231], a[124:127], a[60:63], v[228:231]
s_waitcnt lgkmcnt(5)
v_exp_f32 v207, v207
v_mfma_f32_16x16x32_bf16 a[0:3], a[128:131], v[248:251], a[0:3]
ds_read_b128 a[152:155], v2 offset:6144
v_cvt_pk_bf16_f32 v237, v206, v207
v_mfma_f32_16x16x32_bf16 a[224:227], a[128:131], v[252:255], a[224:227]
v_exp_f32 v208, v208
v_mfma_f32_16x16x32_bf16 v[136:139], a[128:131], v[64:67], v[136:139]
ds_read_b128 a[156:159], v2 offset:7168
buffer_load_dwordx4 v[128:131], v0, s[76:79], s98 offen offset:3072 sc1
v_mfma_f32_16x16x32_bf16 v[168:171], a[128:131], v[68:71], v[168:171]
s_waitcnt lgkmcnt(6)
v_exp_f32 v209, v209
v_mfma_f32_16x16x32_bf16 v[172:175], a[132:135], v[68:71], v[172:175]
v_cvt_pk_bf16_f32 v240, v208, v209
v_and_b32 v240, v240, v18
v_mfma_f32_16x16x32_bf16 v[140:143], a[132:135], v[64:67], v[140:143]
v_exp_f32 v210, v210
v_mfma_f32_16x16x32_bf16 a[228:231], a[132:135], v[252:255], a[228:231]
ds_read_b128 a[96:99], v1 offset:16384
v_add_u32 v2, s12, v3
v_mfma_f32_16x16x32_bf16 a[4:7], a[132:135], v[248:251], a[4:7]
s_waitcnt lgkmcnt(6)
v_exp_f32 v211, v211
v_mfma_f32_16x16x32_bf16 a[8:11], a[136:139], v[248:251], a[8:11]
v_cvt_pk_bf16_f32 v241, v210, v211
v_and_b32 v241, v241, v19
v_mfma_f32_16x16x32_bf16 a[232:235], a[136:139], v[252:255], a[232:235]
v_exp_f32 v212, v212
v_mfma_f32_16x16x32_bf16 v[144:147], a[136:139], v[64:67], v[144:147]
ds_read_b128 a[100:103], v1 offset:17408
buffer_load_dwordx4 v[132:135], v0, s[76:79], s99 offen offset:3072 sc1
v_mfma_f32_16x16x32_bf16 v[176:179], a[136:139], v[68:71], v[176:179]
s_waitcnt lgkmcnt(6)
v_exp_f32 v213, v213
v_mfma_f32_16x16x32_bf16 v[180:183], a[140:143], v[68:71], v[180:183]
ds_read_b128 a[104:107], v1 offset:18432
v_cvt_pk_bf16_f32 v244, v212, v213
v_mfma_f32_16x16x32_bf16 v[148:151], a[140:143], v[64:67], v[148:151]
v_exp_f32 v214, v214
v_mfma_f32_16x16x32_bf16 a[236:239], a[140:143], v[252:255], a[236:239]
v_mfma_f32_16x16x32_bf16 a[12:15], a[140:143], v[248:251], a[12:15]
s_waitcnt lgkmcnt(6)
v_exp_f32 v215, v215
v_mfma_f32_16x16x32_bf16 a[16:19], a[144:147], v[248:251], a[16:19]
ds_read_b128 a[108:111], v1 offset:19456
v_cvt_pk_bf16_f32 v245, v214, v215
v_mfma_f32_16x16x32_bf16 a[240:243], a[144:147], v[252:255], a[240:243]
v_exp_f32 v216, v216
v_mfma_f32_16x16x32_bf16 v[152:155], a[144:147], v[64:67], v[152:155]
v_mfma_f32_16x16x32_bf16 v[184:187], a[144:147], v[68:71], v[184:187]
s_waitcnt lgkmcnt(6)
v_exp_f32 v217, v217
v_mfma_f32_16x16x32_bf16 v[188:191], a[148:151], v[68:71], v[188:191]
ds_read_b128 a[112:115], v1 offset:20480
v_cvt_pk_bf16_f32 v234, v216, v217
v_mfma_f32_16x16x32_bf16 v[156:159], a[148:151], v[64:67], v[156:159]
v_exp_f32 v218, v218
v_mfma_f32_16x16x32_bf16 a[244:247], a[148:151], v[252:255], a[244:247]
v_mfma_f32_16x16x32_bf16 a[20:23], a[148:151], v[248:251], a[20:23]
s_waitcnt lgkmcnt(6)
v_exp_f32 v219, v219
v_mfma_f32_16x16x32_bf16 a[24:27], a[152:155], v[248:251], a[24:27]
ds_read_b128 a[116:119], v1 offset:21504
v_cvt_pk_bf16_f32 v235, v218, v219
v_mfma_f32_16x16x32_bf16 a[248:251], a[152:155], v[252:255], a[248:251]
v_exp_f32 v220, v220
v_mfma_f32_16x16x32_bf16 v[160:163], a[152:155], v[64:67], v[160:163]
v_mfma_f32_16x16x32_bf16 v[192:195], a[152:155], v[68:71], v[192:195]
s_waitcnt lgkmcnt(6)
v_exp_f32 v221, v221
v_mfma_f32_16x16x32_bf16 v[196:199], a[156:159], v[68:71], v[196:199]
ds_read_b128 a[120:123], v1 offset:22528
v_cvt_pk_bf16_f32 v238, v220, v221
v_mfma_f32_16x16x32_bf16 v[164:167], a[156:159], v[64:67], v[164:167]
v_exp_f32 v222, v222
v_mfma_f32_16x16x32_bf16 a[252:255], a[156:159], v[252:255], a[252:255]
v_mfma_f32_16x16x32_bf16 a[28:31], a[156:159], v[248:251], a[28:31]
v_exp_f32 v223, v223
v_mfma_f32_16x16x32_bf16 a[176:179], a[184:187], v[248:251], a[176:179]
ds_read_b128 a[124:127], v1 offset:23552
v_cvt_pk_bf16_f32 v239, v222, v223
v_mfma_f32_16x16x32_bf16 a[180:183], a[184:187], v[252:255], a[180:183]
v_mov_b32 v242, 0
v_add_u32 v1, s11, v0
v_mfma_f32_16x16x32_bf16 a[168:171], a[184:187], v[64:67], a[168:171]
v_mfma_f32_16x16x32_bf16 a[172:175], a[184:187], v[68:71], a[172:175]
s_waitcnt vmcnt(19)
LA_d20:
s_add_u32 s12, s12, s14
s_and_b32 s12, s12, 0xffff
v_add_u32 v1, s12, v3
s_waitcnt lgkmcnt(7)
v_mfma_f32_16x16x32_bf16 v[212:215], a[96:99], a[48:51], v[52:55]
s_waitcnt lgkmcnt(0)
s_barrier
v_mfma_f32_16x16x32_bf16 v[212:215], a[100:103], a[52:55], v[212:215]
v_exp_f32 v230, v230
v_mov_b32 v243, 0
v_mfma_f32_16x16x32_bf16 v[212:215], a[104:107], a[56:59], v[212:215]
v_exp_f32 v228, v228
v_exp_f32 v229, v229
v_exp_f32 v231, v231
v_mfma_f32_16x16x32_bf16 v[212:215], a[108:111], a[60:63], v[212:215]
ds_read_b128 a[128:131], v2 offset:0
v_cvt_pk_bf16_f32 v246, v228, v229
v_cvt_pk_bf16_f32 v247, v230, v231
v_mfma_f32_16x16x32_bf16 v[228:231], a[112:115], a[48:51], v[52:55]
s_add_u32 s18, s85, 0
s_and_b32 s18, s18, 3
ds_read_b128 a[132:135], v2 offset:1024
v_mfma_f32_16x16x32_bf16 v[228:231], a[116:119], a[52:55], v[228:231]
s_lshl_b32 s18, s18, 17
s_lshl_b32 s19, s80, 11
ds_read_b128 a[136:139], v2 offset:2048
v_mfma_f32_16x16x32_bf16 v[228:231], a[120:123], a[56:59], v[228:231]
s_add_u32 s19, s19, s17
s_add_u32 m0, s19, 0
ds_read_b128 a[140:143], v2 offset:3072
v_mfma_f32_16x16x32_bf16 v[228:231], a[124:127], a[60:63], v[228:231]
s_waitcnt lgkmcnt(3)
v_exp_f32 v212, v212
v_mfma_f32_16x16x32_bf16 a[0:3], a[128:131], v[232:235], a[0:3]
buffer_load_dwordx4 v36, s[28:31], s18 offen offset:0 lds
v_mfma_f32_16x16x32_bf16 a[224:227], a[128:131], v[236:239], a[224:227]
s_waitcnt lgkmcnt(2)
v_exp_f32 v213, v213
v_mfma_f32_16x16x32_bf16 a[228:231], a[132:135], v[236:239], a[228:231]
ds_read_b128 a[144:147], v2 offset:4096
v_cvt_pk_bf16_f32 v68, v212, v213
v_mfma_f32_16x16x32_bf16 a[4:7], a[132:135], v[232:235], a[4:7]
s_waitcnt lgkmcnt(2)
v_exp_f32 v214, v214
v_mfma_f32_16x16x32_bf16 a[8:11], a[136:139], v[232:235], a[8:11]
ds_read_b128 a[148:151], v2 offset:5120
buffer_load_dwordx4 v37, s[28:31], s18 offen offset:1024 lds
v_mfma_f32_16x16x32_bf16 a[232:235], a[136:139], v[236:239], a[232:235]
s_waitcnt lgkmcnt(2)
s_add_u32 m0, s19, 8192
v_exp_f32 v215, v215
v_mfma_f32_16x16x32_bf16 a[236:239], a[140:143], v[236:239], a[236:239]
s_add_u32 s18, s18, 32768
ds_read_b128 a[152:155], v2 offset:6144
v_cvt_pk_bf16_f32 v69, v214, v215
v_mfma_f32_16x16x32_bf16 a[12:15], a[140:143], v[232:235], a[12:15]
s_waitcnt lgkmcnt(2)
v_exp_f32 v228, v228
v_mfma_f32_16x16x32_bf16 a[16:19], a[144:147], v[232:235], a[16:19]
ds_read_b128 a[156:159], v2 offset:7168
buffer_load_dwordx4 v36, s[28:31], s18 offen offset:0 lds
v_mfma_f32_16x16x32_bf16 a[240:243], a[144:147], v[236:239], a[240:243]
s_waitcnt lgkmcnt(2)
v_exp_f32 v229, v229
v_mfma_f32_16x16x32_bf16 a[244:247], a[148:151], v[236:239], a[244:247]
v_cvt_pk_bf16_f32 v70, v228, v229
v_and_b32 v70, v70, v18
v_mfma_f32_16x16x32_bf16 a[20:23], a[148:151], v[232:235], a[20:23]
s_waitcnt lgkmcnt(1)
v_exp_f32 v230, v230
v_mfma_f32_16x16x32_bf16 a[24:27], a[152:155], v[232:235], a[24:27]
ds_write_b128 v26, a[0:3] offset:16384
v_mfma_f32_16x16x32_bf16 a[248:251], a[152:155], v[236:239], a[248:251]
s_waitcnt lgkmcnt(1)
v_exp_f32 v231, v231
v_mfma_f32_16x16x32_bf16 a[252:255], a[156:159], v[236:239], a[252:255]
v_cvt_pk_bf16_f32 v71, v230, v231
v_and_b32 v71, v71, v19
v_mfma_f32_16x16x32_bf16 a[28:31], a[156:159], v[232:235], a[28:31]
ds_write_b128 v26, a[4:7] offset:17408
v_mfma_f32_16x16x32_bf16 v[136:139], a[128:131], v[240:243], v[136:139]
ds_write_b128 v26, a[8:11] offset:18432
v_mfma_f32_16x16x32_bf16 v[168:171], a[128:131], v[244:247], v[168:171]
ds_read_b128 a[128:131], v1 offset:0
buffer_load_dwordx4 v37, s[28:31], s18 offen offset:1024 lds
v_mfma_f32_16x16x32_bf16 v[172:175], a[132:135], v[244:247], v[172:175]
s_add_u32 m0, s19, 16384
ds_write_b128 v26, a[12:15] offset:19456
v_mfma_f32_16x16x32_bf16 v[140:143], a[132:135], v[240:243], v[140:143]
s_add_u32 s18, s18, 32768
ds_read_b128 a[132:135], v1 offset:1024
v_mfma_f32_16x16x32_bf16 v[144:147], a[136:139], v[240:243], v[144:147]
ds_write_b128 v26, a[16:19] offset:20480
v_mfma_f32_16x16x32_bf16 v[176:179], a[136:139], v[244:247], v[176:179]
ds_read_b128 a[136:139], v1 offset:2048
buffer_load_dwordx4 v36, s[28:31], s18 offen offset:0 lds
v_mfma_f32_16x16x32_bf16 v[180:183], a[140:143], v[244:247], v[180:183]
ds_write_b128 v26, a[20:23] offset:21504
v_mfma_f32_16x16x32_bf16 v[148:151], a[140:143], v[240:243], v[148:151]
ds_read_b128 a[140:143], v1 offset:3072
v_mfma_f32_16x16x32_bf16 v[152:155], a[144:147], v[240:243], v[152:155]
ds_write_b128 v26, a[24:27] offset:22528
v_mfma_f32_16x16x32_bf16 v[184:187], a[144:147], v[244:247], v[184:187]
ds_read_b128 a[144:147], v1 offset:4096
buffer_load_dwordx4 v37, s[28:31], s18 offen offset:1024 lds
v_mfma_f32_16x16x32_bf16 v[188:191], a[148:151], v[244:247], v[188:191]
s_add_u32 m0, s19, 24576
ds_write_b128 v26, a[28:31] offset:23552
v_mfma_f32_16x16x32_bf16 v[156:159], a[148:151], v[240:243], v[156:159]
s_add_u32 s18, s18, 32768
ds_read_b128 a[148:151], v1 offset:5120
v_mfma_f32_16x16x32_bf16 v[160:163], a[152:155], v[240:243], v[160:163]
v_mfma_f32_16x16x32_bf16 v[192:195], a[152:155], v[244:247], v[192:195]
ds_read_b128 a[152:155], v1 offset:6144
buffer_load_dwordx4 v36, s[28:31], s18 offen offset:0 lds
v_mfma_f32_16x16x32_bf16 v[196:199], a[156:159], v[244:247], v[196:199]
v_mfma_f32_16x16x32_bf16 v[164:167], a[156:159], v[240:243], v[164:167]
ds_read_b128 a[156:159], v1 offset:7168
v_mfma_f32_16x16x32_bf16 a[176:179], a[184:187], v[232:235], a[176:179]
v_mfma_f32_16x16x32_bf16 a[180:183], a[184:187], v[236:239], a[180:183]
buffer_load_dwordx4 v37, s[28:31], s18 offen offset:1024 lds
v_mfma_f32_16x16x32_bf16 a[168:171], a[184:187], v[240:243], a[168:171]
v_mfma_f32_16x16x32_bf16 a[172:175], a[184:187], v[244:247], a[172:175]
s_cmp_eq_u32 s82, 7
s_cbranch_scc0 LA_e0
s_waitcnt vmcnt(24)
s_mov_b32 exec_lo, s87
s_mov_b32 exec_hi, 0
buffer_store_dword v3, off, s[76:79], s43 offset:16 sc1
s_mov_b64 exec, -1
buffer_load_dword v38, v30, s[76:79], s88 offen sc1
buffer_load_dword v38, v30, s[76:79], s89 offen sc1
LA_e0:
s_waitcnt lgkmcnt(12)
v_mfma_f32_16x16x32_bf16 v[168:171], a[128:131], v[68:71], v[168:171]
s_waitcnt lgkmcnt(0)
s_barrier
v_mfma_f32_16x16x32_bf16 v[172:175], a[132:135], v[68:71], v[172:175]
ds_write_b128 v26, a[224:227] offset:24576
v_mfma_f32_16x16x32_bf16 v[176:179], a[136:139], v[68:71], v[176:179]
ds_write_b128 v26, a[228:231] offset:25600
v_mfma_f32_16x16x32_bf16 v[180:183], a[140:143], v[68:71], v[180:183]
ds_write_b128 v26, a[232:235] offset:26624
v_mfma_f32_16x16x32_bf16 v[184:187], a[144:147], v[68:71], v[184:187]
ds_write_b128 v26, a[236:239] offset:27648
v_mfma_f32_16x16x32_bf16 v[188:191], a[148:151], v[68:71], v[188:191]
ds_write_b128 v26, a[240:243] offset:28672
v_mfma_f32_16x16x32_bf16 v[192:195], a[152:155], v[68:71], v[192:195]
ds_write_b128 v26, a[244:247] offset:29696
v_mfma_f32_16x16x32_bf16 v[196:199], a[156:159], v[68:71], v[196:199]
ds_write_b128 v26, a[248:251] offset:30720
v_mfma_f32_16x16x32_bf16 a[172:175], a[184:187], v[68:71], a[172:175]
ds_write_b128 v26, a[252:255] offset:31744
s_add_u32 s18, s85, 1
s_and_b32 s18, s18, 3
s_lshl_b32 s18, s18, 17
s_lshl_b32 s19, s80, 11
s_add_u32 s19, s19, s50
s_add_u32 m0, s19, 0
s_nop 0
buffer_load_dwordx4 v36, s[28:31], s18 offen offset:0 lds
buffer_load_dwordx4 v37, s[28:31], s18 offen offset:1024 lds
s_add_u32 m0, s19, 8192
s_add_u32 s18, s18, 32768
buffer_load_dwordx4 v36, s[28:31], s18 offen offset:0 lds
buffer_load_dwordx4 v37, s[28:31], s18 offen offset:1024 lds
s_add_u32 m0, s19, 16384
s_add_u32 s18, s18, 32768
buffer_load_dwordx4 v36, s[28:31], s18 offen offset:0 lds
buffer_load_dwordx4 v37, s[28:31], s18 offen offset:1024 lds
s_lshl_b32 s34, s82, 3
s_add_u32 s8, s34, s80
s_sub_u32 s11, 127, s8
s_sub_u32 s9, s34, s80
s_add_u32 s9, s9, 7
s_sub_u32 s10, 127, s9
s_lshl3_add_u32 s12, s85, s84
s_lshl_b32 s12, s12, 5
s_lshl_b32 s8, s8, 14
s_add_u32 s8, s8, s12
s_lshl_b32 s9, s9, 14
s_add_u32 s9, s9, s12
s_lshl_b32 s10, s10, 14
s_add_u32 s10, s10, s12
s_lshl_b32 s11, s11, 14
s_add_u32 s11, s11, s12
v_bfe_u32 v25, v0, 4, 4
v_lshrrev_b32 v1, 8, v0
v_lshlrev_b32 v1, 3, v1
v_lshl_or_b32 v2, v25, 10, v1
s_branch LA_fin
LA_pm1:
s_waitcnt lgkmcnt(7)
v_mfma_f32_16x16x32_bf16 v[200:203], a[96:99], a[0:3], v[40:43]
s_waitcnt vmcnt(63) lgkmcnt(0)
s_barrier
v_mfma_f32_16x16x32_bf16 v[200:203], a[100:103], a[4:7], v[200:203]
s_add_u32 s11, s11, 8192
v_bfe_u32 v20, v0, 2, 7
v_mfma_f32_16x16x32_bf16 v[200:203], a[104:107], a[8:11], v[200:203]
s_and_b32 s11, s11, 0xffff
ds_read_b128 a[64:67], v23 offset:0
v_mfma_f32_16x16x32_bf16 v[200:203], a[108:111], a[12:15], v[200:203]
buffer_load_dword v20, v20, s[76:79], s40 offen offset:0 sc1
v_mfma_f32_16x16x32_bf16 v[204:207], a[108:111], a[28:31], v[44:47]
s_add_u32 m0, s5, s6
ds_read_b128 a[68:71], v23 offset:1024
v_mfma_f32_16x16x32_bf16 v[204:207], a[104:107], a[24:27], v[204:207]
buffer_load_dwordx4 v0, s[20:23], s4 offen offset:0 sc1 lds
v_mfma_f32_16x16x32_bf16 v[204:207], a[100:103], a[20:23], v[204:207]
ds_read_b128 a[72:75], v23 offset:2048
v_mfma_f32_16x16x32_bf16 v[204:207], a[96:99], a[16:19], v[204:207]
v_exp_f32 v200, v200
v_mfma_f32_16x16x32_bf16 v[208:211], a[96:99], a[32:35], v[48:51]
v_exp_f32 v201, v201
v_mfma_f32_16x16x32_bf16 v[208:211], a[100:103], a[36:39], v[208:211]
buffer_load_dwordx4 v0, s[20:23], s4 offen offset:1024 sc1 lds
v_cvt_pk_bf16_f32 v232, v200, v201
v_mfma_f32_16x16x32_bf16 v[208:211], a[104:107], a[40:43], v[208:211]
v_exp_f32 v202, v202
v_mfma_f32_16x16x32_bf16 v[208:211], a[108:111], a[44:47], v[208:211]
v_exp_f32 v203, v203
v_mfma_f32_16x16x32_bf16 v[212:215], a[108:111], a[60:63], v[52:55]
ds_read_b128 a[76:79], v23 offset:3072
v_cvt_pk_bf16_f32 v233, v202, v203
v_mfma_f32_16x16x32_bf16 v[212:215], a[104:107], a[56:59], v[212:215]
v_exp_f32 v204, v204
v_mfma_f32_16x16x32_bf16 v[212:215], a[100:103], a[52:55], v[212:215]
v_exp_f32 v205, v205
v_mfma_f32_16x16x32_bf16 v[212:215], a[96:99], a[48:51], v[212:215]
ds_read_b128 a[96:99], v1 offset:16384
v_cvt_pk_bf16_f32 v236, v204, v205
v_mfma_f32_16x16x32_bf16 v[216:219], a[112:115], a[0:3], v[40:43]
v_exp_f32 v206, v206
v_mfma_f32_16x16x32_bf16 v[216:219], a[116:119], a[4:7], v[216:219]
v_exp_f32 v207, v207
v_mfma_f32_16x16x32_bf16 v[216:219], a[120:123], a[8:11], v[216:219]
ds_read_b128 a[100:103], v1 offset:17408
v_cvt_pk_bf16_f32 v237, v206, v207
v_mfma_f32_16x16x32_bf16 v[216:219], a[124:127], a[12:15], v[216:219]
v_exp_f32 v208, v208
v_mfma_f32_16x16x32_bf16 v[220:223], a[124:127], a[28:31], v[44:47]
v_exp_f32 v209, v209
v_mfma_f32_16x16x32_bf16 v[220:223], a[120:123], a[24:27], v[220:223]
ds_read_b128 a[104:107], v1 offset:18432
v_cvt_pk_bf16_f32 v240, v208, v209
v_mfma_f32_16x16x32_bf16 v[220:223], a[116:119], a[20:23], v[220:223]
v_exp_f32 v210, v210
v_mfma_f32_16x16x32_bf16 v[220:223], a[112:115], a[16:19], v[220:223]
v_exp_f32 v211, v211
v_mfma_f32_16x16x32_bf16 v[224:227], a[112:115], a[32:35], v[48:51]
ds_read_b128 a[108:111], v1 offset:19456
v_cvt_pk_bf16_f32 v241, v210, v211
v_mfma_f32_16x16x32_bf16 v[224:227], a[116:119], a[36:39], v[224:227]
v_exp_f32 v212, v212
v_mfma_f32_16x16x32_bf16 v[224:227], a[120:123], a[40:43], v[224:227]
v_exp_f32 v213, v213
v_mfma_f32_16x16x32_bf16 v[224:227], a[124:127], a[44:47], v[224:227]
buffer_load_dwordx4 v0, s[20:23], s4 offen offset:2048 sc1 lds
v_cvt_pk_bf16_f32 v244, v212, v213
v_mfma_f32_16x16x32_bf16 v[228:231], a[124:127], a[60:63], v[52:55]
v_exp_f32 v214, v214
v_mfma_f32_16x16x32_bf16 v[228:231], a[120:123], a[56:59], v[228:231]
v_exp_f32 v215, v215
v_mfma_f32_16x16x32_bf16 v[228:231], a[116:119], a[52:55], v[228:231]
ds_read_b128 a[80:83], v23 offset:4096
v_cvt_pk_bf16_f32 v245, v214, v215
v_mfma_f32_16x16x32_bf16 v[228:231], a[112:115], a[48:51], v[228:231]
ds_read_b128 a[112:115], v1 offset:20480
ds_read_b128 a[116:119], v1 offset:21504
ds_read_b128 a[120:123], v1 offset:22528
ds_read_b128 a[124:127], v1 offset:23552
v_exp_f32 v216, v216
v_exp_f32 v217, v217
s_nop 0
v_cvt_pk_bf16_f32 v234, v216, v217
v_and_b32 v234, v234, v18
v_exp_f32 v218, v218
v_exp_f32 v219, v219
s_nop 0
v_cvt_pk_bf16_f32 v235, v218, v219
v_and_b32 v235, v235, v19
v_exp_f32 v220, v220
v_exp_f32 v221, v221
s_nop 0
v_cvt_pk_bf16_f32 v238, v220, v221
v_exp_f32 v222, v222
v_exp_f32 v223, v223
s_nop 0
v_cvt_pk_bf16_f32 v239, v222, v223
v_exp_f32 v224, v224
v_exp_f32 v225, v225
s_nop 0
v_cvt_pk_bf16_f32 v242, v224, v225
v_add_u32 v1, s11, v0
buffer_load_dwordx4 v0, s[20:23], s4 offen offset:3072 sc1 lds
s_add_u32 s4, s4, 16384
s_add_u32 s5, s5, 8192
s_and_b32 s5, s5, 0xffff
buffer_load_dword v34, v24, s[28:31], 0 offen
buffer_load_dword v35, v25, s[52:55], 0 offen
ds_read_b128 a[84:87], v23 offset:5120
ds_read_b128 a[88:91], v23 offset:6144
ds_read_b128 a[92:95], v23 offset:7168
s_branch LA_b11
LA_ma1:
s_waitcnt lgkmcnt(7)
v_mfma_f32_16x16x32_bf16 v[200:203], a[96:99], a[0:3], v[40:43]
s_waitcnt vmcnt(8) lgkmcnt(0)
s_barrier
v_mfma_f32_16x16x32_bf16 v[200:203], a[100:103], a[4:7], v[200:203]
s_add_u32 s12, s12, 8192
v_exp_f32 v226, v226
v_mfma_f32_16x16x32_bf16 v[200:203], a[104:107], a[8:11], v[200:203]
s_and_b32 s12, s12, 0xffff
s_add_u32 s11, s11, 8192
s_add_u32 m0, s5, s6
v_mfma_f32_16x16x32_bf16 v[200:203], a[108:111], a[12:15], v[200:203]
s_and_b32 s11, s11, 0xffff
v_exp_f32 v227, v227
v_mfma_f32_16x16x32_bf16 v[204:207], a[108:111], a[28:31], v[44:47]
ds_read_b128 a[128:131], v2 offset:0
v_cvt_pk_bf16_f32 v67, v226, v227
v_mfma_f32_16x16x32_bf16 v[204:207], a[104:107], a[24:27], v[204:207]
v_exp_f32 v228, v228
v_mfma_f32_16x16x32_bf16 v[204:207], a[100:103], a[20:23], v[204:207]
buffer_load_dwordx4 v0, s[20:23], s4 offen offset:0 sc1 lds
v_mfma_f32_16x16x32_bf16 v[204:207], a[96:99], a[16:19], v[204:207]
v_exp_f32 v229, v229
v_mfma_f32_16x16x32_bf16 v[208:211], a[96:99], a[32:35], v[48:51]
ds_read_b128 a[132:135], v2 offset:1024
v_cvt_pk_bf16_f32 v70, v228, v229
v_mfma_f32_16x16x32_bf16 v[208:211], a[100:103], a[36:39], v[208:211]
v_exp_f32 v230, v230
v_mfma_f32_16x16x32_bf16 v[208:211], a[104:107], a[40:43], v[208:211]
ds_read_b128 a[136:139], v2 offset:2048
v_mfma_f32_16x16x32_bf16 v[208:211], a[108:111], a[44:47], v[208:211]
v_exp_f32 v231, v231
v_mfma_f32_16x16x32_bf16 v[212:215], a[108:111], a[60:63], v[52:55]
ds_read_b128 a[140:143], v2 offset:3072
v_cvt_pk_bf16_f32 v71, v230, v231
v_mfma_f32_16x16x32_bf16 v[212:215], a[104:107], a[56:59], v[212:215]
v_exp_f32 v200, v200
v_mfma_f32_16x16x32_bf16 v[212:215], a[100:103], a[52:55], v[212:215]
buffer_load_dwordx4 v0, s[20:23], s4 offen offset:1024 sc1 lds
v_mfma_f32_16x16x32_bf16 v[212:215], a[96:99], a[48:51], v[212:215]
v_exp_f32 v201, v201
v_mfma_f32_16x16x32_bf16 v[216:219], a[112:115], a[0:3], v[40:43]
ds_read_b128 a[144:147], v2 offset:4096
v_cvt_pk_bf16_f32 v232, v200, v201
v_mfma_f32_16x16x32_bf16 v[216:219], a[116:119], a[4:7], v[216:219]
v_exp_f32 v202, v202
v_mfma_f32_16x16x32_bf16 v[216:219], a[120:123], a[8:11], v[216:219]
ds_read_b128 a[148:151], v2 offset:5120
v_mfma_f32_16x16x32_bf16 v[216:219], a[124:127], a[12:15], v[216:219]
v_exp_f32 v203, v203
v_mfma_f32_16x16x32_bf16 v[220:223], a[124:127], a[28:31], v[44:47]
ds_read_b128 a[152:155], v2 offset:6144
v_cvt_pk_bf16_f32 v233, v202, v203
v_mfma_f32_16x16x32_bf16 v[220:223], a[120:123], a[24:27], v[220:223]
v_exp_f32 v204, v204
v_mfma_f32_16x16x32_bf16 v[220:223], a[116:119], a[20:23], v[220:223]
buffer_load_dwordx4 v0, s[20:23], s4 offen offset:2048 sc1 lds
v_mfma_f32_16x16x32_bf16 v[220:223], a[112:115], a[16:19], v[220:223]
v_exp_f32 v205, v205
v_mfma_f32_16x16x32_bf16 v[224:227], a[112:115], a[32:35], v[48:51]
ds_read_b128 a[156:159], v2 offset:7168
v_cvt_pk_bf16_f32 v236, v204, v205
v_mfma_f32_16x16x32_bf16 v[224:227], a[116:119], a[36:39], v[224:227]
v_exp_f32 v206, v206
v_mfma_f32_16x16x32_bf16 v[224:227], a[120:123], a[40:43], v[224:227]
buffer_load_dwordx4 v0, s[20:23], s4 offen offset:3072 sc1 lds
v_mfma_f32_16x16x32_bf16 v[224:227], a[124:127], a[44:47], v[224:227]
s_add_u32 s4, s4, 16384
v_exp_f32 v207, v207
v_mfma_f32_16x16x32_bf16 v[228:231], a[124:127], a[60:63], v[52:55]
v_cvt_pk_bf16_f32 v237, v206, v207
v_add_u32 v2, s12, v3
v_mfma_f32_16x16x32_bf16 v[228:231], a[120:123], a[56:59], v[228:231]
s_waitcnt lgkmcnt(0)
v_exp_f32 v208, v208
v_mfma_f32_16x16x32_bf16 v[228:231], a[116:119], a[52:55], v[228:231]
s_add_u32 s5, s5, 8192
s_and_b32 s5, s5, 0xffff
v_mfma_f32_16x16x32_bf16 v[228:231], a[112:115], a[48:51], v[228:231]
v_exp_f32 v209, v209
v_mfma_f32_16x16x32_bf16 v[72:75], a[128:131], v[248:251], v[72:75]
ds_read_b128 a[96:99], v1 offset:16384
v_cvt_pk_bf16_f32 v240, v208, v209
v_mfma_f32_16x16x32_bf16 v[104:107], a[128:131], v[252:255], v[104:107]
v_exp_f32 v210, v210
v_mfma_f32_16x16x32_bf16 v[136:139], a[128:131], v[64:67], v[136:139]
v_add_u32 v30, (LA_fin+4096-LA_pc+4096)/4, v0
v_mad_u64_u32 v[30:31], vcc, v30, 4, s[72:73]
v_mfma_f32_16x16x32_bf16 v[168:171], a[128:131], v[68:71], v[168:171]
v_exp_f32 v211, v211
v_mfma_f32_16x16x32_bf16 v[172:175], a[132:135], v[68:71], v[172:175]
ds_read_b128 a[100:103], v1 offset:17408
v_cvt_pk_bf16_f32 v241, v210, v211
v_mfma_f32_16x16x32_bf16 v[140:143], a[132:135], v[64:67], v[140:143]
v_exp_f32 v212, v212
v_mfma_f32_16x16x32_bf16 v[108:111], a[132:135], v[252:255], v[108:111]
global_load_dword v30, v[30:31], off offset:-4096
v_mfma_f32_16x16x32_bf16 v[76:79], a[132:135], v[248:251], v[76:79]
v_exp_f32 v213, v213
v_mfma_f32_16x16x32_bf16 v[80:83], a[136:139], v[248:251], v[80:83]
ds_read_b128 a[104:107], v1 offset:18432
v_cvt_pk_bf16_f32 v244, v212, v213
v_mfma_f32_16x16x32_bf16 v[112:115], a[136:139], v[252:255], v[112:115]
v_exp_f32 v214, v214
v_mfma_f32_16x16x32_bf16 v[144:147], a[136:139], v[64:67], v[144:147]
v_mfma_f32_16x16x32_bf16 v[176:179], a[136:139], v[68:71], v[176:179]
v_exp_f32 v215, v215
v_mfma_f32_16x16x32_bf16 v[180:183], a[140:143], v[68:71], v[180:183]
ds_read_b128 a[108:111], v1 offset:19456
v_cvt_pk_bf16_f32 v245, v214, v215
v_mfma_f32_16x16x32_bf16 v[148:151], a[140:143], v[64:67], v[148:151]
v_exp_f32 v216, v216
v_mfma_f32_16x16x32_bf16 v[116:119], a[140:143], v[252:255], v[116:119]
v_mfma_f32_16x16x32_bf16 v[84:87], a[140:143], v[248:251], v[84:87]
v_exp_f32 v217, v217
v_mfma_f32_16x16x32_bf16 v[88:91], a[144:147], v[248:251], v[88:91]
v_cvt_pk_bf16_f32 v234, v216, v217
v_and_b32 v234, v234, v18
v_mfma_f32_16x16x32_bf16 v[120:123], a[144:147], v[252:255], v[120:123]
v_exp_f32 v218, v218
v_mfma_f32_16x16x32_bf16 v[152:155], a[144:147], v[64:67], v[152:155]
ds_read_b128 a[112:115], v1 offset:20480
v_mfma_f32_16x16x32_bf16 v[184:187], a[144:147], v[68:71], v[184:187]
v_exp_f32 v219, v219
v_mfma_f32_16x16x32_bf16 v[188:191], a[148:151], v[68:71], v[188:191]
v_cvt_pk_bf16_f32 v235, v218, v219
v_and_b32 v235, v235, v19
v_mfma_f32_16x16x32_bf16 v[156:159], a[148:151], v[64:67], v[156:159]
v_exp_f32 v220, v220
v_mfma_f32_16x16x32_bf16 v[124:127], a[148:151], v[252:255], v[124:127]
ds_read_b128 a[116:119], v1 offset:21504
v_mfma_f32_16x16x32_bf16 v[92:95], a[148:151], v[248:251], v[92:95]
v_exp_f32 v221, v221
v_mfma_f32_16x16x32_bf16 v[96:99], a[152:155], v[248:251], v[96:99]
ds_read_b128 a[120:123], v1 offset:22528
v_cvt_pk_bf16_f32 v238, v220, v221
v_mfma_f32_16x16x32_bf16 v[128:131], a[152:155], v[252:255], v[128:131]
v_exp_f32 v222, v222
v_mfma_f32_16x16x32_bf16 v[160:163], a[152:155], v[64:67], v[160:163]
v_mfma_f32_16x16x32_bf16 v[192:195], a[152:155], v[68:71], v[192:195]
v_exp_f32 v223, v223
v_mfma_f32_16x16x32_bf16 v[196:199], a[156:159], v[68:71], v[196:199]
ds_read_b128 a[124:127], v1 offset:23552
v_cvt_pk_bf16_f32 v239, v222, v223
v_mfma_f32_16x16x32_bf16 v[164:167], a[156:159], v[64:67], v[164:167]
v_exp_f32 v224, v224
v_mfma_f32_16x16x32_bf16 v[132:135], a[156:159], v[252:255], v[132:135]
v_mfma_f32_16x16x32_bf16 v[100:103], a[156:159], v[248:251], v[100:103]
v_exp_f32 v225, v225
v_mfma_f32_16x16x32_bf16 a[160:163], a[184:187], v[248:251], a[160:163]
v_cvt_pk_bf16_f32 v242, v224, v225
v_add_u32 v1, s11, v0
v_mfma_f32_16x16x32_bf16 a[164:167], a[184:187], v[252:255], a[164:167]
v_mfma_f32_16x16x32_bf16 a[168:171], a[184:187], v[64:67], a[168:171]
v_mfma_f32_16x16x32_bf16 a[172:175], a[184:187], v[68:71], a[172:175]
LA_b11:
s_waitcnt lgkmcnt(7)
v_mfma_f32_16x16x32_bf16 v[204:207], a[96:99], a[16:19], v[44:47]
s_waitcnt vmcnt(9) lgkmcnt(0)
s_barrier
v_mfma_f32_16x16x32_bf16 v[204:207], a[100:103], a[20:23], v[204:207]
s_add_u32 s12, s12, 8192
v_exp_f32 v226, v226
v_mfma_f32_16x16x32_bf16 v[204:207], a[104:107], a[24:27], v[204:207]
s_waitcnt vmcnt(6)
s_and_b32 s12, s12, 0xffff
s_add_u32 m0, s5, s6
v_bfe_u32 v20, v0, 2, 7
v_mfma_f32_16x16x32_bf16 v[204:207], a[108:111], a[28:31], v[204:207]
s_add_u32 s11, s11, 8192
v_exp_f32 v227, v227
v_mfma_f32_16x16x32_bf16 v[208:211], a[108:111], a[44:47], v[48:51]
ds_read_b128 a[128:131], v2 offset:0
v_cvt_pk_bf16_f32 v243, v226, v227
v_mfma_f32_16x16x32_bf16 v[208:211], a[104:107], a[40:43], v[208:211]
s_and_b32 s11, s11, 0xffff
v_exp_f32 v228, v228
v_mfma_f32_16x16x32_bf16 v[208:211], a[100:103], a[36:39], v[208:211]
buffer_load_dword v20, v20, s[76:79], s40 offen offset:0 sc1
v_mfma_f32_16x16x32_bf16 v[208:211], a[96:99], a[32:35], v[208:211]
v_exp_f32 v229, v229
v_mfma_f32_16x16x32_bf16 v[212:215], a[96:99], a[48:51], v[52:55]
v_cvt_pk_bf16_f32 v246, v228, v229
v_bfe_u32 v22, v0, 2, 7
v_mfma_f32_16x16x32_bf16 v[212:215], a[100:103], a[52:55], v[212:215]
v_exp_f32 v230, v230
v_mfma_f32_16x16x32_bf16 v[212:215], a[104:107], a[56:59], v[212:215]
buffer_load_dword v22, v22, s[76:79], s41 offen offset:0 sc1
v_mfma_f32_16x16x32_bf16 v[212:215], a[108:111], a[60:63], v[212:215]
v_exp_f32 v231, v231
v_mfma_f32_16x16x32_bf16 v[220:223], a[112:115], a[16:19], v[44:47]
ds_read_b128 a[132:135], v2 offset:1024
v_cvt_pk_bf16_f32 v247, v230, v231
v_mfma_f32_16x16x32_bf16 v[220:223], a[116:119], a[20:23], v[220:223]
v_exp_f32 v204, v204
v_mfma_f32_16x16x32_bf16 v[220:223], a[120:123], a[24:27], v[220:223]
buffer_load_dwordx4 v0, s[20:23], s4 offen offset:0 sc1 lds
v_mfma_f32_16x16x32_bf16 v[220:223], a[124:127], a[28:31], v[220:223]
v_exp_f32 v205, v205
v_mfma_f32_16x16x32_bf16 v[224:227], a[124:127], a[44:47], v[48:51]
ds_read_b128 a[136:139], v2 offset:2048
v_cvt_pk_bf16_f32 v252, v204, v205
v_mfma_f32_16x16x32_bf16 v[224:227], a[120:123], a[40:43], v[224:227]
v_exp_f32 v206, v206
v_mfma_f32_16x16x32_bf16 v[224:227], a[116:119], a[36:39], v[224:227]
buffer_load_dwordx4 v0, s[20:23], s4 offen offset:1024 sc1 lds
v_mfma_f32_16x16x32_bf16 v[224:227], a[112:115], a[32:35], v[224:227]
v_exp_f32 v207, v207
v_mfma_f32_16x16x32_bf16 v[228:231], a[112:115], a[48:51], v[52:55]
ds_read_b128 a[140:143], v2 offset:3072
v_cvt_pk_bf16_f32 v253, v206, v207
v_mfma_f32_16x16x32_bf16 v[228:231], a[116:119], a[52:55], v[228:231]
v_exp_f32 v208, v208
v_mfma_f32_16x16x32_bf16 v[228:231], a[120:123], a[56:59], v[228:231]
buffer_load_dwordx4 v0, s[20:23], s4 offen offset:2048 sc1 lds
v_mfma_f32_16x16x32_bf16 v[228:231], a[124:127], a[60:63], v[228:231]
s_waitcnt lgkmcnt(3)
v_exp_f32 v209, v209
v_mfma_f32_16x16x32_bf16 v[72:75], a[128:131], v[232:235], v[72:75]
ds_read_b128 a[144:147], v2 offset:4096
v_cvt_pk_bf16_f32 v64, v208, v209
v_mfma_f32_16x16x32_bf16 v[104:107], a[128:131], v[236:239], v[104:107]
v_exp_f32 v210, v210
v_mfma_f32_16x16x32_bf16 v[136:139], a[128:131], v[240:243], v[136:139]
ds_read_b128 a[96:99], v1 offset:16384
buffer_load_dwordx4 v0, s[20:23], s4 offen offset:3072 sc1 lds
v_mfma_f32_16x16x32_bf16 v[168:171], a[128:131], v[244:247], v[168:171]
s_waitcnt lgkmcnt(4)
s_add_u32 s4, s4, 16384
v_exp_f32 v211, v211
v_mfma_f32_16x16x32_bf16 v[172:175], a[132:135], v[244:247], v[172:175]
s_add_u32 s5, s5, 8192
ds_read_b128 a[148:151], v2 offset:5120
v_cvt_pk_bf16_f32 v65, v210, v211
v_mfma_f32_16x16x32_bf16 v[140:143], a[132:135], v[240:243], v[140:143]
s_and_b32 s5, s5, 0xffff
v_exp_f32 v212, v212
v_mfma_f32_16x16x32_bf16 v[108:111], a[132:135], v[236:239], v[108:111]
ds_read_b128 a[100:103], v1 offset:17408
v_bfe_u32 v21, v0, 4, 4
v_mfma_f32_16x16x32_bf16 v[76:79], a[132:135], v[232:235], v[76:79]
s_waitcnt lgkmcnt(5)
s_lshl_b32 s34, s80, 6
v_exp_f32 v213, v213
v_mfma_f32_16x16x32_bf16 v[80:83], a[136:139], v[232:235], v[80:83]
ds_read_b128 a[152:155], v2 offset:6144
v_cvt_pk_bf16_f32 v68, v212, v213
v_mfma_f32_16x16x32_bf16 v[112:115], a[136:139], v[236:239], v[112:115]
s_sub_u32 s35, 448, s34
v_exp_f32 v214, v214
v_mfma_f32_16x16x32_bf16 v[144:147], a[136:139], v[240:243], v[144:147]
ds_read_b128 a[104:107], v1 offset:18432
v_lshl_add_u32 v29, v21, 2, s34
v_mfma_f32_16x16x32_bf16 v[176:179], a[136:139], v[244:247], v[176:179]
s_waitcnt lgkmcnt(6)
v_exp_f32 v215, v215
v_mfma_f32_16x16x32_bf16 v[180:183], a[140:143], v[244:247], v[180:183]
ds_read_b128 a[156:159], v2 offset:7168
v_cvt_pk_bf16_f32 v69, v214, v215
v_mfma_f32_16x16x32_bf16 v[148:151], a[140:143], v[240:243], v[148:151]
v_exp_f32 v220, v220
v_mfma_f32_16x16x32_bf16 v[116:119], a[140:143], v[236:239], v[116:119]
ds_read_b128 a[108:111], v1 offset:19456
v_lshl_add_u32 v28, v21, 2, s35
v_mfma_f32_16x16x32_bf16 v[84:87], a[140:143], v[232:235], v[84:87]
s_waitcnt lgkmcnt(7)
v_exp_f32 v221, v221
v_mfma_f32_16x16x32_bf16 v[88:91], a[144:147], v[232:235], v[88:91]
v_cvt_pk_bf16_f32 v254, v220, v221
v_add_u32 v2, s12, v3
v_mfma_f32_16x16x32_bf16 v[120:123], a[144:147], v[236:239], v[120:123]
v_exp_f32 v222, v222
v_mfma_f32_16x16x32_bf16 v[152:155], a[144:147], v[240:243], v[152:155]
ds_read_b128 a[112:115], v1 offset:20480
v_sub_f32 v24, 1.0, v4
v_mfma_f32_16x16x32_bf16 v[184:187], a[144:147], v[244:247], v[184:187]
s_waitcnt lgkmcnt(6)
v_exp_f32 v223, v223
v_mfma_f32_16x16x32_bf16 v[188:191], a[148:151], v[244:247], v[188:191]
ds_read_b128 a[116:119], v1 offset:21504
v_cvt_pk_bf16_f32 v255, v222, v223
v_mfma_f32_16x16x32_bf16 v[156:159], a[148:151], v[240:243], v[156:159]
v_exp_f32 v224, v224
v_mfma_f32_16x16x32_bf16 v[124:127], a[148:151], v[236:239], v[124:127]
v_sub_f32 v25, 1.0, v5
v_sub_f32 v26, 1.0, v6
v_mfma_f32_16x16x32_bf16 v[92:95], a[148:151], v[232:235], v[92:95]
s_waitcnt lgkmcnt(5)
v_exp_f32 v225, v225
v_mfma_f32_16x16x32_bf16 v[96:99], a[152:155], v[232:235], v[96:99]
ds_read_b128 a[120:123], v1 offset:22528
v_cvt_pk_bf16_f32 v66, v224, v225
v_mfma_f32_16x16x32_bf16 v[128:131], a[152:155], v[236:239], v[128:131]
v_sub_f32 v27, 1.0, v7
v_cvt_pk_bf16_f32 v24, v24, v24
v_mfma_f32_16x16x32_bf16 v[160:163], a[152:155], v[240:243], v[160:163]
s_waitcnt vmcnt(5)
v_cvt_pk_bf16_f32 v25, v25, v25
v_cvt_pk_bf16_f32 v26, v26, v26
v_cmp_lt_u32 vcc, 0, v20
v_mfma_f32_16x16x32_bf16 v[192:195], a[152:155], v[244:247], v[192:195]
s_waitcnt vmcnt(4) lgkmcnt(4)
ds_read_b128 a[124:127], v1 offset:23552
v_cvt_pk_bf16_f32 v27, v27, v27
v_cmp_lt_u32 s[32:33], 0, v22
v_mfma_f32_16x16x32_bf16 v[196:199], a[156:159], v[244:247], v[196:199]
v_add_u32 v1, s11, v0
v_lshlrev_b32 v24, 16, v24
v_mfma_f32_16x16x32_bf16 v[164:167], a[156:159], v[240:243], v[164:167]
v_lshlrev_b32 v25, 16, v25
v_lshlrev_b32 v26, 16, v26
v_mfma_f32_16x16x32_bf16 v[132:135], a[156:159], v[236:239], v[132:135]
v_lshlrev_b32 v27, 16, v27
v_add_f32 v24, v24, v24
v_mfma_f32_16x16x32_bf16 v[100:103], a[156:159], v[232:235], v[100:103]
v_add_f32 v25, v25, v25
v_add_f32 v26, v26, v26
v_mfma_f32_16x16x32_bf16 a[160:163], a[184:187], v[232:235], a[160:163]
v_add_f32 v27, v27, v27
v_mfma_f32_16x16x32_bf16 a[164:167], a[184:187], v[236:239], a[164:167]
ds_write_b32 v29, v24 offset:6144
v_mfma_f32_16x16x32_bf16 a[168:171], a[184:187], v[240:243], a[168:171]
s_andn2_b32 s33, 255, s32
s_cbranch_scc1 LA_p41_s
LA_p41:
v_mfma_f32_16x16x32_bf16 a[172:175], a[184:187], v[244:247], a[172:175]
s_andn2_b32 s33, 16776960, vcc_lo
s_cbranch_scc1 LA_p21_s
LA_p21:
ds_write_b32 v28, v25 offset:6144
ds_write_b32 v29, v26 offset:6656
ds_write_b32 v28, v27 offset:6656
v_mfma_f32_16x16x32_bf16 v[204:207], a[96:99], a[16:19], v[44:47]
s_waitcnt vmcnt(63) lgkmcnt(0)
s_barrier
v_mfma_f32_16x16x32_bf16 v[204:207], a[100:103], a[20:23], v[204:207]
s_add_u32 s12, s12, 8192
v_exp_f32 v226, v226
v_mfma_f32_16x16x32_bf16 v[204:207], a[104:107], a[24:27], v[204:207]
s_and_b32 s12, s12, 0xffff
s_add_u32 s11, s11, 8192
v_lshrrev_b32 v22, 1, v0
v_mfma_f32_16x16x32_bf16 v[204:207], a[108:111], a[28:31], v[204:207]
s_and_b32 s11, s11, 0xffff
v_exp_f32 v227, v227
v_mfma_f32_16x16x32_bf16 v[208:211], a[108:111], a[44:47], v[48:51]
ds_read_b128 a[128:131], v2 offset:0
v_cvt_pk_bf16_f32 v67, v226, v227
v_mfma_f32_16x16x32_bf16 v[208:211], a[104:107], a[40:43], v[208:211]
v_exp_f32 v228, v228
v_mfma_f32_16x16x32_bf16 v[208:211], a[100:103], a[36:39], v[208:211]
buffer_load_dwordx2 v[24:25], v22, s[76:79], s86 offen offset:0 sc1
v_mfma_f32_16x16x32_bf16 v[208:211], a[96:99], a[32:35], v[208:211]
v_exp_f32 v229, v229
v_mfma_f32_16x16x32_bf16 v[212:215], a[96:99], a[48:51], v[52:55]
ds_read_b128 a[132:135], v2 offset:1024
v_cvt_pk_bf16_f32 v70, v228, v229
v_mfma_f32_16x16x32_bf16 v[212:215], a[100:103], a[52:55], v[212:215]
v_exp_f32 v230, v230
v_mfma_f32_16x16x32_bf16 v[212:215], a[104:107], a[56:59], v[212:215]
buffer_load_dwordx2 v[26:27], v22, s[76:79], s86 offen offset:512 sc1
v_mfma_f32_16x16x32_bf16 v[212:215], a[108:111], a[60:63], v[212:215]
v_exp_f32 v231, v231
v_mfma_f32_16x16x32_bf16 v[220:223], a[112:115], a[16:19], v[44:47]
ds_read_b128 a[136:139], v2 offset:2048
v_cvt_pk_bf16_f32 v71, v230, v231
v_mfma_f32_16x16x32_bf16 v[220:223], a[116:119], a[20:23], v[220:223]
v_exp_f32 v204, v204
v_mfma_f32_16x16x32_bf16 v[220:223], a[120:123], a[24:27], v[220:223]
ds_read_b128 a[96:99], v1 offset:16384
buffer_load_dwordx2 v[28:29], v22, s[76:79], s86 offen offset:1024 sc1
v_mfma_f32_16x16x32_bf16 v[220:223], a[124:127], a[28:31], v[220:223]
v_exp_f32 v205, v205
v_mfma_f32_16x16x32_bf16 v[224:227], a[124:127], a[44:47], v[48:51]
ds_read_b128 a[140:143], v2 offset:3072
v_cvt_pk_bf16_f32 v236, v204, v205
v_mfma_f32_16x16x32_bf16 v[224:227], a[120:123], a[40:43], v[224:227]
v_exp_f32 v206, v206
v_mfma_f32_16x16x32_bf16 v[224:227], a[116:119], a[36:39], v[224:227]
ds_read_b128 a[100:103], v1 offset:17408
buffer_load_dwordx2 v[30:31], v22, s[76:79], s86 offen offset:1536 sc1
v_mfma_f32_16x16x32_bf16 v[224:227], a[112:115], a[32:35], v[224:227]
v_exp_f32 v207, v207
v_mfma_f32_16x16x32_bf16 v[228:231], a[112:115], a[48:51], v[52:55]
ds_read_b128 a[144:147], v2 offset:4096
v_cvt_pk_bf16_f32 v237, v206, v207
v_mfma_f32_16x16x32_bf16 v[228:231], a[116:119], a[52:55], v[228:231]
v_exp_f32 v208, v208
v_mfma_f32_16x16x32_bf16 v[228:231], a[120:123], a[56:59], v[228:231]
ds_read_b128 a[104:107], v1 offset:18432
buffer_load_dwordx2 v[32:33], v22, s[76:79], s86 offen offset:2048 sc1
v_mfma_f32_16x16x32_bf16 v[228:231], a[124:127], a[60:63], v[228:231]
s_waitcnt lgkmcnt(7)
v_exp_f32 v209, v209
v_mfma_f32_16x16x32_bf16 v[104:107], a[128:131], v[252:255], v[104:107]
ds_read_b128 a[148:151], v2 offset:5120
v_cvt_pk_bf16_f32 v240, v208, v209
v_mfma_f32_16x16x32_bf16 v[136:139], a[128:131], v[64:67], v[136:139]
v_exp_f32 v210, v210
v_mfma_f32_16x16x32_bf16 v[168:171], a[128:131], v[68:71], v[168:171]
s_waitcnt lgkmcnt(7)
ds_read_b128 a[108:111], v1 offset:19456
buffer_load_dwordx2 v[34:35], v22, s[76:79], s86 offen offset:2560 sc1
v_mfma_f32_16x16x32_bf16 v[172:175], a[132:135], v[68:71], v[172:175]
v_exp_f32 v211, v211
v_mfma_f32_16x16x32_bf16 v[140:143], a[132:135], v[64:67], v[140:143]
ds_read_b128 a[152:155], v2 offset:6144
v_cvt_pk_bf16_f32 v241, v210, v211
v_mfma_f32_16x16x32_bf16 v[108:111], a[132:135], v[252:255], v[108:111]
s_waitcnt lgkmcnt(8)
v_exp_f32 v212, v212
v_mfma_f32_16x16x32_bf16 v[112:115], a[136:139], v[252:255], v[112:115]
ds_read_b128 a[112:115], v1 offset:20480
buffer_load_dwordx2 v[36:37], v22, s[76:79], s86 offen offset:3072 sc1
v_mfma_f32_16x16x32_bf16 v[144:147], a[136:139], v[64:67], v[144:147]
v_exp_f32 v213, v213
v_mfma_f32_16x16x32_bf16 v[176:179], a[136:139], v[68:71], v[176:179]
s_waitcnt lgkmcnt(7)
ds_read_b128 a[156:159], v2 offset:7168
v_cvt_pk_bf16_f32 v244, v212, v213
v_mfma_f32_16x16x32_bf16 v[180:183], a[140:143], v[68:71], v[180:183]
v_exp_f32 v214, v214
v_mfma_f32_16x16x32_bf16 v[148:151], a[140:143], v[64:67], v[148:151]
ds_read_b128 a[116:119], v1 offset:21504
buffer_load_dwordx2 v[38:39], v22, s[76:79], s86 offen offset:3584 sc1
v_mfma_f32_16x16x32_bf16 v[116:119], a[140:143], v[252:255], v[116:119]
s_waitcnt lgkmcnt(7)
s_add_u32 m0, s5, s6
v_exp_f32 v215, v215
v_mfma_f32_16x16x32_bf16 v[120:123], a[144:147], v[252:255], v[120:123]
v_cvt_pk_bf16_f32 v245, v214, v215
v_add_u32 v2, s12, v3
v_mfma_f32_16x16x32_bf16 v[152:155], a[144:147], v[64:67], v[152:155]
v_exp_f32 v220, v220
v_mfma_f32_16x16x32_bf16 v[184:187], a[144:147], v[68:71], v[184:187]
s_waitcnt lgkmcnt(5)
buffer_load_dwordx4 v0, s[20:23], s4 offen offset:0 sc1 lds
v_mfma_f32_16x16x32_bf16 v[188:191], a[148:151], v[68:71], v[188:191]
v_exp_f32 v221, v221
v_mfma_f32_16x16x32_bf16 v[156:159], a[148:151], v[64:67], v[156:159]
ds_read_b128 a[120:123], v1 offset:22528
v_cvt_pk_bf16_f32 v238, v220, v221
v_mfma_f32_16x16x32_bf16 v[124:127], a[148:151], v[252:255], v[124:127]
s_waitcnt lgkmcnt(4)
v_exp_f32 v222, v222
v_mfma_f32_16x16x32_bf16 v[128:131], a[152:155], v[252:255], v[128:131]
buffer_load_dwordx4 v0, s[20:23], s4 offen offset:1024 sc1 lds
v_mfma_f32_16x16x32_bf16 v[160:163], a[152:155], v[64:67], v[160:163]
v_exp_f32 v223, v223
v_mfma_f32_16x16x32_bf16 v[192:195], a[152:155], v[68:71], v[192:195]
s_waitcnt lgkmcnt(2)
ds_read_b128 a[124:127], v1 offset:23552
v_cvt_pk_bf16_f32 v239, v222, v223
v_mfma_f32_16x16x32_bf16 v[196:199], a[156:159], v[68:71], v[196:199]
v_exp_f32 v224, v224
v_mfma_f32_16x16x32_bf16 v[164:167], a[156:159], v[64:67], v[164:167]
buffer_load_dwordx4 v0, s[20:23], s4 offen offset:2048 sc1 lds
v_mfma_f32_16x16x32_bf16 v[132:135], a[156:159], v[252:255], v[132:135]
v_exp_f32 v225, v225
v_mfma_f32_16x16x32_bf16 a[164:167], a[184:187], v[252:255], a[164:167]
v_cvt_pk_bf16_f32 v242, v224, v225
v_add_u32 v1, s11, v0
v_mfma_f32_16x16x32_bf16 a[168:171], a[184:187], v[64:67], a[168:171]
buffer_load_dwordx4 v0, s[20:23], s4 offen offset:3072 sc1 lds
v_mfma_f32_16x16x32_bf16 a[172:175], a[184:187], v[68:71], a[172:175]
s_add_u32 s4, s4, 16384
s_add_u32 s5, s5, 8192
s_and_b32 s5, s5, 0xffff
s_cmp_eq_u32 s16, 0
s_cbranch_scc1 LA_ssm
LA_c31:
v_mfma_f32_16x16x32_bf16 v[204:207], a[96:99], a[16:19], v[44:47]
s_waitcnt vmcnt(63) lgkmcnt(0)
s_barrier
v_mfma_f32_16x16x32_bf16 v[204:207], a[100:103], a[20:23], v[204:207]
s_add_u32 s12, s12, 8192
v_exp_f32 v226, v226
v_mfma_f32_16x16x32_bf16 v[204:207], a[104:107], a[24:27], v[204:207]
s_and_b32 s12, s12, 0xffff
s_add_u32 s11, s11, s15
s_add_u32 m0, s5, s6
v_mfma_f32_16x16x32_bf16 v[204:207], a[108:111], a[28:31], v[204:207]
s_and_b32 s11, s11, 0xffff
v_exp_f32 v227, v227
v_mfma_f32_16x16x32_bf16 v[208:211], a[108:111], a[44:47], v[48:51]
ds_read_b128 a[128:131], v2 offset:0
v_cvt_pk_bf16_f32 v243, v226, v227
v_mfma_f32_16x16x32_bf16 v[208:211], a[104:107], a[40:43], v[208:211]
s_lshl_b32 s34, s80, 13
v_exp_f32 v228, v228
v_mfma_f32_16x16x32_bf16 v[208:211], a[100:103], a[36:39], v[208:211]
buffer_load_dwordx4 v0, s[20:23], s4 offen offset:0 sc1 lds
v_mfma_f32_16x16x32_bf16 v[208:211], a[96:99], a[32:35], v[208:211]
s_lshl_b32 s35, s80, 14
v_exp_f32 v229, v229
v_mfma_f32_16x16x32_bf16 v[212:215], a[96:99], a[48:51], v[52:55]
ds_read_b128 a[132:135], v2 offset:1024
v_cvt_pk_bf16_f32 v246, v228, v229
v_mfma_f32_16x16x32_bf16 v[212:215], a[100:103], a[52:55], v[212:215]
s_xor_b32 s50, s17, 0x8000
v_exp_f32 v230, v230
v_mfma_f32_16x16x32_bf16 v[212:215], a[104:107], a[56:59], v[212:215]
ds_read_b128 a[96:99], v1 offset:16384
buffer_load_dwordx4 v0, s[20:23], s4 offen offset:1024 sc1 lds
v_mfma_f32_16x16x32_bf16 v[212:215], a[108:111], a[60:63], v[212:215]
s_lshl_b32 s33, s80, 9
v_exp_f32 v231, v231
v_mfma_f32_16x16x32_bf16 v[224:227], a[112:115], a[32:35], v[48:51]
ds_read_b128 a[136:139], v2 offset:2048
v_cvt_pk_bf16_f32 v247, v230, v231
v_mfma_f32_16x16x32_bf16 v[224:227], a[116:119], a[36:39], v[224:227]
s_add_u32 s33, s33, s50
v_exp_f32 v204, v204
v_mfma_f32_16x16x32_bf16 v[224:227], a[120:123], a[40:43], v[224:227]
ds_read_b128 a[140:143], v2 offset:3072
buffer_load_dwordx4 v0, s[20:23], s4 offen offset:2048 sc1 lds
v_mfma_f32_16x16x32_bf16 v[224:227], a[124:127], a[44:47], v[224:227]
s_sub_u32 s32, 4, s85
v_exp_f32 v205, v205
v_mfma_f32_16x16x32_bf16 v[228:231], a[124:127], a[60:63], v[52:55]
v_cvt_pk_bf16_f32 v252, v204, v205
v_and_b32 v252, v252, v18
v_mfma_f32_16x16x32_bf16 v[228:231], a[120:123], a[56:59], v[228:231]
s_lshl_b32 s32, s32, 12
v_exp_f32 v206, v206
v_mfma_f32_16x16x32_bf16 v[228:231], a[116:119], a[52:55], v[228:231]
ds_read_b128 a[144:147], v2 offset:4096
buffer_load_dwordx4 v0, s[20:23], s4 offen offset:3072 sc1 lds
v_mfma_f32_16x16x32_bf16 v[228:231], a[112:115], a[48:51], v[228:231]
s_waitcnt lgkmcnt(5)
s_add_u32 s4, s4, 16384
v_exp_f32 v207, v207
v_mfma_f32_16x16x32_bf16 v[104:107], a[128:131], v[236:239], v[104:107]
s_add_u32 s5, s5, 8192
v_cvt_pk_bf16_f32 v253, v206, v207
v_and_b32 v253, v253, v19
v_mfma_f32_16x16x32_bf16 v[136:139], a[128:131], v[240:243], v[136:139]
s_and_b32 s5, s5, 0xffff
v_exp_f32 v208, v208
v_mfma_f32_16x16x32_bf16 v[168:171], a[128:131], v[244:247], v[168:171]
s_waitcnt lgkmcnt(4)
s_add_u32 s96, s88, s32
ds_read_b128 a[148:151], v2 offset:5120
v_mfma_f32_16x16x32_bf16 v[172:175], a[132:135], v[244:247], v[172:175]
s_add_u32 s97, s89, s32
v_exp_f32 v209, v209
v_mfma_f32_16x16x32_bf16 v[140:143], a[132:135], v[240:243], v[140:143]
ds_read_b128 a[152:155], v2 offset:6144
v_cvt_pk_bf16_f32 v64, v208, v209
v_mfma_f32_16x16x32_bf16 v[108:111], a[132:135], v[236:239], v[108:111]
s_waitcnt lgkmcnt(4)
s_add_u32 s98, s90, s32
v_exp_f32 v210, v210
v_mfma_f32_16x16x32_bf16 v[112:115], a[136:139], v[236:239], v[112:115]
s_add_u32 s99, s91, s32
ds_read_b128 a[100:103], v1 offset:17408
v_mfma_f32_16x16x32_bf16 v[144:147], a[136:139], v[240:243], v[144:147]
v_exp_f32 v211, v211
v_mfma_f32_16x16x32_bf16 v[176:179], a[136:139], v[244:247], v[176:179]
s_waitcnt lgkmcnt(4)
ds_read_b128 a[156:159], v2 offset:7168
v_cvt_pk_bf16_f32 v65, v210, v211
v_mfma_f32_16x16x32_bf16 v[180:183], a[140:143], v[244:247], v[180:183]
v_exp_f32 v212, v212
v_mfma_f32_16x16x32_bf16 v[148:151], a[140:143], v[240:243], v[148:151]
s_waitcnt vmcnt(15)
ds_read_b128 a[104:107], v1 offset:18432
v_bfe_u32 v24, v0, 4, 4
v_mfma_f32_16x16x32_bf16 v[116:119], a[140:143], v[236:239], v[116:119]
s_waitcnt lgkmcnt(5)
v_exp_f32 v213, v213
v_mfma_f32_16x16x32_bf16 v[120:123], a[144:147], v[236:239], v[120:123]
v_cvt_pk_bf16_f32 v68, v212, v213
v_add_u32 v2, s12, v3
v_mfma_f32_16x16x32_bf16 v[152:155], a[144:147], v[240:243], v[152:155]
v_exp_f32 v214, v214
v_mfma_f32_16x16x32_bf16 v[184:187], a[144:147], v[244:247], v[184:187]
s_waitcnt lgkmcnt(4)
ds_read_b128 a[108:111], v1 offset:19456
v_lshrrev_b32 v25, 8, v0
v_mfma_f32_16x16x32_bf16 v[188:191], a[148:151], v[244:247], v[188:191]
v_exp_f32 v215, v215
v_mfma_f32_16x16x32_bf16 v[156:159], a[148:151], v[240:243], v[156:159]
ds_read_b128 a[112:115], v1 offset:20480
v_cvt_pk_bf16_f32 v69, v214, v215
v_mfma_f32_16x16x32_bf16 v[124:127], a[148:151], v[236:239], v[124:127]
s_waitcnt lgkmcnt(5)
v_mov_b32 v254, 0
v_mov_b32 v255, 0
v_mfma_f32_16x16x32_bf16 v[128:131], a[152:155], v[236:239], v[128:131]
v_exp_f32 v224, v224
v_mfma_f32_16x16x32_bf16 v[160:163], a[152:155], v[240:243], v[160:163]
s_waitcnt vmcnt(14)
v_lshrrev_b32 v26, 1, v24
v_xor_b32 v26, v26, v25
v_mfma_f32_16x16x32_bf16 v[192:195], a[152:155], v[244:247], v[192:195]
s_waitcnt lgkmcnt(3)
v_exp_f32 v225, v225
v_mfma_f32_16x16x32_bf16 v[196:199], a[156:159], v[244:247], v[196:199]
ds_read_b128 a[116:119], v1 offset:21504
v_cvt_pk_bf16_f32 v66, v224, v225
v_mfma_f32_16x16x32_bf16 v[164:167], a[156:159], v[240:243], v[164:167]
ds_read_b128 a[120:123], v1 offset:22528
v_and_b32 v27, 16, v0
v_mfma_f32_16x16x32_bf16 v[132:135], a[156:159], v[236:239], v[132:135]
ds_read_b128 a[124:127], v1 offset:23552
v_lshl_or_b32 v27, v25, 10, v27
v_mfma_f32_16x16x32_bf16 a[164:167], a[184:187], v[236:239], a[164:167]
v_add_u32 v1, s11, v0
v_lshl_or_b32 v27, v26, 5, v27
v_mfma_f32_16x16x32_bf16 a[168:171], a[184:187], v[240:243], a[168:171]
s_waitcnt vmcnt(9)
v_add_u32 v36, s34, v27
v_xor_b32 v27, 128, v36
v_mfma_f32_16x16x32_bf16 a[172:175], a[184:187], v[244:247], a[172:175]
s_waitcnt vmcnt(8)
v_add_u32 v37, 3072, v27
v_lshlrev_b32 v25, 4, v25
v_lshl_or_b32 v38, v24, 10, v25
v_add_u32 v26, s35, v0
v_xor_b32 v27, 0x8000, v26
v_lshrrev_b32 v28, 2, v0
v_add_u32 v28, s33, v28
v_xor_b32 v29, 1024, v28
v_lshlrev_b32 v30, 2, v0
s_waitcnt vmcnt(4)
s_mov_b64 exec, 1
buffer_store_dword v3, off, s[76:79], s44 offset:128 sc1
s_mov_b64 exec, -1
s_cmp_eq_u32 s82, 7
s_cbranch_scc1 LA_t71
v_mfma_f32_16x16x32_bf16 v[200:203], a[96:99], a[64:67], v[56:59]
s_waitcnt vmcnt(63) lgkmcnt(0)
s_barrier
v_mfma_f32_16x16x32_bf16 v[200:203], a[100:103], a[68:71], v[200:203]
s_add_u32 s12, s12, 8192
v_exp_f32 v226, v226
v_mfma_f32_16x16x32_bf16 v[200:203], a[104:107], a[72:75], v[200:203]
s_and_b32 s12, s12, 0xffff
s_add_u32 s11, s11, 16384
s_add_u32 m0, s5, s6
v_mfma_f32_16x16x32_bf16 v[200:203], a[108:111], a[76:79], v[200:203]
s_and_b32 s11, s11, 0xffff
v_exp_f32 v227, v227
v_mfma_f32_16x16x32_bf16 v[204:207], a[108:111], a[92:95], v[60:63]
ds_read_b128 a[128:131], v2 offset:0
v_cvt_pk_bf16_f32 v67, v226, v227
v_mfma_f32_16x16x32_bf16 v[204:207], a[104:107], a[88:91], v[204:207]
v_exp_f32 v228, v228
v_mfma_f32_16x16x32_bf16 v[204:207], a[100:103], a[84:87], v[204:207]
buffer_load_dwordx4 v0, s[20:23], s4 offen offset:0 sc1 lds
v_mfma_f32_16x16x32_bf16 v[204:207], a[96:99], a[80:83], v[204:207]
v_exp_f32 v229, v229
v_mfma_f32_16x16x32_bf16 v[208:211], a[96:99], a[32:35], v[48:51]
ds_read_b128 a[132:135], v2 offset:1024
v_cvt_pk_bf16_f32 v70, v228, v229
v_mfma_f32_16x16x32_bf16 v[208:211], a[100:103], a[36:39], v[208:211]
v_exp_f32 v230, v230
v_mfma_f32_16x16x32_bf16 v[208:211], a[104:107], a[40:43], v[208:211]
buffer_load_dwordx4 v0, s[20:23], s4 offen offset:1024 sc1 lds
v_mfma_f32_16x16x32_bf16 v[208:211], a[108:111], a[44:47], v[208:211]
v_exp_f32 v231, v231
v_mfma_f32_16x16x32_bf16 v[212:215], a[108:111], a[60:63], v[52:55]
ds_read_b128 a[136:139], v2 offset:2048
v_cvt_pk_bf16_f32 v71, v230, v231
v_mfma_f32_16x16x32_bf16 v[212:215], a[104:107], a[56:59], v[212:215]
v_exp_f32 v200, v200
v_mfma_f32_16x16x32_bf16 v[212:215], a[100:103], a[52:55], v[212:215]
buffer_load_dwordx4 v0, s[20:23], s4 offen offset:2048 sc1 lds
v_mfma_f32_16x16x32_bf16 v[212:215], a[96:99], a[48:51], v[212:215]
v_exp_f32 v201, v201
v_mfma_f32_16x16x32_bf16 v[216:219], a[112:115], a[64:67], v[56:59]
ds_read_b128 a[140:143], v2 offset:3072
v_cvt_pk_bf16_f32 v232, v200, v201
v_mfma_f32_16x16x32_bf16 v[216:219], a[116:119], a[68:71], v[216:219]
v_exp_f32 v202, v202
v_mfma_f32_16x16x32_bf16 v[216:219], a[120:123], a[72:75], v[216:219]
buffer_load_dwordx4 v0, s[20:23], s4 offen offset:3072 sc1 lds
v_mfma_f32_16x16x32_bf16 v[216:219], a[124:127], a[76:79], v[216:219]
s_add_u32 s4, s4, 16384
v_exp_f32 v203, v203
v_mfma_f32_16x16x32_bf16 v[220:223], a[124:127], a[92:95], v[60:63]
s_add_u32 s5, s5, 8192
ds_read_b128 a[144:147], v2 offset:4096
v_cvt_pk_bf16_f32 v233, v202, v203
v_mfma_f32_16x16x32_bf16 v[220:223], a[120:123], a[88:91], v[220:223]
s_and_b32 s5, s5, 0xffff
v_exp_f32 v204, v204
v_mfma_f32_16x16x32_bf16 v[220:223], a[116:119], a[84:87], v[220:223]
s_lshl_b32 s74, s82, 15
s_add_u32 s75, s74, 106496
ds_read_b128 a[96:99], v1 offset:16384
v_mfma_f32_16x16x32_bf16 v[220:223], a[112:115], a[80:83], v[220:223]
s_and_b32 s75, s75, 0xffff
v_exp_f32 v205, v205
v_mfma_f32_16x16x32_bf16 v[224:227], a[112:115], a[32:35], v[48:51]
s_add_u32 m0, s75, 18432
ds_read_b128 a[148:151], v2 offset:5120
v_cvt_pk_bf16_f32 v236, v204, v205
v_mfma_f32_16x16x32_bf16 v[224:227], a[116:119], a[36:39], v[224:227]
s_lshl_b32 s74, s74, 1
v_exp_f32 v206, v206
v_mfma_f32_16x16x32_bf16 v[224:227], a[120:123], a[40:43], v[224:227]
s_add_u32 s74, s74, 215040
ds_read_b128 a[100:103], v1 offset:17408
v_mfma_f32_16x16x32_bf16 v[224:227], a[124:127], a[44:47], v[224:227]
v_exp_f32 v207, v207
v_mfma_f32_16x16x32_bf16 v[228:231], a[124:127], a[60:63], v[52:55]
ds_read_b128 a[152:155], v2 offset:6144
v_cvt_pk_bf16_f32 v237, v206, v207
v_mfma_f32_16x16x32_bf16 v[228:231], a[120:123], a[56:59], v[228:231]
v_exp_f32 v208, v208
v_mfma_f32_16x16x32_bf16 v[228:231], a[116:119], a[52:55], v[228:231]
ds_read_b128 a[104:107], v1 offset:18432
buffer_load_dwordx4 v0, s[20:23], s74 offen offset:0 sc1 lds
v_mfma_f32_16x16x32_bf16 v[228:231], a[112:115], a[48:51], v[228:231]
s_waitcnt lgkmcnt(9)
v_exp_f32 v209, v209
v_mfma_f32_16x16x32_bf16 v[104:107], a[128:131], v[252:255], v[104:107]
ds_read_b128 a[156:159], v2 offset:7168
v_cvt_pk_bf16_f32 v240, v208, v209
v_mfma_f32_16x16x32_bf16 v[136:139], a[128:131], v[64:67], v[136:139]
v_exp_f32 v210, v210
v_mfma_f32_16x16x32_bf16 v[168:171], a[128:131], v[68:71], v[168:171]
s_waitcnt lgkmcnt(9)
ds_read_b128 a[108:111], v1 offset:19456
buffer_load_dwordx4 v0, s[20:23], s74 offen offset:1024 sc1 lds
v_mfma_f32_16x16x32_bf16 v[172:175], a[132:135], v[68:71], v[172:175]
s_lshl_b32 s13, s82, 1
v_exp_f32 v211, v211
v_mfma_f32_16x16x32_bf16 v[140:143], a[132:135], v[64:67], v[140:143]
s_sub_u32 s13, 12, s13
v_cvt_pk_bf16_f32 v241, v210, v211
v_add_u32 v2, s12, v3
v_mfma_f32_16x16x32_bf16 v[108:111], a[132:135], v[252:255], v[108:111]
s_waitcnt lgkmcnt(9)
s_lshr_b32 s19, s80, 1
v_exp_f32 v212, v212
v_mfma_f32_16x16x32_bf16 v[112:115], a[136:139], v[252:255], v[112:115]
s_lshl1_add_u32 s18, s85, s19
s_lshl_b32 s18, s18, 9
s_add_u32 s18, s18, s84
v_mfma_f32_16x16x32_bf16 v[144:147], a[136:139], v[64:67], v[144:147]
s_lshl_b32 s18, s18, 7
v_exp_f32 v213, v213
v_mfma_f32_16x16x32_bf16 v[176:179], a[136:139], v[68:71], v[176:179]
s_waitcnt lgkmcnt(8)
s_lshl_b32 s19, s19, 13
ds_read_b128 a[112:115], v1 offset:20480
v_cvt_pk_bf16_f32 v244, v212, v213
v_mfma_f32_16x16x32_bf16 v[180:183], a[140:143], v[68:71], v[180:183]
s_mul_i32 s34, s3, 147456
v_exp_f32 v214, v214
v_mfma_f32_16x16x32_bf16 v[148:151], a[140:143], v[64:67], v[148:151]
s_add_u32 s19, s19, s34
s_add_u32 m0, s19, 0
v_mfma_f32_16x16x32_bf16 v[116:119], a[140:143], v[252:255], v[116:119]
s_waitcnt lgkmcnt(8)
v_exp_f32 v215, v215
v_mfma_f32_16x16x32_bf16 v[120:123], a[144:147], v[252:255], v[120:123]
ds_read_b128 a[116:119], v1 offset:21504
v_cvt_pk_bf16_f32 v245, v214, v215
v_mfma_f32_16x16x32_bf16 v[152:155], a[144:147], v[64:67], v[152:155]
v_exp_f32 v216, v216
v_mfma_f32_16x16x32_bf16 v[184:187], a[144:147], v[68:71], v[184:187]
s_waitcnt lgkmcnt(7)
buffer_load_dwordx4 v38, s[52:55], s18 offen offset:0 lds
v_mfma_f32_16x16x32_bf16 v[188:191], a[148:151], v[68:71], v[188:191]
s_add_u32 m0, s19, 960
v_exp_f32 v217, v217
v_mfma_f32_16x16x32_bf16 v[156:159], a[148:151], v[64:67], v[156:159]
ds_read_b128 a[120:123], v1 offset:22528
v_cvt_pk_bf16_f32 v234, v216, v217
v_mfma_f32_16x16x32_bf16 v[124:127], a[148:151], v[252:255], v[124:127]
s_waitcnt lgkmcnt(6)
v_exp_f32 v218, v218
v_mfma_f32_16x16x32_bf16 v[128:131], a[152:155], v[252:255], v[128:131]
buffer_load_dwordx4 v38, s[52:55], s18 offen offset:64 lds
v_mfma_f32_16x16x32_bf16 v[160:163], a[152:155], v[64:67], v[160:163]
s_add_u32 s18, s18, 16384
v_exp_f32 v219, v219
v_mfma_f32_16x16x32_bf16 v[192:195], a[152:155], v[68:71], v[192:195]
s_waitcnt lgkmcnt(4)
s_add_u32 m0, s19, 2048
ds_read_b128 a[124:127], v1 offset:23552
v_cvt_pk_bf16_f32 v235, v218, v219
v_mfma_f32_16x16x32_bf16 v[196:199], a[156:159], v[68:71], v[196:199]
v_exp_f32 v220, v220
v_mfma_f32_16x16x32_bf16 v[164:167], a[156:159], v[64:67], v[164:167]
buffer_load_dwordx4 v38, s[52:55], s18 offen offset:0 lds
v_mfma_f32_16x16x32_bf16 v[132:135], a[156:159], v[252:255], v[132:135]
s_add_u32 m0, s19, 3008
v_exp_f32 v221, v221
v_mfma_f32_16x16x32_bf16 a[164:167], a[184:187], v[252:255], a[164:167]
v_cvt_pk_bf16_f32 v238, v220, v221
v_add_u32 v1, s11, v0
v_mfma_f32_16x16x32_bf16 a[168:171], a[184:187], v[64:67], a[168:171]
v_exp_f32 v222, v222
v_mfma_f32_16x16x32_bf16 a[172:175], a[184:187], v[68:71], a[172:175]
buffer_load_dwordx4 v38, s[52:55], s18 offen offset:64 lds
v_exp_f32 v223, v223
s_nop 0
v_cvt_pk_bf16_f32 v239, v222, v223
s_add_u32 s18, s18, 16384
s_branch LA_l2p
LA_p21_s:
s_sleep 2
v_bfe_u32 v20, v0, 2, 7
buffer_load_dword v20, v20, s[76:79], s40 offen offset:0 sc1
s_waitcnt vmcnt(0)
v_cmp_lt_u32 s[32:33], 0, v20
s_nop 0
s_andn2_b32 s33, 16776960, s32
s_cbranch_scc1 LA_p21_s
s_branch LA_p21
LA_p41_s:
s_sleep 2
v_bfe_u32 v22, v0, 2, 7
buffer_load_dword v22, v22, s[76:79], s41 offen offset:0 sc1
s_waitcnt vmcnt(0)
v_cmp_lt_u32 s[32:33], 0, v22
s_nop 0
s_andn2_b32 s33, 255, s32
s_cbranch_scc1 LA_p41_s
s_branch LA_p41
LA_t71:
v_mfma_f32_32x32x16_bf16 a[0:15], a[224:227], a[224:227], 0
v_mfma_f32_32x32x16_bf16 a[16:31], a[224:227], a[224:227], 0
v_mfma_f32_16x16x32_bf16 v[200:203], a[96:99], a[64:67], v[56:59]
s_waitcnt vmcnt(63) lgkmcnt(0)
s_barrier
v_mfma_f32_16x16x32_bf16 v[200:203], a[100:103], a[68:71], v[200:203]
s_add_u32 s12, s12, 8192
v_exp_f32 v226, v226
v_mfma_f32_16x16x32_bf16 v[200:203], a[104:107], a[72:75], v[200:203]
s_and_b32 s12, s12, 0xffff
s_add_u32 s11, s11, 8192
s_lshr_b32 s19, s80, 1
v_mfma_f32_16x16x32_bf16 v[200:203], a[108:111], a[76:79], v[200:203]
s_and_b32 s11, s11, 0xffff
v_exp_f32 v227, v227
v_mfma_f32_16x16x32_bf16 v[204:207], a[108:111], a[92:95], v[60:63]
s_lshl1_add_u32 s18, s85, s19
ds_read_b128 a[128:131], v2 offset:0
v_cvt_pk_bf16_f32 v67, v226, v227
v_mfma_f32_16x16x32_bf16 v[204:207], a[104:107], a[88:91], v[204:207]
s_lshl_b32 s18, s18, 9
v_exp_f32 v228, v228
v_mfma_f32_16x16x32_bf16 v[204:207], a[100:103], a[84:87], v[204:207]
s_add_u32 s18, s18, s84
s_lshl_b32 s18, s18, 7
s_lshl_b32 s19, s19, 13
v_mfma_f32_16x16x32_bf16 v[204:207], a[96:99], a[80:83], v[204:207]
s_mul_i32 s34, s3, 147456
v_exp_f32 v229, v229
v_mfma_f32_16x16x32_bf16 v[208:211], a[96:99], a[32:35], v[48:51]
s_add_u32 s19, s19, s34
ds_read_b128 a[132:135], v2 offset:1024
v_cvt_pk_bf16_f32 v70, v228, v229
v_mfma_f32_16x16x32_bf16 v[208:211], a[100:103], a[36:39], v[208:211]
s_add_u32 m0, s19, 0
v_exp_f32 v230, v230
v_mfma_f32_16x16x32_bf16 v[208:211], a[104:107], a[40:43], v[208:211]
buffer_load_dwordx4 v38, s[52:55], s18 offen offset:0 lds
v_mfma_f32_16x16x32_bf16 v[208:211], a[108:111], a[44:47], v[208:211]
s_add_u32 m0, s19, 960
v_exp_f32 v231, v231
v_mfma_f32_16x16x32_bf16 v[212:215], a[108:111], a[60:63], v[52:55]
ds_read_b128 a[136:139], v2 offset:2048
v_cvt_pk_bf16_f32 v71, v230, v231
v_mfma_f32_16x16x32_bf16 v[212:215], a[104:107], a[56:59], v[212:215]
v_exp_f32 v200, v200
v_mfma_f32_16x16x32_bf16 v[212:215], a[100:103], a[52:55], v[212:215]
buffer_load_dwordx4 v38, s[52:55], s18 offen offset:64 lds
v_mfma_f32_16x16x32_bf16 v[212:215], a[96:99], a[48:51], v[212:215]
s_add_u32 s18, s18, 16384
v_exp_f32 v201, v201
v_mfma_f32_16x16x32_bf16 v[216:219], a[112:115], a[64:67], v[56:59]
s_add_u32 m0, s19, 2048
ds_read_b128 a[140:143], v2 offset:3072
v_cvt_pk_bf16_f32 v232, v200, v201
v_mfma_f32_16x16x32_bf16 v[216:219], a[116:119], a[68:71], v[216:219]
v_exp_f32 v202, v202
v_mfma_f32_16x16x32_bf16 v[216:219], a[120:123], a[72:75], v[216:219]
buffer_load_dwordx4 v38, s[52:55], s18 offen offset:0 lds
v_mfma_f32_16x16x32_bf16 v[216:219], a[124:127], a[76:79], v[216:219]
s_add_u32 m0, s19, 3008
v_exp_f32 v203, v203
v_mfma_f32_16x16x32_bf16 v[220:223], a[124:127], a[92:95], v[60:63]
ds_read_b128 a[144:147], v2 offset:4096
v_cvt_pk_bf16_f32 v233, v202, v203
v_mfma_f32_16x16x32_bf16 v[220:223], a[120:123], a[88:91], v[220:223]
v_exp_f32 v204, v204
v_mfma_f32_16x16x32_bf16 v[220:223], a[116:119], a[84:87], v[220:223]
ds_read_b128 a[96:99], v1 offset:16384
buffer_load_dwordx4 v38, s[52:55], s18 offen offset:64 lds
v_mfma_f32_16x16x32_bf16 v[220:223], a[112:115], a[80:83], v[220:223]
s_add_u32 s18, s18, 16384
v_exp_f32 v205, v205
v_mfma_f32_16x16x32_bf16 v[224:227], a[112:115], a[32:35], v[48:51]
ds_read_b128 a[148:151], v2 offset:5120
v_cvt_pk_bf16_f32 v236, v204, v205
v_bfe_u32 v20, v0, 2, 7
v_mfma_f32_16x16x32_bf16 v[224:227], a[116:119], a[36:39], v[224:227]
v_exp_f32 v206, v206
v_mfma_f32_16x16x32_bf16 v[224:227], a[120:123], a[40:43], v[224:227]
ds_read_b128 a[100:103], v1 offset:17408
buffer_load_dword v20, v20, s[76:79], s42 offen offset:128 sc1
v_mfma_f32_16x16x32_bf16 v[224:227], a[124:127], a[44:47], v[224:227]
s_add_u32 m0, s19, 4096
v_exp_f32 v207, v207
v_mfma_f32_16x16x32_bf16 v[228:231], a[124:127], a[60:63], v[52:55]
ds_read_b128 a[152:155], v2 offset:6144
v_cvt_pk_bf16_f32 v237, v206, v207
v_mfma_f32_16x16x32_bf16 v[228:231], a[120:123], a[56:59], v[228:231]
v_exp_f32 v208, v208
v_mfma_f32_16x16x32_bf16 v[228:231], a[116:119], a[52:55], v[228:231]
ds_read_b128 a[104:107], v1 offset:18432
buffer_load_dwordx4 v38, s[52:55], s18 offen offset:0 lds
v_mfma_f32_16x16x32_bf16 v[228:231], a[112:115], a[48:51], v[228:231]
s_waitcnt lgkmcnt(9)
s_add_u32 m0, s19, 5056
v_exp_f32 v209, v209
v_mfma_f32_16x16x32_bf16 v[104:107], a[128:131], v[252:255], v[104:107]
ds_read_b128 a[156:159], v2 offset:7168
v_cvt_pk_bf16_f32 v240, v208, v209
v_mfma_f32_16x16x32_bf16 v[136:139], a[128:131], v[64:67], v[136:139]
v_exp_f32 v210, v210
v_mfma_f32_16x16x32_bf16 v[168:171], a[128:131], v[68:71], v[168:171]
s_waitcnt lgkmcnt(9)
ds_read_b128 a[108:111], v1 offset:19456
buffer_load_dwordx4 v38, s[52:55], s18 offen offset:64 lds
v_mfma_f32_16x16x32_bf16 v[172:175], a[132:135], v[68:71], v[172:175]
s_add_u32 s18, s18, 16384
v_exp_f32 v211, v211
v_mfma_f32_16x16x32_bf16 v[140:143], a[132:135], v[64:67], v[140:143]
s_add_u32 m0, s19, 6144
v_cvt_pk_bf16_f32 v241, v210, v211
v_add_u32 v2, s12, v3
v_mfma_f32_16x16x32_bf16 v[108:111], a[132:135], v[252:255], v[108:111]
s_waitcnt lgkmcnt(9)
v_exp_f32 v212, v212
v_mfma_f32_16x16x32_bf16 v[112:115], a[136:139], v[252:255], v[112:115]
buffer_load_dwordx4 v38, s[52:55], s18 offen offset:0 lds
v_mfma_f32_16x16x32_bf16 v[144:147], a[136:139], v[64:67], v[144:147]
s_add_u32 m0, s19, 7104
v_exp_f32 v213, v213
v_mfma_f32_16x16x32_bf16 v[176:179], a[136:139], v[68:71], v[176:179]
s_waitcnt lgkmcnt(8)
ds_read_b128 a[112:115], v1 offset:20480
v_cvt_pk_bf16_f32 v244, v212, v213
v_mfma_f32_16x16x32_bf16 v[180:183], a[140:143], v[68:71], v[180:183]
v_exp_f32 v214, v214
v_mfma_f32_16x16x32_bf16 v[148:151], a[140:143], v[64:67], v[148:151]
buffer_load_dwordx4 v38, s[52:55], s18 offen offset:64 lds
v_mfma_f32_16x16x32_bf16 v[116:119], a[140:143], v[252:255], v[116:119]
s_waitcnt lgkmcnt(8)
s_add_u32 s18, s18, 16384
v_exp_f32 v215, v215
v_mfma_f32_16x16x32_bf16 v[120:123], a[144:147], v[252:255], v[120:123]
ds_read_b128 a[116:119], v1 offset:21504
v_cvt_pk_bf16_f32 v245, v214, v215
v_mfma_f32_16x16x32_bf16 v[152:155], a[144:147], v[64:67], v[152:155]
v_exp_f32 v216, v216
v_mfma_f32_16x16x32_bf16 v[184:187], a[144:147], v[68:71], v[184:187]
s_waitcnt lgkmcnt(7)
v_lshrrev_b32 v24, 6, v0
v_and_b32 v25, 7, v24
v_mfma_f32_16x16x32_bf16 v[188:191], a[148:151], v[68:71], v[188:191]
v_exp_f32 v217, v217
v_mfma_f32_16x16x32_bf16 v[156:159], a[148:151], v[64:67], v[156:159]
ds_read_b128 a[120:123], v1 offset:22528
v_cvt_pk_bf16_f32 v234, v216, v217
v_mfma_f32_16x16x32_bf16 v[124:127], a[148:151], v[252:255], v[124:127]
s_waitcnt lgkmcnt(6)
v_exp_f32 v218, v218
v_mfma_f32_16x16x32_bf16 v[128:131], a[152:155], v[252:255], v[128:131]
v_lshlrev_b32 v25, 5, v25
v_lshl_or_b32 v25, v24, 8, v25
v_mfma_f32_16x16x32_bf16 v[160:163], a[152:155], v[64:67], v[160:163]
v_exp_f32 v219, v219
v_mfma_f32_16x16x32_bf16 v[192:195], a[152:155], v[68:71], v[192:195]
s_waitcnt lgkmcnt(4)
ds_read_b128 a[124:127], v1 offset:23552
v_cvt_pk_bf16_f32 v235, v218, v219
v_mfma_f32_16x16x32_bf16 v[196:199], a[156:159], v[68:71], v[196:199]
v_exp_f32 v220, v220
v_mfma_f32_16x16x32_bf16 v[164:167], a[156:159], v[64:67], v[164:167]
v_bfe_u32 v24, v0, 4, 2
v_lshl_or_b32 v25, v24, 3, v25
v_mfma_f32_16x16x32_bf16 v[132:135], a[156:159], v[252:255], v[132:135]
v_exp_f32 v221, v221
v_mfma_f32_16x16x32_bf16 a[164:167], a[184:187], v[252:255], a[164:167]
v_cvt_pk_bf16_f32 v238, v220, v221
v_add_u32 v1, s11, v0
v_mfma_f32_16x16x32_bf16 a[168:171], a[184:187], v[64:67], a[168:171]
v_exp_f32 v222, v222
v_mfma_f32_16x16x32_bf16 a[172:175], a[184:187], v[68:71], a[172:175]
v_add_u32 v17, s17, v25
v_and_b32 v24, 511, v0
v_exp_f32 v223, v223
s_nop 0
v_cvt_pk_bf16_f32 v239, v222, v223
v_exp_f32 v224, v224
v_exp_f32 v225, v225
s_nop 0
v_cvt_pk_bf16_f32 v242, v224, v225
v_and_b32 v242, v242, v18
v_lshrrev_b32 v25, 9, v0
v_mul_u32_u24 v25, 147456, v25
v_add_u32 v16, v24, v25
v_mov_b32 v31, s50
s_add_u32 s35, s84, 1
s_and_b32 s35, s35, 7
v_lshl_add_u32 v8, s35, 11, v16
s_add_u32 s35, s84, 2
s_and_b32 s35, s35, 7
v_lshl_add_u32 v9, s35, 11, v16
s_add_u32 s35, s84, 3
s_and_b32 s35, s35, 7
v_lshl_add_u32 v10, s35, 11, v16
s_add_u32 s35, s84, 4
s_and_b32 s35, s35, 7
v_lshl_add_u32 v11, s35, 11, v16
s_add_u32 s35, s84, 5
s_and_b32 s35, s35, 7
v_lshl_add_u32 v12, s35, 11, v16
s_add_u32 s35, s84, 6
s_and_b32 s35, s35, 7
v_lshl_add_u32 v13, s35, 11, v16
s_add_u32 s35, s84, 7
s_and_b32 s35, s35, 7
v_lshl_add_u32 v14, s35, 11, v16
s_add_u32 s35, s84, 8
s_and_b32 s35, s35, 7
v_lshl_add_u32 v15, s35, 11, v16
v_accvgpr_read_b32 v24, a160
v_accvgpr_read_b32 v25, a164
v_subrev_u32 v21, 0x30800000, v24
v_rcp_f32 v24, v24
s_nop 0
v_mul_f32 v24, v24, v4
v_subrev_u32 v22, 0x30800000, v25
v_max_u32 v21, v21, v22
v_rcp_f32 v25, v25
s_nop 0
v_mul_f32 v25, v25, v5
v_cmp_lt_u32 vcc, 0x23000000, v21
v_pk_mul_f32 v[72:73], v[72:73], v[24:25] op_sel:[0,0] op_sel_hi:[1,0]
v_pk_mul_f32 v[74:75], v[74:75], v[24:25] op_sel:[0,0] op_sel_hi:[1,0]
v_pk_mul_f32 v[76:77], v[76:77], v[24:25] op_sel:[0,0] op_sel_hi:[1,0]
v_pk_mul_f32 v[78:79], v[78:79], v[24:25] op_sel:[0,0] op_sel_hi:[1,0]
v_cvt_pk_bf16_f32 v72, v72, v73
v_cvt_pk_bf16_f32 v73, v74, v75
v_cvt_pk_bf16_f32 v74, v76, v77
v_cvt_pk_bf16_f32 v75, v78, v79
buffer_store_dwordx4 v[72:75], v0, s[76:79], s88 offen offset:0 sc1
v_pk_mul_f32 v[80:81], v[80:81], v[24:25] op_sel:[0,0] op_sel_hi:[1,0]
v_pk_mul_f32 v[82:83], v[82:83], v[24:25] op_sel:[0,0] op_sel_hi:[1,0]
v_pk_mul_f32 v[84:85], v[84:85], v[24:25] op_sel:[0,0] op_sel_hi:[1,0]
v_pk_mul_f32 v[86:87], v[86:87], v[24:25] op_sel:[0,0] op_sel_hi:[1,0]
v_cvt_pk_bf16_f32 v76, v80, v81
v_cvt_pk_bf16_f32 v77, v82, v83
v_cvt_pk_bf16_f32 v78, v84, v85
v_cvt_pk_bf16_f32 v79, v86, v87
buffer_store_dwordx4 v[76:79], v0, s[76:79], s88 offen offset:1024 sc1
v_pk_mul_f32 v[88:89], v[88:89], v[24:25] op_sel:[0,0] op_sel_hi:[1,0]
v_pk_mul_f32 v[90:91], v[90:91], v[24:25] op_sel:[0,0] op_sel_hi:[1,0]
v_pk_mul_f32 v[92:93], v[92:93], v[24:25] op_sel:[0,0] op_sel_hi:[1,0]
v_pk_mul_f32 v[94:95], v[94:95], v[24:25] op_sel:[0,0] op_sel_hi:[1,0]
v_cvt_pk_bf16_f32 v80, v88, v89
v_cvt_pk_bf16_f32 v81, v90, v91
v_cvt_pk_bf16_f32 v82, v92, v93
v_cvt_pk_bf16_f32 v83, v94, v95
buffer_store_dwordx4 v[80:83], v0, s[76:79], s88 offen offset:2048 sc1
v_pk_mul_f32 v[96:97], v[96:97], v[24:25] op_sel:[0,0] op_sel_hi:[1,0]
v_pk_mul_f32 v[98:99], v[98:99], v[24:25] op_sel:[0,0] op_sel_hi:[1,0]
v_pk_mul_f32 v[100:101], v[100:101], v[24:25] op_sel:[0,0] op_sel_hi:[1,0]
v_pk_mul_f32 v[102:103], v[102:103], v[24:25] op_sel:[0,0] op_sel_hi:[1,0]
v_cvt_pk_bf16_f32 v84, v96, v97
v_cvt_pk_bf16_f32 v85, v98, v99
v_cvt_pk_bf16_f32 v86, v100, v101
v_cvt_pk_bf16_f32 v87, v102, v103
buffer_store_dwordx4 v[84:87], v0, s[76:79], s88 offen offset:3072 sc1
v_pk_mul_f32 v[104:105], v[104:105], v[24:25] op_sel:[0,1] op_sel_hi:[1,1]
v_pk_mul_f32 v[106:107], v[106:107], v[24:25] op_sel:[0,1] op_sel_hi:[1,1]
v_pk_mul_f32 v[108:109], v[108:109], v[24:25] op_sel:[0,1] op_sel_hi:[1,1]
v_pk_mul_f32 v[110:111], v[110:111], v[24:25] op_sel:[0,1] op_sel_hi:[1,1]
v_cvt_pk_bf16_f32 v88, v104, v105
v_cvt_pk_bf16_f32 v89, v106, v107
v_cvt_pk_bf16_f32 v90, v108, v109
v_cvt_pk_bf16_f32 v91, v110, v111
buffer_store_dwordx4 v[88:91], v0, s[76:79], s89 offen offset:0 sc1
v_pk_mul_f32 v[112:113], v[112:113], v[24:25] op_sel:[0,1] op_sel_hi:[1,1]
v_pk_mul_f32 v[114:115], v[114:115], v[24:25] op_sel:[0,1] op_sel_hi:[1,1]
v_pk_mul_f32 v[116:117], v[116:117], v[24:25] op_sel:[0,1] op_sel_hi:[1,1]
v_pk_mul_f32 v[118:119], v[118:119], v[24:25] op_sel:[0,1] op_sel_hi:[1,1]
v_cvt_pk_bf16_f32 v92, v112, v113
v_cvt_pk_bf16_f32 v93, v114, v115
v_cvt_pk_bf16_f32 v94, v116, v117
v_cvt_pk_bf16_f32 v95, v118, v119
buffer_store_dwordx4 v[92:95], v0, s[76:79], s89 offen offset:1024 sc1
v_pk_mul_f32 v[120:121], v[120:121], v[24:25] op_sel:[0,1] op_sel_hi:[1,1]
v_pk_mul_f32 v[122:123], v[122:123], v[24:25] op_sel:[0,1] op_sel_hi:[1,1]
v_pk_mul_f32 v[124:125], v[124:125], v[24:25] op_sel:[0,1] op_sel_hi:[1,1]
v_pk_mul_f32 v[126:127], v[126:127], v[24:25] op_sel:[0,1] op_sel_hi:[1,1]
v_cvt_pk_bf16_f32 v96, v120, v121
v_cvt_pk_bf16_f32 v97, v122, v123
v_cvt_pk_bf16_f32 v98, v124, v125
v_cvt_pk_bf16_f32 v99, v126, v127
buffer_store_dwordx4 v[96:99], v0, s[76:79], s89 offen offset:2048 sc1
v_pk_mul_f32 v[128:129], v[128:129], v[24:25] op_sel:[0,1] op_sel_hi:[1,1]
v_pk_mul_f32 v[130:131], v[130:131], v[24:25] op_sel:[0,1] op_sel_hi:[1,1]
v_pk_mul_f32 v[132:133], v[132:133], v[24:25] op_sel:[0,1] op_sel_hi:[1,1]
v_pk_mul_f32 v[134:135], v[134:135], v[24:25] op_sel:[0,1] op_sel_hi:[1,1]
v_cvt_pk_bf16_f32 v100, v128, v129
v_cvt_pk_bf16_f32 v101, v130, v131
v_cvt_pk_bf16_f32 v102, v132, v133
v_cvt_pk_bf16_f32 v103, v134, v135
buffer_store_dwordx4 v[100:103], v0, s[76:79], s89 offen offset:3072 sc1
s_cmp_eq_u64 vcc, 0
s_cselect_b32 s87, 1, s16
LA_p51_r:
s_waitcnt vmcnt(12)
v_cmp_lt_u32 vcc, 0, v20
s_nop 0
s_and_b32 s74, vcc_lo, 65535
s_cmp_eq_u32 s74, 65535
s_cbranch_scc1 LA_p51
s_sleep 2
v_bfe_u32 v20, v0, 2, 7
buffer_load_dword v20, v20, s[76:79], s42 offen offset:128 sc1
s_waitcnt vmcnt(0)
s_branch LA_p51_r
LA_p51:
buffer_load_dwordx4 a[192:195], v0, s[76:79], s96 offen offset:0 sc1
buffer_load_dwordx4 a[196:199], v0, s[76:79], s97 offen offset:0 sc1
buffer_load_dwordx4 a[200:203], v0, s[76:79], s98 offen offset:0 sc1
buffer_load_dwordx4 a[204:207], v0, s[76:79], s99 offen offset:0 sc1
buffer_load_dwordx4 a[208:211], v0, s[76:79], s96 offen offset:1024 sc1
buffer_load_dwordx4 a[212:215], v0, s[76:79], s97 offen offset:1024 sc1
buffer_load_dwordx4 a[216:219], v0, s[76:79], s98 offen offset:1024 sc1
buffer_load_dwordx4 a[220:223], v0, s[76:79], s99 offen offset:1024 sc1
buffer_load_dwordx4 v[104:107], v0, s[76:79], s96 offen offset:2048 sc1
buffer_load_dwordx4 v[108:111], v0, s[76:79], s97 offen offset:2048 sc1
buffer_load_dwordx4 v[112:115], v0, s[76:79], s98 offen offset:2048 sc1
buffer_load_dwordx4 v[116:119], v0, s[76:79], s99 offen offset:2048 sc1
buffer_load_dwordx4 v[120:123], v0, s[76:79], s96 offen offset:3072 sc1
buffer_load_dwordx4 v[124:127], v0, s[76:79], s97 offen offset:3072 sc1
buffer_load_dwordx4 v[128:131], v0, s[76:79], s98 offen offset:3072 sc1
buffer_load_dwordx4 v[132:135], v0, s[76:79], s99 offen offset:3072 sc1
s_waitcnt vmcnt(24)
s_branch LA_d21
LA_d11:
s_waitcnt lgkmcnt(7)
v_mfma_f32_16x16x32_bf16 v[200:203], a[96:99], a[64:67], v[56:59]
s_waitcnt vmcnt(63) lgkmcnt(0)
s_barrier
v_mfma_f32_16x16x32_bf16 v[200:203], a[100:103], a[68:71], v[200:203]
s_add_u32 s12, s12, 16384
v_exp_f32 v226, v226
v_mfma_f32_16x16x32_bf16 v[200:203], a[104:107], a[72:75], v[200:203]
s_and_b32 s12, s12, 0xffff
s_add_u32 s11, s11, 8192
v_mfma_f32_16x16x32_bf16 v[200:203], a[108:111], a[76:79], v[200:203]
s_and_b32 s11, s11, 0xffff
v_exp_f32 v227, v227
v_mfma_f32_16x16x32_bf16 v[204:207], a[108:111], a[92:95], v[60:63]
ds_read_b128 a[128:131], v2 offset:0
v_cvt_pk_bf16_f32 v67, v226, v227
v_mfma_f32_16x16x32_bf16 v[204:207], a[104:107], a[88:91], v[204:207]
v_exp_f32 v228, v228
v_mfma_f32_16x16x32_bf16 v[204:207], a[100:103], a[84:87], v[204:207]
buffer_load_dwordx4 v[104:107], v0, s[76:79], s96 offen offset:2048 sc1
v_mfma_f32_16x16x32_bf16 v[204:207], a[96:99], a[80:83], v[204:207]
v_exp_f32 v229, v229
v_mfma_f32_16x16x32_bf16 v[208:211], a[96:99], a[32:35], v[48:51]
ds_read_b128 a[132:135], v2 offset:1024
v_cvt_pk_bf16_f32 v70, v228, v229
v_mfma_f32_16x16x32_bf16 v[208:211], a[100:103], a[36:39], v[208:211]
v_exp_f32 v230, v230
v_mfma_f32_16x16x32_bf16 v[208:211], a[104:107], a[40:43], v[208:211]
buffer_load_dwordx4 v[108:111], v0, s[76:79], s97 offen offset:2048 sc1
v_mfma_f32_16x16x32_bf16 v[208:211], a[108:111], a[44:47], v[208:211]
v_exp_f32 v231, v231
v_mfma_f32_16x16x32_bf16 v[212:215], a[108:111], a[60:63], v[52:55]
ds_read_b128 a[136:139], v2 offset:2048
v_cvt_pk_bf16_f32 v71, v230, v231
v_mfma_f32_16x16x32_bf16 v[212:215], a[104:107], a[56:59], v[212:215]
v_exp_f32 v200, v200
v_mfma_f32_16x16x32_bf16 v[212:215], a[100:103], a[52:55], v[212:215]
buffer_load_dwordx4 v[112:115], v0, s[76:79], s98 offen offset:2048 sc1
v_mfma_f32_16x16x32_bf16 v[212:215], a[96:99], a[48:51], v[212:215]
v_exp_f32 v201, v201
v_mfma_f32_16x16x32_bf16 v[216:219], a[112:115], a[64:67], v[56:59]
ds_read_b128 a[140:143], v2 offset:3072
v_cvt_pk_bf16_f32 v232, v200, v201
v_mfma_f32_16x16x32_bf16 v[216:219], a[116:119], a[68:71], v[216:219]
v_exp_f32 v202, v202
v_mfma_f32_16x16x32_bf16 v[216:219], a[120:123], a[72:75], v[216:219]
buffer_load_dwordx4 v[116:119], v0, s[76:79], s99 offen offset:2048 sc1
v_mfma_f32_16x16x32_bf16 v[216:219], a[124:127], a[76:79], v[216:219]
v_exp_f32 v203, v203
v_mfma_f32_16x16x32_bf16 v[220:223], a[124:127], a[92:95], v[60:63]
ds_read_b128 a[144:147], v2 offset:4096
v_cvt_pk_bf16_f32 v233, v202, v203
v_mfma_f32_16x16x32_bf16 v[220:223], a[120:123], a[88:91], v[220:223]
v_exp_f32 v204, v204
v_mfma_f32_16x16x32_bf16 v[220:223], a[116:119], a[84:87], v[220:223]
buffer_load_dwordx4 v[120:123], v0, s[76:79], s96 offen offset:3072 sc1
v_mfma_f32_16x16x32_bf16 v[220:223], a[112:115], a[80:83], v[220:223]
v_exp_f32 v205, v205
v_mfma_f32_16x16x32_bf16 v[224:227], a[112:115], a[32:35], v[48:51]
ds_read_b128 a[148:151], v2 offset:5120
v_cvt_pk_bf16_f32 v236, v204, v205
v_mfma_f32_16x16x32_bf16 v[224:227], a[116:119], a[36:39], v[224:227]
v_exp_f32 v206, v206
v_mfma_f32_16x16x32_bf16 v[224:227], a[120:123], a[40:43], v[224:227]
buffer_load_dwordx4 v[124:127], v0, s[76:79], s97 offen offset:3072 sc1
v_mfma_f32_16x16x32_bf16 v[224:227], a[124:127], a[44:47], v[224:227]
v_exp_f32 v207, v207
v_mfma_f32_16x16x32_bf16 v[228:231], a[124:127], a[60:63], v[52:55]
ds_read_b128 a[152:155], v2 offset:6144
v_cvt_pk_bf16_f32 v237, v206, v207
v_mfma_f32_16x16x32_bf16 v[228:231], a[120:123], a[56:59], v[228:231]
v_exp_f32 v208, v208
v_mfma_f32_16x16x32_bf16 v[228:231], a[116:119], a[52:55], v[228:231]
buffer_load_dwordx4 v[128:131], v0, s[76:79], s98 offen offset:3072 sc1
v_mfma_f32_16x16x32_bf16 v[228:231], a[112:115], a[48:51], v[228:231]
s_waitcnt lgkmcnt(6)
v_exp_f32 v209, v209
v_mfma_f32_16x16x32_bf16 a[0:3], a[128:131], v[248:251], a[0:3]
ds_read_b128 a[156:159], v2 offset:7168
v_cvt_pk_bf16_f32 v240, v208, v209
v_mfma_f32_16x16x32_bf16 a[224:227], a[128:131], v[252:255], a[224:227]
v_exp_f32 v210, v210
v_mfma_f32_16x16x32_bf16 v[136:139], a[128:131], v[64:67], v[136:139]
ds_read_b128 a[96:99], v1 offset:16384
v_mfma_f32_16x16x32_bf16 v[168:171], a[128:131], v[68:71], v[168:171]
s_waitcnt lgkmcnt(7)
v_exp_f32 v211, v211
v_mfma_f32_16x16x32_bf16 v[172:175], a[132:135], v[68:71], v[172:175]
v_cvt_pk_bf16_f32 v241, v210, v211
v_add_u32 v2, s12, v3
v_mfma_f32_16x16x32_bf16 v[140:143], a[132:135], v[64:67], v[140:143]
v_exp_f32 v212, v212
v_mfma_f32_16x16x32_bf16 a[228:231], a[132:135], v[252:255], a[228:231]
ds_read_b128 a[100:103], v1 offset:17408
v_mfma_f32_16x16x32_bf16 a[4:7], a[132:135], v[248:251], a[4:7]
s_waitcnt lgkmcnt(7)
v_exp_f32 v213, v213
v_mfma_f32_16x16x32_bf16 a[8:11], a[136:139], v[248:251], a[8:11]
ds_read_b128 a[104:107], v1 offset:18432
v_cvt_pk_bf16_f32 v244, v212, v213
v_mfma_f32_16x16x32_bf16 a[232:235], a[136:139], v[252:255], a[232:235]
v_exp_f32 v214, v214
v_mfma_f32_16x16x32_bf16 v[144:147], a[136:139], v[64:67], v[144:147]
buffer_load_dwordx4 v[132:135], v0, s[76:79], s99 offen offset:3072 sc1
v_mfma_f32_16x16x32_bf16 v[176:179], a[136:139], v[68:71], v[176:179]
s_waitcnt lgkmcnt(7)
v_exp_f32 v215, v215
v_mfma_f32_16x16x32_bf16 v[180:183], a[140:143], v[68:71], v[180:183]
ds_read_b128 a[108:111], v1 offset:19456
v_cvt_pk_bf16_f32 v245, v214, v215
v_mfma_f32_16x16x32_bf16 v[148:151], a[140:143], v[64:67], v[148:151]
v_exp_f32 v216, v216
v_mfma_f32_16x16x32_bf16 a[236:239], a[140:143], v[252:255], a[236:239]
v_mfma_f32_16x16x32_bf16 a[12:15], a[140:143], v[248:251], a[12:15]
s_waitcnt lgkmcnt(7)
v_exp_f32 v217, v217
v_mfma_f32_16x16x32_bf16 a[16:19], a[144:147], v[248:251], a[16:19]
ds_read_b128 a[112:115], v1 offset:20480
v_cvt_pk_bf16_f32 v234, v216, v217
v_mfma_f32_16x16x32_bf16 a[240:243], a[144:147], v[252:255], a[240:243]
v_exp_f32 v218, v218
v_mfma_f32_16x16x32_bf16 v[152:155], a[144:147], v[64:67], v[152:155]
v_mfma_f32_16x16x32_bf16 v[184:187], a[144:147], v[68:71], v[184:187]
s_waitcnt lgkmcnt(7)
v_exp_f32 v219, v219
v_mfma_f32_16x16x32_bf16 v[188:191], a[148:151], v[68:71], v[188:191]
ds_read_b128 a[116:119], v1 offset:21504
v_cvt_pk_bf16_f32 v235, v218, v219
v_mfma_f32_16x16x32_bf16 v[156:159], a[148:151], v[64:67], v[156:159]
v_exp_f32 v220, v220
v_mfma_f32_16x16x32_bf16 a[244:247], a[148:151], v[252:255], a[244:247]
v_mfma_f32_16x16x32_bf16 a[20:23], a[148:151], v[248:251], a[20:23]
s_waitcnt lgkmcnt(7)
v_exp_f32 v221, v221
v_mfma_f32_16x16x32_bf16 a[24:27], a[152:155], v[248:251], a[24:27]
ds_read_b128 a[120:123], v1 offset:22528
v_cvt_pk_bf16_f32 v238, v220, v221
v_mfma_f32_16x16x32_bf16 a[248:251], a[152:155], v[252:255], a[248:251]
v_exp_f32 v222, v222
v_mfma_f32_16x16x32_bf16 v[160:163], a[152:155], v[64:67], v[160:163]
v_mfma_f32_16x16x32_bf16 v[192:195], a[152:155], v[68:71], v[192:195]
s_waitcnt lgkmcnt(7)
v_exp_f32 v223, v223
v_mfma_f32_16x16x32_bf16 v[196:199], a[156:159], v[68:71], v[196:199]
ds_read_b128 a[124:127], v1 offset:23552
v_cvt_pk_bf16_f32 v239, v222, v223
v_mfma_f32_16x16x32_bf16 v[164:167], a[156:159], v[64:67], v[164:167]
v_exp_f32 v224, v224
v_mfma_f32_16x16x32_bf16 a[252:255], a[156:159], v[252:255], a[252:255]
v_add_u32 v1, s11, v0
v_mfma_f32_16x16x32_bf16 a[28:31], a[156:159], v[248:251], a[28:31]
v_exp_f32 v225, v225
v_mfma_f32_16x16x32_bf16 a[176:179], a[184:187], v[248:251], a[176:179]
v_cvt_pk_bf16_f32 v242, v224, v225
v_and_b32 v242, v242, v18
v_mfma_f32_16x16x32_bf16 a[180:183], a[184:187], v[252:255], a[180:183]
v_mfma_f32_16x16x32_bf16 a[168:171], a[184:187], v[64:67], a[168:171]
v_mfma_f32_16x16x32_bf16 a[172:175], a[184:187], v[68:71], a[172:175]
s_waitcnt vmcnt(19)
LA_d21:
s_add_u32 s12, s12, s14
s_and_b32 s12, s12, 0xffff
v_add_u32 v1, s12, v3
s_waitcnt lgkmcnt(7)
v_mfma_f32_16x16x32_bf16 v[212:215], a[96:99], a[48:51], v[52:55]
s_waitcnt lgkmcnt(0)
s_barrier
v_mfma_f32_16x16x32_bf16 v[212:215], a[100:103], a[52:55], v[212:215]
ds_read_b128 a[128:131], v2 offset:0
ds_read_b128 a[132:135], v2 offset:1024
v_exp_f32 v226, v226
v_mfma_f32_16x16x32_bf16 v[212:215], a[104:107], a[56:59], v[212:215]
s_add_u32 s18, s85, 0
s_and_b32 s18, s18, 3
ds_read_b128 a[136:139], v2 offset:2048
v_mfma_f32_16x16x32_bf16 v[212:215], a[108:111], a[60:63], v[212:215]
s_waitcnt lgkmcnt(2)
ds_read_b128 a[140:143], v2 offset:3072
v_exp_f32 v227, v227
v_mfma_f32_16x16x32_bf16 a[0:3], a[128:131], v[232:235], a[0:3]
s_lshl_b32 s18, s18, 17
v_cvt_pk_bf16_f32 v243, v226, v227
v_and_b32 v243, v243, v19
v_mfma_f32_16x16x32_bf16 a[224:227], a[128:131], v[236:239], a[224:227]
s_waitcnt lgkmcnt(2)
s_lshl_b32 s19, s80, 11
v_exp_f32 v228, v228
v_mfma_f32_16x16x32_bf16 a[228:231], a[132:135], v[236:239], a[228:231]
s_add_u32 s19, s19, s17
s_add_u32 m0, s19, 0
ds_read_b128 a[144:147], v2 offset:4096
v_mfma_f32_16x16x32_bf16 a[4:7], a[132:135], v[232:235], a[4:7]
s_waitcnt lgkmcnt(2)
v_exp_f32 v229, v229
v_mfma_f32_16x16x32_bf16 a[8:11], a[136:139], v[232:235], a[8:11]
ds_read_b128 a[148:151], v2 offset:5120
v_cvt_pk_bf16_f32 v246, v228, v229
v_mfma_f32_16x16x32_bf16 a[232:235], a[136:139], v[236:239], a[232:235]
s_waitcnt lgkmcnt(2)
v_exp_f32 v230, v230
v_mfma_f32_16x16x32_bf16 a[236:239], a[140:143], v[236:239], a[236:239]
ds_read_b128 a[152:155], v2 offset:6144
buffer_load_dwordx4 v36, s[28:31], s18 offen offset:0 lds
v_mfma_f32_16x16x32_bf16 a[12:15], a[140:143], v[232:235], a[12:15]
s_waitcnt lgkmcnt(2)
v_exp_f32 v231, v231
v_mfma_f32_16x16x32_bf16 a[16:19], a[144:147], v[232:235], a[16:19]
ds_read_b128 a[156:159], v2 offset:7168
v_cvt_pk_bf16_f32 v247, v230, v231
v_mfma_f32_16x16x32_bf16 a[240:243], a[144:147], v[236:239], a[240:243]
s_waitcnt lgkmcnt(2)
v_exp_f32 v212, v212
v_mfma_f32_16x16x32_bf16 a[244:247], a[148:151], v[236:239], a[244:247]
ds_write_b128 v26, a[0:3] offset:16384
v_mfma_f32_16x16x32_bf16 a[20:23], a[148:151], v[232:235], a[20:23]
s_waitcnt lgkmcnt(2)
v_exp_f32 v213, v213
v_mfma_f32_16x16x32_bf16 a[24:27], a[152:155], v[232:235], a[24:27]
v_cvt_pk_bf16_f32 v68, v212, v213
v_and_b32 v68, v68, v18
v_mfma_f32_16x16x32_bf16 a[248:251], a[152:155], v[236:239], a[248:251]
s_waitcnt lgkmcnt(1)
v_exp_f32 v214, v214
v_mfma_f32_16x16x32_bf16 a[252:255], a[156:159], v[236:239], a[252:255]
ds_write_b128 v26, a[4:7] offset:17408
v_mfma_f32_16x16x32_bf16 a[28:31], a[156:159], v[232:235], a[28:31]
v_exp_f32 v215, v215
v_mfma_f32_16x16x32_bf16 v[136:139], a[128:131], v[240:243], v[136:139]
v_cvt_pk_bf16_f32 v69, v214, v215
v_and_b32 v69, v69, v19
v_mfma_f32_16x16x32_bf16 v[168:171], a[128:131], v[244:247], v[168:171]
v_mov_b32 v70, 0
v_mov_b32 v71, 0
v_mfma_f32_16x16x32_bf16 v[172:175], a[132:135], v[244:247], v[172:175]
ds_read_b128 a[128:131], v1 offset:0
buffer_load_dwordx4 v37, s[28:31], s18 offen offset:1024 lds
v_mfma_f32_16x16x32_bf16 v[140:143], a[132:135], v[240:243], v[140:143]
s_add_u32 m0, s19, 8192
s_add_u32 s18, s18, 32768
ds_read_b128 a[132:135], v1 offset:1024
v_mfma_f32_16x16x32_bf16 v[144:147], a[136:139], v[240:243], v[144:147]
ds_write_b128 v26, a[8:11] offset:18432
v_mfma_f32_16x16x32_bf16 v[176:179], a[136:139], v[244:247], v[176:179]
ds_read_b128 a[136:139], v1 offset:2048
v_mfma_f32_16x16x32_bf16 v[180:183], a[140:143], v[244:247], v[180:183]
ds_write_b128 v26, a[12:15] offset:19456
v_mfma_f32_16x16x32_bf16 v[148:151], a[140:143], v[240:243], v[148:151]
ds_read_b128 a[140:143], v1 offset:3072
buffer_load_dwordx4 v36, s[28:31], s18 offen offset:0 lds
v_mfma_f32_16x16x32_bf16 v[152:155], a[144:147], v[240:243], v[152:155]
ds_write_b128 v26, a[16:19] offset:20480
v_mfma_f32_16x16x32_bf16 v[184:187], a[144:147], v[244:247], v[184:187]
ds_read_b128 a[144:147], v1 offset:4096
v_mfma_f32_16x16x32_bf16 v[188:191], a[148:151], v[244:247], v[188:191]
ds_write_b128 v26, a[20:23] offset:21504
v_mfma_f32_16x16x32_bf16 v[156:159], a[148:151], v[240:243], v[156:159]
ds_read_b128 a[148:151], v1 offset:5120
buffer_load_dwordx4 v37, s[28:31], s18 offen offset:1024 lds
v_mfma_f32_16x16x32_bf16 v[160:163], a[152:155], v[240:243], v[160:163]
s_add_u32 m0, s19, 16384
ds_write_b128 v26, a[24:27] offset:22528
v_mfma_f32_16x16x32_bf16 v[192:195], a[152:155], v[244:247], v[192:195]
s_add_u32 s18, s18, 32768
ds_read_b128 a[152:155], v1 offset:6144
v_mfma_f32_16x16x32_bf16 v[196:199], a[156:159], v[244:247], v[196:199]
ds_write_b128 v26, a[28:31] offset:23552
v_mfma_f32_16x16x32_bf16 v[164:167], a[156:159], v[240:243], v[164:167]
ds_read_b128 a[156:159], v1 offset:7168
buffer_load_dwordx4 v36, s[28:31], s18 offen offset:0 lds
v_mfma_f32_16x16x32_bf16 a[176:179], a[184:187], v[232:235], a[176:179]
v_mfma_f32_16x16x32_bf16 a[180:183], a[184:187], v[236:239], a[180:183]
v_mfma_f32_16x16x32_bf16 a[168:171], a[184:187], v[240:243], a[168:171]
v_mfma_f32_16x16x32_bf16 a[172:175], a[184:187], v[244:247], a[172:175]
buffer_load_dwordx4 v37, s[28:31], s18 offen offset:1024 lds
s_add_u32 m0, s19, 24576
s_add_u32 s18, s18, 32768
buffer_load_dwordx4 v36, s[28:31], s18 offen offset:0 lds
buffer_load_dwordx4 v37, s[28:31], s18 offen offset:1024 lds
s_cmp_eq_u32 s82, 7
s_cbranch_scc0 LA_e1
s_waitcnt vmcnt(24)
s_mov_b32 exec_lo, s87
s_mov_b32 exec_hi, 0
buffer_store_dword v3, off, s[76:79], s43 offset:16 sc1
s_mov_b64 exec, -1
buffer_load_dword v38, v30, s[76:79], s88 offen sc1
buffer_load_dword v38, v30, s[76:79], s89 offen sc1
LA_e1:
s_waitcnt lgkmcnt(13)
v_mfma_f32_16x16x32_bf16 v[168:171], a[128:131], v[68:71], v[168:171]
s_waitcnt lgkmcnt(0)
s_barrier
v_mfma_f32_16x16x32_bf16 v[172:175], a[132:135], v[68:71], v[172:175]
ds_write_b128 v26, a[224:227] offset:24576
v_mfma_f32_16x16x32_bf16 v[176:179], a[136:139], v[68:71], v[176:179]
ds_write_b128 v26, a[228:231] offset:25600
v_mfma_f32_16x16x32_bf16 v[180:183], a[140:143], v[68:71], v[180:183]
ds_write_b128 v26, a[232:235] offset:26624
v_mfma_f32_16x16x32_bf16 v[184:187], a[144:147], v[68:71], v[184:187]
ds_write_b128 v26, a[236:239] offset:27648
v_mfma_f32_16x16x32_bf16 v[188:191], a[148:151], v[68:71], v[188:191]
ds_write_b128 v26, a[240:243] offset:28672
v_mfma_f32_16x16x32_bf16 v[192:195], a[152:155], v[68:71], v[192:195]
ds_write_b128 v26, a[244:247] offset:29696
v_mfma_f32_16x16x32_bf16 v[196:199], a[156:159], v[68:71], v[196:199]
ds_write_b128 v26, a[248:251] offset:30720
v_mfma_f32_16x16x32_bf16 a[172:175], a[184:187], v[68:71], a[172:175]
ds_write_b128 v26, a[252:255] offset:31744
s_add_u32 s18, s85, 1
s_and_b32 s18, s18, 3
s_lshl_b32 s18, s18, 17
s_lshl_b32 s19, s80, 11
s_add_u32 s19, s19, s50
s_add_u32 m0, s19, 0
s_nop 0
buffer_load_dwordx4 v36, s[28:31], s18 offen offset:0 lds
buffer_load_dwordx4 v37, s[28:31], s18 offen offset:1024 lds
s_add_u32 m0, s19, 8192
s_add_u32 s18, s18, 32768
buffer_load_dwordx4 v36, s[28:31], s18 offen offset:0 lds
buffer_load_dwordx4 v37, s[28:31], s18 offen offset:1024 lds
s_add_u32 m0, s19, 16384
s_add_u32 s18, s18, 32768
buffer_load_dwordx4 v36, s[28:31], s18 offen offset:0 lds
buffer_load_dwordx4 v37, s[28:31], s18 offen offset:1024 lds
s_lshl_b32 s34, s82, 3
s_add_u32 s8, s34, s80
s_sub_u32 s11, 127, s8
s_sub_u32 s9, s34, s80
s_add_u32 s9, s9, 7
s_sub_u32 s10, 127, s9
s_lshl3_add_u32 s12, s85, s84
s_lshl_b32 s12, s12, 5
s_lshl_b32 s8, s8, 14
s_add_u32 s8, s8, s12
s_lshl_b32 s9, s9, 14
s_add_u32 s9, s9, s12
s_lshl_b32 s10, s10, 14
s_add_u32 s10, s10, s12
s_lshl_b32 s11, s11, 14
s_add_u32 s11, s11, s12
v_bfe_u32 v25, v0, 4, 4
v_lshrrev_b32 v1, 8, v0
v_lshlrev_b32 v1, 3, v1
v_lshl_or_b32 v2, v25, 10, v1
s_branch LA_fin
LA_pm2:
s_waitcnt lgkmcnt(7)
v_mfma_f32_16x16x32_bf16 v[200:203], a[96:99], a[0:3], v[40:43]
s_waitcnt vmcnt(63) lgkmcnt(0)
s_barrier
v_mfma_f32_16x16x32_bf16 v[200:203], a[100:103], a[4:7], v[200:203]
s_add_u32 s11, s11, 8192
v_bfe_u32 v20, v0, 2, 7
v_mfma_f32_16x16x32_bf16 v[200:203], a[104:107], a[8:11], v[200:203]
s_and_b32 s11, s11, 0xffff
ds_read_b128 a[64:67], v23 offset:0
v_mfma_f32_16x16x32_bf16 v[200:203], a[108:111], a[12:15], v[200:203]
buffer_load_dword v20, v20, s[76:79], s40 offen offset:0 sc1
v_mfma_f32_16x16x32_bf16 v[204:207], a[108:111], a[28:31], v[44:47]
s_add_u32 m0, s5, s6
ds_read_b128 a[68:71], v23 offset:1024
v_mfma_f32_16x16x32_bf16 v[204:207], a[104:107], a[24:27], v[204:207]
buffer_load_dwordx4 v0, s[20:23], s4 offen offset:0 sc1 lds
v_mfma_f32_16x16x32_bf16 v[204:207], a[100:103], a[20:23], v[204:207]
ds_read_b128 a[72:75], v23 offset:2048
v_mfma_f32_16x16x32_bf16 v[204:207], a[96:99], a[16:19], v[204:207]
v_exp_f32 v200, v200
v_mfma_f32_16x16x32_bf16 v[208:211], a[96:99], a[32:35], v[48:51]
v_exp_f32 v201, v201
v_mfma_f32_16x16x32_bf16 v[208:211], a[100:103], a[36:39], v[208:211]
buffer_load_dwordx4 v0, s[20:23], s4 offen offset:1024 sc1 lds
v_cvt_pk_bf16_f32 v232, v200, v201
v_mfma_f32_16x16x32_bf16 v[208:211], a[104:107], a[40:43], v[208:211]
v_exp_f32 v202, v202
v_mfma_f32_16x16x32_bf16 v[208:211], a[108:111], a[44:47], v[208:211]
v_exp_f32 v203, v203
v_mfma_f32_16x16x32_bf16 v[212:215], a[108:111], a[60:63], v[52:55]
ds_read_b128 a[76:79], v23 offset:3072
v_cvt_pk_bf16_f32 v233, v202, v203
v_mfma_f32_16x16x32_bf16 v[212:215], a[104:107], a[56:59], v[212:215]
v_exp_f32 v204, v204
v_mfma_f32_16x16x32_bf16 v[212:215], a[100:103], a[52:55], v[212:215]
v_exp_f32 v205, v205
v_mfma_f32_16x16x32_bf16 v[212:215], a[96:99], a[48:51], v[212:215]
ds_read_b128 a[96:99], v1 offset:16384
v_cvt_pk_bf16_f32 v236, v204, v205
v_mfma_f32_16x16x32_bf16 v[216:219], a[112:115], a[0:3], v[40:43]
v_exp_f32 v206, v206
v_mfma_f32_16x16x32_bf16 v[216:219], a[116:119], a[4:7], v[216:219]
v_exp_f32 v207, v207
v_mfma_f32_16x16x32_bf16 v[216:219], a[120:123], a[8:11], v[216:219]
ds_read_b128 a[100:103], v1 offset:17408
v_cvt_pk_bf16_f32 v237, v206, v207
v_mfma_f32_16x16x32_bf16 v[216:219], a[124:127], a[12:15], v[216:219]
v_exp_f32 v208, v208
v_mfma_f32_16x16x32_bf16 v[220:223], a[124:127], a[28:31], v[44:47]
v_exp_f32 v209, v209
v_mfma_f32_16x16x32_bf16 v[220:223], a[120:123], a[24:27], v[220:223]
ds_read_b128 a[104:107], v1 offset:18432
v_cvt_pk_bf16_f32 v240, v208, v209
v_mfma_f32_16x16x32_bf16 v[220:223], a[116:119], a[20:23], v[220:223]
v_exp_f32 v210, v210
v_mfma_f32_16x16x32_bf16 v[220:223], a[112:115], a[16:19], v[220:223]
v_exp_f32 v211, v211
v_mfma_f32_16x16x32_bf16 v[224:227], a[112:115], a[32:35], v[48:51]
ds_read_b128 a[108:111], v1 offset:19456
v_cvt_pk_bf16_f32 v241, v210, v211
v_mfma_f32_16x16x32_bf16 v[224:227], a[116:119], a[36:39], v[224:227]
v_exp_f32 v212, v212
v_mfma_f32_16x16x32_bf16 v[224:227], a[120:123], a[40:43], v[224:227]
v_exp_f32 v213, v213
v_mfma_f32_16x16x32_bf16 v[224:227], a[124:127], a[44:47], v[224:227]
buffer_load_dwordx4 v0, s[20:23], s4 offen offset:2048 sc1 lds
v_cvt_pk_bf16_f32 v244, v212, v213
v_mfma_f32_16x16x32_bf16 v[228:231], a[124:127], a[60:63], v[52:55]
v_exp_f32 v214, v214
v_mfma_f32_16x16x32_bf16 v[228:231], a[120:123], a[56:59], v[228:231]
v_exp_f32 v215, v215
v_mfma_f32_16x16x32_bf16 v[228:231], a[116:119], a[52:55], v[228:231]
ds_read_b128 a[80:83], v23 offset:4096
v_cvt_pk_bf16_f32 v245, v214, v215
v_mfma_f32_16x16x32_bf16 v[228:231], a[112:115], a[48:51], v[228:231]
ds_read_b128 a[112:115], v1 offset:20480
ds_read_b128 a[116:119], v1 offset:21504
ds_read_b128 a[120:123], v1 offset:22528
ds_read_b128 a[124:127], v1 offset:23552
v_exp_f32 v216, v216
v_exp_f32 v217, v217
s_nop 0
v_cvt_pk_bf16_f32 v234, v216, v217
v_exp_f32 v218, v218
v_exp_f32 v219, v219
s_nop 0
v_cvt_pk_bf16_f32 v235, v218, v219
v_exp_f32 v220, v220
v_exp_f32 v221, v221
s_nop 0
v_cvt_pk_bf16_f32 v238, v220, v221
v_exp_f32 v222, v222
v_exp_f32 v223, v223
s_nop 0
v_cvt_pk_bf16_f32 v239, v222, v223
v_exp_f32 v224, v224
v_exp_f32 v225, v225
s_nop 0
v_cvt_pk_bf16_f32 v242, v224, v225
v_add_u32 v1, s11, v0
buffer_load_dwordx4 v0, s[20:23], s4 offen offset:3072 sc1 lds
s_add_u32 s4, s4, 16384
s_add_u32 s5, s5, 8192
s_and_b32 s5, s5, 0xffff
buffer_load_dword v34, v24, s[28:31], 0 offen
buffer_load_dword v35, v25, s[52:55], 0 offen
ds_read_b128 a[84:87], v23 offset:5120
ds_read_b128 a[88:91], v23 offset:6144
ds_read_b128 a[92:95], v23 offset:7168
s_branch LA_b12
LA_ma2:
s_waitcnt lgkmcnt(7)
v_mfma_f32_16x16x32_bf16 v[200:203], a[96:99], a[0:3], v[40:43]
s_waitcnt vmcnt(8) lgkmcnt(0)
s_barrier
v_mfma_f32_16x16x32_bf16 v[200:203], a[100:103], a[4:7], v[200:203]
s_add_u32 s12, s12, 8192
v_exp_f32 v226, v226
v_mfma_f32_16x16x32_bf16 v[200:203], a[104:107], a[8:11], v[200:203]
s_and_b32 s12, s12, 0xffff
s_add_u32 s11, s11, 8192
s_add_u32 m0, s5, s6
v_mfma_f32_16x16x32_bf16 v[200:203], a[108:111], a[12:15], v[200:203]
s_and_b32 s11, s11, 0xffff
v_exp_f32 v227, v227
v_mfma_f32_16x16x32_bf16 v[204:207], a[108:111], a[28:31], v[44:47]
ds_read_b128 a[128:131], v2 offset:0
v_cvt_pk_bf16_f32 v67, v226, v227
v_mfma_f32_16x16x32_bf16 v[204:207], a[104:107], a[24:27], v[204:207]
v_exp_f32 v228, v228
v_mfma_f32_16x16x32_bf16 v[204:207], a[100:103], a[20:23], v[204:207]
buffer_load_dwordx4 v0, s[20:23], s4 offen offset:0 sc1 lds
v_mfma_f32_16x16x32_bf16 v[204:207], a[96:99], a[16:19], v[204:207]
v_exp_f32 v229, v229
v_mfma_f32_16x16x32_bf16 v[208:211], a[96:99], a[32:35], v[48:51]
ds_read_b128 a[132:135], v2 offset:1024
v_cvt_pk_bf16_f32 v70, v228, v229
v_mfma_f32_16x16x32_bf16 v[208:211], a[100:103], a[36:39], v[208:211]
v_exp_f32 v230, v230
v_mfma_f32_16x16x32_bf16 v[208:211], a[104:107], a[40:43], v[208:211]
ds_read_b128 a[136:139], v2 offset:2048
v_mfma_f32_16x16x32_bf16 v[208:211], a[108:111], a[44:47], v[208:211]
v_exp_f32 v231, v231
v_mfma_f32_16x16x32_bf16 v[212:215], a[108:111], a[60:63], v[52:55]
ds_read_b128 a[140:143], v2 offset:3072
v_cvt_pk_bf16_f32 v71, v230, v231
v_mfma_f32_16x16x32_bf16 v[212:215], a[104:107], a[56:59], v[212:215]
v_exp_f32 v200, v200
v_mfma_f32_16x16x32_bf16 v[212:215], a[100:103], a[52:55], v[212:215]
buffer_load_dwordx4 v0, s[20:23], s4 offen offset:1024 sc1 lds
v_mfma_f32_16x16x32_bf16 v[212:215], a[96:99], a[48:51], v[212:215]
v_exp_f32 v201, v201
v_mfma_f32_16x16x32_bf16 v[216:219], a[112:115], a[0:3], v[40:43]
ds_read_b128 a[144:147], v2 offset:4096
v_cvt_pk_bf16_f32 v232, v200, v201
v_mfma_f32_16x16x32_bf16 v[216:219], a[116:119], a[4:7], v[216:219]
v_exp_f32 v202, v202
v_mfma_f32_16x16x32_bf16 v[216:219], a[120:123], a[8:11], v[216:219]
ds_read_b128 a[148:151], v2 offset:5120
v_mfma_f32_16x16x32_bf16 v[216:219], a[124:127], a[12:15], v[216:219]
v_exp_f32 v203, v203
v_mfma_f32_16x16x32_bf16 v[220:223], a[124:127], a[28:31], v[44:47]
ds_read_b128 a[152:155], v2 offset:6144
v_cvt_pk_bf16_f32 v233, v202, v203
v_mfma_f32_16x16x32_bf16 v[220:223], a[120:123], a[24:27], v[220:223]
v_exp_f32 v204, v204
v_mfma_f32_16x16x32_bf16 v[220:223], a[116:119], a[20:23], v[220:223]
buffer_load_dwordx4 v0, s[20:23], s4 offen offset:2048 sc1 lds
v_mfma_f32_16x16x32_bf16 v[220:223], a[112:115], a[16:19], v[220:223]
v_exp_f32 v205, v205
v_mfma_f32_16x16x32_bf16 v[224:227], a[112:115], a[32:35], v[48:51]
ds_read_b128 a[156:159], v2 offset:7168
v_cvt_pk_bf16_f32 v236, v204, v205
v_mfma_f32_16x16x32_bf16 v[224:227], a[116:119], a[36:39], v[224:227]
v_exp_f32 v206, v206
v_mfma_f32_16x16x32_bf16 v[224:227], a[120:123], a[40:43], v[224:227]
buffer_load_dwordx4 v0, s[20:23], s4 offen offset:3072 sc1 lds
v_mfma_f32_16x16x32_bf16 v[224:227], a[124:127], a[44:47], v[224:227]
s_add_u32 s4, s4, 16384
v_exp_f32 v207, v207
v_mfma_f32_16x16x32_bf16 v[228:231], a[124:127], a[60:63], v[52:55]
v_cvt_pk_bf16_f32 v237, v206, v207
v_add_u32 v2, s12, v3
v_mfma_f32_16x16x32_bf16 v[228:231], a[120:123], a[56:59], v[228:231]
s_waitcnt lgkmcnt(0)
v_exp_f32 v208, v208
v_mfma_f32_16x16x32_bf16 v[228:231], a[116:119], a[52:55], v[228:231]
s_add_u32 s5, s5, 8192
s_and_b32 s5, s5, 0xffff
v_mfma_f32_16x16x32_bf16 v[228:231], a[112:115], a[48:51], v[228:231]
v_exp_f32 v209, v209
v_mfma_f32_16x16x32_bf16 v[72:75], a[128:131], v[248:251], v[72:75]
ds_read_b128 a[96:99], v1 offset:16384
v_cvt_pk_bf16_f32 v240, v208, v209
v_mfma_f32_16x16x32_bf16 v[104:107], a[128:131], v[252:255], v[104:107]
v_exp_f32 v210, v210
v_mfma_f32_16x16x32_bf16 v[136:139], a[128:131], v[64:67], v[136:139]
v_add_u32 v30, (LA_fin+8192-LA_pc+4096)/4, v0
v_mad_u64_u32 v[30:31], vcc, v30, 4, s[72:73]
v_mfma_f32_16x16x32_bf16 v[168:171], a[128:131], v[68:71], v[168:171]
v_exp_f32 v211, v211
v_mfma_f32_16x16x32_bf16 v[172:175], a[132:135], v[68:71], v[172:175]
ds_read_b128 a[100:103], v1 offset:17408
v_cvt_pk_bf16_f32 v241, v210, v211
v_mfma_f32_16x16x32_bf16 v[140:143], a[132:135], v[64:67], v[140:143]
v_exp_f32 v212, v212
v_mfma_f32_16x16x32_bf16 v[108:111], a[132:135], v[252:255], v[108:111]
global_load_dword v30, v[30:31], off offset:-4096
v_mfma_f32_16x16x32_bf16 v[76:79], a[132:135], v[248:251], v[76:79]
v_exp_f32 v213, v213
v_mfma_f32_16x16x32_bf16 v[80:83], a[136:139], v[248:251], v[80:83]
ds_read_b128 a[104:107], v1 offset:18432
v_cvt_pk_bf16_f32 v244, v212, v213
v_mfma_f32_16x16x32_bf16 v[112:115], a[136:139], v[252:255], v[112:115]
v_exp_f32 v214, v214
v_mfma_f32_16x16x32_bf16 v[144:147], a[136:139], v[64:67], v[144:147]
v_mfma_f32_16x16x32_bf16 v[176:179], a[136:139], v[68:71], v[176:179]
v_exp_f32 v215, v215
v_mfma_f32_16x16x32_bf16 v[180:183], a[140:143], v[68:71], v[180:183]
ds_read_b128 a[108:111], v1 offset:19456
v_cvt_pk_bf16_f32 v245, v214, v215
v_mfma_f32_16x16x32_bf16 v[148:151], a[140:143], v[64:67], v[148:151]
v_exp_f32 v216, v216
v_mfma_f32_16x16x32_bf16 v[116:119], a[140:143], v[252:255], v[116:119]
v_mfma_f32_16x16x32_bf16 v[84:87], a[140:143], v[248:251], v[84:87]
v_exp_f32 v217, v217
v_mfma_f32_16x16x32_bf16 v[88:91], a[144:147], v[248:251], v[88:91]
ds_read_b128 a[112:115], v1 offset:20480
v_cvt_pk_bf16_f32 v234, v216, v217
v_mfma_f32_16x16x32_bf16 v[120:123], a[144:147], v[252:255], v[120:123]
v_exp_f32 v218, v218
v_mfma_f32_16x16x32_bf16 v[152:155], a[144:147], v[64:67], v[152:155]
v_mfma_f32_16x16x32_bf16 v[184:187], a[144:147], v[68:71], v[184:187]
v_exp_f32 v219, v219
v_mfma_f32_16x16x32_bf16 v[188:191], a[148:151], v[68:71], v[188:191]
ds_read_b128 a[116:119], v1 offset:21504
v_cvt_pk_bf16_f32 v235, v218, v219
v_mfma_f32_16x16x32_bf16 v[156:159], a[148:151], v[64:67], v[156:159]
v_exp_f32 v220, v220
v_mfma_f32_16x16x32_bf16 v[124:127], a[148:151], v[252:255], v[124:127]
v_mfma_f32_16x16x32_bf16 v[92:95], a[148:151], v[248:251], v[92:95]
v_exp_f32 v221, v221
v_mfma_f32_16x16x32_bf16 v[96:99], a[152:155], v[248:251], v[96:99]
ds_read_b128 a[120:123], v1 offset:22528
v_cvt_pk_bf16_f32 v238, v220, v221
v_mfma_f32_16x16x32_bf16 v[128:131], a[152:155], v[252:255], v[128:131]
v_exp_f32 v222, v222
v_mfma_f32_16x16x32_bf16 v[160:163], a[152:155], v[64:67], v[160:163]
v_mfma_f32_16x16x32_bf16 v[192:195], a[152:155], v[68:71], v[192:195]
v_exp_f32 v223, v223
v_mfma_f32_16x16x32_bf16 v[196:199], a[156:159], v[68:71], v[196:199]
ds_read_b128 a[124:127], v1 offset:23552
v_cvt_pk_bf16_f32 v239, v222, v223
v_mfma_f32_16x16x32_bf16 v[164:167], a[156:159], v[64:67], v[164:167]
v_exp_f32 v224, v224
v_mfma_f32_16x16x32_bf16 v[132:135], a[156:159], v[252:255], v[132:135]
v_mfma_f32_16x16x32_bf16 v[100:103], a[156:159], v[248:251], v[100:103]
v_exp_f32 v225, v225
v_mfma_f32_16x16x32_bf16 a[160:163], a[184:187], v[248:251], a[160:163]
v_cvt_pk_bf16_f32 v242, v224, v225
v_add_u32 v1, s11, v0
v_mfma_f32_16x16x32_bf16 a[164:167], a[184:187], v[252:255], a[164:167]
v_mfma_f32_16x16x32_bf16 a[168:171], a[184:187], v[64:67], a[168:171]
v_mfma_f32_16x16x32_bf16 a[172:175], a[184:187], v[68:71], a[172:175]
LA_b12:
s_waitcnt lgkmcnt(7)
v_mfma_f32_16x16x32_bf16 v[200:203], a[96:99], a[0:3], v[40:43]
s_waitcnt vmcnt(9) lgkmcnt(0)
s_barrier
v_mfma_f32_16x16x32_bf16 v[200:203], a[100:103], a[4:7], v[200:203]
s_add_u32 s12, s12, 8192
v_exp_f32 v226, v226
v_mfma_f32_16x16x32_bf16 v[200:203], a[104:107], a[8:11], v[200:203]
s_waitcnt vmcnt(6)
s_and_b32 s12, s12, 0xffff
s_add_u32 m0, s5, s6
v_bfe_u32 v20, v0, 2, 7
v_mfma_f32_16x16x32_bf16 v[200:203], a[108:111], a[12:15], v[200:203]
s_add_u32 s11, s11, 8192
v_exp_f32 v227, v227
v_mfma_f32_16x16x32_bf16 v[204:207], a[108:111], a[28:31], v[44:47]
ds_read_b128 a[128:131], v2 offset:0
v_cvt_pk_bf16_f32 v243, v226, v227
v_mfma_f32_16x16x32_bf16 v[204:207], a[104:107], a[24:27], v[204:207]
s_and_b32 s11, s11, 0xffff
v_exp_f32 v228, v228
v_mfma_f32_16x16x32_bf16 v[204:207], a[100:103], a[20:23], v[204:207]
buffer_load_dword v20, v20, s[76:79], s40 offen offset:0 sc1
v_mfma_f32_16x16x32_bf16 v[204:207], a[96:99], a[16:19], v[204:207]
v_exp_f32 v229, v229
v_mfma_f32_16x16x32_bf16 v[208:211], a[96:99], a[32:35], v[48:51]
v_cvt_pk_bf16_f32 v246, v228, v229
v_bfe_u32 v22, v0, 2, 7
v_mfma_f32_16x16x32_bf16 v[208:211], a[100:103], a[36:39], v[208:211]
v_exp_f32 v230, v230
v_mfma_f32_16x16x32_bf16 v[208:211], a[104:107], a[40:43], v[208:211]
buffer_load_dword v22, v22, s[76:79], s41 offen offset:0 sc1
v_mfma_f32_16x16x32_bf16 v[208:211], a[108:111], a[44:47], v[208:211]
v_exp_f32 v231, v231
v_mfma_f32_16x16x32_bf16 v[212:215], a[108:111], a[60:63], v[52:55]
ds_read_b128 a[132:135], v2 offset:1024
v_cvt_pk_bf16_f32 v247, v230, v231
v_mfma_f32_16x16x32_bf16 v[212:215], a[104:107], a[56:59], v[212:215]
v_exp_f32 v200, v200
v_mfma_f32_16x16x32_bf16 v[212:215], a[100:103], a[52:55], v[212:215]
ds_read_b128 a[136:139], v2 offset:2048
buffer_load_dwordx4 v0, s[20:23], s4 offen offset:0 sc1 lds
v_mfma_f32_16x16x32_bf16 v[212:215], a[96:99], a[48:51], v[212:215]
v_exp_f32 v201, v201
v_mfma_f32_16x16x32_bf16 v[220:223], a[112:115], a[16:19], v[44:47]
v_cvt_pk_bf16_f32 v248, v200, v201
v_and_b32 v248, v248, v18
v_mfma_f32_16x16x32_bf16 v[220:223], a[116:119], a[20:23], v[220:223]
v_exp_f32 v202, v202
v_mfma_f32_16x16x32_bf16 v[220:223], a[120:123], a[24:27], v[220:223]
ds_read_b128 a[140:143], v2 offset:3072
buffer_load_dwordx4 v0, s[20:23], s4 offen offset:1024 sc1 lds
v_mfma_f32_16x16x32_bf16 v[220:223], a[124:127], a[28:31], v[220:223]
v_exp_f32 v203, v203
v_mfma_f32_16x16x32_bf16 v[224:227], a[124:127], a[44:47], v[48:51]
v_cvt_pk_bf16_f32 v249, v202, v203
v_and_b32 v249, v249, v19
v_mfma_f32_16x16x32_bf16 v[224:227], a[120:123], a[40:43], v[224:227]
v_exp_f32 v204, v204
v_mfma_f32_16x16x32_bf16 v[224:227], a[116:119], a[36:39], v[224:227]
ds_read_b128 a[144:147], v2 offset:4096
buffer_load_dwordx4 v0, s[20:23], s4 offen offset:2048 sc1 lds
v_mfma_f32_16x16x32_bf16 v[224:227], a[112:115], a[32:35], v[224:227]
v_exp_f32 v205, v205
v_mfma_f32_16x16x32_bf16 v[228:231], a[112:115], a[48:51], v[52:55]
ds_read_b128 a[148:151], v2 offset:5120
v_cvt_pk_bf16_f32 v252, v204, v205
v_mfma_f32_16x16x32_bf16 v[228:231], a[116:119], a[52:55], v[228:231]
v_exp_f32 v206, v206
v_mfma_f32_16x16x32_bf16 v[228:231], a[120:123], a[56:59], v[228:231]
buffer_load_dwordx4 v0, s[20:23], s4 offen offset:3072 sc1 lds
v_mfma_f32_16x16x32_bf16 v[228:231], a[124:127], a[60:63], v[228:231]
s_waitcnt lgkmcnt(5)
s_add_u32 s4, s4, 16384
v_exp_f32 v207, v207
v_mfma_f32_16x16x32_bf16 v[72:75], a[128:131], v[232:235], v[72:75]
s_add_u32 s5, s5, 8192
ds_read_b128 a[152:155], v2 offset:6144
v_cvt_pk_bf16_f32 v253, v206, v207
v_mfma_f32_16x16x32_bf16 v[104:107], a[128:131], v[236:239], v[104:107]
s_and_b32 s5, s5, 0xffff
v_exp_f32 v208, v208
v_mfma_f32_16x16x32_bf16 v[136:139], a[128:131], v[240:243], v[136:139]
ds_read_b128 a[96:99], v1 offset:16384
v_bfe_u32 v21, v0, 4, 4
v_mfma_f32_16x16x32_bf16 v[168:171], a[128:131], v[244:247], v[168:171]
s_waitcnt lgkmcnt(6)
s_lshl_b32 s34, s80, 6
v_exp_f32 v209, v209
v_mfma_f32_16x16x32_bf16 v[172:175], a[132:135], v[244:247], v[172:175]
ds_read_b128 a[156:159], v2 offset:7168
v_cvt_pk_bf16_f32 v64, v208, v209
v_mfma_f32_16x16x32_bf16 v[140:143], a[132:135], v[240:243], v[140:143]
s_sub_u32 s35, 448, s34
v_exp_f32 v210, v210
v_mfma_f32_16x16x32_bf16 v[108:111], a[132:135], v[236:239], v[108:111]
ds_read_b128 a[100:103], v1 offset:17408
v_lshl_add_u32 v29, v21, 2, s34
v_mfma_f32_16x16x32_bf16 v[76:79], a[132:135], v[232:235], v[76:79]
s_waitcnt lgkmcnt(7)
v_exp_f32 v211, v211
v_mfma_f32_16x16x32_bf16 v[80:83], a[136:139], v[232:235], v[80:83]
v_cvt_pk_bf16_f32 v65, v210, v211
v_add_u32 v2, s12, v3
v_mfma_f32_16x16x32_bf16 v[112:115], a[136:139], v[236:239], v[112:115]
v_exp_f32 v212, v212
v_mfma_f32_16x16x32_bf16 v[144:147], a[136:139], v[240:243], v[144:147]
ds_read_b128 a[104:107], v1 offset:18432
v_lshl_add_u32 v28, v21, 2, s35
v_mfma_f32_16x16x32_bf16 v[176:179], a[136:139], v[244:247], v[176:179]
s_waitcnt lgkmcnt(7)
v_exp_f32 v213, v213
v_mfma_f32_16x16x32_bf16 v[180:183], a[140:143], v[244:247], v[180:183]
ds_read_b128 a[108:111], v1 offset:19456
v_cvt_pk_bf16_f32 v68, v212, v213
v_mfma_f32_16x16x32_bf16 v[148:151], a[140:143], v[240:243], v[148:151]
v_exp_f32 v214, v214
v_mfma_f32_16x16x32_bf16 v[116:119], a[140:143], v[236:239], v[116:119]
v_sub_f32 v24, 1.0, v4
v_sub_f32 v25, 1.0, v5
v_mfma_f32_16x16x32_bf16 v[84:87], a[140:143], v[232:235], v[84:87]
s_waitcnt lgkmcnt(7)
v_exp_f32 v215, v215
v_mfma_f32_16x16x32_bf16 v[88:91], a[144:147], v[232:235], v[88:91]
ds_read_b128 a[112:115], v1 offset:20480
v_cvt_pk_bf16_f32 v69, v214, v215
v_mfma_f32_16x16x32_bf16 v[120:123], a[144:147], v[236:239], v[120:123]
v_mov_b32 v250, 0
v_mov_b32 v251, 0
v_mfma_f32_16x16x32_bf16 v[152:155], a[144:147], v[240:243], v[152:155]
v_exp_f32 v220, v220
v_mfma_f32_16x16x32_bf16 v[184:187], a[144:147], v[244:247], v[184:187]
s_waitcnt lgkmcnt(7)
v_sub_f32 v26, 1.0, v6
v_sub_f32 v27, 1.0, v7
v_mfma_f32_16x16x32_bf16 v[188:191], a[148:151], v[244:247], v[188:191]
v_exp_f32 v221, v221
v_mfma_f32_16x16x32_bf16 v[156:159], a[148:151], v[240:243], v[156:159]
ds_read_b128 a[116:119], v1 offset:21504
v_cvt_pk_bf16_f32 v254, v220, v221
v_mfma_f32_16x16x32_bf16 v[124:127], a[148:151], v[236:239], v[124:127]
v_exp_f32 v222, v222
v_mfma_f32_16x16x32_bf16 v[92:95], a[148:151], v[232:235], v[92:95]
s_waitcnt lgkmcnt(7)
v_cvt_pk_bf16_f32 v24, v24, v24
v_cvt_pk_bf16_f32 v25, v25, v25
v_mfma_f32_16x16x32_bf16 v[96:99], a[152:155], v[232:235], v[96:99]
v_exp_f32 v223, v223
v_mfma_f32_16x16x32_bf16 v[128:131], a[152:155], v[236:239], v[128:131]
ds_read_b128 a[120:123], v1 offset:22528
v_cvt_pk_bf16_f32 v255, v222, v223
v_mfma_f32_16x16x32_bf16 v[160:163], a[152:155], v[240:243], v[160:163]
s_waitcnt vmcnt(5)
v_exp_f32 v224, v224
v_cmp_lt_u32 vcc, 0, v20
v_mfma_f32_16x16x32_bf16 v[192:195], a[152:155], v[244:247], v[192:195]
s_waitcnt vmcnt(4) lgkmcnt(6)
v_cvt_pk_bf16_f32 v26, v26, v26
v_cvt_pk_bf16_f32 v27, v27, v27
v_cmp_lt_u32 s[32:33], 0, v22
v_mfma_f32_16x16x32_bf16 v[196:199], a[156:159], v[244:247], v[196:199]
v_exp_f32 v225, v225
v_mfma_f32_16x16x32_bf16 v[164:167], a[156:159], v[240:243], v[164:167]
ds_read_b128 a[124:127], v1 offset:23552
v_cvt_pk_bf16_f32 v66, v224, v225
v_mfma_f32_16x16x32_bf16 v[132:135], a[156:159], v[236:239], v[132:135]
v_add_u32 v1, s11, v0
v_lshlrev_b32 v24, 16, v24
v_mfma_f32_16x16x32_bf16 v[100:103], a[156:159], v[232:235], v[100:103]
v_lshlrev_b32 v25, 16, v25
v_lshlrev_b32 v26, 16, v26
v_mfma_f32_16x16x32_bf16 a[160:163], a[184:187], v[232:235], a[160:163]
v_lshlrev_b32 v27, 16, v27
v_add_f32 v24, v24, v24
v_mfma_f32_16x16x32_bf16 a[164:167], a[184:187], v[236:239], a[164:167]
v_add_f32 v25, v25, v25
v_add_f32 v26, v26, v26
v_mfma_f32_16x16x32_bf16 a[168:171], a[184:187], v[240:243], a[168:171]
s_andn2_b32 s33, 255, s32
s_cbranch_scc1 LA_p42_s
LA_p42:
v_mfma_f32_16x16x32_bf16 a[172:175], a[184:187], v[244:247], a[172:175]
s_andn2_b32 s33, 16776960, vcc_lo
s_cbranch_scc1 LA_p22_s
LA_p22:
v_add_f32 v27, v27, v27
ds_write_b32 v29, v24 offset:6144
ds_write_b32 v28, v25 offset:6144
ds_write_b32 v29, v26 offset:6656
ds_write_b32 v28, v27 offset:6656
v_mfma_f32_16x16x32_bf16 v[204:207], a[96:99], a[16:19], v[44:47]
s_waitcnt vmcnt(63) lgkmcnt(0)
s_barrier
v_mfma_f32_16x16x32_bf16 v[204:207], a[100:103], a[20:23], v[204:207]
s_add_u32 s12, s12, 8192
v_exp_f32 v226, v226
v_mfma_f32_16x16x32_bf16 v[204:207], a[104:107], a[24:27], v[204:207]
s_and_b32 s12, s12, 0xffff
s_add_u32 s11, s11, 16384
v_lshrrev_b32 v22, 1, v0
v_mfma_f32_16x16x32_bf16 v[204:207], a[108:111], a[28:31], v[204:207]
s_and_b32 s11, s11, 0xffff
v_exp_f32 v227, v227
v_mfma_f32_16x16x32_bf16 v[208:211], a[108:111], a[44:47], v[48:51]
ds_read_b128 a[128:131], v2 offset:0
v_cvt_pk_bf16_f32 v67, v226, v227
v_mfma_f32_16x16x32_bf16 v[208:211], a[104:107], a[40:43], v[208:211]
v_exp_f32 v228, v228
v_mfma_f32_16x16x32_bf16 v[208:211], a[100:103], a[36:39], v[208:211]
buffer_load_dwordx2 v[24:25], v22, s[76:79], s86 offen offset:0 sc1
v_mfma_f32_16x16x32_bf16 v[208:211], a[96:99], a[32:35], v[208:211]
v_exp_f32 v229, v229
v_mfma_f32_16x16x32_bf16 v[212:215], a[96:99], a[48:51], v[52:55]
ds_read_b128 a[132:135], v2 offset:1024
v_cvt_pk_bf16_f32 v70, v228, v229
v_mfma_f32_16x16x32_bf16 v[212:215], a[100:103], a[52:55], v[212:215]
v_exp_f32 v230, v230
v_mfma_f32_16x16x32_bf16 v[212:215], a[104:107], a[56:59], v[212:215]
buffer_load_dwordx2 v[26:27], v22, s[76:79], s86 offen offset:512 sc1
v_mfma_f32_16x16x32_bf16 v[212:215], a[108:111], a[60:63], v[212:215]
v_exp_f32 v231, v231
v_mfma_f32_16x16x32_bf16 v[220:223], a[112:115], a[16:19], v[44:47]
ds_read_b128 a[136:139], v2 offset:2048
v_cvt_pk_bf16_f32 v71, v230, v231
v_mfma_f32_16x16x32_bf16 v[220:223], a[116:119], a[20:23], v[220:223]
v_exp_f32 v204, v204
v_mfma_f32_16x16x32_bf16 v[220:223], a[120:123], a[24:27], v[220:223]
buffer_load_dwordx2 v[28:29], v22, s[76:79], s86 offen offset:1024 sc1
v_mfma_f32_16x16x32_bf16 v[220:223], a[124:127], a[28:31], v[220:223]
v_exp_f32 v205, v205
v_mfma_f32_16x16x32_bf16 v[224:227], a[124:127], a[44:47], v[48:51]
ds_read_b128 a[140:143], v2 offset:3072
v_cvt_pk_bf16_f32 v236, v204, v205
v_mfma_f32_16x16x32_bf16 v[224:227], a[120:123], a[40:43], v[224:227]
v_exp_f32 v206, v206
v_mfma_f32_16x16x32_bf16 v[224:227], a[116:119], a[36:39], v[224:227]
buffer_load_dwordx2 v[30:31], v22, s[76:79], s86 offen offset:1536 sc1
v_mfma_f32_16x16x32_bf16 v[224:227], a[112:115], a[32:35], v[224:227]
v_exp_f32 v207, v207
v_mfma_f32_16x16x32_bf16 v[228:231], a[112:115], a[48:51], v[52:55]
ds_read_b128 a[144:147], v2 offset:4096
v_cvt_pk_bf16_f32 v237, v206, v207
v_mfma_f32_16x16x32_bf16 v[228:231], a[116:119], a[52:55], v[228:231]
v_exp_f32 v208, v208
v_mfma_f32_16x16x32_bf16 v[228:231], a[120:123], a[56:59], v[228:231]
buffer_load_dwordx2 v[32:33], v22, s[76:79], s86 offen offset:2048 sc1
v_mfma_f32_16x16x32_bf16 v[228:231], a[124:127], a[60:63], v[228:231]
s_waitcnt lgkmcnt(4)
v_exp_f32 v209, v209
v_mfma_f32_16x16x32_bf16 v[72:75], a[128:131], v[248:251], v[72:75]
ds_read_b128 a[148:151], v2 offset:5120
v_cvt_pk_bf16_f32 v240, v208, v209
v_mfma_f32_16x16x32_bf16 v[104:107], a[128:131], v[252:255], v[104:107]
v_exp_f32 v210, v210
v_mfma_f32_16x16x32_bf16 v[136:139], a[128:131], v[64:67], v[136:139]
ds_read_b128 a[96:99], v1 offset:16384
buffer_load_dwordx2 v[34:35], v22, s[76:79], s86 offen offset:2560 sc1
v_mfma_f32_16x16x32_bf16 v[168:171], a[128:131], v[68:71], v[168:171]
s_waitcnt lgkmcnt(5)
v_exp_f32 v211, v211
v_mfma_f32_16x16x32_bf16 v[172:175], a[132:135], v[68:71], v[172:175]
ds_read_b128 a[152:155], v2 offset:6144
v_cvt_pk_bf16_f32 v241, v210, v211
v_mfma_f32_16x16x32_bf16 v[140:143], a[132:135], v[64:67], v[140:143]
v_exp_f32 v212, v212
v_mfma_f32_16x16x32_bf16 v[108:111], a[132:135], v[252:255], v[108:111]
ds_read_b128 a[100:103], v1 offset:17408
buffer_load_dwordx2 v[36:37], v22, s[76:79], s86 offen offset:3072 sc1
v_mfma_f32_16x16x32_bf16 v[76:79], a[132:135], v[248:251], v[76:79]
s_waitcnt lgkmcnt(6)
v_exp_f32 v213, v213
v_mfma_f32_16x16x32_bf16 v[80:83], a[136:139], v[248:251], v[80:83]
ds_read_b128 a[156:159], v2 offset:7168
v_cvt_pk_bf16_f32 v244, v212, v213
v_mfma_f32_16x16x32_bf16 v[112:115], a[136:139], v[252:255], v[112:115]
v_exp_f32 v214, v214
v_mfma_f32_16x16x32_bf16 v[144:147], a[136:139], v[64:67], v[144:147]
ds_read_b128 a[104:107], v1 offset:18432
buffer_load_dwordx2 v[38:39], v22, s[76:79], s86 offen offset:3584 sc1
v_mfma_f32_16x16x32_bf16 v[176:179], a[136:139], v[68:71], v[176:179]
s_waitcnt lgkmcnt(7)
s_add_u32 m0, s5, s6
v_exp_f32 v215, v215
v_mfma_f32_16x16x32_bf16 v[180:183], a[140:143], v[68:71], v[180:183]
v_cvt_pk_bf16_f32 v245, v214, v215
v_add_u32 v2, s12, v3
v_mfma_f32_16x16x32_bf16 v[148:151], a[140:143], v[64:67], v[148:151]
v_exp_f32 v220, v220
v_mfma_f32_16x16x32_bf16 v[116:119], a[140:143], v[252:255], v[116:119]
ds_read_b128 a[108:111], v1 offset:19456
buffer_load_dwordx4 v0, s[20:23], s4 offen offset:0 sc1 lds
v_mfma_f32_16x16x32_bf16 v[84:87], a[140:143], v[248:251], v[84:87]
s_waitcnt lgkmcnt(7)
v_exp_f32 v221, v221
v_mfma_f32_16x16x32_bf16 v[88:91], a[144:147], v[248:251], v[88:91]
v_cvt_pk_bf16_f32 v238, v220, v221
v_and_b32 v238, v238, v18
v_mfma_f32_16x16x32_bf16 v[120:123], a[144:147], v[252:255], v[120:123]
v_exp_f32 v222, v222
v_mfma_f32_16x16x32_bf16 v[152:155], a[144:147], v[64:67], v[152:155]
ds_read_b128 a[112:115], v1 offset:20480
buffer_load_dwordx4 v0, s[20:23], s4 offen offset:1024 sc1 lds
v_mfma_f32_16x16x32_bf16 v[184:187], a[144:147], v[68:71], v[184:187]
s_waitcnt lgkmcnt(7)
v_exp_f32 v223, v223
v_mfma_f32_16x16x32_bf16 v[188:191], a[148:151], v[68:71], v[188:191]
v_cvt_pk_bf16_f32 v239, v222, v223
v_and_b32 v239, v239, v19
v_mfma_f32_16x16x32_bf16 v[156:159], a[148:151], v[64:67], v[156:159]
v_exp_f32 v224, v224
v_mfma_f32_16x16x32_bf16 v[124:127], a[148:151], v[252:255], v[124:127]
ds_read_b128 a[116:119], v1 offset:21504
buffer_load_dwordx4 v0, s[20:23], s4 offen offset:2048 sc1 lds
v_mfma_f32_16x16x32_bf16 v[92:95], a[148:151], v[248:251], v[92:95]
s_waitcnt lgkmcnt(6)
v_exp_f32 v225, v225
v_mfma_f32_16x16x32_bf16 v[96:99], a[152:155], v[248:251], v[96:99]
ds_read_b128 a[120:123], v1 offset:22528
v_cvt_pk_bf16_f32 v242, v224, v225
v_mfma_f32_16x16x32_bf16 v[128:131], a[152:155], v[252:255], v[128:131]
v_mfma_f32_16x16x32_bf16 v[160:163], a[152:155], v[64:67], v[160:163]
buffer_load_dwordx4 v0, s[20:23], s4 offen offset:3072 sc1 lds
v_mfma_f32_16x16x32_bf16 v[192:195], a[152:155], v[68:71], v[192:195]
s_waitcnt lgkmcnt(5)
s_add_u32 s4, s4, 16384
s_add_u32 s5, s5, 8192
ds_read_b128 a[124:127], v1 offset:23552
v_mfma_f32_16x16x32_bf16 v[196:199], a[156:159], v[68:71], v[196:199]
s_and_b32 s5, s5, 0xffff
v_add_u32 v1, s11, v0
v_mfma_f32_16x16x32_bf16 v[164:167], a[156:159], v[64:67], v[164:167]
v_mfma_f32_16x16x32_bf16 v[132:135], a[156:159], v[252:255], v[132:135]
v_mfma_f32_16x16x32_bf16 v[100:103], a[156:159], v[248:251], v[100:103]
v_mfma_f32_16x16x32_bf16 a[160:163], a[184:187], v[248:251], a[160:163]
v_mfma_f32_16x16x32_bf16 a[164:167], a[184:187], v[252:255], a[164:167]
v_mfma_f32_16x16x32_bf16 a[168:171], a[184:187], v[64:67], a[168:171]
v_mfma_f32_16x16x32_bf16 a[172:175], a[184:187], v[68:71], a[172:175]
s_cmp_eq_u32 s16, 0
s_cbranch_scc1 LA_ssm
LA_c32:
v_mfma_f32_16x16x32_bf16 v[208:211], a[96:99], a[32:35], v[48:51]
s_waitcnt vmcnt(63) lgkmcnt(0)
s_barrier
v_mfma_f32_16x16x32_bf16 v[208:211], a[100:103], a[36:39], v[208:211]
s_add_u32 s12, s12, 8192
v_exp_f32 v226, v226
v_mfma_f32_16x16x32_bf16 v[208:211], a[104:107], a[40:43], v[208:211]
s_and_b32 s12, s12, 0xffff
s_add_u32 s11, s11, s15
s_add_u32 m0, s5, s6
v_mfma_f32_16x16x32_bf16 v[208:211], a[108:111], a[44:47], v[208:211]
s_and_b32 s11, s11, 0xffff
v_exp_f32 v227, v227
v_mfma_f32_16x16x32_bf16 v[212:215], a[108:111], a[60:63], v[52:55]
ds_read_b128 a[128:131], v2 offset:0
v_cvt_pk_bf16_f32 v243, v226, v227
v_mfma_f32_16x16x32_bf16 v[212:215], a[104:107], a[56:59], v[212:215]
s_lshl_b32 s34, s80, 13
v_exp_f32 v228, v228
v_mfma_f32_16x16x32_bf16 v[212:215], a[100:103], a[52:55], v[212:215]
buffer_load_dwordx4 v0, s[20:23], s4 offen offset:0 sc1 lds
v_mfma_f32_16x16x32_bf16 v[212:215], a[96:99], a[48:51], v[212:215]
s_lshl_b32 s35, s80, 14
v_exp_f32 v229, v229
v_mfma_f32_16x16x32_bf16 v[224:227], a[112:115], a[32:35], v[48:51]
ds_read_b128 a[132:135], v2 offset:1024
v_cvt_pk_bf16_f32 v246, v228, v229
v_mfma_f32_16x16x32_bf16 v[224:227], a[116:119], a[36:39], v[224:227]
s_xor_b32 s50, s17, 0x8000
v_exp_f32 v230, v230
v_mfma_f32_16x16x32_bf16 v[224:227], a[120:123], a[40:43], v[224:227]
s_lshl_b32 s33, s80, 9
v_exp_f32 v231, v231
v_mfma_f32_16x16x32_bf16 v[224:227], a[124:127], a[44:47], v[224:227]
ds_read_b128 a[136:139], v2 offset:2048
v_cvt_pk_bf16_f32 v247, v230, v231
v_mfma_f32_16x16x32_bf16 v[228:231], a[124:127], a[60:63], v[52:55]
s_add_u32 s33, s33, s50
v_exp_f32 v208, v208
v_mfma_f32_16x16x32_bf16 v[228:231], a[120:123], a[56:59], v[228:231]
ds_read_b128 a[96:99], v1 offset:16384
buffer_load_dwordx4 v0, s[20:23], s4 offen offset:1024 sc1 lds
v_mfma_f32_16x16x32_bf16 v[228:231], a[116:119], a[52:55], v[228:231]
s_sub_u32 s32, 4, s85
v_exp_f32 v209, v209
v_mfma_f32_16x16x32_bf16 v[228:231], a[112:115], a[48:51], v[228:231]
s_waitcnt lgkmcnt(3)
ds_read_b128 a[140:143], v2 offset:3072
v_cvt_pk_bf16_f32 v64, v208, v209
v_mfma_f32_16x16x32_bf16 v[104:107], a[128:131], v[236:239], v[104:107]
s_lshl_b32 s32, s32, 12
v_exp_f32 v210, v210
v_mfma_f32_16x16x32_bf16 v[136:139], a[128:131], v[240:243], v[136:139]
ds_read_b128 a[100:103], v1 offset:17408
buffer_load_dwordx4 v0, s[20:23], s4 offen offset:2048 sc1 lds
v_mfma_f32_16x16x32_bf16 v[168:171], a[128:131], v[244:247], v[168:171]
s_waitcnt lgkmcnt(4)
s_add_u32 s96, s88, s32
v_exp_f32 v211, v211
v_mfma_f32_16x16x32_bf16 v[172:175], a[132:135], v[244:247], v[172:175]
ds_read_b128 a[144:147], v2 offset:4096
v_cvt_pk_bf16_f32 v65, v210, v211
v_mfma_f32_16x16x32_bf16 v[140:143], a[132:135], v[240:243], v[140:143]
s_add_u32 s97, s89, s32
v_exp_f32 v212, v212
v_mfma_f32_16x16x32_bf16 v[108:111], a[132:135], v[236:239], v[108:111]
s_waitcnt lgkmcnt(4)
ds_read_b128 a[104:107], v1 offset:18432
buffer_load_dwordx4 v0, s[20:23], s4 offen offset:3072 sc1 lds
v_mfma_f32_16x16x32_bf16 v[112:115], a[136:139], v[236:239], v[112:115]
s_add_u32 s4, s4, 16384
v_exp_f32 v213, v213
v_mfma_f32_16x16x32_bf16 v[144:147], a[136:139], v[240:243], v[144:147]
s_add_u32 s5, s5, 8192
ds_read_b128 a[148:151], v2 offset:5120
v_cvt_pk_bf16_f32 v68, v212, v213
v_mfma_f32_16x16x32_bf16 v[176:179], a[136:139], v[244:247], v[176:179]
s_waitcnt lgkmcnt(4)
s_and_b32 s5, s5, 0xffff
v_exp_f32 v214, v214
v_mfma_f32_16x16x32_bf16 v[180:183], a[140:143], v[244:247], v[180:183]
s_add_u32 s98, s90, s32
ds_read_b128 a[108:111], v1 offset:19456
v_mfma_f32_16x16x32_bf16 v[148:151], a[140:143], v[240:243], v[148:151]
s_add_u32 s99, s91, s32
v_exp_f32 v215, v215
v_mfma_f32_16x16x32_bf16 v[116:119], a[140:143], v[236:239], v[116:119]
s_waitcnt lgkmcnt(3)
ds_read_b128 a[152:155], v2 offset:6144
v_cvt_pk_bf16_f32 v69, v214, v215
v_mfma_f32_16x16x32_bf16 v[120:123], a[144:147], v[236:239], v[120:123]
v_exp_f32 v224, v224
v_mfma_f32_16x16x32_bf16 v[152:155], a[144:147], v[240:243], v[152:155]
s_waitcnt vmcnt(15)
ds_read_b128 a[112:115], v1 offset:20480
v_bfe_u32 v24, v0, 4, 4
v_mfma_f32_16x16x32_bf16 v[184:187], a[144:147], v[244:247], v[184:187]
s_waitcnt lgkmcnt(3)
v_exp_f32 v225, v225
v_mfma_f32_16x16x32_bf16 v[188:191], a[148:151], v[244:247], v[188:191]
ds_read_b128 a[156:159], v2 offset:7168
v_cvt_pk_bf16_f32 v66, v224, v225
v_mfma_f32_16x16x32_bf16 v[156:159], a[148:151], v[240:243], v[156:159]
ds_read_b128 a[116:119], v1 offset:21504
v_add_u32 v2, s12, v3
v_mfma_f32_16x16x32_bf16 v[124:127], a[148:151], v[236:239], v[124:127]
s_waitcnt lgkmcnt(3)
ds_read_b128 a[120:123], v1 offset:22528
v_lshrrev_b32 v25, 8, v0
v_mfma_f32_16x16x32_bf16 v[128:131], a[152:155], v[236:239], v[128:131]
s_waitcnt vmcnt(14)
ds_read_b128 a[124:127], v1 offset:23552
v_lshrrev_b32 v26, 1, v24
v_mfma_f32_16x16x32_bf16 v[160:163], a[152:155], v[240:243], v[160:163]
v_add_u32 v1, s11, v0
v_xor_b32 v26, v26, v25
v_mfma_f32_16x16x32_bf16 v[192:195], a[152:155], v[244:247], v[192:195]
s_waitcnt lgkmcnt(3)
v_and_b32 v27, 16, v0
v_lshl_or_b32 v27, v25, 10, v27
v_mfma_f32_16x16x32_bf16 v[196:199], a[156:159], v[244:247], v[196:199]
s_waitcnt vmcnt(9)
v_lshl_or_b32 v27, v26, 5, v27
v_add_u32 v36, s34, v27
v_mfma_f32_16x16x32_bf16 v[164:167], a[156:159], v[240:243], v[164:167]
v_xor_b32 v27, 128, v36
v_add_u32 v37, 3072, v27
v_mfma_f32_16x16x32_bf16 v[132:135], a[156:159], v[236:239], v[132:135]
s_waitcnt vmcnt(8)
v_lshlrev_b32 v25, 4, v25
v_lshl_or_b32 v38, v24, 10, v25
v_mfma_f32_16x16x32_bf16 a[164:167], a[184:187], v[236:239], a[164:167]
v_add_u32 v26, s35, v0
v_xor_b32 v27, 0x8000, v26
v_mfma_f32_16x16x32_bf16 a[168:171], a[184:187], v[240:243], a[168:171]
v_lshrrev_b32 v28, 2, v0
v_add_u32 v28, s33, v28
v_mfma_f32_16x16x32_bf16 a[172:175], a[184:187], v[244:247], a[172:175]
v_xor_b32 v29, 1024, v28
v_lshlrev_b32 v30, 2, v0
s_waitcnt vmcnt(4)
s_mov_b64 exec, 1
buffer_store_dword v3, off, s[76:79], s44 offset:128 sc1
s_mov_b64 exec, -1
s_cmp_eq_u32 s82, 7
s_cbranch_scc1 LA_t72
v_mfma_f32_16x16x32_bf16 v[200:203], a[96:99], a[64:67], v[56:59]
s_waitcnt vmcnt(63) lgkmcnt(0)
s_barrier
v_mfma_f32_16x16x32_bf16 v[200:203], a[100:103], a[68:71], v[200:203]
s_add_u32 s12, s12, 16384
v_exp_f32 v226, v226
v_mfma_f32_16x16x32_bf16 v[200:203], a[104:107], a[72:75], v[200:203]
s_and_b32 s12, s12, 0xffff
s_add_u32 s11, s11, 16384
s_add_u32 m0, s5, s6
v_mfma_f32_16x16x32_bf16 v[200:203], a[108:111], a[76:79], v[200:203]
s_and_b32 s11, s11, 0xffff
v_exp_f32 v227, v227
v_mfma_f32_16x16x32_bf16 v[204:207], a[108:111], a[92:95], v[60:63]
ds_read_b128 a[128:131], v2 offset:0
v_cvt_pk_bf16_f32 v67, v226, v227
v_mfma_f32_16x16x32_bf16 v[204:207], a[104:107], a[88:91], v[204:207]
v_exp_f32 v228, v228
v_mfma_f32_16x16x32_bf16 v[204:207], a[100:103], a[84:87], v[204:207]
buffer_load_dwordx4 v0, s[20:23], s4 offen offset:0 sc1 lds
v_mfma_f32_16x16x32_bf16 v[204:207], a[96:99], a[80:83], v[204:207]
v_exp_f32 v229, v229
v_mfma_f32_16x16x32_bf16 v[208:211], a[96:99], a[32:35], v[48:51]
ds_read_b128 a[132:135], v2 offset:1024
v_cvt_pk_bf16_f32 v70, v228, v229
v_mfma_f32_16x16x32_bf16 v[208:211], a[100:103], a[36:39], v[208:211]
v_exp_f32 v230, v230
v_mfma_f32_16x16x32_bf16 v[208:211], a[104:107], a[40:43], v[208:211]
buffer_load_dwordx4 v0, s[20:23], s4 offen offset:1024 sc1 lds
v_mfma_f32_16x16x32_bf16 v[208:211], a[108:111], a[44:47], v[208:211]
v_exp_f32 v231, v231
v_mfma_f32_16x16x32_bf16 v[212:215], a[108:111], a[60:63], v[52:55]
ds_read_b128 a[136:139], v2 offset:2048
v_cvt_pk_bf16_f32 v71, v230, v231
v_mfma_f32_16x16x32_bf16 v[212:215], a[104:107], a[56:59], v[212:215]
v_exp_f32 v200, v200
v_mfma_f32_16x16x32_bf16 v[212:215], a[100:103], a[52:55], v[212:215]
buffer_load_dwordx4 v0, s[20:23], s4 offen offset:2048 sc1 lds
v_mfma_f32_16x16x32_bf16 v[212:215], a[96:99], a[48:51], v[212:215]
v_exp_f32 v201, v201
v_mfma_f32_16x16x32_bf16 v[216:219], a[112:115], a[64:67], v[56:59]
ds_read_b128 a[140:143], v2 offset:3072
v_cvt_pk_bf16_f32 v232, v200, v201
v_mfma_f32_16x16x32_bf16 v[216:219], a[116:119], a[68:71], v[216:219]
v_exp_f32 v202, v202
v_mfma_f32_16x16x32_bf16 v[216:219], a[120:123], a[72:75], v[216:219]
ds_read_b128 a[96:99], v1 offset:16384
buffer_load_dwordx4 v0, s[20:23], s4 offen offset:3072 sc1 lds
v_mfma_f32_16x16x32_bf16 v[216:219], a[124:127], a[76:79], v[216:219]
s_add_u32 s4, s4, 16384
v_exp_f32 v203, v203
v_mfma_f32_16x16x32_bf16 v[220:223], a[124:127], a[92:95], v[60:63]
s_add_u32 s5, s5, 8192
ds_read_b128 a[144:147], v2 offset:4096
v_cvt_pk_bf16_f32 v233, v202, v203
v_mfma_f32_16x16x32_bf16 v[220:223], a[120:123], a[88:91], v[220:223]
s_and_b32 s5, s5, 0xffff
v_exp_f32 v204, v204
v_mfma_f32_16x16x32_bf16 v[220:223], a[116:119], a[84:87], v[220:223]
s_lshl_b32 s74, s82, 15
s_add_u32 s75, s74, 106496
ds_read_b128 a[100:103], v1 offset:17408
v_mfma_f32_16x16x32_bf16 v[220:223], a[112:115], a[80:83], v[220:223]
s_and_b32 s75, s75, 0xffff
v_exp_f32 v205, v205
v_mfma_f32_16x16x32_bf16 v[224:227], a[112:115], a[32:35], v[48:51]
s_add_u32 m0, s75, 20480
ds_read_b128 a[148:151], v2 offset:5120
v_cvt_pk_bf16_f32 v236, v204, v205
v_mfma_f32_16x16x32_bf16 v[224:227], a[116:119], a[36:39], v[224:227]
s_lshl_b32 s74, s74, 1
v_exp_f32 v206, v206
v_mfma_f32_16x16x32_bf16 v[224:227], a[120:123], a[40:43], v[224:227]
s_add_u32 s74, s74, 217088
ds_read_b128 a[104:107], v1 offset:18432
v_mfma_f32_16x16x32_bf16 v[224:227], a[124:127], a[44:47], v[224:227]
v_exp_f32 v207, v207
v_mfma_f32_16x16x32_bf16 v[228:231], a[124:127], a[60:63], v[52:55]
ds_read_b128 a[152:155], v2 offset:6144
v_cvt_pk_bf16_f32 v237, v206, v207
v_mfma_f32_16x16x32_bf16 v[228:231], a[120:123], a[56:59], v[228:231]
v_exp_f32 v208, v208
v_mfma_f32_16x16x32_bf16 v[228:231], a[116:119], a[52:55], v[228:231]
ds_read_b128 a[108:111], v1 offset:19456
buffer_load_dwordx4 v0, s[20:23], s74 offen offset:0 sc1 lds
v_mfma_f32_16x16x32_bf16 v[228:231], a[112:115], a[48:51], v[228:231]
s_waitcnt lgkmcnt(10)
v_exp_f32 v209, v209
v_mfma_f32_16x16x32_bf16 v[136:139], a[128:131], v[64:67], v[136:139]
ds_read_b128 a[156:159], v2 offset:7168
v_cvt_pk_bf16_f32 v240, v208, v209
v_mfma_f32_16x16x32_bf16 v[168:171], a[128:131], v[68:71], v[168:171]
s_waitcnt lgkmcnt(10)
v_exp_f32 v210, v210
v_mfma_f32_16x16x32_bf16 v[172:175], a[132:135], v[68:71], v[172:175]
ds_read_b128 a[112:115], v1 offset:20480
buffer_load_dwordx4 v0, s[20:23], s74 offen offset:1024 sc1 lds
v_mfma_f32_16x16x32_bf16 v[140:143], a[132:135], v[64:67], v[140:143]
s_waitcnt lgkmcnt(10)
s_lshl_b32 s13, s82, 1
v_exp_f32 v211, v211
v_mfma_f32_16x16x32_bf16 v[144:147], a[136:139], v[64:67], v[144:147]
s_sub_u32 s13, 12, s13
v_cvt_pk_bf16_f32 v241, v210, v211
v_add_u32 v2, s12, v3
v_mfma_f32_16x16x32_bf16 v[176:179], a[136:139], v[68:71], v[176:179]
s_waitcnt lgkmcnt(9)
s_lshr_b32 s19, s80, 1
v_exp_f32 v212, v212
v_mfma_f32_16x16x32_bf16 v[180:183], a[140:143], v[68:71], v[180:183]
s_lshl1_add_u32 s18, s85, s19
s_lshl_b32 s18, s18, 9
ds_read_b128 a[116:119], v1 offset:21504
v_mfma_f32_16x16x32_bf16 v[148:151], a[140:143], v[64:67], v[148:151]
s_waitcnt lgkmcnt(8)
s_add_u32 s18, s18, s84
v_exp_f32 v213, v213
v_mfma_f32_16x16x32_bf16 v[152:155], a[144:147], v[64:67], v[152:155]
s_lshl_b32 s18, s18, 7
ds_read_b128 a[120:123], v1 offset:22528
v_cvt_pk_bf16_f32 v244, v212, v213
v_mfma_f32_16x16x32_bf16 v[184:187], a[144:147], v[68:71], v[184:187]
s_waitcnt lgkmcnt(7)
s_lshl_b32 s19, s19, 13
v_exp_f32 v214, v214
v_mfma_f32_16x16x32_bf16 v[188:191], a[148:151], v[68:71], v[188:191]
s_mul_i32 s34, s3, 147456
s_add_u32 s19, s19, s34
s_add_u32 m0, s19, 0
v_mfma_f32_16x16x32_bf16 v[156:159], a[148:151], v[64:67], v[156:159]
s_waitcnt lgkmcnt(5)
v_exp_f32 v215, v215
v_mfma_f32_16x16x32_bf16 v[160:163], a[152:155], v[64:67], v[160:163]
ds_read_b128 a[124:127], v1 offset:23552
v_cvt_pk_bf16_f32 v245, v214, v215
v_mfma_f32_16x16x32_bf16 v[192:195], a[152:155], v[68:71], v[192:195]
s_waitcnt lgkmcnt(4)
v_exp_f32 v216, v216
v_mfma_f32_16x16x32_bf16 v[196:199], a[156:159], v[68:71], v[196:199]
buffer_load_dwordx4 v38, s[52:55], s18 offen offset:0 lds
v_mfma_f32_16x16x32_bf16 v[164:167], a[156:159], v[64:67], v[164:167]
s_add_u32 m0, s19, 960
v_exp_f32 v217, v217
v_mfma_f32_16x16x32_bf16 a[168:171], a[184:187], v[64:67], a[168:171]
v_cvt_pk_bf16_f32 v234, v216, v217
v_add_u32 v1, s11, v0
v_mfma_f32_16x16x32_bf16 a[172:175], a[184:187], v[68:71], a[172:175]
v_exp_f32 v218, v218
v_exp_f32 v219, v219
s_nop 0
v_cvt_pk_bf16_f32 v235, v218, v219
v_exp_f32 v220, v220
v_exp_f32 v221, v221
s_nop 0
v_cvt_pk_bf16_f32 v238, v220, v221
v_exp_f32 v222, v222
v_exp_f32 v223, v223
s_nop 0
v_cvt_pk_bf16_f32 v239, v222, v223
buffer_load_dwordx4 v38, s[52:55], s18 offen offset:64 lds
s_add_u32 s18, s18, 16384
s_add_u32 m0, s19, 2048
s_nop 0
buffer_load_dwordx4 v38, s[52:55], s18 offen offset:0 lds
s_add_u32 m0, s19, 3008
s_nop 0
buffer_load_dwordx4 v38, s[52:55], s18 offen offset:64 lds
s_add_u32 s18, s18, 16384
s_branch LA_l2p
LA_p22_s:
s_sleep 2
v_bfe_u32 v20, v0, 2, 7
buffer_load_dword v20, v20, s[76:79], s40 offen offset:0 sc1
s_waitcnt vmcnt(0)
v_cmp_lt_u32 s[32:33], 0, v20
s_nop 0
s_andn2_b32 s33, 16776960, s32
s_cbranch_scc1 LA_p22_s
s_branch LA_p22
LA_p42_s:
s_sleep 2
v_bfe_u32 v22, v0, 2, 7
buffer_load_dword v22, v22, s[76:79], s41 offen offset:0 sc1
s_waitcnt vmcnt(0)
v_cmp_lt_u32 s[32:33], 0, v22
s_nop 0
s_andn2_b32 s33, 255, s32
s_cbranch_scc1 LA_p42_s
s_branch LA_p42
LA_t72:
v_mfma_f32_32x32x16_bf16 a[0:15], a[224:227], a[224:227], 0
v_mfma_f32_32x32x16_bf16 a[16:31], a[224:227], a[224:227], 0
v_mfma_f32_16x16x32_bf16 v[204:207], a[96:99], a[80:83], v[60:63]
s_waitcnt vmcnt(63) lgkmcnt(0)
s_barrier
v_mfma_f32_16x16x32_bf16 v[204:207], a[100:103], a[84:87], v[204:207]
s_add_u32 s12, s12, 16384
v_exp_f32 v226, v226
v_mfma_f32_16x16x32_bf16 v[204:207], a[104:107], a[88:91], v[204:207]
s_and_b32 s12, s12, 0xffff
s_add_u32 s11, s11, 8192
s_lshr_b32 s19, s80, 1
v_mfma_f32_16x16x32_bf16 v[204:207], a[108:111], a[92:95], v[204:207]
s_and_b32 s11, s11, 0xffff
v_exp_f32 v227, v227
v_mfma_f32_16x16x32_bf16 v[208:211], a[108:111], a[44:47], v[48:51]
s_lshl1_add_u32 s18, s85, s19
ds_read_b128 a[128:131], v2 offset:0
v_cvt_pk_bf16_f32 v67, v226, v227
v_mfma_f32_16x16x32_bf16 v[208:211], a[104:107], a[40:43], v[208:211]
s_lshl_b32 s18, s18, 9
v_exp_f32 v228, v228
v_mfma_f32_16x16x32_bf16 v[208:211], a[100:103], a[36:39], v[208:211]
s_add_u32 s18, s18, s84
s_lshl_b32 s18, s18, 7
s_lshl_b32 s19, s19, 13
v_mfma_f32_16x16x32_bf16 v[208:211], a[96:99], a[32:35], v[208:211]
s_mul_i32 s34, s3, 147456
v_exp_f32 v229, v229
v_mfma_f32_16x16x32_bf16 v[212:215], a[96:99], a[48:51], v[52:55]
s_add_u32 s19, s19, s34
ds_read_b128 a[132:135], v2 offset:1024
v_cvt_pk_bf16_f32 v70, v228, v229
v_mfma_f32_16x16x32_bf16 v[212:215], a[100:103], a[52:55], v[212:215]
s_add_u32 m0, s19, 0
v_exp_f32 v230, v230
v_mfma_f32_16x16x32_bf16 v[212:215], a[104:107], a[56:59], v[212:215]
ds_read_b128 a[96:99], v1 offset:16384
buffer_load_dwordx4 v38, s[52:55], s18 offen offset:0 lds
v_mfma_f32_16x16x32_bf16 v[212:215], a[108:111], a[60:63], v[212:215]
s_add_u32 m0, s19, 960
v_exp_f32 v231, v231
v_mfma_f32_16x16x32_bf16 v[220:223], a[112:115], a[80:83], v[60:63]
ds_read_b128 a[136:139], v2 offset:2048
v_cvt_pk_bf16_f32 v71, v230, v231
v_mfma_f32_16x16x32_bf16 v[220:223], a[116:119], a[84:87], v[220:223]
v_exp_f32 v204, v204
v_mfma_f32_16x16x32_bf16 v[220:223], a[120:123], a[88:91], v[220:223]
ds_read_b128 a[100:103], v1 offset:17408
buffer_load_dwordx4 v38, s[52:55], s18 offen offset:64 lds
v_mfma_f32_16x16x32_bf16 v[220:223], a[124:127], a[92:95], v[220:223]
s_add_u32 s18, s18, 16384
v_exp_f32 v205, v205
v_mfma_f32_16x16x32_bf16 v[228:231], a[124:127], a[60:63], v[52:55]
s_add_u32 m0, s19, 2048
ds_read_b128 a[140:143], v2 offset:3072
v_cvt_pk_bf16_f32 v236, v204, v205
v_mfma_f32_16x16x32_bf16 v[228:231], a[120:123], a[56:59], v[228:231]
v_exp_f32 v206, v206
v_mfma_f32_16x16x32_bf16 v[228:231], a[116:119], a[52:55], v[228:231]
ds_read_b128 a[104:107], v1 offset:18432
buffer_load_dwordx4 v38, s[52:55], s18 offen offset:0 lds
v_mfma_f32_16x16x32_bf16 v[228:231], a[112:115], a[48:51], v[228:231]
s_waitcnt lgkmcnt(6)
s_add_u32 m0, s19, 3008
v_exp_f32 v207, v207
v_mfma_f32_16x16x32_bf16 v[136:139], a[128:131], v[64:67], v[136:139]
ds_read_b128 a[144:147], v2 offset:4096
v_cvt_pk_bf16_f32 v237, v206, v207
v_mfma_f32_16x16x32_bf16 v[168:171], a[128:131], v[68:71], v[168:171]
s_waitcnt lgkmcnt(6)
v_exp_f32 v208, v208
v_mfma_f32_16x16x32_bf16 v[172:175], a[132:135], v[68:71], v[172:175]
ds_read_b128 a[148:151], v2 offset:5120
buffer_load_dwordx4 v38, s[52:55], s18 offen offset:64 lds
v_mfma_f32_16x16x32_bf16 v[140:143], a[132:135], v[64:67], v[140:143]
s_waitcnt lgkmcnt(5)
s_add_u32 s18, s18, 16384
v_exp_f32 v209, v209
v_mfma_f32_16x16x32_bf16 v[144:147], a[136:139], v[64:67], v[144:147]
v_cvt_pk_bf16_f32 v240, v208, v209
v_and_b32 v240, v240, v18
v_bfe_u32 v20, v0, 2, 7
v_mfma_f32_16x16x32_bf16 v[176:179], a[136:139], v[68:71], v[176:179]
s_waitcnt lgkmcnt(3)
v_exp_f32 v210, v210
v_mfma_f32_16x16x32_bf16 v[180:183], a[140:143], v[68:71], v[180:183]
ds_read_b128 a[152:155], v2 offset:6144
buffer_load_dword v20, v20, s[76:79], s42 offen offset:128 sc1
v_mfma_f32_16x16x32_bf16 v[148:151], a[140:143], v[64:67], v[148:151]
s_waitcnt lgkmcnt(2)
ds_read_b128 a[156:159], v2 offset:7168
v_exp_f32 v211, v211
v_mfma_f32_16x16x32_bf16 v[152:155], a[144:147], v[64:67], v[152:155]
s_add_u32 m0, s19, 4096
v_cvt_pk_bf16_f32 v241, v210, v211
v_and_b32 v241, v241, v19
v_mfma_f32_16x16x32_bf16 v[184:187], a[144:147], v[68:71], v[184:187]
s_waitcnt lgkmcnt(2)
v_exp_f32 v212, v212
v_mfma_f32_16x16x32_bf16 v[188:191], a[148:151], v[68:71], v[188:191]
ds_read_b128 a[108:111], v1 offset:19456
buffer_load_dwordx4 v38, s[52:55], s18 offen offset:0 lds
v_mfma_f32_16x16x32_bf16 v[156:159], a[148:151], v[64:67], v[156:159]
s_waitcnt lgkmcnt(2)
s_add_u32 m0, s19, 5056
v_exp_f32 v213, v213
v_mfma_f32_16x16x32_bf16 v[160:163], a[152:155], v[64:67], v[160:163]
v_cvt_pk_bf16_f32 v244, v212, v213
v_add_u32 v2, s12, v3
v_mfma_f32_16x16x32_bf16 v[192:195], a[152:155], v[68:71], v[192:195]
s_waitcnt lgkmcnt(1)
v_exp_f32 v214, v214
v_mfma_f32_16x16x32_bf16 v[196:199], a[156:159], v[68:71], v[196:199]
ds_read_b128 a[112:115], v1 offset:20480
buffer_load_dwordx4 v38, s[52:55], s18 offen offset:64 lds
v_mfma_f32_16x16x32_bf16 v[164:167], a[156:159], v[64:67], v[164:167]
s_add_u32 s18, s18, 16384
v_exp_f32 v215, v215
v_mfma_f32_16x16x32_bf16 a[168:171], a[184:187], v[64:67], a[168:171]
s_add_u32 m0, s19, 6144
ds_read_b128 a[116:119], v1 offset:21504
v_cvt_pk_bf16_f32 v245, v214, v215
v_mfma_f32_16x16x32_bf16 a[172:175], a[184:187], v[68:71], a[172:175]
ds_read_b128 a[120:123], v1 offset:22528
ds_read_b128 a[124:127], v1 offset:23552
v_exp_f32 v220, v220
v_exp_f32 v221, v221
s_nop 0
v_cvt_pk_bf16_f32 v238, v220, v221
v_exp_f32 v222, v222
v_exp_f32 v223, v223
s_nop 0
v_cvt_pk_bf16_f32 v239, v222, v223
v_mov_b32 v242, 0
v_add_u32 v1, s11, v0
buffer_load_dwordx4 v38, s[52:55], s18 offen offset:0 lds
s_add_u32 m0, s19, 7104
s_nop 0
buffer_load_dwordx4 v38, s[52:55], s18 offen offset:64 lds
s_add_u32 s18, s18, 16384
v_lshrrev_b32 v24, 6, v0
v_and_b32 v25, 7, v24
v_lshlrev_b32 v25, 5, v25
v_lshl_or_b32 v25, v24, 8, v25
v_bfe_u32 v24, v0, 4, 2
v_lshl_or_b32 v25, v24, 3, v25
v_add_u32 v17, s17, v25
v_and_b32 v24, 511, v0
v_lshrrev_b32 v25, 9, v0
v_mul_u32_u24 v25, 147456, v25
v_add_u32 v16, v24, v25
v_mov_b32 v31, s50
s_add_u32 s35, s84, 1
s_and_b32 s35, s35, 7
v_lshl_add_u32 v8, s35, 11, v16
s_add_u32 s35, s84, 2
s_and_b32 s35, s35, 7
v_lshl_add_u32 v9, s35, 11, v16
s_add_u32 s35, s84, 3
s_and_b32 s35, s35, 7
v_lshl_add_u32 v10, s35, 11, v16
s_add_u32 s35, s84, 4
s_and_b32 s35, s35, 7
v_lshl_add_u32 v11, s35, 11, v16
s_add_u32 s35, s84, 5
s_and_b32 s35, s35, 7
v_lshl_add_u32 v12, s35, 11, v16
s_add_u32 s35, s84, 6
s_and_b32 s35, s35, 7
v_lshl_add_u32 v13, s35, 11, v16
s_add_u32 s35, s84, 7
s_and_b32 s35, s35, 7
v_lshl_add_u32 v14, s35, 11, v16
s_add_u32 s35, s84, 8
s_and_b32 s35, s35, 7
v_lshl_add_u32 v15, s35, 11, v16
v_accvgpr_read_b32 v24, a160
v_accvgpr_read_b32 v25, a164
v_subrev_u32 v21, 0x30800000, v24
v_rcp_f32 v24, v24
s_nop 0
v_mul_f32 v24, v24, v4
v_subrev_u32 v22, 0x30800000, v25
v_max_u32 v21, v21, v22
v_rcp_f32 v25, v25
s_nop 0
v_mul_f32 v25, v25, v5
v_cmp_lt_u32 vcc, 0x23000000, v21
v_pk_mul_f32 v[72:73], v[72:73], v[24:25] op_sel:[0,0] op_sel_hi:[1,0]
v_pk_mul_f32 v[74:75], v[74:75], v[24:25] op_sel:[0,0] op_sel_hi:[1,0]
v_pk_mul_f32 v[76:77], v[76:77], v[24:25] op_sel:[0,0] op_sel_hi:[1,0]
v_pk_mul_f32 v[78:79], v[78:79], v[24:25] op_sel:[0,0] op_sel_hi:[1,0]
v_cvt_pk_bf16_f32 v72, v72, v73
v_cvt_pk_bf16_f32 v73, v74, v75
v_cvt_pk_bf16_f32 v74, v76, v77
v_cvt_pk_bf16_f32 v75, v78, v79
buffer_store_dwordx4 v[72:75], v0, s[76:79], s88 offen offset:0 sc1
v_pk_mul_f32 v[80:81], v[80:81], v[24:25] op_sel:[0,0] op_sel_hi:[1,0]
v_pk_mul_f32 v[82:83], v[82:83], v[24:25] op_sel:[0,0] op_sel_hi:[1,0]
v_pk_mul_f32 v[84:85], v[84:85], v[24:25] op_sel:[0,0] op_sel_hi:[1,0]
v_pk_mul_f32 v[86:87], v[86:87], v[24:25] op_sel:[0,0] op_sel_hi:[1,0]
v_cvt_pk_bf16_f32 v76, v80, v81
v_cvt_pk_bf16_f32 v77, v82, v83
v_cvt_pk_bf16_f32 v78, v84, v85
v_cvt_pk_bf16_f32 v79, v86, v87
buffer_store_dwordx4 v[76:79], v0, s[76:79], s88 offen offset:1024 sc1
v_pk_mul_f32 v[88:89], v[88:89], v[24:25] op_sel:[0,0] op_sel_hi:[1,0]
v_pk_mul_f32 v[90:91], v[90:91], v[24:25] op_sel:[0,0] op_sel_hi:[1,0]
v_pk_mul_f32 v[92:93], v[92:93], v[24:25] op_sel:[0,0] op_sel_hi:[1,0]
v_pk_mul_f32 v[94:95], v[94:95], v[24:25] op_sel:[0,0] op_sel_hi:[1,0]
v_cvt_pk_bf16_f32 v80, v88, v89
v_cvt_pk_bf16_f32 v81, v90, v91
v_cvt_pk_bf16_f32 v82, v92, v93
v_cvt_pk_bf16_f32 v83, v94, v95
buffer_store_dwordx4 v[80:83], v0, s[76:79], s88 offen offset:2048 sc1
v_pk_mul_f32 v[96:97], v[96:97], v[24:25] op_sel:[0,0] op_sel_hi:[1,0]
v_pk_mul_f32 v[98:99], v[98:99], v[24:25] op_sel:[0,0] op_sel_hi:[1,0]
v_pk_mul_f32 v[100:101], v[100:101], v[24:25] op_sel:[0,0] op_sel_hi:[1,0]
v_pk_mul_f32 v[102:103], v[102:103], v[24:25] op_sel:[0,0] op_sel_hi:[1,0]
v_cvt_pk_bf16_f32 v84, v96, v97
v_cvt_pk_bf16_f32 v85, v98, v99
v_cvt_pk_bf16_f32 v86, v100, v101
v_cvt_pk_bf16_f32 v87, v102, v103
buffer_store_dwordx4 v[84:87], v0, s[76:79], s88 offen offset:3072 sc1
v_pk_mul_f32 v[104:105], v[104:105], v[24:25] op_sel:[0,1] op_sel_hi:[1,1]
v_pk_mul_f32 v[106:107], v[106:107], v[24:25] op_sel:[0,1] op_sel_hi:[1,1]
v_pk_mul_f32 v[108:109], v[108:109], v[24:25] op_sel:[0,1] op_sel_hi:[1,1]
v_pk_mul_f32 v[110:111], v[110:111], v[24:25] op_sel:[0,1] op_sel_hi:[1,1]
v_cvt_pk_bf16_f32 v88, v104, v105
v_cvt_pk_bf16_f32 v89, v106, v107
v_cvt_pk_bf16_f32 v90, v108, v109
v_cvt_pk_bf16_f32 v91, v110, v111
buffer_store_dwordx4 v[88:91], v0, s[76:79], s89 offen offset:0 sc1
v_pk_mul_f32 v[112:113], v[112:113], v[24:25] op_sel:[0,1] op_sel_hi:[1,1]
v_pk_mul_f32 v[114:115], v[114:115], v[24:25] op_sel:[0,1] op_sel_hi:[1,1]
v_pk_mul_f32 v[116:117], v[116:117], v[24:25] op_sel:[0,1] op_sel_hi:[1,1]
v_pk_mul_f32 v[118:119], v[118:119], v[24:25] op_sel:[0,1] op_sel_hi:[1,1]
v_cvt_pk_bf16_f32 v92, v112, v113
v_cvt_pk_bf16_f32 v93, v114, v115
v_cvt_pk_bf16_f32 v94, v116, v117
v_cvt_pk_bf16_f32 v95, v118, v119
buffer_store_dwordx4 v[92:95], v0, s[76:79], s89 offen offset:1024 sc1
v_pk_mul_f32 v[120:121], v[120:121], v[24:25] op_sel:[0,1] op_sel_hi:[1,1]
v_pk_mul_f32 v[122:123], v[122:123], v[24:25] op_sel:[0,1] op_sel_hi:[1,1]
v_pk_mul_f32 v[124:125], v[124:125], v[24:25] op_sel:[0,1] op_sel_hi:[1,1]
v_pk_mul_f32 v[126:127], v[126:127], v[24:25] op_sel:[0,1] op_sel_hi:[1,1]
v_cvt_pk_bf16_f32 v96, v120, v121
v_cvt_pk_bf16_f32 v97, v122, v123
v_cvt_pk_bf16_f32 v98, v124, v125
v_cvt_pk_bf16_f32 v99, v126, v127
buffer_store_dwordx4 v[96:99], v0, s[76:79], s89 offen offset:2048 sc1
v_pk_mul_f32 v[128:129], v[128:129], v[24:25] op_sel:[0,1] op_sel_hi:[1,1]
v_pk_mul_f32 v[130:131], v[130:131], v[24:25] op_sel:[0,1] op_sel_hi:[1,1]
v_pk_mul_f32 v[132:133], v[132:133], v[24:25] op_sel:[0,1] op_sel_hi:[1,1]
v_pk_mul_f32 v[134:135], v[134:135], v[24:25] op_sel:[0,1] op_sel_hi:[1,1]
v_cvt_pk_bf16_f32 v100, v128, v129
v_cvt_pk_bf16_f32 v101, v130, v131
v_cvt_pk_bf16_f32 v102, v132, v133
v_cvt_pk_bf16_f32 v103, v134, v135
buffer_store_dwordx4 v[100:103], v0, s[76:79], s89 offen offset:3072 sc1
s_cmp_eq_u64 vcc, 0
s_cselect_b32 s87, 1, s16
LA_p52_r:
s_waitcnt vmcnt(12)
v_cmp_lt_u32 vcc, 0, v20
s_nop 0
s_and_b32 s74, vcc_lo, 65535
s_cmp_eq_u32 s74, 65535
s_cbranch_scc1 LA_p52
s_sleep 2
v_bfe_u32 v20, v0, 2, 7
buffer_load_dword v20, v20, s[76:79], s42 offen offset:128 sc1
s_waitcnt vmcnt(0)
s_branch LA_p52_r
LA_p52:
buffer_load_dwordx4 a[192:195], v0, s[76:79], s96 offen offset:0 sc1
buffer_load_dwordx4 a[196:199], v0, s[76:79], s97 offen offset:0 sc1
buffer_load_dwordx4 a[200:203], v0, s[76:79], s98 offen offset:0 sc1
buffer_load_dwordx4 a[204:207], v0, s[76:79], s99 offen offset:0 sc1
buffer_load_dwordx4 a[208:211], v0, s[76:79], s96 offen offset:1024 sc1
buffer_load_dwordx4 a[212:215], v0, s[76:79], s97 offen offset:1024 sc1
buffer_load_dwordx4 a[216:219], v0, s[76:79], s98 offen offset:1024 sc1
buffer_load_dwordx4 a[220:223], v0, s[76:79], s99 offen offset:1024 sc1
buffer_load_dwordx4 v[104:107], v0, s[76:79], s96 offen offset:2048 sc1
buffer_load_dwordx4 v[108:111], v0, s[76:79], s97 offen offset:2048 sc1
buffer_load_dwordx4 v[112:115], v0, s[76:79], s98 offen offset:2048 sc1
buffer_load_dwordx4 v[116:119], v0, s[76:79], s99 offen offset:2048 sc1
buffer_load_dwordx4 v[120:123], v0, s[76:79], s96 offen offset:3072 sc1
buffer_load_dwordx4 v[124:127], v0, s[76:79], s97 offen offset:3072 sc1
buffer_load_dwordx4 v[128:131], v0, s[76:79], s98 offen offset:3072 sc1
buffer_load_dwordx4 v[132:135], v0, s[76:79], s99 offen offset:3072 sc1
s_waitcnt vmcnt(24)
s_branch LA_d22
LA_d12:
s_waitcnt lgkmcnt(7)
v_mfma_f32_16x16x32_bf16 v[204:207], a[96:99], a[80:83], v[60:63]
s_waitcnt vmcnt(63) lgkmcnt(0)
s_barrier
v_mfma_f32_16x16x32_bf16 v[204:207], a[100:103], a[84:87], v[204:207]
s_add_u32 s12, s12, 16384
v_exp_f32 v226, v226
v_mfma_f32_16x16x32_bf16 v[204:207], a[104:107], a[88:91], v[204:207]
s_and_b32 s12, s12, 0xffff
s_add_u32 s11, s11, 8192
v_mfma_f32_16x16x32_bf16 v[204:207], a[108:111], a[92:95], v[204:207]
s_and_b32 s11, s11, 0xffff
v_exp_f32 v227, v227
v_mfma_f32_16x16x32_bf16 v[208:211], a[108:111], a[44:47], v[48:51]
ds_read_b128 a[128:131], v2 offset:0
v_cvt_pk_bf16_f32 v67, v226, v227
v_mfma_f32_16x16x32_bf16 v[208:211], a[104:107], a[40:43], v[208:211]
v_exp_f32 v228, v228
v_mfma_f32_16x16x32_bf16 v[208:211], a[100:103], a[36:39], v[208:211]
buffer_load_dwordx4 v[104:107], v0, s[76:79], s96 offen offset:2048 sc1
v_mfma_f32_16x16x32_bf16 v[208:211], a[96:99], a[32:35], v[208:211]
v_exp_f32 v229, v229
v_mfma_f32_16x16x32_bf16 v[212:215], a[96:99], a[48:51], v[52:55]
ds_read_b128 a[132:135], v2 offset:1024
v_cvt_pk_bf16_f32 v70, v228, v229
v_mfma_f32_16x16x32_bf16 v[212:215], a[100:103], a[52:55], v[212:215]
v_exp_f32 v230, v230
v_mfma_f32_16x16x32_bf16 v[212:215], a[104:107], a[56:59], v[212:215]
buffer_load_dwordx4 v[108:111], v0, s[76:79], s97 offen offset:2048 sc1
v_mfma_f32_16x16x32_bf16 v[212:215], a[108:111], a[60:63], v[212:215]
v_exp_f32 v231, v231
v_mfma_f32_16x16x32_bf16 v[220:223], a[112:115], a[80:83], v[60:63]
ds_read_b128 a[136:139], v2 offset:2048
v_cvt_pk_bf16_f32 v71, v230, v231
v_mfma_f32_16x16x32_bf16 v[220:223], a[116:119], a[84:87], v[220:223]
v_exp_f32 v204, v204
v_mfma_f32_16x16x32_bf16 v[220:223], a[120:123], a[88:91], v[220:223]
buffer_load_dwordx4 v[112:115], v0, s[76:79], s98 offen offset:2048 sc1
v_mfma_f32_16x16x32_bf16 v[220:223], a[124:127], a[92:95], v[220:223]
v_exp_f32 v205, v205
v_mfma_f32_16x16x32_bf16 v[228:231], a[124:127], a[60:63], v[52:55]
ds_read_b128 a[140:143], v2 offset:3072
v_cvt_pk_bf16_f32 v236, v204, v205
v_mfma_f32_16x16x32_bf16 v[228:231], a[120:123], a[56:59], v[228:231]
v_exp_f32 v206, v206
v_mfma_f32_16x16x32_bf16 v[228:231], a[116:119], a[52:55], v[228:231]
buffer_load_dwordx4 v[116:119], v0, s[76:79], s99 offen offset:2048 sc1
v_mfma_f32_16x16x32_bf16 v[228:231], a[112:115], a[48:51], v[228:231]
s_waitcnt lgkmcnt(3)
v_exp_f32 v207, v207
v_mfma_f32_16x16x32_bf16 a[0:3], a[128:131], v[248:251], a[0:3]
ds_read_b128 a[144:147], v2 offset:4096
v_cvt_pk_bf16_f32 v237, v206, v207
v_mfma_f32_16x16x32_bf16 a[224:227], a[128:131], v[252:255], a[224:227]
v_exp_f32 v208, v208
v_mfma_f32_16x16x32_bf16 v[136:139], a[128:131], v[64:67], v[136:139]
ds_read_b128 a[148:151], v2 offset:5120
buffer_load_dwordx4 v[120:123], v0, s[76:79], s96 offen offset:3072 sc1
v_mfma_f32_16x16x32_bf16 v[168:171], a[128:131], v[68:71], v[168:171]
s_waitcnt lgkmcnt(4)
v_exp_f32 v209, v209
v_mfma_f32_16x16x32_bf16 v[172:175], a[132:135], v[68:71], v[172:175]
v_cvt_pk_bf16_f32 v240, v208, v209
v_and_b32 v240, v240, v18
v_mfma_f32_16x16x32_bf16 v[140:143], a[132:135], v[64:67], v[140:143]
v_exp_f32 v210, v210
v_mfma_f32_16x16x32_bf16 a[228:231], a[132:135], v[252:255], a[228:231]
ds_read_b128 a[152:155], v2 offset:6144
buffer_load_dwordx4 v[124:127], v0, s[76:79], s97 offen offset:3072 sc1
v_mfma_f32_16x16x32_bf16 a[4:7], a[132:135], v[248:251], a[4:7]
s_waitcnt lgkmcnt(4)
v_exp_f32 v211, v211
v_mfma_f32_16x16x32_bf16 a[8:11], a[136:139], v[248:251], a[8:11]
v_cvt_pk_bf16_f32 v241, v210, v211
v_and_b32 v241, v241, v19
v_mfma_f32_16x16x32_bf16 a[232:235], a[136:139], v[252:255], a[232:235]
v_exp_f32 v212, v212
v_mfma_f32_16x16x32_bf16 v[144:147], a[136:139], v[64:67], v[144:147]
ds_read_b128 a[156:159], v2 offset:7168
buffer_load_dwordx4 v[128:131], v0, s[76:79], s98 offen offset:3072 sc1
v_mfma_f32_16x16x32_bf16 v[176:179], a[136:139], v[68:71], v[176:179]
s_waitcnt lgkmcnt(4)
v_exp_f32 v213, v213
v_mfma_f32_16x16x32_bf16 v[180:183], a[140:143], v[68:71], v[180:183]
v_cvt_pk_bf16_f32 v244, v212, v213
v_add_u32 v2, s12, v3
v_mfma_f32_16x16x32_bf16 v[148:151], a[140:143], v[64:67], v[148:151]
v_exp_f32 v214, v214
v_mfma_f32_16x16x32_bf16 a[236:239], a[140:143], v[252:255], a[236:239]
ds_read_b128 a[96:99], v1 offset:16384
buffer_load_dwordx4 v[132:135], v0, s[76:79], s99 offen offset:3072 sc1
v_mfma_f32_16x16x32_bf16 a[12:15], a[140:143], v[248:251], a[12:15]
s_waitcnt lgkmcnt(4)
v_exp_f32 v215, v215
v_mfma_f32_16x16x32_bf16 a[16:19], a[144:147], v[248:251], a[16:19]
ds_read_b128 a[100:103], v1 offset:17408
v_cvt_pk_bf16_f32 v245, v214, v215
v_mfma_f32_16x16x32_bf16 a[240:243], a[144:147], v[252:255], a[240:243]
v_exp_f32 v220, v220
v_mfma_f32_16x16x32_bf16 v[152:155], a[144:147], v[64:67], v[152:155]
v_mfma_f32_16x16x32_bf16 v[184:187], a[144:147], v[68:71], v[184:187]
s_waitcnt lgkmcnt(4)
v_exp_f32 v221, v221
v_mfma_f32_16x16x32_bf16 v[188:191], a[148:151], v[68:71], v[188:191]
ds_read_b128 a[104:107], v1 offset:18432
v_cvt_pk_bf16_f32 v238, v220, v221
v_mfma_f32_16x16x32_bf16 v[156:159], a[148:151], v[64:67], v[156:159]
v_exp_f32 v222, v222
v_mfma_f32_16x16x32_bf16 a[244:247], a[148:151], v[252:255], a[244:247]
v_mfma_f32_16x16x32_bf16 a[20:23], a[148:151], v[248:251], a[20:23]
s_waitcnt lgkmcnt(4)
v_exp_f32 v223, v223
v_mfma_f32_16x16x32_bf16 a[24:27], a[152:155], v[248:251], a[24:27]
ds_read_b128 a[108:111], v1 offset:19456
v_cvt_pk_bf16_f32 v239, v222, v223
v_mfma_f32_16x16x32_bf16 a[248:251], a[152:155], v[252:255], a[248:251]
ds_read_b128 a[112:115], v1 offset:20480
v_mov_b32 v242, 0
v_mfma_f32_16x16x32_bf16 v[160:163], a[152:155], v[64:67], v[160:163]
ds_read_b128 a[116:119], v1 offset:21504
v_mfma_f32_16x16x32_bf16 v[192:195], a[152:155], v[68:71], v[192:195]
s_waitcnt lgkmcnt(6)
ds_read_b128 a[120:123], v1 offset:22528
v_mfma_f32_16x16x32_bf16 v[196:199], a[156:159], v[68:71], v[196:199]
ds_read_b128 a[124:127], v1 offset:23552
v_mfma_f32_16x16x32_bf16 v[164:167], a[156:159], v[64:67], v[164:167]
v_add_u32 v1, s11, v0
v_mfma_f32_16x16x32_bf16 a[252:255], a[156:159], v[252:255], a[252:255]
v_mfma_f32_16x16x32_bf16 a[28:31], a[156:159], v[248:251], a[28:31]
v_mfma_f32_16x16x32_bf16 a[176:179], a[184:187], v[248:251], a[176:179]
v_mfma_f32_16x16x32_bf16 a[180:183], a[184:187], v[252:255], a[180:183]
v_mfma_f32_16x16x32_bf16 a[168:171], a[184:187], v[64:67], a[168:171]
v_mfma_f32_16x16x32_bf16 a[172:175], a[184:187], v[68:71], a[172:175]
s_waitcnt vmcnt(19)
LA_d22:
s_add_u32 s12, s12, s14
s_and_b32 s12, s12, 0xffff
v_add_u32 v1, s12, v3
s_waitcnt lgkmcnt(7)
v_mfma_f32_16x16x32_bf16 v[204:207], a[96:99], a[80:83], v[60:63]
s_waitcnt lgkmcnt(0)
s_barrier
v_mfma_f32_16x16x32_bf16 v[204:207], a[100:103], a[84:87], v[204:207]
s_add_u32 s18, s85, 0
ds_read_b128 a[128:131], v2 offset:0
v_mov_b32 v243, 0
v_mfma_f32_16x16x32_bf16 v[204:207], a[104:107], a[88:91], v[204:207]
s_and_b32 s18, s18, 3
v_exp_f32 v228, v228
v_mfma_f32_16x16x32_bf16 v[204:207], a[108:111], a[92:95], v[204:207]
s_lshl_b32 s18, s18, 17
ds_write_b128 v26, a[0:3] offset:16384
v_mfma_f32_16x16x32_bf16 v[212:215], a[108:111], a[60:63], v[52:55]
s_lshl_b32 s19, s80, 11
v_exp_f32 v229, v229
v_mfma_f32_16x16x32_bf16 v[212:215], a[104:107], a[56:59], v[212:215]
s_add_u32 s19, s19, s17
ds_read_b128 a[132:135], v2 offset:1024
v_cvt_pk_bf16_f32 v246, v228, v229
v_mfma_f32_16x16x32_bf16 v[212:215], a[100:103], a[52:55], v[212:215]
s_add_u32 m0, s19, 0
v_exp_f32 v230, v230
v_mfma_f32_16x16x32_bf16 v[212:215], a[96:99], a[48:51], v[212:215]
ds_write_b128 v26, a[4:7] offset:17408
v_mfma_f32_16x16x32_bf16 v[220:223], a[112:115], a[80:83], v[60:63]
v_exp_f32 v231, v231
v_mfma_f32_16x16x32_bf16 v[220:223], a[116:119], a[84:87], v[220:223]
ds_read_b128 a[136:139], v2 offset:2048
v_cvt_pk_bf16_f32 v247, v230, v231
v_mfma_f32_16x16x32_bf16 v[220:223], a[120:123], a[88:91], v[220:223]
v_exp_f32 v204, v204
v_mfma_f32_16x16x32_bf16 v[220:223], a[124:127], a[92:95], v[220:223]
ds_write_b128 v26, a[8:11] offset:18432
v_mfma_f32_16x16x32_bf16 v[228:231], a[124:127], a[60:63], v[52:55]
v_exp_f32 v205, v205
v_mfma_f32_16x16x32_bf16 v[228:231], a[120:123], a[56:59], v[228:231]
ds_read_b128 a[140:143], v2 offset:3072
v_cvt_pk_bf16_f32 v252, v204, v205
v_mfma_f32_16x16x32_bf16 v[228:231], a[116:119], a[52:55], v[228:231]
v_exp_f32 v206, v206
v_mfma_f32_16x16x32_bf16 v[228:231], a[112:115], a[48:51], v[228:231]
s_waitcnt lgkmcnt(6)
ds_read_b128 a[144:147], v2 offset:4096
ds_read_b128 a[148:151], v2 offset:5120
v_mfma_f32_16x16x32_bf16 a[224:227], a[128:131], v[236:239], a[224:227]
s_waitcnt lgkmcnt(6)
v_exp_f32 v207, v207
v_mfma_f32_16x16x32_bf16 a[228:231], a[132:135], v[236:239], a[228:231]
s_waitcnt lgkmcnt(4)
ds_read_b128 a[152:155], v2 offset:6144
ds_read_b128 a[156:159], v2 offset:7168
v_cvt_pk_bf16_f32 v253, v206, v207
v_mfma_f32_16x16x32_bf16 a[232:235], a[136:139], v[236:239], a[232:235]
s_waitcnt lgkmcnt(4)
v_exp_f32 v212, v212
v_mfma_f32_16x16x32_bf16 a[236:239], a[140:143], v[236:239], a[236:239]
s_waitcnt lgkmcnt(3)
ds_write_b128 v26, a[12:15] offset:19456
v_mfma_f32_16x16x32_bf16 a[240:243], a[144:147], v[236:239], a[240:243]
s_waitcnt lgkmcnt(3)
v_exp_f32 v213, v213
v_mfma_f32_16x16x32_bf16 a[244:247], a[148:151], v[236:239], a[244:247]
s_waitcnt lgkmcnt(2)
buffer_load_dwordx4 v36, s[28:31], s18 offen offset:0 lds
v_cvt_pk_bf16_f32 v68, v212, v213
v_mfma_f32_16x16x32_bf16 a[248:251], a[152:155], v[236:239], a[248:251]
s_waitcnt lgkmcnt(1)
v_exp_f32 v214, v214
v_mfma_f32_16x16x32_bf16 a[252:255], a[156:159], v[236:239], a[252:255]
ds_write_b128 v26, a[16:19] offset:20480
v_mfma_f32_16x16x32_bf16 v[136:139], a[128:131], v[240:243], v[136:139]
v_exp_f32 v215, v215
v_mfma_f32_16x16x32_bf16 v[168:171], a[128:131], v[244:247], v[168:171]
ds_read_b128 a[128:131], v1 offset:0
v_cvt_pk_bf16_f32 v69, v214, v215
v_mfma_f32_16x16x32_bf16 v[172:175], a[132:135], v[244:247], v[172:175]
v_exp_f32 v220, v220
v_mfma_f32_16x16x32_bf16 v[140:143], a[132:135], v[240:243], v[140:143]
ds_write_b128 v26, a[20:23] offset:21504
v_mfma_f32_16x16x32_bf16 v[144:147], a[136:139], v[240:243], v[144:147]
v_exp_f32 v221, v221
v_mfma_f32_16x16x32_bf16 v[176:179], a[136:139], v[244:247], v[176:179]
ds_read_b128 a[132:135], v1 offset:1024
v_cvt_pk_bf16_f32 v254, v220, v221
v_mfma_f32_16x16x32_bf16 v[180:183], a[140:143], v[244:247], v[180:183]
v_exp_f32 v222, v222
v_mfma_f32_16x16x32_bf16 v[148:151], a[140:143], v[240:243], v[148:151]
ds_write_b128 v26, a[24:27] offset:22528
v_mfma_f32_16x16x32_bf16 v[152:155], a[144:147], v[240:243], v[152:155]
v_exp_f32 v223, v223
v_mfma_f32_16x16x32_bf16 v[184:187], a[144:147], v[244:247], v[184:187]
ds_read_b128 a[136:139], v1 offset:2048
v_cvt_pk_bf16_f32 v255, v222, v223
v_mfma_f32_16x16x32_bf16 v[188:191], a[148:151], v[244:247], v[188:191]
v_exp_f32 v228, v228
v_mfma_f32_16x16x32_bf16 v[156:159], a[148:151], v[240:243], v[156:159]
ds_read_b128 a[140:143], v1 offset:3072
buffer_load_dwordx4 v37, s[28:31], s18 offen offset:1024 lds
v_mfma_f32_16x16x32_bf16 v[160:163], a[152:155], v[240:243], v[160:163]
s_add_u32 m0, s19, 8192
v_exp_f32 v229, v229
v_mfma_f32_16x16x32_bf16 v[192:195], a[152:155], v[244:247], v[192:195]
s_add_u32 s18, s18, 32768
v_cvt_pk_bf16_f32 v70, v228, v229
v_and_b32 v70, v70, v18
v_mfma_f32_16x16x32_bf16 v[196:199], a[156:159], v[244:247], v[196:199]
v_exp_f32 v230, v230
v_mfma_f32_16x16x32_bf16 v[164:167], a[156:159], v[240:243], v[164:167]
ds_read_b128 a[144:147], v1 offset:4096
buffer_load_dwordx4 v36, s[28:31], s18 offen offset:0 lds
v_mfma_f32_16x16x32_bf16 a[180:183], a[184:187], v[236:239], a[180:183]
v_exp_f32 v231, v231
v_mfma_f32_16x16x32_bf16 a[168:171], a[184:187], v[240:243], a[168:171]
v_cvt_pk_bf16_f32 v71, v230, v231
v_and_b32 v71, v71, v19
v_mfma_f32_16x16x32_bf16 a[172:175], a[184:187], v[244:247], a[172:175]
ds_read_b128 a[148:151], v1 offset:5120
ds_read_b128 a[152:155], v1 offset:6144
ds_read_b128 a[156:159], v1 offset:7168
ds_write_b128 v26, a[28:31] offset:23552
buffer_load_dwordx4 v37, s[28:31], s18 offen offset:1024 lds
s_add_u32 m0, s19, 16384
s_add_u32 s18, s18, 32768
buffer_load_dwordx4 v36, s[28:31], s18 offen offset:0 lds
buffer_load_dwordx4 v37, s[28:31], s18 offen offset:1024 lds
s_add_u32 m0, s19, 24576
s_add_u32 s18, s18, 32768
buffer_load_dwordx4 v36, s[28:31], s18 offen offset:0 lds
buffer_load_dwordx4 v37, s[28:31], s18 offen offset:1024 lds
s_cmp_eq_u32 s82, 7
s_cbranch_scc0 LA_e2
s_waitcnt vmcnt(24)
s_mov_b32 exec_lo, s87
s_mov_b32 exec_hi, 0
buffer_store_dword v3, off, s[76:79], s43 offset:16 sc1
s_mov_b64 exec, -1
buffer_load_dword v38, v30, s[76:79], s88 offen sc1
buffer_load_dword v38, v30, s[76:79], s89 offen sc1
LA_e2:
s_waitcnt lgkmcnt(10)
v_mfma_f32_16x16x32_bf16 a[224:227], a[128:131], v[252:255], a[224:227]
s_waitcnt lgkmcnt(0)
s_barrier
v_mfma_f32_16x16x32_bf16 a[228:231], a[132:135], v[252:255], a[228:231]
s_add_u32 s18, s85, 1
s_and_b32 s18, s18, 3
s_lshl_b32 s18, s18, 17
v_mfma_f32_16x16x32_bf16 a[232:235], a[136:139], v[252:255], a[232:235]
s_lshl_b32 s19, s80, 11
s_add_u32 s19, s19, s50
s_add_u32 m0, s19, 0
v_mfma_f32_16x16x32_bf16 a[236:239], a[140:143], v[252:255], a[236:239]
buffer_load_dwordx4 v36, s[28:31], s18 offen offset:0 lds
v_mfma_f32_16x16x32_bf16 a[240:243], a[144:147], v[252:255], a[240:243]
ds_write_b128 v26, a[224:227] offset:24576
v_mfma_f32_16x16x32_bf16 a[244:247], a[148:151], v[252:255], a[244:247]
ds_write_b128 v26, a[228:231] offset:25600
v_mfma_f32_16x16x32_bf16 a[248:251], a[152:155], v[252:255], a[248:251]
ds_write_b128 v26, a[232:235] offset:26624
v_mfma_f32_16x16x32_bf16 a[252:255], a[156:159], v[252:255], a[252:255]
ds_write_b128 v26, a[236:239] offset:27648
v_mfma_f32_16x16x32_bf16 v[168:171], a[128:131], v[68:71], v[168:171]
ds_write_b128 v26, a[240:243] offset:28672
v_mfma_f32_16x16x32_bf16 v[172:175], a[132:135], v[68:71], v[172:175]
ds_write_b128 v26, a[244:247] offset:29696
v_mfma_f32_16x16x32_bf16 v[176:179], a[136:139], v[68:71], v[176:179]
ds_write_b128 v26, a[248:251] offset:30720
v_mfma_f32_16x16x32_bf16 v[180:183], a[140:143], v[68:71], v[180:183]
ds_write_b128 v26, a[252:255] offset:31744
v_mfma_f32_16x16x32_bf16 v[184:187], a[144:147], v[68:71], v[184:187]
buffer_load_dwordx4 v37, s[28:31], s18 offen offset:1024 lds
v_mfma_f32_16x16x32_bf16 v[188:191], a[148:151], v[68:71], v[188:191]
s_add_u32 m0, s19, 8192
s_add_u32 s18, s18, 32768
s_lshl_b32 s34, s82, 3
v_mfma_f32_16x16x32_bf16 v[192:195], a[152:155], v[68:71], v[192:195]
buffer_load_dwordx4 v36, s[28:31], s18 offen offset:0 lds
v_mfma_f32_16x16x32_bf16 v[196:199], a[156:159], v[68:71], v[196:199]
s_add_u32 s8, s34, s80
s_sub_u32 s11, 127, s8
s_sub_u32 s9, s34, s80
v_mfma_f32_16x16x32_bf16 a[180:183], a[184:187], v[252:255], a[180:183]
buffer_load_dwordx4 v37, s[28:31], s18 offen offset:1024 lds
v_mfma_f32_16x16x32_bf16 a[172:175], a[184:187], v[68:71], a[172:175]
s_add_u32 m0, s19, 16384
s_add_u32 s18, s18, 32768
s_add_u32 s9, s9, 7
buffer_load_dwordx4 v36, s[28:31], s18 offen offset:0 lds
buffer_load_dwordx4 v37, s[28:31], s18 offen offset:1024 lds
s_sub_u32 s10, 127, s9
s_lshl3_add_u32 s12, s85, s84
s_lshl_b32 s12, s12, 5
s_lshl_b32 s8, s8, 14
s_add_u32 s8, s8, s12
s_lshl_b32 s9, s9, 14
s_add_u32 s9, s9, s12
s_lshl_b32 s10, s10, 14
s_add_u32 s10, s10, s12
s_lshl_b32 s11, s11, 14
s_add_u32 s11, s11, s12
v_bfe_u32 v25, v0, 4, 4
v_lshrrev_b32 v1, 8, v0
v_lshlrev_b32 v1, 3, v1
v_lshl_or_b32 v2, v25, 10, v1
s_branch LA_fin
LA_pm3:
s_waitcnt lgkmcnt(7)
v_mfma_f32_16x16x32_bf16 v[200:203], a[96:99], a[0:3], v[40:43]
s_waitcnt vmcnt(63) lgkmcnt(0)
s_barrier
v_mfma_f32_16x16x32_bf16 v[200:203], a[100:103], a[4:7], v[200:203]
s_add_u32 s11, s11, 8192
v_bfe_u32 v20, v0, 2, 7
v_mfma_f32_16x16x32_bf16 v[200:203], a[104:107], a[8:11], v[200:203]
s_and_b32 s11, s11, 0xffff
ds_read_b128 a[64:67], v23 offset:0
v_mfma_f32_16x16x32_bf16 v[200:203], a[108:111], a[12:15], v[200:203]
buffer_load_dword v20, v20, s[76:79], s40 offen offset:0 sc1
v_mfma_f32_16x16x32_bf16 v[204:207], a[108:111], a[28:31], v[44:47]
s_add_u32 m0, s5, s6
ds_read_b128 a[68:71], v23 offset:1024
v_mfma_f32_16x16x32_bf16 v[204:207], a[104:107], a[24:27], v[204:207]
buffer_load_dwordx4 v0, s[20:23], s4 offen offset:0 sc1 lds
v_mfma_f32_16x16x32_bf16 v[204:207], a[100:103], a[20:23], v[204:207]
ds_read_b128 a[72:75], v23 offset:2048
v_mfma_f32_16x16x32_bf16 v[204:207], a[96:99], a[16:19], v[204:207]
v_exp_f32 v200, v200
v_mfma_f32_16x16x32_bf16 v[208:211], a[96:99], a[32:35], v[48:51]
v_exp_f32 v201, v201
v_mfma_f32_16x16x32_bf16 v[208:211], a[100:103], a[36:39], v[208:211]
buffer_load_dwordx4 v0, s[20:23], s4 offen offset:1024 sc1 lds
v_cvt_pk_bf16_f32 v232, v200, v201
v_mfma_f32_16x16x32_bf16 v[208:211], a[104:107], a[40:43], v[208:211]
v_exp_f32 v202, v202
v_mfma_f32_16x16x32_bf16 v[208:211], a[108:111], a[44:47], v[208:211]
v_exp_f32 v203, v203
v_mfma_f32_16x16x32_bf16 v[212:215], a[108:111], a[60:63], v[52:55]
ds_read_b128 a[76:79], v23 offset:3072
v_cvt_pk_bf16_f32 v233, v202, v203
v_mfma_f32_16x16x32_bf16 v[212:215], a[104:107], a[56:59], v[212:215]
v_exp_f32 v204, v204
v_mfma_f32_16x16x32_bf16 v[212:215], a[100:103], a[52:55], v[212:215]
v_exp_f32 v205, v205
v_mfma_f32_16x16x32_bf16 v[212:215], a[96:99], a[48:51], v[212:215]
ds_read_b128 a[96:99], v1 offset:16384
v_cvt_pk_bf16_f32 v236, v204, v205
v_mfma_f32_16x16x32_bf16 v[216:219], a[112:115], a[0:3], v[40:43]
v_exp_f32 v206, v206
v_mfma_f32_16x16x32_bf16 v[216:219], a[116:119], a[4:7], v[216:219]
v_exp_f32 v207, v207
v_mfma_f32_16x16x32_bf16 v[216:219], a[120:123], a[8:11], v[216:219]
ds_read_b128 a[100:103], v1 offset:17408
v_cvt_pk_bf16_f32 v237, v206, v207
v_mfma_f32_16x16x32_bf16 v[216:219], a[124:127], a[12:15], v[216:219]
v_exp_f32 v208, v208
v_mfma_f32_16x16x32_bf16 v[220:223], a[124:127], a[28:31], v[44:47]
v_exp_f32 v209, v209
v_mfma_f32_16x16x32_bf16 v[220:223], a[120:123], a[24:27], v[220:223]
ds_read_b128 a[104:107], v1 offset:18432
v_cvt_pk_bf16_f32 v240, v208, v209
v_mfma_f32_16x16x32_bf16 v[220:223], a[116:119], a[20:23], v[220:223]
v_exp_f32 v210, v210
v_mfma_f32_16x16x32_bf16 v[220:223], a[112:115], a[16:19], v[220:223]
v_exp_f32 v211, v211
v_mfma_f32_16x16x32_bf16 v[224:227], a[112:115], a[32:35], v[48:51]
ds_read_b128 a[108:111], v1 offset:19456
v_cvt_pk_bf16_f32 v241, v210, v211
v_mfma_f32_16x16x32_bf16 v[224:227], a[116:119], a[36:39], v[224:227]
v_exp_f32 v212, v212
v_mfma_f32_16x16x32_bf16 v[224:227], a[120:123], a[40:43], v[224:227]
v_exp_f32 v213, v213
v_mfma_f32_16x16x32_bf16 v[224:227], a[124:127], a[44:47], v[224:227]
buffer_load_dwordx4 v0, s[20:23], s4 offen offset:2048 sc1 lds
v_cvt_pk_bf16_f32 v244, v212, v213
v_mfma_f32_16x16x32_bf16 v[228:231], a[124:127], a[60:63], v[52:55]
v_exp_f32 v214, v214
v_mfma_f32_16x16x32_bf16 v[228:231], a[120:123], a[56:59], v[228:231]
v_exp_f32 v215, v215
v_mfma_f32_16x16x32_bf16 v[228:231], a[116:119], a[52:55], v[228:231]
ds_read_b128 a[80:83], v23 offset:4096
v_cvt_pk_bf16_f32 v245, v214, v215
v_mfma_f32_16x16x32_bf16 v[228:231], a[112:115], a[48:51], v[228:231]
ds_read_b128 a[112:115], v1 offset:20480
ds_read_b128 a[116:119], v1 offset:21504
ds_read_b128 a[120:123], v1 offset:22528
ds_read_b128 a[124:127], v1 offset:23552
v_exp_f32 v216, v216
v_exp_f32 v217, v217
s_nop 0
v_cvt_pk_bf16_f32 v234, v216, v217
v_exp_f32 v218, v218
v_exp_f32 v219, v219
s_nop 0
v_cvt_pk_bf16_f32 v235, v218, v219
v_exp_f32 v220, v220
v_exp_f32 v221, v221
s_nop 0
v_cvt_pk_bf16_f32 v238, v220, v221
v_exp_f32 v222, v222
v_exp_f32 v223, v223
s_nop 0
v_cvt_pk_bf16_f32 v239, v222, v223
v_exp_f32 v224, v224
v_exp_f32 v225, v225
s_nop 0
v_cvt_pk_bf16_f32 v242, v224, v225
v_add_u32 v1, s11, v0
buffer_load_dwordx4 v0, s[20:23], s4 offen offset:3072 sc1 lds
s_add_u32 s4, s4, 16384
s_add_u32 s5, s5, 8192
s_and_b32 s5, s5, 0xffff
buffer_load_dword v34, v24, s[28:31], 0 offen
buffer_load_dword v35, v25, s[52:55], 0 offen
ds_read_b128 a[84:87], v23 offset:5120
ds_read_b128 a[88:91], v23 offset:6144
ds_read_b128 a[92:95], v23 offset:7168
s_branch LA_b13
LA_ma3:
s_waitcnt lgkmcnt(7)
v_mfma_f32_16x16x32_bf16 v[200:203], a[96:99], a[0:3], v[40:43]
s_waitcnt vmcnt(8) lgkmcnt(0)
s_barrier
v_mfma_f32_16x16x32_bf16 v[200:203], a[100:103], a[4:7], v[200:203]
s_add_u32 s12, s12, 8192
v_exp_f32 v226, v226
v_mfma_f32_16x16x32_bf16 v[200:203], a[104:107], a[8:11], v[200:203]
s_and_b32 s12, s12, 0xffff
s_add_u32 s11, s11, 8192
s_add_u32 m0, s5, s6
v_mfma_f32_16x16x32_bf16 v[200:203], a[108:111], a[12:15], v[200:203]
s_and_b32 s11, s11, 0xffff
v_exp_f32 v227, v227
v_mfma_f32_16x16x32_bf16 v[204:207], a[108:111], a[28:31], v[44:47]
ds_read_b128 a[128:131], v2 offset:0
v_cvt_pk_bf16_f32 v67, v226, v227
v_mfma_f32_16x16x32_bf16 v[204:207], a[104:107], a[24:27], v[204:207]
v_exp_f32 v228, v228
v_mfma_f32_16x16x32_bf16 v[204:207], a[100:103], a[20:23], v[204:207]
buffer_load_dwordx4 v0, s[20:23], s4 offen offset:0 sc1 lds
v_mfma_f32_16x16x32_bf16 v[204:207], a[96:99], a[16:19], v[204:207]
v_exp_f32 v229, v229
v_mfma_f32_16x16x32_bf16 v[208:211], a[96:99], a[32:35], v[48:51]
ds_read_b128 a[132:135], v2 offset:1024
v_cvt_pk_bf16_f32 v70, v228, v229
v_mfma_f32_16x16x32_bf16 v[208:211], a[100:103], a[36:39], v[208:211]
v_exp_f32 v230, v230
v_mfma_f32_16x16x32_bf16 v[208:211], a[104:107], a[40:43], v[208:211]
ds_read_b128 a[136:139], v2 offset:2048
v_mfma_f32_16x16x32_bf16 v[208:211], a[108:111], a[44:47], v[208:211]
v_exp_f32 v231, v231
v_mfma_f32_16x16x32_bf16 v[212:215], a[108:111], a[60:63], v[52:55]
ds_read_b128 a[140:143], v2 offset:3072
v_cvt_pk_bf16_f32 v71, v230, v231
v_mfma_f32_16x16x32_bf16 v[212:215], a[104:107], a[56:59], v[212:215]
v_exp_f32 v200, v200
v_mfma_f32_16x16x32_bf16 v[212:215], a[100:103], a[52:55], v[212:215]
buffer_load_dwordx4 v0, s[20:23], s4 offen offset:1024 sc1 lds
v_mfma_f32_16x16x32_bf16 v[212:215], a[96:99], a[48:51], v[212:215]
v_exp_f32 v201, v201
v_mfma_f32_16x16x32_bf16 v[216:219], a[112:115], a[0:3], v[40:43]
ds_read_b128 a[144:147], v2 offset:4096
v_cvt_pk_bf16_f32 v232, v200, v201
v_mfma_f32_16x16x32_bf16 v[216:219], a[116:119], a[4:7], v[216:219]
v_exp_f32 v202, v202
v_mfma_f32_16x16x32_bf16 v[216:219], a[120:123], a[8:11], v[216:219]
ds_read_b128 a[148:151], v2 offset:5120
v_mfma_f32_16x16x32_bf16 v[216:219], a[124:127], a[12:15], v[216:219]
v_exp_f32 v203, v203
v_mfma_f32_16x16x32_bf16 v[220:223], a[124:127], a[28:31], v[44:47]
ds_read_b128 a[152:155], v2 offset:6144
v_cvt_pk_bf16_f32 v233, v202, v203
v_mfma_f32_16x16x32_bf16 v[220:223], a[120:123], a[24:27], v[220:223]
v_exp_f32 v204, v204
v_mfma_f32_16x16x32_bf16 v[220:223], a[116:119], a[20:23], v[220:223]
buffer_load_dwordx4 v0, s[20:23], s4 offen offset:2048 sc1 lds
v_mfma_f32_16x16x32_bf16 v[220:223], a[112:115], a[16:19], v[220:223]
v_exp_f32 v205, v205
v_mfma_f32_16x16x32_bf16 v[224:227], a[112:115], a[32:35], v[48:51]
ds_read_b128 a[156:159], v2 offset:7168
v_cvt_pk_bf16_f32 v236, v204, v205
v_mfma_f32_16x16x32_bf16 v[224:227], a[116:119], a[36:39], v[224:227]
v_exp_f32 v206, v206
v_mfma_f32_16x16x32_bf16 v[224:227], a[120:123], a[40:43], v[224:227]
buffer_load_dwordx4 v0, s[20:23], s4 offen offset:3072 sc1 lds
v_mfma_f32_16x16x32_bf16 v[224:227], a[124:127], a[44:47], v[224:227]
s_add_u32 s4, s4, 16384
v_exp_f32 v207, v207
v_mfma_f32_16x16x32_bf16 v[228:231], a[124:127], a[60:63], v[52:55]
v_cvt_pk_bf16_f32 v237, v206, v207
v_add_u32 v2, s12, v3
v_mfma_f32_16x16x32_bf16 v[228:231], a[120:123], a[56:59], v[228:231]
s_waitcnt lgkmcnt(0)
v_exp_f32 v208, v208
v_mfma_f32_16x16x32_bf16 v[228:231], a[116:119], a[52:55], v[228:231]
s_add_u32 s5, s5, 8192
s_and_b32 s5, s5, 0xffff
v_mfma_f32_16x16x32_bf16 v[228:231], a[112:115], a[48:51], v[228:231]
v_exp_f32 v209, v209
v_mfma_f32_16x16x32_bf16 v[72:75], a[128:131], v[248:251], v[72:75]
ds_read_b128 a[96:99], v1 offset:16384
v_cvt_pk_bf16_f32 v240, v208, v209
v_mfma_f32_16x16x32_bf16 v[104:107], a[128:131], v[252:255], v[104:107]
v_exp_f32 v210, v210
v_mfma_f32_16x16x32_bf16 v[136:139], a[128:131], v[64:67], v[136:139]
v_add_u32 v30, (LA_fin+12288-LA_pc+4096)/4, v0
v_mad_u64_u32 v[30:31], vcc, v30, 4, s[72:73]
v_mfma_f32_16x16x32_bf16 v[168:171], a[128:131], v[68:71], v[168:171]
v_exp_f32 v211, v211
v_mfma_f32_16x16x32_bf16 v[172:175], a[132:135], v[68:71], v[172:175]
ds_read_b128 a[100:103], v1 offset:17408
v_cvt_pk_bf16_f32 v241, v210, v211
v_mfma_f32_16x16x32_bf16 v[140:143], a[132:135], v[64:67], v[140:143]
v_exp_f32 v212, v212
v_mfma_f32_16x16x32_bf16 v[108:111], a[132:135], v[252:255], v[108:111]
global_load_dword v30, v[30:31], off offset:-4096
v_mfma_f32_16x16x32_bf16 v[76:79], a[132:135], v[248:251], v[76:79]
v_exp_f32 v213, v213
v_mfma_f32_16x16x32_bf16 v[80:83], a[136:139], v[248:251], v[80:83]
ds_read_b128 a[104:107], v1 offset:18432
v_cvt_pk_bf16_f32 v244, v212, v213
v_mfma_f32_16x16x32_bf16 v[112:115], a[136:139], v[252:255], v[112:115]
v_exp_f32 v214, v214
v_mfma_f32_16x16x32_bf16 v[144:147], a[136:139], v[64:67], v[144:147]
v_mfma_f32_16x16x32_bf16 v[176:179], a[136:139], v[68:71], v[176:179]
v_exp_f32 v215, v215
v_mfma_f32_16x16x32_bf16 v[180:183], a[140:143], v[68:71], v[180:183]
ds_read_b128 a[108:111], v1 offset:19456
v_cvt_pk_bf16_f32 v245, v214, v215
v_mfma_f32_16x16x32_bf16 v[148:151], a[140:143], v[64:67], v[148:151]
v_exp_f32 v216, v216
v_mfma_f32_16x16x32_bf16 v[116:119], a[140:143], v[252:255], v[116:119]
v_mfma_f32_16x16x32_bf16 v[84:87], a[140:143], v[248:251], v[84:87]
v_exp_f32 v217, v217
v_mfma_f32_16x16x32_bf16 v[88:91], a[144:147], v[248:251], v[88:91]
ds_read_b128 a[112:115], v1 offset:20480
v_cvt_pk_bf16_f32 v234, v216, v217
v_mfma_f32_16x16x32_bf16 v[120:123], a[144:147], v[252:255], v[120:123]
v_exp_f32 v218, v218
v_mfma_f32_16x16x32_bf16 v[152:155], a[144:147], v[64:67], v[152:155]
v_mfma_f32_16x16x32_bf16 v[184:187], a[144:147], v[68:71], v[184:187]
v_exp_f32 v219, v219
v_mfma_f32_16x16x32_bf16 v[188:191], a[148:151], v[68:71], v[188:191]
ds_read_b128 a[116:119], v1 offset:21504
v_cvt_pk_bf16_f32 v235, v218, v219
v_mfma_f32_16x16x32_bf16 v[156:159], a[148:151], v[64:67], v[156:159]
v_exp_f32 v220, v220
v_mfma_f32_16x16x32_bf16 v[124:127], a[148:151], v[252:255], v[124:127]
v_mfma_f32_16x16x32_bf16 v[92:95], a[148:151], v[248:251], v[92:95]
v_exp_f32 v221, v221
v_mfma_f32_16x16x32_bf16 v[96:99], a[152:155], v[248:251], v[96:99]
ds_read_b128 a[120:123], v1 offset:22528
v_cvt_pk_bf16_f32 v238, v220, v221
v_mfma_f32_16x16x32_bf16 v[128:131], a[152:155], v[252:255], v[128:131]
v_exp_f32 v222, v222
v_mfma_f32_16x16x32_bf16 v[160:163], a[152:155], v[64:67], v[160:163]
v_mfma_f32_16x16x32_bf16 v[192:195], a[152:155], v[68:71], v[192:195]
v_exp_f32 v223, v223
v_mfma_f32_16x16x32_bf16 v[196:199], a[156:159], v[68:71], v[196:199]
ds_read_b128 a[124:127], v1 offset:23552
v_cvt_pk_bf16_f32 v239, v222, v223
v_mfma_f32_16x16x32_bf16 v[164:167], a[156:159], v[64:67], v[164:167]
v_exp_f32 v224, v224
v_mfma_f32_16x16x32_bf16 v[132:135], a[156:159], v[252:255], v[132:135]
v_mfma_f32_16x16x32_bf16 v[100:103], a[156:159], v[248:251], v[100:103]
v_exp_f32 v225, v225
v_mfma_f32_16x16x32_bf16 a[160:163], a[184:187], v[248:251], a[160:163]
v_cvt_pk_bf16_f32 v242, v224, v225
v_add_u32 v1, s11, v0
v_mfma_f32_16x16x32_bf16 a[164:167], a[184:187], v[252:255], a[164:167]
v_mfma_f32_16x16x32_bf16 a[168:171], a[184:187], v[64:67], a[168:171]
v_mfma_f32_16x16x32_bf16 a[172:175], a[184:187], v[68:71], a[172:175]
LA_b13:
s_waitcnt lgkmcnt(7)
v_mfma_f32_16x16x32_bf16 v[200:203], a[96:99], a[0:3], v[40:43]
s_waitcnt vmcnt(9) lgkmcnt(0)
s_barrier
v_mfma_f32_16x16x32_bf16 v[200:203], a[100:103], a[4:7], v[200:203]
s_add_u32 s12, s12, 8192
v_exp_f32 v226, v226
v_mfma_f32_16x16x32_bf16 v[200:203], a[104:107], a[8:11], v[200:203]
s_waitcnt vmcnt(6)
s_and_b32 s12, s12, 0xffff
v_bfe_u32 v20, v0, 2, 7
v_mfma_f32_16x16x32_bf16 v[200:203], a[108:111], a[12:15], v[200:203]
s_add_u32 s11, s11, 8192
v_exp_f32 v227, v227
v_mfma_f32_16x16x32_bf16 v[204:207], a[108:111], a[28:31], v[44:47]
ds_read_b128 a[128:131], v2 offset:0
ds_read_b128 a[132:135], v2 offset:1024
v_cvt_pk_bf16_f32 v243, v226, v227
v_mfma_f32_16x16x32_bf16 v[204:207], a[104:107], a[24:27], v[204:207]
ds_read_b128 a[136:139], v2 offset:2048
v_exp_f32 v228, v228
v_mfma_f32_16x16x32_bf16 v[204:207], a[100:103], a[20:23], v[204:207]
buffer_load_dword v20, v20, s[76:79], s40 offen offset:0 sc1
v_mfma_f32_16x16x32_bf16 v[204:207], a[96:99], a[16:19], v[204:207]
s_and_b32 s11, s11, 0xffff
v_exp_f32 v229, v229
v_mfma_f32_16x16x32_bf16 v[208:211], a[96:99], a[32:35], v[48:51]
v_cvt_pk_bf16_f32 v246, v228, v229
v_bfe_u32 v22, v0, 2, 7
v_mfma_f32_16x16x32_bf16 v[208:211], a[100:103], a[36:39], v[208:211]
s_add_u32 m0, s5, s6
v_exp_f32 v230, v230
v_mfma_f32_16x16x32_bf16 v[208:211], a[104:107], a[40:43], v[208:211]
buffer_load_dword v22, v22, s[76:79], s41 offen offset:0 sc1
v_mfma_f32_16x16x32_bf16 v[208:211], a[108:111], a[44:47], v[208:211]
v_exp_f32 v231, v231
v_mfma_f32_16x16x32_bf16 v[212:215], a[108:111], a[60:63], v[52:55]
ds_read_b128 a[140:143], v2 offset:3072
v_cvt_pk_bf16_f32 v247, v230, v231
v_mfma_f32_16x16x32_bf16 v[212:215], a[104:107], a[56:59], v[212:215]
v_exp_f32 v200, v200
v_mfma_f32_16x16x32_bf16 v[212:215], a[100:103], a[52:55], v[212:215]
buffer_load_dwordx4 v0, s[20:23], s4 offen offset:0 sc1 lds
v_mfma_f32_16x16x32_bf16 v[212:215], a[96:99], a[48:51], v[212:215]
v_exp_f32 v201, v201
v_mfma_f32_16x16x32_bf16 v[216:219], a[112:115], a[0:3], v[40:43]
ds_read_b128 a[144:147], v2 offset:4096
v_cvt_pk_bf16_f32 v248, v200, v201
v_mfma_f32_16x16x32_bf16 v[216:219], a[116:119], a[4:7], v[216:219]
v_exp_f32 v202, v202
v_mfma_f32_16x16x32_bf16 v[216:219], a[120:123], a[8:11], v[216:219]
ds_read_b128 a[148:151], v2 offset:5120
v_bfe_u32 v21, v0, 4, 4
v_mfma_f32_16x16x32_bf16 v[216:219], a[124:127], a[12:15], v[216:219]
s_lshl_b32 s34, s80, 6
v_exp_f32 v203, v203
v_mfma_f32_16x16x32_bf16 v[220:223], a[124:127], a[28:31], v[44:47]
ds_read_b128 a[152:155], v2 offset:6144
v_cvt_pk_bf16_f32 v249, v202, v203
v_mfma_f32_16x16x32_bf16 v[220:223], a[120:123], a[24:27], v[220:223]
s_sub_u32 s35, 448, s34
v_exp_f32 v204, v204
v_mfma_f32_16x16x32_bf16 v[220:223], a[116:119], a[20:23], v[220:223]
buffer_load_dwordx4 v0, s[20:23], s4 offen offset:1024 sc1 lds
v_mfma_f32_16x16x32_bf16 v[220:223], a[112:115], a[16:19], v[220:223]
v_exp_f32 v205, v205
v_mfma_f32_16x16x32_bf16 v[224:227], a[112:115], a[32:35], v[48:51]
ds_read_b128 a[156:159], v2 offset:7168
v_cvt_pk_bf16_f32 v252, v204, v205
v_mfma_f32_16x16x32_bf16 v[224:227], a[116:119], a[36:39], v[224:227]
v_exp_f32 v206, v206
v_mfma_f32_16x16x32_bf16 v[224:227], a[120:123], a[40:43], v[224:227]
buffer_load_dwordx4 v0, s[20:23], s4 offen offset:2048 sc1 lds
v_mfma_f32_16x16x32_bf16 v[224:227], a[124:127], a[44:47], v[224:227]
v_exp_f32 v207, v207
v_mfma_f32_16x16x32_bf16 v[228:231], a[124:127], a[60:63], v[52:55]
v_cvt_pk_bf16_f32 v253, v206, v207
v_add_u32 v2, s12, v3
v_mfma_f32_16x16x32_bf16 v[228:231], a[120:123], a[56:59], v[228:231]
s_waitcnt lgkmcnt(0)
v_exp_f32 v208, v208
v_mfma_f32_16x16x32_bf16 v[228:231], a[116:119], a[52:55], v[228:231]
buffer_load_dwordx4 v0, s[20:23], s4 offen offset:3072 sc1 lds
v_mfma_f32_16x16x32_bf16 v[228:231], a[112:115], a[48:51], v[228:231]
s_add_u32 s4, s4, 16384
v_exp_f32 v209, v209
v_mfma_f32_16x16x32_bf16 v[72:75], a[128:131], v[232:235], v[72:75]
ds_read_b128 a[96:99], v1 offset:16384
v_cvt_pk_bf16_f32 v64, v208, v209
v_mfma_f32_16x16x32_bf16 v[104:107], a[128:131], v[236:239], v[104:107]
s_add_u32 s5, s5, 8192
v_exp_f32 v210, v210
v_mfma_f32_16x16x32_bf16 v[136:139], a[128:131], v[240:243], v[136:139]
s_and_b32 s5, s5, 0xffff
v_lshl_add_u32 v29, v21, 2, s34
v_mfma_f32_16x16x32_bf16 v[168:171], a[128:131], v[244:247], v[168:171]
v_exp_f32 v211, v211
v_mfma_f32_16x16x32_bf16 v[172:175], a[132:135], v[244:247], v[172:175]
ds_read_b128 a[100:103], v1 offset:17408
v_cvt_pk_bf16_f32 v65, v210, v211
v_mfma_f32_16x16x32_bf16 v[140:143], a[132:135], v[240:243], v[140:143]
v_exp_f32 v212, v212
v_mfma_f32_16x16x32_bf16 v[108:111], a[132:135], v[236:239], v[108:111]
v_lshl_add_u32 v28, v21, 2, s35
v_sub_f32 v24, 1.0, v4
v_mfma_f32_16x16x32_bf16 v[76:79], a[132:135], v[232:235], v[76:79]
v_exp_f32 v213, v213
v_mfma_f32_16x16x32_bf16 v[80:83], a[136:139], v[232:235], v[80:83]
ds_read_b128 a[104:107], v1 offset:18432
v_cvt_pk_bf16_f32 v68, v212, v213
v_mfma_f32_16x16x32_bf16 v[112:115], a[136:139], v[236:239], v[112:115]
v_exp_f32 v214, v214
v_mfma_f32_16x16x32_bf16 v[144:147], a[136:139], v[240:243], v[144:147]
v_sub_f32 v25, 1.0, v5
v_sub_f32 v26, 1.0, v6
v_mfma_f32_16x16x32_bf16 v[176:179], a[136:139], v[244:247], v[176:179]
v_exp_f32 v215, v215
v_mfma_f32_16x16x32_bf16 v[180:183], a[140:143], v[244:247], v[180:183]
ds_read_b128 a[108:111], v1 offset:19456
v_cvt_pk_bf16_f32 v69, v214, v215
v_mfma_f32_16x16x32_bf16 v[148:151], a[140:143], v[240:243], v[148:151]
v_exp_f32 v216, v216
v_mfma_f32_16x16x32_bf16 v[116:119], a[140:143], v[236:239], v[116:119]
v_sub_f32 v27, 1.0, v7
v_cvt_pk_bf16_f32 v24, v24, v24
v_mfma_f32_16x16x32_bf16 v[84:87], a[140:143], v[232:235], v[84:87]
v_exp_f32 v217, v217
v_mfma_f32_16x16x32_bf16 v[88:91], a[144:147], v[232:235], v[88:91]
v_cvt_pk_bf16_f32 v250, v216, v217
v_and_b32 v250, v250, v18
v_mfma_f32_16x16x32_bf16 v[120:123], a[144:147], v[236:239], v[120:123]
v_exp_f32 v218, v218
v_mfma_f32_16x16x32_bf16 v[152:155], a[144:147], v[240:243], v[152:155]
ds_read_b128 a[112:115], v1 offset:20480
v_cvt_pk_bf16_f32 v25, v25, v25
v_mfma_f32_16x16x32_bf16 v[184:187], a[144:147], v[244:247], v[184:187]
v_exp_f32 v219, v219
v_mfma_f32_16x16x32_bf16 v[188:191], a[148:151], v[244:247], v[188:191]
v_cvt_pk_bf16_f32 v251, v218, v219
v_and_b32 v251, v251, v19
v_mfma_f32_16x16x32_bf16 v[156:159], a[148:151], v[240:243], v[156:159]
v_exp_f32 v220, v220
v_mfma_f32_16x16x32_bf16 v[124:127], a[148:151], v[236:239], v[124:127]
ds_read_b128 a[116:119], v1 offset:21504
v_cvt_pk_bf16_f32 v26, v26, v26
v_mfma_f32_16x16x32_bf16 v[92:95], a[148:151], v[232:235], v[92:95]
v_exp_f32 v221, v221
v_mfma_f32_16x16x32_bf16 v[96:99], a[152:155], v[232:235], v[96:99]
ds_read_b128 a[120:123], v1 offset:22528
v_cvt_pk_bf16_f32 v254, v220, v221
v_mfma_f32_16x16x32_bf16 v[128:131], a[152:155], v[236:239], v[128:131]
v_exp_f32 v222, v222
v_mfma_f32_16x16x32_bf16 v[160:163], a[152:155], v[240:243], v[160:163]
s_waitcnt vmcnt(5)
v_cvt_pk_bf16_f32 v27, v27, v27
v_lshlrev_b32 v24, 16, v24
v_cmp_lt_u32 vcc, 0, v20
v_mfma_f32_16x16x32_bf16 v[192:195], a[152:155], v[244:247], v[192:195]
s_waitcnt vmcnt(4)
v_exp_f32 v223, v223
v_cmp_lt_u32 s[32:33], 0, v22
v_mfma_f32_16x16x32_bf16 v[196:199], a[156:159], v[244:247], v[196:199]
ds_read_b128 a[124:127], v1 offset:23552
v_cvt_pk_bf16_f32 v255, v222, v223
v_mfma_f32_16x16x32_bf16 v[164:167], a[156:159], v[240:243], v[164:167]
v_exp_f32 v224, v224
v_mfma_f32_16x16x32_bf16 v[132:135], a[156:159], v[236:239], v[132:135]
v_lshlrev_b32 v25, 16, v25
v_lshlrev_b32 v26, 16, v26
v_mfma_f32_16x16x32_bf16 v[100:103], a[156:159], v[232:235], v[100:103]
v_exp_f32 v225, v225
v_mfma_f32_16x16x32_bf16 a[160:163], a[184:187], v[232:235], a[160:163]
v_cvt_pk_bf16_f32 v66, v224, v225
v_add_u32 v1, s11, v0
v_mfma_f32_16x16x32_bf16 a[164:167], a[184:187], v[236:239], a[164:167]
v_lshlrev_b32 v27, 16, v27
v_add_f32 v24, v24, v24
v_mfma_f32_16x16x32_bf16 a[168:171], a[184:187], v[240:243], a[168:171]
s_andn2_b32 s33, 255, s32
s_cbranch_scc1 LA_p43_s
LA_p43:
v_mfma_f32_16x16x32_bf16 a[172:175], a[184:187], v[244:247], a[172:175]
s_andn2_b32 s33, 16776960, vcc_lo
s_cbranch_scc1 LA_p23_s
LA_p23:
v_add_f32 v25, v25, v25
v_add_f32 v26, v26, v26
v_add_f32 v27, v27, v27
ds_write_b32 v29, v24 offset:6144
ds_write_b32 v28, v25 offset:6144
ds_write_b32 v29, v26 offset:6656
ds_write_b32 v28, v27 offset:6656
s_waitcnt lgkmcnt(11)
v_mfma_f32_16x16x32_bf16 v[204:207], a[96:99], a[16:19], v[44:47]
s_waitcnt vmcnt(63) lgkmcnt(0)
s_barrier
v_mfma_f32_16x16x32_bf16 v[204:207], a[100:103], a[20:23], v[204:207]
s_add_u32 s12, s12, 8192
v_exp_f32 v226, v226
v_mfma_f32_16x16x32_bf16 v[204:207], a[104:107], a[24:27], v[204:207]
s_and_b32 s12, s12, 0xffff
s_add_u32 s11, s11, 16384
v_lshrrev_b32 v22, 1, v0
v_mfma_f32_16x16x32_bf16 v[204:207], a[108:111], a[28:31], v[204:207]
s_and_b32 s11, s11, 0xffff
v_exp_f32 v227, v227
v_mfma_f32_16x16x32_bf16 v[208:211], a[108:111], a[44:47], v[48:51]
ds_read_b128 a[128:131], v2 offset:0
v_cvt_pk_bf16_f32 v67, v226, v227
v_mfma_f32_16x16x32_bf16 v[208:211], a[104:107], a[40:43], v[208:211]
v_exp_f32 v228, v228
v_mfma_f32_16x16x32_bf16 v[208:211], a[100:103], a[36:39], v[208:211]
buffer_load_dwordx2 v[24:25], v22, s[76:79], s86 offen offset:0 sc1
v_mfma_f32_16x16x32_bf16 v[208:211], a[96:99], a[32:35], v[208:211]
v_exp_f32 v229, v229
v_mfma_f32_16x16x32_bf16 v[212:215], a[96:99], a[48:51], v[52:55]
ds_read_b128 a[132:135], v2 offset:1024
v_cvt_pk_bf16_f32 v70, v228, v229
v_mfma_f32_16x16x32_bf16 v[212:215], a[100:103], a[52:55], v[212:215]
v_exp_f32 v230, v230
v_mfma_f32_16x16x32_bf16 v[212:215], a[104:107], a[56:59], v[212:215]
buffer_load_dwordx2 v[26:27], v22, s[76:79], s86 offen offset:512 sc1
v_mfma_f32_16x16x32_bf16 v[212:215], a[108:111], a[60:63], v[212:215]
v_exp_f32 v231, v231
v_mfma_f32_16x16x32_bf16 v[224:227], a[112:115], a[32:35], v[48:51]
ds_read_b128 a[136:139], v2 offset:2048
v_cvt_pk_bf16_f32 v71, v230, v231
v_mfma_f32_16x16x32_bf16 v[224:227], a[116:119], a[36:39], v[224:227]
v_exp_f32 v204, v204
v_mfma_f32_16x16x32_bf16 v[224:227], a[120:123], a[40:43], v[224:227]
ds_read_b128 a[140:143], v2 offset:3072
buffer_load_dwordx2 v[28:29], v22, s[76:79], s86 offen offset:1024 sc1
v_mfma_f32_16x16x32_bf16 v[224:227], a[124:127], a[44:47], v[224:227]
v_exp_f32 v205, v205
v_mfma_f32_16x16x32_bf16 v[228:231], a[124:127], a[60:63], v[52:55]
v_cvt_pk_bf16_f32 v236, v204, v205
v_and_b32 v236, v236, v18
v_mfma_f32_16x16x32_bf16 v[228:231], a[120:123], a[56:59], v[228:231]
v_exp_f32 v206, v206
v_mfma_f32_16x16x32_bf16 v[228:231], a[116:119], a[52:55], v[228:231]
ds_read_b128 a[144:147], v2 offset:4096
buffer_load_dwordx2 v[30:31], v22, s[76:79], s86 offen offset:1536 sc1
v_mfma_f32_16x16x32_bf16 v[228:231], a[112:115], a[48:51], v[228:231]
s_waitcnt lgkmcnt(4)
v_exp_f32 v207, v207
v_mfma_f32_16x16x32_bf16 v[72:75], a[128:131], v[248:251], v[72:75]
v_cvt_pk_bf16_f32 v237, v206, v207
v_and_b32 v237, v237, v19
v_mfma_f32_16x16x32_bf16 v[104:107], a[128:131], v[252:255], v[104:107]
v_exp_f32 v208, v208
v_mfma_f32_16x16x32_bf16 v[136:139], a[128:131], v[64:67], v[136:139]
ds_read_b128 a[148:151], v2 offset:5120
buffer_load_dwordx2 v[32:33], v22, s[76:79], s86 offen offset:2048 sc1
v_mfma_f32_16x16x32_bf16 v[168:171], a[128:131], v[68:71], v[168:171]
s_waitcnt lgkmcnt(4)
v_exp_f32 v209, v209
v_mfma_f32_16x16x32_bf16 v[172:175], a[132:135], v[68:71], v[172:175]
ds_read_b128 a[152:155], v2 offset:6144
v_cvt_pk_bf16_f32 v240, v208, v209
v_mfma_f32_16x16x32_bf16 v[140:143], a[132:135], v[64:67], v[140:143]
v_exp_f32 v210, v210
v_mfma_f32_16x16x32_bf16 v[108:111], a[132:135], v[252:255], v[108:111]
ds_read_b128 a[96:99], v1 offset:16384
buffer_load_dwordx2 v[34:35], v22, s[76:79], s86 offen offset:2560 sc1
v_mfma_f32_16x16x32_bf16 v[76:79], a[132:135], v[248:251], v[76:79]
s_waitcnt lgkmcnt(5)
v_exp_f32 v211, v211
v_mfma_f32_16x16x32_bf16 v[80:83], a[136:139], v[248:251], v[80:83]
ds_read_b128 a[156:159], v2 offset:7168
v_cvt_pk_bf16_f32 v241, v210, v211
v_mfma_f32_16x16x32_bf16 v[112:115], a[136:139], v[252:255], v[112:115]
v_exp_f32 v212, v212
v_mfma_f32_16x16x32_bf16 v[144:147], a[136:139], v[64:67], v[144:147]
ds_read_b128 a[100:103], v1 offset:17408
buffer_load_dwordx2 v[36:37], v22, s[76:79], s86 offen offset:3072 sc1
v_mfma_f32_16x16x32_bf16 v[176:179], a[136:139], v[68:71], v[176:179]
s_waitcnt lgkmcnt(6)
v_exp_f32 v213, v213
v_mfma_f32_16x16x32_bf16 v[180:183], a[140:143], v[68:71], v[180:183]
v_cvt_pk_bf16_f32 v244, v212, v213
v_add_u32 v2, s12, v3
v_mfma_f32_16x16x32_bf16 v[148:151], a[140:143], v[64:67], v[148:151]
v_exp_f32 v214, v214
v_mfma_f32_16x16x32_bf16 v[116:119], a[140:143], v[252:255], v[116:119]
ds_read_b128 a[104:107], v1 offset:18432
buffer_load_dwordx2 v[38:39], v22, s[76:79], s86 offen offset:3584 sc1
v_mfma_f32_16x16x32_bf16 v[84:87], a[140:143], v[248:251], v[84:87]
s_waitcnt lgkmcnt(6)
s_add_u32 m0, s5, s6
v_exp_f32 v215, v215
v_mfma_f32_16x16x32_bf16 v[88:91], a[144:147], v[248:251], v[88:91]
ds_read_b128 a[108:111], v1 offset:19456
v_cvt_pk_bf16_f32 v245, v214, v215
v_mfma_f32_16x16x32_bf16 v[120:123], a[144:147], v[252:255], v[120:123]
v_mov_b32 v238, 0
v_mov_b32 v239, 0
v_mfma_f32_16x16x32_bf16 v[152:155], a[144:147], v[64:67], v[152:155]
v_exp_f32 v224, v224
v_mfma_f32_16x16x32_bf16 v[184:187], a[144:147], v[68:71], v[184:187]
s_waitcnt lgkmcnt(6)
buffer_load_dwordx4 v0, s[20:23], s4 offen offset:0 sc1 lds
v_mfma_f32_16x16x32_bf16 v[188:191], a[148:151], v[68:71], v[188:191]
v_exp_f32 v225, v225
v_mfma_f32_16x16x32_bf16 v[156:159], a[148:151], v[64:67], v[156:159]
ds_read_b128 a[112:115], v1 offset:20480
v_cvt_pk_bf16_f32 v242, v224, v225
v_mfma_f32_16x16x32_bf16 v[124:127], a[148:151], v[252:255], v[124:127]
ds_read_b128 a[116:119], v1 offset:21504
v_mfma_f32_16x16x32_bf16 v[92:95], a[148:151], v[248:251], v[92:95]
s_waitcnt lgkmcnt(7)
ds_read_b128 a[120:123], v1 offset:22528
buffer_load_dwordx4 v0, s[20:23], s4 offen offset:1024 sc1 lds
v_mfma_f32_16x16x32_bf16 v[96:99], a[152:155], v[248:251], v[96:99]
v_mfma_f32_16x16x32_bf16 v[128:131], a[152:155], v[252:255], v[128:131]
v_mfma_f32_16x16x32_bf16 v[160:163], a[152:155], v[64:67], v[160:163]
v_mfma_f32_16x16x32_bf16 v[192:195], a[152:155], v[68:71], v[192:195]
s_waitcnt lgkmcnt(6)
ds_read_b128 a[124:127], v1 offset:23552
buffer_load_dwordx4 v0, s[20:23], s4 offen offset:2048 sc1 lds
v_mfma_f32_16x16x32_bf16 v[196:199], a[156:159], v[68:71], v[196:199]
v_add_u32 v1, s11, v0
v_mfma_f32_16x16x32_bf16 v[164:167], a[156:159], v[64:67], v[164:167]
v_mfma_f32_16x16x32_bf16 v[132:135], a[156:159], v[252:255], v[132:135]
v_mfma_f32_16x16x32_bf16 v[100:103], a[156:159], v[248:251], v[100:103]
buffer_load_dwordx4 v0, s[20:23], s4 offen offset:3072 sc1 lds
v_mfma_f32_16x16x32_bf16 a[160:163], a[184:187], v[248:251], a[160:163]
s_add_u32 s4, s4, 16384
s_add_u32 s5, s5, 8192
s_and_b32 s5, s5, 0xffff
v_mfma_f32_16x16x32_bf16 a[164:167], a[184:187], v[252:255], a[164:167]
v_mfma_f32_16x16x32_bf16 a[168:171], a[184:187], v[64:67], a[168:171]
v_mfma_f32_16x16x32_bf16 a[172:175], a[184:187], v[68:71], a[172:175]
s_cmp_eq_u32 s16, 0
s_cbranch_scc1 LA_ssm
LA_c33:
v_mfma_f32_16x16x32_bf16 v[208:211], a[96:99], a[32:35], v[48:51]
s_waitcnt vmcnt(63) lgkmcnt(0)
s_barrier
v_mfma_f32_16x16x32_bf16 v[208:211], a[100:103], a[36:39], v[208:211]
s_add_u32 s12, s12, 8192
v_exp_f32 v226, v226
v_mfma_f32_16x16x32_bf16 v[208:211], a[104:107], a[40:43], v[208:211]
s_and_b32 s12, s12, 0xffff
s_add_u32 s11, s11, s15
s_add_u32 m0, s5, s6
v_mfma_f32_16x16x32_bf16 v[208:211], a[108:111], a[44:47], v[208:211]
s_and_b32 s11, s11, 0xffff
v_exp_f32 v227, v227
v_mfma_f32_16x16x32_bf16 v[212:215], a[108:111], a[60:63], v[52:55]
ds_read_b128 a[128:131], v2 offset:0
v_cvt_pk_bf16_f32 v243, v226, v227
v_mfma_f32_16x16x32_bf16 v[212:215], a[104:107], a[56:59], v[212:215]
s_lshl_b32 s34, s80, 13
v_exp_f32 v228, v228
v_mfma_f32_16x16x32_bf16 v[212:215], a[100:103], a[52:55], v[212:215]
buffer_load_dwordx4 v0, s[20:23], s4 offen offset:0 sc1 lds
v_mfma_f32_16x16x32_bf16 v[212:215], a[96:99], a[48:51], v[212:215]
s_lshl_b32 s35, s80, 14
v_exp_f32 v229, v229
v_mfma_f32_16x16x32_bf16 v[224:227], a[112:115], a[32:35], v[48:51]
ds_read_b128 a[132:135], v2 offset:1024
v_cvt_pk_bf16_f32 v246, v228, v229
v_mfma_f32_16x16x32_bf16 v[224:227], a[116:119], a[36:39], v[224:227]
s_xor_b32 s50, s17, 0x8000
v_exp_f32 v230, v230
v_mfma_f32_16x16x32_bf16 v[224:227], a[120:123], a[40:43], v[224:227]
s_lshl_b32 s33, s80, 9
v_exp_f32 v231, v231
v_mfma_f32_16x16x32_bf16 v[224:227], a[124:127], a[44:47], v[224:227]
ds_read_b128 a[136:139], v2 offset:2048
v_cvt_pk_bf16_f32 v247, v230, v231
v_mfma_f32_16x16x32_bf16 v[228:231], a[124:127], a[60:63], v[52:55]
s_add_u32 s33, s33, s50
v_exp_f32 v208, v208
v_mfma_f32_16x16x32_bf16 v[228:231], a[120:123], a[56:59], v[228:231]
ds_read_b128 a[96:99], v1 offset:16384
buffer_load_dwordx4 v0, s[20:23], s4 offen offset:1024 sc1 lds
v_mfma_f32_16x16x32_bf16 v[228:231], a[116:119], a[52:55], v[228:231]
s_sub_u32 s32, 4, s85
v_exp_f32 v209, v209
v_mfma_f32_16x16x32_bf16 v[228:231], a[112:115], a[48:51], v[228:231]
s_waitcnt lgkmcnt(3)
ds_read_b128 a[140:143], v2 offset:3072
v_cvt_pk_bf16_f32 v64, v208, v209
v_mfma_f32_16x16x32_bf16 v[104:107], a[128:131], v[236:239], v[104:107]
s_lshl_b32 s32, s32, 12
v_exp_f32 v210, v210
v_mfma_f32_16x16x32_bf16 v[136:139], a[128:131], v[240:243], v[136:139]
ds_read_b128 a[100:103], v1 offset:17408
buffer_load_dwordx4 v0, s[20:23], s4 offen offset:2048 sc1 lds
v_mfma_f32_16x16x32_bf16 v[168:171], a[128:131], v[244:247], v[168:171]
s_waitcnt lgkmcnt(4)
s_add_u32 s96, s88, s32
v_exp_f32 v211, v211
v_mfma_f32_16x16x32_bf16 v[172:175], a[132:135], v[244:247], v[172:175]
ds_read_b128 a[144:147], v2 offset:4096
v_cvt_pk_bf16_f32 v65, v210, v211
v_mfma_f32_16x16x32_bf16 v[140:143], a[132:135], v[240:243], v[140:143]
s_add_u32 s97, s89, s32
v_exp_f32 v212, v212
v_mfma_f32_16x16x32_bf16 v[108:111], a[132:135], v[236:239], v[108:111]
s_waitcnt lgkmcnt(4)
ds_read_b128 a[104:107], v1 offset:18432
buffer_load_dwordx4 v0, s[20:23], s4 offen offset:3072 sc1 lds
v_mfma_f32_16x16x32_bf16 v[112:115], a[136:139], v[236:239], v[112:115]
s_add_u32 s4, s4, 16384
v_exp_f32 v213, v213
v_mfma_f32_16x16x32_bf16 v[144:147], a[136:139], v[240:243], v[144:147]
s_add_u32 s5, s5, 8192
ds_read_b128 a[148:151], v2 offset:5120
v_cvt_pk_bf16_f32 v68, v212, v213
v_mfma_f32_16x16x32_bf16 v[176:179], a[136:139], v[244:247], v[176:179]
s_waitcnt lgkmcnt(4)
s_and_b32 s5, s5, 0xffff
v_exp_f32 v214, v214
v_mfma_f32_16x16x32_bf16 v[180:183], a[140:143], v[244:247], v[180:183]
s_add_u32 s98, s90, s32
ds_read_b128 a[108:111], v1 offset:19456
v_mfma_f32_16x16x32_bf16 v[148:151], a[140:143], v[240:243], v[148:151]
s_add_u32 s99, s91, s32
v_exp_f32 v215, v215
v_mfma_f32_16x16x32_bf16 v[116:119], a[140:143], v[236:239], v[116:119]
s_waitcnt lgkmcnt(3)
ds_read_b128 a[152:155], v2 offset:6144
v_cvt_pk_bf16_f32 v69, v214, v215
v_mfma_f32_16x16x32_bf16 v[120:123], a[144:147], v[236:239], v[120:123]
v_exp_f32 v224, v224
v_mfma_f32_16x16x32_bf16 v[152:155], a[144:147], v[240:243], v[152:155]
s_waitcnt vmcnt(15)
ds_read_b128 a[112:115], v1 offset:20480
v_bfe_u32 v24, v0, 4, 4
v_mfma_f32_16x16x32_bf16 v[184:187], a[144:147], v[244:247], v[184:187]
s_waitcnt lgkmcnt(3)
v_exp_f32 v225, v225
v_mfma_f32_16x16x32_bf16 v[188:191], a[148:151], v[244:247], v[188:191]
ds_read_b128 a[156:159], v2 offset:7168
v_cvt_pk_bf16_f32 v66, v224, v225
v_mfma_f32_16x16x32_bf16 v[156:159], a[148:151], v[240:243], v[156:159]
ds_read_b128 a[116:119], v1 offset:21504
v_add_u32 v2, s12, v3
v_mfma_f32_16x16x32_bf16 v[124:127], a[148:151], v[236:239], v[124:127]
s_waitcnt lgkmcnt(3)
ds_read_b128 a[120:123], v1 offset:22528
v_lshrrev_b32 v25, 8, v0
v_mfma_f32_16x16x32_bf16 v[128:131], a[152:155], v[236:239], v[128:131]
s_waitcnt vmcnt(14)
ds_read_b128 a[124:127], v1 offset:23552
v_lshrrev_b32 v26, 1, v24
v_mfma_f32_16x16x32_bf16 v[160:163], a[152:155], v[240:243], v[160:163]
v_add_u32 v1, s11, v0
v_xor_b32 v26, v26, v25
v_mfma_f32_16x16x32_bf16 v[192:195], a[152:155], v[244:247], v[192:195]
s_waitcnt lgkmcnt(3)
v_and_b32 v27, 16, v0
v_lshl_or_b32 v27, v25, 10, v27
v_mfma_f32_16x16x32_bf16 v[196:199], a[156:159], v[244:247], v[196:199]
s_waitcnt vmcnt(9)
v_lshl_or_b32 v27, v26, 5, v27
v_add_u32 v36, s34, v27
v_mfma_f32_16x16x32_bf16 v[164:167], a[156:159], v[240:243], v[164:167]
v_xor_b32 v27, 128, v36
v_add_u32 v37, 3072, v27
v_mfma_f32_16x16x32_bf16 v[132:135], a[156:159], v[236:239], v[132:135]
s_waitcnt vmcnt(8)
v_lshlrev_b32 v25, 4, v25
v_lshl_or_b32 v38, v24, 10, v25
v_mfma_f32_16x16x32_bf16 a[164:167], a[184:187], v[236:239], a[164:167]
v_add_u32 v26, s35, v0
v_xor_b32 v27, 0x8000, v26
v_mfma_f32_16x16x32_bf16 a[168:171], a[184:187], v[240:243], a[168:171]
v_lshrrev_b32 v28, 2, v0
v_add_u32 v28, s33, v28
v_mfma_f32_16x16x32_bf16 a[172:175], a[184:187], v[244:247], a[172:175]
v_xor_b32 v29, 1024, v28
v_lshlrev_b32 v30, 2, v0
s_waitcnt vmcnt(4)
s_mov_b64 exec, 1
buffer_store_dword v3, off, s[76:79], s44 offset:128 sc1
s_mov_b64 exec, -1
s_cmp_eq_u32 s82, 7
s_cbranch_scc1 LA_t73
v_mfma_f32_16x16x32_bf16 v[200:203], a[96:99], a[64:67], v[56:59]
s_waitcnt vmcnt(63) lgkmcnt(0)
s_barrier
v_mfma_f32_16x16x32_bf16 v[200:203], a[100:103], a[68:71], v[200:203]
s_add_u32 s12, s12, 16384
v_exp_f32 v226, v226
v_mfma_f32_16x16x32_bf16 v[200:203], a[104:107], a[72:75], v[200:203]
s_and_b32 s12, s12, 0xffff
s_add_u32 s11, s11, 16384
s_add_u32 m0, s5, s6
v_mfma_f32_16x16x32_bf16 v[200:203], a[108:111], a[76:79], v[200:203]
s_and_b32 s11, s11, 0xffff
v_exp_f32 v227, v227
v_mfma_f32_16x16x32_bf16 v[204:207], a[108:111], a[92:95], v[60:63]
ds_read_b128 a[128:131], v2 offset:0
v_cvt_pk_bf16_f32 v67, v226, v227
v_mfma_f32_16x16x32_bf16 v[204:207], a[104:107], a[88:91], v[204:207]
v_exp_f32 v228, v228
v_mfma_f32_16x16x32_bf16 v[204:207], a[100:103], a[84:87], v[204:207]
buffer_load_dwordx4 v0, s[20:23], s4 offen offset:0 sc1 lds
v_mfma_f32_16x16x32_bf16 v[204:207], a[96:99], a[80:83], v[204:207]
v_exp_f32 v229, v229
v_mfma_f32_16x16x32_bf16 v[208:211], a[96:99], a[32:35], v[48:51]
ds_read_b128 a[132:135], v2 offset:1024
v_cvt_pk_bf16_f32 v70, v228, v229
v_mfma_f32_16x16x32_bf16 v[208:211], a[100:103], a[36:39], v[208:211]
v_exp_f32 v230, v230
v_mfma_f32_16x16x32_bf16 v[208:211], a[104:107], a[40:43], v[208:211]
buffer_load_dwordx4 v0, s[20:23], s4 offen offset:1024 sc1 lds
v_mfma_f32_16x16x32_bf16 v[208:211], a[108:111], a[44:47], v[208:211]
v_exp_f32 v231, v231
v_mfma_f32_16x16x32_bf16 v[212:215], a[108:111], a[60:63], v[52:55]
ds_read_b128 a[136:139], v2 offset:2048
v_cvt_pk_bf16_f32 v71, v230, v231
v_mfma_f32_16x16x32_bf16 v[212:215], a[104:107], a[56:59], v[212:215]
v_exp_f32 v200, v200
v_mfma_f32_16x16x32_bf16 v[212:215], a[100:103], a[52:55], v[212:215]
buffer_load_dwordx4 v0, s[20:23], s4 offen offset:2048 sc1 lds
v_mfma_f32_16x16x32_bf16 v[212:215], a[96:99], a[48:51], v[212:215]
v_exp_f32 v201, v201
v_mfma_f32_16x16x32_bf16 v[216:219], a[112:115], a[64:67], v[56:59]
ds_read_b128 a[140:143], v2 offset:3072
v_cvt_pk_bf16_f32 v232, v200, v201
v_mfma_f32_16x16x32_bf16 v[216:219], a[116:119], a[68:71], v[216:219]
v_exp_f32 v202, v202
v_mfma_f32_16x16x32_bf16 v[216:219], a[120:123], a[72:75], v[216:219]
ds_read_b128 a[96:99], v1 offset:16384
buffer_load_dwordx4 v0, s[20:23], s4 offen offset:3072 sc1 lds
v_mfma_f32_16x16x32_bf16 v[216:219], a[124:127], a[76:79], v[216:219]
s_add_u32 s4, s4, 16384
v_exp_f32 v203, v203
v_mfma_f32_16x16x32_bf16 v[220:223], a[124:127], a[92:95], v[60:63]
s_add_u32 s5, s5, 8192
ds_read_b128 a[144:147], v2 offset:4096
v_cvt_pk_bf16_f32 v233, v202, v203
v_mfma_f32_16x16x32_bf16 v[220:223], a[120:123], a[88:91], v[220:223]
s_and_b32 s5, s5, 0xffff
v_exp_f32 v204, v204
v_mfma_f32_16x16x32_bf16 v[220:223], a[116:119], a[84:87], v[220:223]
s_lshl_b32 s74, s82, 15
s_add_u32 s75, s74, 106496
ds_read_b128 a[100:103], v1 offset:17408
v_mfma_f32_16x16x32_bf16 v[220:223], a[112:115], a[80:83], v[220:223]
s_and_b32 s75, s75, 0xffff
v_exp_f32 v205, v205
v_mfma_f32_16x16x32_bf16 v[224:227], a[112:115], a[32:35], v[48:51]
s_add_u32 m0, s75, 22528
ds_read_b128 a[148:151], v2 offset:5120
v_cvt_pk_bf16_f32 v236, v204, v205
v_mfma_f32_16x16x32_bf16 v[224:227], a[116:119], a[36:39], v[224:227]
s_lshl_b32 s74, s74, 1
v_exp_f32 v206, v206
v_mfma_f32_16x16x32_bf16 v[224:227], a[120:123], a[40:43], v[224:227]
s_add_u32 s74, s74, 219136
ds_read_b128 a[104:107], v1 offset:18432
v_mfma_f32_16x16x32_bf16 v[224:227], a[124:127], a[44:47], v[224:227]
v_exp_f32 v207, v207
v_mfma_f32_16x16x32_bf16 v[228:231], a[124:127], a[60:63], v[52:55]
ds_read_b128 a[152:155], v2 offset:6144
v_cvt_pk_bf16_f32 v237, v206, v207
v_mfma_f32_16x16x32_bf16 v[228:231], a[120:123], a[56:59], v[228:231]
v_exp_f32 v208, v208
v_mfma_f32_16x16x32_bf16 v[228:231], a[116:119], a[52:55], v[228:231]
ds_read_b128 a[108:111], v1 offset:19456
buffer_load_dwordx4 v0, s[20:23], s74 offen offset:0 sc1 lds
v_mfma_f32_16x16x32_bf16 v[228:231], a[112:115], a[48:51], v[228:231]
s_waitcnt lgkmcnt(10)
v_exp_f32 v209, v209
v_mfma_f32_16x16x32_bf16 v[136:139], a[128:131], v[64:67], v[136:139]
ds_read_b128 a[156:159], v2 offset:7168
v_cvt_pk_bf16_f32 v240, v208, v209
v_mfma_f32_16x16x32_bf16 v[168:171], a[128:131], v[68:71], v[168:171]
s_waitcnt lgkmcnt(10)
v_exp_f32 v210, v210
v_mfma_f32_16x16x32_bf16 v[172:175], a[132:135], v[68:71], v[172:175]
ds_read_b128 a[112:115], v1 offset:20480
buffer_load_dwordx4 v0, s[20:23], s74 offen offset:1024 sc1 lds
v_mfma_f32_16x16x32_bf16 v[140:143], a[132:135], v[64:67], v[140:143]
s_waitcnt lgkmcnt(10)
s_lshl_b32 s13, s82, 1
v_exp_f32 v211, v211
v_mfma_f32_16x16x32_bf16 v[144:147], a[136:139], v[64:67], v[144:147]
s_sub_u32 s13, 12, s13
v_cvt_pk_bf16_f32 v241, v210, v211
v_add_u32 v2, s12, v3
v_mfma_f32_16x16x32_bf16 v[176:179], a[136:139], v[68:71], v[176:179]
s_waitcnt lgkmcnt(9)
s_lshr_b32 s19, s80, 1
v_exp_f32 v212, v212
v_mfma_f32_16x16x32_bf16 v[180:183], a[140:143], v[68:71], v[180:183]
s_lshl1_add_u32 s18, s85, s19
s_lshl_b32 s18, s18, 9
ds_read_b128 a[116:119], v1 offset:21504
v_mfma_f32_16x16x32_bf16 v[148:151], a[140:143], v[64:67], v[148:151]
s_waitcnt lgkmcnt(8)
s_add_u32 s18, s18, s84
v_exp_f32 v213, v213
v_mfma_f32_16x16x32_bf16 v[152:155], a[144:147], v[64:67], v[152:155]
s_lshl_b32 s18, s18, 7
ds_read_b128 a[120:123], v1 offset:22528
v_cvt_pk_bf16_f32 v244, v212, v213
v_mfma_f32_16x16x32_bf16 v[184:187], a[144:147], v[68:71], v[184:187]
s_waitcnt lgkmcnt(7)
s_lshl_b32 s19, s19, 13
v_exp_f32 v214, v214
v_mfma_f32_16x16x32_bf16 v[188:191], a[148:151], v[68:71], v[188:191]
s_mul_i32 s34, s3, 147456
s_add_u32 s19, s19, s34
s_add_u32 m0, s19, 0
v_mfma_f32_16x16x32_bf16 v[156:159], a[148:151], v[64:67], v[156:159]
s_waitcnt lgkmcnt(5)
v_exp_f32 v215, v215
v_mfma_f32_16x16x32_bf16 v[160:163], a[152:155], v[64:67], v[160:163]
ds_read_b128 a[124:127], v1 offset:23552
v_cvt_pk_bf16_f32 v245, v214, v215
v_mfma_f32_16x16x32_bf16 v[192:195], a[152:155], v[68:71], v[192:195]
s_waitcnt lgkmcnt(4)
v_exp_f32 v216, v216
v_mfma_f32_16x16x32_bf16 v[196:199], a[156:159], v[68:71], v[196:199]
buffer_load_dwordx4 v38, s[52:55], s18 offen offset:0 lds
v_mfma_f32_16x16x32_bf16 v[164:167], a[156:159], v[64:67], v[164:167]
s_add_u32 m0, s19, 960
v_exp_f32 v217, v217
v_mfma_f32_16x16x32_bf16 a[168:171], a[184:187], v[64:67], a[168:171]
v_cvt_pk_bf16_f32 v234, v216, v217
v_add_u32 v1, s11, v0
v_mfma_f32_16x16x32_bf16 a[172:175], a[184:187], v[68:71], a[172:175]
v_exp_f32 v218, v218
v_exp_f32 v219, v219
s_nop 0
v_cvt_pk_bf16_f32 v235, v218, v219
v_exp_f32 v220, v220
v_exp_f32 v221, v221
s_nop 0
v_cvt_pk_bf16_f32 v238, v220, v221
v_exp_f32 v222, v222
v_exp_f32 v223, v223
s_nop 0
v_cvt_pk_bf16_f32 v239, v222, v223
buffer_load_dwordx4 v38, s[52:55], s18 offen offset:64 lds
s_add_u32 s18, s18, 16384
s_add_u32 m0, s19, 2048
s_nop 0
buffer_load_dwordx4 v38, s[52:55], s18 offen offset:0 lds
s_add_u32 m0, s19, 3008
s_nop 0
buffer_load_dwordx4 v38, s[52:55], s18 offen offset:64 lds
s_add_u32 s18, s18, 16384
s_branch LA_l2p
LA_p23_s:
s_sleep 2
v_bfe_u32 v20, v0, 2, 7
buffer_load_dword v20, v20, s[76:79], s40 offen offset:0 sc1
s_waitcnt vmcnt(0)
v_cmp_lt_u32 s[32:33], 0, v20
s_nop 0
s_andn2_b32 s33, 16776960, s32
s_cbranch_scc1 LA_p23_s
s_branch LA_p23
LA_p43_s:
s_sleep 2
v_bfe_u32 v22, v0, 2, 7
buffer_load_dword v22, v22, s[76:79], s41 offen offset:0 sc1
s_waitcnt vmcnt(0)
v_cmp_lt_u32 s[32:33], 0, v22
s_nop 0
s_andn2_b32 s33, 255, s32
s_cbranch_scc1 LA_p43_s
s_branch LA_p43
LA_t73:
v_mfma_f32_32x32x16_bf16 a[0:15], a[224:227], a[224:227], 0
v_mfma_f32_32x32x16_bf16 a[16:31], a[224:227], a[224:227], 0
v_mfma_f32_16x16x32_bf16 v[204:207], a[96:99], a[80:83], v[60:63]
s_waitcnt vmcnt(63) lgkmcnt(0)
s_barrier
v_mfma_f32_16x16x32_bf16 v[204:207], a[100:103], a[84:87], v[204:207]
s_add_u32 s12, s12, 16384
v_exp_f32 v226, v226
v_mfma_f32_16x16x32_bf16 v[204:207], a[104:107], a[88:91], v[204:207]
s_and_b32 s12, s12, 0xffff
s_add_u32 s11, s11, 8192
s_lshr_b32 s19, s80, 1
v_mfma_f32_16x16x32_bf16 v[204:207], a[108:111], a[92:95], v[204:207]
s_and_b32 s11, s11, 0xffff
v_exp_f32 v227, v227
v_mfma_f32_16x16x32_bf16 v[208:211], a[108:111], a[44:47], v[48:51]
s_lshl1_add_u32 s18, s85, s19
ds_read_b128 a[128:131], v2 offset:0
v_cvt_pk_bf16_f32 v67, v226, v227
v_mfma_f32_16x16x32_bf16 v[208:211], a[104:107], a[40:43], v[208:211]
s_lshl_b32 s18, s18, 9
v_exp_f32 v228, v228
v_mfma_f32_16x16x32_bf16 v[208:211], a[100:103], a[36:39], v[208:211]
s_add_u32 s18, s18, s84
s_lshl_b32 s18, s18, 7
s_lshl_b32 s19, s19, 13
v_mfma_f32_16x16x32_bf16 v[208:211], a[96:99], a[32:35], v[208:211]
s_mul_i32 s34, s3, 147456
v_exp_f32 v229, v229
v_mfma_f32_16x16x32_bf16 v[212:215], a[96:99], a[48:51], v[52:55]
s_add_u32 s19, s19, s34
ds_read_b128 a[132:135], v2 offset:1024
v_cvt_pk_bf16_f32 v70, v228, v229
v_mfma_f32_16x16x32_bf16 v[212:215], a[100:103], a[52:55], v[212:215]
s_add_u32 m0, s19, 0
v_exp_f32 v230, v230
v_mfma_f32_16x16x32_bf16 v[212:215], a[104:107], a[56:59], v[212:215]
ds_read_b128 a[96:99], v1 offset:16384
buffer_load_dwordx4 v38, s[52:55], s18 offen offset:0 lds
v_mfma_f32_16x16x32_bf16 v[212:215], a[108:111], a[60:63], v[212:215]
s_add_u32 m0, s19, 960
v_exp_f32 v231, v231
v_mfma_f32_16x16x32_bf16 v[220:223], a[112:115], a[80:83], v[60:63]
ds_read_b128 a[136:139], v2 offset:2048
v_cvt_pk_bf16_f32 v71, v230, v231
v_mfma_f32_16x16x32_bf16 v[220:223], a[116:119], a[84:87], v[220:223]
v_exp_f32 v204, v204
v_mfma_f32_16x16x32_bf16 v[220:223], a[120:123], a[88:91], v[220:223]
ds_read_b128 a[100:103], v1 offset:17408
buffer_load_dwordx4 v38, s[52:55], s18 offen offset:64 lds
v_mfma_f32_16x16x32_bf16 v[220:223], a[124:127], a[92:95], v[220:223]
s_add_u32 s18, s18, 16384
v_exp_f32 v205, v205
v_mfma_f32_16x16x32_bf16 v[224:227], a[124:127], a[44:47], v[48:51]
s_add_u32 m0, s19, 2048
ds_read_b128 a[140:143], v2 offset:3072
v_cvt_pk_bf16_f32 v236, v204, v205
v_mfma_f32_16x16x32_bf16 v[224:227], a[120:123], a[40:43], v[224:227]
v_exp_f32 v206, v206
v_mfma_f32_16x16x32_bf16 v[224:227], a[116:119], a[36:39], v[224:227]
ds_read_b128 a[104:107], v1 offset:18432
buffer_load_dwordx4 v38, s[52:55], s18 offen offset:0 lds
v_mfma_f32_16x16x32_bf16 v[224:227], a[112:115], a[32:35], v[224:227]
s_add_u32 m0, s19, 3008
v_exp_f32 v207, v207
v_mfma_f32_16x16x32_bf16 v[228:231], a[112:115], a[48:51], v[52:55]
ds_read_b128 a[144:147], v2 offset:4096
v_cvt_pk_bf16_f32 v237, v206, v207
v_mfma_f32_16x16x32_bf16 v[228:231], a[116:119], a[52:55], v[228:231]
v_exp_f32 v208, v208
v_mfma_f32_16x16x32_bf16 v[228:231], a[120:123], a[56:59], v[228:231]
ds_read_b128 a[108:111], v1 offset:19456
buffer_load_dwordx4 v38, s[52:55], s18 offen offset:64 lds
v_mfma_f32_16x16x32_bf16 v[228:231], a[124:127], a[60:63], v[228:231]
s_waitcnt lgkmcnt(8)
s_add_u32 s18, s18, 16384
v_exp_f32 v209, v209
v_mfma_f32_16x16x32_bf16 v[136:139], a[128:131], v[64:67], v[136:139]
ds_read_b128 a[148:151], v2 offset:5120
v_cvt_pk_bf16_f32 v240, v208, v209
v_bfe_u32 v20, v0, 2, 7
v_mfma_f32_16x16x32_bf16 v[168:171], a[128:131], v[68:71], v[168:171]
s_waitcnt lgkmcnt(8)
v_exp_f32 v210, v210
v_mfma_f32_16x16x32_bf16 v[172:175], a[132:135], v[68:71], v[172:175]
ds_read_b128 a[112:115], v1 offset:20480
buffer_load_dword v20, v20, s[76:79], s42 offen offset:128 sc1
v_mfma_f32_16x16x32_bf16 v[140:143], a[132:135], v[64:67], v[140:143]
s_waitcnt lgkmcnt(7)
s_add_u32 m0, s19, 4096
v_exp_f32 v211, v211
v_mfma_f32_16x16x32_bf16 v[144:147], a[136:139], v[64:67], v[144:147]
ds_read_b128 a[152:155], v2 offset:6144
v_cvt_pk_bf16_f32 v241, v210, v211
v_mfma_f32_16x16x32_bf16 v[176:179], a[136:139], v[68:71], v[176:179]
s_waitcnt lgkmcnt(6)
v_exp_f32 v212, v212
v_mfma_f32_16x16x32_bf16 v[180:183], a[140:143], v[68:71], v[180:183]
ds_read_b128 a[116:119], v1 offset:21504
buffer_load_dwordx4 v38, s[52:55], s18 offen offset:0 lds
v_mfma_f32_16x16x32_bf16 v[148:151], a[140:143], v[64:67], v[148:151]
s_waitcnt lgkmcnt(5)
s_add_u32 m0, s19, 5056
v_exp_f32 v213, v213
v_mfma_f32_16x16x32_bf16 v[152:155], a[144:147], v[64:67], v[152:155]
ds_read_b128 a[156:159], v2 offset:7168
v_cvt_pk_bf16_f32 v244, v212, v213
v_mfma_f32_16x16x32_bf16 v[184:187], a[144:147], v[68:71], v[184:187]
s_waitcnt lgkmcnt(4)
v_exp_f32 v214, v214
v_mfma_f32_16x16x32_bf16 v[188:191], a[148:151], v[68:71], v[188:191]
ds_read_b128 a[120:123], v1 offset:22528
buffer_load_dwordx4 v38, s[52:55], s18 offen offset:64 lds
v_mfma_f32_16x16x32_bf16 v[156:159], a[148:151], v[64:67], v[156:159]
s_waitcnt lgkmcnt(3)
s_add_u32 s18, s18, 16384
v_exp_f32 v215, v215
v_mfma_f32_16x16x32_bf16 v[160:163], a[152:155], v[64:67], v[160:163]
s_add_u32 m0, s19, 6144
v_cvt_pk_bf16_f32 v245, v214, v215
v_add_u32 v2, s12, v3
v_mfma_f32_16x16x32_bf16 v[192:195], a[152:155], v[68:71], v[192:195]
s_waitcnt lgkmcnt(1)
v_exp_f32 v220, v220
v_mfma_f32_16x16x32_bf16 v[196:199], a[156:159], v[68:71], v[196:199]
ds_read_b128 a[124:127], v1 offset:23552
buffer_load_dwordx4 v38, s[52:55], s18 offen offset:0 lds
v_mfma_f32_16x16x32_bf16 v[164:167], a[156:159], v[64:67], v[164:167]
s_add_u32 m0, s19, 7104
v_exp_f32 v221, v221
v_mfma_f32_16x16x32_bf16 a[168:171], a[184:187], v[64:67], a[168:171]
v_cvt_pk_bf16_f32 v238, v220, v221
v_add_u32 v1, s11, v0
v_mfma_f32_16x16x32_bf16 a[172:175], a[184:187], v[68:71], a[172:175]
v_exp_f32 v222, v222
v_exp_f32 v223, v223
s_nop 0
v_cvt_pk_bf16_f32 v239, v222, v223
v_exp_f32 v224, v224
v_exp_f32 v225, v225
s_nop 0
v_cvt_pk_bf16_f32 v242, v224, v225
v_and_b32 v242, v242, v18
buffer_load_dwordx4 v38, s[52:55], s18 offen offset:64 lds
s_add_u32 s18, s18, 16384
v_lshrrev_b32 v24, 6, v0
v_and_b32 v25, 7, v24
v_lshlrev_b32 v25, 5, v25
v_lshl_or_b32 v25, v24, 8, v25
v_bfe_u32 v24, v0, 4, 2
v_lshl_or_b32 v25, v24, 3, v25
v_add_u32 v17, s17, v25
v_and_b32 v24, 511, v0
v_lshrrev_b32 v25, 9, v0
v_mul_u32_u24 v25, 147456, v25
v_add_u32 v16, v24, v25
v_mov_b32 v31, s50
s_add_u32 s35, s84, 1
s_and_b32 s35, s35, 7
v_lshl_add_u32 v8, s35, 11, v16
s_add_u32 s35, s84, 2
s_and_b32 s35, s35, 7
v_lshl_add_u32 v9, s35, 11, v16
s_add_u32 s35, s84, 3
s_and_b32 s35, s35, 7
v_lshl_add_u32 v10, s35, 11, v16
s_add_u32 s35, s84, 4
s_and_b32 s35, s35, 7
v_lshl_add_u32 v11, s35, 11, v16
s_add_u32 s35, s84, 5
s_and_b32 s35, s35, 7
v_lshl_add_u32 v12, s35, 11, v16
s_add_u32 s35, s84, 6
s_and_b32 s35, s35, 7
v_lshl_add_u32 v13, s35, 11, v16
s_add_u32 s35, s84, 7
s_and_b32 s35, s35, 7
v_lshl_add_u32 v14, s35, 11, v16
s_add_u32 s35, s84, 8
s_and_b32 s35, s35, 7
v_lshl_add_u32 v15, s35, 11, v16
v_accvgpr_read_b32 v24, a160
v_accvgpr_read_b32 v25, a164
v_subrev_u32 v21, 0x30800000, v24
v_rcp_f32 v24, v24
s_nop 0
v_mul_f32 v24, v24, v4
v_subrev_u32 v22, 0x30800000, v25
v_max_u32 v21, v21, v22
v_rcp_f32 v25, v25
s_nop 0
v_mul_f32 v25, v25, v5
v_cmp_lt_u32 vcc, 0x23000000, v21
v_pk_mul_f32 v[72:73], v[72:73], v[24:25] op_sel:[0,0] op_sel_hi:[1,0]
v_pk_mul_f32 v[74:75], v[74:75], v[24:25] op_sel:[0,0] op_sel_hi:[1,0]
v_pk_mul_f32 v[76:77], v[76:77], v[24:25] op_sel:[0,0] op_sel_hi:[1,0]
v_pk_mul_f32 v[78:79], v[78:79], v[24:25] op_sel:[0,0] op_sel_hi:[1,0]
v_cvt_pk_bf16_f32 v72, v72, v73
v_cvt_pk_bf16_f32 v73, v74, v75
v_cvt_pk_bf16_f32 v74, v76, v77
v_cvt_pk_bf16_f32 v75, v78, v79
buffer_store_dwordx4 v[72:75], v0, s[76:79], s88 offen offset:0 sc1
v_pk_mul_f32 v[80:81], v[80:81], v[24:25] op_sel:[0,0] op_sel_hi:[1,0]
v_pk_mul_f32 v[82:83], v[82:83], v[24:25] op_sel:[0,0] op_sel_hi:[1,0]
v_pk_mul_f32 v[84:85], v[84:85], v[24:25] op_sel:[0,0] op_sel_hi:[1,0]
v_pk_mul_f32 v[86:87], v[86:87], v[24:25] op_sel:[0,0] op_sel_hi:[1,0]
v_cvt_pk_bf16_f32 v76, v80, v81
v_cvt_pk_bf16_f32 v77, v82, v83
v_cvt_pk_bf16_f32 v78, v84, v85
v_cvt_pk_bf16_f32 v79, v86, v87
buffer_store_dwordx4 v[76:79], v0, s[76:79], s88 offen offset:1024 sc1
v_pk_mul_f32 v[88:89], v[88:89], v[24:25] op_sel:[0,0] op_sel_hi:[1,0]
v_pk_mul_f32 v[90:91], v[90:91], v[24:25] op_sel:[0,0] op_sel_hi:[1,0]
v_pk_mul_f32 v[92:93], v[92:93], v[24:25] op_sel:[0,0] op_sel_hi:[1,0]
v_pk_mul_f32 v[94:95], v[94:95], v[24:25] op_sel:[0,0] op_sel_hi:[1,0]
v_cvt_pk_bf16_f32 v80, v88, v89
v_cvt_pk_bf16_f32 v81, v90, v91
v_cvt_pk_bf16_f32 v82, v92, v93
v_cvt_pk_bf16_f32 v83, v94, v95
buffer_store_dwordx4 v[80:83], v0, s[76:79], s88 offen offset:2048 sc1
v_pk_mul_f32 v[96:97], v[96:97], v[24:25] op_sel:[0,0] op_sel_hi:[1,0]
v_pk_mul_f32 v[98:99], v[98:99], v[24:25] op_sel:[0,0] op_sel_hi:[1,0]
v_pk_mul_f32 v[100:101], v[100:101], v[24:25] op_sel:[0,0] op_sel_hi:[1,0]
v_pk_mul_f32 v[102:103], v[102:103], v[24:25] op_sel:[0,0] op_sel_hi:[1,0]
v_cvt_pk_bf16_f32 v84, v96, v97
v_cvt_pk_bf16_f32 v85, v98, v99
v_cvt_pk_bf16_f32 v86, v100, v101
v_cvt_pk_bf16_f32 v87, v102, v103
buffer_store_dwordx4 v[84:87], v0, s[76:79], s88 offen offset:3072 sc1
v_pk_mul_f32 v[104:105], v[104:105], v[24:25] op_sel:[0,1] op_sel_hi:[1,1]
v_pk_mul_f32 v[106:107], v[106:107], v[24:25] op_sel:[0,1] op_sel_hi:[1,1]
v_pk_mul_f32 v[108:109], v[108:109], v[24:25] op_sel:[0,1] op_sel_hi:[1,1]
v_pk_mul_f32 v[110:111], v[110:111], v[24:25] op_sel:[0,1] op_sel_hi:[1,1]
v_cvt_pk_bf16_f32 v88, v104, v105
v_cvt_pk_bf16_f32 v89, v106, v107
v_cvt_pk_bf16_f32 v90, v108, v109
v_cvt_pk_bf16_f32 v91, v110, v111
buffer_store_dwordx4 v[88:91], v0, s[76:79], s89 offen offset:0 sc1
v_pk_mul_f32 v[112:113], v[112:113], v[24:25] op_sel:[0,1] op_sel_hi:[1,1]
v_pk_mul_f32 v[114:115], v[114:115], v[24:25] op_sel:[0,1] op_sel_hi:[1,1]
v_pk_mul_f32 v[116:117], v[116:117], v[24:25] op_sel:[0,1] op_sel_hi:[1,1]
v_pk_mul_f32 v[118:119], v[118:119], v[24:25] op_sel:[0,1] op_sel_hi:[1,1]
v_cvt_pk_bf16_f32 v92, v112, v113
v_cvt_pk_bf16_f32 v93, v114, v115
v_cvt_pk_bf16_f32 v94, v116, v117
v_cvt_pk_bf16_f32 v95, v118, v119
buffer_store_dwordx4 v[92:95], v0, s[76:79], s89 offen offset:1024 sc1
v_pk_mul_f32 v[120:121], v[120:121], v[24:25] op_sel:[0,1] op_sel_hi:[1,1]
v_pk_mul_f32 v[122:123], v[122:123], v[24:25] op_sel:[0,1] op_sel_hi:[1,1]
v_pk_mul_f32 v[124:125], v[124:125], v[24:25] op_sel:[0,1] op_sel_hi:[1,1]
v_pk_mul_f32 v[126:127], v[126:127], v[24:25] op_sel:[0,1] op_sel_hi:[1,1]
v_cvt_pk_bf16_f32 v96, v120, v121
v_cvt_pk_bf16_f32 v97, v122, v123
v_cvt_pk_bf16_f32 v98, v124, v125
v_cvt_pk_bf16_f32 v99, v126, v127
buffer_store_dwordx4 v[96:99], v0, s[76:79], s89 offen offset:2048 sc1
v_pk_mul_f32 v[128:129], v[128:129], v[24:25] op_sel:[0,1] op_sel_hi:[1,1]
v_pk_mul_f32 v[130:131], v[130:131], v[24:25] op_sel:[0,1] op_sel_hi:[1,1]
v_pk_mul_f32 v[132:133], v[132:133], v[24:25] op_sel:[0,1] op_sel_hi:[1,1]
v_pk_mul_f32 v[134:135], v[134:135], v[24:25] op_sel:[0,1] op_sel_hi:[1,1]
v_cvt_pk_bf16_f32 v100, v128, v129
v_cvt_pk_bf16_f32 v101, v130, v131
v_cvt_pk_bf16_f32 v102, v132, v133
v_cvt_pk_bf16_f32 v103, v134, v135
buffer_store_dwordx4 v[100:103], v0, s[76:79], s89 offen offset:3072 sc1
s_cmp_eq_u64 vcc, 0
s_cselect_b32 s87, 1, s16
LA_p53_r:
s_waitcnt vmcnt(12)
v_cmp_lt_u32 vcc, 0, v20
s_nop 0
s_and_b32 s74, vcc_lo, 65535
s_cmp_eq_u32 s74, 65535
s_cbranch_scc1 LA_p53
s_sleep 2
v_bfe_u32 v20, v0, 2, 7
buffer_load_dword v20, v20, s[76:79], s42 offen offset:128 sc1
s_waitcnt vmcnt(0)
s_branch LA_p53_r
LA_p53:
buffer_load_dwordx4 a[192:195], v0, s[76:79], s96 offen offset:0 sc1
buffer_load_dwordx4 a[196:199], v0, s[76:79], s97 offen offset:0 sc1
buffer_load_dwordx4 a[200:203], v0, s[76:79], s98 offen offset:0 sc1
buffer_load_dwordx4 a[204:207], v0, s[76:79], s99 offen offset:0 sc1
buffer_load_dwordx4 a[208:211], v0, s[76:79], s96 offen offset:1024 sc1
buffer_load_dwordx4 a[212:215], v0, s[76:79], s97 offen offset:1024 sc1
buffer_load_dwordx4 a[216:219], v0, s[76:79], s98 offen offset:1024 sc1
buffer_load_dwordx4 a[220:223], v0, s[76:79], s99 offen offset:1024 sc1
buffer_load_dwordx4 v[104:107], v0, s[76:79], s96 offen offset:2048 sc1
buffer_load_dwordx4 v[108:111], v0, s[76:79], s97 offen offset:2048 sc1
buffer_load_dwordx4 v[112:115], v0, s[76:79], s98 offen offset:2048 sc1
buffer_load_dwordx4 v[116:119], v0, s[76:79], s99 offen offset:2048 sc1
buffer_load_dwordx4 v[120:123], v0, s[76:79], s96 offen offset:3072 sc1
buffer_load_dwordx4 v[124:127], v0, s[76:79], s97 offen offset:3072 sc1
buffer_load_dwordx4 v[128:131], v0, s[76:79], s98 offen offset:3072 sc1
buffer_load_dwordx4 v[132:135], v0, s[76:79], s99 offen offset:3072 sc1
s_waitcnt vmcnt(24)
s_branch LA_d23
LA_d13:
s_waitcnt lgkmcnt(7)
v_mfma_f32_16x16x32_bf16 v[204:207], a[96:99], a[80:83], v[60:63]
s_waitcnt vmcnt(63) lgkmcnt(0)
s_barrier
v_mfma_f32_16x16x32_bf16 v[204:207], a[100:103], a[84:87], v[204:207]
s_add_u32 s12, s12, 16384
v_exp_f32 v226, v226
v_mfma_f32_16x16x32_bf16 v[204:207], a[104:107], a[88:91], v[204:207]
s_and_b32 s12, s12, 0xffff
s_add_u32 s11, s11, 8192
v_mfma_f32_16x16x32_bf16 v[204:207], a[108:111], a[92:95], v[204:207]
s_and_b32 s11, s11, 0xffff
v_exp_f32 v227, v227
v_mfma_f32_16x16x32_bf16 v[208:211], a[108:111], a[44:47], v[48:51]
ds_read_b128 a[128:131], v2 offset:0
v_cvt_pk_bf16_f32 v67, v226, v227
v_mfma_f32_16x16x32_bf16 v[208:211], a[104:107], a[40:43], v[208:211]
v_exp_f32 v228, v228
v_mfma_f32_16x16x32_bf16 v[208:211], a[100:103], a[36:39], v[208:211]
buffer_load_dwordx4 v[104:107], v0, s[76:79], s96 offen offset:2048 sc1
v_mfma_f32_16x16x32_bf16 v[208:211], a[96:99], a[32:35], v[208:211]
v_exp_f32 v229, v229
v_mfma_f32_16x16x32_bf16 v[212:215], a[96:99], a[48:51], v[52:55]
ds_read_b128 a[132:135], v2 offset:1024
v_cvt_pk_bf16_f32 v70, v228, v229
v_mfma_f32_16x16x32_bf16 v[212:215], a[100:103], a[52:55], v[212:215]
v_exp_f32 v230, v230
v_mfma_f32_16x16x32_bf16 v[212:215], a[104:107], a[56:59], v[212:215]
buffer_load_dwordx4 v[108:111], v0, s[76:79], s97 offen offset:2048 sc1
v_mfma_f32_16x16x32_bf16 v[212:215], a[108:111], a[60:63], v[212:215]
v_exp_f32 v231, v231
v_mfma_f32_16x16x32_bf16 v[220:223], a[112:115], a[80:83], v[60:63]
ds_read_b128 a[136:139], v2 offset:2048
v_cvt_pk_bf16_f32 v71, v230, v231
v_mfma_f32_16x16x32_bf16 v[220:223], a[116:119], a[84:87], v[220:223]
v_exp_f32 v204, v204
v_mfma_f32_16x16x32_bf16 v[220:223], a[120:123], a[88:91], v[220:223]
buffer_load_dwordx4 v[112:115], v0, s[76:79], s98 offen offset:2048 sc1
v_mfma_f32_16x16x32_bf16 v[220:223], a[124:127], a[92:95], v[220:223]
v_exp_f32 v205, v205
v_mfma_f32_16x16x32_bf16 v[224:227], a[124:127], a[44:47], v[48:51]
ds_read_b128 a[140:143], v2 offset:3072
v_cvt_pk_bf16_f32 v236, v204, v205
v_mfma_f32_16x16x32_bf16 v[224:227], a[120:123], a[40:43], v[224:227]
v_exp_f32 v206, v206
v_mfma_f32_16x16x32_bf16 v[224:227], a[116:119], a[36:39], v[224:227]
buffer_load_dwordx4 v[116:119], v0, s[76:79], s99 offen offset:2048 sc1
v_mfma_f32_16x16x32_bf16 v[224:227], a[112:115], a[32:35], v[224:227]
v_exp_f32 v207, v207
v_mfma_f32_16x16x32_bf16 v[228:231], a[112:115], a[48:51], v[52:55]
ds_read_b128 a[144:147], v2 offset:4096
v_cvt_pk_bf16_f32 v237, v206, v207
v_mfma_f32_16x16x32_bf16 v[228:231], a[116:119], a[52:55], v[228:231]
v_exp_f32 v208, v208
v_mfma_f32_16x16x32_bf16 v[228:231], a[120:123], a[56:59], v[228:231]
buffer_load_dwordx4 v[120:123], v0, s[76:79], s96 offen offset:3072 sc1
v_mfma_f32_16x16x32_bf16 v[228:231], a[124:127], a[60:63], v[228:231]
s_waitcnt lgkmcnt(4)
v_exp_f32 v209, v209
v_mfma_f32_16x16x32_bf16 a[0:3], a[128:131], v[248:251], a[0:3]
ds_read_b128 a[148:151], v2 offset:5120
v_cvt_pk_bf16_f32 v240, v208, v209
v_mfma_f32_16x16x32_bf16 a[224:227], a[128:131], v[252:255], a[224:227]
v_exp_f32 v210, v210
v_mfma_f32_16x16x32_bf16 v[136:139], a[128:131], v[64:67], v[136:139]
ds_read_b128 a[96:99], v1 offset:16384
buffer_load_dwordx4 v[124:127], v0, s[76:79], s97 offen offset:3072 sc1
v_mfma_f32_16x16x32_bf16 v[168:171], a[128:131], v[68:71], v[168:171]
s_waitcnt lgkmcnt(5)
v_exp_f32 v211, v211
v_mfma_f32_16x16x32_bf16 v[172:175], a[132:135], v[68:71], v[172:175]
ds_read_b128 a[152:155], v2 offset:6144
v_cvt_pk_bf16_f32 v241, v210, v211
v_mfma_f32_16x16x32_bf16 v[140:143], a[132:135], v[64:67], v[140:143]
v_exp_f32 v212, v212
v_mfma_f32_16x16x32_bf16 a[228:231], a[132:135], v[252:255], a[228:231]
ds_read_b128 a[100:103], v1 offset:17408
buffer_load_dwordx4 v[128:131], v0, s[76:79], s98 offen offset:3072 sc1
v_mfma_f32_16x16x32_bf16 a[4:7], a[132:135], v[248:251], a[4:7]
s_waitcnt lgkmcnt(6)
v_exp_f32 v213, v213
v_mfma_f32_16x16x32_bf16 a[8:11], a[136:139], v[248:251], a[8:11]
ds_read_b128 a[156:159], v2 offset:7168
v_cvt_pk_bf16_f32 v244, v212, v213
v_mfma_f32_16x16x32_bf16 a[232:235], a[136:139], v[252:255], a[232:235]
v_exp_f32 v214, v214
v_mfma_f32_16x16x32_bf16 v[144:147], a[136:139], v[64:67], v[144:147]
ds_read_b128 a[104:107], v1 offset:18432
buffer_load_dwordx4 v[132:135], v0, s[76:79], s99 offen offset:3072 sc1
v_mfma_f32_16x16x32_bf16 v[176:179], a[136:139], v[68:71], v[176:179]
s_waitcnt lgkmcnt(7)
v_exp_f32 v215, v215
v_mfma_f32_16x16x32_bf16 v[180:183], a[140:143], v[68:71], v[180:183]
v_cvt_pk_bf16_f32 v245, v214, v215
v_add_u32 v2, s12, v3
v_mfma_f32_16x16x32_bf16 v[148:151], a[140:143], v[64:67], v[148:151]
v_exp_f32 v220, v220
v_mfma_f32_16x16x32_bf16 a[236:239], a[140:143], v[252:255], a[236:239]
ds_read_b128 a[108:111], v1 offset:19456
v_mfma_f32_16x16x32_bf16 a[12:15], a[140:143], v[248:251], a[12:15]
s_waitcnt lgkmcnt(7)
v_exp_f32 v221, v221
v_mfma_f32_16x16x32_bf16 a[16:19], a[144:147], v[248:251], a[16:19]
ds_read_b128 a[112:115], v1 offset:20480
v_cvt_pk_bf16_f32 v238, v220, v221
v_mfma_f32_16x16x32_bf16 a[240:243], a[144:147], v[252:255], a[240:243]
v_exp_f32 v222, v222
v_mfma_f32_16x16x32_bf16 v[152:155], a[144:147], v[64:67], v[152:155]
v_mfma_f32_16x16x32_bf16 v[184:187], a[144:147], v[68:71], v[184:187]
s_waitcnt lgkmcnt(7)
v_exp_f32 v223, v223
v_mfma_f32_16x16x32_bf16 v[188:191], a[148:151], v[68:71], v[188:191]
ds_read_b128 a[116:119], v1 offset:21504
v_cvt_pk_bf16_f32 v239, v222, v223
v_mfma_f32_16x16x32_bf16 v[156:159], a[148:151], v[64:67], v[156:159]
v_exp_f32 v224, v224
v_mfma_f32_16x16x32_bf16 a[244:247], a[148:151], v[252:255], a[244:247]
v_mfma_f32_16x16x32_bf16 a[20:23], a[148:151], v[248:251], a[20:23]
s_waitcnt lgkmcnt(6)
v_exp_f32 v225, v225
v_mfma_f32_16x16x32_bf16 a[24:27], a[152:155], v[248:251], a[24:27]
v_cvt_pk_bf16_f32 v242, v224, v225
v_and_b32 v242, v242, v18
v_mfma_f32_16x16x32_bf16 a[248:251], a[152:155], v[252:255], a[248:251]
ds_read_b128 a[120:123], v1 offset:22528
v_mfma_f32_16x16x32_bf16 v[160:163], a[152:155], v[64:67], v[160:163]
v_mfma_f32_16x16x32_bf16 v[192:195], a[152:155], v[68:71], v[192:195]
s_waitcnt lgkmcnt(5)
ds_read_b128 a[124:127], v1 offset:23552
v_mfma_f32_16x16x32_bf16 v[196:199], a[156:159], v[68:71], v[196:199]
v_add_u32 v1, s11, v0
v_mfma_f32_16x16x32_bf16 v[164:167], a[156:159], v[64:67], v[164:167]
v_mfma_f32_16x16x32_bf16 a[252:255], a[156:159], v[252:255], a[252:255]
v_mfma_f32_16x16x32_bf16 a[28:31], a[156:159], v[248:251], a[28:31]
v_mfma_f32_16x16x32_bf16 a[176:179], a[184:187], v[248:251], a[176:179]
v_mfma_f32_16x16x32_bf16 a[180:183], a[184:187], v[252:255], a[180:183]
v_mfma_f32_16x16x32_bf16 a[168:171], a[184:187], v[64:67], a[168:171]
v_mfma_f32_16x16x32_bf16 a[172:175], a[184:187], v[68:71], a[172:175]
s_waitcnt vmcnt(19)
LA_d23:
s_add_u32 s12, s12, s14
s_and_b32 s12, s12, 0xffff
v_add_u32 v1, s12, v3
v_mfma_f32_16x16x32_bf16 v[204:207], a[96:99], a[80:83], v[60:63]
s_waitcnt lgkmcnt(0)
s_barrier
v_mfma_f32_16x16x32_bf16 v[204:207], a[100:103], a[84:87], v[204:207]
s_add_u32 s18, s85, 0
v_exp_f32 v226, v226
v_mfma_f32_16x16x32_bf16 v[204:207], a[104:107], a[88:91], v[204:207]
s_and_b32 s18, s18, 3
s_lshl_b32 s18, s18, 17
ds_read_b128 a[128:131], v2 offset:0
v_mfma_f32_16x16x32_bf16 v[204:207], a[108:111], a[92:95], v[204:207]
s_lshl_b32 s19, s80, 11
v_exp_f32 v227, v227
v_mfma_f32_16x16x32_bf16 v[212:215], a[108:111], a[60:63], v[52:55]
s_add_u32 s19, s19, s17
v_cvt_pk_bf16_f32 v243, v226, v227
v_and_b32 v243, v243, v19
v_mfma_f32_16x16x32_bf16 v[212:215], a[104:107], a[56:59], v[212:215]
s_add_u32 m0, s19, 0
v_exp_f32 v228, v228
v_mfma_f32_16x16x32_bf16 v[212:215], a[100:103], a[52:55], v[212:215]
ds_read_b128 a[132:135], v2 offset:1024
buffer_load_dwordx4 v36, s[28:31], s18 offen offset:0 lds
v_mfma_f32_16x16x32_bf16 v[212:215], a[96:99], a[48:51], v[212:215]
v_exp_f32 v229, v229
v_mfma_f32_16x16x32_bf16 v[220:223], a[112:115], a[80:83], v[60:63]
ds_read_b128 a[136:139], v2 offset:2048
v_cvt_pk_bf16_f32 v246, v228, v229
v_mfma_f32_16x16x32_bf16 v[220:223], a[116:119], a[84:87], v[220:223]
v_exp_f32 v230, v230
v_mfma_f32_16x16x32_bf16 v[220:223], a[120:123], a[88:91], v[220:223]
ds_read_b128 a[140:143], v2 offset:3072
ds_read_b128 a[144:147], v2 offset:4096
v_mfma_f32_16x16x32_bf16 v[220:223], a[124:127], a[92:95], v[220:223]
s_waitcnt lgkmcnt(4)
v_exp_f32 v231, v231
v_mfma_f32_16x16x32_bf16 a[224:227], a[128:131], v[236:239], a[224:227]
s_waitcnt lgkmcnt(3)
ds_read_b128 a[148:151], v2 offset:5120
ds_read_b128 a[152:155], v2 offset:6144
v_cvt_pk_bf16_f32 v247, v230, v231
v_mfma_f32_16x16x32_bf16 a[228:231], a[132:135], v[236:239], a[228:231]
s_waitcnt lgkmcnt(4)
v_exp_f32 v204, v204
v_mfma_f32_16x16x32_bf16 a[232:235], a[136:139], v[236:239], a[232:235]
s_waitcnt lgkmcnt(3)
ds_read_b128 a[156:159], v2 offset:7168
buffer_load_dwordx4 v37, s[28:31], s18 offen offset:1024 lds
v_mfma_f32_16x16x32_bf16 a[236:239], a[140:143], v[236:239], a[236:239]
s_waitcnt lgkmcnt(3)
s_add_u32 m0, s19, 8192
v_exp_f32 v205, v205
v_mfma_f32_16x16x32_bf16 a[240:243], a[144:147], v[236:239], a[240:243]
s_waitcnt lgkmcnt(2)
s_add_u32 s18, s18, 32768
v_cvt_pk_bf16_f32 v252, v204, v205
v_mfma_f32_16x16x32_bf16 a[244:247], a[148:151], v[236:239], a[244:247]
s_waitcnt lgkmcnt(1)
v_exp_f32 v206, v206
v_mfma_f32_16x16x32_bf16 a[248:251], a[152:155], v[236:239], a[248:251]
s_waitcnt lgkmcnt(0)
ds_write_b128 v26, a[0:3] offset:16384
v_mfma_f32_16x16x32_bf16 a[252:255], a[156:159], v[236:239], a[252:255]
v_exp_f32 v207, v207
v_mfma_f32_16x16x32_bf16 v[136:139], a[128:131], v[240:243], v[136:139]
buffer_load_dwordx4 v36, s[28:31], s18 offen offset:0 lds
v_cvt_pk_bf16_f32 v253, v206, v207
v_mfma_f32_16x16x32_bf16 v[168:171], a[128:131], v[244:247], v[168:171]
v_exp_f32 v212, v212
v_mfma_f32_16x16x32_bf16 v[172:175], a[132:135], v[244:247], v[172:175]
ds_read_b128 a[128:131], v1 offset:0
v_mfma_f32_16x16x32_bf16 v[140:143], a[132:135], v[240:243], v[140:143]
v_exp_f32 v213, v213
v_mfma_f32_16x16x32_bf16 v[144:147], a[136:139], v[240:243], v[144:147]
v_cvt_pk_bf16_f32 v68, v212, v213
v_and_b32 v68, v68, v18
v_mfma_f32_16x16x32_bf16 v[176:179], a[136:139], v[244:247], v[176:179]
v_exp_f32 v214, v214
v_mfma_f32_16x16x32_bf16 v[180:183], a[140:143], v[244:247], v[180:183]
ds_read_b128 a[132:135], v1 offset:1024
buffer_load_dwordx4 v37, s[28:31], s18 offen offset:1024 lds
v_mfma_f32_16x16x32_bf16 v[148:151], a[140:143], v[240:243], v[148:151]
s_add_u32 m0, s19, 16384
v_exp_f32 v215, v215
v_mfma_f32_16x16x32_bf16 v[152:155], a[144:147], v[240:243], v[152:155]
s_add_u32 s18, s18, 32768
v_cvt_pk_bf16_f32 v69, v214, v215
v_and_b32 v69, v69, v19
v_mfma_f32_16x16x32_bf16 v[184:187], a[144:147], v[244:247], v[184:187]
v_exp_f32 v220, v220
v_mfma_f32_16x16x32_bf16 v[188:191], a[148:151], v[244:247], v[188:191]
ds_read_b128 a[136:139], v1 offset:2048
buffer_load_dwordx4 v36, s[28:31], s18 offen offset:0 lds
v_mfma_f32_16x16x32_bf16 v[156:159], a[148:151], v[240:243], v[156:159]
v_exp_f32 v221, v221
v_mfma_f32_16x16x32_bf16 v[160:163], a[152:155], v[240:243], v[160:163]
ds_read_b128 a[140:143], v1 offset:3072
v_cvt_pk_bf16_f32 v254, v220, v221
v_mfma_f32_16x16x32_bf16 v[192:195], a[152:155], v[244:247], v[192:195]
v_exp_f32 v222, v222
v_mfma_f32_16x16x32_bf16 v[196:199], a[156:159], v[244:247], v[196:199]
ds_write_b128 v26, a[4:7] offset:17408
v_mfma_f32_16x16x32_bf16 v[164:167], a[156:159], v[240:243], v[164:167]
v_exp_f32 v223, v223
v_mfma_f32_16x16x32_bf16 a[180:183], a[184:187], v[236:239], a[180:183]
ds_read_b128 a[144:147], v1 offset:4096
v_cvt_pk_bf16_f32 v255, v222, v223
v_mfma_f32_16x16x32_bf16 a[168:171], a[184:187], v[240:243], a[168:171]
v_mov_b32 v70, 0
v_mov_b32 v71, 0
v_mfma_f32_16x16x32_bf16 a[172:175], a[184:187], v[244:247], a[172:175]
ds_read_b128 a[148:151], v1 offset:5120
ds_read_b128 a[152:155], v1 offset:6144
ds_read_b128 a[156:159], v1 offset:7168
ds_write_b128 v26, a[8:11] offset:18432
ds_write_b128 v26, a[12:15] offset:19456
ds_write_b128 v26, a[16:19] offset:20480
ds_write_b128 v26, a[20:23] offset:21504
ds_write_b128 v26, a[24:27] offset:22528
ds_write_b128 v26, a[28:31] offset:23552
buffer_load_dwordx4 v37, s[28:31], s18 offen offset:1024 lds
s_add_u32 m0, s19, 24576
s_add_u32 s18, s18, 32768
buffer_load_dwordx4 v36, s[28:31], s18 offen offset:0 lds
buffer_load_dwordx4 v37, s[28:31], s18 offen offset:1024 lds
s_cmp_eq_u32 s82, 7
s_cbranch_scc0 LA_e3
s_waitcnt vmcnt(24)
s_mov_b32 exec_lo, s87
s_mov_b32 exec_hi, 0
buffer_store_dword v3, off, s[76:79], s43 offset:16 sc1
s_mov_b64 exec, -1
buffer_load_dword v38, v30, s[76:79], s88 offen sc1
buffer_load_dword v38, v30, s[76:79], s89 offen sc1
LA_e3:
s_waitcnt lgkmcnt(14)
v_mfma_f32_16x16x32_bf16 a[224:227], a[128:131], v[252:255], a[224:227]
s_waitcnt lgkmcnt(0)
s_barrier
v_mfma_f32_16x16x32_bf16 a[228:231], a[132:135], v[252:255], a[228:231]
s_add_u32 s18, s85, 1
s_and_b32 s18, s18, 3
s_lshl_b32 s18, s18, 17
v_mfma_f32_16x16x32_bf16 a[232:235], a[136:139], v[252:255], a[232:235]
s_lshl_b32 s19, s80, 11
s_add_u32 s19, s19, s50
s_add_u32 m0, s19, 0
v_mfma_f32_16x16x32_bf16 a[236:239], a[140:143], v[252:255], a[236:239]
buffer_load_dwordx4 v36, s[28:31], s18 offen offset:0 lds
v_mfma_f32_16x16x32_bf16 a[240:243], a[144:147], v[252:255], a[240:243]
ds_write_b128 v26, a[224:227] offset:24576
v_mfma_f32_16x16x32_bf16 a[244:247], a[148:151], v[252:255], a[244:247]
ds_write_b128 v26, a[228:231] offset:25600
v_mfma_f32_16x16x32_bf16 a[248:251], a[152:155], v[252:255], a[248:251]
ds_write_b128 v26, a[232:235] offset:26624
v_mfma_f32_16x16x32_bf16 a[252:255], a[156:159], v[252:255], a[252:255]
ds_write_b128 v26, a[236:239] offset:27648
v_mfma_f32_16x16x32_bf16 v[168:171], a[128:131], v[68:71], v[168:171]
ds_write_b128 v26, a[240:243] offset:28672
v_mfma_f32_16x16x32_bf16 v[172:175], a[132:135], v[68:71], v[172:175]
ds_write_b128 v26, a[244:247] offset:29696
v_mfma_f32_16x16x32_bf16 v[176:179], a[136:139], v[68:71], v[176:179]
ds_write_b128 v26, a[248:251] offset:30720
v_mfma_f32_16x16x32_bf16 v[180:183], a[140:143], v[68:71], v[180:183]
ds_write_b128 v26, a[252:255] offset:31744
v_mfma_f32_16x16x32_bf16 v[184:187], a[144:147], v[68:71], v[184:187]
buffer_load_dwordx4 v37, s[28:31], s18 offen offset:1024 lds
v_mfma_f32_16x16x32_bf16 v[188:191], a[148:151], v[68:71], v[188:191]
s_add_u32 m0, s19, 8192
s_add_u32 s18, s18, 32768
s_lshl_b32 s34, s82, 3
v_mfma_f32_16x16x32_bf16 v[192:195], a[152:155], v[68:71], v[192:195]
buffer_load_dwordx4 v36, s[28:31], s18 offen offset:0 lds
v_mfma_f32_16x16x32_bf16 v[196:199], a[156:159], v[68:71], v[196:199]
s_add_u32 s8, s34, s80
s_sub_u32 s11, 127, s8
s_sub_u32 s9, s34, s80
v_mfma_f32_16x16x32_bf16 a[180:183], a[184:187], v[252:255], a[180:183]
buffer_load_dwordx4 v37, s[28:31], s18 offen offset:1024 lds
v_mfma_f32_16x16x32_bf16 a[172:175], a[184:187], v[68:71], a[172:175]
s_add_u32 m0, s19, 16384
s_add_u32 s18, s18, 32768
s_add_u32 s9, s9, 7
buffer_load_dwordx4 v36, s[28:31], s18 offen offset:0 lds
buffer_load_dwordx4 v37, s[28:31], s18 offen offset:1024 lds
s_sub_u32 s10, 127, s9
s_lshl3_add_u32 s12, s85, s84
s_lshl_b32 s12, s12, 5
s_lshl_b32 s8, s8, 14
s_add_u32 s8, s8, s12
s_lshl_b32 s9, s9, 14
s_add_u32 s9, s9, s12
s_lshl_b32 s10, s10, 14
s_add_u32 s10, s10, s12
s_lshl_b32 s11, s11, 14
s_add_u32 s11, s11, s12
v_bfe_u32 v25, v0, 4, 4
v_lshrrev_b32 v1, 8, v0
v_lshlrev_b32 v1, 3, v1
v_lshl_or_b32 v2, v25, 10, v1
LA_fin:
ds_read_b128 v[40:43], v8 offset:0
ds_read_b128 v[44:47], v8 offset:512
ds_read_b128 v[48:51], v9 offset:0
ds_write_b32 v28, a176 offset:24576
ds_write_b32 v28, a180 offset:24832
s_waitcnt vmcnt(32) lgkmcnt(3)
v_mfma_f32_16x16x32_bf16 a[96:99], v[40:43], a[192:195], 0
s_waitcnt vmcnt(28)
s_lshl_b32 s34, 1, s85
s_xor_b32 s34, s34, 15
ds_read_b128 v[52:55], v9 offset:512
v_mfma_f32_16x16x32_bf16 a[96:99], v[44:47], a[208:211], a[96:99]
s_lshl_b32 s35, s80, 3
s_lshl_b32 s13, s34, s35
s_lshl_b32 s14, s13, 4
v_mfma_f32_16x16x32_bf16 a[100:103], v[40:43], a[196:199], 0
s_waitcnt lgkmcnt(0)
s_barrier
s_waitcnt vmcnt(27)
v_mfma_f32_16x16x32_bf16 a[100:103], v[44:47], a[212:215], a[100:103]
ds_read_b32 v34, v29 offset:24576
ds_read_b32 v35, v29 offset:24832
v_mfma_f32_16x16x32_bf16 a[104:107], v[40:43], a[200:203], 0
s_waitcnt vmcnt(26)
ds_read_b128 v[56:59], v10 offset:0
v_mfma_f32_16x16x32_bf16 a[104:107], v[44:47], a[216:219], a[104:107]
ds_read_b128 v[200:203], v27 offset:16384
v_mfma_f32_16x16x32_bf16 a[108:111], v[40:43], a[204:207], 0
s_waitcnt vmcnt(25)
ds_read_b128 v[204:207], v27 offset:17408
buffer_load_dwordx2 a[248:249], v1, s[64:67], s12 offen
v_mfma_f32_16x16x32_bf16 a[108:111], v[44:47], a[220:223], a[108:111]
ds_read_b128 v[208:211], v27 offset:24576
v_accvgpr_read_b32 v24, a168
v_mfma_f32_16x16x32_bf16 a[112:115], v[48:51], a[192:195], 0
ds_read_b128 v[60:63], v10 offset:512
v_accvgpr_read_b32 v25, a172
v_lshl_add_u32 v1, s80, 2, v31
v_mfma_f32_16x16x32_bf16 a[112:115], v[52:55], a[208:211], a[112:115]
s_waitcnt lgkmcnt(6)
ds_read_b128 v[212:215], v27 offset:25600
v_add_f32 v24, v24, v34
v_mfma_f32_16x16x32_bf16 a[116:119], v[48:51], a[196:199], 0
s_waitcnt lgkmcnt(6)
buffer_load_dwordx2 a[240:241], v2, s[36:39], s8 offen
v_add_f32 v25, v25, v35
v_mfma_f32_16x16x32_bf16 a[116:119], v[52:55], a[212:215], a[116:119]
s_waitcnt lgkmcnt(4)
v_subrev_u32 v22, 0x30800000, v24
v_add_f32 v136, v136, v200
v_mfma_f32_16x16x32_bf16 a[120:123], v[48:51], a[200:203], 0
ds_read_b128 v[40:43], v11 offset:0
v_max_u32 v21, v21, v22
v_add_f32 v137, v137, v201
v_mfma_f32_16x16x32_bf16 a[120:123], v[52:55], a[216:219], a[120:123]
v_rcp_f32 v24, v24
v_add_f32 v138, v138, v202
v_mfma_f32_16x16x32_bf16 a[124:127], v[48:51], a[204:207], 0
buffer_load_dwordx2 a[242:243], v2, s[36:39], s9 offen
v_subrev_u32 v22, 0x30800000, v25
v_mfma_f32_16x16x32_bf16 a[124:127], v[52:55], a[220:223], a[124:127]
s_waitcnt lgkmcnt(2)
v_bfe_u32 v20, v0, 2, 7
v_max_u32 v21, v21, v22
v_mfma_f32_16x16x32_bf16 a[128:131], v[56:59], a[192:195], 0
ds_read_b128 v[44:47], v11 offset:512
v_rcp_f32 v25, v25
v_mfma_f32_16x16x32_bf16 a[128:131], v[60:63], a[208:211], a[128:131]
v_cmp_lt_u32 vcc, 0x23000000, v21
v_mul_f32 v24, v24, v6
v_mul_f32 v25, v25, v7
v_mfma_f32_16x16x32_bf16 a[132:135], v[56:59], a[196:199], 0
s_or_b32 s34, vcc_lo, vcc_hi
buffer_load_dwordx2 a[244:245], v2, s[36:39], s10 offen
v_mfma_f32_16x16x32_bf16 a[132:135], v[60:63], a[212:215], a[132:135]
v_mov_b32 v22, s34
v_add_f32 v139, v139, v203
v_mfma_f32_16x16x32_bf16 a[136:139], v[56:59], a[200:203], 0
ds_read_b128 v[48:51], v12 offset:0
ds_write_b32 v1, v22 offset:26624
v_mfma_f32_16x16x32_bf16 a[136:139], v[60:63], a[216:219], a[136:139]
v_add_f32 v140, v140, v204
v_add_f32 v141, v141, v205
v_add_f32 v142, v142, v206
v_mfma_f32_16x16x32_bf16 a[140:143], v[56:59], a[204:207], 0
s_waitcnt lgkmcnt(0)
s_barrier
v_mfma_f32_16x16x32_bf16 a[140:143], v[60:63], a[220:223], a[140:143]
ds_read_b128 v[32:35], v31 offset:26624
v_add_f32 v143, v143, v207
v_mfma_f32_16x16x32_bf16 a[144:147], v[40:43], a[192:195], 0
ds_read_b128 v[52:55], v12 offset:512
v_mul_f32 v136, v136, v24
v_mul_f32 v137, v137, v24
v_mfma_f32_16x16x32_bf16 a[144:147], v[44:47], a[208:211], a[144:147]
ds_read_b128 v[200:203], v27 offset:18432
v_mul_f32 v138, v138, v24
v_mul_f32 v139, v139, v24
v_mul_f32 v140, v140, v24
v_mul_f32 v141, v141, v24
v_mul_f32 v142, v142, v24
v_mul_f32 v143, v143, v24
v_cvt_pk_bf16_f32 v232, v136, v137
v_cvt_pk_bf16_f32 v233, v138, v139
v_cvt_pk_bf16_f32 v234, v140, v141
v_cvt_pk_bf16_f32 v235, v142, v143
v_mfma_f32_16x16x32_bf16 a[148:151], v[40:43], a[196:199], 0
ds_read_b128 v[204:207], v27 offset:19456
buffer_store_dwordx4 v[232:235], v0, s[76:79], s90 offen offset:0 sc1
v_mfma_f32_16x16x32_bf16 a[148:151], v[44:47], a[212:215], a[148:151]
v_add_f32 v168, v168, v208
v_add_f32 v169, v169, v209
v_mfma_f32_16x16x32_bf16 a[152:155], v[40:43], a[200:203], 0
ds_read_b128 v[56:59], v13 offset:0
v_add_f32 v170, v170, v210
v_add_f32 v171, v171, v211
v_mfma_f32_16x16x32_bf16 a[152:155], v[44:47], a[216:219], a[152:155]
v_add_f32 v172, v172, v212
v_add_f32 v173, v173, v213
v_add_f32 v174, v174, v214
v_mfma_f32_16x16x32_bf16 a[156:159], v[40:43], a[204:207], 0
buffer_load_dwordx2 a[246:247], v2, s[36:39], s11 offen
v_add_f32 v175, v175, v215
v_mfma_f32_16x16x32_bf16 a[156:159], v[44:47], a[220:223], a[156:159]
s_waitcnt lgkmcnt(3)
ds_read_b128 v[208:211], v27 offset:26624
v_mul_f32 v168, v168, v25
v_mfma_f32_16x16x32_bf16 a[0:3], v[48:51], a[192:195], 0
ds_read_b128 v[60:63], v13 offset:512
v_mul_f32 v169, v169, v25
v_mul_f32 v170, v170, v25
v_mfma_f32_16x16x32_bf16 a[0:3], v[52:55], a[208:211], a[0:3]
ds_read_b128 v[212:215], v27 offset:27648
v_mul_f32 v171, v171, v25
v_mul_f32 v172, v172, v25
v_mfma_f32_16x16x32_bf16 a[4:7], v[48:51], a[196:199], 0
v_or3_b32 v32, v32, v33, v34
v_or_b32 v32, v32, v35
s_nop 0
v_readfirstlane_b32 s34, v32
s_cmp_eq_u32 s16, 0
s_cselect_b32 s34, s34, 0
s_cmp_eq_u32 s34, 0
s_cbranch_scc0 LA_redo
v_mfma_f32_16x16x32_bf16 a[4:7], v[52:55], a[212:215], a[4:7]
s_add_u32 s35, s85, 1
s_and_b32 s35, s35, 3
v_mul_f32 v173, v173, v25
v_mfma_f32_16x16x32_bf16 a[8:11], v[48:51], a[200:203], 0
s_sub_u32 s35, s35, s85
s_lshl_b32 s35, s35, 12
ds_read_b128 v[40:43], v14 offset:0
v_mfma_f32_16x16x32_bf16 a[8:11], v[52:55], a[216:219], a[8:11]
s_add_u32 s4, s88, s35
s_add_u32 s5, s89, s35
s_add_u32 s6, s90, s35
v_mul_f32 v174, v174, v25
v_mul_f32 v175, v175, v25
v_cvt_pk_bf16_f32 v248, v168, v169
v_cvt_pk_bf16_f32 v249, v170, v171
v_cvt_pk_bf16_f32 v250, v172, v173
v_cvt_pk_bf16_f32 v251, v174, v175
v_mfma_f32_16x16x32_bf16 a[12:15], v[48:51], a[204:207], 0
s_add_u32 s7, s91, s35
buffer_store_dwordx4 v[248:251], v0, s[76:79], s91 offen offset:0 sc1
v_mfma_f32_16x16x32_bf16 a[12:15], v[52:55], a[220:223], a[12:15]
s_waitcnt lgkmcnt(2)
v_add_f32 v144, v144, v200
v_add_f32 v145, v145, v201
v_mfma_f32_16x16x32_bf16 a[16:19], v[56:59], a[192:195], 0
ds_read_b128 v[44:47], v14 offset:512
v_add_f32 v146, v146, v202
v_add_f32 v147, v147, v203
v_mfma_f32_16x16x32_bf16 a[16:19], v[60:63], a[208:211], a[16:19]
v_add_f32 v148, v148, v204
v_add_f32 v149, v149, v205
v_add_f32 v150, v150, v206
v_mfma_f32_16x16x32_bf16 a[20:23], v[56:59], a[196:199], 0
buffer_load_dword v20, v20, s[76:79], s42 offen offset:0 sc1
v_add_f32 v151, v151, v207
v_mfma_f32_16x16x32_bf16 a[20:23], v[60:63], a[212:215], a[20:23]
ds_read_b128 v[200:203], v27 offset:20480
v_mul_f32 v144, v144, v24
v_mfma_f32_16x16x32_bf16 a[24:27], v[56:59], a[200:203], 0
ds_read_b128 v[48:51], v15 offset:0
v_mul_f32 v145, v145, v24
v_mul_f32 v146, v146, v24
v_mfma_f32_16x16x32_bf16 a[24:27], v[60:63], a[216:219], a[24:27]
ds_read_b128 v[204:207], v27 offset:21504
v_mul_f32 v147, v147, v24
v_mul_f32 v148, v148, v24
v_mfma_f32_16x16x32_bf16 a[28:31], v[56:59], a[204:207], 0
v_mul_f32 v149, v149, v24
v_mul_f32 v150, v150, v24
v_mul_f32 v151, v151, v24
v_mfma_f32_16x16x32_bf16 a[28:31], v[60:63], a[220:223], a[28:31]
s_waitcnt lgkmcnt(3)
v_cvt_pk_bf16_f32 v236, v144, v145
v_cvt_pk_bf16_f32 v237, v146, v147
v_mfma_f32_16x16x32_bf16 a[224:227], v[40:43], a[192:195], 0
ds_read_b128 v[52:55], v15 offset:512
v_cvt_pk_bf16_f32 v238, v148, v149
v_cvt_pk_bf16_f32 v239, v150, v151
v_mfma_f32_16x16x32_bf16 a[224:227], v[44:47], a[208:211], a[224:227]
v_add_f32 v176, v176, v208
v_add_f32 v177, v177, v209
v_add_f32 v178, v178, v210
v_mfma_f32_16x16x32_bf16 a[228:231], v[40:43], a[196:199], 0
buffer_store_dwordx4 v[236:239], v0, s[76:79], s90 offen offset:1024 sc1
v_add_f32 v179, v179, v211
v_mfma_f32_16x16x32_bf16 a[228:231], v[44:47], a[212:215], a[228:231]
v_add_f32 v180, v180, v212
v_add_f32 v181, v181, v213
v_mfma_f32_16x16x32_bf16 a[232:235], v[40:43], a[200:203], 0
ds_read_b128 v[56:59], v8 offset:1024
v_add_f32 v182, v182, v214
v_add_f32 v183, v183, v215
v_mfma_f32_16x16x32_bf16 a[232:235], v[44:47], a[216:219], a[232:235]
ds_read_b128 v[208:211], v27 offset:28672
v_mul_f32 v176, v176, v25
v_mul_f32 v177, v177, v25
v_mfma_f32_16x16x32_bf16 a[236:239], v[40:43], a[204:207], 0
ds_read_b128 v[212:215], v27 offset:29696
v_mul_f32 v178, v178, v25
v_mul_f32 v179, v179, v25
v_mfma_f32_16x16x32_bf16 a[236:239], v[44:47], a[220:223], a[236:239]
s_waitcnt lgkmcnt(3)
v_mul_f32 v180, v180, v25
v_mul_f32 v181, v181, v25
v_mfma_f32_16x16x32_bf16 v[216:219], v[48:51], a[192:195], 0
ds_read_b128 v[60:63], v8 offset:1536
v_mul_f32 v182, v182, v25
v_mul_f32 v183, v183, v25
v_mfma_f32_16x16x32_bf16 v[216:219], v[52:55], a[208:211], v[216:219]
s_add_u32 s33, s84, 1
s_and_b32 s33, s33, 7
s_lshl_b32 s33, s33, 5
v_mfma_f32_16x16x32_bf16 v[220:223], v[48:51], a[196:199], 0
LG_p0_r:
s_waitcnt vmcnt(1)
v_cmp_lt_u32 vcc, 0, v20
s_nop 0
s_and_b32 s74, vcc_lo, s14
s_cmp_eq_u32 s74, s14
s_cbranch_scc1 LG_p0
s_sleep 2
v_bfe_u32 v20, v0, 2, 7
buffer_load_dword v20, v20, s[76:79], s42 offen offset:0 sc1
s_waitcnt vmcnt(0)
s_branch LG_p0_r
LG_p0:
v_mfma_f32_16x16x32_bf16 v[220:223], v[52:55], a[212:215], v[220:223]
v_xor_b32 v8, s33, v17
v_cvt_pk_bf16_f32 v252, v176, v177
v_mfma_f32_16x16x32_bf16 v[224:227], v[48:51], a[200:203], 0
ds_read_b128 v[40:43], v9 offset:1024
v_cvt_pk_bf16_f32 v253, v178, v179
v_cvt_pk_bf16_f32 v254, v180, v181
v_mfma_f32_16x16x32_bf16 v[224:227], v[52:55], a[216:219], v[224:227]
v_cvt_pk_bf16_f32 v255, v182, v183
v_add_f32 v152, v152, v200
v_add_f32 v153, v153, v201
v_mfma_f32_16x16x32_bf16 v[228:231], v[48:51], a[204:207], 0
buffer_store_dwordx4 v[252:255], v0, s[76:79], s91 offen offset:1024 sc1
v_add_f32 v154, v154, v202
v_mfma_f32_16x16x32_bf16 v[228:231], v[52:55], a[220:223], v[228:231]
s_waitcnt lgkmcnt(1)
v_add_f32 v155, v155, v203
v_add_f32 v156, v156, v204
v_mfma_f32_16x16x32_bf16 a[96:99], v[56:59], v[104:107], a[96:99]
ds_read_b128 v[44:47], v9 offset:1536
v_add_f32 v157, v157, v205
v_add_f32 v158, v158, v206
v_mfma_f32_16x16x32_bf16 a[96:99], v[60:63], v[120:123], a[96:99]
s_add_u32 s33, s84, 2
s_and_b32 s33, s33, 7
s_lshl_b32 s33, s33, 5
v_mfma_f32_16x16x32_bf16 a[100:103], v[60:63], v[124:127], a[100:103]
buffer_load_dwordx4 a[32:35], v0, s[76:79], s4 offen offset:0 sc1
v_add_f32 v159, v159, v207
v_mfma_f32_16x16x32_bf16 a[100:103], v[56:59], v[108:111], a[100:103]
ds_read_b128 v[200:203], v27 offset:22528
v_xor_b32 v9, s33, v17
v_mfma_f32_16x16x32_bf16 a[104:107], v[56:59], v[112:115], a[104:107]
ds_read_b128 v[48:51], v10 offset:1024
v_mul_f32 v152, v152, v24
v_mul_f32 v153, v153, v24
v_mfma_f32_16x16x32_bf16 a[104:107], v[60:63], v[128:131], a[104:107]
ds_read_b128 v[204:207], v27 offset:23552
v_mul_f32 v154, v154, v24
v_mul_f32 v155, v155, v24
v_mfma_f32_16x16x32_bf16 a[108:111], v[60:63], v[132:135], a[108:111]
buffer_load_dwordx4 a[36:39], v0, s[76:79], s5 offen offset:0 sc1
v_mul_f32 v156, v156, v24
v_mfma_f32_16x16x32_bf16 a[108:111], v[56:59], v[116:119], a[108:111]
s_waitcnt lgkmcnt(3)
v_mul_f32 v157, v157, v24
v_mul_f32 v158, v158, v24
v_mfma_f32_16x16x32_bf16 a[112:115], v[40:43], v[104:107], a[112:115]
ds_read_b128 v[52:55], v10 offset:1536
v_mul_f32 v159, v159, v24
v_cvt_pk_bf16_f32 v240, v152, v153
v_mfma_f32_16x16x32_bf16 a[112:115], v[44:47], v[120:123], a[112:115]
s_add_u32 s33, s84, 3
s_and_b32 s33, s33, 7
s_lshl_b32 s33, s33, 5
v_cvt_pk_bf16_f32 v241, v154, v155
v_cvt_pk_bf16_f32 v242, v156, v157
v_cvt_pk_bf16_f32 v243, v158, v159
v_mfma_f32_16x16x32_bf16 a[116:119], v[44:47], v[124:127], a[116:119]
buffer_store_dwordx4 v[240:243], v0, s[76:79], s90 offen offset:2048 sc1
v_add_f32 v184, v184, v208
v_mfma_f32_16x16x32_bf16 a[116:119], v[40:43], v[108:111], a[116:119]
v_xor_b32 v10, s33, v17
v_add_f32 v185, v185, v209
v_mfma_f32_16x16x32_bf16 a[120:123], v[40:43], v[112:115], a[120:123]
ds_read_b128 v[60:63], v11 offset:1024
v_add_f32 v186, v186, v210
v_add_f32 v187, v187, v211
v_mfma_f32_16x16x32_bf16 a[120:123], v[44:47], v[128:131], a[120:123]
v_add_f32 v188, v188, v212
v_add_f32 v189, v189, v213
v_add_f32 v190, v190, v214
v_mfma_f32_16x16x32_bf16 a[124:127], v[44:47], v[132:135], a[124:127]
buffer_load_dwordx4 a[40:43], v0, s[76:79], s4 offen offset:1024 sc1
v_add_f32 v191, v191, v215
v_mfma_f32_16x16x32_bf16 a[124:127], v[40:43], v[116:119], a[124:127]
s_waitcnt lgkmcnt(1)
ds_read_b128 v[208:211], v27 offset:30720
v_mul_f32 v184, v184, v25
v_mfma_f32_16x16x32_bf16 a[128:131], v[48:51], v[104:107], a[128:131]
ds_read_b128 v[56:59], v11 offset:1536
v_mul_f32 v185, v185, v25
v_mul_f32 v186, v186, v25
v_mfma_f32_16x16x32_bf16 a[128:131], v[52:55], v[120:123], a[128:131]
s_add_u32 s33, s84, 4
s_and_b32 s33, s33, 7
s_lshl_b32 s33, s33, 5
v_mfma_f32_16x16x32_bf16 a[132:135], v[52:55], v[124:127], a[132:135]
ds_read_b128 v[212:215], v27 offset:31744
buffer_load_dwordx4 a[44:47], v0, s[76:79], s5 offen offset:1024 sc1
v_mfma_f32_16x16x32_bf16 a[132:135], v[48:51], v[108:111], a[132:135]
v_xor_b32 v11, s33, v17
v_mul_f32 v187, v187, v25
v_mfma_f32_16x16x32_bf16 a[136:139], v[48:51], v[112:115], a[136:139]
ds_read_b128 v[44:47], v12 offset:1024
v_mul_f32 v188, v188, v25
v_mul_f32 v189, v189, v25
v_mfma_f32_16x16x32_bf16 a[136:139], v[52:55], v[128:131], a[136:139]
v_mul_f32 v190, v190, v25
v_mul_f32 v191, v191, v25
v_cvt_pk_bf16_f32 v64, v184, v185
v_cvt_pk_bf16_f32 v65, v186, v187
v_cvt_pk_bf16_f32 v66, v188, v189
v_cvt_pk_bf16_f32 v67, v190, v191
v_mfma_f32_16x16x32_bf16 a[140:143], v[52:55], v[132:135], a[140:143]
buffer_store_dwordx4 v[64:67], v0, s[76:79], s91 offen offset:2048 sc1
v_add_f32 v160, v160, v200
v_mfma_f32_16x16x32_bf16 a[140:143], v[48:51], v[116:119], a[140:143]
s_waitcnt lgkmcnt(2)
v_add_f32 v161, v161, v201
v_add_f32 v162, v162, v202
v_mfma_f32_16x16x32_bf16 a[144:147], v[60:63], v[104:107], a[144:147]
ds_read_b128 v[40:43], v12 offset:1536
v_add_f32 v163, v163, v203
v_add_f32 v164, v164, v204
v_mfma_f32_16x16x32_bf16 a[144:147], v[56:59], v[120:123], a[144:147]
s_add_u32 s33, s84, 5
s_and_b32 s33, s33, 7
s_lshl_b32 s33, s33, 5
v_mfma_f32_16x16x32_bf16 a[148:151], v[56:59], v[124:127], a[148:151]
buffer_load_dwordx4 a[48:51], v0, s[76:79], s4 offen offset:2048 sc1
v_add_f32 v165, v165, v205
v_mfma_f32_16x16x32_bf16 a[148:151], v[60:63], v[108:111], a[148:151]
v_xor_b32 v12, s33, v17
v_add_f32 v166, v166, v206
v_mfma_f32_16x16x32_bf16 a[152:155], v[60:63], v[112:115], a[152:155]
ds_read_b128 v[52:55], v13 offset:1024
v_add_f32 v167, v167, v207
v_mul_f32 v160, v160, v24
v_mfma_f32_16x16x32_bf16 a[152:155], v[56:59], v[128:131], a[152:155]
v_mul_f32 v161, v161, v24
v_mul_f32 v162, v162, v24
v_mul_f32 v163, v163, v24
v_mfma_f32_16x16x32_bf16 a[156:159], v[56:59], v[132:135], a[156:159]
buffer_load_dwordx4 a[52:55], v0, s[76:79], s5 offen offset:2048 sc1
v_mul_f32 v164, v164, v24
v_mfma_f32_16x16x32_bf16 a[156:159], v[60:63], v[116:119], a[156:159]
s_waitcnt lgkmcnt(1)
v_mul_f32 v165, v165, v24
v_mul_f32 v166, v166, v24
v_mfma_f32_16x16x32_bf16 a[0:3], v[44:47], v[104:107], a[0:3]
ds_read_b128 v[48:51], v13 offset:1536
v_mul_f32 v167, v167, v24
v_cvt_pk_bf16_f32 v244, v160, v161
v_mfma_f32_16x16x32_bf16 a[0:3], v[40:43], v[120:123], a[0:3]
s_add_u32 s33, s84, 6
s_and_b32 s33, s33, 7
s_lshl_b32 s33, s33, 5
v_cvt_pk_bf16_f32 v245, v162, v163
v_cvt_pk_bf16_f32 v246, v164, v165
v_cvt_pk_bf16_f32 v247, v166, v167
v_mfma_f32_16x16x32_bf16 a[4:7], v[40:43], v[124:127], a[4:7]
buffer_store_dwordx4 v[244:247], v0, s[76:79], s90 offen offset:3072 sc1
v_add_f32 v192, v192, v208
v_mfma_f32_16x16x32_bf16 a[4:7], v[44:47], v[108:111], a[4:7]
v_xor_b32 v13, s33, v17
v_add_f32 v193, v193, v209
v_mfma_f32_16x16x32_bf16 a[8:11], v[44:47], v[112:115], a[8:11]
ds_read_b128 v[56:59], v14 offset:1024
v_add_f32 v194, v194, v210
v_add_f32 v195, v195, v211
v_mfma_f32_16x16x32_bf16 a[8:11], v[40:43], v[128:131], a[8:11]
v_add_f32 v196, v196, v212
v_add_f32 v197, v197, v213
v_add_f32 v198, v198, v214
v_mfma_f32_16x16x32_bf16 a[12:15], v[40:43], v[132:135], a[12:15]
buffer_load_dwordx4 a[56:59], v0, s[76:79], s4 offen offset:3072 sc1
v_add_f32 v199, v199, v215
v_mfma_f32_16x16x32_bf16 a[12:15], v[44:47], v[116:119], a[12:15]
s_waitcnt lgkmcnt(1)
v_mul_f32 v192, v192, v25
v_mul_f32 v193, v193, v25
v_mfma_f32_16x16x32_bf16 a[16:19], v[52:55], v[104:107], a[16:19]
ds_read_b128 v[60:63], v14 offset:1536
v_mul_f32 v194, v194, v25
v_mul_f32 v195, v195, v25
v_mfma_f32_16x16x32_bf16 a[16:19], v[48:51], v[120:123], a[16:19]
s_add_u32 s33, s84, 7
s_and_b32 s33, s33, 7
s_lshl_b32 s33, s33, 5
v_mfma_f32_16x16x32_bf16 a[20:23], v[48:51], v[124:127], a[20:23]
buffer_load_dwordx4 a[60:63], v0, s[76:79], s5 offen offset:3072 sc1
v_mul_f32 v196, v196, v25
v_mfma_f32_16x16x32_bf16 a[20:23], v[52:55], v[108:111], a[20:23]
v_xor_b32 v14, s33, v17
v_mul_f32 v197, v197, v25
v_mfma_f32_16x16x32_bf16 a[24:27], v[52:55], v[112:115], a[24:27]
ds_read_b128 v[40:43], v15 offset:1024
v_mul_f32 v198, v198, v25
v_mul_f32 v199, v199, v25
v_mfma_f32_16x16x32_bf16 a[24:27], v[48:51], v[128:131], a[24:27]
v_cvt_pk_bf16_f32 v68, v192, v193
v_cvt_pk_bf16_f32 v69, v194, v195
v_cvt_pk_bf16_f32 v70, v196, v197
v_cvt_pk_bf16_f32 v71, v198, v199
v_mfma_f32_16x16x32_bf16 a[28:31], v[48:51], v[132:135], a[28:31]
buffer_store_dwordx4 v[68:71], v0, s[76:79], s91 offen offset:3072 sc1
v_mfma_f32_16x16x32_bf16 a[28:31], v[52:55], v[116:119], a[28:31]
s_waitcnt lgkmcnt(1)
v_mfma_f32_16x16x32_bf16 a[224:227], v[56:59], v[104:107], a[224:227]
ds_read_b128 v[44:47], v15 offset:1536
v_mfma_f32_16x16x32_bf16 a[224:227], v[60:63], v[120:123], a[224:227]
s_add_u32 s33, s84, 8
s_and_b32 s33, s33, 7
s_lshl_b32 s33, s33, 5
v_mfma_f32_16x16x32_bf16 a[228:231], v[60:63], v[124:127], a[228:231]
s_waitcnt vmcnt(63) lgkmcnt(0)
s_barrier
v_mfma_f32_16x16x32_bf16 a[228:231], v[56:59], v[108:111], a[228:231]
s_add_u32 m0, s19, 24576
v_xor_b32 v15, s33, v17
v_mfma_f32_16x16x32_bf16 a[232:235], v[56:59], v[112:115], a[232:235]
s_add_u32 s18, s18, 32768
ds_read_b64_tr_b16 v[48:49], v8 offset:0
v_mfma_f32_16x16x32_bf16 a[232:235], v[60:63], v[128:131], a[232:235]
ds_read_b64_tr_b16 v[50:51], v8 offset:4096
v_mfma_f32_16x16x32_bf16 a[236:239], v[60:63], v[132:135], a[236:239]
buffer_load_dwordx4 v36, s[28:31], s18 offen offset:0 lds
v_mfma_f32_16x16x32_bf16 a[236:239], v[56:59], v[116:119], a[236:239]
v_mfma_f32_16x16x32_bf16 v[216:219], v[40:43], v[104:107], v[216:219]
s_add_u32 s35, s85, 2
s_and_b32 s35, s35, 3
ds_read_b64_tr_b16 v[52:53], v8 offset:8192
v_mfma_f32_16x16x32_bf16 v[216:219], v[44:47], v[120:123], v[216:219]
s_sub_u32 s35, s35, s85
s_lshl_b32 s35, s35, 12
ds_read_b64_tr_b16 v[54:55], v8 offset:12288
v_mfma_f32_16x16x32_bf16 v[220:223], v[44:47], v[124:127], v[220:223]
s_add_u32 s92, s88, s35
buffer_load_dwordx4 v37, s[28:31], s18 offen offset:1024 lds
v_mfma_f32_16x16x32_bf16 v[220:223], v[40:43], v[108:111], v[220:223]
s_add_u32 s18, s85, 2
s_and_b32 s18, s18, 3
v_mfma_f32_16x16x32_bf16 v[224:227], v[40:43], v[112:115], v[224:227]
s_lshl_b32 s18, s18, 17
ds_read_b64_tr_b16 v[60:61], v9 offset:0
v_mfma_f32_16x16x32_bf16 v[224:227], v[44:47], v[128:131], v[224:227]
s_lshl_b32 s19, s80, 11
ds_read_b64_tr_b16 v[62:63], v9 offset:4096
v_mfma_f32_16x16x32_bf16 v[228:231], v[44:47], v[132:135], v[228:231]
s_add_u32 s19, s19, 16384
s_add_u32 m0, s19, 0
s_add_u32 s93, s89, s35
v_mfma_f32_16x16x32_bf16 v[228:231], v[40:43], v[116:119], v[228:231]
s_waitcnt lgkmcnt(2)
s_add_u32 s94, s90, s35
s_add_u32 s95, s91, s35
v_mfma_f32_16x16x32_bf16 a[96:99], v[48:51], v[72:75], a[96:99]
s_add_u32 s35, s85, 3
ds_read_b64_tr_b16 v[56:57], v9 offset:8192
v_mfma_f32_16x16x32_bf16 a[96:99], v[52:55], v[76:79], a[96:99]
s_and_b32 s35, s35, 3
ds_read_b64_tr_b16 v[58:59], v9 offset:12288
v_mfma_f32_16x16x32_bf16 a[100:103], v[52:55], v[92:95], a[100:103]
buffer_load_dwordx4 v36, s[28:31], s18 offen offset:0 lds
v_mfma_f32_16x16x32_bf16 a[100:103], v[48:51], v[88:91], a[100:103]
s_sub_u32 s35, s35, s85
s_lshl_b32 s35, s35, 12
v_mfma_f32_16x16x32_bf16 a[104:107], v[48:51], v[232:235], a[104:107]
s_add_u32 s96, s88, s35
ds_read_b64_tr_b16 v[44:45], v10 offset:0
v_mfma_f32_16x16x32_bf16 a[104:107], v[52:55], v[236:239], a[104:107]
s_add_u32 s97, s89, s35
ds_read_b64_tr_b16 v[46:47], v10 offset:4096
v_mfma_f32_16x16x32_bf16 a[108:111], v[52:55], v[252:255], a[108:111]
buffer_load_dwordx4 v37, s[28:31], s18 offen offset:1024 lds
v_mfma_f32_16x16x32_bf16 a[108:111], v[48:51], v[248:251], a[108:111]
s_waitcnt lgkmcnt(2)
s_add_u32 m0, s19, 8192
s_add_u32 s18, s18, 32768
v_mfma_f32_16x16x32_bf16 a[112:115], v[60:63], v[72:75], a[112:115]
s_add_u32 s98, s90, s35
ds_read_b64_tr_b16 v[40:41], v10 offset:8192
v_mfma_f32_16x16x32_bf16 a[112:115], v[56:59], v[76:79], a[112:115]
s_add_u32 s99, s91, s35
ds_read_b64_tr_b16 v[42:43], v10 offset:12288
v_mfma_f32_16x16x32_bf16 a[116:119], v[56:59], v[92:95], a[116:119]
buffer_load_dwordx4 v36, s[28:31], s18 offen offset:0 lds
v_mfma_f32_16x16x32_bf16 a[116:119], v[60:63], v[88:91], a[116:119]
s_lshl_b32 s8, s8, 1
s_lshl_b32 s9, s9, 1
v_mfma_f32_16x16x32_bf16 a[120:123], v[60:63], v[232:235], a[120:123]
s_lshl_b32 s10, s10, 1
ds_read_b64_tr_b16 v[52:53], v11 offset:0
v_mfma_f32_16x16x32_bf16 a[120:123], v[56:59], v[236:239], a[120:123]
s_lshl_b32 s11, s11, 1
ds_read_b64_tr_b16 v[54:55], v11 offset:4096
v_mfma_f32_16x16x32_bf16 a[124:127], v[56:59], v[252:255], a[124:127]
buffer_load_dwordx4 v37, s[28:31], s18 offen offset:1024 lds
v_mfma_f32_16x16x32_bf16 a[124:127], v[60:63], v[248:251], a[124:127]
s_waitcnt lgkmcnt(2)
s_add_u32 m0, s19, 16384
s_add_u32 s18, s18, 32768
v_mfma_f32_16x16x32_bf16 a[128:131], v[44:47], v[72:75], a[128:131]
s_sub_u32 s15, s50, 16384
ds_read_b64_tr_b16 v[48:49], v11 offset:8192
v_mfma_f32_16x16x32_bf16 a[128:131], v[40:43], v[76:79], a[128:131]
s_and_b32 s34, s2, 0xf8
ds_read_b64_tr_b16 v[50:51], v11 offset:12288
v_mfma_f32_16x16x32_bf16 a[132:135], v[40:43], v[92:95], a[132:135]
buffer_load_dwordx4 v36, s[28:31], s18 offen offset:0 lds
v_mfma_f32_16x16x32_bf16 a[132:135], v[44:47], v[88:91], a[132:135]
s_lshl2_add_u32 s34, s34, s80
s_lshl_b32 s34, s34, 14
v_mfma_f32_16x16x32_bf16 a[136:139], v[44:47], v[232:235], a[136:139]
s_add_u32 s34, s34, 67108864
ds_read_b64_tr_b16 v[56:57], v12 offset:0
v_mfma_f32_16x16x32_bf16 a[136:139], v[40:43], v[236:239], a[136:139]
s_lshl_b32 s35, s84, 16
ds_read_b64_tr_b16 v[58:59], v12 offset:4096
v_mfma_f32_16x16x32_bf16 a[140:143], v[40:43], v[252:255], a[140:143]
buffer_load_dwordx4 v37, s[28:31], s18 offen offset:1024 lds
v_mfma_f32_16x16x32_bf16 a[140:143], v[44:47], v[248:251], a[140:143]
s_waitcnt lgkmcnt(2)
s_add_u32 m0, s19, 24576
s_add_u32 s18, s18, 32768
v_mfma_f32_16x16x32_bf16 a[144:147], v[52:55], v[72:75], a[144:147]
s_add_u32 s35, s35, 0x10000
ds_read_b64_tr_b16 v[60:61], v12 offset:8192
v_mfma_f32_16x16x32_bf16 a[144:147], v[48:51], v[76:79], a[144:147]
s_and_b32 s35, s35, 0x7ffff
ds_read_b64_tr_b16 v[62:63], v12 offset:12288
v_mfma_f32_16x16x32_bf16 a[148:151], v[48:51], v[92:95], a[148:151]
buffer_load_dwordx4 v36, s[28:31], s18 offen offset:0 lds
v_mfma_f32_16x16x32_bf16 a[148:151], v[52:55], v[88:91], a[148:151]
s_add_u32 s56, s34, s35
s_add_u32 s34, s34, 2048
v_mfma_f32_16x16x32_bf16 a[152:155], v[52:55], v[232:235], a[152:155]
s_add_u32 s35, s35, 0x10000
ds_read_b64_tr_b16 v[40:41], v13 offset:0
v_mfma_f32_16x16x32_bf16 a[152:155], v[48:51], v[236:239], a[152:155]
s_and_b32 s35, s35, 0x7ffff
ds_read_b64_tr_b16 v[42:43], v13 offset:4096
v_mfma_f32_16x16x32_bf16 a[156:159], v[48:51], v[252:255], a[156:159]
buffer_load_dwordx4 v37, s[28:31], s18 offen offset:1024 lds
v_mfma_f32_16x16x32_bf16 a[156:159], v[52:55], v[248:251], a[156:159]
s_waitcnt lgkmcnt(2)
s_add_u32 s18, s85, 3
s_and_b32 s18, s18, 3
v_mfma_f32_16x16x32_bf16 a[0:3], v[56:59], v[72:75], a[0:3]
s_lshl_b32 s18, s18, 17
ds_read_b64_tr_b16 v[44:45], v13 offset:8192
v_mfma_f32_16x16x32_bf16 a[0:3], v[60:63], v[76:79], a[0:3]
s_lshl_b32 s19, s80, 11
ds_read_b64_tr_b16 v[46:47], v13 offset:12288
v_mfma_f32_16x16x32_bf16 a[4:7], v[60:63], v[92:95], a[4:7]
s_add_u32 s19, s19, 49152
s_add_u32 m0, s19, 0
s_add_u32 s57, s34, s35
v_mfma_f32_16x16x32_bf16 a[4:7], v[56:59], v[88:91], a[4:7]
s_add_u32 s34, s34, 2048
s_add_u32 s35, s35, 0x10000
v_mfma_f32_16x16x32_bf16 a[8:11], v[56:59], v[232:235], a[8:11]
s_and_b32 s35, s35, 0x7ffff
ds_read_b64_tr_b16 v[48:49], v14 offset:0
v_mfma_f32_16x16x32_bf16 a[8:11], v[60:63], v[236:239], a[8:11]
s_add_u32 s58, s34, s35
ds_read_b64_tr_b16 v[50:51], v14 offset:4096
v_mfma_f32_16x16x32_bf16 a[12:15], v[60:63], v[252:255], a[12:15]
buffer_load_dwordx4 v36, s[28:31], s18 offen offset:0 lds
v_mfma_f32_16x16x32_bf16 a[12:15], v[56:59], v[248:251], a[12:15]
s_waitcnt lgkmcnt(2)
s_add_u32 s34, s34, 2048
s_add_u32 s35, s35, 0x10000
v_mfma_f32_16x16x32_bf16 a[16:19], v[40:43], v[72:75], a[16:19]
s_and_b32 s35, s35, 0x7ffff
ds_read_b64_tr_b16 v[52:53], v14 offset:8192
v_mfma_f32_16x16x32_bf16 a[16:19], v[44:47], v[76:79], a[16:19]
s_add_u32 s59, s34, s35
ds_read_b64_tr_b16 v[54:55], v14 offset:12288
v_mfma_f32_16x16x32_bf16 a[20:23], v[44:47], v[92:95], a[20:23]
buffer_load_dwordx4 v37, s[28:31], s18 offen offset:1024 lds
v_mfma_f32_16x16x32_bf16 a[20:23], v[40:43], v[88:91], a[20:23]
s_add_u32 m0, s19, 8192
s_add_u32 s18, s18, 32768
v_mfma_f32_16x16x32_bf16 a[24:27], v[40:43], v[232:235], a[24:27]
s_add_u32 s34, s34, 2048
ds_read_b64_tr_b16 v[60:61], v15 offset:0
v_mfma_f32_16x16x32_bf16 a[24:27], v[44:47], v[236:239], a[24:27]
s_add_u32 s35, s35, 0x10000
ds_read_b64_tr_b16 v[62:63], v15 offset:4096
v_mfma_f32_16x16x32_bf16 a[28:31], v[44:47], v[252:255], a[28:31]
buffer_load_dwordx4 v36, s[28:31], s18 offen offset:0 lds
v_mfma_f32_16x16x32_bf16 a[28:31], v[40:43], v[248:251], a[28:31]
s_waitcnt lgkmcnt(2)
s_and_b32 s35, s35, 0x7ffff
s_add_u32 s60, s34, s35
v_mfma_f32_16x16x32_bf16 a[224:227], v[48:51], v[72:75], a[224:227]
s_add_u32 s34, s34, 2048
ds_read_b64_tr_b16 v[56:57], v15 offset:8192
v_mfma_f32_16x16x32_bf16 a[224:227], v[52:55], v[76:79], a[224:227]
s_add_u32 s35, s35, 0x10000
ds_read_b64_tr_b16 v[58:59], v15 offset:12288
v_mfma_f32_16x16x32_bf16 a[228:231], v[52:55], v[92:95], a[228:231]
buffer_load_dwordx4 v37, s[28:31], s18 offen offset:1024 lds
v_mfma_f32_16x16x32_bf16 a[228:231], v[48:51], v[88:91], a[228:231]
s_add_u32 m0, s19, 16384
s_add_u32 s18, s18, 32768
v_mfma_f32_16x16x32_bf16 a[232:235], v[48:51], v[232:235], a[232:235]
s_and_b32 s35, s35, 0x7ffff
ds_read_b64_tr_b16 v[44:45], v8 offset:16384
v_mfma_f32_16x16x32_bf16 a[232:235], v[52:55], v[236:239], a[232:235]
s_add_u32 s61, s34, s35
ds_read_b64_tr_b16 v[46:47], v8 offset:20480
v_mfma_f32_16x16x32_bf16 a[236:239], v[52:55], v[252:255], a[236:239]
buffer_load_dwordx4 v36, s[28:31], s18 offen offset:0 lds
v_mfma_f32_16x16x32_bf16 a[236:239], v[48:51], v[248:251], a[236:239]
s_waitcnt lgkmcnt(2)
s_add_u32 s34, s34, 2048
s_add_u32 s35, s35, 0x10000
v_mfma_f32_16x16x32_bf16 v[216:219], v[60:63], v[72:75], v[216:219]
s_and_b32 s35, s35, 0x7ffff
ds_read_b64_tr_b16 v[40:41], v8 offset:24576
v_mfma_f32_16x16x32_bf16 v[216:219], v[56:59], v[76:79], v[216:219]
s_add_u32 s62, s34, s35
ds_read_b64_tr_b16 v[42:43], v8 offset:28672
v_mfma_f32_16x16x32_bf16 v[220:223], v[56:59], v[92:95], v[220:223]
buffer_load_dwordx4 v37, s[28:31], s18 offen offset:1024 lds
v_mfma_f32_16x16x32_bf16 v[220:223], v[60:63], v[88:91], v[220:223]
v_xor_b32 v8, 0x8000, v8
v_mfma_f32_16x16x32_bf16 v[224:227], v[60:63], v[232:235], v[224:227]
s_add_u32 m0, s19, 24576
ds_read_b64_tr_b16 v[52:53], v9 offset:16384
v_mfma_f32_16x16x32_bf16 v[224:227], v[56:59], v[236:239], v[224:227]
s_add_u32 s18, s18, 32768
ds_read_b64_tr_b16 v[54:55], v9 offset:20480
v_mfma_f32_16x16x32_bf16 v[228:231], v[56:59], v[252:255], v[228:231]
buffer_load_dwordx4 v36, s[28:31], s18 offen offset:0 lds
v_mfma_f32_16x16x32_bf16 v[228:231], v[60:63], v[248:251], v[228:231]
s_waitcnt lgkmcnt(2)
s_add_u32 s34, s34, 2048
v_mfma_f32_16x16x32_bf16 a[96:99], v[44:47], v[80:83], a[96:99]
ds_read_b64_tr_b16 v[48:49], v9 offset:24576
v_bfe_u32 v25, v0, 4, 4
v_mfma_f32_16x16x32_bf16 a[96:99], v[40:43], v[84:87], a[96:99]
ds_read_b64_tr_b16 v[50:51], v9 offset:28672
v_lshrrev_b32 v26, 8, v0
v_mfma_f32_16x16x32_bf16 a[100:103], v[40:43], v[100:103], a[100:103]
buffer_load_dwordx4 v37, s[28:31], s18 offen offset:1024 lds
v_mfma_f32_16x16x32_bf16 a[100:103], v[44:47], v[96:99], a[100:103]
v_xor_b32 v9, 0x8000, v9
v_mfma_f32_16x16x32_bf16 a[104:107], v[44:47], v[240:243], a[104:107]
ds_read_b64_tr_b16 v[56:57], v10 offset:16384
v_lshlrev_b32 v26, 2, v26
v_mfma_f32_16x16x32_bf16 a[104:107], v[40:43], v[244:247], a[104:107]
ds_read_b64_tr_b16 v[58:59], v10 offset:20480
v_sub_u32 v25, v25, v26
v_mfma_f32_16x16x32_bf16 a[108:111], v[40:43], v[68:71], a[108:111]
buffer_load_dwordx4 a[160:163], v0, s[76:79], s92 offen offset:0 sc1
v_mfma_f32_16x16x32_bf16 a[108:111], v[44:47], v[64:67], a[108:111]
s_waitcnt lgkmcnt(2)
v_cmp_gt_u32 s[32:33], 4, v25
v_mfma_f32_16x16x32_bf16 a[112:115], v[52:55], v[80:83], a[112:115]
ds_read_b64_tr_b16 v[60:61], v10 offset:24576
v_lshlrev_b32 v25, 4, v25
v_mfma_f32_16x16x32_bf16 a[112:115], v[48:51], v[84:87], a[112:115]
ds_read_b64_tr_b16 v[62:63], v10 offset:28672
v_mov_b32 v28, 0x3f80
v_mfma_f32_16x16x32_bf16 a[116:119], v[48:51], v[100:103], a[116:119]
s_waitcnt vmcnt(19)
s_mov_b64 exec, 1
buffer_store_dword v3, off, s[76:79], s43 offset:0 sc1
s_mov_b64 exec, -1
v_mfma_f32_16x16x32_bf16 a[116:119], v[52:55], v[96:99], a[116:119]
v_xor_b32 v10, 0x8000, v10
v_mfma_f32_16x16x32_bf16 a[120:123], v[52:55], v[240:243], a[120:123]
ds_read_b64_tr_b16 v[40:41], v11 offset:16384
v_mov_b32 v29, 0
v_mfma_f32_16x16x32_bf16 a[120:123], v[48:51], v[244:247], a[120:123]
ds_read_b64_tr_b16 v[42:43], v11 offset:20480
v_cndmask_b32 v28, 0, v28, s[32:33]
v_mfma_f32_16x16x32_bf16 a[124:127], v[48:51], v[68:71], a[124:127]
buffer_load_dwordx4 a[164:167], v0, s[76:79], s93 offen offset:0 sc1
v_mfma_f32_16x16x32_bf16 a[124:127], v[52:55], v[64:67], a[124:127]
s_waitcnt lgkmcnt(2)
v_lshlrev_b64 v[186:187], v25, v[28:29]
v_mfma_f32_16x16x32_bf16 a[128:131], v[56:59], v[80:83], a[128:131]
ds_read_b64_tr_b16 v[44:45], v11 offset:24576
v_mov_b32 v184, 0
v_mfma_f32_16x16x32_bf16 a[128:131], v[60:63], v[84:87], a[128:131]
ds_read_b64_tr_b16 v[46:47], v11 offset:28672
v_mov_b32 v185, 0
v_mfma_f32_16x16x32_bf16 a[132:135], v[60:63], v[100:103], a[132:135]
buffer_load_dwordx4 a[168:171], v0, s[76:79], s92 offen offset:1024 sc1
v_mfma_f32_16x16x32_bf16 a[132:135], v[56:59], v[96:99], a[132:135]
v_xor_b32 v11, 0x8000, v11
v_mfma_f32_16x16x32_bf16 a[136:139], v[56:59], v[240:243], a[136:139]
ds_read_b64_tr_b16 v[48:49], v12 offset:16384
v_mov_b32 v188, 0
v_mfma_f32_16x16x32_bf16 a[136:139], v[60:63], v[244:247], a[136:139]
ds_read_b64_tr_b16 v[50:51], v12 offset:20480
v_mov_b32 v189, 0
v_mfma_f32_16x16x32_bf16 a[140:143], v[60:63], v[68:71], a[140:143]
buffer_load_dwordx4 a[172:175], v0, s[76:79], s93 offen offset:1024 sc1
v_mfma_f32_16x16x32_bf16 a[140:143], v[56:59], v[64:67], a[140:143]
s_waitcnt lgkmcnt(2)
v_lshlrev_b32 v2, 1, v2
v_mfma_f32_16x16x32_bf16 a[144:147], v[40:43], v[80:83], a[144:147]
ds_read_b64_tr_b16 v[52:53], v12 offset:24576
v_accvgpr_read_b32 v27, a248
v_mfma_f32_16x16x32_bf16 a[144:147], v[44:47], v[84:87], a[144:147]
ds_read_b64_tr_b16 v[54:55], v12 offset:28672
v_lshlrev_b32 v26, 16, v27
v_mfma_f32_16x16x32_bf16 a[148:151], v[44:47], v[100:103], a[148:151]
buffer_load_dwordx4 a[176:179], v0, s[76:79], s92 offen offset:2048 sc1
v_mfma_f32_16x16x32_bf16 a[148:151], v[40:43], v[96:99], a[148:151]
v_xor_b32 v12, 0x8000, v12
v_mfma_f32_16x16x32_bf16 a[152:155], v[40:43], v[240:243], a[152:155]
ds_read_b64_tr_b16 v[60:61], v13 offset:16384
v_and_b32 v27, 0xffff0000, v27
v_mfma_f32_16x16x32_bf16 a[152:155], v[44:47], v[244:247], a[152:155]
ds_read_b64_tr_b16 v[62:63], v13 offset:20480
v_accvgpr_read_b32 v29, a249
v_mfma_f32_16x16x32_bf16 a[156:159], v[44:47], v[68:71], a[156:159]
buffer_load_dwordx4 a[180:183], v0, s[76:79], s93 offen offset:2048 sc1
v_mfma_f32_16x16x32_bf16 a[156:159], v[40:43], v[64:67], a[156:159]
s_waitcnt lgkmcnt(2)
v_lshlrev_b32 v28, 16, v29
v_mfma_f32_16x16x32_bf16 a[0:3], v[48:51], v[80:83], a[0:3]
ds_read_b64_tr_b16 v[56:57], v13 offset:24576
v_and_b32 v29, 0xffff0000, v29
v_mfma_f32_16x16x32_bf16 a[0:3], v[52:55], v[84:87], a[0:3]
ds_read_b64_tr_b16 v[58:59], v13 offset:28672
v_sub_f32 v4, 1.0, v4
v_mfma_f32_16x16x32_bf16 a[4:7], v[52:55], v[100:103], a[4:7]
buffer_load_dwordx4 a[184:187], v0, s[76:79], s92 offen offset:3072 sc1
v_mfma_f32_16x16x32_bf16 a[4:7], v[48:51], v[96:99], a[4:7]
v_xor_b32 v13, 0x8000, v13
v_mfma_f32_16x16x32_bf16 a[8:11], v[48:51], v[240:243], a[8:11]
ds_read_b64_tr_b16 v[44:45], v14 offset:16384
v_cvt_pk_bf16_f32 v4, v4, v4
v_mfma_f32_16x16x32_bf16 a[8:11], v[52:55], v[244:247], a[8:11]
ds_read_b64_tr_b16 v[46:47], v14 offset:20480
v_lshlrev_b32 v4, 16, v4
v_mfma_f32_16x16x32_bf16 a[12:15], v[52:55], v[68:71], a[12:15]
buffer_load_dwordx4 a[188:191], v0, s[76:79], s93 offen offset:3072 sc1
v_mfma_f32_16x16x32_bf16 a[12:15], v[48:51], v[64:67], a[12:15]
s_waitcnt lgkmcnt(2)
v_accvgpr_read_b32 v169, a240
v_mfma_f32_16x16x32_bf16 a[16:19], v[60:63], v[80:83], a[16:19]
ds_read_b64_tr_b16 v[40:41], v14 offset:24576
v_lshlrev_b32 v168, 16, v169
v_mfma_f32_16x16x32_bf16 a[16:19], v[56:59], v[84:87], a[16:19]
ds_read_b64_tr_b16 v[42:43], v14 offset:28672
v_and_b32 v169, 0xffff0000, v169
v_mfma_f32_16x16x32_bf16 a[20:23], v[56:59], v[100:103], a[20:23]
buffer_load_dwordx4 v[104:107], v0, s[76:79], s96 offen offset:0 sc1
v_mfma_f32_16x16x32_bf16 a[20:23], v[60:63], v[96:99], a[20:23]
v_xor_b32 v14, 0x8000, v14
v_mfma_f32_16x16x32_bf16 a[24:27], v[60:63], v[240:243], a[24:27]
ds_read_b64_tr_b16 v[52:53], v15 offset:16384
v_mul_f32 v168, v168, v26
v_mfma_f32_16x16x32_bf16 a[24:27], v[56:59], v[244:247], a[24:27]
ds_read_b64_tr_b16 v[54:55], v15 offset:20480
v_mul_f32 v169, v169, v27
v_mfma_f32_16x16x32_bf16 a[28:31], v[56:59], v[68:71], a[28:31]
buffer_load_dwordx4 v[108:111], v0, s[76:79], s97 offen offset:0 sc1
v_mfma_f32_16x16x32_bf16 a[28:31], v[60:63], v[64:67], a[28:31]
s_waitcnt lgkmcnt(2)
v_cvt_pk_bf16_f32 v168, v168, v169
v_mfma_f32_16x16x32_bf16 a[224:227], v[44:47], v[80:83], a[224:227]
ds_read_b64_tr_b16 v[48:49], v15 offset:24576
v_and_b32 v169, 0xffff0000, v168
v_mfma_f32_16x16x32_bf16 a[224:227], v[40:43], v[84:87], a[224:227]
ds_read_b64_tr_b16 v[50:51], v15 offset:28672
v_lshlrev_b32 v168, 16, v168
v_mfma_f32_16x16x32_bf16 a[228:231], v[40:43], v[100:103], a[228:231]
buffer_load_dwordx4 v[112:115], v0, s[76:79], s96 offen offset:1024 sc1
v_mfma_f32_16x16x32_bf16 a[228:231], v[44:47], v[96:99], a[228:231]
v_xor_b32 v15, 0x8000, v15
v_mfma_f32_16x16x32_bf16 a[232:235], v[44:47], v[240:243], a[232:235]
ds_read_b64_tr_b16 v[200:201], v8 offset:0
v_accvgpr_read_b32 v171, a241
v_mfma_f32_16x16x32_bf16 a[232:235], v[40:43], v[244:247], a[232:235]
ds_read_b64_tr_b16 v[202:203], v8 offset:4096
v_lshlrev_b32 v170, 16, v171
v_mfma_f32_16x16x32_bf16 a[236:239], v[40:43], v[68:71], a[236:239]
ds_read_b64_tr_b16 v[204:205], v8 offset:8192
buffer_load_dwordx4 v[116:119], v0, s[76:79], s97 offen offset:1024 sc1
v_mfma_f32_16x16x32_bf16 a[236:239], v[44:47], v[64:67], a[236:239]
s_waitcnt lgkmcnt(3)
ds_read_b64_tr_b16 v[206:207], v8 offset:12288
v_mfma_f32_16x16x32_bf16 v[216:219], v[52:55], v[80:83], v[216:219]
ds_read_b64_tr_b16 v[208:209], v9 offset:0
v_and_b32 v171, 0xffff0000, v171
v_mfma_f32_16x16x32_bf16 v[216:219], v[48:51], v[84:87], v[216:219]
ds_read_b64_tr_b16 v[210:211], v9 offset:4096
v_mul_f32 v170, v170, v28
v_mfma_f32_16x16x32_bf16 v[220:223], v[48:51], v[100:103], v[220:223]
ds_read_b64_tr_b16 v[212:213], v9 offset:8192
buffer_load_dwordx4 v[120:123], v0, s[76:79], s96 offen offset:2048 sc1
v_mfma_f32_16x16x32_bf16 v[220:223], v[52:55], v[96:99], v[220:223]
ds_read_b64_tr_b16 v[214:215], v9 offset:12288
v_mfma_f32_16x16x32_bf16 v[224:227], v[52:55], v[240:243], v[224:227]
ds_read_b64_tr_b16 v[56:57], v10 offset:0
v_mul_f32 v171, v171, v29
v_mfma_f32_16x16x32_bf16 v[224:227], v[48:51], v[244:247], v[224:227]
ds_read_b64_tr_b16 v[58:59], v10 offset:4096
v_cvt_pk_bf16_f32 v170, v170, v171
v_mfma_f32_16x16x32_bf16 v[228:231], v[48:51], v[68:71], v[228:231]
ds_read_b64_tr_b16 v[60:61], v10 offset:8192
buffer_load_dwordx4 v[124:127], v0, s[76:79], s97 offen offset:2048 sc1
v_mfma_f32_16x16x32_bf16 v[228:231], v[52:55], v[64:67], v[228:231]
s_waitcnt lgkmcnt(7)
ds_read_b64_tr_b16 v[62:63], v10 offset:12288
v_mfma_f32_16x16x32_bf16 a[96:99], v[200:203], a[32:35], a[96:99]
ds_read_b64_tr_b16 v[40:41], v11 offset:0
v_bfe_u32 v20, v0, 2, 7
v_mfma_f32_16x16x32_bf16 a[96:99], v[204:207], a[40:43], a[96:99]
ds_read_b64_tr_b16 v[42:43], v11 offset:4096
v_and_b32 v171, 0xffff0000, v170
v_mfma_f32_16x16x32_bf16 a[100:103], v[204:207], a[44:47], a[100:103]
ds_read_b64_tr_b16 v[44:45], v11 offset:8192
buffer_load_dword v20, v20, s[76:79], s42 offen offset:0 sc1
v_mfma_f32_16x16x32_bf16 a[100:103], v[200:203], a[36:39], a[100:103]
s_waitcnt lgkmcnt(7)
ds_read_b64_tr_b16 v[46:47], v11 offset:12288
v_mfma_f32_16x16x32_bf16 a[112:115], v[208:211], a[32:35], a[112:115]
ds_read_b64_tr_b16 v[48:49], v12 offset:0
v_lshlrev_b32 v170, 16, v170
v_mfma_f32_16x16x32_bf16 a[112:115], v[212:215], a[40:43], a[112:115]
ds_read_b64_tr_b16 v[50:51], v12 offset:4096
v_sub_f32 v5, 1.0, v5
v_mfma_f32_16x16x32_bf16 a[116:119], v[212:215], a[44:47], a[116:119]
ds_read_b64_tr_b16 v[52:53], v12 offset:8192
buffer_load_dwordx4 v[128:131], v0, s[76:79], s96 offen offset:3072 sc1
v_mfma_f32_16x16x32_bf16 a[116:119], v[208:211], a[36:39], a[116:119]
s_waitcnt lgkmcnt(7)
ds_read_b64_tr_b16 v[54:55], v12 offset:12288
v_mfma_f32_16x16x32_bf16 a[128:131], v[56:59], a[32:35], a[128:131]
ds_read_b64_tr_b16 v[204:205], v13 offset:0
v_cvt_pk_bf16_f32 v5, v5, v5
v_mfma_f32_16x16x32_bf16 a[128:131], v[60:63], a[40:43], a[128:131]
ds_read_b64_tr_b16 v[206:207], v13 offset:4096
v_lshlrev_b32 v5, 16, v5
v_mfma_f32_16x16x32_bf16 a[132:135], v[60:63], a[44:47], a[132:135]
ds_read_b64_tr_b16 v[200:201], v13 offset:8192
buffer_load_dwordx4 v[132:135], v0, s[76:79], s97 offen offset:3072 sc1
v_mfma_f32_16x16x32_bf16 a[132:135], v[56:59], a[36:39], a[132:135]
s_waitcnt lgkmcnt(7)
ds_read_b64_tr_b16 v[202:203], v13 offset:12288
v_mfma_f32_16x16x32_bf16 a[144:147], v[40:43], a[32:35], a[144:147]
ds_read_b64_tr_b16 v[212:213], v14 offset:0
v_accvgpr_read_b32 v173, a242
v_mfma_f32_16x16x32_bf16 a[144:147], v[44:47], a[40:43], a[144:147]
ds_read_b64_tr_b16 v[214:215], v14 offset:4096
v_lshlrev_b32 v172, 16, v173
v_mfma_f32_16x16x32_bf16 a[148:151], v[44:47], a[44:47], a[148:151]
ds_read_b64_tr_b16 v[208:209], v14 offset:8192
s_waitcnt vmcnt(18)
s_barrier
v_mfma_f32_16x16x32_bf16 a[148:151], v[40:43], a[36:39], a[148:151]
s_waitcnt lgkmcnt(7)
ds_read_b64_tr_b16 v[210:211], v14 offset:12288
v_mfma_f32_16x16x32_bf16 a[0:3], v[48:51], a[32:35], a[0:3]
ds_read_b64_tr_b16 v[60:61], v8 offset:16384
v_and_b32 v173, 0xffff0000, v173
v_mfma_f32_16x16x32_bf16 a[0:3], v[52:55], a[40:43], a[0:3]
ds_read_b64_tr_b16 v[62:63], v8 offset:20480
v_mul_f32 v172, v172, v26
v_mfma_f32_16x16x32_bf16 a[4:7], v[52:55], a[44:47], a[4:7]
ds_read_b64_tr_b16 v[56:57], v8 offset:24576
v_mul_f32 v173, v173, v27
v_mfma_f32_16x16x32_bf16 a[4:7], v[48:51], a[36:39], a[4:7]
s_waitcnt lgkmcnt(7)
ds_read_b64_tr_b16 v[58:59], v8 offset:28672
v_mfma_f32_16x16x32_bf16 a[16:19], v[204:207], a[32:35], a[16:19]
ds_read_b64_tr_b16 v[44:45], v9 offset:16384
v_cvt_pk_bf16_f32 v172, v172, v173
v_mfma_f32_16x16x32_bf16 a[16:19], v[200:203], a[40:43], a[16:19]
ds_read_b64_tr_b16 v[46:47], v9 offset:20480
v_subrev_u32 v8, s15, v8
v_mfma_f32_16x16x32_bf16 a[20:23], v[200:203], a[44:47], a[20:23]
ds_read_b64_tr_b16 v[40:41], v9 offset:24576
v_and_b32 v173, 0xffff0000, v172
v_mfma_f32_16x16x32_bf16 a[20:23], v[204:207], a[36:39], a[20:23]
s_waitcnt lgkmcnt(7)
ds_read_b64_tr_b16 v[42:43], v9 offset:28672
v_mfma_f32_16x16x32_bf16 a[224:227], v[212:215], a[32:35], a[224:227]
ds_read_b64_tr_b16 v[52:53], v10 offset:16384
v_lshlrev_b32 v172, 16, v172
v_mfma_f32_16x16x32_bf16 a[224:227], v[208:211], a[40:43], a[224:227]
ds_read_b64_tr_b16 v[54:55], v10 offset:20480
v_subrev_u32 v9, s15, v9
v_mfma_f32_16x16x32_bf16 a[228:231], v[208:211], a[44:47], a[228:231]
ds_read_b64_tr_b16 v[48:49], v10 offset:24576
v_accvgpr_read_b32 v175, a243
v_mfma_f32_16x16x32_bf16 a[228:231], v[212:215], a[36:39], a[228:231]
s_waitcnt lgkmcnt(7)
ds_read_b64_tr_b16 v[50:51], v10 offset:28672
v_mfma_f32_16x16x32_bf16 a[96:99], v[60:63], a[48:51], a[96:99]
ds_read_b64_tr_b16 v[200:201], v11 offset:16384
v_lshlrev_b32 v174, 16, v175
v_mfma_f32_16x16x32_bf16 a[96:99], v[56:59], a[56:59], a[96:99]
ds_read_b64_tr_b16 v[202:203], v11 offset:20480
v_subrev_u32 v10, s15, v10
v_mfma_f32_16x16x32_bf16 a[100:103], v[56:59], a[60:63], a[100:103]
ds_read_b64_tr_b16 v[204:205], v11 offset:24576
v_and_b32 v175, 0xffff0000, v175
v_mfma_f32_16x16x32_bf16 a[100:103], v[60:63], a[52:55], a[100:103]
s_waitcnt lgkmcnt(7)
ds_read_b64_tr_b16 v[206:207], v11 offset:28672
v_mfma_f32_16x16x32_bf16 a[112:115], v[44:47], a[48:51], a[112:115]
ds_read_b64_tr_b16 v[208:209], v12 offset:16384
v_mul_f32 v174, v174, v28
v_mfma_f32_16x16x32_bf16 a[112:115], v[40:43], a[56:59], a[112:115]
ds_read_b64_tr_b16 v[210:211], v12 offset:20480
v_subrev_u32 v11, s15, v11
v_mfma_f32_16x16x32_bf16 a[116:119], v[40:43], a[60:63], a[116:119]
ds_read_b64_tr_b16 v[212:213], v12 offset:24576
LG_p1_r:
s_waitcnt vmcnt(2)
v_cmp_lt_u32 vcc, 0, v20
s_nop 0
s_and_b32 s74, vcc_lo, s13
s_cmp_eq_u32 s74, s13
s_cbranch_scc1 LG_p1
s_sleep 2
v_bfe_u32 v20, v0, 2, 7
buffer_load_dword v20, v20, s[76:79], s42 offen offset:0 sc1
s_waitcnt vmcnt(0)
s_branch LG_p1_r
LG_p1:
v_mfma_f32_16x16x32_bf16 a[116:119], v[44:47], a[52:55], a[116:119]
s_waitcnt lgkmcnt(7)
ds_read_b64_tr_b16 v[214:215], v12 offset:28672
v_mfma_f32_16x16x32_bf16 a[128:131], v[52:55], a[48:51], a[128:131]
ds_read_b64_tr_b16 v[56:57], v13 offset:16384
v_mul_f32 v175, v175, v29
v_mfma_f32_16x16x32_bf16 a[128:131], v[48:51], a[56:59], a[128:131]
ds_read_b64_tr_b16 v[58:59], v13 offset:20480
v_subrev_u32 v12, s15, v12
v_mfma_f32_16x16x32_bf16 a[132:135], v[48:51], a[60:63], a[132:135]
ds_read_b64_tr_b16 v[60:61], v13 offset:24576
buffer_load_dwordx4 a[64:67], v0, s[76:79], s6 offen offset:0 sc1
v_mfma_f32_16x16x32_bf16 a[132:135], v[52:55], a[52:55], a[132:135]
s_waitcnt lgkmcnt(7)
ds_read_b64_tr_b16 v[62:63], v13 offset:28672
v_mfma_f32_16x16x32_bf16 a[144:147], v[200:203], a[48:51], a[144:147]
ds_read_b64_tr_b16 v[40:41], v14 offset:16384
v_cvt_pk_bf16_f32 v174, v174, v175
v_mfma_f32_16x16x32_bf16 a[144:147], v[204:207], a[56:59], a[144:147]
ds_read_b64_tr_b16 v[42:43], v14 offset:20480
v_subrev_u32 v13, s15, v13
v_mfma_f32_16x16x32_bf16 a[148:151], v[204:207], a[60:63], a[148:151]
ds_read_b64_tr_b16 v[44:45], v14 offset:24576
buffer_load_dwordx4 a[68:71], v0, s[76:79], s7 offen offset:0 sc1
v_mfma_f32_16x16x32_bf16 a[148:151], v[200:203], a[52:55], a[148:151]
s_waitcnt lgkmcnt(7)
ds_read_b64_tr_b16 v[46:47], v14 offset:28672
v_mfma_f32_16x16x32_bf16 a[0:3], v[208:211], a[48:51], a[0:3]
ds_read_b64_tr_b16 v[48:49], v8 offset:0
v_and_b32 v175, 0xffff0000, v174
v_mfma_f32_16x16x32_bf16 a[0:3], v[212:215], a[56:59], a[0:3]
ds_read_b64_tr_b16 v[50:51], v8 offset:4096
v_subrev_u32 v14, s15, v14
v_mfma_f32_16x16x32_bf16 a[4:7], v[212:215], a[60:63], a[4:7]
ds_read_b64_tr_b16 v[52:53], v8 offset:8192
buffer_load_dwordx4 a[72:75], v0, s[76:79], s6 offen offset:1024 sc1
v_mfma_f32_16x16x32_bf16 a[4:7], v[208:211], a[52:55], a[4:7]
s_waitcnt lgkmcnt(7)
ds_read_b64_tr_b16 v[54:55], v8 offset:12288
v_mfma_f32_16x16x32_bf16 a[16:19], v[56:59], a[48:51], a[16:19]
ds_read_b64_tr_b16 v[204:205], v8 offset:16384
v_lshlrev_b32 v174, 16, v174
v_mfma_f32_16x16x32_bf16 a[16:19], v[60:63], a[56:59], a[16:19]
ds_read_b64_tr_b16 v[206:207], v8 offset:20480
v_sub_f32 v6, 1.0, v6
v_mfma_f32_16x16x32_bf16 a[20:23], v[60:63], a[60:63], a[20:23]
ds_read_b64_tr_b16 v[200:201], v8 offset:24576
buffer_load_dwordx4 a[76:79], v0, s[76:79], s7 offen offset:1024 sc1
v_mfma_f32_16x16x32_bf16 a[20:23], v[56:59], a[52:55], a[20:23]
s_waitcnt lgkmcnt(7)
ds_read_b64_tr_b16 v[202:203], v8 offset:28672
v_mfma_f32_16x16x32_bf16 a[224:227], v[40:43], a[48:51], a[224:227]
ds_read_b64_tr_b16 v[212:213], v8 offset:32768
v_cvt_pk_bf16_f32 v6, v6, v6
v_mfma_f32_16x16x32_bf16 a[224:227], v[44:47], a[56:59], a[224:227]
ds_read_b64_tr_b16 v[214:215], v8 offset:36864
v_lshlrev_b32 v6, 16, v6
v_mfma_f32_16x16x32_bf16 a[228:231], v[44:47], a[60:63], a[228:231]
ds_read_b64_tr_b16 v[208:209], v8 offset:40960
buffer_load_dwordx4 a[80:83], v0, s[76:79], s6 offen offset:2048 sc1
v_mfma_f32_16x16x32_bf16 a[228:231], v[40:43], a[52:55], a[228:231]
s_waitcnt lgkmcnt(7)
ds_read_b64_tr_b16 v[210:211], v8 offset:45056
v_mfma_f32_16x16x32_bf16 a[96:99], v[48:51], a[160:163], a[96:99]
s_lshl2_add_u32 s33, s2, s80
ds_read_b64_tr_b16 v[60:61], v8 offset:49152
v_accvgpr_read_b32 v177, a244
v_mfma_f32_16x16x32_bf16 a[96:99], v[52:55], a[168:171], a[96:99]
s_lshl_b32 s33, s33, 14
ds_read_b64_tr_b16 v[62:63], v8 offset:53248
v_lshlrev_b32 v176, 16, v177
v_mfma_f32_16x16x32_bf16 a[100:103], v[52:55], a[172:175], a[100:103]
ds_read_b64_tr_b16 v[56:57], v8 offset:57344
buffer_load_dwordx4 a[84:87], v0, s[76:79], s7 offen offset:2048 sc1
v_mfma_f32_16x16x32_bf16 a[100:103], v[48:51], a[164:167], a[100:103]
s_waitcnt lgkmcnt(7)
ds_read_b64_tr_b16 v[58:59], v8 offset:61440
v_and_b32 v177, 0xffff0000, v177
v_mfma_f32_16x16x32_bf16 a[96:99], v[204:207], a[176:179], a[96:99]
ds_read_b64_tr_b16 v[44:45], v9 offset:0
v_add_u32 v8, s15, v8
v_mul_f32 v176, v176, v26
v_mfma_f32_16x16x32_bf16 a[96:99], v[200:203], a[184:187], a[96:99]
s_add_u32 s88, s33, 67108864
ds_read_b64_tr_b16 v[46:47], v9 offset:4096
v_mul_f32 v177, v177, v27
v_mfma_f32_16x16x32_bf16 a[100:103], v[200:203], a[188:191], a[100:103]
ds_read_b64_tr_b16 v[40:41], v9 offset:8192
buffer_load_dwordx4 a[88:91], v0, s[76:79], s6 offen offset:3072 sc1
v_mfma_f32_16x16x32_bf16 a[100:103], v[204:207], a[180:183], a[100:103]
s_waitcnt lgkmcnt(7)
ds_read_b64_tr_b16 v[42:43], v9 offset:12288
v_cvt_pk_bf16_f32 v176, v176, v177
v_mfma_f32_16x16x32_bf16 a[96:99], v[212:215], v[104:107], a[96:99]
s_add_u32 s89, s33, 67112960
ds_read_b64_tr_b16 v[52:53], v9 offset:16384
v_and_b32 v177, 0xffff0000, v176
v_mfma_f32_16x16x32_bf16 a[96:99], v[208:211], v[112:115], a[96:99]
s_add_u32 s90, s33, 67117056
ds_read_b64_tr_b16 v[54:55], v9 offset:20480
v_lshlrev_b32 v176, 16, v176
v_mfma_f32_16x16x32_bf16 a[100:103], v[208:211], v[116:119], a[100:103]
ds_read_b64_tr_b16 v[48:49], v9 offset:24576
buffer_load_dwordx4 a[92:95], v0, s[76:79], s7 offen offset:3072 sc1
v_mfma_f32_16x16x32_bf16 a[100:103], v[212:215], v[108:111], a[100:103]
s_waitcnt lgkmcnt(7)
ds_read_b64_tr_b16 v[50:51], v9 offset:28672
v_accvgpr_read_b32 v179, a245
v_mfma_f32_16x16x32_bf16 a[96:99], v[60:63], v[120:123], a[96:99]
s_waitcnt vmcnt(9)
s_add_u32 s91, s33, 67121152
ds_read_b64_tr_b16 v[200:201], v9 offset:32768
v_lshlrev_b32 v178, 16, v179
v_mfma_f32_16x16x32_bf16 a[96:99], v[56:59], v[128:131], a[96:99]
s_waitcnt vmcnt(8)
ds_read_b64_tr_b16 v[202:203], v9 offset:36864
v_and_b32 v179, 0xffff0000, v179
v_mfma_f32_16x16x32_bf16 a[100:103], v[56:59], v[132:135], a[100:103]
ds_read_b64_tr_b16 v[204:205], v9 offset:40960
buffer_load_dwordx4 a[192:195], v0, s[76:79], s94 offen offset:0 sc1
v_mfma_f32_16x16x32_bf16 a[100:103], v[60:63], v[124:127], a[100:103]
s_waitcnt lgkmcnt(7)
ds_read_b64_tr_b16 v[206:207], v9 offset:45056
v_mul_f32 v178, v178, v28
v_mfma_f32_16x16x32_bf16 a[112:115], v[44:47], a[160:163], a[112:115]
ds_read_b64_tr_b16 v[208:209], v9 offset:49152
v_mul_f32 v179, v179, v29
v_mfma_f32_16x16x32_bf16 a[112:115], v[40:43], a[168:171], a[112:115]
ds_read_b64_tr_b16 v[210:211], v9 offset:53248
v_cvt_pk_bf16_f32 v178, v178, v179
v_mfma_f32_16x16x32_bf16 a[116:119], v[40:43], a[172:175], a[116:119]
ds_read_b64_tr_b16 v[212:213], v9 offset:57344
buffer_load_dwordx4 a[196:199], v0, s[76:79], s95 offen offset:0 sc1
v_mfma_f32_16x16x32_bf16 a[116:119], v[44:47], a[164:167], a[116:119]
s_waitcnt lgkmcnt(7)
ds_read_b64_tr_b16 v[214:215], v9 offset:61440
v_and_b32 v179, 0xffff0000, v178
v_mfma_f32_16x16x32_bf16 a[112:115], v[52:55], a[176:179], a[112:115]
ds_read_b64_tr_b16 v[56:57], v10 offset:0
v_add_u32 v9, s15, v9
v_lshlrev_b32 v178, 16, v178
v_mfma_f32_16x16x32_bf16 a[112:115], v[48:51], a[184:187], a[112:115]
ds_read_b64_tr_b16 v[58:59], v10 offset:4096
v_sub_f32 v7, 1.0, v7
v_mfma_f32_16x16x32_bf16 a[116:119], v[48:51], a[188:191], a[116:119]
ds_read_b64_tr_b16 v[60:61], v10 offset:8192
buffer_load_dwordx4 a[200:203], v0, s[76:79], s94 offen offset:1024 sc1
v_mfma_f32_16x16x32_bf16 a[116:119], v[52:55], a[180:183], a[116:119]
s_waitcnt lgkmcnt(7)
ds_read_b64_tr_b16 v[62:63], v10 offset:12288
v_cvt_pk_bf16_f32 v7, v7, v7
v_mfma_f32_16x16x32_bf16 a[112:115], v[200:203], v[104:107], a[112:115]
ds_read_b64_tr_b16 v[40:41], v10 offset:16384
v_lshlrev_b32 v7, 16, v7
v_mfma_f32_16x16x32_bf16 a[112:115], v[204:207], v[112:115], a[112:115]
ds_read_b64_tr_b16 v[42:43], v10 offset:20480
v_accvgpr_read_b32 v181, a246
v_mfma_f32_16x16x32_bf16 a[116:119], v[204:207], v[116:119], a[116:119]
ds_read_b64_tr_b16 v[44:45], v10 offset:24576
buffer_load_dwordx4 a[204:207], v0, s[76:79], s95 offen offset:1024 sc1
v_mfma_f32_16x16x32_bf16 a[116:119], v[200:203], v[108:111], a[116:119]
s_waitcnt lgkmcnt(7)
ds_read_b64_tr_b16 v[46:47], v10 offset:28672
v_lshlrev_b32 v180, 16, v181
v_mfma_f32_16x16x32_bf16 a[112:115], v[208:211], v[120:123], a[112:115]
ds_read_b64_tr_b16 v[48:49], v10 offset:32768
v_accvgpr_read_b32 v72, a96
v_accvgpr_read_b32 v73, a97
v_mfma_f32_16x16x32_bf16 a[112:115], v[212:215], v[128:131], a[112:115]
ds_read_b64_tr_b16 v[50:51], v10 offset:36864
v_accvgpr_read_b32 v74, a98
v_accvgpr_read_b32 v75, a99
v_mfma_f32_16x16x32_bf16 a[116:119], v[212:215], v[132:135], a[116:119]
ds_read_b64_tr_b16 v[52:53], v10 offset:40960
buffer_load_dwordx4 a[208:211], v0, s[76:79], s94 offen offset:2048 sc1
v_mfma_f32_16x16x32_bf16 a[116:119], v[208:211], v[124:127], a[116:119]
s_waitcnt lgkmcnt(7)
ds_read_b64_tr_b16 v[54:55], v10 offset:45056
v_accvgpr_read_b32 v76, a100
v_mfma_f32_16x16x32_bf16 a[128:131], v[56:59], a[160:163], a[128:131]
ds_read_b64_tr_b16 v[204:205], v10 offset:49152
v_accvgpr_read_b32 v77, a101
v_accvgpr_read_b32 v78, a102
v_mfma_f32_16x16x32_bf16 a[128:131], v[60:63], a[168:171], a[128:131]
ds_read_b64_tr_b16 v[206:207], v10 offset:53248
v_accvgpr_read_b32 v79, a103
v_cvt_pk_bf16_f32 v232, v72, v73
v_mfma_f32_16x16x32_bf16 a[132:135], v[60:63], a[172:175], a[132:135]
ds_read_b64_tr_b16 v[200:201], v10 offset:57344
buffer_load_dwordx4 a[212:215], v0, s[76:79], s95 offen offset:2048 sc1
v_mfma_f32_16x16x32_bf16 a[132:135], v[56:59], a[164:167], a[132:135]
s_waitcnt lgkmcnt(7)
ds_read_b64_tr_b16 v[202:203], v10 offset:61440
v_cvt_pk_bf16_f32 v233, v74, v75
v_mfma_f32_16x16x32_bf16 a[128:131], v[40:43], a[176:179], a[128:131]
ds_read_b64_tr_b16 v[212:213], v11 offset:0
v_add_u32 v10, s15, v10
v_cvt_pk_bf16_f32 v234, v76, v77
v_mfma_f32_16x16x32_bf16 a[128:131], v[44:47], a[184:187], a[128:131]
ds_read_b64_tr_b16 v[214:215], v11 offset:4096
v_cvt_pk_bf16_f32 v235, v78, v79
v_min_u32 v232, -2, v232
v_mfma_f32_16x16x32_bf16 a[132:135], v[44:47], a[188:191], a[132:135]
ds_read_b64_tr_b16 v[208:209], v11 offset:8192
buffer_load_dwordx4 a[216:219], v0, s[76:79], s94 offen offset:3072 sc1
v_mfma_f32_16x16x32_bf16 a[132:135], v[40:43], a[180:183], a[132:135]
s_waitcnt lgkmcnt(7)
ds_read_b64_tr_b16 v[210:211], v11 offset:12288
v_and_b32 v181, 0xffff0000, v181
v_mfma_f32_16x16x32_bf16 a[128:131], v[48:51], v[104:107], a[128:131]
ds_read_b64_tr_b16 v[60:61], v11 offset:16384
buffer_store_dwordx4 v[232:235], v0, s[76:79], s56 offen offset:0 sc1
v_mfma_f32_16x16x32_bf16 a[128:131], v[52:55], v[112:115], a[128:131]
ds_read_b64_tr_b16 v[62:63], v11 offset:20480
v_mul_f32 v180, v180, v26
v_mfma_f32_16x16x32_bf16 a[132:135], v[52:55], v[116:119], a[132:135]
ds_read_b64_tr_b16 v[56:57], v11 offset:24576
buffer_load_dwordx4 a[220:223], v0, s[76:79], s95 offen offset:3072 sc1
v_mfma_f32_16x16x32_bf16 a[132:135], v[48:51], v[108:111], a[132:135]
s_waitcnt lgkmcnt(7)
ds_read_b64_tr_b16 v[58:59], v11 offset:28672
v_accvgpr_read_b32 v80, a112
v_mfma_f32_16x16x32_bf16 a[128:131], v[204:207], v[120:123], a[128:131]
ds_read_b64_tr_b16 v[44:45], v11 offset:32768
v_accvgpr_read_b32 v81, a113
v_accvgpr_read_b32 v82, a114
v_mfma_f32_16x16x32_bf16 a[128:131], v[200:203], v[128:131], a[128:131]
ds_read_b64_tr_b16 v[46:47], v11 offset:36864
v_accvgpr_read_b32 v83, a115
v_accvgpr_read_b32 v84, a116
v_mfma_f32_16x16x32_bf16 a[132:135], v[200:203], v[132:135], a[132:135]
ds_read_b64_tr_b16 v[40:41], v11 offset:40960
buffer_load_dwordx4 v[136:139], v0, s[76:79], s98 offen offset:0 sc1
v_mfma_f32_16x16x32_bf16 a[132:135], v[204:207], v[124:127], a[132:135]
s_waitcnt lgkmcnt(7)
ds_read_b64_tr_b16 v[42:43], v11 offset:45056
v_accvgpr_read_b32 v85, a117
v_mfma_f32_16x16x32_bf16 a[144:147], v[212:215], a[160:163], a[144:147]
ds_read_b64_tr_b16 v[52:53], v11 offset:49152
v_accvgpr_read_b32 v86, a118
v_accvgpr_read_b32 v87, a119
v_mfma_f32_16x16x32_bf16 a[144:147], v[208:211], a[168:171], a[144:147]
ds_read_b64_tr_b16 v[54:55], v11 offset:53248
v_cvt_pk_bf16_f32 v236, v80, v81
v_cvt_pk_bf16_f32 v237, v82, v83
v_mfma_f32_16x16x32_bf16 a[148:151], v[208:211], a[172:175], a[148:151]
ds_read_b64_tr_b16 v[48:49], v11 offset:57344
buffer_load_dwordx4 v[140:143], v0, s[76:79], s99 offen offset:0 sc1
v_mfma_f32_16x16x32_bf16 a[148:151], v[212:215], a[164:167], a[148:151]
s_waitcnt lgkmcnt(7)
ds_read_b64_tr_b16 v[50:51], v11 offset:61440
v_cvt_pk_bf16_f32 v238, v84, v85
v_mfma_f32_16x16x32_bf16 a[144:147], v[60:63], a[176:179], a[144:147]
ds_read_b64_tr_b16 v[200:201], v12 offset:0
v_add_u32 v11, s15, v11
v_cvt_pk_bf16_f32 v239, v86, v87
v_mfma_f32_16x16x32_bf16 a[144:147], v[56:59], a[184:187], a[144:147]
ds_read_b64_tr_b16 v[202:203], v12 offset:4096
v_min_u32 v236, -2, v236
v_mul_f32 v181, v181, v27
v_mfma_f32_16x16x32_bf16 a[148:151], v[56:59], a[188:191], a[148:151]
ds_read_b64_tr_b16 v[204:205], v12 offset:8192
buffer_load_dwordx4 v[144:147], v0, s[76:79], s98 offen offset:1024 sc1
v_mfma_f32_16x16x32_bf16 a[148:151], v[60:63], a[180:183], a[148:151]
s_waitcnt lgkmcnt(7)
ds_read_b64_tr_b16 v[206:207], v12 offset:12288
v_cvt_pk_bf16_f32 v180, v180, v181
v_mfma_f32_16x16x32_bf16 a[144:147], v[44:47], v[104:107], a[144:147]
ds_read_b64_tr_b16 v[208:209], v12 offset:16384
buffer_store_dwordx4 v[236:239], v0, s[76:79], s57 offen offset:0 sc1
v_mfma_f32_16x16x32_bf16 a[144:147], v[40:43], v[112:115], a[144:147]
ds_read_b64_tr_b16 v[210:211], v12 offset:20480
v_accvgpr_read_b32 v88, a128
v_accvgpr_read_b32 v89, a129
v_mfma_f32_16x16x32_bf16 a[148:151], v[40:43], v[116:119], a[148:151]
ds_read_b64_tr_b16 v[212:213], v12 offset:24576
buffer_load_dwordx4 v[148:151], v0, s[76:79], s99 offen offset:1024 sc1
v_mfma_f32_16x16x32_bf16 a[148:151], v[44:47], v[108:111], a[148:151]
s_waitcnt lgkmcnt(7)
ds_read_b64_tr_b16 v[214:215], v12 offset:28672
v_accvgpr_read_b32 v90, a130
v_mfma_f32_16x16x32_bf16 a[144:147], v[52:55], v[120:123], a[144:147]
ds_read_b64_tr_b16 v[56:57], v12 offset:32768
v_accvgpr_read_b32 v91, a131
v_accvgpr_read_b32 v92, a132
v_mfma_f32_16x16x32_bf16 a[144:147], v[48:51], v[128:131], a[144:147]
ds_read_b64_tr_b16 v[58:59], v12 offset:36864
v_accvgpr_read_b32 v93, a133
v_accvgpr_read_b32 v94, a134
v_mfma_f32_16x16x32_bf16 a[148:151], v[48:51], v[132:135], a[148:151]
ds_read_b64_tr_b16 v[60:61], v12 offset:40960
buffer_load_dwordx4 v[152:155], v0, s[76:79], s98 offen offset:2048 sc1
v_mfma_f32_16x16x32_bf16 a[148:151], v[52:55], v[124:127], a[148:151]
s_waitcnt lgkmcnt(7)
ds_read_b64_tr_b16 v[62:63], v12 offset:45056
v_accvgpr_read_b32 v95, a135
v_mfma_f32_16x16x32_bf16 a[0:3], v[200:203], a[160:163], a[0:3]
ds_read_b64_tr_b16 v[40:41], v12 offset:49152
v_cvt_pk_bf16_f32 v240, v88, v89
v_cvt_pk_bf16_f32 v241, v90, v91
v_mfma_f32_16x16x32_bf16 a[0:3], v[204:207], a[168:171], a[0:3]
ds_read_b64_tr_b16 v[42:43], v12 offset:53248
v_cvt_pk_bf16_f32 v242, v92, v93
v_cvt_pk_bf16_f32 v243, v94, v95
v_mfma_f32_16x16x32_bf16 a[4:7], v[204:207], a[172:175], a[4:7]
ds_read_b64_tr_b16 v[44:45], v12 offset:57344
buffer_load_dwordx4 v[156:159], v0, s[76:79], s99 offen offset:2048 sc1
v_mfma_f32_16x16x32_bf16 a[4:7], v[200:203], a[164:167], a[4:7]
s_waitcnt lgkmcnt(7)
ds_read_b64_tr_b16 v[46:47], v12 offset:61440
v_min_u32 v240, -2, v240
v_mfma_f32_16x16x32_bf16 a[0:3], v[208:211], a[176:179], a[0:3]
ds_read_b64_tr_b16 v[48:49], v13 offset:0
v_add_u32 v12, s15, v12
v_and_b32 v181, 0xffff0000, v180
v_mfma_f32_16x16x32_bf16 a[0:3], v[212:215], a[184:187], a[0:3]
ds_read_b64_tr_b16 v[50:51], v13 offset:4096
buffer_store_dwordx4 v[240:243], v0, s[76:79], s58 offen offset:0 sc1
v_mfma_f32_16x16x32_bf16 a[4:7], v[212:215], a[188:191], a[4:7]
ds_read_b64_tr_b16 v[52:53], v13 offset:8192
buffer_load_dwordx4 v[160:163], v0, s[76:79], s98 offen offset:3072 sc1
v_mfma_f32_16x16x32_bf16 a[4:7], v[208:211], a[180:183], a[4:7]
s_waitcnt lgkmcnt(7)
ds_read_b64_tr_b16 v[54:55], v13 offset:12288
v_accvgpr_read_b32 v72, a144
v_mfma_f32_16x16x32_bf16 a[0:3], v[56:59], v[104:107], a[0:3]
ds_read_b64_tr_b16 v[204:205], v13 offset:16384
v_accvgpr_read_b32 v73, a145
v_accvgpr_read_b32 v74, a146
v_mfma_f32_16x16x32_bf16 a[0:3], v[60:63], v[112:115], a[0:3]
ds_read_b64_tr_b16 v[206:207], v13 offset:20480
v_accvgpr_read_b32 v75, a147
v_accvgpr_read_b32 v76, a148
v_mfma_f32_16x16x32_bf16 a[4:7], v[60:63], v[116:119], a[4:7]
ds_read_b64_tr_b16 v[200:201], v13 offset:24576
buffer_load_dwordx4 v[164:167], v0, s[76:79], s99 offen offset:3072 sc1
v_mfma_f32_16x16x32_bf16 a[4:7], v[56:59], v[108:111], a[4:7]
s_waitcnt lgkmcnt(7)
ds_read_b64_tr_b16 v[202:203], v13 offset:28672
v_accvgpr_read_b32 v77, a149
v_mfma_f32_16x16x32_bf16 a[0:3], v[40:43], v[120:123], a[0:3]
ds_read_b64_tr_b16 v[212:213], v13 offset:32768
v_accvgpr_read_b32 v78, a150
v_accvgpr_read_b32 v79, a151
v_mfma_f32_16x16x32_bf16 a[0:3], v[44:47], v[128:131], a[0:3]
ds_read_b64_tr_b16 v[214:215], v13 offset:36864
v_cvt_pk_bf16_f32 v244, v72, v73
v_cvt_pk_bf16_f32 v245, v74, v75
v_mfma_f32_16x16x32_bf16 a[4:7], v[44:47], v[132:135], a[4:7]
ds_read_b64_tr_b16 v[208:209], v13 offset:40960
v_cvt_pk_bf16_f32 v246, v76, v77
v_cvt_pk_bf16_f32 v247, v78, v79
v_mfma_f32_16x16x32_bf16 a[4:7], v[40:43], v[124:127], a[4:7]
s_waitcnt lgkmcnt(7)
ds_read_b64_tr_b16 v[210:211], v13 offset:45056
v_min_u32 v244, -2, v244
v_mfma_f32_16x16x32_bf16 a[16:19], v[48:51], a[160:163], a[16:19]
ds_read_b64_tr_b16 v[60:61], v13 offset:49152
buffer_store_dwordx4 v[244:247], v0, s[76:79], s59 offen offset:0 sc1
v_mfma_f32_16x16x32_bf16 a[16:19], v[52:55], a[168:171], a[16:19]
ds_read_b64_tr_b16 v[62:63], v13 offset:53248
v_lshlrev_b32 v180, 16, v180
v_mfma_f32_16x16x32_bf16 a[20:23], v[52:55], a[172:175], a[20:23]
ds_read_b64_tr_b16 v[56:57], v13 offset:57344
v_accvgpr_read_b32 v183, a247
v_mfma_f32_16x16x32_bf16 a[20:23], v[48:51], a[164:167], a[20:23]
s_waitcnt lgkmcnt(7)
ds_read_b64_tr_b16 v[58:59], v13 offset:61440
v_lshlrev_b32 v182, 16, v183
v_mfma_f32_16x16x32_bf16 a[16:19], v[204:207], a[176:179], a[16:19]
ds_read_b64_tr_b16 v[44:45], v14 offset:0
v_add_u32 v13, s15, v13
v_accvgpr_read_b32 v80, a0
v_mfma_f32_16x16x32_bf16 a[16:19], v[200:203], a[184:187], a[16:19]
ds_read_b64_tr_b16 v[46:47], v14 offset:4096
v_accvgpr_read_b32 v81, a1
v_accvgpr_read_b32 v82, a2
v_mfma_f32_16x16x32_bf16 a[20:23], v[200:203], a[188:191], a[20:23]
ds_read_b64_tr_b16 v[40:41], v14 offset:8192
v_accvgpr_read_b32 v83, a3
v_accvgpr_read_b32 v84, a4
v_mfma_f32_16x16x32_bf16 a[20:23], v[204:207], a[180:183], a[20:23]
s_waitcnt lgkmcnt(7)
ds_read_b64_tr_b16 v[42:43], v14 offset:12288
v_accvgpr_read_b32 v85, a5
v_mfma_f32_16x16x32_bf16 a[16:19], v[212:215], v[104:107], a[16:19]
ds_read_b64_tr_b16 v[52:53], v14 offset:16384
v_accvgpr_read_b32 v86, a6
v_accvgpr_read_b32 v87, a7
v_mfma_f32_16x16x32_bf16 a[16:19], v[208:211], v[112:115], a[16:19]
ds_read_b64_tr_b16 v[54:55], v14 offset:20480
v_cvt_pk_bf16_f32 v248, v80, v81
v_cvt_pk_bf16_f32 v249, v82, v83
v_mfma_f32_16x16x32_bf16 a[20:23], v[208:211], v[116:119], a[20:23]
ds_read_b64_tr_b16 v[48:49], v14 offset:24576
v_cvt_pk_bf16_f32 v250, v84, v85
v_cvt_pk_bf16_f32 v251, v86, v87
v_mfma_f32_16x16x32_bf16 a[20:23], v[212:215], v[108:111], a[20:23]
s_waitcnt lgkmcnt(7)
ds_read_b64_tr_b16 v[50:51], v14 offset:28672
v_min_u32 v248, -2, v248
v_mfma_f32_16x16x32_bf16 a[16:19], v[60:63], v[120:123], a[16:19]
ds_read_b64_tr_b16 v[200:201], v14 offset:32768
buffer_store_dwordx4 v[248:251], v0, s[76:79], s60 offen offset:0 sc1
v_mfma_f32_16x16x32_bf16 a[16:19], v[56:59], v[128:131], a[16:19]
ds_read_b64_tr_b16 v[202:203], v14 offset:36864
v_and_b32 v183, 0xffff0000, v183
v_mfma_f32_16x16x32_bf16 a[20:23], v[56:59], v[132:135], a[20:23]
ds_read_b64_tr_b16 v[204:205], v14 offset:40960
v_mul_f32 v182, v182, v28
v_mfma_f32_16x16x32_bf16 a[20:23], v[60:63], v[124:127], a[20:23]
s_waitcnt lgkmcnt(7)
ds_read_b64_tr_b16 v[206:207], v14 offset:45056
v_mul_f32 v183, v183, v29
v_mfma_f32_16x16x32_bf16 a[224:227], v[44:47], a[160:163], a[224:227]
ds_read_b64_tr_b16 v[208:209], v14 offset:49152
v_cvt_pk_bf16_f32 v182, v182, v183
v_mfma_f32_16x16x32_bf16 a[224:227], v[40:43], a[168:171], a[224:227]
ds_read_b64_tr_b16 v[210:211], v14 offset:53248
v_and_b32 v183, 0xffff0000, v182
v_mfma_f32_16x16x32_bf16 a[228:231], v[40:43], a[172:175], a[228:231]
ds_read_b64_tr_b16 v[212:213], v14 offset:57344
v_accvgpr_read_b32 v88, a16
v_accvgpr_read_b32 v89, a17
v_mfma_f32_16x16x32_bf16 a[228:231], v[44:47], a[164:167], a[228:231]
s_waitcnt lgkmcnt(7)
ds_read_b64_tr_b16 v[214:215], v14 offset:61440
v_accvgpr_read_b32 v90, a18
v_mfma_f32_16x16x32_bf16 a[224:227], v[52:55], a[176:179], a[224:227]
ds_read_b64_tr_b16 v[56:57], v8 offset:0
v_add_u32 v14, s15, v14
v_accvgpr_read_b32 v91, a19
v_mfma_f32_16x16x32_bf16 a[224:227], v[48:51], a[184:187], a[224:227]
ds_read_b64_tr_b16 v[58:59], v8 offset:4096
v_accvgpr_read_b32 v92, a20
v_accvgpr_read_b32 v93, a21
v_mfma_f32_16x16x32_bf16 a[228:231], v[48:51], a[188:191], a[228:231]
ds_read_b64_tr_b16 v[60:61], v8 offset:8192
v_accvgpr_read_b32 v94, a22
v_accvgpr_read_b32 v95, a23
v_mfma_f32_16x16x32_bf16 a[228:231], v[52:55], a[180:183], a[228:231]
s_waitcnt lgkmcnt(7)
ds_read_b64_tr_b16 v[62:63], v8 offset:12288
v_cvt_pk_bf16_f32 v252, v88, v89
v_mfma_f32_16x16x32_bf16 a[224:227], v[200:203], v[104:107], a[224:227]
ds_read_b64_tr_b16 v[40:41], v8 offset:16384
v_cvt_pk_bf16_f32 v253, v90, v91
v_cvt_pk_bf16_f32 v254, v92, v93
v_mfma_f32_16x16x32_bf16 a[224:227], v[204:207], v[112:115], a[224:227]
ds_read_b64_tr_b16 v[42:43], v8 offset:20480
v_cvt_pk_bf16_f32 v255, v94, v95
v_min_u32 v252, -2, v252
v_mfma_f32_16x16x32_bf16 a[228:231], v[204:207], v[116:119], a[228:231]
ds_read_b64_tr_b16 v[44:45], v8 offset:24576
buffer_store_dwordx4 v[252:255], v0, s[76:79], s61 offen offset:0 sc1
v_mfma_f32_16x16x32_bf16 a[228:231], v[200:203], v[108:111], a[228:231]
s_waitcnt lgkmcnt(7)
ds_read_b64_tr_b16 v[46:47], v8 offset:28672
v_subrev_u32 v8, s15, v8
v_mfma_f32_16x16x32_bf16 a[224:227], v[208:211], v[120:123], a[224:227]
ds_read_b64_tr_b16 v[48:49], v8 offset:0
v_lshlrev_b32 v182, 16, v182
v_mfma_f32_16x16x32_bf16 a[224:227], v[212:215], v[128:131], a[224:227]
ds_read_b64_tr_b16 v[50:51], v8 offset:4096
v_fmac_f32 v216, v168, v4
v_fmac_f32 v217, v169, v4
v_mfma_f32_16x16x32_bf16 a[228:231], v[212:215], v[132:135], a[228:231]
ds_read_b64_tr_b16 v[52:53], v8 offset:8192
v_fmac_f32 v218, v170, v4
v_fmac_f32 v219, v171, v4
v_mfma_f32_16x16x32_bf16 a[228:231], v[208:211], v[124:127], a[228:231]
s_waitcnt vmcnt(29) lgkmcnt(7)
ds_read_b64_tr_b16 v[54:55], v8 offset:12288
v_fmac_f32 v220, v172, v5
v_mfma_f32_16x16x32_bf16 a[104:107], v[56:59], a[64:67], a[104:107]
s_waitcnt vmcnt(27)
ds_read_b64_tr_b16 v[204:205], v8 offset:16384
v_fmac_f32 v221, v173, v5
v_fmac_f32 v222, v174, v5
v_mfma_f32_16x16x32_bf16 a[104:107], v[60:63], a[72:75], a[104:107]
s_waitcnt vmcnt(26)
ds_read_b64_tr_b16 v[206:207], v8 offset:20480
v_fmac_f32 v223, v175, v5
v_fmac_f32 v224, v176, v6
v_mfma_f32_16x16x32_bf16 a[108:111], v[60:63], a[76:79], a[108:111]
ds_read_b64_tr_b16 v[200:201], v8 offset:24576
v_accvgpr_read_b32 v72, a224
v_accvgpr_read_b32 v73, a225
v_mfma_f32_16x16x32_bf16 a[108:111], v[56:59], a[68:71], a[108:111]
s_waitcnt vmcnt(25) lgkmcnt(7)
ds_read_b64_tr_b16 v[202:203], v8 offset:28672
v_accvgpr_read_b32 v74, a226
v_mfma_f32_16x16x32_bf16 a[104:107], v[40:43], a[80:83], a[104:107]
s_waitcnt vmcnt(23)
ds_read_b64_tr_b16 v[212:213], v8 offset:32768
v_accvgpr_read_b32 v75, a227
v_accvgpr_read_b32 v76, a228
v_mfma_f32_16x16x32_bf16 a[104:107], v[44:47], a[88:91], a[104:107]
s_waitcnt vmcnt(22)
ds_read_b64_tr_b16 v[214:215], v8 offset:36864
v_accvgpr_read_b32 v77, a229
v_accvgpr_read_b32 v78, a230
v_mfma_f32_16x16x32_bf16 a[108:111], v[44:47], a[92:95], a[108:111]
ds_read_b64_tr_b16 v[208:209], v8 offset:40960
v_accvgpr_read_b32 v79, a231
v_cvt_pk_bf16_f32 v64, v72, v73
v_mfma_f32_16x16x32_bf16 a[108:111], v[40:43], a[84:87], a[108:111]
s_waitcnt vmcnt(21) lgkmcnt(7)
ds_read_b64_tr_b16 v[210:211], v8 offset:45056
v_cvt_pk_bf16_f32 v65, v74, v75
v_mfma_f32_16x16x32_bf16 a[104:107], v[48:51], a[192:195], a[104:107]
s_waitcnt vmcnt(19)
ds_read_b64_tr_b16 v[60:61], v8 offset:49152
v_cvt_pk_bf16_f32 v66, v76, v77
v_cvt_pk_bf16_f32 v67, v78, v79
v_mfma_f32_16x16x32_bf16 a[104:107], v[52:55], a[200:203], a[104:107]
s_waitcnt vmcnt(18)
ds_read_b64_tr_b16 v[62:63], v8 offset:53248
v_min_u32 v64, -2, v64
v_fmac_f32 v225, v177, v6
v_mfma_f32_16x16x32_bf16 a[108:111], v[52:55], a[204:207], a[108:111]
ds_read_b64_tr_b16 v[56:57], v8 offset:57344
buffer_store_dwordx4 v[64:67], v0, s[76:79], s62 offen offset:0 sc1
v_mfma_f32_16x16x32_bf16 a[108:111], v[48:51], a[196:199], a[108:111]
s_waitcnt vmcnt(18) lgkmcnt(7)
ds_read_b64_tr_b16 v[58:59], v8 offset:61440
v_fmac_f32 v226, v178, v6
v_mfma_f32_16x16x32_bf16 a[104:107], v[204:207], a[208:211], a[104:107]
s_waitcnt vmcnt(16)
ds_read_b64_tr_b16 v[44:45], v9 offset:0
v_fmac_f32 v227, v179, v6
v_fmac_f32 v228, v180, v7
v_mfma_f32_16x16x32_bf16 a[104:107], v[200:203], a[216:219], a[104:107]
s_waitcnt vmcnt(14)
ds_read_b64_tr_b16 v[46:47], v9 offset:4096
v_fmac_f32 v229, v181, v7
v_fmac_f32 v230, v182, v7
v_mfma_f32_16x16x32_bf16 a[108:111], v[200:203], a[220:223], a[108:111]
ds_read_b64_tr_b16 v[40:41], v9 offset:8192
v_fmac_f32 v231, v183, v7
v_mfma_f32_16x16x32_bf16 a[108:111], v[204:207], a[212:215], a[108:111]
s_waitcnt vmcnt(13) lgkmcnt(7)
ds_read_b64_tr_b16 v[42:43], v9 offset:12288
v_mfma_f32_16x16x32_bf16 a[104:107], v[212:215], v[136:139], a[104:107]
s_waitcnt vmcnt(11)
ds_read_b64_tr_b16 v[52:53], v9 offset:16384
v_mfma_f32_16x16x32_bf16 a[104:107], v[208:211], v[144:147], a[104:107]
s_waitcnt vmcnt(9)
ds_read_b64_tr_b16 v[54:55], v9 offset:20480
v_mfma_f32_16x16x32_bf16 a[108:111], v[208:211], v[148:151], a[108:111]
ds_read_b64_tr_b16 v[48:49], v9 offset:24576
v_mfma_f32_16x16x32_bf16 a[108:111], v[212:215], v[140:143], a[108:111]
s_waitcnt vmcnt(8) lgkmcnt(7)
ds_read_b64_tr_b16 v[50:51], v9 offset:28672
v_subrev_u32 v9, s15, v9
v_mfma_f32_16x16x32_bf16 a[104:107], v[60:63], v[152:155], a[104:107]
s_waitcnt vmcnt(5)
ds_read_b64_tr_b16 v[200:201], v9 offset:0
v_mfma_f32_16x16x32_bf16 a[104:107], v[56:59], v[160:163], a[104:107]
s_waitcnt vmcnt(4)
ds_read_b64_tr_b16 v[202:203], v9 offset:4096
v_mfma_f32_16x16x32_bf16 a[108:111], v[56:59], v[164:167], a[108:111]
ds_read_b64_tr_b16 v[204:205], v9 offset:8192
v_mfma_f32_16x16x32_bf16 a[108:111], v[60:63], v[156:159], a[108:111]
s_waitcnt lgkmcnt(7)
ds_read_b64_tr_b16 v[206:207], v9 offset:12288
v_mfma_f32_16x16x32_bf16 a[120:123], v[44:47], a[64:67], a[120:123]
ds_read_b64_tr_b16 v[208:209], v9 offset:16384
v_mfma_f32_16x16x32_bf16 a[120:123], v[40:43], a[72:75], a[120:123]
ds_read_b64_tr_b16 v[210:211], v9 offset:20480
v_mfma_f32_16x16x32_bf16 a[124:127], v[40:43], a[76:79], a[124:127]
ds_read_b64_tr_b16 v[212:213], v9 offset:24576
v_accvgpr_read_b32 v80, a104
v_accvgpr_read_b32 v81, a105
v_mfma_f32_16x16x32_bf16 a[124:127], v[44:47], a[68:71], a[124:127]
s_waitcnt lgkmcnt(7)
ds_read_b64_tr_b16 v[214:215], v9 offset:28672
v_accvgpr_read_b32 v82, a106
v_mfma_f32_16x16x32_bf16 a[120:123], v[52:55], a[80:83], a[120:123]
ds_read_b64_tr_b16 v[56:57], v9 offset:32768
v_accvgpr_read_b32 v83, a107
v_accvgpr_read_b32 v84, a108
v_mfma_f32_16x16x32_bf16 a[120:123], v[48:51], a[88:91], a[120:123]
ds_read_b64_tr_b16 v[58:59], v9 offset:36864
v_accvgpr_read_b32 v85, a109
v_accvgpr_read_b32 v86, a110
v_mfma_f32_16x16x32_bf16 a[124:127], v[48:51], a[92:95], a[124:127]
ds_read_b64_tr_b16 v[60:61], v9 offset:40960
v_accvgpr_read_b32 v87, a111
v_cvt_pk_bf16_f32 v80, v80, v81
v_mfma_f32_16x16x32_bf16 a[124:127], v[52:55], a[84:87], a[124:127]
s_waitcnt lgkmcnt(7)
ds_read_b64_tr_b16 v[62:63], v9 offset:45056
v_cvt_pk_bf16_f32 v81, v82, v83
v_mfma_f32_16x16x32_bf16 a[120:123], v[200:203], a[192:195], a[120:123]
ds_read_b64_tr_b16 v[40:41], v9 offset:49152
v_cvt_pk_bf16_f32 v82, v84, v85
v_cvt_pk_bf16_f32 v83, v86, v87
v_mfma_f32_16x16x32_bf16 a[120:123], v[204:207], a[200:203], a[120:123]
ds_read_b64_tr_b16 v[42:43], v9 offset:53248
v_min_u32 v80, -2, v80
v_mfma_f32_16x16x32_bf16 a[124:127], v[204:207], a[204:207], a[124:127]
ds_read_b64_tr_b16 v[44:45], v9 offset:57344
buffer_store_dwordx4 v[80:83], v0, s[76:79], s56 offen offset:1024 sc1
v_mfma_f32_16x16x32_bf16 a[124:127], v[200:203], a[196:199], a[124:127]
s_waitcnt lgkmcnt(7)
ds_read_b64_tr_b16 v[46:47], v9 offset:61440
v_mfma_f32_16x16x32_bf16 a[120:123], v[208:211], a[208:211], a[120:123]
ds_read_b64_tr_b16 v[48:49], v10 offset:0
v_mfma_f32_16x16x32_bf16 a[120:123], v[212:215], a[216:219], a[120:123]
ds_read_b64_tr_b16 v[50:51], v10 offset:4096
v_mfma_f32_16x16x32_bf16 a[124:127], v[212:215], a[220:223], a[124:127]
ds_read_b64_tr_b16 v[52:53], v10 offset:8192
v_mfma_f32_16x16x32_bf16 a[124:127], v[208:211], a[212:215], a[124:127]
s_waitcnt lgkmcnt(7)
ds_read_b64_tr_b16 v[54:55], v10 offset:12288
v_mfma_f32_16x16x32_bf16 a[120:123], v[56:59], v[136:139], a[120:123]
ds_read_b64_tr_b16 v[204:205], v10 offset:16384
v_mfma_f32_16x16x32_bf16 a[120:123], v[60:63], v[144:147], a[120:123]
ds_read_b64_tr_b16 v[206:207], v10 offset:20480
v_mfma_f32_16x16x32_bf16 a[124:127], v[60:63], v[148:151], a[124:127]
ds_read_b64_tr_b16 v[200:201], v10 offset:24576
v_mfma_f32_16x16x32_bf16 a[124:127], v[56:59], v[140:143], a[124:127]
s_waitcnt lgkmcnt(7)
ds_read_b64_tr_b16 v[202:203], v10 offset:28672
v_subrev_u32 v10, s15, v10
v_mfma_f32_16x16x32_bf16 a[120:123], v[40:43], v[152:155], a[120:123]
ds_read_b64_tr_b16 v[212:213], v10 offset:0
v_mfma_f32_16x16x32_bf16 a[120:123], v[44:47], v[160:163], a[120:123]
ds_read_b64_tr_b16 v[214:215], v10 offset:4096
v_mfma_f32_16x16x32_bf16 a[124:127], v[44:47], v[164:167], a[124:127]
ds_read_b64_tr_b16 v[208:209], v10 offset:8192
v_mfma_f32_16x16x32_bf16 a[124:127], v[40:43], v[156:159], a[124:127]
s_waitcnt lgkmcnt(7)
ds_read_b64_tr_b16 v[210:211], v10 offset:12288
v_mfma_f32_16x16x32_bf16 a[136:139], v[48:51], a[64:67], a[136:139]
ds_read_b64_tr_b16 v[60:61], v10 offset:16384
v_mfma_f32_16x16x32_bf16 a[136:139], v[52:55], a[72:75], a[136:139]
ds_read_b64_tr_b16 v[62:63], v10 offset:20480
v_mfma_f32_16x16x32_bf16 a[140:143], v[52:55], a[76:79], a[140:143]
ds_read_b64_tr_b16 v[56:57], v10 offset:24576
v_accvgpr_read_b32 v88, a120
v_accvgpr_read_b32 v89, a121
v_mfma_f32_16x16x32_bf16 a[140:143], v[48:51], a[68:71], a[140:143]
s_waitcnt lgkmcnt(7)
ds_read_b64_tr_b16 v[58:59], v10 offset:28672
v_accvgpr_read_b32 v90, a122
v_mfma_f32_16x16x32_bf16 a[136:139], v[204:207], a[80:83], a[136:139]
ds_read_b64_tr_b16 v[44:45], v10 offset:32768
v_accvgpr_read_b32 v91, a123
v_accvgpr_read_b32 v92, a124
v_mfma_f32_16x16x32_bf16 a[136:139], v[200:203], a[88:91], a[136:139]
ds_read_b64_tr_b16 v[46:47], v10 offset:36864
v_accvgpr_read_b32 v93, a125
v_accvgpr_read_b32 v94, a126
v_mfma_f32_16x16x32_bf16 a[140:143], v[200:203], a[92:95], a[140:143]
ds_read_b64_tr_b16 v[40:41], v10 offset:40960
v_accvgpr_read_b32 v95, a127
v_cvt_pk_bf16_f32 v88, v88, v89
v_mfma_f32_16x16x32_bf16 a[140:143], v[204:207], a[84:87], a[140:143]
s_waitcnt lgkmcnt(7)
ds_read_b64_tr_b16 v[42:43], v10 offset:45056
v_cvt_pk_bf16_f32 v89, v90, v91
v_mfma_f32_16x16x32_bf16 a[136:139], v[212:215], a[192:195], a[136:139]
ds_read_b64_tr_b16 v[52:53], v10 offset:49152
v_cvt_pk_bf16_f32 v90, v92, v93
v_cvt_pk_bf16_f32 v91, v94, v95
v_mfma_f32_16x16x32_bf16 a[136:139], v[208:211], a[200:203], a[136:139]
ds_read_b64_tr_b16 v[54:55], v10 offset:53248
v_min_u32 v88, -2, v88
v_mfma_f32_16x16x32_bf16 a[140:143], v[208:211], a[204:207], a[140:143]
ds_read_b64_tr_b16 v[48:49], v10 offset:57344
buffer_store_dwordx4 v[88:91], v0, s[76:79], s57 offen offset:1024 sc1
v_mfma_f32_16x16x32_bf16 a[140:143], v[212:215], a[196:199], a[140:143]
s_waitcnt lgkmcnt(7)
ds_read_b64_tr_b16 v[50:51], v10 offset:61440
v_mfma_f32_16x16x32_bf16 a[136:139], v[60:63], a[208:211], a[136:139]
ds_read_b64_tr_b16 v[200:201], v11 offset:0
v_mfma_f32_16x16x32_bf16 a[136:139], v[56:59], a[216:219], a[136:139]
ds_read_b64_tr_b16 v[202:203], v11 offset:4096
v_mfma_f32_16x16x32_bf16 a[140:143], v[56:59], a[220:223], a[140:143]
ds_read_b64_tr_b16 v[204:205], v11 offset:8192
v_mfma_f32_16x16x32_bf16 a[140:143], v[60:63], a[212:215], a[140:143]
s_waitcnt lgkmcnt(7)
ds_read_b64_tr_b16 v[206:207], v11 offset:12288
v_mfma_f32_16x16x32_bf16 a[136:139], v[44:47], v[136:139], a[136:139]
ds_read_b64_tr_b16 v[208:209], v11 offset:16384
v_mfma_f32_16x16x32_bf16 a[136:139], v[40:43], v[144:147], a[136:139]
ds_read_b64_tr_b16 v[210:211], v11 offset:20480
v_mfma_f32_16x16x32_bf16 a[140:143], v[40:43], v[148:151], a[140:143]
ds_read_b64_tr_b16 v[212:213], v11 offset:24576
v_mfma_f32_16x16x32_bf16 a[140:143], v[44:47], v[140:143], a[140:143]
s_waitcnt lgkmcnt(7)
ds_read_b64_tr_b16 v[214:215], v11 offset:28672
v_subrev_u32 v11, s15, v11
v_mfma_f32_16x16x32_bf16 a[136:139], v[52:55], v[152:155], a[136:139]
ds_read_b64_tr_b16 v[56:57], v11 offset:0
v_mfma_f32_16x16x32_bf16 a[136:139], v[48:51], v[160:163], a[136:139]
ds_read_b64_tr_b16 v[58:59], v11 offset:4096
v_mfma_f32_16x16x32_bf16 a[140:143], v[48:51], v[164:167], a[140:143]
ds_read_b64_tr_b16 v[60:61], v11 offset:8192
v_mfma_f32_16x16x32_bf16 a[140:143], v[52:55], v[156:159], a[140:143]
s_waitcnt lgkmcnt(7)
ds_read_b64_tr_b16 v[62:63], v11 offset:12288
v_mfma_f32_16x16x32_bf16 a[152:155], v[200:203], a[64:67], a[152:155]
ds_read_b64_tr_b16 v[40:41], v11 offset:16384
v_mfma_f32_16x16x32_bf16 a[152:155], v[204:207], a[72:75], a[152:155]
ds_read_b64_tr_b16 v[42:43], v11 offset:20480
v_mfma_f32_16x16x32_bf16 a[156:159], v[204:207], a[76:79], a[156:159]
ds_read_b64_tr_b16 v[44:45], v11 offset:24576
v_accvgpr_read_b32 v72, a136
v_accvgpr_read_b32 v73, a137
v_mfma_f32_16x16x32_bf16 a[156:159], v[200:203], a[68:71], a[156:159]
s_waitcnt lgkmcnt(7)
ds_read_b64_tr_b16 v[46:47], v11 offset:28672
v_accvgpr_read_b32 v74, a138
v_mfma_f32_16x16x32_bf16 a[152:155], v[208:211], a[80:83], a[152:155]
ds_read_b64_tr_b16 v[48:49], v11 offset:32768
v_accvgpr_read_b32 v75, a139
v_accvgpr_read_b32 v76, a140
v_mfma_f32_16x16x32_bf16 a[152:155], v[212:215], a[88:91], a[152:155]
ds_read_b64_tr_b16 v[50:51], v11 offset:36864
v_accvgpr_read_b32 v77, a141
v_accvgpr_read_b32 v78, a142
v_mfma_f32_16x16x32_bf16 a[156:159], v[212:215], a[92:95], a[156:159]
ds_read_b64_tr_b16 v[52:53], v11 offset:40960
v_accvgpr_read_b32 v79, a143
v_cvt_pk_bf16_f32 v72, v72, v73
v_mfma_f32_16x16x32_bf16 a[156:159], v[208:211], a[84:87], a[156:159]
s_waitcnt lgkmcnt(7)
ds_read_b64_tr_b16 v[54:55], v11 offset:45056
v_cvt_pk_bf16_f32 v73, v74, v75
v_mfma_f32_16x16x32_bf16 a[152:155], v[56:59], a[192:195], a[152:155]
ds_read_b64_tr_b16 v[204:205], v11 offset:49152
v_cvt_pk_bf16_f32 v74, v76, v77
v_cvt_pk_bf16_f32 v75, v78, v79
v_mfma_f32_16x16x32_bf16 a[152:155], v[60:63], a[200:203], a[152:155]
ds_read_b64_tr_b16 v[206:207], v11 offset:53248
v_min_u32 v72, -2, v72
v_mfma_f32_16x16x32_bf16 a[156:159], v[60:63], a[204:207], a[156:159]
ds_read_b64_tr_b16 v[200:201], v11 offset:57344
buffer_store_dwordx4 v[72:75], v0, s[76:79], s58 offen offset:1024 sc1
v_mfma_f32_16x16x32_bf16 a[156:159], v[56:59], a[196:199], a[156:159]
s_waitcnt lgkmcnt(7)
ds_read_b64_tr_b16 v[202:203], v11 offset:61440
v_mfma_f32_16x16x32_bf16 a[152:155], v[40:43], a[208:211], a[152:155]
ds_read_b64_tr_b16 v[212:213], v12 offset:0
v_mfma_f32_16x16x32_bf16 a[152:155], v[44:47], a[216:219], a[152:155]
ds_read_b64_tr_b16 v[214:215], v12 offset:4096
v_mfma_f32_16x16x32_bf16 a[156:159], v[44:47], a[220:223], a[156:159]
ds_read_b64_tr_b16 v[208:209], v12 offset:8192
v_mfma_f32_16x16x32_bf16 a[156:159], v[40:43], a[212:215], a[156:159]
s_waitcnt lgkmcnt(7)
ds_read_b64_tr_b16 v[210:211], v12 offset:12288
v_mfma_f32_16x16x32_bf16 a[152:155], v[48:51], v[136:139], a[152:155]
ds_read_b64_tr_b16 v[60:61], v12 offset:16384
v_mfma_f32_16x16x32_bf16 a[152:155], v[52:55], v[144:147], a[152:155]
ds_read_b64_tr_b16 v[62:63], v12 offset:20480
v_mfma_f32_16x16x32_bf16 a[156:159], v[52:55], v[148:151], a[156:159]
ds_read_b64_tr_b16 v[56:57], v12 offset:24576
v_mfma_f32_16x16x32_bf16 a[156:159], v[48:51], v[140:143], a[156:159]
s_waitcnt lgkmcnt(7)
ds_read_b64_tr_b16 v[58:59], v12 offset:28672
v_subrev_u32 v12, s15, v12
v_mfma_f32_16x16x32_bf16 a[152:155], v[204:207], v[152:155], a[152:155]
ds_read_b64_tr_b16 v[44:45], v12 offset:0
v_mfma_f32_16x16x32_bf16 a[152:155], v[200:203], v[160:163], a[152:155]
ds_read_b64_tr_b16 v[46:47], v12 offset:4096
v_mfma_f32_16x16x32_bf16 a[156:159], v[200:203], v[164:167], a[156:159]
ds_read_b64_tr_b16 v[40:41], v12 offset:8192
v_mfma_f32_16x16x32_bf16 a[156:159], v[204:207], v[156:159], a[156:159]
s_waitcnt lgkmcnt(7)
ds_read_b64_tr_b16 v[42:43], v12 offset:12288
v_mfma_f32_16x16x32_bf16 a[8:11], v[212:215], a[64:67], a[8:11]
ds_read_b64_tr_b16 v[52:53], v12 offset:16384
v_mfma_f32_16x16x32_bf16 a[8:11], v[208:211], a[72:75], a[8:11]
ds_read_b64_tr_b16 v[54:55], v12 offset:20480
v_mfma_f32_16x16x32_bf16 a[12:15], v[208:211], a[76:79], a[12:15]
ds_read_b64_tr_b16 v[48:49], v12 offset:24576
v_accvgpr_read_b32 v80, a152
v_accvgpr_read_b32 v81, a153
v_mfma_f32_16x16x32_bf16 a[12:15], v[212:215], a[68:71], a[12:15]
s_waitcnt lgkmcnt(7)
ds_read_b64_tr_b16 v[50:51], v12 offset:28672
v_accvgpr_read_b32 v82, a154
v_mfma_f32_16x16x32_bf16 a[8:11], v[60:63], a[80:83], a[8:11]
ds_read_b64_tr_b16 v[200:201], v12 offset:32768
v_accvgpr_read_b32 v83, a155
v_accvgpr_read_b32 v84, a156
v_mfma_f32_16x16x32_bf16 a[8:11], v[56:59], a[88:91], a[8:11]
ds_read_b64_tr_b16 v[202:203], v12 offset:36864
v_accvgpr_read_b32 v85, a157
v_accvgpr_read_b32 v86, a158
v_mfma_f32_16x16x32_bf16 a[12:15], v[56:59], a[92:95], a[12:15]
ds_read_b64_tr_b16 v[204:205], v12 offset:40960
v_accvgpr_read_b32 v87, a159
v_cvt_pk_bf16_f32 v80, v80, v81
v_mfma_f32_16x16x32_bf16 a[12:15], v[60:63], a[84:87], a[12:15]
s_waitcnt lgkmcnt(7)
ds_read_b64_tr_b16 v[206:207], v12 offset:45056
v_cvt_pk_bf16_f32 v81, v82, v83
v_mfma_f32_16x16x32_bf16 a[8:11], v[44:47], a[192:195], a[8:11]
ds_read_b64_tr_b16 v[208:209], v12 offset:49152
v_cvt_pk_bf16_f32 v82, v84, v85
v_cvt_pk_bf16_f32 v83, v86, v87
v_mfma_f32_16x16x32_bf16 a[8:11], v[40:43], a[200:203], a[8:11]
ds_read_b64_tr_b16 v[210:211], v12 offset:53248
v_min_u32 v80, -2, v80
v_mfma_f32_16x16x32_bf16 a[12:15], v[40:43], a[204:207], a[12:15]
ds_read_b64_tr_b16 v[212:213], v12 offset:57344
buffer_store_dwordx4 v[80:83], v0, s[76:79], s59 offen offset:1024 sc1
v_mfma_f32_16x16x32_bf16 a[12:15], v[44:47], a[196:199], a[12:15]
s_waitcnt lgkmcnt(7)
ds_read_b64_tr_b16 v[214:215], v12 offset:61440
v_mfma_f32_16x16x32_bf16 a[8:11], v[52:55], a[208:211], a[8:11]
ds_read_b64_tr_b16 v[56:57], v13 offset:0
v_mfma_f32_16x16x32_bf16 a[8:11], v[48:51], a[216:219], a[8:11]
ds_read_b64_tr_b16 v[58:59], v13 offset:4096
v_mfma_f32_16x16x32_bf16 a[12:15], v[48:51], a[220:223], a[12:15]
ds_read_b64_tr_b16 v[60:61], v13 offset:8192
v_mfma_f32_16x16x32_bf16 a[12:15], v[52:55], a[212:215], a[12:15]
s_waitcnt lgkmcnt(7)
ds_read_b64_tr_b16 v[62:63], v13 offset:12288
v_mfma_f32_16x16x32_bf16 a[8:11], v[200:203], v[136:139], a[8:11]
ds_read_b64_tr_b16 v[40:41], v13 offset:16384
v_mfma_f32_16x16x32_bf16 a[8:11], v[204:207], v[144:147], a[8:11]
ds_read_b64_tr_b16 v[42:43], v13 offset:20480
v_mfma_f32_16x16x32_bf16 a[12:15], v[204:207], v[148:151], a[12:15]
ds_read_b64_tr_b16 v[44:45], v13 offset:24576
v_mfma_f32_16x16x32_bf16 a[12:15], v[200:203], v[140:143], a[12:15]
s_waitcnt lgkmcnt(7)
ds_read_b64_tr_b16 v[46:47], v13 offset:28672
v_subrev_u32 v13, s15, v13
v_mfma_f32_16x16x32_bf16 a[8:11], v[208:211], v[152:155], a[8:11]
ds_read_b64_tr_b16 v[48:49], v13 offset:0
v_mfma_f32_16x16x32_bf16 a[8:11], v[212:215], v[160:163], a[8:11]
ds_read_b64_tr_b16 v[50:51], v13 offset:4096
v_mfma_f32_16x16x32_bf16 a[12:15], v[212:215], v[164:167], a[12:15]
ds_read_b64_tr_b16 v[52:53], v13 offset:8192
v_mfma_f32_16x16x32_bf16 a[12:15], v[208:211], v[156:159], a[12:15]
s_waitcnt lgkmcnt(7)
ds_read_b64_tr_b16 v[54:55], v13 offset:12288
v_mfma_f32_16x16x32_bf16 a[24:27], v[56:59], a[64:67], a[24:27]
ds_read_b64_tr_b16 v[204:205], v13 offset:16384
v_mfma_f32_16x16x32_bf16 a[24:27], v[60:63], a[72:75], a[24:27]
ds_read_b64_tr_b16 v[206:207], v13 offset:20480
v_mfma_f32_16x16x32_bf16 a[28:31], v[60:63], a[76:79], a[28:31]
ds_read_b64_tr_b16 v[200:201], v13 offset:24576
v_accvgpr_read_b32 v88, a8
v_accvgpr_read_b32 v89, a9
v_mfma_f32_16x16x32_bf16 a[28:31], v[56:59], a[68:71], a[28:31]
s_waitcnt lgkmcnt(7)
ds_read_b64_tr_b16 v[202:203], v13 offset:28672
v_accvgpr_read_b32 v90, a10
v_mfma_f32_16x16x32_bf16 a[24:27], v[40:43], a[80:83], a[24:27]
ds_read_b64_tr_b16 v[212:213], v13 offset:32768
v_accvgpr_read_b32 v91, a11
v_accvgpr_read_b32 v92, a12
v_mfma_f32_16x16x32_bf16 a[24:27], v[44:47], a[88:91], a[24:27]
ds_read_b64_tr_b16 v[214:215], v13 offset:36864
v_accvgpr_read_b32 v93, a13
v_accvgpr_read_b32 v94, a14
v_mfma_f32_16x16x32_bf16 a[28:31], v[44:47], a[92:95], a[28:31]
ds_read_b64_tr_b16 v[208:209], v13 offset:40960
v_accvgpr_read_b32 v95, a15
v_cvt_pk_bf16_f32 v88, v88, v89
v_mfma_f32_16x16x32_bf16 a[28:31], v[40:43], a[84:87], a[28:31]
s_waitcnt lgkmcnt(7)
ds_read_b64_tr_b16 v[210:211], v13 offset:45056
v_cvt_pk_bf16_f32 v89, v90, v91
v_mfma_f32_16x16x32_bf16 a[24:27], v[48:51], a[192:195], a[24:27]
ds_read_b64_tr_b16 v[60:61], v13 offset:49152
v_cvt_pk_bf16_f32 v90, v92, v93
v_cvt_pk_bf16_f32 v91, v94, v95
v_mfma_f32_16x16x32_bf16 a[24:27], v[52:55], a[200:203], a[24:27]
ds_read_b64_tr_b16 v[62:63], v13 offset:53248
v_min_u32 v88, -2, v88
v_mfma_f32_16x16x32_bf16 a[28:31], v[52:55], a[204:207], a[28:31]
ds_read_b64_tr_b16 v[56:57], v13 offset:57344
buffer_store_dwordx4 v[88:91], v0, s[76:79], s60 offen offset:1024 sc1
v_mfma_f32_16x16x32_bf16 a[28:31], v[48:51], a[196:199], a[28:31]
s_waitcnt lgkmcnt(7)
ds_read_b64_tr_b16 v[58:59], v13 offset:61440
v_mfma_f32_16x16x32_bf16 a[24:27], v[204:207], a[208:211], a[24:27]
ds_read_b64_tr_b16 v[44:45], v14 offset:0
v_mfma_f32_16x16x32_bf16 a[24:27], v[200:203], a[216:219], a[24:27]
ds_read_b64_tr_b16 v[46:47], v14 offset:4096
v_mfma_f32_16x16x32_bf16 a[28:31], v[200:203], a[220:223], a[28:31]
ds_read_b64_tr_b16 v[40:41], v14 offset:8192
v_mfma_f32_16x16x32_bf16 a[28:31], v[204:207], a[212:215], a[28:31]
s_waitcnt lgkmcnt(7)
ds_read_b64_tr_b16 v[42:43], v14 offset:12288
v_mfma_f32_16x16x32_bf16 a[24:27], v[212:215], v[136:139], a[24:27]
ds_read_b64_tr_b16 v[52:53], v14 offset:16384
v_mfma_f32_16x16x32_bf16 a[24:27], v[208:211], v[144:147], a[24:27]
ds_read_b64_tr_b16 v[54:55], v14 offset:20480
v_mfma_f32_16x16x32_bf16 a[28:31], v[208:211], v[148:151], a[28:31]
ds_read_b64_tr_b16 v[48:49], v14 offset:24576
v_mfma_f32_16x16x32_bf16 a[28:31], v[212:215], v[140:143], a[28:31]
s_waitcnt lgkmcnt(7)
ds_read_b64_tr_b16 v[50:51], v14 offset:28672
v_subrev_u32 v14, s15, v14
v_mfma_f32_16x16x32_bf16 a[24:27], v[60:63], v[152:155], a[24:27]
ds_read_b64_tr_b16 v[200:201], v14 offset:0
v_mfma_f32_16x16x32_bf16 a[24:27], v[56:59], v[160:163], a[24:27]
ds_read_b64_tr_b16 v[202:203], v14 offset:4096
v_mfma_f32_16x16x32_bf16 a[28:31], v[56:59], v[164:167], a[28:31]
ds_read_b64_tr_b16 v[204:205], v14 offset:8192
v_mfma_f32_16x16x32_bf16 a[28:31], v[60:63], v[156:159], a[28:31]
s_waitcnt lgkmcnt(7)
ds_read_b64_tr_b16 v[206:207], v14 offset:12288
v_mfma_f32_16x16x32_bf16 a[232:235], v[44:47], a[64:67], a[232:235]
ds_read_b64_tr_b16 v[208:209], v14 offset:16384
v_mfma_f32_16x16x32_bf16 a[232:235], v[40:43], a[72:75], a[232:235]
ds_read_b64_tr_b16 v[210:211], v14 offset:20480
v_mfma_f32_16x16x32_bf16 a[236:239], v[40:43], a[76:79], a[236:239]
ds_read_b64_tr_b16 v[212:213], v14 offset:24576
v_accvgpr_read_b32 v72, a24
v_accvgpr_read_b32 v73, a25
v_mfma_f32_16x16x32_bf16 a[236:239], v[44:47], a[68:71], a[236:239]
s_waitcnt lgkmcnt(7)
ds_read_b64_tr_b16 v[214:215], v14 offset:28672
v_accvgpr_read_b32 v74, a26
v_mfma_f32_16x16x32_bf16 a[232:235], v[52:55], a[80:83], a[232:235]
ds_read_b64_tr_b16 v[56:57], v14 offset:32768
v_accvgpr_read_b32 v75, a27
v_accvgpr_read_b32 v76, a28
v_mfma_f32_16x16x32_bf16 a[232:235], v[48:51], a[88:91], a[232:235]
ds_read_b64_tr_b16 v[58:59], v14 offset:36864
v_accvgpr_read_b32 v77, a29
v_accvgpr_read_b32 v78, a30
v_mfma_f32_16x16x32_bf16 a[236:239], v[48:51], a[92:95], a[236:239]
ds_read_b64_tr_b16 v[60:61], v14 offset:40960
v_accvgpr_read_b32 v79, a31
v_cvt_pk_bf16_f32 v72, v72, v73
v_mfma_f32_16x16x32_bf16 a[236:239], v[52:55], a[84:87], a[236:239]
s_waitcnt lgkmcnt(7)
ds_read_b64_tr_b16 v[62:63], v14 offset:45056
v_cvt_pk_bf16_f32 v73, v74, v75
v_mfma_f32_16x16x32_bf16 a[232:235], v[200:203], a[192:195], a[232:235]
ds_read_b64_tr_b16 v[40:41], v14 offset:49152
v_cvt_pk_bf16_f32 v74, v76, v77
v_cvt_pk_bf16_f32 v75, v78, v79
v_mfma_f32_16x16x32_bf16 a[232:235], v[204:207], a[200:203], a[232:235]
ds_read_b64_tr_b16 v[42:43], v14 offset:53248
v_min_u32 v72, -2, v72
v_mfma_f32_16x16x32_bf16 a[236:239], v[204:207], a[204:207], a[236:239]
ds_read_b64_tr_b16 v[44:45], v14 offset:57344
buffer_store_dwordx4 v[72:75], v0, s[76:79], s61 offen offset:1024 sc1
v_mfma_f32_16x16x32_bf16 a[236:239], v[200:203], a[196:199], a[236:239]
s_waitcnt lgkmcnt(7)
ds_read_b64_tr_b16 v[46:47], v14 offset:61440
v_mfma_f32_16x16x32_bf16 a[232:235], v[208:211], a[208:211], a[232:235]
ds_read_b64_tr_b16 v[48:49], v15 offset:0
v_mfma_f32_16x16x32_bf16 a[232:235], v[212:215], a[216:219], a[232:235]
ds_read_b64_tr_b16 v[50:51], v15 offset:4096
v_mfma_f32_16x16x32_bf16 a[236:239], v[212:215], a[220:223], a[236:239]
v_mfma_f32_16x16x32_bf16 a[236:239], v[208:211], a[212:215], a[236:239]
s_waitcnt lgkmcnt(6)
v_mfma_f32_16x16x32_bf16 a[232:235], v[56:59], v[136:139], a[232:235]
ds_read_b64_tr_b16 v[52:53], v15 offset:8192
v_mfma_f32_16x16x32_bf16 a[232:235], v[60:63], v[144:147], a[232:235]
ds_read_b64_tr_b16 v[54:55], v15 offset:12288
v_mfma_f32_16x16x32_bf16 a[236:239], v[60:63], v[148:151], a[236:239]
v_mfma_f32_16x16x32_bf16 a[236:239], v[56:59], v[140:143], a[236:239]
s_waitcnt lgkmcnt(4)
v_mfma_f32_16x16x32_bf16 a[232:235], v[40:43], v[152:155], a[232:235]
ds_read_b64_tr_b16 v[204:205], v15 offset:16384
v_mfma_f32_16x16x32_bf16 a[232:235], v[44:47], v[160:163], a[232:235]
ds_read_b64_tr_b16 v[206:207], v15 offset:20480
v_mfma_f32_16x16x32_bf16 a[236:239], v[44:47], v[164:167], a[236:239]
v_mfma_f32_16x16x32_bf16 a[236:239], v[40:43], v[156:159], a[236:239]
s_waitcnt lgkmcnt(2)
v_mfma_f32_16x16x32_bf16 v[216:219], v[48:51], a[32:35], v[216:219]
ds_read_b64_tr_b16 v[200:201], v15 offset:24576
v_mfma_f32_16x16x32_bf16 v[216:219], v[52:55], a[40:43], v[216:219]
ds_read_b64_tr_b16 v[202:203], v15 offset:28672
v_mfma_f32_16x16x32_bf16 v[220:223], v[52:55], a[44:47], v[220:223]
v_accvgpr_read_b32 v80, a232
v_accvgpr_read_b32 v81, a233
v_accvgpr_read_b32 v82, a234
v_mfma_f32_16x16x32_bf16 v[220:223], v[48:51], a[36:39], v[220:223]
v_subrev_u32 v15, s15, v15
v_accvgpr_read_b32 v83, a235
v_mfma_f32_16x16x32_bf16 v[224:227], v[48:51], a[64:67], v[224:227]
ds_read_b64_tr_b16 v[60:61], v15 offset:0
v_accvgpr_read_b32 v84, a236
v_accvgpr_read_b32 v85, a237
v_mfma_f32_16x16x32_bf16 v[224:227], v[52:55], a[72:75], v[224:227]
ds_read_b64_tr_b16 v[62:63], v15 offset:4096
v_accvgpr_read_b32 v86, a238
v_accvgpr_read_b32 v87, a239
v_mfma_f32_16x16x32_bf16 v[228:231], v[52:55], a[76:79], v[228:231]
v_cvt_pk_bf16_f32 v80, v80, v81
v_cvt_pk_bf16_f32 v81, v82, v83
v_cvt_pk_bf16_f32 v82, v84, v85
v_mfma_f32_16x16x32_bf16 v[228:231], v[48:51], a[68:71], v[228:231]
s_waitcnt lgkmcnt(2)
v_cvt_pk_bf16_f32 v83, v86, v87
v_min_u32 v80, -2, v80
v_mfma_f32_16x16x32_bf16 v[216:219], v[204:207], a[48:51], v[216:219]
ds_read_b64_tr_b16 v[56:57], v15 offset:8192
buffer_store_dwordx4 v[80:83], v0, s[76:79], s62 offen offset:1024 sc1
v_mfma_f32_16x16x32_bf16 v[216:219], v[200:203], a[56:59], v[216:219]
ds_read_b64_tr_b16 v[58:59], v15 offset:12288
v_mfma_f32_16x16x32_bf16 v[220:223], v[200:203], a[60:63], v[220:223]
buffer_load_dwordx4 v[232:235], v0, s[76:79], s88 offen offset:0 sc1
v_mfma_f32_16x16x32_bf16 v[220:223], v[204:207], a[52:55], v[220:223]
v_mfma_f32_16x16x32_bf16 v[224:227], v[204:207], a[80:83], v[224:227]
ds_read_b64_tr_b16 v[44:45], v15 offset:16384
v_mfma_f32_16x16x32_bf16 v[224:227], v[200:203], a[88:91], v[224:227]
ds_read_b64_tr_b16 v[46:47], v15 offset:20480
v_mfma_f32_16x16x32_bf16 v[228:231], v[200:203], a[92:95], v[228:231]
buffer_load_dwordx4 v[236:239], v0, s[76:79], s88 offen offset:2048 sc1
v_mfma_f32_16x16x32_bf16 v[228:231], v[204:207], a[84:87], v[228:231]
s_waitcnt lgkmcnt(2)
v_mfma_f32_16x16x32_bf16 v[216:219], v[60:63], a[160:163], v[216:219]
ds_read_b64_tr_b16 v[40:41], v15 offset:24576
v_mfma_f32_16x16x32_bf16 v[216:219], v[56:59], a[168:171], v[216:219]
ds_read_b64_tr_b16 v[42:43], v15 offset:28672
v_mfma_f32_16x16x32_bf16 v[220:223], v[56:59], a[172:175], v[220:223]
buffer_load_dwordx4 v[240:243], v0, s[76:79], s89 offen offset:0 sc1
v_mfma_f32_16x16x32_bf16 v[220:223], v[60:63], a[164:167], v[220:223]
v_mfma_f32_16x16x32_bf16 v[224:227], v[60:63], a[192:195], v[224:227]
ds_read_b64_tr_b16 v[52:53], v15 offset:32768
v_mfma_f32_16x16x32_bf16 v[224:227], v[56:59], a[200:203], v[224:227]
ds_read_b64_tr_b16 v[54:55], v15 offset:36864
v_mfma_f32_16x16x32_bf16 v[228:231], v[56:59], a[204:207], v[228:231]
buffer_load_dwordx4 v[244:247], v0, s[76:79], s89 offen offset:2048 sc1
v_mfma_f32_16x16x32_bf16 v[228:231], v[60:63], a[196:199], v[228:231]
s_waitcnt lgkmcnt(2)
v_mfma_f32_16x16x32_bf16 v[216:219], v[44:47], a[176:179], v[216:219]
ds_read_b64_tr_b16 v[48:49], v15 offset:40960
v_mfma_f32_16x16x32_bf16 v[216:219], v[40:43], a[184:187], v[216:219]
ds_read_b64_tr_b16 v[50:51], v15 offset:45056
v_mfma_f32_16x16x32_bf16 v[220:223], v[40:43], a[188:191], v[220:223]
buffer_load_dwordx4 v[248:251], v0, s[76:79], s90 offen offset:0 sc1
v_mfma_f32_16x16x32_bf16 v[220:223], v[44:47], a[180:183], v[220:223]
v_mfma_f32_16x16x32_bf16 v[224:227], v[44:47], a[208:211], v[224:227]
ds_read_b64_tr_b16 v[56:57], v15 offset:49152
v_mfma_f32_16x16x32_bf16 v[224:227], v[40:43], a[216:219], v[224:227]
ds_read_b64_tr_b16 v[58:59], v15 offset:53248
v_mfma_f32_16x16x32_bf16 v[228:231], v[40:43], a[220:223], v[228:231]
buffer_load_dwordx4 v[252:255], v0, s[76:79], s90 offen offset:2048 sc1
v_mfma_f32_16x16x32_bf16 v[228:231], v[44:47], a[212:215], v[228:231]
s_waitcnt lgkmcnt(2)
v_mfma_f32_16x16x32_bf16 v[216:219], v[52:55], v[104:107], v[216:219]
ds_read_b64_tr_b16 v[60:61], v15 offset:57344
v_mfma_f32_16x16x32_bf16 v[216:219], v[48:51], v[112:115], v[216:219]
ds_read_b64_tr_b16 v[62:63], v15 offset:61440
v_mfma_f32_16x16x32_bf16 v[220:223], v[48:51], v[116:119], v[220:223]
buffer_load_dwordx4 v[64:67], v0, s[76:79], s91 offen offset:0 sc1
v_mfma_f32_16x16x32_bf16 v[220:223], v[52:55], v[108:111], v[220:223]
v_mfma_f32_16x16x32_bf16 v[224:227], v[52:55], v[136:139], v[224:227]
buffer_load_dwordx4 v[68:71], v0, s[76:79], s88 offen offset:1024 sc1
v_mfma_f32_16x16x32_bf16 v[224:227], v[48:51], v[144:147], v[224:227]
v_mfma_f32_16x16x32_bf16 v[228:231], v[48:51], v[148:151], v[228:231]
buffer_load_dwordx4 v[96:99], v0, s[76:79], s88 offen offset:3072 sc1
v_mfma_f32_16x16x32_bf16 v[228:231], v[52:55], v[140:143], v[228:231]
s_waitcnt lgkmcnt(0)
v_mfma_f32_16x16x32_bf16 v[216:219], v[56:59], v[120:123], v[216:219]
buffer_load_dwordx4 v[100:103], v0, s[76:79], s89 offen offset:1024 sc1
v_mfma_f32_16x16x32_bf16 v[216:219], v[60:63], v[128:131], v[216:219]
v_mfma_f32_16x16x32_bf16 v[220:223], v[60:63], v[132:135], v[220:223]
buffer_load_dwordx4 v[200:203], v0, s[76:79], s89 offen offset:3072 sc1
v_mfma_f32_16x16x32_bf16 v[220:223], v[56:59], v[124:127], v[220:223]
v_mfma_f32_16x16x32_bf16 v[224:227], v[56:59], v[152:155], v[224:227]
buffer_load_dwordx4 v[204:207], v0, s[76:79], s90 offen offset:1024 sc1
v_mfma_f32_16x16x32_bf16 v[224:227], v[60:63], v[160:163], v[224:227]
v_mfma_f32_16x16x32_bf16 v[228:231], v[60:63], v[164:167], v[228:231]
buffer_load_dwordx4 v[208:211], v0, s[76:79], s90 offen offset:3072 sc1
v_mfma_f32_16x16x32_bf16 v[228:231], v[56:59], v[156:159], v[228:231]
buffer_load_dwordx4 v[212:215], v0, s[76:79], s91 offen offset:1024 sc1
LG_r0:
s_waitcnt vmcnt(6)
v_mfma_f32_16x16x32_bf16 v[72:75], v[186:189], v[232:235], v[216:219]
v_mfma_f32_16x16x32_bf16 v[76:79], v[184:187], v[232:235], v[220:223]
s_waitcnt vmcnt(5)
v_mfma_f32_16x16x32_bf16 v[72:75], v[186:189], v[236:239], v[72:75]
v_max3_u32 v24, v232, v236, 0
v_mfma_f32_16x16x32_bf16 v[76:79], v[184:187], v[236:239], v[76:79]
s_waitcnt vmcnt(4)
v_mfma_f32_16x16x32_bf16 v[72:75], v[186:189], v[240:243], v[72:75]
v_mfma_f32_16x16x32_bf16 v[76:79], v[184:187], v[240:243], v[76:79]
s_waitcnt vmcnt(3)
v_mfma_f32_16x16x32_bf16 v[72:75], v[186:189], v[244:247], v[72:75]
v_max3_u32 v24, v240, v244, v24
v_mfma_f32_16x16x32_bf16 v[76:79], v[184:187], v[244:247], v[76:79]
s_waitcnt vmcnt(2)
v_mfma_f32_16x16x32_bf16 v[72:75], v[186:189], v[248:251], v[72:75]
v_mfma_f32_16x16x32_bf16 v[76:79], v[184:187], v[248:251], v[76:79]
s_waitcnt vmcnt(1)
v_mfma_f32_16x16x32_bf16 v[72:75], v[186:189], v[252:255], v[72:75]
v_max3_u32 v24, v248, v252, v24
v_mfma_f32_16x16x32_bf16 v[76:79], v[184:187], v[252:255], v[76:79]
s_waitcnt vmcnt(0)
v_mfma_f32_16x16x32_bf16 v[72:75], v[186:189], v[64:67], v[72:75]
v_max3_u32 v24, v64, v232, v24
v_mfma_f32_16x16x32_bf16 v[76:79], v[184:187], v[64:67], v[76:79]
v_cmp_eq_u32 vcc, -1, v24
s_nop 4
s_cbranch_vccz LG_ok0
buffer_load_dwordx4 v[232:235], v0, s[76:79], s88 offen offset:0 sc1
buffer_load_dwordx4 v[236:239], v0, s[76:79], s88 offen offset:2048 sc1
buffer_load_dwordx4 v[240:243], v0, s[76:79], s89 offen offset:0 sc1
buffer_load_dwordx4 v[244:247], v0, s[76:79], s89 offen offset:2048 sc1
buffer_load_dwordx4 v[248:251], v0, s[76:79], s90 offen offset:0 sc1
buffer_load_dwordx4 v[252:255], v0, s[76:79], s90 offen offset:2048 sc1
buffer_load_dwordx4 v[64:67], v0, s[76:79], s91 offen offset:0 sc1
s_branch LG_r0
LG_ok0:
buffer_store_dwordx4 v[72:75], v2, s[68:71], s8 offen nt
buffer_store_dwordx4 v[76:79], v2, s[68:71], s9 offen nt
LG_r1:
s_waitcnt vmcnt(6)
v_mfma_f32_16x16x32_bf16 v[80:83], v[186:189], v[68:71], v[224:227]
v_mfma_f32_16x16x32_bf16 v[84:87], v[184:187], v[68:71], v[228:231]
s_waitcnt vmcnt(5)
v_mfma_f32_16x16x32_bf16 v[80:83], v[186:189], v[96:99], v[80:83]
v_max3_u32 v24, v68, v96, 0
v_mfma_f32_16x16x32_bf16 v[84:87], v[184:187], v[96:99], v[84:87]
s_waitcnt vmcnt(4)
v_mfma_f32_16x16x32_bf16 v[80:83], v[186:189], v[100:103], v[80:83]
v_mfma_f32_16x16x32_bf16 v[84:87], v[184:187], v[100:103], v[84:87]
s_waitcnt vmcnt(3)
v_mfma_f32_16x16x32_bf16 v[80:83], v[186:189], v[200:203], v[80:83]
v_max3_u32 v24, v100, v200, v24
v_mfma_f32_16x16x32_bf16 v[84:87], v[184:187], v[200:203], v[84:87]
s_waitcnt vmcnt(2)
v_mfma_f32_16x16x32_bf16 v[80:83], v[186:189], v[204:207], v[80:83]
v_mfma_f32_16x16x32_bf16 v[84:87], v[184:187], v[204:207], v[84:87]
s_waitcnt vmcnt(1)
v_mfma_f32_16x16x32_bf16 v[80:83], v[186:189], v[208:211], v[80:83]
v_max3_u32 v24, v204, v208, v24
v_mfma_f32_16x16x32_bf16 v[84:87], v[184:187], v[208:211], v[84:87]
s_waitcnt vmcnt(0)
v_mfma_f32_16x16x32_bf16 v[80:83], v[186:189], v[212:215], v[80:83]
v_max3_u32 v24, v212, v68, v24
v_mfma_f32_16x16x32_bf16 v[84:87], v[184:187], v[212:215], v[84:87]
v_cmp_eq_u32 vcc, -1, v24
s_nop 4
s_cbranch_vccz LG_ok1
buffer_load_dwordx4 v[68:71], v0, s[76:79], s88 offen offset:1024 sc1
buffer_load_dwordx4 v[96:99], v0, s[76:79], s88 offen offset:3072 sc1
buffer_load_dwordx4 v[100:103], v0, s[76:79], s89 offen offset:1024 sc1
buffer_load_dwordx4 v[200:203], v0, s[76:79], s89 offen offset:3072 sc1
buffer_load_dwordx4 v[204:207], v0, s[76:79], s90 offen offset:1024 sc1
buffer_load_dwordx4 v[208:211], v0, s[76:79], s90 offen offset:3072 sc1
buffer_load_dwordx4 v[212:215], v0, s[76:79], s91 offen offset:1024 sc1
s_branch LG_r1
LG_ok1:
buffer_store_dwordx4 v[80:83], v2, s[68:71], s10 offen nt
buffer_store_dwordx4 v[84:87], v2, s[68:71], s11 offen nt
LA_last:
s_endpgm
LA_redo:
s_mov_b32 s16, 1
s_waitcnt vmcnt(0)
buffer_load_dwordx4 a[0:3], v0, s[76:79], s94 offen offset:0 sc1
buffer_load_dwordx4 a[4:7], v0, s[76:79], s94 offen offset:1024 sc1
buffer_load_dwordx4 a[8:11], v0, s[76:79], s94 offen offset:2048 sc1
buffer_load_dwordx4 a[12:15], v0, s[76:79], s94 offen offset:3072 sc1
buffer_load_dwordx4 a[16:19], v0, s[76:79], s95 offen offset:0 sc1
buffer_load_dwordx4 a[20:23], v0, s[76:79], s95 offen offset:1024 sc1
buffer_load_dwordx4 a[24:27], v0, s[76:79], s95 offen offset:2048 sc1
buffer_load_dwordx4 a[28:31], v0, s[76:79], s95 offen offset:3072 sc1
v_bfe_u32 v24, v0, 4, 4
v_lshrrev_b32 v25, 8, v0
v_lshlrev_b32 v25, 2, v25
v_sub_u32 v24, v24, v25
s_lshl_b32 s34, s82, 7
s_lshl_b32 s35, s80, 4
s_add_u32 s33, s34, s35
v_add_u32 v26, s33, v24
s_sub_u32 s33, s34, s35
s_add_u32 s33, s33, 112
v_add_u32 v27, s33, v24
s_sub_u32 s33, s35, s34
s_add_u32 s33, s33, 1920
v_add_u32 v28, s33, v24
s_add_u32 s33, s34, s35
s_sub_u32 s33, 2032, s33
v_add_u32 v29, s33, v24
v_mov_b32 v30, 0xff800000
s_mov_b32 s34, 0
v_mov_b32 v32, v30
v_mov_b32 v33, v30
v_mov_b32 v34, v30
v_mov_b32 v35, v30
LA_mx:
s_add_u32 s35, s34, 4096
buffer_load_dwordx4 a[96:99], v0, s[20:23], s34 offen offset:0 sc1
buffer_load_dwordx4 a[100:103], v0, s[20:23], s34 offen offset:1024 sc1
buffer_load_dwordx4 a[104:107], v0, s[20:23], s34 offen offset:2048 sc1
buffer_load_dwordx4 a[108:111], v0, s[20:23], s34 offen offset:3072 sc1
buffer_load_dwordx4 a[112:115], v0, s[20:23], s35 offen offset:0 sc1
buffer_load_dwordx4 a[116:119], v0, s[20:23], s35 offen offset:1024 sc1
buffer_load_dwordx4 a[120:123], v0, s[20:23], s35 offen offset:2048 sc1
buffer_load_dwordx4 a[124:127], v0, s[20:23], s35 offen offset:3072 sc1
s_waitcnt vmcnt(7) lgkmcnt(5)
v_mfma_f32_16x16x32_bf16 v[200:203], a[96:99], a[0:3], 0
s_waitcnt lgkmcnt(4)
v_mfma_f32_16x16x32_bf16 v[204:207], a[96:99], a[16:19], 0
s_waitcnt lgkmcnt(2)
v_mfma_f32_16x16x32_bf16 v[208:211], a[96:99], a[32:35], 0
s_waitcnt lgkmcnt(0)
v_mfma_f32_16x16x32_bf16 v[212:215], a[96:99], a[48:51], 0
s_waitcnt vmcnt(6)
v_mfma_f32_16x16x32_bf16 v[200:203], a[100:103], a[4:7], v[200:203]
v_mfma_f32_16x16x32_bf16 v[204:207], a[100:103], a[20:23], v[204:207]
v_mfma_f32_16x16x32_bf16 v[208:211], a[100:103], a[36:39], v[208:211]
v_mfma_f32_16x16x32_bf16 v[212:215], a[100:103], a[52:55], v[212:215]
s_waitcnt vmcnt(5)
v_mfma_f32_16x16x32_bf16 v[200:203], a[104:107], a[8:11], v[200:203]
v_mfma_f32_16x16x32_bf16 v[204:207], a[104:107], a[24:27], v[204:207]
v_mfma_f32_16x16x32_bf16 v[208:211], a[104:107], a[40:43], v[208:211]
v_mfma_f32_16x16x32_bf16 v[212:215], a[104:107], a[56:59], v[212:215]
s_waitcnt vmcnt(4)
v_mfma_f32_16x16x32_bf16 v[200:203], a[108:111], a[12:15], v[200:203]
v_mfma_f32_16x16x32_bf16 v[204:207], a[108:111], a[28:31], v[204:207]
v_mfma_f32_16x16x32_bf16 v[208:211], a[108:111], a[44:47], v[208:211]
v_mfma_f32_16x16x32_bf16 v[212:215], a[108:111], a[60:63], v[212:215]
s_waitcnt vmcnt(3)
v_mfma_f32_16x16x32_bf16 v[216:219], a[112:115], a[0:3], 0
v_mfma_f32_16x16x32_bf16 v[220:223], a[112:115], a[16:19], 0
v_mfma_f32_16x16x32_bf16 v[224:227], a[112:115], a[32:35], 0
v_mfma_f32_16x16x32_bf16 v[228:231], a[112:115], a[48:51], 0
s_waitcnt vmcnt(2)
v_mfma_f32_16x16x32_bf16 v[216:219], a[116:119], a[4:7], v[216:219]
v_mfma_f32_16x16x32_bf16 v[220:223], a[116:119], a[20:23], v[220:223]
v_mfma_f32_16x16x32_bf16 v[224:227], a[116:119], a[36:39], v[224:227]
v_mfma_f32_16x16x32_bf16 v[228:231], a[116:119], a[52:55], v[228:231]
s_waitcnt vmcnt(1)
v_mfma_f32_16x16x32_bf16 v[216:219], a[120:123], a[8:11], v[216:219]
v_mfma_f32_16x16x32_bf16 v[220:223], a[120:123], a[24:27], v[220:223]
v_mfma_f32_16x16x32_bf16 v[224:227], a[120:123], a[40:43], v[224:227]
v_mfma_f32_16x16x32_bf16 v[228:231], a[120:123], a[56:59], v[228:231]
s_waitcnt vmcnt(0)
v_mfma_f32_16x16x32_bf16 v[216:219], a[124:127], a[12:15], v[216:219]
v_mfma_f32_16x16x32_bf16 v[220:223], a[124:127], a[28:31], v[220:223]
v_mfma_f32_16x16x32_bf16 v[224:227], a[124:127], a[44:47], v[224:227]
v_mfma_f32_16x16x32_bf16 v[228:231], a[124:127], a[60:63], v[228:231]
v_cmp_le_i32 vcc, 0, v26
s_nop 1
v_cndmask_b32 v200, v30, v200, vcc
v_max_f32 v32, v32, v200
v_cmp_le_i32 vcc, 1, v26
s_nop 1
v_cndmask_b32 v201, v30, v201, vcc
v_max_f32 v32, v32, v201
v_cmp_le_i32 vcc, 2, v26
s_nop 1
v_cndmask_b32 v202, v30, v202, vcc
v_max_f32 v32, v32, v202
v_cmp_le_i32 vcc, 3, v26
s_nop 1
v_cndmask_b32 v203, v30, v203, vcc
v_max_f32 v32, v32, v203
v_cmp_le_i32 vcc, 0, v27
s_nop 1
v_cndmask_b32 v204, v30, v204, vcc
v_max_f32 v33, v33, v204
v_cmp_le_i32 vcc, 1, v27
s_nop 1
v_cndmask_b32 v205, v30, v205, vcc
v_max_f32 v33, v33, v205
v_cmp_le_i32 vcc, 2, v27
s_nop 1
v_cndmask_b32 v206, v30, v206, vcc
v_max_f32 v33, v33, v206
v_cmp_le_i32 vcc, 3, v27
s_nop 1
v_cndmask_b32 v207, v30, v207, vcc
v_max_f32 v33, v33, v207
v_cmp_le_i32 vcc, 0, v28
s_nop 1
v_cndmask_b32 v208, v30, v208, vcc
v_max_f32 v34, v34, v208
v_cmp_le_i32 vcc, 1, v28
s_nop 1
v_cndmask_b32 v209, v30, v209, vcc
v_max_f32 v34, v34, v209
v_cmp_le_i32 vcc, 2, v28
s_nop 1
v_cndmask_b32 v210, v30, v210, vcc
v_max_f32 v34, v34, v210
v_cmp_le_i32 vcc, 3, v28
s_nop 1
v_cndmask_b32 v211, v30, v211, vcc
v_max_f32 v34, v34, v211
v_cmp_le_i32 vcc, 0, v29
s_nop 1
v_cndmask_b32 v212, v30, v212, vcc
v_max_f32 v35, v35, v212
v_cmp_le_i32 vcc, 1, v29
s_nop 1
v_cndmask_b32 v213, v30, v213, vcc
v_max_f32 v35, v35, v213
v_cmp_le_i32 vcc, 2, v29
s_nop 1
v_cndmask_b32 v214, v30, v214, vcc
v_max_f32 v35, v35, v214
v_cmp_le_i32 vcc, 3, v29
s_nop 1
v_cndmask_b32 v215, v30, v215, vcc
v_max_f32 v35, v35, v215
v_cmp_le_i32 vcc, 16, v26
s_nop 1
v_cndmask_b32 v216, v30, v216, vcc
v_max_f32 v32, v32, v216
v_cmp_le_i32 vcc, 17, v26
s_nop 1
v_cndmask_b32 v217, v30, v217, vcc
v_max_f32 v32, v32, v217
v_cmp_le_i32 vcc, 18, v26
s_nop 1
v_cndmask_b32 v218, v30, v218, vcc
v_max_f32 v32, v32, v218
v_cmp_le_i32 vcc, 19, v26
s_nop 1
v_cndmask_b32 v219, v30, v219, vcc
v_max_f32 v32, v32, v219
v_cmp_le_i32 vcc, 16, v27
s_nop 1
v_cndmask_b32 v220, v30, v220, vcc
v_max_f32 v33, v33, v220
v_cmp_le_i32 vcc, 17, v27
s_nop 1
v_cndmask_b32 v221, v30, v221, vcc
v_max_f32 v33, v33, v221
v_cmp_le_i32 vcc, 18, v27
s_nop 1
v_cndmask_b32 v222, v30, v222, vcc
v_max_f32 v33, v33, v222
v_cmp_le_i32 vcc, 19, v27
s_nop 1
v_cndmask_b32 v223, v30, v223, vcc
v_max_f32 v33, v33, v223
v_cmp_le_i32 vcc, 16, v28
s_nop 1
v_cndmask_b32 v224, v30, v224, vcc
v_max_f32 v34, v34, v224
v_cmp_le_i32 vcc, 17, v28
s_nop 1
v_cndmask_b32 v225, v30, v225, vcc
v_max_f32 v34, v34, v225
v_cmp_le_i32 vcc, 18, v28
s_nop 1
v_cndmask_b32 v226, v30, v226, vcc
v_max_f32 v34, v34, v226
v_cmp_le_i32 vcc, 19, v28
s_nop 1
v_cndmask_b32 v227, v30, v227, vcc
v_max_f32 v34, v34, v227
v_cmp_le_i32 vcc, 16, v29
s_nop 1
v_cndmask_b32 v228, v30, v228, vcc
v_max_f32 v35, v35, v228
v_cmp_le_i32 vcc, 17, v29
s_nop 1
v_cndmask_b32 v229, v30, v229, vcc
v_max_f32 v35, v35, v229
v_cmp_le_i32 vcc, 18, v29
s_nop 1
v_cndmask_b32 v230, v30, v230, vcc
v_max_f32 v35, v35, v230
v_cmp_le_i32 vcc, 19, v29
s_nop 1
v_cndmask_b32 v231, v30, v231, vcc
v_max_f32 v35, v35, v231
v_subrev_u32 v26, 32, v26
v_subrev_u32 v27, 32, v27
v_subrev_u32 v28, 32, v28
v_subrev_u32 v29, 32, v29
s_add_u32 s34, s34, 16384
s_cmp_lt_u32 s34, s22
s_cbranch_scc1 LA_mx
s_lshl_b32 s34, s80, 10
s_add_u32 s34, s34, 151552
v_add_u32 v24, s34, v0
ds_write_b128 v24, v[32:35]
v_and_b32 v25, 0xf0, v0
v_add_u32 v25, s34, v25
v_xor_b32 v26, 2048, v25
s_waitcnt lgkmcnt(0)
s_barrier
ds_read_b128 v[200:203], v25 offset:0
ds_read_b128 v[204:207], v25 offset:256
ds_read_b128 v[208:211], v25 offset:512
ds_read_b128 v[212:215], v25 offset:768
ds_read_b128 v[216:219], v26 offset:0
ds_read_b128 v[220:223], v26 offset:256
ds_read_b128 v[224:227], v26 offset:512
ds_read_b128 v[228:231], v26 offset:768
s_waitcnt lgkmcnt(5)
v_max3_f32 v24, v200, v204, v208
s_waitcnt lgkmcnt(4)
v_max_f32 v24, v24, v212
v_sub_f32 v40, 0, v24
v_sub_f32 v41, 0, v24
v_sub_f32 v42, 0, v24
v_sub_f32 v43, 0, v24
v_max3_f32 v24, v201, v205, v209
v_max_f32 v24, v24, v213
v_sub_f32 v44, 0, v24
v_sub_f32 v45, 0, v24
v_sub_f32 v46, 0, v24
v_sub_f32 v47, 0, v24
v_max3_f32 v24, v202, v206, v210
v_max_f32 v24, v24, v214
v_sub_f32 v48, 0, v24
v_sub_f32 v49, 0, v24
v_sub_f32 v50, 0, v24
v_sub_f32 v51, 0, v24
v_max3_f32 v24, v203, v207, v211
v_max_f32 v24, v24, v215
v_sub_f32 v52, 0, v24
v_sub_f32 v53, 0, v24
v_sub_f32 v54, 0, v24
v_sub_f32 v55, 0, v24
s_waitcnt lgkmcnt(1)
v_max3_f32 v24, v218, v222, v226
s_waitcnt lgkmcnt(0)
v_max_f32 v24, v24, v230
v_sub_f32 v56, 0, v24
v_sub_f32 v57, 0, v24
v_sub_f32 v58, 0, v24
v_sub_f32 v59, 0, v24
v_max3_f32 v24, v219, v223, v227
v_max_f32 v24, v24, v231
v_sub_f32 v60, 0, v24
v_sub_f32 v61, 0, v24
v_sub_f32 v62, 0, v24
v_sub_f32 v63, 0, v24
v_accvgpr_write_b32 a224, 0
v_accvgpr_write_b32 a225, 0
v_accvgpr_write_b32 a226, 0
v_accvgpr_write_b32 a227, 0
v_accvgpr_write_b32 a228, 0
v_accvgpr_write_b32 a229, 0
v_accvgpr_write_b32 a230, 0
v_accvgpr_write_b32 a231, 0
v_accvgpr_write_b32 a232, 0
v_accvgpr_write_b32 a233, 0
v_accvgpr_write_b32 a234, 0
v_accvgpr_write_b32 a235, 0
v_accvgpr_write_b32 a236, 0
v_accvgpr_write_b32 a237, 0
v_accvgpr_write_b32 a238, 0
v_accvgpr_write_b32 a239, 0
v_mov_b32 v72, 0
v_mov_b32 v73, 0
v_mov_b32 v74, 0
v_mov_b32 v75, 0
v_mov_b32 v76, 0
v_mov_b32 v77, 0
v_mov_b32 v78, 0
v_mov_b32 v79, 0
v_mov_b32 v80, 0
v_mov_b32 v81, 0
v_mov_b32 v82, 0
v_mov_b32 v83, 0
v_mov_b32 v84, 0
v_mov_b32 v85, 0
v_mov_b32 v86, 0
v_mov_b32 v87, 0
v_mov_b32 v88, 0
v_mov_b32 v89, 0
v_mov_b32 v90, 0
v_mov_b32 v91, 0
v_mov_b32 v92, 0
v_mov_b32 v93, 0
v_mov_b32 v94, 0
v_mov_b32 v95, 0
v_mov_b32 v96, 0
v_mov_b32 v97, 0
v_mov_b32 v98, 0
v_mov_b32 v99, 0
v_mov_b32 v100, 0
v_mov_b32 v101, 0
v_mov_b32 v102, 0
v_mov_b32 v103, 0
v_mov_b32 v104, 0
v_mov_b32 v105, 0
v_mov_b32 v106, 0
v_mov_b32 v107, 0
v_mov_b32 v108, 0
v_mov_b32 v109, 0
v_mov_b32 v110, 0
v_mov_b32 v111, 0
v_mov_b32 v112, 0
v_mov_b32 v113, 0
v_mov_b32 v114, 0
v_mov_b32 v115, 0
v_mov_b32 v116, 0
v_mov_b32 v117, 0
v_mov_b32 v118, 0
v_mov_b32 v119, 0
v_mov_b32 v120, 0
v_mov_b32 v121, 0
v_mov_b32 v122, 0
v_mov_b32 v123, 0
v_mov_b32 v124, 0
v_mov_b32 v125, 0
v_mov_b32 v126, 0
v_mov_b32 v127, 0
v_mov_b32 v128, 0
v_mov_b32 v129, 0
v_mov_b32 v130, 0
v_mov_b32 v131, 0
v_mov_b32 v132, 0
v_mov_b32 v133, 0
v_mov_b32 v134, 0
v_mov_b32 v135, 0
v_mov_b32 v136, 0
v_mov_b32 v137, 0
v_mov_b32 v138, 0
v_mov_b32 v139, 0
v_mov_b32 v140, 0
v_mov_b32 v141, 0
v_mov_b32 v142, 0
v_mov_b32 v143, 0
v_mov_b32 v144, 0
v_mov_b32 v145, 0
v_mov_b32 v146, 0
v_mov_b32 v147, 0
v_mov_b32 v148, 0
v_mov_b32 v149, 0
v_mov_b32 v150, 0
v_mov_b32 v151, 0
v_mov_b32 v152, 0
v_mov_b32 v153, 0
v_mov_b32 v154, 0
v_mov_b32 v155, 0
v_mov_b32 v156, 0
v_mov_b32 v157, 0
v_mov_b32 v158, 0
v_mov_b32 v159, 0
v_mov_b32 v160, 0
v_mov_b32 v161, 0
v_mov_b32 v162, 0
v_mov_b32 v163, 0
s_barrier
ds_write_b128 v23, a[64:67] offset:0
ds_write_b128 v23, a[68:71] offset:1024
ds_write_b128 v23, a[72:75] offset:2048
ds_write_b128 v23, a[76:79] offset:3072
ds_write_b128 v23, a[80:83] offset:4096
ds_write_b128 v23, a[84:87] offset:5120
ds_write_b128 v23, a[88:91] offset:6144
ds_write_b128 v23, a[92:95] offset:7168
s_and_b32 s3, s80, 1
s_lshr_b32 s33, s80, 1
s_lshl_b32 s34, s3, 12
s_add_u32 s9, s34, 16384
s_add_u32 s10, s34, 81920
s_cmp_eq_u32 s33, 0
s_cselect_b32 s6, s9, s10
s_cselect_b32 s5, 0, 40960
s_cselect_b32 s4, 40960, 0
s_cselect_b32 s14, 16384, 0
s_add_u32 s14, s14, 8192
s_add_u32 s4, s4, s34
s_add_u32 s4, s4, 90112
s_cmp_eq_u32 s82, 7
s_cselect_b32 s15, s14, 16384
s_lshl_b32 s35, s82, 2
s_add_u32 s35, s35, s33
s_add_u32 s35, s35, 14
s_lshl_b32 s7, s35, 14
s_add_u32 s7, s7, s34
s_lshl_b32 s8, s35, 13
s_and_b32 s8, s8, 0xffff
s_mov_b32 s11, 8192
s_mov_b32 s12, 0
v_add_u32 v1, 8192, v0
v_add_u32 v3, 81920, v0
v_add_u32 v2, 81920, v0
s_waitcnt lgkmcnt(0)
s_barrier
s_add_u32 m0, s101, -81920
s_add_u32 s74, s101, 4294868992
buffer_load_dwordx4 v0, s[20:23], s74 offen offset:0 sc1 lds
buffer_load_dwordx4 v0, s[20:23], s74 offen offset:1024 sc1 lds
s_add_u32 m0, s101, -73728
s_add_u32 s74, s101, 4294885376
buffer_load_dwordx4 v0, s[20:23], s74 offen offset:0 sc1 lds
buffer_load_dwordx4 v0, s[20:23], s74 offen offset:1024 sc1 lds
s_add_u32 m0, s101, -65536
s_add_u32 s74, s101, 4294901760
buffer_load_dwordx4 v0, s[20:23], s74 offen offset:0 sc1 lds
buffer_load_dwordx4 v0, s[20:23], s74 offen offset:1024 sc1 lds
s_add_u32 m0, s101, -57344
s_add_u32 s74, s101, 4294918144
buffer_load_dwordx4 v0, s[20:23], s74 offen offset:0 sc1 lds
buffer_load_dwordx4 v0, s[20:23], s74 offen offset:1024 sc1 lds
s_add_u32 m0, s101, -49152
s_add_u32 s74, s101, 4294934528
buffer_load_dwordx4 v0, s[20:23], s74 offen offset:0 sc1 lds
buffer_load_dwordx4 v0, s[20:23], s74 offen offset:1024 sc1 lds
s_add_u32 m0, s101, -40960
s_add_u32 s74, s101, 4294950912
buffer_load_dwordx4 v0, s[20:23], s74 offen offset:0 sc1 lds
buffer_load_dwordx4 v0, s[20:23], s74 offen offset:1024 sc1 lds
s_add_u32 m0, s101, -32768
s_add_u32 s74, s101, 0
buffer_load_dwordx4 v0, s[20:23], s74 offen offset:0 sc1 lds
buffer_load_dwordx4 v0, s[20:23], s74 offen offset:1024 sc1 lds
s_add_u32 m0, s101, -24576
s_add_u32 s74, s101, 16384
buffer_load_dwordx4 v0, s[20:23], s74 offen offset:0 sc1 lds
buffer_load_dwordx4 v0, s[20:23], s74 offen offset:1024 sc1 lds
s_add_u32 m0, s101, -16384
s_add_u32 s74, s101, 4294877184
buffer_load_dwordx4 v0, s[20:23], s74 offen offset:0 sc1 lds
buffer_load_dwordx4 v0, s[20:23], s74 offen offset:1024 sc1 lds
s_add_u32 m0, s101, -8192
s_add_u32 s74, s101, 4294893568
buffer_load_dwordx4 v0, s[20:23], s74 offen offset:0 sc1 lds
buffer_load_dwordx4 v0, s[20:23], s74 offen offset:1024 sc1 lds
s_add_u32 m0, s101, 0
s_add_u32 s74, s101, 4294909952
buffer_load_dwordx4 v0, s[20:23], s74 offen offset:0 sc1 lds
buffer_load_dwordx4 v0, s[20:23], s74 offen offset:1024 sc1 lds
s_add_u32 m0, s101, 8192
s_add_u32 s74, s101, 4294926336
buffer_load_dwordx4 v0, s[20:23], s74 offen offset:0 sc1 lds
buffer_load_dwordx4 v0, s[20:23], s74 offen offset:1024 sc1 lds
s_add_u32 m0, s101, 16384
s_add_u32 s74, s101, 4294942720
buffer_load_dwordx4 v0, s[20:23], s74 offen offset:0 sc1 lds
buffer_load_dwordx4 v0, s[20:23], s74 offen offset:1024 sc1 lds
s_waitcnt vmcnt(0)
s_barrier
s_branch LA_att
.section .rodata,"a"
.p2align 6
.amdhsa_kernel gated_mix__compressed_kv_cla__ssm_conv_s5__prompt_kernel
.amdhsa_next_free_vgpr 512
.amdhsa_next_free_sgpr 102
.amdhsa_accum_offset 256
.amdhsa_group_segment_fixed_size 0
.amdhsa_kernarg_size 152
.amdhsa_user_sgpr_count 2
.amdhsa_user_sgpr_kernarg_segment_ptr 1
.amdhsa_system_sgpr_workgroup_id_x 1
.end_amdhsa_kernel
```
